```python
import torch

def _softmax(x, axis=-1):
    return torch.softmax(x, dim=axis)
def _gelu(x):
    return torch.nn.functional.gelu(x, approximate="tanh")
def _silu(x):
    return torch.nn.functional.silu(x)
def _sigmoid(x):
    return torch.sigmoid(x)
def _layernorm(x, axis=-1, eps=1e-5):
    m = x.mean(dim=axis, keepdim=True)
    v = x.var(dim=axis, keepdim=True, unbiased=False)
    return (x - m) / torch.sqrt(v + eps)
def _scatter_add(tgt, idx, src, axis=0):
    return tgt.clone().index_add_(axis, idx, src)
def _segment_sum(src, seg, n):
    out = torch.zeros((n,) + src.shape[1:], dtype=src.dtype)
    return out.index_add_(0, seg, src)
def _pad(x, pw):
    flat = tuple(v for pair in reversed(pw) for v in pair)
    return torch.nn.functional.pad(x, flat)

kernel_name = 'sequential_preLN__ssm_conv_s4__moe_arch_mod__prompt'

def setup_inputs():

    _w = (lambda a: (lambda t: t.to(torch.bfloat16) if t.is_floating_point() else t)(torch.as_tensor(a)))
    def _A_setup():
        B, L, D, N = 1, 2048, 576, 128
        A_re = -(lambda _x: torch.exp(torch.as_tensor(_x)))((lambda *s: torch.randn(*s, dtype=torch.bfloat16) * 1.6)(D, N))
        A_im = torch.pi * (lambda *s: torch.randn(*s, dtype=torch.bfloat16) * 0.2)(D, N)
        B_re = (lambda *s: torch.randn(*s, dtype=torch.bfloat16) * 0.2)(D, N)
        B_im = (lambda *s: torch.randn(*s, dtype=torch.bfloat16) * 0.2)(D, N)
        C_re = (lambda *s: torch.randn(*s, dtype=torch.bfloat16) * 0.2)(D, N)
        C_im = (lambda *s: torch.randn(*s, dtype=torch.bfloat16) * 0.2)(D, N)
        log_dt = (lambda *s: torch.randn(*s, dtype=torch.bfloat16) * 0.2)(D) * 0.5 - 4.0
        Dskip = (lambda *s: torch.randn(*s, dtype=torch.bfloat16) * 0.2)(D)
        return {
            "u": _w((lambda *s: torch.randn(*s, dtype=torch.bfloat16) * 0.05)(B, L, D)),
            "A_re": _w(A_re),
            "A_im": _w(A_im),
            "B_re": _w(B_re),
            "B_im": _w(B_im),
            "C_re": _w(C_re),
            "C_im": _w(C_im),
            "log_dt": _w(log_dt),
            "Dskip": _w(Dskip),
        }
    _A_in = _A_setup()

    def _B_setup():
        B, S, D, F, C = 1, 2048, 576, 4608, 8
        return {
            "x": _w((lambda *s: torch.randn(*s, dtype=torch.bfloat16) * 0.05)(B, S, D)),
            "w_r": _w((lambda *s: torch.randn(*s, dtype=torch.bfloat16) * 0.2)(D)),
            "w_gate": _w((lambda *s: torch.randn(*s, dtype=torch.bfloat16) * 0.2)(D, F)),
            "w_up": _w((lambda *s: torch.randn(*s, dtype=torch.bfloat16) * 0.2)(D, F)),
            "w_down": _w((lambda *s: torch.randn(*s, dtype=torch.bfloat16) * 0.2)(F, D)),
        }
    _B_in = _B_setup()

    return {
        "A_u": _A_in["u"],
        "A_A_re": _A_in["A_re"],
        "A_A_im": _A_in["A_im"],
        "A_B_re": _A_in["B_re"],
        "A_B_im": _A_in["B_im"],
        "A_C_re": _A_in["C_re"],
        "A_C_im": _A_in["C_im"],
        "A_log_dt": _A_in["log_dt"],
        "A_Dskip": _A_in["Dskip"],
        "B_x": _B_in["x"],
        "B_w_r": _B_in["w_r"],
        "B_w_gate": _B_in["w_gate"],
        "B_w_up": _B_in["w_up"],
        "B_w_down": _B_in["w_down"],
    }

def reference(A_u, A_A_re, A_A_im, A_B_re, A_B_im, A_C_re, A_C_im, A_log_dt, A_Dskip, B_x, B_w_r, B_w_gate, B_w_up, B_w_down):
    def _A_ref(u, A_re, A_im, B_re, B_im, C_re, C_im, log_dt, Dskip):
        Bsz, L, D = u.shape
        dt = torch.exp(log_dt)[:, None]
        A = A_re + 1j * A_im
        Bc = B_re + 1j * B_im
        Cc = C_re + 1j * C_im
        logdA = dt * A
        dB = dt * Bc
        l = (lambda x, dt: x.to(dt))(torch.arange(L), A_re.dtype)
        P = torch.exp(logdA[:, :, None] * l[None, None, :])
        K = torch.einsum("dn,dnl,dn->dl", Cc, P, dB).real
        L2 = 2 * L
        Kp = _pad(K, ((0, 0), (0, L)))
        up = (lambda x, *d: x.permute(*d))(u, 0, 2, 1)
        up = _pad(up, ((0, 0), (0, 0), (0, L)))
        Kf = (lambda x, axes=(-2,-1): torch.fft.rfft2(x.float(), dim=axes))(Kp[:, None, :], axes=(-2, -1))
        Uf = (lambda x, axes=(-2,-1): torch.fft.rfft2(x.float(), dim=axes))(up[:, :, None, :], axes=(-2, -1))
        Yf = Uf * Kf[None, :, :, :]
        y = (lambda x, s, axes=(-2,-1): torch.fft.irfft2(x, s=s, dim=axes).to(torch.bfloat16))(Yf, (1, L2), axes=(-2, -1))[:, :, 0, :L]
        y = (lambda x, *d: x.permute(*d))(y, 0, 2, 1) + u * Dskip[None, None, :]
        return y

    def _B_ref(x, w_r, w_gate, w_up, w_down):
        B, S, D = x.shape
        C = 8
        r = x @ w_r
        idx = torch.argsort(-r, axis=-1)[:, :C]
        idx_e = (lambda x, n, axis: torch.repeat_interleave(x, n, dim=axis))(idx.reshape(B, C, 1), D, axis=2)
        x_sel = (lambda x, i, axis: torch.take_along_dim(x, i, dim=axis))(x, idx_e, axis=1)
        g = _silu(x_sel @ w_gate)
        u = x_sel @ w_up
        y = (g * u) @ w_down
        r_sel = _sigmoid((lambda x, i, axis: torch.take_along_dim(x, i, dim=axis))(r, idx, axis=1))
        y = y * r_sel.reshape(B, C, 1)
        b_off = (torch.arange(B) * S).reshape(B, 1)
        flat_idx = (idx + b_off).reshape(B * C)
        zero = (x * 0.0).reshape(B * S, D)
        upd = _scatter_add(zero, flat_idx, y.reshape(B * C, D), axis=0)
        return x + upd.reshape(B, S, D)

    x = A_u
    h = x + _A_ref(_layernorm(x, axis=-1), A_A_re, A_A_im, A_B_re, A_B_im, A_C_re, A_C_im, A_log_dt, A_Dskip)
    h2 = h + _B_ref(_layernorm(h, axis=-1), B_w_r, B_w_gate, B_w_up, B_w_down)
    return h2
```

```asm
; @launch kernel=k1_kernel grid=(832,1,1) block=(256,1,1) lds=36352
; @launch kernel=k2_kernel grid=(576,1,1) block=(256,1,1) lds=47360
; @launch kernel=k3_kernel grid=(256,1,1) block=(256,1,1) lds=9216
; @launch kernel=k4_kernel grid=(144,1,1) block=(576,1,1) lds=19968
; @launch kernel=k5_kernel grid=(72,1,1) block=(256,1,1) lds=4096
.amdgcn_target "amdgcn-amd-amdhsa--gfx950"
.text
.globl k1_kernel
.p2align 8
.type k1_kernel,@function
k1_kernel:
    s_cmp_ge_u32 s2, 832
    s_cbranch_scc1 K1_END
    s_cmp_ge_u32 s2, 256
    s_cbranch_scc1 K1_KGEN
    s_load_dwordx2 s[4:5], s[0:1], 0
    s_load_dwordx2 s[6:7], s[0:1], 128
    v_lshrrev_b32 v1, 5, v0
    v_and_b32 v2, 31, v0
    v_mul_u32_u24 v3, 1152, v1
    v_lshl_add_u32 v3, v2, 2, v3
    s_mul_i32 s3, s2, 9216
    s_waitcnt lgkmcnt(0)
    s_mov_b32 s8, s4
    s_mov_b32 s9, s5
    s_mov_b32 s10, 0x240000
    s_mov_b32 s11, 0x20000
    s_mov_b32 s12, s6
    s_mov_b32 s13, s7
    s_mov_b32 s14, 0x240000
    s_mov_b32 s15, 0x20000
    buffer_load_dword v10, v3, s[8:11], s3 offen offset:0
    buffer_load_dword v11, v3, s[8:11], s3 offen offset:128
    buffer_load_dword v12, v3, s[8:11], s3 offen offset:256
    buffer_load_dword v13, v3, s[8:11], s3 offen offset:384
    buffer_load_dword v14, v3, s[8:11], s3 offen offset:512
    buffer_load_dword v15, v3, s[8:11], s3 offen offset:640
    buffer_load_dword v16, v3, s[8:11], s3 offen offset:768
    buffer_load_dword v17, v3, s[8:11], s3 offen offset:896
    buffer_load_dword v18, v3, s[8:11], s3 offen offset:1024
    v_lshrrev_b32 v4, 6, v0
    v_mul_u32_u24 v4, 2304, v4
    v_lshl_add_u32 v4, v2, 3, v4
    v_and_b32 v5, 1, v1
    v_lshl_add_u32 v4, v5, 2, v4
    v_mul_u32_u24 v5, 0x020202, v5
    v_lshlrev_b32 v6, 25, v1
    v_and_b32 v6, 0x02000000, v6
    v_or_b32 v5, v5, v6
    v_add_u32 v5, 0x05040100, v5
    s_waitcnt vmcnt(8)
    v_lshlrev_b32 v20, 16, v10
    v_and_b32 v21, 0xffff0000, v10
    s_waitcnt vmcnt(7)
    v_lshlrev_b32 v22, 16, v11
    v_and_b32 v23, 0xffff0000, v11
    s_waitcnt vmcnt(6)
    v_lshlrev_b32 v24, 16, v12
    v_and_b32 v25, 0xffff0000, v12
    s_waitcnt vmcnt(5)
    v_lshlrev_b32 v26, 16, v13
    v_and_b32 v27, 0xffff0000, v13
    s_waitcnt vmcnt(4)
    v_lshlrev_b32 v28, 16, v14
    v_and_b32 v29, 0xffff0000, v14
    s_waitcnt vmcnt(3)
    v_lshlrev_b32 v30, 16, v15
    v_and_b32 v31, 0xffff0000, v15
    s_waitcnt vmcnt(2)
    v_lshlrev_b32 v32, 16, v16
    v_and_b32 v33, 0xffff0000, v16
    s_waitcnt vmcnt(1)
    v_lshlrev_b32 v34, 16, v17
    v_and_b32 v35, 0xffff0000, v17
    s_waitcnt vmcnt(0)
    v_lshlrev_b32 v36, 16, v18
    v_and_b32 v37, 0xffff0000, v18
    v_pk_add_f32 v[44:45], v[20:21], v[22:23]
    v_pk_add_f32 v[46:47], v[24:25], v[26:27]
    v_pk_add_f32 v[44:45], v[44:45], v[28:29]
    v_pk_add_f32 v[46:47], v[46:47], v[30:31]
    v_pk_add_f32 v[44:45], v[44:45], v[32:33]
    v_pk_add_f32 v[46:47], v[46:47], v[34:35]
    v_pk_add_f32 v[44:45], v[44:45], v[36:37]
    v_pk_add_f32 v[44:45], v[44:45], v[46:47]
    v_add_f32 v44, v44, v45
    s_nop 1
    v_add_f32_dpp v44, v44, v44 row_ror:8 row_mask:0xf bank_mask:0xf
    s_nop 1
    v_add_f32_dpp v44, v44, v44 row_ror:4 row_mask:0xf bank_mask:0xf
    s_nop 1
    v_add_f32_dpp v44, v44, v44 row_ror:2 row_mask:0xf bank_mask:0xf
    s_nop 1
    v_add_f32_dpp v44, v44, v44 row_ror:1 row_mask:0xf bank_mask:0xf
    v_mov_b32 v46, v44
    s_nop 1
    v_permlane16_swap_b32 v44, v46
    v_add_f32 v44, v44, v46
    v_mul_f32 v48, 0x3ae38e39, v44
    v_mov_b32 v49, v48
    v_cvt_pk_bf16_f32 v40, v48, v48
    v_and_b32 v40, 0xffff0000, v40
    v_mov_b32 v41, v40
    v_pk_add_f32 v[42:43], v[20:21], v[48:49] neg_lo:[0,1] neg_hi:[0,1]
    v_pk_mul_f32 v[44:45], v[42:43], v[42:43]
    v_pk_add_f32 v[42:43], v[22:23], v[48:49] neg_lo:[0,1] neg_hi:[0,1]
    v_pk_mul_f32 v[46:47], v[42:43], v[42:43]
    v_pk_add_f32 v[42:43], v[24:25], v[48:49] neg_lo:[0,1] neg_hi:[0,1]
    v_pk_fma_f32 v[44:45], v[42:43], v[42:43], v[44:45]
    v_pk_add_f32 v[42:43], v[26:27], v[48:49] neg_lo:[0,1] neg_hi:[0,1]
    v_pk_fma_f32 v[46:47], v[42:43], v[42:43], v[46:47]
    v_pk_add_f32 v[42:43], v[28:29], v[48:49] neg_lo:[0,1] neg_hi:[0,1]
    v_pk_fma_f32 v[44:45], v[42:43], v[42:43], v[44:45]
    v_pk_add_f32 v[42:43], v[30:31], v[48:49] neg_lo:[0,1] neg_hi:[0,1]
    v_pk_fma_f32 v[46:47], v[42:43], v[42:43], v[46:47]
    v_pk_add_f32 v[42:43], v[32:33], v[48:49] neg_lo:[0,1] neg_hi:[0,1]
    v_pk_fma_f32 v[44:45], v[42:43], v[42:43], v[44:45]
    v_pk_add_f32 v[42:43], v[34:35], v[48:49] neg_lo:[0,1] neg_hi:[0,1]
    v_pk_fma_f32 v[46:47], v[42:43], v[42:43], v[46:47]
    v_pk_add_f32 v[42:43], v[36:37], v[48:49] neg_lo:[0,1] neg_hi:[0,1]
    v_pk_fma_f32 v[44:45], v[42:43], v[42:43], v[44:45]
    v_pk_add_f32 v[44:45], v[44:45], v[46:47]
    v_add_f32 v44, v44, v45
    s_nop 1
    v_add_f32_dpp v44, v44, v44 row_ror:8 row_mask:0xf bank_mask:0xf
    s_nop 1
    v_add_f32_dpp v44, v44, v44 row_ror:4 row_mask:0xf bank_mask:0xf
    s_nop 1
    v_add_f32_dpp v44, v44, v44 row_ror:2 row_mask:0xf bank_mask:0xf
    s_nop 1
    v_add_f32_dpp v44, v44, v44 row_ror:1 row_mask:0xf bank_mask:0xf
    v_mov_b32 v46, v44
    s_nop 1
    v_permlane16_swap_b32 v44, v46
    v_add_f32 v44, v44, v46
    v_mul_f32 v44, 0x3ae38e39, v44
    v_cvt_pk_bf16_f32 v44, v44, v44
    v_and_b32 v44, 0xffff0000, v44
    v_add_f32 v44, 0x3727c5ac, v44
    v_cvt_pk_bf16_f32 v44, v44, v44
    v_and_b32 v44, 0xffff0000, v44
    v_sqrt_f32 v44, v44
    s_nop 0
    v_cvt_pk_bf16_f32 v44, v44, v44
    v_and_b32 v44, 0xffff0000, v44
    v_rcp_f32 v42, v44
    s_nop 0
    v_mov_b32 v43, v42
    v_pk_add_f32 v[44:45], v[20:21], v[40:41] neg_lo:[0,1] neg_hi:[0,1]
    v_cvt_pk_bf16_f32 v46, v44, v45
    v_lshlrev_b32 v44, 16, v46
    v_and_b32 v45, 0xffff0000, v46
    v_pk_mul_f32 v[44:45], v[44:45], v[42:43]
    v_cvt_pk_bf16_f32 v46, v44, v45
    v_lshlrev_b32 v44, 16, v46
    v_and_b32 v45, 0xffff0000, v46
    v_cvt_pk_f16_f32 v46, v44, v45
    v_mov_b32 v47, v46
    s_nop 1
    v_permlane32_swap_b32 v46, v47
    v_perm_b32 v10, v47, v46, v5
    ds_write_b32 v4, v10 offset:0
    v_pk_add_f32 v[44:45], v[22:23], v[40:41] neg_lo:[0,1] neg_hi:[0,1]
    v_cvt_pk_bf16_f32 v46, v44, v45
    v_lshlrev_b32 v44, 16, v46
    v_and_b32 v45, 0xffff0000, v46
    v_pk_mul_f32 v[44:45], v[44:45], v[42:43]
    v_cvt_pk_bf16_f32 v46, v44, v45
    v_lshlrev_b32 v44, 16, v46
    v_and_b32 v45, 0xffff0000, v46
    v_cvt_pk_f16_f32 v46, v44, v45
    v_mov_b32 v47, v46
    s_nop 1
    v_permlane32_swap_b32 v46, v47
    v_perm_b32 v11, v47, v46, v5
    ds_write_b32 v4, v11 offset:256
    v_pk_add_f32 v[44:45], v[24:25], v[40:41] neg_lo:[0,1] neg_hi:[0,1]
    v_cvt_pk_bf16_f32 v46, v44, v45
    v_lshlrev_b32 v44, 16, v46
    v_and_b32 v45, 0xffff0000, v46
    v_pk_mul_f32 v[44:45], v[44:45], v[42:43]
    v_cvt_pk_bf16_f32 v46, v44, v45
    v_lshlrev_b32 v44, 16, v46
    v_and_b32 v45, 0xffff0000, v46
    v_cvt_pk_f16_f32 v46, v44, v45
    v_mov_b32 v47, v46
    s_nop 1
    v_permlane32_swap_b32 v46, v47
    v_perm_b32 v12, v47, v46, v5
    ds_write_b32 v4, v12 offset:512
    v_pk_add_f32 v[44:45], v[26:27], v[40:41] neg_lo:[0,1] neg_hi:[0,1]
    v_cvt_pk_bf16_f32 v46, v44, v45
    v_lshlrev_b32 v44, 16, v46
    v_and_b32 v45, 0xffff0000, v46
    v_pk_mul_f32 v[44:45], v[44:45], v[42:43]
    v_cvt_pk_bf16_f32 v46, v44, v45
    v_lshlrev_b32 v44, 16, v46
    v_and_b32 v45, 0xffff0000, v46
    v_cvt_pk_f16_f32 v46, v44, v45
    v_mov_b32 v47, v46
    s_nop 1
    v_permlane32_swap_b32 v46, v47
    v_perm_b32 v13, v47, v46, v5
    ds_write_b32 v4, v13 offset:768
    v_pk_add_f32 v[44:45], v[28:29], v[40:41] neg_lo:[0,1] neg_hi:[0,1]
    v_cvt_pk_bf16_f32 v46, v44, v45
    v_lshlrev_b32 v44, 16, v46
    v_and_b32 v45, 0xffff0000, v46
    v_pk_mul_f32 v[44:45], v[44:45], v[42:43]
    v_cvt_pk_bf16_f32 v46, v44, v45
    v_lshlrev_b32 v44, 16, v46
    v_and_b32 v45, 0xffff0000, v46
    v_cvt_pk_f16_f32 v46, v44, v45
    v_mov_b32 v47, v46
    s_nop 1
    v_permlane32_swap_b32 v46, v47
    v_perm_b32 v14, v47, v46, v5
    ds_write_b32 v4, v14 offset:1024
    v_pk_add_f32 v[44:45], v[30:31], v[40:41] neg_lo:[0,1] neg_hi:[0,1]
    v_cvt_pk_bf16_f32 v46, v44, v45
    v_lshlrev_b32 v44, 16, v46
    v_and_b32 v45, 0xffff0000, v46
    v_pk_mul_f32 v[44:45], v[44:45], v[42:43]
    v_cvt_pk_bf16_f32 v46, v44, v45
    v_lshlrev_b32 v44, 16, v46
    v_and_b32 v45, 0xffff0000, v46
    v_cvt_pk_f16_f32 v46, v44, v45
    v_mov_b32 v47, v46
    s_nop 1
    v_permlane32_swap_b32 v46, v47
    v_perm_b32 v15, v47, v46, v5
    ds_write_b32 v4, v15 offset:1280
    v_pk_add_f32 v[44:45], v[32:33], v[40:41] neg_lo:[0,1] neg_hi:[0,1]
    v_cvt_pk_bf16_f32 v46, v44, v45
    v_lshlrev_b32 v44, 16, v46
    v_and_b32 v45, 0xffff0000, v46
    v_pk_mul_f32 v[44:45], v[44:45], v[42:43]
    v_cvt_pk_bf16_f32 v46, v44, v45
    v_lshlrev_b32 v44, 16, v46
    v_and_b32 v45, 0xffff0000, v46
    v_cvt_pk_f16_f32 v46, v44, v45
    v_mov_b32 v47, v46
    s_nop 1
    v_permlane32_swap_b32 v46, v47
    v_perm_b32 v16, v47, v46, v5
    ds_write_b32 v4, v16 offset:1536
    v_pk_add_f32 v[44:45], v[34:35], v[40:41] neg_lo:[0,1] neg_hi:[0,1]
    v_cvt_pk_bf16_f32 v46, v44, v45
    v_lshlrev_b32 v44, 16, v46
    v_and_b32 v45, 0xffff0000, v46
    v_pk_mul_f32 v[44:45], v[44:45], v[42:43]
    v_cvt_pk_bf16_f32 v46, v44, v45
    v_lshlrev_b32 v44, 16, v46
    v_and_b32 v45, 0xffff0000, v46
    v_cvt_pk_f16_f32 v46, v44, v45
    v_mov_b32 v47, v46
    s_nop 1
    v_permlane32_swap_b32 v46, v47
    v_perm_b32 v17, v47, v46, v5
    ds_write_b32 v4, v17 offset:1792
    v_pk_add_f32 v[44:45], v[36:37], v[40:41] neg_lo:[0,1] neg_hi:[0,1]
    v_cvt_pk_bf16_f32 v46, v44, v45
    v_lshlrev_b32 v44, 16, v46
    v_and_b32 v45, 0xffff0000, v46
    v_pk_mul_f32 v[44:45], v[44:45], v[42:43]
    v_cvt_pk_bf16_f32 v46, v44, v45
    v_lshlrev_b32 v44, 16, v46
    v_and_b32 v45, 0xffff0000, v46
    v_cvt_pk_f16_f32 v46, v44, v45
    v_mov_b32 v47, v46
    s_nop 1
    v_permlane32_swap_b32 v46, v47
    v_perm_b32 v18, v47, v46, v5
    ds_write_b32 v4, v18 offset:2048
    s_waitcnt lgkmcnt(0)
    s_barrier
    v_lshlrev_b32 v6, 2, v0
    v_lshlrev_b32 v7, 4, v0
    v_readfirstlane_b32 s16, v0
    ds_read2st64_b32 v[20:21], v6 offset0:0 offset1:9
    ds_read2st64_b32 v[22:23], v6 offset0:18 offset1:27
    ds_read2st64_b32 v[24:25], v6 offset0:4 offset1:13
    ds_read2st64_b32 v[26:27], v6 offset0:22 offset1:31
    s_cmp_ge_u32 s16, 64
    s_cbranch_scc1 K1_LN_SKIP
    ds_read2st64_b32 v[28:29], v6 offset0:8 offset1:17
    ds_read2st64_b32 v[30:31], v6 offset0:26 offset1:35
    s_add_u32 s17, s3, 8192
    s_waitcnt lgkmcnt(0)
    buffer_store_dwordx4 v[28:31], v7, s[12:15], s17 offen
K1_LN_SKIP:
    s_add_u32 s17, s3, 4096
    s_waitcnt lgkmcnt(0)
    buffer_store_dwordx4 v[20:23], v7, s[12:15], s3 offen
    buffer_store_dwordx4 v[24:27], v7, s[12:15], s17 offen
    s_endpgm
K1_KGEN:
    s_load_dwordx16 s[16:31], s[0:1], 0
    s_load_dwordx2 s[6:7], s[0:1], 128
    s_sub_u32 s3, s2, 256
    s_and_b32 s4, s3, 7
    s_mul_i32 s4, s4, 72
    s_lshr_b32 s3, s3, 3
    s_add_u32 s3, s3, s4
    v_and_b32 v1, 63, v0
    s_lshl_b32 s4, s3, 8
    v_lshl_add_u32 v2, v1, 2, s4
    s_lshl_b32 s4, s3, 1
    v_mov_b32 v3, s4
    v_readfirstlane_b32 s5, v0
    s_lshr_b32 s5, s5, 6
    s_waitcnt lgkmcnt(0)
    global_load_ushort v16, v3, s[30:31]
    global_load_dword v10, v2, s[18:19]
    global_load_dword v11, v2, s[20:21]
    global_load_dword v12, v2, s[22:23]
    global_load_dword v13, v2, s[24:25]
    global_load_dword v14, v2, s[26:27]
    global_load_dword v15, v2, s[28:29]
    s_add_u32 s8, s6, 0x300000
    s_addc_u32 s9, s7, 0
    s_mov_b32 s10, 0x242400
    s_mov_b32 s11, 0x20000
    s_add_u32 s12, s6, 0xc10000
    s_addc_u32 s13, s7, 0
    s_mov_b32 s14, 0x900
    s_mov_b32 s15, 0x20000
    v_lshlrev_b32 v4, 3, v0
    v_sub_u32 v4, 2047, v4
    v_subrev_u32 v5, 0, v4
    v_subrev_u32 v6, 1, v4
    v_cvt_f32_u32 v7, v5
    v_cvt_f32_u32 v8, v6
    v_cvt_pk_bf16_f32 v7, v7, v8
    v_and_b32 v8, 0xffff, v7
    v_lshrrev_b32 v7, 16, v7
    v_subrev_u32 v8, 0x4280, v8
    v_subrev_u32 v7, 0x4280, v7
    v_cmp_gt_u32 vcc, 128, v5
    s_nop 1
    v_cndmask_b32 v8, v8, v5, vcc
    v_cmp_gt_u32 vcc, 128, v6
    s_nop 1
    v_cndmask_b32 v7, v7, v6, vcc
    v_lshlrev_b32 v100, 1, v8
    v_lshlrev_b32 v101, 1, v7
    v_subrev_u32 v5, 2, v4
    v_subrev_u32 v6, 3, v4
    v_cvt_f32_u32 v7, v5
    v_cvt_f32_u32 v8, v6
    v_cvt_pk_bf16_f32 v7, v7, v8
    v_and_b32 v8, 0xffff, v7
    v_lshrrev_b32 v7, 16, v7
    v_subrev_u32 v8, 0x4280, v8
    v_subrev_u32 v7, 0x4280, v7
    v_cmp_gt_u32 vcc, 128, v5
    s_nop 1
    v_cndmask_b32 v8, v8, v5, vcc
    v_cmp_gt_u32 vcc, 128, v6
    s_nop 1
    v_cndmask_b32 v7, v7, v6, vcc
    v_lshlrev_b32 v102, 1, v8
    v_lshlrev_b32 v103, 1, v7
    v_subrev_u32 v5, 4, v4
    v_subrev_u32 v6, 5, v4
    v_cvt_f32_u32 v7, v5
    v_cvt_f32_u32 v8, v6
    v_cvt_pk_bf16_f32 v7, v7, v8
    v_and_b32 v8, 0xffff, v7
    v_lshrrev_b32 v7, 16, v7
    v_subrev_u32 v8, 0x4280, v8
    v_subrev_u32 v7, 0x4280, v7
    v_cmp_gt_u32 vcc, 128, v5
    s_nop 1
    v_cndmask_b32 v8, v8, v5, vcc
    v_cmp_gt_u32 vcc, 128, v6
    s_nop 1
    v_cndmask_b32 v7, v7, v6, vcc
    v_lshlrev_b32 v104, 1, v8
    v_lshlrev_b32 v105, 1, v7
    v_subrev_u32 v5, 6, v4
    v_subrev_u32 v6, 7, v4
    v_cvt_f32_u32 v7, v5
    v_cvt_f32_u32 v8, v6
    v_cvt_pk_bf16_f32 v7, v7, v8
    v_and_b32 v8, 0xffff, v7
    v_lshrrev_b32 v7, 16, v7
    v_subrev_u32 v8, 0x4280, v8
    v_subrev_u32 v7, 0x4280, v7
    v_cmp_gt_u32 vcc, 128, v5
    s_nop 1
    v_cndmask_b32 v8, v8, v5, vcc
    v_cmp_gt_u32 vcc, 128, v6
    s_nop 1
    v_cndmask_b32 v7, v7, v6, vcc
    v_lshlrev_b32 v106, 1, v8
    v_lshlrev_b32 v107, 1, v7
    s_waitcnt vmcnt(6)
    v_lshlrev_b32 v16, 16, v16
    v_mul_f32 v17, 0x3fb8aa3b, v16
    s_mov_b32 s32, 0x3fb8aa3b
    s_mov_b32 s33, 0x32a57060
    v_fma_f32 v18, v16, s32, -v17
    v_fma_f32 v18, v16, s33, v18
    v_exp_f32 v17, v17
    v_mul_f32 v18, 0x3f317218, v18
    v_fma_f32 v17, v17, v18, v17
    v_cvt_pk_bf16_f32 v17, v17, v17
    v_and_b32 v16, 0xffff0000, v17
    v_mov_b32 v17, v16
    s_waitcnt vmcnt(0)
    v_lshlrev_b32 v20, 16, v10
    v_and_b32 v21, 0xffff0000, v10
    v_lshlrev_b32 v22, 16, v11
    v_and_b32 v23, 0xffff0000, v11
    v_lshlrev_b32 v24, 16, v12
    v_and_b32 v25, 0xffff0000, v12
    v_lshlrev_b32 v26, 16, v13
    v_and_b32 v27, 0xffff0000, v13
    v_lshlrev_b32 v28, 16, v14
    v_and_b32 v29, 0xffff0000, v14
    v_lshlrev_b32 v30, 16, v15
    v_and_b32 v31, 0xffff0000, v15
    v_pk_mul_f32 v[20:21], v[20:21], v[16:17]
    v_pk_mul_f32 v[22:23], v[22:23], v[16:17]
    v_pk_mul_f32 v[24:25], v[24:25], v[16:17]
    v_pk_mul_f32 v[26:27], v[26:27], v[16:17]
    v_pk_mul_f32 v[90:91], v[30:31], v[26:27]
    v_pk_mul_f32 v[92:93], v[30:31], v[24:25]
    v_pk_fma_f32 v[34:35], v[28:29], v[26:27], v[92:93]
    v_pk_fma_f32 v[32:33], v[28:29], v[24:25], v[90:91] neg_lo:[0,0,1] neg_hi:[0,0,1]
    v_max_f32 v36, v20, v21
    s_nop 1
    v_max_f32_dpp v36, v36, v36 row_ror:8 row_mask:0xf bank_mask:0xf
    s_nop 1
    v_max_f32_dpp v36, v36, v36 row_ror:4 row_mask:0xf bank_mask:0xf
    s_nop 1
    v_max_f32_dpp v36, v36, v36 row_ror:2 row_mask:0xf bank_mask:0xf
    s_nop 1
    v_max_f32_dpp v36, v36, v36 row_ror:1 row_mask:0xf bank_mask:0xf
    v_mov_b32 v38, v36
    s_nop 1
    v_permlane16_swap_b32 v36, v38
    v_max_f32 v36, v36, v38
    v_mov_b32 v38, v36
    s_nop 1
    v_permlane32_swap_b32 v36, v38
    v_max_f32 v36, v36, v38
    v_add_f32 v37, abs(v32), abs(v33)
    v_add_f32 v38, abs(v34), abs(v35)
    v_add_f32 v37, v37, v38
    s_nop 1
    v_add_f32_dpp v37, v37, v37 row_ror:8 row_mask:0xf bank_mask:0xf
    s_nop 1
    v_add_f32_dpp v37, v37, v37 row_ror:4 row_mask:0xf bank_mask:0xf
    s_nop 1
    v_add_f32_dpp v37, v37, v37 row_ror:2 row_mask:0xf bank_mask:0xf
    s_nop 1
    v_add_f32_dpp v37, v37, v37 row_ror:1 row_mask:0xf bank_mask:0xf
    v_mov_b32 v38, v37
    s_nop 1
    v_permlane16_swap_b32 v37, v38
    v_add_f32 v37, v37, v38
    v_mov_b32 v38, v37
    s_nop 1
    v_permlane32_swap_b32 v37, v38
    v_add_f32 v37, v37, v38
    v_max_f32 v37, 0x03aa2425, v37
    v_rcp_f32 v38, v37
    s_nop 0
    v_mul_f32 v38, 0x47000000, v38
    v_mov_b32 v39, v38
    v_pk_mul_f32 v[32:33], v[32:33], v[38:39]
    v_pk_mul_f32 v[34:35], v[34:35], v[38:39]
    v_sub_f32 v20, v20, v36
    v_sub_f32 v21, v21, v36
    v_mul_f32 v20, 0x3fb8aa3b, v20
    v_mul_f32 v21, 0x3fb8aa3b, v21
    v_mul_f32 v36, 0x3fb8aa3b, v36
    s_mov_b32 s32, 0x3e22f983
    s_mov_b32 s33, 0x31dc9c88
    s_mul_i32 s4, s5, 8704
    v_lshl_add_u32 v4, v1, 3, s4
    v_and_b32 v5, 15, v1
    v_lshrrev_b32 v6, 4, v1
    v_lshlrev_b32 v7, 3, v5
    s_cmp_eq_u32 s5, 1
    s_cbranch_scc1 K1_J1
    s_cmp_eq_u32 s5, 2
    s_cbranch_scc1 K1_J2
    s_cmp_eq_u32 s5, 3
    s_cbranch_scc1 K1_J3
    v_mul_f32 v90, 0x3f800000, v20
    v_mul_f32 v91, 0x3f800000, v22
    v_exp_f32 v90, v90
    v_mul_f32 v92, s32, v91
    v_rndne_f32 v92, v92
    v_fma_f32 v92, v91, s32, -v92
    v_fma_f32 v92, v91, s33, v92
    v_cos_f32 v91, v92
    v_sin_f32 v92, v92
    v_mul_f32 v40, v90, v91
    v_mul_f32 v42, v90, v92
    v_mul_f32 v90, 0x3f800000, v21
    v_mul_f32 v91, 0x3f800000, v23
    v_exp_f32 v90, v90
    v_mul_f32 v92, s32, v91
    v_rndne_f32 v92, v92
    v_fma_f32 v92, v91, s32, -v92
    v_fma_f32 v92, v91, s33, v92
    v_cos_f32 v91, v92
    v_sin_f32 v92, v92
    v_mul_f32 v41, v90, v91
    v_mul_f32 v43, v90, v92
    v_mul_f32 v90, 0x43000000, v20
    v_mul_f32 v91, 0x43000000, v22
    v_exp_f32 v90, v90
    v_mul_f32 v92, s32, v91
    v_rndne_f32 v92, v92
    v_fma_f32 v92, v91, s32, -v92
    v_fma_f32 v92, v91, s33, v92
    v_cos_f32 v91, v92
    v_sin_f32 v92, v92
    v_mul_f32 v44, v90, v91
    v_mul_f32 v46, v90, v92
    v_mul_f32 v90, 0x43000000, v21
    v_mul_f32 v91, 0x43000000, v23
    v_exp_f32 v90, v90
    v_mul_f32 v92, s32, v91
    v_rndne_f32 v92, v92
    v_fma_f32 v92, v91, s32, -v92
    v_fma_f32 v92, v91, s33, v92
    v_cos_f32 v91, v92
    v_sin_f32 v92, v92
    v_mul_f32 v45, v90, v91
    v_mul_f32 v47, v90, v92
    v_cvt_pk_f16_f32 v94, v32, v34
    v_cvt_pk_f16_f32 v95, v33, v35
    ds_write_b64 v4, v[94:95] offset:0
    v_pk_mul_f32 v[90:91], v[34:35], v[46:47]
    v_pk_mul_f32 v[92:93], v[34:35], v[44:45]
    v_pk_fma_f32 v[62:63], v[32:33], v[46:47], v[92:93]
    v_pk_fma_f32 v[60:61], v[32:33], v[44:45], v[90:91] neg_lo:[0,0,1] neg_hi:[0,0,1]
    v_cvt_pk_f16_f32 v94, v60, v62
    v_cvt_pk_f16_f32 v95, v61, v63
    ds_write_b64 v4, v[94:95] offset:4352
    v_pk_mul_f32 v[90:91], v[34:35], v[42:43]
    v_pk_mul_f32 v[92:93], v[34:35], v[40:41]
    v_pk_fma_f32 v[54:55], v[32:33], v[42:43], v[92:93]
    v_pk_fma_f32 v[52:53], v[32:33], v[40:41], v[90:91] neg_lo:[0,0,1] neg_hi:[0,0,1]
    v_cvt_pk_f16_f32 v94, v52, v54
    v_cvt_pk_f16_f32 v95, v53, v55
    ds_write_b64 v4, v[94:95] offset:544
    v_pk_mul_f32 v[90:91], v[54:55], v[46:47]
    v_pk_mul_f32 v[92:93], v[54:55], v[44:45]
    v_pk_fma_f32 v[62:63], v[52:53], v[46:47], v[92:93]
    v_pk_fma_f32 v[60:61], v[52:53], v[44:45], v[90:91] neg_lo:[0,0,1] neg_hi:[0,0,1]
    v_cvt_pk_f16_f32 v94, v60, v62
    v_cvt_pk_f16_f32 v95, v61, v63
    ds_write_b64 v4, v[94:95] offset:4896
    v_pk_mul_f32 v[90:91], v[54:55], v[42:43]
    v_pk_mul_f32 v[92:93], v[54:55], v[40:41]
    v_pk_fma_f32 v[58:59], v[52:53], v[42:43], v[92:93]
    v_pk_fma_f32 v[56:57], v[52:53], v[40:41], v[90:91] neg_lo:[0,0,1] neg_hi:[0,0,1]
    v_cvt_pk_f16_f32 v94, v56, v58
    v_cvt_pk_f16_f32 v95, v57, v59
    ds_write_b64 v4, v[94:95] offset:1088
    v_pk_mul_f32 v[90:91], v[58:59], v[46:47]
    v_pk_mul_f32 v[92:93], v[58:59], v[44:45]
    v_pk_fma_f32 v[62:63], v[56:57], v[46:47], v[92:93]
    v_pk_fma_f32 v[60:61], v[56:57], v[44:45], v[90:91] neg_lo:[0,0,1] neg_hi:[0,0,1]
    v_cvt_pk_f16_f32 v94, v60, v62
    v_cvt_pk_f16_f32 v95, v61, v63
    ds_write_b64 v4, v[94:95] offset:5440
    v_pk_mul_f32 v[90:91], v[58:59], v[42:43]
    v_pk_mul_f32 v[92:93], v[58:59], v[40:41]
    v_pk_fma_f32 v[54:55], v[56:57], v[42:43], v[92:93]
    v_pk_fma_f32 v[52:53], v[56:57], v[40:41], v[90:91] neg_lo:[0,0,1] neg_hi:[0,0,1]
    v_cvt_pk_f16_f32 v94, v52, v54
    v_cvt_pk_f16_f32 v95, v53, v55
    ds_write_b64 v4, v[94:95] offset:1632
    v_pk_mul_f32 v[90:91], v[54:55], v[46:47]
    v_pk_mul_f32 v[92:93], v[54:55], v[44:45]
    v_pk_fma_f32 v[62:63], v[52:53], v[46:47], v[92:93]
    v_pk_fma_f32 v[60:61], v[52:53], v[44:45], v[90:91] neg_lo:[0,0,1] neg_hi:[0,0,1]
    v_cvt_pk_f16_f32 v94, v60, v62
    v_cvt_pk_f16_f32 v95, v61, v63
    ds_write_b64 v4, v[94:95] offset:5984
    v_pk_mul_f32 v[90:91], v[54:55], v[42:43]
    v_pk_mul_f32 v[92:93], v[54:55], v[40:41]
    v_pk_fma_f32 v[58:59], v[52:53], v[42:43], v[92:93]
    v_pk_fma_f32 v[56:57], v[52:53], v[40:41], v[90:91] neg_lo:[0,0,1] neg_hi:[0,0,1]
    v_cvt_pk_f16_f32 v94, v56, v58
    v_cvt_pk_f16_f32 v95, v57, v59
    ds_write_b64 v4, v[94:95] offset:2176
    v_pk_mul_f32 v[90:91], v[58:59], v[46:47]
    v_pk_mul_f32 v[92:93], v[58:59], v[44:45]
    v_pk_fma_f32 v[62:63], v[56:57], v[46:47], v[92:93]
    v_pk_fma_f32 v[60:61], v[56:57], v[44:45], v[90:91] neg_lo:[0,0,1] neg_hi:[0,0,1]
    v_cvt_pk_f16_f32 v94, v60, v62
    v_cvt_pk_f16_f32 v95, v61, v63
    ds_write_b64 v4, v[94:95] offset:6528
    v_pk_mul_f32 v[90:91], v[58:59], v[42:43]
    v_pk_mul_f32 v[92:93], v[58:59], v[40:41]
    v_pk_fma_f32 v[54:55], v[56:57], v[42:43], v[92:93]
    v_pk_fma_f32 v[52:53], v[56:57], v[40:41], v[90:91] neg_lo:[0,0,1] neg_hi:[0,0,1]
    v_cvt_pk_f16_f32 v94, v52, v54
    v_cvt_pk_f16_f32 v95, v53, v55
    ds_write_b64 v4, v[94:95] offset:2720
    v_pk_mul_f32 v[90:91], v[54:55], v[46:47]
    v_pk_mul_f32 v[92:93], v[54:55], v[44:45]
    v_pk_fma_f32 v[62:63], v[52:53], v[46:47], v[92:93]
    v_pk_fma_f32 v[60:61], v[52:53], v[44:45], v[90:91] neg_lo:[0,0,1] neg_hi:[0,0,1]
    v_cvt_pk_f16_f32 v94, v60, v62
    v_cvt_pk_f16_f32 v95, v61, v63
    ds_write_b64 v4, v[94:95] offset:7072
    v_pk_mul_f32 v[90:91], v[54:55], v[42:43]
    v_pk_mul_f32 v[92:93], v[54:55], v[40:41]
    v_pk_fma_f32 v[58:59], v[52:53], v[42:43], v[92:93]
    v_pk_fma_f32 v[56:57], v[52:53], v[40:41], v[90:91] neg_lo:[0,0,1] neg_hi:[0,0,1]
    v_cvt_pk_f16_f32 v94, v56, v58
    v_cvt_pk_f16_f32 v95, v57, v59
    ds_write_b64 v4, v[94:95] offset:3264
    v_pk_mul_f32 v[90:91], v[58:59], v[46:47]
    v_pk_mul_f32 v[92:93], v[58:59], v[44:45]
    v_pk_fma_f32 v[62:63], v[56:57], v[46:47], v[92:93]
    v_pk_fma_f32 v[60:61], v[56:57], v[44:45], v[90:91] neg_lo:[0,0,1] neg_hi:[0,0,1]
    v_cvt_pk_f16_f32 v94, v60, v62
    v_cvt_pk_f16_f32 v95, v61, v63
    ds_write_b64 v4, v[94:95] offset:7616
    v_pk_mul_f32 v[90:91], v[58:59], v[42:43]
    v_pk_mul_f32 v[92:93], v[58:59], v[40:41]
    v_pk_fma_f32 v[54:55], v[56:57], v[42:43], v[92:93]
    v_pk_fma_f32 v[52:53], v[56:57], v[40:41], v[90:91] neg_lo:[0,0,1] neg_hi:[0,0,1]
    v_cvt_pk_f16_f32 v94, v52, v54
    v_cvt_pk_f16_f32 v95, v53, v55
    ds_write_b64 v4, v[94:95] offset:3808
    v_pk_mul_f32 v[90:91], v[54:55], v[46:47]
    v_pk_mul_f32 v[92:93], v[54:55], v[44:45]
    v_pk_fma_f32 v[62:63], v[52:53], v[46:47], v[92:93]
    v_pk_fma_f32 v[60:61], v[52:53], v[44:45], v[90:91] neg_lo:[0,0,1] neg_hi:[0,0,1]
    v_cvt_pk_f16_f32 v94, v60, v62
    v_cvt_pk_f16_f32 v95, v61, v63
    ds_write_b64 v4, v[94:95] offset:8160
    v_lshrrev_b32 v8, 1, v6
    v_lshl_add_u32 v7, v8, 7, v7
    v_and_b32 v8, 1, v6
    v_lshl_add_u32 v7, v8, 2, v7
    v_mov_b32 v8, 1
    v_mov_b32 v9, 2
    s_branch K1_JOIN
K1_J1:
    v_mul_f32 v90, 0x40000000, v20
    v_mul_f32 v91, 0x40000000, v22
    v_exp_f32 v90, v90
    v_mul_f32 v92, s32, v91
    v_rndne_f32 v92, v92
    v_fma_f32 v92, v91, s32, -v92
    v_fma_f32 v92, v91, s33, v92
    v_cos_f32 v91, v92
    v_sin_f32 v92, v92
    v_mul_f32 v40, v90, v91
    v_mul_f32 v42, v90, v92
    v_mul_f32 v90, 0x40000000, v21
    v_mul_f32 v91, 0x40000000, v23
    v_exp_f32 v90, v90
    v_mul_f32 v92, s32, v91
    v_rndne_f32 v92, v92
    v_fma_f32 v92, v91, s32, -v92
    v_fma_f32 v92, v91, s33, v92
    v_cos_f32 v91, v92
    v_sin_f32 v92, v92
    v_mul_f32 v41, v90, v91
    v_mul_f32 v43, v90, v92
    v_mul_f32 v90, 0x43000000, v20
    v_mul_f32 v91, 0x43000000, v22
    v_exp_f32 v90, v90
    v_mul_f32 v92, s32, v91
    v_rndne_f32 v92, v92
    v_fma_f32 v92, v91, s32, -v92
    v_fma_f32 v92, v91, s33, v92
    v_cos_f32 v91, v92
    v_sin_f32 v92, v92
    v_mul_f32 v44, v90, v91
    v_mul_f32 v46, v90, v92
    v_mul_f32 v90, 0x43000000, v21
    v_mul_f32 v91, 0x43000000, v23
    v_exp_f32 v90, v90
    v_mul_f32 v92, s32, v91
    v_rndne_f32 v92, v92
    v_fma_f32 v92, v91, s32, -v92
    v_fma_f32 v92, v91, s33, v92
    v_cos_f32 v91, v92
    v_sin_f32 v92, v92
    v_mul_f32 v45, v90, v91
    v_mul_f32 v47, v90, v92
    v_mul_f32 v90, 0x43800000, v20
    v_mul_f32 v91, 0x43800000, v22
    v_exp_f32 v90, v90
    v_mul_f32 v92, s32, v91
    v_rndne_f32 v92, v92
    v_fma_f32 v92, v91, s32, -v92
    v_fma_f32 v92, v91, s33, v92
    v_cos_f32 v91, v92
    v_sin_f32 v92, v92
    v_mul_f32 v48, v90, v91
    v_mul_f32 v50, v90, v92
    v_mul_f32 v90, 0x43800000, v21
    v_mul_f32 v91, 0x43800000, v23
    v_exp_f32 v90, v90
    v_mul_f32 v92, s32, v91
    v_rndne_f32 v92, v92
    v_fma_f32 v92, v91, s32, -v92
    v_fma_f32 v92, v91, s33, v92
    v_cos_f32 v91, v92
    v_sin_f32 v92, v92
    v_mul_f32 v49, v90, v91
    v_mul_f32 v51, v90, v92
    v_pk_mul_f32 v[90:91], v[34:35], v[50:51]
    v_pk_mul_f32 v[92:93], v[34:35], v[48:49]
    v_pk_fma_f32 v[54:55], v[32:33], v[50:51], v[92:93]
    v_pk_fma_f32 v[52:53], v[32:33], v[48:49], v[90:91] neg_lo:[0,0,1] neg_hi:[0,0,1]
    v_pk_mul_f32 v[90:91], v[54:55], v[50:51]
    v_pk_mul_f32 v[92:93], v[54:55], v[48:49]
    v_pk_fma_f32 v[66:67], v[52:53], v[50:51], v[92:93]
    v_pk_fma_f32 v[64:65], v[52:53], v[48:49], v[90:91] neg_lo:[0,0,1] neg_hi:[0,0,1]
    v_cvt_pk_f16_f32 v94, v52, v54
    v_cvt_pk_f16_f32 v95, v53, v55
    ds_write_b64 v4, v[94:95] offset:0
    v_pk_mul_f32 v[90:91], v[54:55], v[46:47]
    v_pk_mul_f32 v[92:93], v[54:55], v[44:45]
    v_pk_fma_f32 v[62:63], v[52:53], v[46:47], v[92:93]
    v_pk_fma_f32 v[60:61], v[52:53], v[44:45], v[90:91] neg_lo:[0,0,1] neg_hi:[0,0,1]
    v_cvt_pk_f16_f32 v94, v60, v62
    v_cvt_pk_f16_f32 v95, v61, v63
    ds_write_b64 v4, v[94:95] offset:2176
    v_pk_mul_f32 v[90:91], v[54:55], v[42:43]
    v_pk_mul_f32 v[92:93], v[54:55], v[40:41]
    v_pk_fma_f32 v[58:59], v[52:53], v[42:43], v[92:93]
    v_pk_fma_f32 v[56:57], v[52:53], v[40:41], v[90:91] neg_lo:[0,0,1] neg_hi:[0,0,1]
    v_cvt_pk_f16_f32 v94, v56, v58
    v_cvt_pk_f16_f32 v95, v57, v59
    ds_write_b64 v4, v[94:95] offset:544
    v_pk_mul_f32 v[90:91], v[58:59], v[46:47]
    v_pk_mul_f32 v[92:93], v[58:59], v[44:45]
    v_pk_fma_f32 v[62:63], v[56:57], v[46:47], v[92:93]
    v_pk_fma_f32 v[60:61], v[56:57], v[44:45], v[90:91] neg_lo:[0,0,1] neg_hi:[0,0,1]
    v_cvt_pk_f16_f32 v94, v60, v62
    v_cvt_pk_f16_f32 v95, v61, v63
    ds_write_b64 v4, v[94:95] offset:2720
    v_pk_mul_f32 v[90:91], v[58:59], v[42:43]
    v_pk_mul_f32 v[92:93], v[58:59], v[40:41]
    v_pk_fma_f32 v[54:55], v[56:57], v[42:43], v[92:93]
    v_pk_fma_f32 v[52:53], v[56:57], v[40:41], v[90:91] neg_lo:[0,0,1] neg_hi:[0,0,1]
    v_cvt_pk_f16_f32 v94, v52, v54
    v_cvt_pk_f16_f32 v95, v53, v55
    ds_write_b64 v4, v[94:95] offset:1088
    v_pk_mul_f32 v[90:91], v[54:55], v[46:47]
    v_pk_mul_f32 v[92:93], v[54:55], v[44:45]
    v_pk_fma_f32 v[62:63], v[52:53], v[46:47], v[92:93]
    v_pk_fma_f32 v[60:61], v[52:53], v[44:45], v[90:91] neg_lo:[0,0,1] neg_hi:[0,0,1]
    v_cvt_pk_f16_f32 v94, v60, v62
    v_cvt_pk_f16_f32 v95, v61, v63
    ds_write_b64 v4, v[94:95] offset:3264
    v_pk_mul_f32 v[90:91], v[54:55], v[42:43]
    v_pk_mul_f32 v[92:93], v[54:55], v[40:41]
    v_pk_fma_f32 v[58:59], v[52:53], v[42:43], v[92:93]
    v_pk_fma_f32 v[56:57], v[52:53], v[40:41], v[90:91] neg_lo:[0,0,1] neg_hi:[0,0,1]
    v_cvt_pk_f16_f32 v94, v56, v58
    v_cvt_pk_f16_f32 v95, v57, v59
    ds_write_b64 v4, v[94:95] offset:1632
    v_pk_mul_f32 v[90:91], v[58:59], v[46:47]
    v_pk_mul_f32 v[92:93], v[58:59], v[44:45]
    v_pk_fma_f32 v[62:63], v[56:57], v[46:47], v[92:93]
    v_pk_fma_f32 v[60:61], v[56:57], v[44:45], v[90:91] neg_lo:[0,0,1] neg_hi:[0,0,1]
    v_cvt_pk_f16_f32 v94, v60, v62
    v_cvt_pk_f16_f32 v95, v61, v63
    ds_write_b64 v4, v[94:95] offset:3808
    v_pk_mul_f32 v[90:91], v[42:43], v[42:43]
    v_pk_mul_f32 v[92:93], v[42:43], v[40:41]
    v_pk_fma_f32 v[50:51], v[40:41], v[42:43], v[92:93]
    v_pk_fma_f32 v[48:49], v[40:41], v[40:41], v[90:91] neg_lo:[0,0,1] neg_hi:[0,0,1]
    v_cvt_pk_f16_f32 v94, v64, v66
    v_cvt_pk_f16_f32 v95, v65, v67
    ds_write_b64 v4, v[94:95] offset:4352
    v_pk_mul_f32 v[90:91], v[66:67], v[50:51]
    v_pk_mul_f32 v[92:93], v[66:67], v[48:49]
    v_pk_fma_f32 v[62:63], v[64:65], v[50:51], v[92:93]
    v_pk_fma_f32 v[60:61], v[64:65], v[48:49], v[90:91] neg_lo:[0,0,1] neg_hi:[0,0,1]
    v_cvt_pk_f16_f32 v94, v60, v62
    v_cvt_pk_f16_f32 v95, v61, v63
    ds_write_b64 v4, v[94:95] offset:4896
    v_pk_mul_f32 v[90:91], v[66:67], v[46:47]
    v_pk_mul_f32 v[92:93], v[66:67], v[44:45]
    v_pk_fma_f32 v[54:55], v[64:65], v[46:47], v[92:93]
    v_pk_fma_f32 v[52:53], v[64:65], v[44:45], v[90:91] neg_lo:[0,0,1] neg_hi:[0,0,1]
    v_cvt_pk_f16_f32 v94, v52, v54
    v_cvt_pk_f16_f32 v95, v53, v55
    ds_write_b64 v4, v[94:95] offset:5440
    v_pk_mul_f32 v[90:91], v[54:55], v[50:51]
    v_pk_mul_f32 v[92:93], v[54:55], v[48:49]
    v_pk_fma_f32 v[62:63], v[52:53], v[50:51], v[92:93]
    v_pk_fma_f32 v[60:61], v[52:53], v[48:49], v[90:91] neg_lo:[0,0,1] neg_hi:[0,0,1]
    v_cvt_pk_f16_f32 v94, v60, v62
    v_cvt_pk_f16_f32 v95, v61, v63
    ds_write_b64 v4, v[94:95] offset:5984
    v_pk_mul_f32 v[90:91], v[54:55], v[46:47]
    v_pk_mul_f32 v[92:93], v[54:55], v[44:45]
    v_pk_fma_f32 v[58:59], v[52:53], v[46:47], v[92:93]
    v_pk_fma_f32 v[56:57], v[52:53], v[44:45], v[90:91] neg_lo:[0,0,1] neg_hi:[0,0,1]
    v_cvt_pk_f16_f32 v94, v56, v58
    v_cvt_pk_f16_f32 v95, v57, v59
    ds_write_b64 v4, v[94:95] offset:6528
    v_pk_mul_f32 v[90:91], v[58:59], v[50:51]
    v_pk_mul_f32 v[92:93], v[58:59], v[48:49]
    v_pk_fma_f32 v[62:63], v[56:57], v[50:51], v[92:93]
    v_pk_fma_f32 v[60:61], v[56:57], v[48:49], v[90:91] neg_lo:[0,0,1] neg_hi:[0,0,1]
    v_cvt_pk_f16_f32 v94, v60, v62
    v_cvt_pk_f16_f32 v95, v61, v63
    ds_write_b64 v4, v[94:95] offset:7072
    v_pk_mul_f32 v[90:91], v[58:59], v[46:47]
    v_pk_mul_f32 v[92:93], v[58:59], v[44:45]
    v_pk_fma_f32 v[54:55], v[56:57], v[46:47], v[92:93]
    v_pk_fma_f32 v[52:53], v[56:57], v[44:45], v[90:91] neg_lo:[0,0,1] neg_hi:[0,0,1]
    v_cvt_pk_f16_f32 v94, v52, v54
    v_cvt_pk_f16_f32 v95, v53, v55
    ds_write_b64 v4, v[94:95] offset:7616
    v_pk_mul_f32 v[90:91], v[54:55], v[50:51]
    v_pk_mul_f32 v[92:93], v[54:55], v[48:49]
    v_pk_fma_f32 v[62:63], v[52:53], v[50:51], v[92:93]
    v_pk_fma_f32 v[60:61], v[52:53], v[48:49], v[90:91] neg_lo:[0,0,1] neg_hi:[0,0,1]
    v_cvt_pk_f16_f32 v94, v60, v62
    v_cvt_pk_f16_f32 v95, v61, v63
    ds_write_b64 v4, v[94:95] offset:8160
    v_lshl_add_u32 v8, v6, 7, v7
    v_add_u32 v8, 256, v8
    v_lshl_add_u32 v7, v6, 8, v7
    v_cmp_gt_u32 vcc, 2, v6
    s_nop 1
    v_cndmask_b32 v7, v7, v8, vcc
    v_mov_b32 v8, 4
    v_mov_b32 v9, 0x80
    v_cndmask_b32 v8, v8, 2, vcc
    v_cndmask_b32 v9, v9, 4, vcc
    s_branch K1_JOIN
K1_J2:
    v_mul_f32 v90, 0x43000000, v20
    v_mul_f32 v91, 0x43000000, v22
    v_exp_f32 v90, v90
    v_mul_f32 v92, s32, v91
    v_rndne_f32 v92, v92
    v_fma_f32 v92, v91, s32, -v92
    v_fma_f32 v92, v91, s33, v92
    v_cos_f32 v91, v92
    v_sin_f32 v92, v92
    v_mul_f32 v44, v90, v91
    v_mul_f32 v46, v90, v92
    v_mul_f32 v90, 0x43000000, v21
    v_mul_f32 v91, 0x43000000, v23
    v_exp_f32 v90, v90
    v_mul_f32 v92, s32, v91
    v_rndne_f32 v92, v92
    v_fma_f32 v92, v91, s32, -v92
    v_fma_f32 v92, v91, s33, v92
    v_cos_f32 v91, v92
    v_sin_f32 v92, v92
    v_mul_f32 v45, v90, v91
    v_mul_f32 v47, v90, v92
    v_mul_f32 v90, 0x44800000, v20
    v_mul_f32 v91, 0x44800000, v22
    v_exp_f32 v90, v90
    v_mul_f32 v92, s32, v91
    v_rndne_f32 v92, v92
    v_fma_f32 v92, v91, s32, -v92
    v_fma_f32 v92, v91, s33, v92
    v_cos_f32 v91, v92
    v_sin_f32 v92, v92
    v_mul_f32 v48, v90, v91
    v_mul_f32 v50, v90, v92
    v_mul_f32 v90, 0x44800000, v21
    v_mul_f32 v91, 0x44800000, v23
    v_exp_f32 v90, v90
    v_mul_f32 v92, s32, v91
    v_rndne_f32 v92, v92
    v_fma_f32 v92, v91, s32, -v92
    v_fma_f32 v92, v91, s33, v92
    v_cos_f32 v91, v92
    v_sin_f32 v92, v92
    v_mul_f32 v49, v90, v91
    v_mul_f32 v51, v90, v92
    v_pk_mul_f32 v[90:91], v[34:35], v[50:51]
    v_pk_mul_f32 v[92:93], v[34:35], v[48:49]
    v_pk_fma_f32 v[54:55], v[32:33], v[50:51], v[92:93]
    v_pk_fma_f32 v[52:53], v[32:33], v[48:49], v[90:91] neg_lo:[0,0,1] neg_hi:[0,0,1]
    v_cvt_pk_f16_f32 v94, v52, v54
    v_cvt_pk_f16_f32 v95, v53, v55
    ds_write_b64 v4, v[94:95] offset:0
    v_pk_mul_f32 v[90:91], v[54:55], v[46:47]
    v_pk_mul_f32 v[92:93], v[54:55], v[44:45]
    v_pk_fma_f32 v[58:59], v[52:53], v[46:47], v[92:93]
    v_pk_fma_f32 v[56:57], v[52:53], v[44:45], v[90:91] neg_lo:[0,0,1] neg_hi:[0,0,1]
    v_cvt_pk_f16_f32 v94, v56, v58
    v_cvt_pk_f16_f32 v95, v57, v59
    ds_write_b64 v4, v[94:95] offset:544
    v_pk_mul_f32 v[90:91], v[58:59], v[46:47]
    v_pk_mul_f32 v[92:93], v[58:59], v[44:45]
    v_pk_fma_f32 v[54:55], v[56:57], v[46:47], v[92:93]
    v_pk_fma_f32 v[52:53], v[56:57], v[44:45], v[90:91] neg_lo:[0,0,1] neg_hi:[0,0,1]
    v_cvt_pk_f16_f32 v94, v52, v54
    v_cvt_pk_f16_f32 v95, v53, v55
    ds_write_b64 v4, v[94:95] offset:1088
    v_pk_mul_f32 v[90:91], v[54:55], v[46:47]
    v_pk_mul_f32 v[92:93], v[54:55], v[44:45]
    v_pk_fma_f32 v[58:59], v[52:53], v[46:47], v[92:93]
    v_pk_fma_f32 v[56:57], v[52:53], v[44:45], v[90:91] neg_lo:[0,0,1] neg_hi:[0,0,1]
    v_cvt_pk_f16_f32 v94, v56, v58
    v_cvt_pk_f16_f32 v95, v57, v59
    ds_write_b64 v4, v[94:95] offset:1632
    v_pk_mul_f32 v[90:91], v[58:59], v[46:47]
    v_pk_mul_f32 v[92:93], v[58:59], v[44:45]
    v_pk_fma_f32 v[54:55], v[56:57], v[46:47], v[92:93]
    v_pk_fma_f32 v[52:53], v[56:57], v[44:45], v[90:91] neg_lo:[0,0,1] neg_hi:[0,0,1]
    v_cvt_pk_f16_f32 v94, v52, v54
    v_cvt_pk_f16_f32 v95, v53, v55
    ds_write_b64 v4, v[94:95] offset:2176
    v_pk_mul_f32 v[90:91], v[54:55], v[46:47]
    v_pk_mul_f32 v[92:93], v[54:55], v[44:45]
    v_pk_fma_f32 v[58:59], v[52:53], v[46:47], v[92:93]
    v_pk_fma_f32 v[56:57], v[52:53], v[44:45], v[90:91] neg_lo:[0,0,1] neg_hi:[0,0,1]
    v_cvt_pk_f16_f32 v94, v56, v58
    v_cvt_pk_f16_f32 v95, v57, v59
    ds_write_b64 v4, v[94:95] offset:2720
    v_pk_mul_f32 v[90:91], v[58:59], v[46:47]
    v_pk_mul_f32 v[92:93], v[58:59], v[44:45]
    v_pk_fma_f32 v[54:55], v[56:57], v[46:47], v[92:93]
    v_pk_fma_f32 v[52:53], v[56:57], v[44:45], v[90:91] neg_lo:[0,0,1] neg_hi:[0,0,1]
    v_cvt_pk_f16_f32 v94, v52, v54
    v_cvt_pk_f16_f32 v95, v53, v55
    ds_write_b64 v4, v[94:95] offset:3264
    v_pk_mul_f32 v[90:91], v[54:55], v[46:47]
    v_pk_mul_f32 v[92:93], v[54:55], v[44:45]
    v_pk_fma_f32 v[58:59], v[52:53], v[46:47], v[92:93]
    v_pk_fma_f32 v[56:57], v[52:53], v[44:45], v[90:91] neg_lo:[0,0,1] neg_hi:[0,0,1]
    v_cvt_pk_f16_f32 v94, v56, v58
    v_cvt_pk_f16_f32 v95, v57, v59
    ds_write_b64 v4, v[94:95] offset:3808
    v_pk_mul_f32 v[90:91], v[58:59], v[46:47]
    v_pk_mul_f32 v[92:93], v[58:59], v[44:45]
    v_pk_fma_f32 v[54:55], v[56:57], v[46:47], v[92:93]
    v_pk_fma_f32 v[52:53], v[56:57], v[44:45], v[90:91] neg_lo:[0,0,1] neg_hi:[0,0,1]
    v_cvt_pk_f16_f32 v94, v52, v54
    v_cvt_pk_f16_f32 v95, v53, v55
    ds_write_b64 v4, v[94:95] offset:4352
    v_lshl_add_u32 v7, v6, 9, v7
    v_add_u32 v7, 0x400, v7
    v_mov_b32 v8, 0x80
    v_mov_b32 v9, 0x100
    s_branch K1_JOIN
K1_J3:
    v_mul_f32 v90, 0x41000000, v20
    v_mul_f32 v91, 0x41000000, v22
    v_exp_f32 v90, v90
    v_mul_f32 v92, s32, v91
    v_rndne_f32 v92, v92
    v_fma_f32 v92, v91, s32, -v92
    v_fma_f32 v92, v91, s33, v92
    v_cos_f32 v91, v92
    v_sin_f32 v92, v92
    v_mul_f32 v40, v90, v91
    v_mul_f32 v42, v90, -v92
    v_mul_f32 v90, 0x41000000, v21
    v_mul_f32 v91, 0x41000000, v23
    v_exp_f32 v90, v90
    v_mul_f32 v92, s32, v91
    v_rndne_f32 v92, v92
    v_fma_f32 v92, v91, s32, -v92
    v_fma_f32 v92, v91, s33, v92
    v_cos_f32 v91, v92
    v_sin_f32 v92, v92
    v_mul_f32 v41, v90, v91
    v_mul_f32 v43, v90, -v92
    v_mov_b32 v52, 0x47000000
    v_mov_b32 v53, 0x47000000
    v_mov_b32 v54, 0
    v_mov_b32 v55, 0
    v_cvt_pk_f16_f32 v94, v52, v54
    v_cvt_pk_f16_f32 v95, v53, v55
    ds_write_b64 v4, v[94:95] offset:0
    v_pk_mul_f32 v[90:91], v[54:55], v[42:43]
    v_pk_mul_f32 v[92:93], v[54:55], v[40:41]
    v_pk_fma_f32 v[58:59], v[52:53], v[42:43], v[92:93]
    v_pk_fma_f32 v[56:57], v[52:53], v[40:41], v[90:91] neg_lo:[0,0,1] neg_hi:[0,0,1]
    v_cvt_pk_f16_f32 v94, v56, v58
    v_cvt_pk_f16_f32 v95, v57, v59
    ds_write_b64 v4, v[94:95] offset:544
    v_pk_mul_f32 v[90:91], v[58:59], v[42:43]
    v_pk_mul_f32 v[92:93], v[58:59], v[40:41]
    v_pk_fma_f32 v[54:55], v[56:57], v[42:43], v[92:93]
    v_pk_fma_f32 v[52:53], v[56:57], v[40:41], v[90:91] neg_lo:[0,0,1] neg_hi:[0,0,1]
    v_cvt_pk_f16_f32 v94, v52, v54
    v_cvt_pk_f16_f32 v95, v53, v55
    ds_write_b64 v4, v[94:95] offset:1088
    v_pk_mul_f32 v[90:91], v[54:55], v[42:43]
    v_pk_mul_f32 v[92:93], v[54:55], v[40:41]
    v_pk_fma_f32 v[58:59], v[52:53], v[42:43], v[92:93]
    v_pk_fma_f32 v[56:57], v[52:53], v[40:41], v[90:91] neg_lo:[0,0,1] neg_hi:[0,0,1]
    v_cvt_pk_f16_f32 v94, v56, v58
    v_cvt_pk_f16_f32 v95, v57, v59
    ds_write_b64 v4, v[94:95] offset:1632
    v_pk_mul_f32 v[90:91], v[58:59], v[42:43]
    v_pk_mul_f32 v[92:93], v[58:59], v[40:41]
    v_pk_fma_f32 v[54:55], v[56:57], v[42:43], v[92:93]
    v_pk_fma_f32 v[52:53], v[56:57], v[40:41], v[90:91] neg_lo:[0,0,1] neg_hi:[0,0,1]
    v_cvt_pk_f16_f32 v94, v52, v54
    v_cvt_pk_f16_f32 v95, v53, v55
    ds_write_b64 v4, v[94:95] offset:2176
    v_pk_mul_f32 v[90:91], v[54:55], v[42:43]
    v_pk_mul_f32 v[92:93], v[54:55], v[40:41]
    v_pk_fma_f32 v[58:59], v[52:53], v[42:43], v[92:93]
    v_pk_fma_f32 v[56:57], v[52:53], v[40:41], v[90:91] neg_lo:[0,0,1] neg_hi:[0,0,1]
    v_cvt_pk_f16_f32 v94, v56, v58
    v_cvt_pk_f16_f32 v95, v57, v59
    ds_write_b64 v4, v[94:95] offset:2720
    v_pk_mul_f32 v[90:91], v[58:59], v[42:43]
    v_pk_mul_f32 v[92:93], v[58:59], v[40:41]
    v_pk_fma_f32 v[54:55], v[56:57], v[42:43], v[92:93]
    v_pk_fma_f32 v[52:53], v[56:57], v[40:41], v[90:91] neg_lo:[0,0,1] neg_hi:[0,0,1]
    v_cvt_pk_f16_f32 v94, v52, v54
    v_cvt_pk_f16_f32 v95, v53, v55
    ds_write_b64 v4, v[94:95] offset:3264
    v_pk_mul_f32 v[90:91], v[54:55], v[42:43]
    v_pk_mul_f32 v[92:93], v[54:55], v[40:41]
    v_pk_fma_f32 v[58:59], v[52:53], v[42:43], v[92:93]
    v_pk_fma_f32 v[56:57], v[52:53], v[40:41], v[90:91] neg_lo:[0,0,1] neg_hi:[0,0,1]
    v_cvt_pk_f16_f32 v94, v56, v58
    v_cvt_pk_f16_f32 v95, v57, v59
    ds_write_b64 v4, v[94:95] offset:3808
    v_pk_mul_f32 v[90:91], v[58:59], v[42:43]
    v_pk_mul_f32 v[92:93], v[58:59], v[40:41]
    v_pk_fma_f32 v[54:55], v[56:57], v[42:43], v[92:93]
    v_pk_fma_f32 v[52:53], v[56:57], v[40:41], v[90:91] neg_lo:[0,0,1] neg_hi:[0,0,1]
    v_cvt_pk_f16_f32 v94, v52, v54
    v_cvt_pk_f16_f32 v95, v53, v55
    ds_write_b64 v4, v[94:95] offset:4352
    v_pk_mul_f32 v[90:91], v[54:55], v[42:43]
    v_pk_mul_f32 v[92:93], v[54:55], v[40:41]
    v_pk_fma_f32 v[58:59], v[52:53], v[42:43], v[92:93]
    v_pk_fma_f32 v[56:57], v[52:53], v[40:41], v[90:91] neg_lo:[0,0,1] neg_hi:[0,0,1]
    v_cvt_pk_f16_f32 v94, v56, v58
    v_cvt_pk_f16_f32 v95, v57, v59
    ds_write_b64 v4, v[94:95] offset:4896
    v_pk_mul_f32 v[90:91], v[58:59], v[42:43]
    v_pk_mul_f32 v[92:93], v[58:59], v[40:41]
    v_pk_fma_f32 v[54:55], v[56:57], v[42:43], v[92:93]
    v_pk_fma_f32 v[52:53], v[56:57], v[40:41], v[90:91] neg_lo:[0,0,1] neg_hi:[0,0,1]
    v_cvt_pk_f16_f32 v94, v52, v54
    v_cvt_pk_f16_f32 v95, v53, v55
    ds_write_b64 v4, v[94:95] offset:5440
    v_pk_mul_f32 v[90:91], v[54:55], v[42:43]
    v_pk_mul_f32 v[92:93], v[54:55], v[40:41]
    v_pk_fma_f32 v[58:59], v[52:53], v[42:43], v[92:93]
    v_pk_fma_f32 v[56:57], v[52:53], v[40:41], v[90:91] neg_lo:[0,0,1] neg_hi:[0,0,1]
    v_cvt_pk_f16_f32 v94, v56, v58
    v_cvt_pk_f16_f32 v95, v57, v59
    ds_write_b64 v4, v[94:95] offset:5984
    v_pk_mul_f32 v[90:91], v[58:59], v[42:43]
    v_pk_mul_f32 v[92:93], v[58:59], v[40:41]
    v_pk_fma_f32 v[54:55], v[56:57], v[42:43], v[92:93]
    v_pk_fma_f32 v[52:53], v[56:57], v[40:41], v[90:91] neg_lo:[0,0,1] neg_hi:[0,0,1]
    v_cvt_pk_f16_f32 v94, v52, v54
    v_cvt_pk_f16_f32 v95, v53, v55
    ds_write_b64 v4, v[94:95] offset:6528
    v_pk_mul_f32 v[90:91], v[54:55], v[42:43]
    v_pk_mul_f32 v[92:93], v[54:55], v[40:41]
    v_pk_fma_f32 v[58:59], v[52:53], v[42:43], v[92:93]
    v_pk_fma_f32 v[56:57], v[52:53], v[40:41], v[90:91] neg_lo:[0,0,1] neg_hi:[0,0,1]
    v_cvt_pk_f16_f32 v94, v56, v58
    v_cvt_pk_f16_f32 v95, v57, v59
    ds_write_b64 v4, v[94:95] offset:7072
    v_pk_mul_f32 v[90:91], v[58:59], v[42:43]
    v_pk_mul_f32 v[92:93], v[58:59], v[40:41]
    v_pk_fma_f32 v[54:55], v[56:57], v[42:43], v[92:93]
    v_pk_fma_f32 v[52:53], v[56:57], v[40:41], v[90:91] neg_lo:[0,0,1] neg_hi:[0,0,1]
    v_cvt_pk_f16_f32 v94, v52, v54
    v_cvt_pk_f16_f32 v95, v53, v55
    ds_write_b64 v4, v[94:95] offset:7616
    v_pk_mul_f32 v[90:91], v[54:55], v[42:43]
    v_pk_mul_f32 v[92:93], v[54:55], v[40:41]
    v_pk_fma_f32 v[58:59], v[52:53], v[42:43], v[92:93]
    v_pk_fma_f32 v[56:57], v[52:53], v[40:41], v[90:91] neg_lo:[0,0,1] neg_hi:[0,0,1]
    v_cvt_pk_f16_f32 v94, v56, v58
    v_cvt_pk_f16_f32 v95, v57, v59
    ds_write_b64 v4, v[94:95] offset:8160
    v_mul_f32 v40, 0x45000000, v36
    v_max_f32 v40, 0, v40
    v_exp_f32 v40, v40
    v_mul_f32 v41, 0x38000000, v37
    v_mul_f32 v40, v40, v41
    s_lshl_b32 s4, s3, 2
    v_mov_b32 v41, s4
    s_mul_i32 s4, s3, 4112
    s_add_u32 s4, s4, 4096
    v_mov_b32 v42, s4
    v_mov_b32 v44, 0
    v_mov_b32 v45, 0
    v_mov_b32 v46, 0
    v_mov_b32 v47, 0
    s_mov_b64 s[34:35], exec
    s_mov_b64 exec, 1
    buffer_store_dword v40, v41, s[12:15], 0 offen
    buffer_store_dwordx4 v[44:47], v42, s[8:11], 0 offen
    s_mov_b64 exec, s[34:35]
K1_JOIN:
    s_nop 3
    s_waitcnt lgkmcnt(0)
    s_barrier
    s_cmp_eq_u32 s5, 3
    s_cbranch_scc1 K1_EXPAND
    v_mul_u32_u24 v10, 544, v5
    v_lshl_add_u32 v10, v6, 4, v10
    s_mul_i32 s4, s5, 8704
    v_add_u32 v11, s4, v10
    ds_read_b128 v[40:43], v11 offset:0
    ds_read_b128 v[72:75], v10 offset:26112
    ds_read_b128 v[44:47], v11 offset:64
    ds_read_b128 v[76:79], v10 offset:26176
    ds_read_b128 v[48:51], v11 offset:128
    ds_read_b128 v[80:83], v10 offset:26240
    ds_read_b128 v[52:55], v11 offset:192
    ds_read_b128 v[84:87], v10 offset:26304
    ds_read_b128 v[56:59], v11 offset:256
    ds_read_b128 v[60:63], v11 offset:320
    ds_read_b128 v[64:67], v11 offset:384
    ds_read_b128 v[68:71], v11 offset:448
    v_mov_b32 v12, 0
    v_mov_b32 v13, 0
    v_mov_b32 v14, 0
    v_mov_b32 v15, 0
    ds_read_b128 v[20:23], v10 offset:26368
    ds_read_b128 v[24:27], v10 offset:26432
    ds_read_b128 v[28:31], v10 offset:26496
    ds_read_b128 v[32:35], v10 offset:26560
    s_waitcnt lgkmcnt(0)
    v_mfma_f32_16x16x32_f16 v[12:15], v[40:43], v[72:75], v[12:15]
    v_mfma_f32_16x16x32_f16 v[12:15], v[44:47], v[76:79], v[12:15]
    v_mfma_f32_16x16x32_f16 v[12:15], v[48:51], v[80:83], v[12:15]
    v_mfma_f32_16x16x32_f16 v[12:15], v[52:55], v[84:87], v[12:15]
    v_mfma_f32_16x16x32_f16 v[12:15], v[56:59], v[20:23], v[12:15]
    v_mfma_f32_16x16x32_f16 v[12:15], v[60:63], v[24:27], v[12:15]
    v_mfma_f32_16x16x32_f16 v[12:15], v[64:67], v[28:31], v[12:15]
    v_mfma_f32_16x16x32_f16 v[12:15], v[68:71], v[32:35], v[12:15]
    v_mul_f32 v40, 0x45000000, v36
    v_max_f32 v40, 0, v40
    v_add_f32 v40, 0x41700000, v40
    v_mov_b32 v41, v7
    v_add_u32 v42, v7, v8
    v_add_u32 v43, v7, v9
    v_add_u32 v44, v42, v9
    v_cvt_f32_u32 v45, v41
    v_fma_f32 v46, v45, v36, -v40
    v_exp_f32 v46, v46
    v_lshrrev_b32 v45, 16, v45
    v_subrev_u32 v45, 0x4280, v45
    v_cmp_gt_u32 vcc, 128, v41
    s_nop 1
    v_cndmask_b32 v45, v45, v41, vcc
    v_cmp_lt_u32 vcc, 0x800, v41
    v_mov_b32 v47, 0x2f0
    s_nop 0
    v_cndmask_b32 v45, v45, v47, vcc
    v_mul_f32 v46, v46, v12
    v_cvt_f16_f32 v46, v46
    v_lshlrev_b32 v45, 1, v45
    ds_write_b16 v45, v46 offset:34816
    v_cvt_f32_u32 v45, v42
    v_fma_f32 v46, v45, v36, -v40
    v_exp_f32 v46, v46
    v_lshrrev_b32 v45, 16, v45
    v_subrev_u32 v45, 0x4280, v45
    v_cmp_gt_u32 vcc, 128, v42
    s_nop 1
    v_cndmask_b32 v45, v45, v42, vcc
    v_cmp_lt_u32 vcc, 0x800, v42
    v_mov_b32 v47, 0x2f0
    s_nop 0
    v_cndmask_b32 v45, v45, v47, vcc
    v_mul_f32 v46, v46, v13
    v_cvt_f16_f32 v46, v46
    v_lshlrev_b32 v45, 1, v45
    ds_write_b16 v45, v46 offset:34816
    v_cvt_f32_u32 v45, v43
    v_fma_f32 v46, v45, v36, -v40
    v_exp_f32 v46, v46
    v_lshrrev_b32 v45, 16, v45
    v_subrev_u32 v45, 0x4280, v45
    v_cmp_gt_u32 vcc, 128, v43
    s_nop 1
    v_cndmask_b32 v45, v45, v43, vcc
    v_cmp_lt_u32 vcc, 0x800, v43
    v_mov_b32 v47, 0x2f0
    s_nop 0
    v_cndmask_b32 v45, v45, v47, vcc
    v_mul_f32 v46, v46, v14
    v_cvt_f16_f32 v46, v46
    v_lshlrev_b32 v45, 1, v45
    ds_write_b16 v45, v46 offset:34816
    v_cvt_f32_u32 v45, v44
    v_fma_f32 v46, v45, v36, -v40
    v_exp_f32 v46, v46
    v_lshrrev_b32 v45, 16, v45
    v_subrev_u32 v45, 0x4280, v45
    v_cmp_gt_u32 vcc, 128, v44
    s_nop 1
    v_cndmask_b32 v45, v45, v44, vcc
    v_cmp_lt_u32 vcc, 0x800, v44
    v_mov_b32 v47, 0x2f0
    s_nop 0
    v_cndmask_b32 v45, v45, v47, vcc
    v_mul_f32 v46, v46, v15
    v_cvt_f16_f32 v46, v46
    v_lshlrev_b32 v45, 1, v45
    ds_write_b16 v45, v46 offset:34816
K1_EXPAND:
    s_nop 3
    s_waitcnt lgkmcnt(0)
    s_barrier
    ds_read_u16 v48, v100 offset:34816
    ds_read_u16 v49, v101 offset:34816
    ds_read_u16 v50, v102 offset:34816
    ds_read_u16 v51, v103 offset:34816
    ds_read_u16 v52, v104 offset:34816
    ds_read_u16 v53, v105 offset:34816
    ds_read_u16 v54, v106 offset:34816
    ds_read_u16 v55, v107 offset:34816
    s_mul_i32 s4, s3, 4112
    v_lshlrev_b32 v44, 4, v0
    s_waitcnt lgkmcnt(0)
    v_lshl_or_b32 v40, v49, 16, v48
    v_lshl_or_b32 v41, v51, 16, v50
    v_lshl_or_b32 v42, v53, 16, v52
    v_lshl_or_b32 v43, v55, 16, v54
    buffer_store_dwordx4 v[40:43], v44, s[8:11], s4 offen
K1_END:
    s_endpgm
.globl k2_kernel
.p2align 8
.type k2_kernel,@function
k2_kernel:
    s_cmp_ge_u32 s2, 576
    s_cbranch_scc1 K2_END
    s_load_dwordx2 s[6:7], s[0:1], 128
    s_load_dwordx2 s[4:5], s[0:1], 64
    s_and_b32 s16, s2, 7
    s_mul_i32 s16, s16, 72
    s_lshr_b32 s3, s2, 3
    s_add_u32 s3, s3, s16
    v_readfirstlane_b32 s17, v0
    s_lshr_b32 s17, s17, 6
    v_mul_u32_u24 v1, 9216, v0
    v_lshlrev_b32 v2, 4, v0
    s_lshl_b32 s18, s3, 4
    s_mul_i32 s19, s3, 4112
    s_waitcnt lgkmcnt(0)
    s_mov_b32 s8, s6
    s_mov_b32 s9, s7
    s_mov_b32 s10, 0x240000
    s_mov_b32 s11, 0x20000
    s_add_u32 s12, s6, 0x300000
    s_addc_u32 s13, s7, 0
    s_mov_b32 s14, 0x242400
    s_mov_b32 s15, 0x20000
    buffer_load_dwordx4 v[4:7], v2, s[12:15], s19 offen
    buffer_load_dwordx2 v[8:9], v2, s[12:15], s19 offen offset:16
    buffer_load_dwordx4 v[12:15], v1, s[8:11], s18 offen
    s_lshl_b32 s20, s3, 2
    s_add_u32 s20, s20, 0xc10000
    s_add_u32 s20, s6, s20
    s_addc_u32 s21, s7, 0
    s_load_dword s24, s[20:21], 0
    s_lshr_b32 s20, s3, 1
    s_lshl_b32 s20, s20, 2
    s_add_u32 s20, s4, s20
    s_addc_u32 s21, s5, 0
    s_load_dword s25, s[20:21], 0
    s_add_u32 s28, s6, 0x600000
    s_addc_u32 s29, s7, 0
    s_mov_b32 s30, 0x240000
    s_mov_b32 s31, 0x20000
    v_mov_b32 v16, 0
    v_mov_b32 v17, 0
    v_mov_b32 v18, 0
    v_mov_b32 v19, 0
    v_lshrrev_b32 v3, 5, v0
    v_and_b32 v10, 31, v0
    v_mul_u32_u24 v11, 4640, v3
    v_lshl_add_u32 v11, v10, 4, v11
    v_add_u32 v11, 4096, v11
    v_cmp_gt_u32 vcc, 4, v3
    v_cmp_gt_u32 s[22:23], 24, v10
    s_and_b64 vcc, vcc, s[22:23]
    s_and_saveexec_b64 s[22:23], vcc
    ds_write_b128 v11, v[16:19]
    s_mov_b64 exec, s[22:23]
    v_cmp_gt_u32 vcc, 8, v0
    s_and_saveexec_b64 s[22:23], vcc
    ds_write_b128 v2, v[16:19] offset:18560
    s_mov_b64 exec, s[22:23]
    v_and_b32 v3, 63, v0
    v_and_b32 v10, 15, v3
    v_lshrrev_b32 v11, 4, v3
    v_and_b32 v16, 3, v10
    v_mul_u32_u24 v16, 4640, v16
    v_lshrrev_b32 v17, 2, v10
    v_lshlrev_b32 v17, 7, v17
    v_sub_u32 v16, v16, v17
    v_lshl_add_u32 v16, v11, 4, v16
    s_lshl_b32 s20, s17, 7
    s_sub_u32 s20, 384, s20
    s_add_u32 s21, s20, 384
    v_add_u32 v16, s21, v16
    v_lshlrev_b32 v17, 3, v10
    v_lshl_add_u32 v17, v11, 4, v17
    s_add_u32 s21, s20, 18568
    v_add_u32 v17, s21, v17
    s_waitcnt vmcnt(1)
    v_alignbit_b32 v20, v5, v4, 16
    v_alignbit_b32 v21, v6, v5, 16
    v_alignbit_b32 v22, v7, v6, 16
    v_alignbit_b32 v23, v8, v7, 16
    v_alignbit_b32 v24, v9, v8, 16
    ds_write_b128 v2, v[4:7] offset:13920
    ds_write_b128 v2, v[20:23] offset:9280
    v_mov_b32 v26, v5
    v_mov_b32 v27, v6
    v_mov_b32 v28, v7
    v_mov_b32 v29, v8
    v_mov_b32 v30, v21
    v_mov_b32 v31, v22
    v_mov_b32 v32, v23
    v_mov_b32 v33, v24
    ds_write_b128 v2, v[26:29] offset:4640
    ds_write_b128 v2, v[30:33] offset:0
    s_waitcnt vmcnt(0)
    ds_write_b128 v2, v[12:15] offset:18688
    s_waitcnt lgkmcnt(0)
    s_barrier
    v_mov_b32 v20, 0
    v_mov_b32 v21, 0
    v_mov_b32 v22, 0
    v_mov_b32 v23, 0
    v_mov_b32 v24, 0
    v_mov_b32 v25, 0
    v_mov_b32 v26, 0
    v_mov_b32 v27, 0
    v_mov_b32 v28, 0
    v_mov_b32 v29, 0
    v_mov_b32 v30, 0
    v_mov_b32 v31, 0
    v_mov_b32 v32, 0
    v_mov_b32 v33, 0
    v_mov_b32 v34, 0
    v_mov_b32 v35, 0
    v_mov_b32 v36, 0
    v_mov_b32 v37, 0
    v_mov_b32 v38, 0
    v_mov_b32 v39, 0
    v_mov_b32 v40, 0
    v_mov_b32 v41, 0
    v_mov_b32 v42, 0
    v_mov_b32 v43, 0
    v_mov_b32 v44, 0
    v_mov_b32 v45, 0
    v_mov_b32 v46, 0
    v_mov_b32 v47, 0
    v_mov_b32 v48, 0
    v_mov_b32 v49, 0
    v_mov_b32 v50, 0
    v_mov_b32 v51, 0
    ds_read_b128 v[80:83], v16 offset:64
    ds_read_b64 v[84:85], v17 offset:64
    ds_read_b64 v[86:87], v17 offset:72
    ds_read_b128 v[76:79], v16 offset:576
    ds_read_b64 v[88:89], v17 offset:576
    ds_read_b64 v[90:91], v17 offset:584
    ds_read_b128 v[72:75], v16 offset:1088
    ds_read_b64 v[92:93], v17 offset:1088
    ds_read_b64 v[94:95], v17 offset:1096
    ds_read_b128 v[68:71], v16 offset:1600
    ds_read_b64 v[96:97], v17 offset:1600
    ds_read_b64 v[98:99], v17 offset:1608
    s_waitcnt lgkmcnt(9)
    v_mfma_f32_16x16x32_f16 v[48:51], v[80:83], v[84:87], v[48:51]
    ds_read_b128 v[64:67], v16 offset:2112
    ds_read_b64 v[100:101], v17 offset:2112
    ds_read_b64 v[102:103], v17 offset:2120
    s_waitcnt lgkmcnt(9)
    v_mfma_f32_16x16x32_f16 v[44:47], v[76:79], v[84:87], v[44:47]
    ds_read_b128 v[60:63], v16 offset:2624
    ds_read_b64 v[104:105], v17 offset:2624
    ds_read_b64 v[106:107], v17 offset:2632
    v_mfma_f32_16x16x32_f16 v[48:51], v[76:79], v[88:91], v[48:51]
    s_waitcnt lgkmcnt(9)
    v_mfma_f32_16x16x32_f16 v[40:43], v[72:75], v[84:87], v[40:43]
    ds_read_b128 v[56:59], v16 offset:3136
    ds_read_b64 v[108:109], v17 offset:3136
    ds_read_b64 v[110:111], v17 offset:3144
    v_mfma_f32_16x16x32_f16 v[44:47], v[72:75], v[88:91], v[44:47]
    v_mfma_f32_16x16x32_f16 v[48:51], v[72:75], v[92:95], v[48:51]
    s_waitcnt lgkmcnt(9)
    v_mfma_f32_16x16x32_f16 v[36:39], v[68:71], v[84:87], v[36:39]
    ds_read_b128 v[52:55], v16 offset:3648
    ds_read_b64 v[112:113], v17 offset:3648
    ds_read_b64 v[114:115], v17 offset:3656
    v_mfma_f32_16x16x32_f16 v[40:43], v[68:71], v[88:91], v[40:43]
    v_mfma_f32_16x16x32_f16 v[44:47], v[68:71], v[92:95], v[44:47]
    v_mfma_f32_16x16x32_f16 v[48:51], v[68:71], v[96:99], v[48:51]
    s_waitcnt lgkmcnt(9)
    v_mfma_f32_16x16x32_f16 v[32:35], v[64:67], v[84:87], v[32:35]
    ds_read_b128 v[80:83], v16 offset:0
    ds_read_b64 v[116:117], v17 offset:0
    ds_read_b64 v[118:119], v17 offset:8
    v_mfma_f32_16x16x32_f16 v[36:39], v[64:67], v[88:91], v[36:39]
    v_mfma_f32_16x16x32_f16 v[40:43], v[64:67], v[92:95], v[40:43]
    v_mfma_f32_16x16x32_f16 v[44:47], v[64:67], v[96:99], v[44:47]
    v_mfma_f32_16x16x32_f16 v[48:51], v[64:67], v[100:103], v[48:51]
    s_waitcnt lgkmcnt(9)
    v_mfma_f32_16x16x32_f16 v[28:31], v[60:63], v[84:87], v[28:31]
    ds_read_b128 v[76:79], v16 offset:512
    ds_read_b64 v[120:121], v17 offset:512
    ds_read_b64 v[122:123], v17 offset:520
    v_mfma_f32_16x16x32_f16 v[32:35], v[60:63], v[88:91], v[32:35]
    v_mfma_f32_16x16x32_f16 v[36:39], v[60:63], v[92:95], v[36:39]
    v_mfma_f32_16x16x32_f16 v[40:43], v[60:63], v[96:99], v[40:43]
    v_mfma_f32_16x16x32_f16 v[44:47], v[60:63], v[100:103], v[44:47]
    v_mfma_f32_16x16x32_f16 v[48:51], v[60:63], v[104:107], v[48:51]
    s_waitcnt lgkmcnt(9)
    v_mfma_f32_16x16x32_f16 v[24:27], v[56:59], v[84:87], v[24:27]
    ds_read_b128 v[72:75], v16 offset:1024
    ds_read_b64 v[124:125], v17 offset:1024
    ds_read_b64 v[126:127], v17 offset:1032
    v_mfma_f32_16x16x32_f16 v[28:31], v[56:59], v[88:91], v[28:31]
    v_mfma_f32_16x16x32_f16 v[32:35], v[56:59], v[92:95], v[32:35]
    v_mfma_f32_16x16x32_f16 v[36:39], v[56:59], v[96:99], v[36:39]
    v_mfma_f32_16x16x32_f16 v[40:43], v[56:59], v[100:103], v[40:43]
    v_mfma_f32_16x16x32_f16 v[44:47], v[56:59], v[104:107], v[44:47]
    v_mfma_f32_16x16x32_f16 v[48:51], v[56:59], v[108:111], v[48:51]
    s_waitcnt lgkmcnt(9)
    v_mfma_f32_16x16x32_f16 v[20:23], v[52:55], v[84:87], v[20:23]
    ds_read_b128 v[68:71], v16 offset:1536
    ds_read_b64 v[128:129], v17 offset:1536
    ds_read_b64 v[130:131], v17 offset:1544
    v_mfma_f32_16x16x32_f16 v[24:27], v[52:55], v[88:91], v[24:27]
    v_mfma_f32_16x16x32_f16 v[28:31], v[52:55], v[92:95], v[28:31]
    v_mfma_f32_16x16x32_f16 v[32:35], v[52:55], v[96:99], v[32:35]
    v_mfma_f32_16x16x32_f16 v[36:39], v[52:55], v[100:103], v[36:39]
    v_mfma_f32_16x16x32_f16 v[40:43], v[52:55], v[104:107], v[40:43]
    v_mfma_f32_16x16x32_f16 v[44:47], v[52:55], v[108:111], v[44:47]
    v_mfma_f32_16x16x32_f16 v[48:51], v[52:55], v[112:115], v[48:51]
    s_waitcnt lgkmcnt(9)
    v_mfma_f32_16x16x32_f16 v[48:51], v[80:83], v[116:119], v[48:51]
    ds_read_b128 v[64:67], v16 offset:2048
    ds_read_b64 v[132:133], v17 offset:2048
    ds_read_b64 v[134:135], v17 offset:2056
    s_waitcnt lgkmcnt(9)
    v_mfma_f32_16x16x32_f16 v[44:47], v[76:79], v[116:119], v[44:47]
    ds_read_b128 v[60:63], v16 offset:2560
    ds_read_b64 v[136:137], v17 offset:2560
    ds_read_b64 v[138:139], v17 offset:2568
    v_mfma_f32_16x16x32_f16 v[48:51], v[76:79], v[120:123], v[48:51]
    s_waitcnt lgkmcnt(9)
    v_mfma_f32_16x16x32_f16 v[40:43], v[72:75], v[116:119], v[40:43]
    ds_read_b128 v[56:59], v16 offset:3072
    ds_read_b64 v[140:141], v17 offset:3072
    ds_read_b64 v[142:143], v17 offset:3080
    v_mfma_f32_16x16x32_f16 v[44:47], v[72:75], v[120:123], v[44:47]
    v_mfma_f32_16x16x32_f16 v[48:51], v[72:75], v[124:127], v[48:51]
    s_waitcnt lgkmcnt(9)
    v_mfma_f32_16x16x32_f16 v[36:39], v[68:71], v[116:119], v[36:39]
    ds_read_b128 v[52:55], v16 offset:3584
    ds_read_b64 v[144:145], v17 offset:3584
    ds_read_b64 v[146:147], v17 offset:3592
    v_mfma_f32_16x16x32_f16 v[40:43], v[68:71], v[120:123], v[40:43]
    v_mfma_f32_16x16x32_f16 v[44:47], v[68:71], v[124:127], v[44:47]
    v_mfma_f32_16x16x32_f16 v[48:51], v[68:71], v[128:131], v[48:51]
    s_waitcnt lgkmcnt(9)
    v_mfma_f32_16x16x32_f16 v[32:35], v[64:67], v[116:119], v[32:35]
    v_mfma_f32_16x16x32_f16 v[36:39], v[64:67], v[120:123], v[36:39]
    v_mfma_f32_16x16x32_f16 v[40:43], v[64:67], v[124:127], v[40:43]
    v_mfma_f32_16x16x32_f16 v[44:47], v[64:67], v[128:131], v[44:47]
    v_mfma_f32_16x16x32_f16 v[48:51], v[64:67], v[132:135], v[48:51]
    s_waitcnt lgkmcnt(6)
    v_mfma_f32_16x16x32_f16 v[28:31], v[60:63], v[116:119], v[28:31]
    v_mfma_f32_16x16x32_f16 v[32:35], v[60:63], v[120:123], v[32:35]
    v_mfma_f32_16x16x32_f16 v[36:39], v[60:63], v[124:127], v[36:39]
    v_mfma_f32_16x16x32_f16 v[40:43], v[60:63], v[128:131], v[40:43]
    v_mfma_f32_16x16x32_f16 v[44:47], v[60:63], v[132:135], v[44:47]
    v_mfma_f32_16x16x32_f16 v[48:51], v[60:63], v[136:139], v[48:51]
    s_waitcnt lgkmcnt(3)
    v_mfma_f32_16x16x32_f16 v[24:27], v[56:59], v[116:119], v[24:27]
    v_mfma_f32_16x16x32_f16 v[28:31], v[56:59], v[120:123], v[28:31]
    v_mfma_f32_16x16x32_f16 v[32:35], v[56:59], v[124:127], v[32:35]
    v_mfma_f32_16x16x32_f16 v[36:39], v[56:59], v[128:131], v[36:39]
    v_mfma_f32_16x16x32_f16 v[40:43], v[56:59], v[132:135], v[40:43]
    v_mfma_f32_16x16x32_f16 v[44:47], v[56:59], v[136:139], v[44:47]
    v_mfma_f32_16x16x32_f16 v[48:51], v[56:59], v[140:143], v[48:51]
    s_waitcnt lgkmcnt(0)
    v_mfma_f32_16x16x32_f16 v[20:23], v[52:55], v[116:119], v[20:23]
    v_mfma_f32_16x16x32_f16 v[24:27], v[52:55], v[120:123], v[24:27]
    v_mfma_f32_16x16x32_f16 v[28:31], v[52:55], v[124:127], v[28:31]
    v_mfma_f32_16x16x32_f16 v[32:35], v[52:55], v[128:131], v[32:35]
    v_mfma_f32_16x16x32_f16 v[36:39], v[52:55], v[132:135], v[36:39]
    v_mfma_f32_16x16x32_f16 v[40:43], v[52:55], v[136:139], v[40:43]
    v_mfma_f32_16x16x32_f16 v[44:47], v[52:55], v[140:143], v[44:47]
    v_mfma_f32_16x16x32_f16 v[48:51], v[52:55], v[144:147], v[48:51]
    v_lshlrev_b32 v4, 4, v3
    s_nop 9
    s_cmp_eq_u32 s17, 0
    s_cbranch_scc0 K2_R0
    ds_write_b128 v4, v[28:31] offset:33024
    ds_write_b128 v4, v[32:35] offset:34048
    ds_write_b128 v4, v[36:39] offset:37120
    ds_write_b128 v4, v[40:43] offset:38144
    ds_write_b128 v4, v[44:47] offset:41216
    ds_write_b128 v4, v[48:51] offset:42240
    v_mov_b32 v52, v20
    v_mov_b32 v53, v21
    v_mov_b32 v54, v22
    v_mov_b32 v55, v23
    v_mov_b32 v56, v24
    v_mov_b32 v57, v25
    v_mov_b32 v58, v26
    v_mov_b32 v59, v27
K2_R0:
    s_cmp_eq_u32 s17, 1
    s_cbranch_scc0 K2_R1
    ds_write_b128 v4, v[20:23] offset:22784
    ds_write_b128 v4, v[24:27] offset:23808
    ds_write_b128 v4, v[36:39] offset:39168
    ds_write_b128 v4, v[40:43] offset:40192
    ds_write_b128 v4, v[44:47] offset:43264
    ds_write_b128 v4, v[48:51] offset:44288
    v_mov_b32 v52, v28
    v_mov_b32 v53, v29
    v_mov_b32 v54, v30
    v_mov_b32 v55, v31
    v_mov_b32 v56, v32
    v_mov_b32 v57, v33
    v_mov_b32 v58, v34
    v_mov_b32 v59, v35
K2_R1:
    s_cmp_eq_u32 s17, 2
    s_cbranch_scc0 K2_R2
    ds_write_b128 v4, v[20:23] offset:24832
    ds_write_b128 v4, v[24:27] offset:25856
    ds_write_b128 v4, v[28:31] offset:28928
    ds_write_b128 v4, v[32:35] offset:29952
    ds_write_b128 v4, v[44:47] offset:45312
    ds_write_b128 v4, v[48:51] offset:46336
    v_mov_b32 v52, v36
    v_mov_b32 v53, v37
    v_mov_b32 v54, v38
    v_mov_b32 v55, v39
    v_mov_b32 v56, v40
    v_mov_b32 v57, v41
    v_mov_b32 v58, v42
    v_mov_b32 v59, v43
K2_R2:
    s_cmp_eq_u32 s17, 3
    s_cbranch_scc0 K2_R3
    ds_write_b128 v4, v[20:23] offset:26880
    ds_write_b128 v4, v[24:27] offset:27904
    ds_write_b128 v4, v[28:31] offset:30976
    ds_write_b128 v4, v[32:35] offset:32000
    ds_write_b128 v4, v[36:39] offset:35072
    ds_write_b128 v4, v[40:43] offset:36096
    v_mov_b32 v52, v44
    v_mov_b32 v53, v45
    v_mov_b32 v54, v46
    v_mov_b32 v55, v47
    v_mov_b32 v56, v48
    v_mov_b32 v57, v49
    v_mov_b32 v58, v50
    v_mov_b32 v59, v51
K2_R3:
    s_nop 7
    s_waitcnt lgkmcnt(0)
    s_barrier
    s_mul_i32 s20, s17, 6144
    v_add_u32 v4, s20, v4
    ds_read_b128 v[60:63], v4 offset:22784
    ds_read_b128 v[64:67], v4 offset:23808
    ds_read_b128 v[68:71], v4 offset:24832
    ds_read_b128 v[72:75], v4 offset:25856
    ds_read_b128 v[76:79], v4 offset:26880
    ds_read_b128 v[80:83], v4 offset:27904
    s_lshl_b32 s20, s17, 10
    v_lshl_add_u32 v5, v3, 3, s20
    ds_read_b64 v[84:85], v5 offset:18688
    ds_read_b64 v[86:87], v5 offset:19200
    s_waitcnt lgkmcnt(0)
    s_lshl_b32 s26, s25, 16
    s_and_b32 s27, s25, 0xffff0000
    s_bitcmp1_b32 s3, 0
    s_cselect_b32 s25, s27, s26
    v_pk_add_f32 v[52:53], v[52:53], v[60:61]
    v_pk_add_f32 v[54:55], v[54:55], v[62:63]
    v_pk_add_f32 v[56:57], v[56:57], v[64:65]
    v_pk_add_f32 v[58:59], v[58:59], v[66:67]
    v_pk_add_f32 v[52:53], v[52:53], v[68:69]
    v_pk_add_f32 v[54:55], v[54:55], v[70:71]
    v_pk_add_f32 v[56:57], v[56:57], v[72:73]
    v_pk_add_f32 v[58:59], v[58:59], v[74:75]
    v_pk_add_f32 v[52:53], v[52:53], v[76:77]
    v_pk_add_f32 v[54:55], v[54:55], v[78:79]
    v_pk_add_f32 v[56:57], v[56:57], v[80:81]
    v_pk_add_f32 v[58:59], v[58:59], v[82:83]
    v_mul_f32 v52, s24, v52
    v_mul_f32 v53, s24, v53
    v_cvt_pk_bf16_f32 v6, v52, v53
    v_lshlrev_b32 v52, 16, v6
    v_and_b32 v53, 0xffff0000, v6
    v_cvt_f32_f16 v8, v84
    v_cvt_f32_f16_sdwa v9, v84 dst_sel:DWORD dst_unused:UNUSED_PAD src0_sel:WORD_1
    v_mul_f32 v8, s25, v8
    v_mul_f32 v9, s25, v9
    v_cvt_pk_bf16_f32 v6, v8, v9
    v_lshlrev_b32 v8, 16, v6
    v_and_b32 v9, 0xffff0000, v6
    v_pk_add_f32 v[8:9], v[8:9], v[52:53]
    v_cvt_pk_bf16_f32 v88, v8, v9
    v_mul_f32 v54, s24, v54
    v_mul_f32 v55, s24, v55
    v_cvt_pk_bf16_f32 v6, v54, v55
    v_lshlrev_b32 v54, 16, v6
    v_and_b32 v55, 0xffff0000, v6
    v_cvt_f32_f16 v8, v85
    v_cvt_f32_f16_sdwa v9, v85 dst_sel:DWORD dst_unused:UNUSED_PAD src0_sel:WORD_1
    v_mul_f32 v8, s25, v8
    v_mul_f32 v9, s25, v9
    v_cvt_pk_bf16_f32 v6, v8, v9
    v_lshlrev_b32 v8, 16, v6
    v_and_b32 v9, 0xffff0000, v6
    v_pk_add_f32 v[8:9], v[8:9], v[54:55]
    v_cvt_pk_bf16_f32 v89, v8, v9
    v_mul_f32 v56, s24, v56
    v_mul_f32 v57, s24, v57
    v_cvt_pk_bf16_f32 v6, v56, v57
    v_lshlrev_b32 v56, 16, v6
    v_and_b32 v57, 0xffff0000, v6
    v_cvt_f32_f16 v8, v86
    v_cvt_f32_f16_sdwa v9, v86 dst_sel:DWORD dst_unused:UNUSED_PAD src0_sel:WORD_1
    v_mul_f32 v8, s25, v8
    v_mul_f32 v9, s25, v9
    v_cvt_pk_bf16_f32 v6, v8, v9
    v_lshlrev_b32 v8, 16, v6
    v_and_b32 v9, 0xffff0000, v6
    v_pk_add_f32 v[8:9], v[8:9], v[56:57]
    v_cvt_pk_bf16_f32 v90, v8, v9
    v_mul_f32 v58, s24, v58
    v_mul_f32 v59, s24, v59
    v_cvt_pk_bf16_f32 v6, v58, v59
    v_lshlrev_b32 v58, 16, v6
    v_and_b32 v59, 0xffff0000, v6
    v_cvt_f32_f16 v8, v87
    v_cvt_f32_f16_sdwa v9, v87 dst_sel:DWORD dst_unused:UNUSED_PAD src0_sel:WORD_1
    v_mul_f32 v8, s25, v8
    v_mul_f32 v9, s25, v9
    v_cvt_pk_bf16_f32 v6, v8, v9
    v_lshlrev_b32 v8, 16, v6
    v_and_b32 v9, 0xffff0000, v6
    v_pk_add_f32 v[8:9], v[8:9], v[58:59]
    v_cvt_pk_bf16_f32 v91, v8, v9
    s_lshl_b32 s20, s3, 12
    buffer_store_dwordx2 v[88:89], v5, s[28:31], s20 offen
    buffer_store_dwordx2 v[90:91], v5, s[28:31], s20 offen offset:512
K2_END:
    s_endpgm
.globl k3_kernel
.p2align 8
.type k3_kernel,@function
k3_kernel:
    s_cmp_ge_u32 s2, 256
    s_cbranch_scc1 K3_END
    s_load_dwordx2 s[4:5], s[0:1], 0
    s_load_dwordx2 s[6:7], s[0:1], 128
    s_load_dwordx2 s[32:33], s[0:1], 80
    s_load_dwordx2 s[34:35], s[0:1], 112
    s_and_b32 s16, s2, 7
    s_lshl_b32 s16, s16, 5
    s_lshr_b32 s3, s2, 3
    s_add_u32 s16, s3, s16
    s_mul_i32 s3, s16, 9216
    s_lshl_b32 s17, s16, 4
    v_lshrrev_b32 v1, 5, v0
    v_and_b32 v2, 31, v0
    v_mul_u32_u24 v3, 1152, v1
    v_lshl_add_u32 v3, v2, 2, v3
    v_lshlrev_b32 v6, 12, v0
    v_lshlrev_b32 v7, 2, v2
    v_readfirstlane_b32 s18, v0
    s_waitcnt lgkmcnt(0)
    s_mov_b32 s8, s4
    s_mov_b32 s9, s5
    s_mov_b32 s10, 0x240000
    s_mov_b32 s11, 0x20000
    s_add_u32 s12, s6, 0x600000
    s_addc_u32 s13, s7, 0
    s_mov_b32 s14, 0x240000
    s_mov_b32 s15, 0x20000
    s_mov_b32 s20, s32
    s_mov_b32 s21, s33
    s_mov_b32 s22, 0x480
    s_mov_b32 s23, 0x20000
    s_add_u32 s19, s17, 0x100000
    buffer_load_dwordx4 v[60:63], v6, s[12:15], s17 offen
    buffer_load_dwordx4 v[64:67], v6, s[12:15], s19 offen
    s_add_u32 s19, s17, 0x200000
    buffer_load_dwordx4 v[68:71], v6, s[12:15], s19 offen
    buffer_load_dword v10, v3, s[8:11], s3 offen offset:0
    buffer_load_dword v11, v3, s[8:11], s3 offen offset:128
    buffer_load_dword v12, v3, s[8:11], s3 offen offset:256
    buffer_load_dword v13, v3, s[8:11], s3 offen offset:384
    buffer_load_dword v14, v3, s[8:11], s3 offen offset:512
    buffer_load_dword v15, v3, s[8:11], s3 offen offset:640
    buffer_load_dword v16, v3, s[8:11], s3 offen offset:768
    buffer_load_dword v17, v3, s[8:11], s3 offen offset:896
    buffer_load_dword v18, v3, s[8:11], s3 offen offset:1024
    buffer_load_dword v50, v7, s[20:23], 0 offen offset:0
    buffer_load_dword v51, v7, s[20:23], 0 offen offset:128
    buffer_load_dword v52, v7, s[20:23], 0 offen offset:256
    buffer_load_dword v53, v7, s[20:23], 0 offen offset:384
    buffer_load_dword v54, v7, s[20:23], 0 offen offset:512
    buffer_load_dword v55, v7, s[20:23], 0 offen offset:640
    buffer_load_dword v56, v7, s[20:23], 0 offen offset:768
    buffer_load_dword v57, v7, s[20:23], 0 offen offset:896
    buffer_load_dword v58, v7, s[20:23], 0 offen offset:1024
    s_mov_b32 s24, s34
    s_mov_b32 s25, s35
    s_mov_b32 s26, 0x240000
    s_mov_b32 s27, 0x20000
    s_add_u32 s28, s6, 0x900000
    s_addc_u32 s29, s7, 0
    s_mov_b32 s30, 0x240000
    s_mov_b32 s31, 0x20000
    s_add_u32 s36, s6, 0xc00000
    s_addc_u32 s37, s7, 0
    s_mov_b32 s38, 0x2000
    s_mov_b32 s39, 0x20000
    v_lshrrev_b32 v4, 6, v0
    v_mul_u32_u24 v4, 2304, v4
    v_lshl_add_u32 v4, v2, 3, v4
    v_and_b32 v5, 1, v1
    v_mul_u32_u24 v5, 0x020202, v5
    v_lshlrev_b32 v8, 25, v1
    v_and_b32 v8, 0x02000000, v8
    v_or_b32 v5, v5, v8
    v_add_u32 v5, 0x05040100, v5
    v_lshlrev_b32 v8, 2, v0
    s_waitcnt vmcnt(19)
    ds_write2st64_b32 v8, v60, v61 offset0:0 offset1:9
    ds_write2st64_b32 v8, v62, v63 offset0:18 offset1:27
    ds_write2st64_b32 v8, v64, v65 offset0:4 offset1:13
    ds_write2st64_b32 v8, v66, v67 offset0:22 offset1:31
    s_waitcnt vmcnt(18)
    s_cmp_ge_u32 s18, 64
    s_cbranch_scc1 K3_SKIP
    ds_write2st64_b32 v8, v68, v69 offset0:8 offset1:17
    ds_write2st64_b32 v8, v70, v71 offset0:26 offset1:35
K3_SKIP:
    s_waitcnt lgkmcnt(0)
    s_barrier
    ds_read_b64 v[60:61], v4 offset:0
    ds_read_b64 v[62:63], v4 offset:256
    ds_read_b64 v[64:65], v4 offset:512
    ds_read_b64 v[66:67], v4 offset:768
    ds_read_b64 v[68:69], v4 offset:1024
    ds_read_b64 v[70:71], v4 offset:1280
    ds_read_b64 v[72:73], v4 offset:1536
    ds_read_b64 v[74:75], v4 offset:1792
    ds_read_b64 v[76:77], v4 offset:2048
    s_waitcnt vmcnt(9)
    s_waitcnt lgkmcnt(8)
    v_perm_b32 v44, v61, v60, v5
    v_lshlrev_b32 v46, 16, v44
    v_and_b32 v47, 0xffff0000, v44
    v_lshlrev_b32 v20, 16, v10
    v_and_b32 v21, 0xffff0000, v10
    v_pk_add_f32 v[46:47], v[46:47], v[20:21]
    v_cvt_pk_bf16_f32 v44, v46, v47
    v_lshlrev_b32 v20, 16, v44
    v_and_b32 v21, 0xffff0000, v44
    s_waitcnt lgkmcnt(7)
    v_perm_b32 v44, v63, v62, v5
    v_lshlrev_b32 v46, 16, v44
    v_and_b32 v47, 0xffff0000, v44
    v_lshlrev_b32 v22, 16, v11
    v_and_b32 v23, 0xffff0000, v11
    v_pk_add_f32 v[46:47], v[46:47], v[22:23]
    v_cvt_pk_bf16_f32 v44, v46, v47
    v_lshlrev_b32 v22, 16, v44
    v_and_b32 v23, 0xffff0000, v44
    s_waitcnt lgkmcnt(6)
    v_perm_b32 v44, v65, v64, v5
    v_lshlrev_b32 v46, 16, v44
    v_and_b32 v47, 0xffff0000, v44
    v_lshlrev_b32 v24, 16, v12
    v_and_b32 v25, 0xffff0000, v12
    v_pk_add_f32 v[46:47], v[46:47], v[24:25]
    v_cvt_pk_bf16_f32 v44, v46, v47
    v_lshlrev_b32 v24, 16, v44
    v_and_b32 v25, 0xffff0000, v44
    s_waitcnt lgkmcnt(5)
    v_perm_b32 v44, v67, v66, v5
    v_lshlrev_b32 v46, 16, v44
    v_and_b32 v47, 0xffff0000, v44
    v_lshlrev_b32 v26, 16, v13
    v_and_b32 v27, 0xffff0000, v13
    v_pk_add_f32 v[46:47], v[46:47], v[26:27]
    v_cvt_pk_bf16_f32 v44, v46, v47
    v_lshlrev_b32 v26, 16, v44
    v_and_b32 v27, 0xffff0000, v44
    s_waitcnt lgkmcnt(4)
    v_perm_b32 v44, v69, v68, v5
    v_lshlrev_b32 v46, 16, v44
    v_and_b32 v47, 0xffff0000, v44
    v_lshlrev_b32 v28, 16, v14
    v_and_b32 v29, 0xffff0000, v14
    v_pk_add_f32 v[46:47], v[46:47], v[28:29]
    v_cvt_pk_bf16_f32 v44, v46, v47
    v_lshlrev_b32 v28, 16, v44
    v_and_b32 v29, 0xffff0000, v44
    s_waitcnt lgkmcnt(3)
    v_perm_b32 v44, v71, v70, v5
    v_lshlrev_b32 v46, 16, v44
    v_and_b32 v47, 0xffff0000, v44
    v_lshlrev_b32 v30, 16, v15
    v_and_b32 v31, 0xffff0000, v15
    v_pk_add_f32 v[46:47], v[46:47], v[30:31]
    v_cvt_pk_bf16_f32 v44, v46, v47
    v_lshlrev_b32 v30, 16, v44
    v_and_b32 v31, 0xffff0000, v44
    s_waitcnt lgkmcnt(2)
    v_perm_b32 v44, v73, v72, v5
    v_lshlrev_b32 v46, 16, v44
    v_and_b32 v47, 0xffff0000, v44
    v_lshlrev_b32 v32, 16, v16
    v_and_b32 v33, 0xffff0000, v16
    v_pk_add_f32 v[46:47], v[46:47], v[32:33]
    v_cvt_pk_bf16_f32 v44, v46, v47
    v_lshlrev_b32 v32, 16, v44
    v_and_b32 v33, 0xffff0000, v44
    s_waitcnt lgkmcnt(1)
    v_perm_b32 v44, v75, v74, v5
    v_lshlrev_b32 v46, 16, v44
    v_and_b32 v47, 0xffff0000, v44
    v_lshlrev_b32 v34, 16, v17
    v_and_b32 v35, 0xffff0000, v17
    v_pk_add_f32 v[46:47], v[46:47], v[34:35]
    v_cvt_pk_bf16_f32 v44, v46, v47
    v_lshlrev_b32 v34, 16, v44
    v_and_b32 v35, 0xffff0000, v44
    s_waitcnt lgkmcnt(0)
    v_perm_b32 v44, v77, v76, v5
    v_lshlrev_b32 v46, 16, v44
    v_and_b32 v47, 0xffff0000, v44
    v_lshlrev_b32 v36, 16, v18
    v_and_b32 v37, 0xffff0000, v18
    v_pk_add_f32 v[46:47], v[46:47], v[36:37]
    v_cvt_pk_bf16_f32 v44, v46, v47
    v_lshlrev_b32 v36, 16, v44
    v_and_b32 v37, 0xffff0000, v44
    v_pk_add_f32 v[44:45], v[20:21], v[22:23]
    v_pk_add_f32 v[46:47], v[24:25], v[26:27]
    v_pk_add_f32 v[44:45], v[44:45], v[28:29]
    v_pk_add_f32 v[46:47], v[46:47], v[30:31]
    v_pk_add_f32 v[44:45], v[44:45], v[32:33]
    v_pk_add_f32 v[46:47], v[46:47], v[34:35]
    v_pk_add_f32 v[44:45], v[44:45], v[36:37]
    v_pk_add_f32 v[44:45], v[44:45], v[46:47]
    v_add_f32 v44, v44, v45
    s_nop 1
    v_add_f32_dpp v44, v44, v44 row_ror:8 row_mask:0xf bank_mask:0xf
    s_nop 1
    v_add_f32_dpp v44, v44, v44 row_ror:4 row_mask:0xf bank_mask:0xf
    s_nop 1
    v_add_f32_dpp v44, v44, v44 row_ror:2 row_mask:0xf bank_mask:0xf
    s_nop 1
    v_add_f32_dpp v44, v44, v44 row_ror:1 row_mask:0xf bank_mask:0xf
    v_mov_b32 v46, v44
    s_nop 1
    v_permlane16_swap_b32 v44, v46
    v_add_f32 v44, v44, v46
    v_mul_f32 v48, 0x3ae38e39, v44
    v_mov_b32 v49, v48
    v_cvt_pk_bf16_f32 v40, v48, v48
    v_and_b32 v40, 0xffff0000, v40
    v_mov_b32 v41, v40
    v_pk_add_f32 v[42:43], v[20:21], v[48:49] neg_lo:[0,1] neg_hi:[0,1]
    v_pk_mul_f32 v[44:45], v[42:43], v[42:43]
    v_pk_add_f32 v[42:43], v[22:23], v[48:49] neg_lo:[0,1] neg_hi:[0,1]
    v_pk_mul_f32 v[46:47], v[42:43], v[42:43]
    v_pk_add_f32 v[42:43], v[24:25], v[48:49] neg_lo:[0,1] neg_hi:[0,1]
    v_pk_fma_f32 v[44:45], v[42:43], v[42:43], v[44:45]
    v_pk_add_f32 v[42:43], v[26:27], v[48:49] neg_lo:[0,1] neg_hi:[0,1]
    v_pk_fma_f32 v[46:47], v[42:43], v[42:43], v[46:47]
    v_pk_add_f32 v[42:43], v[28:29], v[48:49] neg_lo:[0,1] neg_hi:[0,1]
    v_pk_fma_f32 v[44:45], v[42:43], v[42:43], v[44:45]
    v_pk_add_f32 v[42:43], v[30:31], v[48:49] neg_lo:[0,1] neg_hi:[0,1]
    v_pk_fma_f32 v[46:47], v[42:43], v[42:43], v[46:47]
    v_pk_add_f32 v[42:43], v[32:33], v[48:49] neg_lo:[0,1] neg_hi:[0,1]
    v_pk_fma_f32 v[44:45], v[42:43], v[42:43], v[44:45]
    v_pk_add_f32 v[42:43], v[34:35], v[48:49] neg_lo:[0,1] neg_hi:[0,1]
    v_pk_fma_f32 v[46:47], v[42:43], v[42:43], v[46:47]
    v_pk_add_f32 v[42:43], v[36:37], v[48:49] neg_lo:[0,1] neg_hi:[0,1]
    v_pk_fma_f32 v[44:45], v[42:43], v[42:43], v[44:45]
    v_pk_add_f32 v[44:45], v[44:45], v[46:47]
    v_add_f32 v44, v44, v45
    s_nop 1
    v_add_f32_dpp v44, v44, v44 row_ror:8 row_mask:0xf bank_mask:0xf
    s_nop 1
    v_add_f32_dpp v44, v44, v44 row_ror:4 row_mask:0xf bank_mask:0xf
    s_nop 1
    v_add_f32_dpp v44, v44, v44 row_ror:2 row_mask:0xf bank_mask:0xf
    s_nop 1
    v_add_f32_dpp v44, v44, v44 row_ror:1 row_mask:0xf bank_mask:0xf
    v_mov_b32 v46, v44
    s_nop 1
    v_permlane16_swap_b32 v44, v46
    v_add_f32 v44, v44, v46
    v_mul_f32 v44, 0x3ae38e39, v44
    v_cvt_pk_bf16_f32 v44, v44, v44
    v_and_b32 v44, 0xffff0000, v44
    v_add_f32 v44, 0x3727c5ac, v44
    v_cvt_pk_bf16_f32 v44, v44, v44
    v_and_b32 v44, 0xffff0000, v44
    v_sqrt_f32 v44, v44
    s_nop 0
    v_cvt_pk_bf16_f32 v44, v44, v44
    v_and_b32 v44, 0xffff0000, v44
    v_rcp_f32 v42, v44
    s_nop 0
    v_mov_b32 v43, v42
    s_waitcnt vmcnt(0)
    v_mov_b32 v60, 0
    v_mov_b32 v61, 0
    v_pk_add_f32 v[44:45], v[20:21], v[40:41] neg_lo:[0,1] neg_hi:[0,1]
    v_cvt_pk_bf16_f32 v10, v44, v45
    v_lshlrev_b32 v44, 16, v10
    v_and_b32 v45, 0xffff0000, v10
    v_pk_mul_f32 v[44:45], v[44:45], v[42:43]
    v_cvt_pk_bf16_f32 v10, v44, v45
    v_lshlrev_b32 v44, 16, v10
    v_and_b32 v45, 0xffff0000, v10
    buffer_store_dword v10, v3, s[28:31], s3 offen offset:0
    v_lshlrev_b32 v46, 16, v50
    v_and_b32 v47, 0xffff0000, v50
    v_pk_fma_f32 v[60:61], v[44:45], v[46:47], v[60:61]
    v_pk_add_f32 v[44:45], v[44:45], v[20:21]
    v_cvt_pk_bf16_f32 v50, v44, v45
    buffer_store_dword v50, v3, s[24:27], s3 offen offset:0
    v_pk_add_f32 v[44:45], v[22:23], v[40:41] neg_lo:[0,1] neg_hi:[0,1]
    v_cvt_pk_bf16_f32 v11, v44, v45
    v_lshlrev_b32 v44, 16, v11
    v_and_b32 v45, 0xffff0000, v11
    v_pk_mul_f32 v[44:45], v[44:45], v[42:43]
    v_cvt_pk_bf16_f32 v11, v44, v45
    v_lshlrev_b32 v44, 16, v11
    v_and_b32 v45, 0xffff0000, v11
    buffer_store_dword v11, v3, s[28:31], s3 offen offset:128
    v_lshlrev_b32 v46, 16, v51
    v_and_b32 v47, 0xffff0000, v51
    v_pk_fma_f32 v[60:61], v[44:45], v[46:47], v[60:61]
    v_pk_add_f32 v[44:45], v[44:45], v[22:23]
    v_cvt_pk_bf16_f32 v51, v44, v45
    buffer_store_dword v51, v3, s[24:27], s3 offen offset:128
    v_pk_add_f32 v[44:45], v[24:25], v[40:41] neg_lo:[0,1] neg_hi:[0,1]
    v_cvt_pk_bf16_f32 v12, v44, v45
    v_lshlrev_b32 v44, 16, v12
    v_and_b32 v45, 0xffff0000, v12
    v_pk_mul_f32 v[44:45], v[44:45], v[42:43]
    v_cvt_pk_bf16_f32 v12, v44, v45
    v_lshlrev_b32 v44, 16, v12
    v_and_b32 v45, 0xffff0000, v12
    buffer_store_dword v12, v3, s[28:31], s3 offen offset:256
    v_lshlrev_b32 v46, 16, v52
    v_and_b32 v47, 0xffff0000, v52
    v_pk_fma_f32 v[60:61], v[44:45], v[46:47], v[60:61]
    v_pk_add_f32 v[44:45], v[44:45], v[24:25]
    v_cvt_pk_bf16_f32 v52, v44, v45
    buffer_store_dword v52, v3, s[24:27], s3 offen offset:256
    v_pk_add_f32 v[44:45], v[26:27], v[40:41] neg_lo:[0,1] neg_hi:[0,1]
    v_cvt_pk_bf16_f32 v13, v44, v45
    v_lshlrev_b32 v44, 16, v13
    v_and_b32 v45, 0xffff0000, v13
    v_pk_mul_f32 v[44:45], v[44:45], v[42:43]
    v_cvt_pk_bf16_f32 v13, v44, v45
    v_lshlrev_b32 v44, 16, v13
    v_and_b32 v45, 0xffff0000, v13
    buffer_store_dword v13, v3, s[28:31], s3 offen offset:384
    v_lshlrev_b32 v46, 16, v53
    v_and_b32 v47, 0xffff0000, v53
    v_pk_fma_f32 v[60:61], v[44:45], v[46:47], v[60:61]
    v_pk_add_f32 v[44:45], v[44:45], v[26:27]
    v_cvt_pk_bf16_f32 v53, v44, v45
    buffer_store_dword v53, v3, s[24:27], s3 offen offset:384
    v_pk_add_f32 v[44:45], v[28:29], v[40:41] neg_lo:[0,1] neg_hi:[0,1]
    v_cvt_pk_bf16_f32 v14, v44, v45
    v_lshlrev_b32 v44, 16, v14
    v_and_b32 v45, 0xffff0000, v14
    v_pk_mul_f32 v[44:45], v[44:45], v[42:43]
    v_cvt_pk_bf16_f32 v14, v44, v45
    v_lshlrev_b32 v44, 16, v14
    v_and_b32 v45, 0xffff0000, v14
    buffer_store_dword v14, v3, s[28:31], s3 offen offset:512
    v_lshlrev_b32 v46, 16, v54
    v_and_b32 v47, 0xffff0000, v54
    v_pk_fma_f32 v[60:61], v[44:45], v[46:47], v[60:61]
    v_pk_add_f32 v[44:45], v[44:45], v[28:29]
    v_cvt_pk_bf16_f32 v54, v44, v45
    buffer_store_dword v54, v3, s[24:27], s3 offen offset:512
    v_pk_add_f32 v[44:45], v[30:31], v[40:41] neg_lo:[0,1] neg_hi:[0,1]
    v_cvt_pk_bf16_f32 v15, v44, v45
    v_lshlrev_b32 v44, 16, v15
    v_and_b32 v45, 0xffff0000, v15
    v_pk_mul_f32 v[44:45], v[44:45], v[42:43]
    v_cvt_pk_bf16_f32 v15, v44, v45
    v_lshlrev_b32 v44, 16, v15
    v_and_b32 v45, 0xffff0000, v15
    buffer_store_dword v15, v3, s[28:31], s3 offen offset:640
    v_lshlrev_b32 v46, 16, v55
    v_and_b32 v47, 0xffff0000, v55
    v_pk_fma_f32 v[60:61], v[44:45], v[46:47], v[60:61]
    v_pk_add_f32 v[44:45], v[44:45], v[30:31]
    v_cvt_pk_bf16_f32 v55, v44, v45
    buffer_store_dword v55, v3, s[24:27], s3 offen offset:640
    v_pk_add_f32 v[44:45], v[32:33], v[40:41] neg_lo:[0,1] neg_hi:[0,1]
    v_cvt_pk_bf16_f32 v16, v44, v45
    v_lshlrev_b32 v44, 16, v16
    v_and_b32 v45, 0xffff0000, v16
    v_pk_mul_f32 v[44:45], v[44:45], v[42:43]
    v_cvt_pk_bf16_f32 v16, v44, v45
    v_lshlrev_b32 v44, 16, v16
    v_and_b32 v45, 0xffff0000, v16
    buffer_store_dword v16, v3, s[28:31], s3 offen offset:768
    v_lshlrev_b32 v46, 16, v56
    v_and_b32 v47, 0xffff0000, v56
    v_pk_fma_f32 v[60:61], v[44:45], v[46:47], v[60:61]
    v_pk_add_f32 v[44:45], v[44:45], v[32:33]
    v_cvt_pk_bf16_f32 v56, v44, v45
    buffer_store_dword v56, v3, s[24:27], s3 offen offset:768
    v_pk_add_f32 v[44:45], v[34:35], v[40:41] neg_lo:[0,1] neg_hi:[0,1]
    v_cvt_pk_bf16_f32 v17, v44, v45
    v_lshlrev_b32 v44, 16, v17
    v_and_b32 v45, 0xffff0000, v17
    v_pk_mul_f32 v[44:45], v[44:45], v[42:43]
    v_cvt_pk_bf16_f32 v17, v44, v45
    v_lshlrev_b32 v44, 16, v17
    v_and_b32 v45, 0xffff0000, v17
    buffer_store_dword v17, v3, s[28:31], s3 offen offset:896
    v_lshlrev_b32 v46, 16, v57
    v_and_b32 v47, 0xffff0000, v57
    v_pk_fma_f32 v[60:61], v[44:45], v[46:47], v[60:61]
    v_pk_add_f32 v[44:45], v[44:45], v[34:35]
    v_cvt_pk_bf16_f32 v57, v44, v45
    buffer_store_dword v57, v3, s[24:27], s3 offen offset:896
    v_pk_add_f32 v[44:45], v[36:37], v[40:41] neg_lo:[0,1] neg_hi:[0,1]
    v_cvt_pk_bf16_f32 v18, v44, v45
    v_lshlrev_b32 v44, 16, v18
    v_and_b32 v45, 0xffff0000, v18
    v_pk_mul_f32 v[44:45], v[44:45], v[42:43]
    v_cvt_pk_bf16_f32 v18, v44, v45
    v_lshlrev_b32 v44, 16, v18
    v_and_b32 v45, 0xffff0000, v18
    buffer_store_dword v18, v3, s[28:31], s3 offen offset:1024
    v_lshlrev_b32 v46, 16, v58
    v_and_b32 v47, 0xffff0000, v58
    v_pk_fma_f32 v[60:61], v[44:45], v[46:47], v[60:61]
    v_pk_add_f32 v[44:45], v[44:45], v[36:37]
    v_cvt_pk_bf16_f32 v58, v44, v45
    buffer_store_dword v58, v3, s[24:27], s3 offen offset:1024
    v_add_f32 v60, v60, v61
    s_nop 1
    v_add_f32_dpp v60, v60, v60 row_ror:8 row_mask:0xf bank_mask:0xf
    s_nop 1
    v_add_f32_dpp v60, v60, v60 row_ror:4 row_mask:0xf bank_mask:0xf
    s_nop 1
    v_add_f32_dpp v60, v60, v60 row_ror:2 row_mask:0xf bank_mask:0xf
    s_nop 1
    v_add_f32_dpp v60, v60, v60 row_ror:1 row_mask:0xf bank_mask:0xf
    v_mov_b32 v61, v60
    s_nop 1
    v_permlane16_swap_b32 v60, v61
    v_add_f32 v60, v60, v61
    v_cvt_pk_bf16_f32 v60, v60, v60
    v_ashrrev_i32 v61, 31, v60
    v_or_b32 v61, 0x80000000, v61
    v_xor_b32 v60, v60, v61
    v_and_b32 v60, 0xffff0000, v60
    s_lshl_b32 s19, s16, 3
    v_add_u32 v61, s19, v1
    v_sub_u32 v62, 2047, v61
    v_or_b32 v60, v60, v62
    v_lshlrev_b32 v61, 2, v61
    v_cmp_eq_u32 vcc, 0, v2
    s_and_saveexec_b64 s[40:41], vcc
    buffer_store_dword v60, v61, s[36:39], 0 offen
K3_END:
    s_endpgm
.globl k4_kernel
.p2align 8
.type k4_kernel,@function
k4_kernel:
    s_cmp_ge_u32 s2, 144
    s_cbranch_scc1 K4_END
    s_load_dwordx4 s[4:7], s[0:1], 88
    s_load_dwordx2 s[32:33], s[0:1], 104
    s_load_dwordx2 s[34:35], s[0:1], 128
    v_readfirstlane_b32 s17, v0
    s_lshr_b32 s17, s17, 6
    v_and_b32 v1, 63, v0
    v_and_b32 v2, 15, v1
    v_lshrrev_b32 v3, 4, v1
    s_waitcnt lgkmcnt(0)
    s_add_u32 s36, s34, 0xc00000
    s_addc_u32 s37, s35, 0
    s_mov_b32 s38, 0x2000
    s_mov_b32 s39, 0x20000
    v_lshlrev_b32 v4, 4, v0
    buffer_load_dwordx4 v[8:11], v4, s[36:39], 0 offen
    v_mov_b32 v12, s4
    v_mov_b32 v13, s5
    v_mov_b32 v14, s6
    v_mov_b32 v15, s7
    v_cmp_gt_u32 vcc, 8, v2
    s_nop 1
    v_cndmask_b32 v12, v14, v12, vcc
    v_cndmask_b32 v13, v15, v13, vcc
    s_lshl_b32 s18, s17, 6
    v_lshl_add_u32 v5, v3, 3, s18
    v_mul_u32_u24 v5, 9216, v5
    v_and_b32 v6, 7, v2
    v_lshl_add_u32 v5, v6, 3, v5
    s_lshl_b32 s18, s2, 6
    v_add_u32 v5, s18, v5
    v_add_co_u32 v12, vcc, v12, v5
    s_nop 1
    v_addc_co_u32 v13, vcc, 0, v13, vcc
    global_load_dwordx2 v[32:33], v[12:13], off
    v_add_co_u32 v12, vcc, 9216, v12
    s_nop 1
    v_addc_co_u32 v13, vcc, 0, v13, vcc
    global_load_dwordx2 v[34:35], v[12:13], off
    v_add_co_u32 v12, vcc, 9216, v12
    s_nop 1
    v_addc_co_u32 v13, vcc, 0, v13, vcc
    global_load_dwordx2 v[36:37], v[12:13], off
    v_add_co_u32 v12, vcc, 9216, v12
    s_nop 1
    v_addc_co_u32 v13, vcc, 0, v13, vcc
    global_load_dwordx2 v[38:39], v[12:13], off
    v_add_co_u32 v12, vcc, 9216, v12
    s_nop 1
    v_addc_co_u32 v13, vcc, 0, v13, vcc
    global_load_dwordx2 v[40:41], v[12:13], off
    v_add_co_u32 v12, vcc, 9216, v12
    s_nop 1
    v_addc_co_u32 v13, vcc, 0, v13, vcc
    global_load_dwordx2 v[42:43], v[12:13], off
    v_add_co_u32 v12, vcc, 9216, v12
    s_nop 1
    v_addc_co_u32 v13, vcc, 0, v13, vcc
    global_load_dwordx2 v[44:45], v[12:13], off
    v_add_co_u32 v12, vcc, 9216, v12
    s_nop 1
    v_addc_co_u32 v13, vcc, 0, v13, vcc
    global_load_dwordx2 v[46:47], v[12:13], off
    v_add_co_u32 v12, vcc, 230400, v12
    s_nop 1
    v_addc_co_u32 v13, vcc, 0, v13, vcc
    global_load_dwordx2 v[48:49], v[12:13], off
    v_add_co_u32 v12, vcc, 9216, v12
    s_nop 1
    v_addc_co_u32 v13, vcc, 0, v13, vcc
    global_load_dwordx2 v[50:51], v[12:13], off
    v_add_co_u32 v12, vcc, 9216, v12
    s_nop 1
    v_addc_co_u32 v13, vcc, 0, v13, vcc
    global_load_dwordx2 v[52:53], v[12:13], off
    v_add_co_u32 v12, vcc, 9216, v12
    s_nop 1
    v_addc_co_u32 v13, vcc, 0, v13, vcc
    global_load_dwordx2 v[54:55], v[12:13], off
    v_add_co_u32 v12, vcc, 9216, v12
    s_nop 1
    v_addc_co_u32 v13, vcc, 0, v13, vcc
    global_load_dwordx2 v[56:57], v[12:13], off
    v_add_co_u32 v12, vcc, 9216, v12
    s_nop 1
    v_addc_co_u32 v13, vcc, 0, v13, vcc
    global_load_dwordx2 v[58:59], v[12:13], off
    v_add_co_u32 v12, vcc, 9216, v12
    s_nop 1
    v_addc_co_u32 v13, vcc, 0, v13, vcc
    global_load_dwordx2 v[60:61], v[12:13], off
    v_add_co_u32 v12, vcc, 9216, v12
    s_nop 1
    v_addc_co_u32 v13, vcc, 0, v13, vcc
    global_load_dwordx2 v[62:63], v[12:13], off
    s_mov_b32 s8, s32
    s_mov_b32 s9, s33
    s_mov_b32 s10, 0x510000
    s_mov_b32 s11, 0x20000
    v_mul_u32_u24 v5, 9216, v3
    v_lshl_add_u32 v5, v2, 3, v5
    s_mul_i32 s18, s2, 36864
    s_lshl_b32 s19, s17, 7
    s_add_u32 s18, s18, s19
    buffer_load_dwordx2 v[64:65], v5, s[8:11], s18 offen offset:0
    buffer_load_dwordx2 v[66:67], v5, s[8:11], s18 offen offset:1152
    buffer_load_dwordx2 v[68:69], v5, s[8:11], s18 offen offset:2304
    buffer_load_dwordx2 v[70:71], v5, s[8:11], s18 offen offset:3456
    s_add_u32 s18, s18, 4608
    buffer_load_dwordx2 v[72:73], v5, s[8:11], s18 offen offset:0
    buffer_load_dwordx2 v[74:75], v5, s[8:11], s18 offen offset:1152
    buffer_load_dwordx2 v[76:77], v5, s[8:11], s18 offen offset:2304
    buffer_load_dwordx2 v[78:79], v5, s[8:11], s18 offen offset:3456
    s_add_u32 s12, s34, 0x900000
    s_addc_u32 s13, s35, 0
    s_mov_b32 s14, 0x240000
    s_mov_b32 s15, 0x20000
    s_add_u32 s20, s34, 0xd00000
    s_addc_u32 s21, s35, 0
    s_mov_b32 s22, 0x288000
    s_mov_b32 s23, 0x20000
    s_add_u32 s24, s34, 0xc20000
    s_addc_u32 s25, s35, 0
    s_mov_b32 s26, 0x20
    s_mov_b32 s27, 0x20000
    s_waitcnt vmcnt(24)
    v_max_u32 v16, v8, v9
    v_min_u32 v9, v8, v9
    v_mov_b32 v8, v16
    v_max_u32 v16, v10, v11
    v_min_u32 v11, v10, v11
    v_mov_b32 v10, v16
    v_max_u32 v16, v8, v10
    v_min_u32 v10, v8, v10
    v_mov_b32 v8, v16
    v_max_u32 v16, v9, v11
    v_min_u32 v11, v9, v11
    v_mov_b32 v9, v16
    v_max_u32 v16, v9, v10
    v_min_u32 v10, v9, v10
    v_mov_b32 v9, v16
    v_mov_b32 v17, 0
    v_mov_b32 v16, v8
    s_nop 1
    v_max_u32_dpp v16, v16, v16 row_shr:1 row_mask:0xf bank_mask:0xf
    s_nop 1
    v_max_u32_dpp v16, v16, v16 row_shr:2 row_mask:0xf bank_mask:0xf
    s_nop 1
    v_max_u32_dpp v16, v16, v16 row_shr:4 row_mask:0xf bank_mask:0xf
    s_nop 1
    v_max_u32_dpp v16, v16, v16 row_shr:8 row_mask:0xf bank_mask:0xf
    s_nop 1
    v_max_u32_dpp v16, v16, v16 row_bcast:15 row_mask:0xa bank_mask:0xf
    s_nop 1
    v_max_u32_dpp v16, v16, v16 row_bcast:31 row_mask:0xc bank_mask:0xf
    s_nop 0
    v_readlane_b32 s28, v16, 63
    s_nop 3
    v_writelane_b32 v17, s28, 0
    v_cmp_eq_u32 vcc, s28, v8
    s_nop 1
    v_cndmask_b32 v8, v8, v9, vcc
    v_cndmask_b32 v9, v9, v10, vcc
    v_cndmask_b32 v10, v10, v11, vcc
    v_cndmask_b32 v11, v11, 0, vcc
    v_mov_b32 v16, v8
    s_nop 1
    v_max_u32_dpp v16, v16, v16 row_shr:1 row_mask:0xf bank_mask:0xf
    s_nop 1
    v_max_u32_dpp v16, v16, v16 row_shr:2 row_mask:0xf bank_mask:0xf
    s_nop 1
    v_max_u32_dpp v16, v16, v16 row_shr:4 row_mask:0xf bank_mask:0xf
    s_nop 1
    v_max_u32_dpp v16, v16, v16 row_shr:8 row_mask:0xf bank_mask:0xf
    s_nop 1
    v_max_u32_dpp v16, v16, v16 row_bcast:15 row_mask:0xa bank_mask:0xf
    s_nop 1
    v_max_u32_dpp v16, v16, v16 row_bcast:31 row_mask:0xc bank_mask:0xf
    s_nop 0
    v_readlane_b32 s28, v16, 63
    s_nop 3
    v_writelane_b32 v17, s28, 1
    v_cmp_eq_u32 vcc, s28, v8
    s_nop 1
    v_cndmask_b32 v8, v8, v9, vcc
    v_cndmask_b32 v9, v9, v10, vcc
    v_cndmask_b32 v10, v10, v11, vcc
    v_cndmask_b32 v11, v11, 0, vcc
    v_mov_b32 v16, v8
    s_nop 1
    v_max_u32_dpp v16, v16, v16 row_shr:1 row_mask:0xf bank_mask:0xf
    s_nop 1
    v_max_u32_dpp v16, v16, v16 row_shr:2 row_mask:0xf bank_mask:0xf
    s_nop 1
    v_max_u32_dpp v16, v16, v16 row_shr:4 row_mask:0xf bank_mask:0xf
    s_nop 1
    v_max_u32_dpp v16, v16, v16 row_shr:8 row_mask:0xf bank_mask:0xf
    s_nop 1
    v_max_u32_dpp v16, v16, v16 row_bcast:15 row_mask:0xa bank_mask:0xf
    s_nop 1
    v_max_u32_dpp v16, v16, v16 row_bcast:31 row_mask:0xc bank_mask:0xf
    s_nop 0
    v_readlane_b32 s28, v16, 63
    s_nop 3
    v_writelane_b32 v17, s28, 2
    v_cmp_eq_u32 vcc, s28, v8
    s_nop 1
    v_cndmask_b32 v8, v8, v9, vcc
    v_cndmask_b32 v9, v9, v10, vcc
    v_cndmask_b32 v10, v10, v11, vcc
    v_cndmask_b32 v11, v11, 0, vcc
    v_mov_b32 v16, v8
    s_nop 1
    v_max_u32_dpp v16, v16, v16 row_shr:1 row_mask:0xf bank_mask:0xf
    s_nop 1
    v_max_u32_dpp v16, v16, v16 row_shr:2 row_mask:0xf bank_mask:0xf
    s_nop 1
    v_max_u32_dpp v16, v16, v16 row_shr:4 row_mask:0xf bank_mask:0xf
    s_nop 1
    v_max_u32_dpp v16, v16, v16 row_shr:8 row_mask:0xf bank_mask:0xf
    s_nop 1
    v_max_u32_dpp v16, v16, v16 row_bcast:15 row_mask:0xa bank_mask:0xf
    s_nop 1
    v_max_u32_dpp v16, v16, v16 row_bcast:31 row_mask:0xc bank_mask:0xf
    s_nop 0
    v_readlane_b32 s28, v16, 63
    s_nop 3
    v_writelane_b32 v17, s28, 3
    v_cmp_eq_u32 vcc, s28, v8
    s_nop 1
    v_cndmask_b32 v8, v8, v9, vcc
    v_cndmask_b32 v9, v9, v10, vcc
    v_cndmask_b32 v10, v10, v11, vcc
    v_cndmask_b32 v11, v11, 0, vcc
    v_mov_b32 v16, v8
    s_nop 1
    v_max_u32_dpp v16, v16, v16 row_shr:1 row_mask:0xf bank_mask:0xf
    s_nop 1
    v_max_u32_dpp v16, v16, v16 row_shr:2 row_mask:0xf bank_mask:0xf
    s_nop 1
    v_max_u32_dpp v16, v16, v16 row_shr:4 row_mask:0xf bank_mask:0xf
    s_nop 1
    v_max_u32_dpp v16, v16, v16 row_shr:8 row_mask:0xf bank_mask:0xf
    s_nop 1
    v_max_u32_dpp v16, v16, v16 row_bcast:15 row_mask:0xa bank_mask:0xf
    s_nop 1
    v_max_u32_dpp v16, v16, v16 row_bcast:31 row_mask:0xc bank_mask:0xf
    s_nop 0
    v_readlane_b32 s28, v16, 63
    s_nop 3
    v_writelane_b32 v17, s28, 4
    v_cmp_eq_u32 vcc, s28, v8
    s_nop 1
    v_cndmask_b32 v8, v8, v9, vcc
    v_cndmask_b32 v9, v9, v10, vcc
    v_cndmask_b32 v10, v10, v11, vcc
    v_cndmask_b32 v11, v11, 0, vcc
    v_mov_b32 v16, v8
    s_nop 1
    v_max_u32_dpp v16, v16, v16 row_shr:1 row_mask:0xf bank_mask:0xf
    s_nop 1
    v_max_u32_dpp v16, v16, v16 row_shr:2 row_mask:0xf bank_mask:0xf
    s_nop 1
    v_max_u32_dpp v16, v16, v16 row_shr:4 row_mask:0xf bank_mask:0xf
    s_nop 1
    v_max_u32_dpp v16, v16, v16 row_shr:8 row_mask:0xf bank_mask:0xf
    s_nop 1
    v_max_u32_dpp v16, v16, v16 row_bcast:15 row_mask:0xa bank_mask:0xf
    s_nop 1
    v_max_u32_dpp v16, v16, v16 row_bcast:31 row_mask:0xc bank_mask:0xf
    s_nop 0
    v_readlane_b32 s28, v16, 63
    s_nop 3
    v_writelane_b32 v17, s28, 5
    v_cmp_eq_u32 vcc, s28, v8
    s_nop 1
    v_cndmask_b32 v8, v8, v9, vcc
    v_cndmask_b32 v9, v9, v10, vcc
    v_cndmask_b32 v10, v10, v11, vcc
    v_cndmask_b32 v11, v11, 0, vcc
    v_mov_b32 v16, v8
    s_nop 1
    v_max_u32_dpp v16, v16, v16 row_shr:1 row_mask:0xf bank_mask:0xf
    s_nop 1
    v_max_u32_dpp v16, v16, v16 row_shr:2 row_mask:0xf bank_mask:0xf
    s_nop 1
    v_max_u32_dpp v16, v16, v16 row_shr:4 row_mask:0xf bank_mask:0xf
    s_nop 1
    v_max_u32_dpp v16, v16, v16 row_shr:8 row_mask:0xf bank_mask:0xf
    s_nop 1
    v_max_u32_dpp v16, v16, v16 row_bcast:15 row_mask:0xa bank_mask:0xf
    s_nop 1
    v_max_u32_dpp v16, v16, v16 row_bcast:31 row_mask:0xc bank_mask:0xf
    s_nop 0
    v_readlane_b32 s28, v16, 63
    s_nop 3
    v_writelane_b32 v17, s28, 6
    v_cmp_eq_u32 vcc, s28, v8
    s_nop 1
    v_cndmask_b32 v8, v8, v9, vcc
    v_cndmask_b32 v9, v9, v10, vcc
    v_cndmask_b32 v10, v10, v11, vcc
    v_cndmask_b32 v11, v11, 0, vcc
    v_mov_b32 v16, v8
    s_nop 1
    v_max_u32_dpp v16, v16, v16 row_shr:1 row_mask:0xf bank_mask:0xf
    s_nop 1
    v_max_u32_dpp v16, v16, v16 row_shr:2 row_mask:0xf bank_mask:0xf
    s_nop 1
    v_max_u32_dpp v16, v16, v16 row_shr:4 row_mask:0xf bank_mask:0xf
    s_nop 1
    v_max_u32_dpp v16, v16, v16 row_shr:8 row_mask:0xf bank_mask:0xf
    s_nop 1
    v_max_u32_dpp v16, v16, v16 row_bcast:15 row_mask:0xa bank_mask:0xf
    s_nop 1
    v_max_u32_dpp v16, v16, v16 row_bcast:31 row_mask:0xc bank_mask:0xf
    s_nop 0
    v_readlane_b32 s28, v16, 63
    s_nop 3
    v_writelane_b32 v17, s28, 7
    v_cmp_eq_u32 vcc, s28, v8
    s_nop 1
    v_cndmask_b32 v8, v8, v9, vcc
    v_cndmask_b32 v9, v9, v10, vcc
    v_cndmask_b32 v10, v10, v11, vcc
    v_cndmask_b32 v11, v11, 0, vcc
    s_lshl_b32 s18, s17, 5
    v_lshl_add_u32 v16, v1, 2, s18
    s_cmp_lt_u32 s17, 8
    s_cselect_b64 s[28:29], 0xff, 0
    s_mov_b64 exec, s[28:29]
    ds_write_b32 v16, v17 offset:0
    s_mov_b64 exec, -1
    s_waitcnt lgkmcnt(0)
    s_barrier
    v_lshlrev_b32 v16, 2, v1
    ds_read_b32 v8, v16 offset:0
    s_waitcnt lgkmcnt(0)
    v_mov_b32 v17, 0
    v_mov_b32 v16, v8
    s_nop 1
    v_max_u32_dpp v16, v16, v16 row_shr:1 row_mask:0xf bank_mask:0xf
    s_nop 1
    v_max_u32_dpp v16, v16, v16 row_shr:2 row_mask:0xf bank_mask:0xf
    s_nop 1
    v_max_u32_dpp v16, v16, v16 row_shr:4 row_mask:0xf bank_mask:0xf
    s_nop 1
    v_max_u32_dpp v16, v16, v16 row_shr:8 row_mask:0xf bank_mask:0xf
    s_nop 1
    v_max_u32_dpp v16, v16, v16 row_bcast:15 row_mask:0xa bank_mask:0xf
    s_nop 1
    v_max_u32_dpp v16, v16, v16 row_bcast:31 row_mask:0xc bank_mask:0xf
    s_nop 0
    v_readlane_b32 s28, v16, 63
    s_nop 3
    v_writelane_b32 v17, s28, 0
    v_writelane_b32 v17, s28, 8
    v_cmp_eq_u32 vcc, s28, v8
    s_nop 1
    v_cndmask_b32 v8, v8, 0, vcc
    v_mov_b32 v16, v8
    s_nop 1
    v_max_u32_dpp v16, v16, v16 row_shr:1 row_mask:0xf bank_mask:0xf
    s_nop 1
    v_max_u32_dpp v16, v16, v16 row_shr:2 row_mask:0xf bank_mask:0xf
    s_nop 1
    v_max_u32_dpp v16, v16, v16 row_shr:4 row_mask:0xf bank_mask:0xf
    s_nop 1
    v_max_u32_dpp v16, v16, v16 row_shr:8 row_mask:0xf bank_mask:0xf
    s_nop 1
    v_max_u32_dpp v16, v16, v16 row_bcast:15 row_mask:0xa bank_mask:0xf
    s_nop 1
    v_max_u32_dpp v16, v16, v16 row_bcast:31 row_mask:0xc bank_mask:0xf
    s_nop 0
    v_readlane_b32 s28, v16, 63
    s_nop 3
    v_writelane_b32 v17, s28, 1
    v_writelane_b32 v17, s28, 9
    v_cmp_eq_u32 vcc, s28, v8
    s_nop 1
    v_cndmask_b32 v8, v8, 0, vcc
    v_mov_b32 v16, v8
    s_nop 1
    v_max_u32_dpp v16, v16, v16 row_shr:1 row_mask:0xf bank_mask:0xf
    s_nop 1
    v_max_u32_dpp v16, v16, v16 row_shr:2 row_mask:0xf bank_mask:0xf
    s_nop 1
    v_max_u32_dpp v16, v16, v16 row_shr:4 row_mask:0xf bank_mask:0xf
    s_nop 1
    v_max_u32_dpp v16, v16, v16 row_shr:8 row_mask:0xf bank_mask:0xf
    s_nop 1
    v_max_u32_dpp v16, v16, v16 row_bcast:15 row_mask:0xa bank_mask:0xf
    s_nop 1
    v_max_u32_dpp v16, v16, v16 row_bcast:31 row_mask:0xc bank_mask:0xf
    s_nop 0
    v_readlane_b32 s28, v16, 63
    s_nop 3
    v_writelane_b32 v17, s28, 2
    v_writelane_b32 v17, s28, 10
    v_cmp_eq_u32 vcc, s28, v8
    s_nop 1
    v_cndmask_b32 v8, v8, 0, vcc
    v_mov_b32 v16, v8
    s_nop 1
    v_max_u32_dpp v16, v16, v16 row_shr:1 row_mask:0xf bank_mask:0xf
    s_nop 1
    v_max_u32_dpp v16, v16, v16 row_shr:2 row_mask:0xf bank_mask:0xf
    s_nop 1
    v_max_u32_dpp v16, v16, v16 row_shr:4 row_mask:0xf bank_mask:0xf
    s_nop 1
    v_max_u32_dpp v16, v16, v16 row_shr:8 row_mask:0xf bank_mask:0xf
    s_nop 1
    v_max_u32_dpp v16, v16, v16 row_bcast:15 row_mask:0xa bank_mask:0xf
    s_nop 1
    v_max_u32_dpp v16, v16, v16 row_bcast:31 row_mask:0xc bank_mask:0xf
    s_nop 0
    v_readlane_b32 s28, v16, 63
    s_nop 3
    v_writelane_b32 v17, s28, 3
    v_writelane_b32 v17, s28, 11
    v_cmp_eq_u32 vcc, s28, v8
    s_nop 1
    v_cndmask_b32 v8, v8, 0, vcc
    v_mov_b32 v16, v8
    s_nop 1
    v_max_u32_dpp v16, v16, v16 row_shr:1 row_mask:0xf bank_mask:0xf
    s_nop 1
    v_max_u32_dpp v16, v16, v16 row_shr:2 row_mask:0xf bank_mask:0xf
    s_nop 1
    v_max_u32_dpp v16, v16, v16 row_shr:4 row_mask:0xf bank_mask:0xf
    s_nop 1
    v_max_u32_dpp v16, v16, v16 row_shr:8 row_mask:0xf bank_mask:0xf
    s_nop 1
    v_max_u32_dpp v16, v16, v16 row_bcast:15 row_mask:0xa bank_mask:0xf
    s_nop 1
    v_max_u32_dpp v16, v16, v16 row_bcast:31 row_mask:0xc bank_mask:0xf
    s_nop 0
    v_readlane_b32 s28, v16, 63
    s_nop 3
    v_writelane_b32 v17, s28, 4
    v_writelane_b32 v17, s28, 12
    v_cmp_eq_u32 vcc, s28, v8
    s_nop 1
    v_cndmask_b32 v8, v8, 0, vcc
    v_mov_b32 v16, v8
    s_nop 1
    v_max_u32_dpp v16, v16, v16 row_shr:1 row_mask:0xf bank_mask:0xf
    s_nop 1
    v_max_u32_dpp v16, v16, v16 row_shr:2 row_mask:0xf bank_mask:0xf
    s_nop 1
    v_max_u32_dpp v16, v16, v16 row_shr:4 row_mask:0xf bank_mask:0xf
    s_nop 1
    v_max_u32_dpp v16, v16, v16 row_shr:8 row_mask:0xf bank_mask:0xf
    s_nop 1
    v_max_u32_dpp v16, v16, v16 row_bcast:15 row_mask:0xa bank_mask:0xf
    s_nop 1
    v_max_u32_dpp v16, v16, v16 row_bcast:31 row_mask:0xc bank_mask:0xf
    s_nop 0
    v_readlane_b32 s28, v16, 63
    s_nop 3
    v_writelane_b32 v17, s28, 5
    v_writelane_b32 v17, s28, 13
    v_cmp_eq_u32 vcc, s28, v8
    s_nop 1
    v_cndmask_b32 v8, v8, 0, vcc
    v_mov_b32 v16, v8
    s_nop 1
    v_max_u32_dpp v16, v16, v16 row_shr:1 row_mask:0xf bank_mask:0xf
    s_nop 1
    v_max_u32_dpp v16, v16, v16 row_shr:2 row_mask:0xf bank_mask:0xf
    s_nop 1
    v_max_u32_dpp v16, v16, v16 row_shr:4 row_mask:0xf bank_mask:0xf
    s_nop 1
    v_max_u32_dpp v16, v16, v16 row_shr:8 row_mask:0xf bank_mask:0xf
    s_nop 1
    v_max_u32_dpp v16, v16, v16 row_bcast:15 row_mask:0xa bank_mask:0xf
    s_nop 1
    v_max_u32_dpp v16, v16, v16 row_bcast:31 row_mask:0xc bank_mask:0xf
    s_nop 0
    v_readlane_b32 s28, v16, 63
    s_nop 3
    v_writelane_b32 v17, s28, 6
    v_writelane_b32 v17, s28, 14
    v_cmp_eq_u32 vcc, s28, v8
    s_nop 1
    v_cndmask_b32 v8, v8, 0, vcc
    v_mov_b32 v16, v8
    s_nop 1
    v_max_u32_dpp v16, v16, v16 row_shr:1 row_mask:0xf bank_mask:0xf
    s_nop 1
    v_max_u32_dpp v16, v16, v16 row_shr:2 row_mask:0xf bank_mask:0xf
    s_nop 1
    v_max_u32_dpp v16, v16, v16 row_shr:4 row_mask:0xf bank_mask:0xf
    s_nop 1
    v_max_u32_dpp v16, v16, v16 row_shr:8 row_mask:0xf bank_mask:0xf
    s_nop 1
    v_max_u32_dpp v16, v16, v16 row_bcast:15 row_mask:0xa bank_mask:0xf
    s_nop 1
    v_max_u32_dpp v16, v16, v16 row_bcast:31 row_mask:0xc bank_mask:0xf
    s_nop 0
    v_readlane_b32 s28, v16, 63
    s_nop 3
    v_writelane_b32 v17, s28, 7
    v_writelane_b32 v17, s28, 15
    v_cmp_eq_u32 vcc, s28, v8
    s_nop 1
    v_cndmask_b32 v8, v8, 0, vcc
    v_lshlrev_b32 v16, 2, v2
    ds_bpermute_b32 v18, v16, v17
    s_or_b32 s18, s2, s17
    s_cmp_eq_u32 s18, 0
    s_cbranch_scc0 K4_NOIDX
    v_lshlrev_b32 v16, 2, v1
    buffer_store_dword v17, v16, s[24:27], 0 offen
K4_NOIDX:
    s_waitcnt lgkmcnt(0)
    v_and_b32 v18, 0x7ff, v18
    v_sub_u32 v18, 2047, v18
    v_mul_u32_u24 v18, 1152, v18
    v_lshl_add_u32 v18, v3, 4, v18
    s_lshl_b32 s18, s17, 7
    buffer_load_dwordx4 v[20:23], v18, s[12:15], s18 offen
    buffer_load_dwordx4 v[24:27], v18, s[12:15], s18 offen offset:64
    s_mov_b32 s28, 0x05040100
    s_mov_b32 s29, 0x07060302
    s_waitcnt vmcnt(18)
    v_perm_b32 v80, v34, v32, s28
    v_perm_b32 v81, v38, v36, s28
    v_perm_b32 v82, v42, v40, s28
    v_perm_b32 v83, v46, v44, s28
    v_perm_b32 v84, v34, v32, s29
    v_perm_b32 v85, v38, v36, s29
    v_perm_b32 v86, v42, v40, s29
    v_perm_b32 v87, v46, v44, s29
    v_perm_b32 v88, v35, v33, s28
    v_perm_b32 v89, v39, v37, s28
    v_perm_b32 v90, v43, v41, s28
    v_perm_b32 v91, v47, v45, s28
    v_perm_b32 v92, v35, v33, s29
    v_perm_b32 v93, v39, v37, s29
    v_perm_b32 v94, v43, v41, s29
    v_perm_b32 v95, v47, v45, s29
    s_waitcnt vmcnt(10)
    v_perm_b32 v96, v50, v48, s28
    v_perm_b32 v97, v54, v52, s28
    v_perm_b32 v98, v58, v56, s28
    v_perm_b32 v99, v62, v60, s28
    v_perm_b32 v100, v50, v48, s29
    v_perm_b32 v101, v54, v52, s29
    v_perm_b32 v102, v58, v56, s29
    v_perm_b32 v103, v62, v60, s29
    v_perm_b32 v104, v51, v49, s28
    v_perm_b32 v105, v55, v53, s28
    v_perm_b32 v106, v59, v57, s28
    v_perm_b32 v107, v63, v61, s28
    v_perm_b32 v108, v51, v49, s29
    v_perm_b32 v109, v55, v53, s29
    v_perm_b32 v110, v59, v57, s29
    v_perm_b32 v111, v63, v61, s29
    s_waitcnt vmcnt(2)
    v_perm_b32 v112, v66, v64, s28
    v_perm_b32 v113, v70, v68, s28
    v_perm_b32 v114, v74, v72, s28
    v_perm_b32 v115, v78, v76, s28
    v_perm_b32 v116, v66, v64, s29
    v_perm_b32 v117, v70, v68, s29
    v_perm_b32 v118, v74, v72, s29
    v_perm_b32 v119, v78, v76, s29
    v_perm_b32 v120, v67, v65, s28
    v_perm_b32 v121, v71, v69, s28
    v_perm_b32 v122, v75, v73, s28
    v_perm_b32 v123, v79, v77, s28
    v_perm_b32 v124, v67, v65, s29
    v_perm_b32 v125, v71, v69, s29
    v_perm_b32 v126, v75, v73, s29
    v_perm_b32 v127, v79, v77, s29
    v_mov_b32 v32, 0
    v_mov_b32 v33, 0
    v_mov_b32 v34, 0
    v_mov_b32 v35, 0
    v_mov_b32 v36, 0
    v_mov_b32 v37, 0
    v_mov_b32 v38, 0
    v_mov_b32 v39, 0
    v_mov_b32 v40, 0
    v_mov_b32 v41, 0
    v_mov_b32 v42, 0
    v_mov_b32 v43, 0
    v_mov_b32 v44, 0
    v_mov_b32 v45, 0
    v_mov_b32 v46, 0
    v_mov_b32 v47, 0
    s_waitcnt vmcnt(0)
    v_mfma_f32_16x16x32_bf16 v[32:35], v[20:23], v[80:83], v[32:35]
    v_mfma_f32_16x16x32_bf16 v[36:39], v[20:23], v[84:87], v[36:39]
    v_mfma_f32_16x16x32_bf16 v[40:43], v[20:23], v[88:91], v[40:43]
    v_mfma_f32_16x16x32_bf16 v[44:47], v[20:23], v[92:95], v[44:47]
    v_mfma_f32_16x16x32_bf16 v[32:35], v[24:27], v[96:99], v[32:35]
    v_mfma_f32_16x16x32_bf16 v[36:39], v[24:27], v[100:103], v[36:39]
    v_mfma_f32_16x16x32_bf16 v[40:43], v[24:27], v[104:107], v[40:43]
    v_mfma_f32_16x16x32_bf16 v[44:47], v[24:27], v[108:111], v[44:47]
    s_lshl_b32 s18, s17, 11
    v_lshl_add_u32 v16, v1, 4, s18
    s_mov_b32 exec_lo, -1
    s_mov_b32 exec_hi, 0
    s_nop 0
    ds_write_b128 v16, v[32:35] offset:512
    ds_write_b128 v16, v[36:39] offset:1024
    ds_write_b128 v16, v[40:43] offset:1536
    ds_write_b128 v16, v[44:47] offset:2048
    s_mov_b64 exec, -1
    s_waitcnt lgkmcnt(0)
    s_barrier
    s_cmp_ge_u32 s17, 4
    s_cbranch_scc1 K4_NOACT
    v_lshrrev_b32 v8, 5, v0
    v_and_b32 v9, 31, v0
    v_and_b32 v10, 3, v9
    v_lshlrev_b32 v10, 9, v10
    v_lshrrev_b32 v11, 2, v9
    v_lshl_add_u32 v10, v11, 4, v10
    v_lshrrev_b32 v11, 2, v8
    v_lshl_add_u32 v10, v11, 8, v10
    v_and_b32 v11, 3, v8
    v_lshl_add_u32 v10, v11, 2, v10
    ds_read_b32 v32, v10 offset:512
    ds_read_b32 v33, v10 offset:640
    ds_read_b32 v34, v10 offset:2560
    ds_read_b32 v35, v10 offset:2688
    ds_read_b32 v36, v10 offset:4608
    ds_read_b32 v37, v10 offset:4736
    ds_read_b32 v38, v10 offset:6656
    ds_read_b32 v39, v10 offset:6784
    ds_read_b32 v40, v10 offset:8704
    ds_read_b32 v41, v10 offset:8832
    ds_read_b32 v42, v10 offset:10752
    ds_read_b32 v43, v10 offset:10880
    s_waitcnt lgkmcnt(4)
    ds_read_b32 v44, v10 offset:12800
    ds_read_b32 v45, v10 offset:12928
    ds_read_b32 v46, v10 offset:14848
    ds_read_b32 v47, v10 offset:14976
    ds_read_b32 v48, v10 offset:16896
    ds_read_b32 v49, v10 offset:17024
    s_waitcnt lgkmcnt(0)
    v_pk_add_f32 v[32:33], v[32:33], v[34:35]
    v_pk_add_f32 v[32:33], v[32:33], v[36:37]
    v_pk_add_f32 v[32:33], v[32:33], v[38:39]
    v_pk_add_f32 v[32:33], v[32:33], v[40:41]
    v_pk_add_f32 v[32:33], v[32:33], v[42:43]
    v_pk_add_f32 v[32:33], v[32:33], v[44:45]
    v_pk_add_f32 v[32:33], v[32:33], v[46:47]
    v_pk_add_f32 v[32:33], v[32:33], v[48:49]
    v_cvt_pk_bf16_f32 v34, v32, v33
    v_lshlrev_b32 v32, 16, v34
    v_and_b32 v33, 0xffff0000, v34
    v_mul_f32 v34, 0xbfb8aa3b, v32
    v_exp_f32 v34, v34
    s_nop 0
    v_add_f32 v34, 1.0, v34
    v_rcp_f32 v34, v34
    s_nop 0
    v_mul_f32 v34, v32, v34
    v_cvt_pk_bf16_f32 v34, v34, v34
    v_lshlrev_b32 v34, 16, v34
    v_mul_f32 v34, v34, v33
    v_cvt_pk_bf16_f32 v34, v34, v34
    v_lshlrev_b32 v10, 1, v0
    ds_write_b16 v10, v34 offset:18944
K4_NOACT:
    s_nop 3
    s_waitcnt lgkmcnt(0)
    s_barrier
    v_and_b32 v16, 7, v2
    v_lshlrev_b32 v16, 6, v16
    v_lshl_add_u32 v16, v3, 4, v16
    ds_read_b128 v[20:23], v16 offset:18944
    s_waitcnt lgkmcnt(0)
    v_mfma_f32_16x16x32_bf16 v[32:35], v[20:23], v[112:115], 0
    v_mfma_f32_16x16x32_bf16 v[36:39], v[20:23], v[116:119], 0
    v_mfma_f32_16x16x32_bf16 v[40:43], v[20:23], v[120:123], 0
    v_mfma_f32_16x16x32_bf16 v[44:47], v[20:23], v[124:127], 0
    s_mul_i32 s18, s2, 18432
    s_lshl_b32 s19, s17, 11
    s_add_u32 s18, s18, s19
    v_lshlrev_b32 v16, 4, v1
    s_mov_b32 exec_lo, -1
    s_mov_b32 exec_hi, 0
    buffer_store_dwordx4 v[32:35], v16, s[20:23], s18 offen offset:0
    buffer_store_dwordx4 v[36:39], v16, s[20:23], s18 offen offset:512
    buffer_store_dwordx4 v[40:43], v16, s[20:23], s18 offen offset:1024
    buffer_store_dwordx4 v[44:47], v16, s[20:23], s18 offen offset:1536
K4_END:
    s_endpgm
.globl k5_kernel
.p2align 8
.type k5_kernel,@function
k5_kernel:
    s_cmp_ge_u32 s2, 72
    s_cbranch_scc1 K5_END
    s_load_dwordx2 s[4:5], s[0:1], 0
    s_load_dwordx2 s[6:7], s[0:1], 128
    s_load_dwordx2 s[34:35], s[0:1], 112
    v_and_b32 v1, 15, v0
    v_lshrrev_b32 v2, 4, v0
    v_mul_u32_u24 v3, 165888, v2
    v_lshl_add_u32 v3, v1, 4, v3
    s_lshl_b32 s3, s2, 8
    s_waitcnt lgkmcnt(0)
    s_add_u32 s8, s6, 0xd00000
    s_addc_u32 s9, s7, 0
    s_mov_b32 s10, 0x288000
    s_mov_b32 s11, 0x20000
    buffer_load_dwordx4 v[8:11], v3, s[8:11], s3 offen
    s_add_u32 s3, s3, 18432
    buffer_load_dwordx4 v[12:15], v3, s[8:11], s3 offen
    s_add_u32 s3, s3, 18432
    buffer_load_dwordx4 v[16:19], v3, s[8:11], s3 offen
    s_add_u32 s3, s3, 18432
    buffer_load_dwordx4 v[20:23], v3, s[8:11], s3 offen
    s_add_u32 s3, s3, 18432
    buffer_load_dwordx4 v[24:27], v3, s[8:11], s3 offen
    s_add_u32 s3, s3, 18432
    buffer_load_dwordx4 v[28:31], v3, s[8:11], s3 offen
    s_add_u32 s3, s3, 18432
    buffer_load_dwordx4 v[32:35], v3, s[8:11], s3 offen
    s_add_u32 s3, s3, 18432
    buffer_load_dwordx4 v[36:39], v3, s[8:11], s3 offen
    s_add_u32 s3, s3, 18432
    buffer_load_dwordx4 v[40:43], v3, s[8:11], s3 offen
    s_add_u32 s12, s6, 0xc20000
    s_addc_u32 s13, s7, 0
    s_mov_b32 s14, 0x20
    s_mov_b32 s15, 0x20000
    s_add_u32 s16, s6, 0x900000
    s_addc_u32 s17, s7, 0
    s_mov_b32 s18, 0x240000
    s_mov_b32 s19, 0x20000
    s_add_u32 s20, s6, 0x600000
    s_addc_u32 s21, s7, 0
    s_mov_b32 s22, 0x240000
    s_mov_b32 s23, 0x20000
    s_mov_b32 s24, s4
    s_mov_b32 s25, s5
    s_mov_b32 s26, 0x240000
    s_mov_b32 s27, 0x20000
    s_mov_b32 s28, s34
    s_mov_b32 s29, s35
    s_mov_b32 s30, 0x240000
    s_mov_b32 s31, 0x20000
    v_lshrrev_b32 v4, 2, v0
    s_lshl_b32 s3, s2, 4
    v_add_u32 v4, s3, v4
    v_and_b32 v5, 3, v0
    v_bfe_u32 v6, v4, 4, 1
    v_lshl_add_u32 v5, v6, 2, v5
    v_lshrrev_b32 v6, 7, v4
    v_lshlrev_b32 v6, 6, v6
    v_and_b32 v7, 15, v4
    v_lshl_add_u32 v6, v7, 2, v6
    v_bfe_u32 v7, v4, 5, 2
    v_add_u32 v6, v6, v7
    v_lshlrev_b32 v5, 2, v5
    buffer_load_dword v44, v5, s[12:15], 0 offen
    s_waitcnt vmcnt(0)
    v_and_b32 v45, 0x7ff, v44
    v_sub_u32 v45, 2047, v45
    v_mul_u32_u24 v46, 1152, v45
    v_lshl_add_u32 v46, v6, 1, v46
    v_lshlrev_b32 v47, 12, v6
    v_lshl_add_u32 v47, v45, 1, v47
    buffer_load_ushort v48, v46, s[16:19], 0 offen
    buffer_load_ushort v49, v47, s[20:23], 0 offen
    buffer_load_ushort v50, v46, s[24:27], 0 offen
    v_pk_add_f32 v[8:9], v[8:9], v[12:13]
    v_pk_add_f32 v[10:11], v[10:11], v[14:15]
    v_pk_add_f32 v[8:9], v[8:9], v[16:17]
    v_pk_add_f32 v[10:11], v[10:11], v[18:19]
    v_pk_add_f32 v[8:9], v[8:9], v[20:21]
    v_pk_add_f32 v[10:11], v[10:11], v[22:23]
    v_pk_add_f32 v[8:9], v[8:9], v[24:25]
    v_pk_add_f32 v[10:11], v[10:11], v[26:27]
    v_pk_add_f32 v[8:9], v[8:9], v[28:29]
    v_pk_add_f32 v[10:11], v[10:11], v[30:31]
    v_pk_add_f32 v[8:9], v[8:9], v[32:33]
    v_pk_add_f32 v[10:11], v[10:11], v[34:35]
    v_pk_add_f32 v[8:9], v[8:9], v[36:37]
    v_pk_add_f32 v[10:11], v[10:11], v[38:39]
    v_pk_add_f32 v[8:9], v[8:9], v[40:41]
    v_pk_add_f32 v[10:11], v[10:11], v[42:43]
    v_lshlrev_b32 v7, 4, v0
    ds_write_b128 v7, v[8:11]
    s_waitcnt lgkmcnt(0)
    s_barrier
    v_readfirstlane_b32 s3, v0
    s_cmp_ge_u32 s3, 64
    s_cbranch_scc1 K5_END1
    v_lshlrev_b32 v7, 2, v0
    ds_read_b32 v8, v7 offset:0
    ds_read_b32 v9, v7 offset:256
    ds_read_b32 v10, v7 offset:512
    ds_read_b32 v11, v7 offset:768
    ds_read_b32 v12, v7 offset:1024
    ds_read_b32 v13, v7 offset:1280
    ds_read_b32 v14, v7 offset:1536
    ds_read_b32 v15, v7 offset:1792
    ds_read_b32 v16, v7 offset:2048
    ds_read_b32 v17, v7 offset:2304
    ds_read_b32 v18, v7 offset:2560
    ds_read_b32 v19, v7 offset:2816
    s_waitcnt lgkmcnt(4)
    ds_read_b32 v20, v7 offset:3072
    ds_read_b32 v21, v7 offset:3328
    ds_read_b32 v22, v7 offset:3584
    ds_read_b32 v23, v7 offset:3840
    s_waitcnt lgkmcnt(0)
    v_pk_add_f32 v[8:9], v[8:9], v[10:11]
    v_pk_add_f32 v[8:9], v[8:9], v[12:13]
    v_pk_add_f32 v[8:9], v[8:9], v[14:15]
    v_pk_add_f32 v[8:9], v[8:9], v[16:17]
    v_pk_add_f32 v[8:9], v[8:9], v[18:19]
    v_pk_add_f32 v[8:9], v[8:9], v[20:21]
    v_pk_add_f32 v[8:9], v[8:9], v[22:23]
    v_add_f32 v8, v8, v9
    v_cvt_pk_bf16_f32 v8, v8, v8
    v_lshlrev_b32 v8, 16, v8
    v_ashrrev_i32 v9, 31, v44
    v_not_b32 v9, v9
    v_or_b32 v9, 0x80000000, v9
    v_xor_b32 v9, v44, v9
    v_and_b32 v9, 0xffff0000, v9
    v_mul_f32 v9, 0xbfb8aa3b, v9
    v_exp_f32 v9, v9
    s_nop 0
    v_add_f32 v9, 1.0, v9
    v_rcp_f32 v9, v9
    s_nop 0
    v_cvt_pk_bf16_f32 v9, v9, v9
    v_lshlrev_b32 v9, 16, v9
    v_mul_f32 v8, v8, v9
    v_cvt_pk_bf16_f32 v8, v8, v8
    v_lshlrev_b32 v8, 16, v8
    s_waitcnt vmcnt(0)
    v_lshlrev_b32 v48, 16, v48
    v_lshlrev_b32 v49, 16, v49
    v_lshlrev_b32 v50, 16, v50
    v_add_f32 v8, v8, v48
    v_add_f32 v49, v49, v50
    v_cvt_pk_bf16_f32 v8, v8, v49
    v_lshlrev_b32 v10, 16, v8
    v_and_b32 v11, 0xffff0000, v8
    v_add_f32 v8, v10, v11
    v_cvt_pk_bf16_f32 v8, v8, v8
    buffer_store_short v8, v46, s[28:31], 0 offen
K5_END1:
K5_END:
    s_endpgm
.section .rodata,"a"
.p2align 6
.amdhsa_kernel k1_kernel
  .amdhsa_next_free_vgpr 108
  .amdhsa_next_free_sgpr 40
  .amdhsa_accum_offset 108
  .amdhsa_group_segment_fixed_size 0
  .amdhsa_kernarg_size 136
  .amdhsa_user_sgpr_count 2
  .amdhsa_user_sgpr_kernarg_segment_ptr 1
  .amdhsa_system_sgpr_workgroup_id_x 1
  .amdhsa_float_denorm_mode_32 3
.end_amdhsa_kernel
.p2align 6
.amdhsa_kernel k2_kernel
  .amdhsa_next_free_vgpr 148
  .amdhsa_next_free_sgpr 40
  .amdhsa_accum_offset 148
  .amdhsa_group_segment_fixed_size 0
  .amdhsa_kernarg_size 136
  .amdhsa_user_sgpr_count 2
  .amdhsa_user_sgpr_kernarg_segment_ptr 1
  .amdhsa_system_sgpr_workgroup_id_x 1
  .amdhsa_float_denorm_mode_32 3
.end_amdhsa_kernel
.p2align 6
.amdhsa_kernel k3_kernel
  .amdhsa_next_free_vgpr 80
  .amdhsa_next_free_sgpr 48
  .amdhsa_accum_offset 80
  .amdhsa_group_segment_fixed_size 0
  .amdhsa_kernarg_size 136
  .amdhsa_user_sgpr_count 2
  .amdhsa_user_sgpr_kernarg_segment_ptr 1
  .amdhsa_system_sgpr_workgroup_id_x 1
  .amdhsa_float_denorm_mode_32 3
.end_amdhsa_kernel
.p2align 6
.amdhsa_kernel k4_kernel
  .amdhsa_next_free_vgpr 128
  .amdhsa_next_free_sgpr 48
  .amdhsa_accum_offset 128
  .amdhsa_group_segment_fixed_size 0
  .amdhsa_kernarg_size 136
  .amdhsa_user_sgpr_count 2
  .amdhsa_user_sgpr_kernarg_segment_ptr 1
  .amdhsa_system_sgpr_workgroup_id_x 1
  .amdhsa_float_denorm_mode_32 3
.end_amdhsa_kernel
.p2align 6
.amdhsa_kernel k5_kernel
  .amdhsa_next_free_vgpr 52
  .amdhsa_next_free_sgpr 40
  .amdhsa_accum_offset 52
  .amdhsa_group_segment_fixed_size 0
  .amdhsa_kernarg_size 136
  .amdhsa_user_sgpr_count 2
  .amdhsa_user_sgpr_kernarg_segment_ptr 1
  .amdhsa_system_sgpr_workgroup_id_x 1
  .amdhsa_float_denorm_mode_32 3
.end_amdhsa_kernel
```

```asm
; @launch kernel=k1_kernel grid=(832,1,1) block=(256,1,1) lds=36352
; @launch kernel=k2_kernel grid=(576,1,1) block=(256,1,1) lds=47360
; @launch kernel=k3_kernel grid=(256,1,1) block=(256,1,1) lds=9216
; @launch kernel=k4_kernel grid=(144,1,1) block=(960,1,1) lds=14336
; @launch kernel=k5_kernel grid=(72,1,1) block=(256,1,1) lds=4096
.amdgcn_target "amdgcn-amd-amdhsa--gfx950"
.text
.globl k1_kernel
.p2align 8
.type k1_kernel,@function
k1_kernel:
    s_cmp_ge_u32 s2, 832
    s_cbranch_scc1 K1_END
    s_cmp_ge_u32 s2, 256
    s_cbranch_scc1 K1_KGEN
    s_load_dwordx2 s[4:5], s[0:1], 0
    s_load_dwordx2 s[6:7], s[0:1], 128
    v_lshrrev_b32 v1, 5, v0
    v_and_b32 v2, 31, v0
    v_mul_u32_u24 v3, 1152, v1
    v_lshl_add_u32 v3, v2, 2, v3
    s_and_b32 s16, s2, 7
    s_lshl_b32 s16, s16, 5
    s_lshr_b32 s3, s2, 3
    s_add_u32 s18, s3, s16
    s_mul_i32 s3, s18, 9216
    s_lshl_b32 s18, s18, 4
    s_waitcnt lgkmcnt(0)
    s_mov_b32 s8, s4
    s_mov_b32 s9, s5
    s_mov_b32 s10, 0x240000
    s_mov_b32 s11, 0x20000
    s_mov_b32 s12, s6
    s_mov_b32 s13, s7
    s_mov_b32 s14, 0x240000
    s_mov_b32 s15, 0x20000
    buffer_load_dword v10, v3, s[8:11], s3 offen offset:0
    buffer_load_dword v11, v3, s[8:11], s3 offen offset:128
    buffer_load_dword v12, v3, s[8:11], s3 offen offset:256
    buffer_load_dword v13, v3, s[8:11], s3 offen offset:384
    buffer_load_dword v14, v3, s[8:11], s3 offen offset:512
    buffer_load_dword v15, v3, s[8:11], s3 offen offset:640
    buffer_load_dword v16, v3, s[8:11], s3 offen offset:768
    buffer_load_dword v17, v3, s[8:11], s3 offen offset:896
    buffer_load_dword v18, v3, s[8:11], s3 offen offset:1024
    v_lshrrev_b32 v4, 6, v0
    v_mul_u32_u24 v4, 2304, v4
    v_lshl_add_u32 v4, v2, 3, v4
    v_and_b32 v5, 1, v1
    v_lshl_add_u32 v4, v5, 2, v4
    v_mul_u32_u24 v5, 0x020202, v5
    v_lshlrev_b32 v6, 25, v1
    v_and_b32 v6, 0x02000000, v6
    v_or_b32 v5, v5, v6
    v_add_u32 v5, 0x05040100, v5
    s_waitcnt vmcnt(8)
    v_lshlrev_b32 v20, 16, v10
    v_and_b32 v21, 0xffff0000, v10
    s_waitcnt vmcnt(7)
    v_lshlrev_b32 v22, 16, v11
    v_and_b32 v23, 0xffff0000, v11
    s_waitcnt vmcnt(6)
    v_lshlrev_b32 v24, 16, v12
    v_and_b32 v25, 0xffff0000, v12
    s_waitcnt vmcnt(5)
    v_lshlrev_b32 v26, 16, v13
    v_and_b32 v27, 0xffff0000, v13
    s_waitcnt vmcnt(4)
    v_lshlrev_b32 v28, 16, v14
    v_and_b32 v29, 0xffff0000, v14
    s_waitcnt vmcnt(3)
    v_lshlrev_b32 v30, 16, v15
    v_and_b32 v31, 0xffff0000, v15
    s_waitcnt vmcnt(2)
    v_lshlrev_b32 v32, 16, v16
    v_and_b32 v33, 0xffff0000, v16
    s_waitcnt vmcnt(1)
    v_lshlrev_b32 v34, 16, v17
    v_and_b32 v35, 0xffff0000, v17
    s_waitcnt vmcnt(0)
    v_lshlrev_b32 v36, 16, v18
    v_and_b32 v37, 0xffff0000, v18
    v_pk_add_f32 v[44:45], v[20:21], v[22:23]
    v_pk_add_f32 v[46:47], v[24:25], v[26:27]
    v_pk_add_f32 v[44:45], v[44:45], v[28:29]
    v_pk_add_f32 v[46:47], v[46:47], v[30:31]
    v_pk_add_f32 v[44:45], v[44:45], v[32:33]
    v_pk_add_f32 v[46:47], v[46:47], v[34:35]
    v_pk_add_f32 v[44:45], v[44:45], v[36:37]
    v_pk_add_f32 v[44:45], v[44:45], v[46:47]
    v_add_f32 v44, v44, v45
    s_nop 1
    v_add_f32_dpp v44, v44, v44 row_ror:8 row_mask:0xf bank_mask:0xf
    s_nop 1
    v_add_f32_dpp v44, v44, v44 row_ror:4 row_mask:0xf bank_mask:0xf
    s_nop 1
    v_add_f32_dpp v44, v44, v44 row_ror:2 row_mask:0xf bank_mask:0xf
    s_nop 1
    v_add_f32_dpp v44, v44, v44 row_ror:1 row_mask:0xf bank_mask:0xf
    v_mov_b32 v46, v44
    s_nop 1
    v_permlane16_swap_b32 v44, v46
    v_add_f32 v44, v44, v46
    v_mul_f32 v48, 0x3ae38e39, v44
    v_mov_b32 v49, v48
    v_cvt_pk_bf16_f32 v40, v48, v48
    v_and_b32 v40, 0xffff0000, v40
    v_mov_b32 v41, v40
    v_pk_add_f32 v[42:43], v[20:21], v[48:49] neg_lo:[0,1] neg_hi:[0,1]
    v_pk_mul_f32 v[44:45], v[42:43], v[42:43]
    v_pk_add_f32 v[42:43], v[22:23], v[48:49] neg_lo:[0,1] neg_hi:[0,1]
    v_pk_mul_f32 v[46:47], v[42:43], v[42:43]
    v_pk_add_f32 v[42:43], v[24:25], v[48:49] neg_lo:[0,1] neg_hi:[0,1]
    v_pk_fma_f32 v[44:45], v[42:43], v[42:43], v[44:45]
    v_pk_add_f32 v[42:43], v[26:27], v[48:49] neg_lo:[0,1] neg_hi:[0,1]
    v_pk_fma_f32 v[46:47], v[42:43], v[42:43], v[46:47]
    v_pk_add_f32 v[42:43], v[28:29], v[48:49] neg_lo:[0,1] neg_hi:[0,1]
    v_pk_fma_f32 v[44:45], v[42:43], v[42:43], v[44:45]
    v_pk_add_f32 v[42:43], v[30:31], v[48:49] neg_lo:[0,1] neg_hi:[0,1]
    v_pk_fma_f32 v[46:47], v[42:43], v[42:43], v[46:47]
    v_pk_add_f32 v[42:43], v[32:33], v[48:49] neg_lo:[0,1] neg_hi:[0,1]
    v_pk_fma_f32 v[44:45], v[42:43], v[42:43], v[44:45]
    v_pk_add_f32 v[42:43], v[34:35], v[48:49] neg_lo:[0,1] neg_hi:[0,1]
    v_pk_fma_f32 v[46:47], v[42:43], v[42:43], v[46:47]
    v_pk_add_f32 v[42:43], v[36:37], v[48:49] neg_lo:[0,1] neg_hi:[0,1]
    v_pk_fma_f32 v[44:45], v[42:43], v[42:43], v[44:45]
    v_pk_add_f32 v[44:45], v[44:45], v[46:47]
    v_add_f32 v44, v44, v45
    s_nop 1
    v_add_f32_dpp v44, v44, v44 row_ror:8 row_mask:0xf bank_mask:0xf
    s_nop 1
    v_add_f32_dpp v44, v44, v44 row_ror:4 row_mask:0xf bank_mask:0xf
    s_nop 1
    v_add_f32_dpp v44, v44, v44 row_ror:2 row_mask:0xf bank_mask:0xf
    s_nop 1
    v_add_f32_dpp v44, v44, v44 row_ror:1 row_mask:0xf bank_mask:0xf
    v_mov_b32 v46, v44
    s_nop 1
    v_permlane16_swap_b32 v44, v46
    v_add_f32 v44, v44, v46
    v_mul_f32 v44, 0x3ae38e39, v44
    v_cvt_pk_bf16_f32 v44, v44, v44
    v_and_b32 v44, 0xffff0000, v44
    v_add_f32 v44, 0x3727c5ac, v44
    v_cvt_pk_bf16_f32 v44, v44, v44
    v_and_b32 v44, 0xffff0000, v44
    v_sqrt_f32 v44, v44
    s_nop 0
    v_cvt_pk_bf16_f32 v44, v44, v44
    v_and_b32 v44, 0xffff0000, v44
    v_rcp_f32 v42, v44
    s_nop 0
    v_mov_b32 v43, v42
    v_pk_add_f32 v[44:45], v[20:21], v[40:41] neg_lo:[0,1] neg_hi:[0,1]
    v_cvt_pk_bf16_f32 v46, v44, v45
    v_lshlrev_b32 v44, 16, v46
    v_and_b32 v45, 0xffff0000, v46
    v_pk_mul_f32 v[44:45], v[44:45], v[42:43]
    v_cvt_pk_bf16_f32 v46, v44, v45
    v_lshlrev_b32 v44, 16, v46
    v_and_b32 v45, 0xffff0000, v46
    v_cvt_pk_f16_f32 v46, v44, v45
    v_mov_b32 v47, v46
    s_nop 1
    v_permlane32_swap_b32 v46, v47
    v_perm_b32 v10, v47, v46, v5
    ds_write_b32 v4, v10 offset:0
    v_pk_add_f32 v[44:45], v[22:23], v[40:41] neg_lo:[0,1] neg_hi:[0,1]
    v_cvt_pk_bf16_f32 v46, v44, v45
    v_lshlrev_b32 v44, 16, v46
    v_and_b32 v45, 0xffff0000, v46
    v_pk_mul_f32 v[44:45], v[44:45], v[42:43]
    v_cvt_pk_bf16_f32 v46, v44, v45
    v_lshlrev_b32 v44, 16, v46
    v_and_b32 v45, 0xffff0000, v46
    v_cvt_pk_f16_f32 v46, v44, v45
    v_mov_b32 v47, v46
    s_nop 1
    v_permlane32_swap_b32 v46, v47
    v_perm_b32 v11, v47, v46, v5
    ds_write_b32 v4, v11 offset:256
    v_pk_add_f32 v[44:45], v[24:25], v[40:41] neg_lo:[0,1] neg_hi:[0,1]
    v_cvt_pk_bf16_f32 v46, v44, v45
    v_lshlrev_b32 v44, 16, v46
    v_and_b32 v45, 0xffff0000, v46
    v_pk_mul_f32 v[44:45], v[44:45], v[42:43]
    v_cvt_pk_bf16_f32 v46, v44, v45
    v_lshlrev_b32 v44, 16, v46
    v_and_b32 v45, 0xffff0000, v46
    v_cvt_pk_f16_f32 v46, v44, v45
    v_mov_b32 v47, v46
    s_nop 1
    v_permlane32_swap_b32 v46, v47
    v_perm_b32 v12, v47, v46, v5
    ds_write_b32 v4, v12 offset:512
    v_pk_add_f32 v[44:45], v[26:27], v[40:41] neg_lo:[0,1] neg_hi:[0,1]
    v_cvt_pk_bf16_f32 v46, v44, v45
    v_lshlrev_b32 v44, 16, v46
    v_and_b32 v45, 0xffff0000, v46
    v_pk_mul_f32 v[44:45], v[44:45], v[42:43]
    v_cvt_pk_bf16_f32 v46, v44, v45
    v_lshlrev_b32 v44, 16, v46
    v_and_b32 v45, 0xffff0000, v46
    v_cvt_pk_f16_f32 v46, v44, v45
    v_mov_b32 v47, v46
    s_nop 1
    v_permlane32_swap_b32 v46, v47
    v_perm_b32 v13, v47, v46, v5
    ds_write_b32 v4, v13 offset:768
    v_pk_add_f32 v[44:45], v[28:29], v[40:41] neg_lo:[0,1] neg_hi:[0,1]
    v_cvt_pk_bf16_f32 v46, v44, v45
    v_lshlrev_b32 v44, 16, v46
    v_and_b32 v45, 0xffff0000, v46
    v_pk_mul_f32 v[44:45], v[44:45], v[42:43]
    v_cvt_pk_bf16_f32 v46, v44, v45
    v_lshlrev_b32 v44, 16, v46
    v_and_b32 v45, 0xffff0000, v46
    v_cvt_pk_f16_f32 v46, v44, v45
    v_mov_b32 v47, v46
    s_nop 1
    v_permlane32_swap_b32 v46, v47
    v_perm_b32 v14, v47, v46, v5
    ds_write_b32 v4, v14 offset:1024
    v_pk_add_f32 v[44:45], v[30:31], v[40:41] neg_lo:[0,1] neg_hi:[0,1]
    v_cvt_pk_bf16_f32 v46, v44, v45
    v_lshlrev_b32 v44, 16, v46
    v_and_b32 v45, 0xffff0000, v46
    v_pk_mul_f32 v[44:45], v[44:45], v[42:43]
    v_cvt_pk_bf16_f32 v46, v44, v45
    v_lshlrev_b32 v44, 16, v46
    v_and_b32 v45, 0xffff0000, v46
    v_cvt_pk_f16_f32 v46, v44, v45
    v_mov_b32 v47, v46
    s_nop 1
    v_permlane32_swap_b32 v46, v47
    v_perm_b32 v15, v47, v46, v5
    ds_write_b32 v4, v15 offset:1280
    v_pk_add_f32 v[44:45], v[32:33], v[40:41] neg_lo:[0,1] neg_hi:[0,1]
    v_cvt_pk_bf16_f32 v46, v44, v45
    v_lshlrev_b32 v44, 16, v46
    v_and_b32 v45, 0xffff0000, v46
    v_pk_mul_f32 v[44:45], v[44:45], v[42:43]
    v_cvt_pk_bf16_f32 v46, v44, v45
    v_lshlrev_b32 v44, 16, v46
    v_and_b32 v45, 0xffff0000, v46
    v_cvt_pk_f16_f32 v46, v44, v45
    v_mov_b32 v47, v46
    s_nop 1
    v_permlane32_swap_b32 v46, v47
    v_perm_b32 v16, v47, v46, v5
    ds_write_b32 v4, v16 offset:1536
    v_pk_add_f32 v[44:45], v[34:35], v[40:41] neg_lo:[0,1] neg_hi:[0,1]
    v_cvt_pk_bf16_f32 v46, v44, v45
    v_lshlrev_b32 v44, 16, v46
    v_and_b32 v45, 0xffff0000, v46
    v_pk_mul_f32 v[44:45], v[44:45], v[42:43]
    v_cvt_pk_bf16_f32 v46, v44, v45
    v_lshlrev_b32 v44, 16, v46
    v_and_b32 v45, 0xffff0000, v46
    v_cvt_pk_f16_f32 v46, v44, v45
    v_mov_b32 v47, v46
    s_nop 1
    v_permlane32_swap_b32 v46, v47
    v_perm_b32 v17, v47, v46, v5
    ds_write_b32 v4, v17 offset:1792
    v_pk_add_f32 v[44:45], v[36:37], v[40:41] neg_lo:[0,1] neg_hi:[0,1]
    v_cvt_pk_bf16_f32 v46, v44, v45
    v_lshlrev_b32 v44, 16, v46
    v_and_b32 v45, 0xffff0000, v46
    v_pk_mul_f32 v[44:45], v[44:45], v[42:43]
    v_cvt_pk_bf16_f32 v46, v44, v45
    v_lshlrev_b32 v44, 16, v46
    v_and_b32 v45, 0xffff0000, v46
    v_cvt_pk_f16_f32 v46, v44, v45
    v_mov_b32 v47, v46
    s_nop 1
    v_permlane32_swap_b32 v46, v47
    v_perm_b32 v18, v47, v46, v5
    ds_write_b32 v4, v18 offset:2048
    s_waitcnt lgkmcnt(0)
    s_barrier
    v_lshlrev_b32 v6, 2, v0
    v_lshlrev_b32 v7, 12, v0
    v_readfirstlane_b32 s16, v0
    ds_read2st64_b32 v[20:21], v6 offset0:0 offset1:9
    ds_read2st64_b32 v[22:23], v6 offset0:18 offset1:27
    ds_read2st64_b32 v[24:25], v6 offset0:4 offset1:13
    ds_read2st64_b32 v[26:27], v6 offset0:22 offset1:31
    s_cmp_ge_u32 s16, 64
    s_cbranch_scc1 K1_LN_SKIP
    ds_read2st64_b32 v[28:29], v6 offset0:8 offset1:17
    ds_read2st64_b32 v[30:31], v6 offset0:26 offset1:35
    s_add_u32 s17, s18, 0x200000
    s_waitcnt lgkmcnt(0)
    buffer_store_dwordx4 v[28:31], v7, s[12:15], s17 offen
K1_LN_SKIP:
    s_add_u32 s17, s18, 0x100000
    s_waitcnt lgkmcnt(0)
    buffer_store_dwordx4 v[20:23], v7, s[12:15], s18 offen
    buffer_store_dwordx4 v[24:27], v7, s[12:15], s17 offen
    s_endpgm
K1_KGEN:
    s_load_dwordx16 s[16:31], s[0:1], 0
    s_load_dwordx2 s[6:7], s[0:1], 128
    s_sub_u32 s3, s2, 256
    s_and_b32 s4, s3, 7
    s_mul_i32 s4, s4, 72
    s_lshr_b32 s3, s3, 3
    s_add_u32 s3, s3, s4
    v_and_b32 v1, 63, v0
    s_lshl_b32 s4, s3, 8
    v_lshl_add_u32 v2, v1, 2, s4
    s_lshl_b32 s4, s3, 1
    v_mov_b32 v3, s4
    v_readfirstlane_b32 s5, v0
    s_lshr_b32 s5, s5, 6
    s_waitcnt lgkmcnt(0)
    global_load_ushort v16, v3, s[30:31]
    global_load_dword v10, v2, s[18:19]
    global_load_dword v11, v2, s[20:21]
    global_load_dword v12, v2, s[22:23]
    global_load_dword v13, v2, s[24:25]
    global_load_dword v14, v2, s[26:27]
    global_load_dword v15, v2, s[28:29]
    s_add_u32 s8, s6, 0x300000
    s_addc_u32 s9, s7, 0
    s_mov_b32 s10, 0x242400
    s_mov_b32 s11, 0x20000
    s_add_u32 s12, s6, 0xc10000
    s_addc_u32 s13, s7, 0
    s_mov_b32 s14, 0x900
    s_mov_b32 s15, 0x20000
    v_lshlrev_b32 v4, 3, v0
    v_sub_u32 v4, 2047, v4
    v_subrev_u32 v5, 0, v4
    v_subrev_u32 v6, 1, v4
    v_cvt_f32_u32 v7, v5
    v_cvt_f32_u32 v8, v6
    v_cvt_pk_bf16_f32 v7, v7, v8
    v_and_b32 v8, 0xffff, v7
    v_lshrrev_b32 v7, 16, v7
    v_subrev_u32 v8, 0x4280, v8
    v_subrev_u32 v7, 0x4280, v7
    v_cmp_gt_u32 vcc, 128, v5
    s_nop 1
    v_cndmask_b32 v8, v8, v5, vcc
    v_cmp_gt_u32 vcc, 128, v6
    s_nop 1
    v_cndmask_b32 v7, v7, v6, vcc
    v_lshlrev_b32 v100, 1, v8
    v_lshlrev_b32 v101, 1, v7
    v_subrev_u32 v5, 2, v4
    v_subrev_u32 v6, 3, v4
    v_cvt_f32_u32 v7, v5
    v_cvt_f32_u32 v8, v6
    v_cvt_pk_bf16_f32 v7, v7, v8
    v_and_b32 v8, 0xffff, v7
    v_lshrrev_b32 v7, 16, v7
    v_subrev_u32 v8, 0x4280, v8
    v_subrev_u32 v7, 0x4280, v7
    v_cmp_gt_u32 vcc, 128, v5
    s_nop 1
    v_cndmask_b32 v8, v8, v5, vcc
    v_cmp_gt_u32 vcc, 128, v6
    s_nop 1
    v_cndmask_b32 v7, v7, v6, vcc
    v_lshlrev_b32 v102, 1, v8
    v_lshlrev_b32 v103, 1, v7
    v_subrev_u32 v5, 4, v4
    v_subrev_u32 v6, 5, v4
    v_cvt_f32_u32 v7, v5
    v_cvt_f32_u32 v8, v6
    v_cvt_pk_bf16_f32 v7, v7, v8
    v_and_b32 v8, 0xffff, v7
    v_lshrrev_b32 v7, 16, v7
    v_subrev_u32 v8, 0x4280, v8
    v_subrev_u32 v7, 0x4280, v7
    v_cmp_gt_u32 vcc, 128, v5
    s_nop 1
    v_cndmask_b32 v8, v8, v5, vcc
    v_cmp_gt_u32 vcc, 128, v6
    s_nop 1
    v_cndmask_b32 v7, v7, v6, vcc
    v_lshlrev_b32 v104, 1, v8
    v_lshlrev_b32 v105, 1, v7
    v_subrev_u32 v5, 6, v4
    v_subrev_u32 v6, 7, v4
    v_cvt_f32_u32 v7, v5
    v_cvt_f32_u32 v8, v6
    v_cvt_pk_bf16_f32 v7, v7, v8
    v_and_b32 v8, 0xffff, v7
    v_lshrrev_b32 v7, 16, v7
    v_subrev_u32 v8, 0x4280, v8
    v_subrev_u32 v7, 0x4280, v7
    v_cmp_gt_u32 vcc, 128, v5
    s_nop 1
    v_cndmask_b32 v8, v8, v5, vcc
    v_cmp_gt_u32 vcc, 128, v6
    s_nop 1
    v_cndmask_b32 v7, v7, v6, vcc
    v_lshlrev_b32 v106, 1, v8
    v_lshlrev_b32 v107, 1, v7
    s_waitcnt vmcnt(6)
    v_lshlrev_b32 v16, 16, v16
    v_mul_f32 v17, 0x3fb8aa3b, v16
    s_mov_b32 s32, 0x3fb8aa3b
    s_mov_b32 s33, 0x32a57060
    v_fma_f32 v18, v16, s32, -v17
    v_fma_f32 v18, v16, s33, v18
    v_exp_f32 v17, v17
    v_mul_f32 v18, 0x3f317218, v18
    v_fma_f32 v17, v17, v18, v17
    v_cvt_pk_bf16_f32 v17, v17, v17
    v_and_b32 v16, 0xffff0000, v17
    v_mov_b32 v17, v16
    s_waitcnt vmcnt(0)
    v_lshlrev_b32 v20, 16, v10
    v_and_b32 v21, 0xffff0000, v10
    v_lshlrev_b32 v22, 16, v11
    v_and_b32 v23, 0xffff0000, v11
    v_lshlrev_b32 v24, 16, v12
    v_and_b32 v25, 0xffff0000, v12
    v_lshlrev_b32 v26, 16, v13
    v_and_b32 v27, 0xffff0000, v13
    v_lshlrev_b32 v28, 16, v14
    v_and_b32 v29, 0xffff0000, v14
    v_lshlrev_b32 v30, 16, v15
    v_and_b32 v31, 0xffff0000, v15
    v_pk_mul_f32 v[20:21], v[20:21], v[16:17]
    v_pk_mul_f32 v[22:23], v[22:23], v[16:17]
    v_pk_mul_f32 v[24:25], v[24:25], v[16:17]
    v_pk_mul_f32 v[26:27], v[26:27], v[16:17]
    v_pk_mul_f32 v[90:91], v[30:31], v[26:27]
    v_pk_mul_f32 v[92:93], v[30:31], v[24:25]
    v_pk_fma_f32 v[34:35], v[28:29], v[26:27], v[92:93]
    v_pk_fma_f32 v[32:33], v[28:29], v[24:25], v[90:91] neg_lo:[0,0,1] neg_hi:[0,0,1]
    v_max_f32 v36, v20, v21
    s_nop 1
    v_max_f32_dpp v36, v36, v36 row_ror:8 row_mask:0xf bank_mask:0xf
    s_nop 1
    v_max_f32_dpp v36, v36, v36 row_ror:4 row_mask:0xf bank_mask:0xf
    s_nop 1
    v_max_f32_dpp v36, v36, v36 row_ror:2 row_mask:0xf bank_mask:0xf
    s_nop 1
    v_max_f32_dpp v36, v36, v36 row_ror:1 row_mask:0xf bank_mask:0xf
    v_mov_b32 v38, v36
    s_nop 1
    v_permlane16_swap_b32 v36, v38
    v_max_f32 v36, v36, v38
    v_mov_b32 v38, v36
    s_nop 1
    v_permlane32_swap_b32 v36, v38
    v_max_f32 v36, v36, v38
    v_add_f32 v37, abs(v32), abs(v33)
    v_add_f32 v38, abs(v34), abs(v35)
    v_add_f32 v37, v37, v38
    s_nop 1
    v_add_f32_dpp v37, v37, v37 row_ror:8 row_mask:0xf bank_mask:0xf
    s_nop 1
    v_add_f32_dpp v37, v37, v37 row_ror:4 row_mask:0xf bank_mask:0xf
    s_nop 1
    v_add_f32_dpp v37, v37, v37 row_ror:2 row_mask:0xf bank_mask:0xf
    s_nop 1
    v_add_f32_dpp v37, v37, v37 row_ror:1 row_mask:0xf bank_mask:0xf
    v_mov_b32 v38, v37
    s_nop 1
    v_permlane16_swap_b32 v37, v38
    v_add_f32 v37, v37, v38
    v_mov_b32 v38, v37
    s_nop 1
    v_permlane32_swap_b32 v37, v38
    v_add_f32 v37, v37, v38
    v_max_f32 v37, 0x03aa2425, v37
    v_rcp_f32 v38, v37
    s_nop 0
    v_mul_f32 v38, 0x47000000, v38
    v_mov_b32 v39, v38
    v_pk_mul_f32 v[32:33], v[32:33], v[38:39]
    v_pk_mul_f32 v[34:35], v[34:35], v[38:39]
    v_sub_f32 v20, v20, v36
    v_sub_f32 v21, v21, v36
    v_mul_f32 v20, 0x3fb8aa3b, v20
    v_mul_f32 v21, 0x3fb8aa3b, v21
    v_mul_f32 v36, 0x3fb8aa3b, v36
    s_mov_b32 s32, 0x3e22f983
    s_mov_b32 s33, 0x31dc9c88
    s_mul_i32 s4, s5, 8704
    v_lshl_add_u32 v4, v1, 3, s4
    v_and_b32 v5, 15, v1
    v_lshrrev_b32 v6, 4, v1
    v_lshlrev_b32 v7, 3, v5
    s_cmp_eq_u32 s5, 1
    s_cbranch_scc1 K1_J1
    s_cmp_eq_u32 s5, 2
    s_cbranch_scc1 K1_J2
    s_cmp_eq_u32 s5, 3
    s_cbranch_scc1 K1_J3
    v_mul_f32 v90, 0x3f800000, v20
    v_mul_f32 v91, 0x3f800000, v22
    v_exp_f32 v90, v90
    v_mul_f32 v92, s32, v91
    v_rndne_f32 v92, v92
    v_fma_f32 v92, v91, s32, -v92
    v_fma_f32 v92, v91, s33, v92
    v_cos_f32 v91, v92
    v_sin_f32 v92, v92
    v_mul_f32 v40, v90, v91
    v_mul_f32 v42, v90, v92
    v_mul_f32 v90, 0x3f800000, v21
    v_mul_f32 v91, 0x3f800000, v23
    v_exp_f32 v90, v90
    v_mul_f32 v92, s32, v91
    v_rndne_f32 v92, v92
    v_fma_f32 v92, v91, s32, -v92
    v_fma_f32 v92, v91, s33, v92
    v_cos_f32 v91, v92
    v_sin_f32 v92, v92
    v_mul_f32 v41, v90, v91
    v_mul_f32 v43, v90, v92
    v_mul_f32 v90, 0x43000000, v20
    v_mul_f32 v91, 0x43000000, v22
    v_exp_f32 v90, v90
    v_mul_f32 v92, s32, v91
    v_rndne_f32 v92, v92
    v_fma_f32 v92, v91, s32, -v92
    v_fma_f32 v92, v91, s33, v92
    v_cos_f32 v91, v92
    v_sin_f32 v92, v92
    v_mul_f32 v44, v90, v91
    v_mul_f32 v46, v90, v92
    v_mul_f32 v90, 0x43000000, v21
    v_mul_f32 v91, 0x43000000, v23
    v_exp_f32 v90, v90
    v_mul_f32 v92, s32, v91
    v_rndne_f32 v92, v92
    v_fma_f32 v92, v91, s32, -v92
    v_fma_f32 v92, v91, s33, v92
    v_cos_f32 v91, v92
    v_sin_f32 v92, v92
    v_mul_f32 v45, v90, v91
    v_mul_f32 v47, v90, v92
    v_cvt_pk_f16_f32 v94, v32, v34
    v_cvt_pk_f16_f32 v95, v33, v35
    ds_write_b64 v4, v[94:95] offset:0
    v_pk_mul_f32 v[90:91], v[34:35], v[46:47]
    v_pk_mul_f32 v[92:93], v[34:35], v[44:45]
    v_pk_fma_f32 v[62:63], v[32:33], v[46:47], v[92:93]
    v_pk_fma_f32 v[60:61], v[32:33], v[44:45], v[90:91] neg_lo:[0,0,1] neg_hi:[0,0,1]
    v_cvt_pk_f16_f32 v94, v60, v62
    v_cvt_pk_f16_f32 v95, v61, v63
    ds_write_b64 v4, v[94:95] offset:4352
    v_pk_mul_f32 v[90:91], v[34:35], v[42:43]
    v_pk_mul_f32 v[92:93], v[34:35], v[40:41]
    v_pk_fma_f32 v[54:55], v[32:33], v[42:43], v[92:93]
    v_pk_fma_f32 v[52:53], v[32:33], v[40:41], v[90:91] neg_lo:[0,0,1] neg_hi:[0,0,1]
    v_cvt_pk_f16_f32 v94, v52, v54
    v_cvt_pk_f16_f32 v95, v53, v55
    ds_write_b64 v4, v[94:95] offset:544
    v_pk_mul_f32 v[90:91], v[54:55], v[46:47]
    v_pk_mul_f32 v[92:93], v[54:55], v[44:45]
    v_pk_fma_f32 v[62:63], v[52:53], v[46:47], v[92:93]
    v_pk_fma_f32 v[60:61], v[52:53], v[44:45], v[90:91] neg_lo:[0,0,1] neg_hi:[0,0,1]
    v_cvt_pk_f16_f32 v94, v60, v62
    v_cvt_pk_f16_f32 v95, v61, v63
    ds_write_b64 v4, v[94:95] offset:4896
    v_pk_mul_f32 v[90:91], v[54:55], v[42:43]
    v_pk_mul_f32 v[92:93], v[54:55], v[40:41]
    v_pk_fma_f32 v[58:59], v[52:53], v[42:43], v[92:93]
    v_pk_fma_f32 v[56:57], v[52:53], v[40:41], v[90:91] neg_lo:[0,0,1] neg_hi:[0,0,1]
    v_cvt_pk_f16_f32 v94, v56, v58
    v_cvt_pk_f16_f32 v95, v57, v59
    ds_write_b64 v4, v[94:95] offset:1088
    v_pk_mul_f32 v[90:91], v[58:59], v[46:47]
    v_pk_mul_f32 v[92:93], v[58:59], v[44:45]
    v_pk_fma_f32 v[62:63], v[56:57], v[46:47], v[92:93]
    v_pk_fma_f32 v[60:61], v[56:57], v[44:45], v[90:91] neg_lo:[0,0,1] neg_hi:[0,0,1]
    v_cvt_pk_f16_f32 v94, v60, v62
    v_cvt_pk_f16_f32 v95, v61, v63
    ds_write_b64 v4, v[94:95] offset:5440
    v_pk_mul_f32 v[90:91], v[58:59], v[42:43]
    v_pk_mul_f32 v[92:93], v[58:59], v[40:41]
    v_pk_fma_f32 v[54:55], v[56:57], v[42:43], v[92:93]
    v_pk_fma_f32 v[52:53], v[56:57], v[40:41], v[90:91] neg_lo:[0,0,1] neg_hi:[0,0,1]
    v_cvt_pk_f16_f32 v94, v52, v54
    v_cvt_pk_f16_f32 v95, v53, v55
    ds_write_b64 v4, v[94:95] offset:1632
    v_pk_mul_f32 v[90:91], v[54:55], v[46:47]
    v_pk_mul_f32 v[92:93], v[54:55], v[44:45]
    v_pk_fma_f32 v[62:63], v[52:53], v[46:47], v[92:93]
    v_pk_fma_f32 v[60:61], v[52:53], v[44:45], v[90:91] neg_lo:[0,0,1] neg_hi:[0,0,1]
    v_cvt_pk_f16_f32 v94, v60, v62
    v_cvt_pk_f16_f32 v95, v61, v63
    ds_write_b64 v4, v[94:95] offset:5984
    v_pk_mul_f32 v[90:91], v[54:55], v[42:43]
    v_pk_mul_f32 v[92:93], v[54:55], v[40:41]
    v_pk_fma_f32 v[58:59], v[52:53], v[42:43], v[92:93]
    v_pk_fma_f32 v[56:57], v[52:53], v[40:41], v[90:91] neg_lo:[0,0,1] neg_hi:[0,0,1]
    v_cvt_pk_f16_f32 v94, v56, v58
    v_cvt_pk_f16_f32 v95, v57, v59
    ds_write_b64 v4, v[94:95] offset:2176
    v_pk_mul_f32 v[90:91], v[58:59], v[46:47]
    v_pk_mul_f32 v[92:93], v[58:59], v[44:45]
    v_pk_fma_f32 v[62:63], v[56:57], v[46:47], v[92:93]
    v_pk_fma_f32 v[60:61], v[56:57], v[44:45], v[90:91] neg_lo:[0,0,1] neg_hi:[0,0,1]
    v_cvt_pk_f16_f32 v94, v60, v62
    v_cvt_pk_f16_f32 v95, v61, v63
    ds_write_b64 v4, v[94:95] offset:6528
    v_pk_mul_f32 v[90:91], v[58:59], v[42:43]
    v_pk_mul_f32 v[92:93], v[58:59], v[40:41]
    v_pk_fma_f32 v[54:55], v[56:57], v[42:43], v[92:93]
    v_pk_fma_f32 v[52:53], v[56:57], v[40:41], v[90:91] neg_lo:[0,0,1] neg_hi:[0,0,1]
    v_cvt_pk_f16_f32 v94, v52, v54
    v_cvt_pk_f16_f32 v95, v53, v55
    ds_write_b64 v4, v[94:95] offset:2720
    v_pk_mul_f32 v[90:91], v[54:55], v[46:47]
    v_pk_mul_f32 v[92:93], v[54:55], v[44:45]
    v_pk_fma_f32 v[62:63], v[52:53], v[46:47], v[92:93]
    v_pk_fma_f32 v[60:61], v[52:53], v[44:45], v[90:91] neg_lo:[0,0,1] neg_hi:[0,0,1]
    v_cvt_pk_f16_f32 v94, v60, v62
    v_cvt_pk_f16_f32 v95, v61, v63
    ds_write_b64 v4, v[94:95] offset:7072
    v_pk_mul_f32 v[90:91], v[54:55], v[42:43]
    v_pk_mul_f32 v[92:93], v[54:55], v[40:41]
    v_pk_fma_f32 v[58:59], v[52:53], v[42:43], v[92:93]
    v_pk_fma_f32 v[56:57], v[52:53], v[40:41], v[90:91] neg_lo:[0,0,1] neg_hi:[0,0,1]
    v_cvt_pk_f16_f32 v94, v56, v58
    v_cvt_pk_f16_f32 v95, v57, v59
    ds_write_b64 v4, v[94:95] offset:3264
    v_pk_mul_f32 v[90:91], v[58:59], v[46:47]
    v_pk_mul_f32 v[92:93], v[58:59], v[44:45]
    v_pk_fma_f32 v[62:63], v[56:57], v[46:47], v[92:93]
    v_pk_fma_f32 v[60:61], v[56:57], v[44:45], v[90:91] neg_lo:[0,0,1] neg_hi:[0,0,1]
    v_cvt_pk_f16_f32 v94, v60, v62
    v_cvt_pk_f16_f32 v95, v61, v63
    ds_write_b64 v4, v[94:95] offset:7616
    v_pk_mul_f32 v[90:91], v[58:59], v[42:43]
    v_pk_mul_f32 v[92:93], v[58:59], v[40:41]
    v_pk_fma_f32 v[54:55], v[56:57], v[42:43], v[92:93]
    v_pk_fma_f32 v[52:53], v[56:57], v[40:41], v[90:91] neg_lo:[0,0,1] neg_hi:[0,0,1]
    v_cvt_pk_f16_f32 v94, v52, v54
    v_cvt_pk_f16_f32 v95, v53, v55
    ds_write_b64 v4, v[94:95] offset:3808
    v_pk_mul_f32 v[90:91], v[54:55], v[46:47]
    v_pk_mul_f32 v[92:93], v[54:55], v[44:45]
    v_pk_fma_f32 v[62:63], v[52:53], v[46:47], v[92:93]
    v_pk_fma_f32 v[60:61], v[52:53], v[44:45], v[90:91] neg_lo:[0,0,1] neg_hi:[0,0,1]
    v_cvt_pk_f16_f32 v94, v60, v62
    v_cvt_pk_f16_f32 v95, v61, v63
    ds_write_b64 v4, v[94:95] offset:8160
    v_lshrrev_b32 v8, 1, v6
    v_lshl_add_u32 v7, v8, 7, v7
    v_and_b32 v8, 1, v6
    v_lshl_add_u32 v7, v8, 2, v7
    v_mov_b32 v8, 1
    v_mov_b32 v9, 2
    s_branch K1_JOIN
K1_J1:
    v_mul_f32 v90, 0x40000000, v20
    v_mul_f32 v91, 0x40000000, v22
    v_exp_f32 v90, v90
    v_mul_f32 v92, s32, v91
    v_rndne_f32 v92, v92
    v_fma_f32 v92, v91, s32, -v92
    v_fma_f32 v92, v91, s33, v92
    v_cos_f32 v91, v92
    v_sin_f32 v92, v92
    v_mul_f32 v40, v90, v91
    v_mul_f32 v42, v90, v92
    v_mul_f32 v90, 0x40000000, v21
    v_mul_f32 v91, 0x40000000, v23
    v_exp_f32 v90, v90
    v_mul_f32 v92, s32, v91
    v_rndne_f32 v92, v92
    v_fma_f32 v92, v91, s32, -v92
    v_fma_f32 v92, v91, s33, v92
    v_cos_f32 v91, v92
    v_sin_f32 v92, v92
    v_mul_f32 v41, v90, v91
    v_mul_f32 v43, v90, v92
    v_mul_f32 v90, 0x43000000, v20
    v_mul_f32 v91, 0x43000000, v22
    v_exp_f32 v90, v90
    v_mul_f32 v92, s32, v91
    v_rndne_f32 v92, v92
    v_fma_f32 v92, v91, s32, -v92
    v_fma_f32 v92, v91, s33, v92
    v_cos_f32 v91, v92
    v_sin_f32 v92, v92
    v_mul_f32 v44, v90, v91
    v_mul_f32 v46, v90, v92
    v_mul_f32 v90, 0x43000000, v21
    v_mul_f32 v91, 0x43000000, v23
    v_exp_f32 v90, v90
    v_mul_f32 v92, s32, v91
    v_rndne_f32 v92, v92
    v_fma_f32 v92, v91, s32, -v92
    v_fma_f32 v92, v91, s33, v92
    v_cos_f32 v91, v92
    v_sin_f32 v92, v92
    v_mul_f32 v45, v90, v91
    v_mul_f32 v47, v90, v92
    v_mul_f32 v90, 0x43800000, v20
    v_mul_f32 v91, 0x43800000, v22
    v_exp_f32 v90, v90
    v_mul_f32 v92, s32, v91
    v_rndne_f32 v92, v92
    v_fma_f32 v92, v91, s32, -v92
    v_fma_f32 v92, v91, s33, v92
    v_cos_f32 v91, v92
    v_sin_f32 v92, v92
    v_mul_f32 v48, v90, v91
    v_mul_f32 v50, v90, v92
    v_mul_f32 v90, 0x43800000, v21
    v_mul_f32 v91, 0x43800000, v23
    v_exp_f32 v90, v90
    v_mul_f32 v92, s32, v91
    v_rndne_f32 v92, v92
    v_fma_f32 v92, v91, s32, -v92
    v_fma_f32 v92, v91, s33, v92
    v_cos_f32 v91, v92
    v_sin_f32 v92, v92
    v_mul_f32 v49, v90, v91
    v_mul_f32 v51, v90, v92
    v_pk_mul_f32 v[90:91], v[34:35], v[50:51]
    v_pk_mul_f32 v[92:93], v[34:35], v[48:49]
    v_pk_fma_f32 v[54:55], v[32:33], v[50:51], v[92:93]
    v_pk_fma_f32 v[52:53], v[32:33], v[48:49], v[90:91] neg_lo:[0,0,1] neg_hi:[0,0,1]
    v_pk_mul_f32 v[90:91], v[54:55], v[50:51]
    v_pk_mul_f32 v[92:93], v[54:55], v[48:49]
    v_pk_fma_f32 v[66:67], v[52:53], v[50:51], v[92:93]
    v_pk_fma_f32 v[64:65], v[52:53], v[48:49], v[90:91] neg_lo:[0,0,1] neg_hi:[0,0,1]
    v_cvt_pk_f16_f32 v94, v52, v54
    v_cvt_pk_f16_f32 v95, v53, v55
    ds_write_b64 v4, v[94:95] offset:0
    v_pk_mul_f32 v[90:91], v[54:55], v[46:47]
    v_pk_mul_f32 v[92:93], v[54:55], v[44:45]
    v_pk_fma_f32 v[62:63], v[52:53], v[46:47], v[92:93]
    v_pk_fma_f32 v[60:61], v[52:53], v[44:45], v[90:91] neg_lo:[0,0,1] neg_hi:[0,0,1]
    v_cvt_pk_f16_f32 v94, v60, v62
    v_cvt_pk_f16_f32 v95, v61, v63
    ds_write_b64 v4, v[94:95] offset:2176
    v_pk_mul_f32 v[90:91], v[54:55], v[42:43]
    v_pk_mul_f32 v[92:93], v[54:55], v[40:41]
    v_pk_fma_f32 v[58:59], v[52:53], v[42:43], v[92:93]
    v_pk_fma_f32 v[56:57], v[52:53], v[40:41], v[90:91] neg_lo:[0,0,1] neg_hi:[0,0,1]
    v_cvt_pk_f16_f32 v94, v56, v58
    v_cvt_pk_f16_f32 v95, v57, v59
    ds_write_b64 v4, v[94:95] offset:544
    v_pk_mul_f32 v[90:91], v[58:59], v[46:47]
    v_pk_mul_f32 v[92:93], v[58:59], v[44:45]
    v_pk_fma_f32 v[62:63], v[56:57], v[46:47], v[92:93]
    v_pk_fma_f32 v[60:61], v[56:57], v[44:45], v[90:91] neg_lo:[0,0,1] neg_hi:[0,0,1]
    v_cvt_pk_f16_f32 v94, v60, v62
    v_cvt_pk_f16_f32 v95, v61, v63
    ds_write_b64 v4, v[94:95] offset:2720
    v_pk_mul_f32 v[90:91], v[58:59], v[42:43]
    v_pk_mul_f32 v[92:93], v[58:59], v[40:41]
    v_pk_fma_f32 v[54:55], v[56:57], v[42:43], v[92:93]
    v_pk_fma_f32 v[52:53], v[56:57], v[40:41], v[90:91] neg_lo:[0,0,1] neg_hi:[0,0,1]
    v_cvt_pk_f16_f32 v94, v52, v54
    v_cvt_pk_f16_f32 v95, v53, v55
    ds_write_b64 v4, v[94:95] offset:1088
    v_pk_mul_f32 v[90:91], v[54:55], v[46:47]
    v_pk_mul_f32 v[92:93], v[54:55], v[44:45]
    v_pk_fma_f32 v[62:63], v[52:53], v[46:47], v[92:93]
    v_pk_fma_f32 v[60:61], v[52:53], v[44:45], v[90:91] neg_lo:[0,0,1] neg_hi:[0,0,1]
    v_cvt_pk_f16_f32 v94, v60, v62
    v_cvt_pk_f16_f32 v95, v61, v63
    ds_write_b64 v4, v[94:95] offset:3264
    v_pk_mul_f32 v[90:91], v[54:55], v[42:43]
    v_pk_mul_f32 v[92:93], v[54:55], v[40:41]
    v_pk_fma_f32 v[58:59], v[52:53], v[42:43], v[92:93]
    v_pk_fma_f32 v[56:57], v[52:53], v[40:41], v[90:91] neg_lo:[0,0,1] neg_hi:[0,0,1]
    v_cvt_pk_f16_f32 v94, v56, v58
    v_cvt_pk_f16_f32 v95, v57, v59
    ds_write_b64 v4, v[94:95] offset:1632
    v_pk_mul_f32 v[90:91], v[58:59], v[46:47]
    v_pk_mul_f32 v[92:93], v[58:59], v[44:45]
    v_pk_fma_f32 v[62:63], v[56:57], v[46:47], v[92:93]
    v_pk_fma_f32 v[60:61], v[56:57], v[44:45], v[90:91] neg_lo:[0,0,1] neg_hi:[0,0,1]
    v_cvt_pk_f16_f32 v94, v60, v62
    v_cvt_pk_f16_f32 v95, v61, v63
    ds_write_b64 v4, v[94:95] offset:3808
    v_pk_mul_f32 v[90:91], v[42:43], v[42:43]
    v_pk_mul_f32 v[92:93], v[42:43], v[40:41]
    v_pk_fma_f32 v[50:51], v[40:41], v[42:43], v[92:93]
    v_pk_fma_f32 v[48:49], v[40:41], v[40:41], v[90:91] neg_lo:[0,0,1] neg_hi:[0,0,1]
    v_cvt_pk_f16_f32 v94, v64, v66
    v_cvt_pk_f16_f32 v95, v65, v67
    ds_write_b64 v4, v[94:95] offset:4352
    v_pk_mul_f32 v[90:91], v[66:67], v[50:51]
    v_pk_mul_f32 v[92:93], v[66:67], v[48:49]
    v_pk_fma_f32 v[62:63], v[64:65], v[50:51], v[92:93]
    v_pk_fma_f32 v[60:61], v[64:65], v[48:49], v[90:91] neg_lo:[0,0,1] neg_hi:[0,0,1]
    v_cvt_pk_f16_f32 v94, v60, v62
    v_cvt_pk_f16_f32 v95, v61, v63
    ds_write_b64 v4, v[94:95] offset:4896
    v_pk_mul_f32 v[90:91], v[66:67], v[46:47]
    v_pk_mul_f32 v[92:93], v[66:67], v[44:45]
    v_pk_fma_f32 v[54:55], v[64:65], v[46:47], v[92:93]
    v_pk_fma_f32 v[52:53], v[64:65], v[44:45], v[90:91] neg_lo:[0,0,1] neg_hi:[0,0,1]
    v_cvt_pk_f16_f32 v94, v52, v54
    v_cvt_pk_f16_f32 v95, v53, v55
    ds_write_b64 v4, v[94:95] offset:5440
    v_pk_mul_f32 v[90:91], v[54:55], v[50:51]
    v_pk_mul_f32 v[92:93], v[54:55], v[48:49]
    v_pk_fma_f32 v[62:63], v[52:53], v[50:51], v[92:93]
    v_pk_fma_f32 v[60:61], v[52:53], v[48:49], v[90:91] neg_lo:[0,0,1] neg_hi:[0,0,1]
    v_cvt_pk_f16_f32 v94, v60, v62
    v_cvt_pk_f16_f32 v95, v61, v63
    ds_write_b64 v4, v[94:95] offset:5984
    v_pk_mul_f32 v[90:91], v[54:55], v[46:47]
    v_pk_mul_f32 v[92:93], v[54:55], v[44:45]
    v_pk_fma_f32 v[58:59], v[52:53], v[46:47], v[92:93]
    v_pk_fma_f32 v[56:57], v[52:53], v[44:45], v[90:91] neg_lo:[0,0,1] neg_hi:[0,0,1]
    v_cvt_pk_f16_f32 v94, v56, v58
    v_cvt_pk_f16_f32 v95, v57, v59
    ds_write_b64 v4, v[94:95] offset:6528
    v_pk_mul_f32 v[90:91], v[58:59], v[50:51]
    v_pk_mul_f32 v[92:93], v[58:59], v[48:49]
    v_pk_fma_f32 v[62:63], v[56:57], v[50:51], v[92:93]
    v_pk_fma_f32 v[60:61], v[56:57], v[48:49], v[90:91] neg_lo:[0,0,1] neg_hi:[0,0,1]
    v_cvt_pk_f16_f32 v94, v60, v62
    v_cvt_pk_f16_f32 v95, v61, v63
    ds_write_b64 v4, v[94:95] offset:7072
    v_pk_mul_f32 v[90:91], v[58:59], v[46:47]
    v_pk_mul_f32 v[92:93], v[58:59], v[44:45]
    v_pk_fma_f32 v[54:55], v[56:57], v[46:47], v[92:93]
    v_pk_fma_f32 v[52:53], v[56:57], v[44:45], v[90:91] neg_lo:[0,0,1] neg_hi:[0,0,1]
    v_cvt_pk_f16_f32 v94, v52, v54
    v_cvt_pk_f16_f32 v95, v53, v55
    ds_write_b64 v4, v[94:95] offset:7616
    v_pk_mul_f32 v[90:91], v[54:55], v[50:51]
    v_pk_mul_f32 v[92:93], v[54:55], v[48:49]
    v_pk_fma_f32 v[62:63], v[52:53], v[50:51], v[92:93]
    v_pk_fma_f32 v[60:61], v[52:53], v[48:49], v[90:91] neg_lo:[0,0,1] neg_hi:[0,0,1]
    v_cvt_pk_f16_f32 v94, v60, v62
    v_cvt_pk_f16_f32 v95, v61, v63
    ds_write_b64 v4, v[94:95] offset:8160
    v_lshl_add_u32 v8, v6, 7, v7
    v_add_u32 v8, 256, v8
    v_lshl_add_u32 v7, v6, 8, v7
    v_cmp_gt_u32 vcc, 2, v6
    s_nop 1
    v_cndmask_b32 v7, v7, v8, vcc
    v_mov_b32 v8, 4
    v_mov_b32 v9, 0x80
    v_cndmask_b32 v8, v8, 2, vcc
    v_cndmask_b32 v9, v9, 4, vcc
    s_branch K1_JOIN
K1_J2:
    v_mul_f32 v90, 0x43000000, v20
    v_mul_f32 v91, 0x43000000, v22
    v_exp_f32 v90, v90
    v_mul_f32 v92, s32, v91
    v_rndne_f32 v92, v92
    v_fma_f32 v92, v91, s32, -v92
    v_fma_f32 v92, v91, s33, v92
    v_cos_f32 v91, v92
    v_sin_f32 v92, v92
    v_mul_f32 v44, v90, v91
    v_mul_f32 v46, v90, v92
    v_mul_f32 v90, 0x43000000, v21
    v_mul_f32 v91, 0x43000000, v23
    v_exp_f32 v90, v90
    v_mul_f32 v92, s32, v91
    v_rndne_f32 v92, v92
    v_fma_f32 v92, v91, s32, -v92
    v_fma_f32 v92, v91, s33, v92
    v_cos_f32 v91, v92
    v_sin_f32 v92, v92
    v_mul_f32 v45, v90, v91
    v_mul_f32 v47, v90, v92
    v_mul_f32 v90, 0x44800000, v20
    v_mul_f32 v91, 0x44800000, v22
    v_exp_f32 v90, v90
    v_mul_f32 v92, s32, v91
    v_rndne_f32 v92, v92
    v_fma_f32 v92, v91, s32, -v92
    v_fma_f32 v92, v91, s33, v92
    v_cos_f32 v91, v92
    v_sin_f32 v92, v92
    v_mul_f32 v48, v90, v91
    v_mul_f32 v50, v90, v92
    v_mul_f32 v90, 0x44800000, v21
    v_mul_f32 v91, 0x44800000, v23
    v_exp_f32 v90, v90
    v_mul_f32 v92, s32, v91
    v_rndne_f32 v92, v92
    v_fma_f32 v92, v91, s32, -v92
    v_fma_f32 v92, v91, s33, v92
    v_cos_f32 v91, v92
    v_sin_f32 v92, v92
    v_mul_f32 v49, v90, v91
    v_mul_f32 v51, v90, v92
    v_pk_mul_f32 v[90:91], v[34:35], v[50:51]
    v_pk_mul_f32 v[92:93], v[34:35], v[48:49]
    v_pk_fma_f32 v[54:55], v[32:33], v[50:51], v[92:93]
    v_pk_fma_f32 v[52:53], v[32:33], v[48:49], v[90:91] neg_lo:[0,0,1] neg_hi:[0,0,1]
    v_cvt_pk_f16_f32 v94, v52, v54
    v_cvt_pk_f16_f32 v95, v53, v55
    ds_write_b64 v4, v[94:95] offset:0
    v_pk_mul_f32 v[90:91], v[54:55], v[46:47]
    v_pk_mul_f32 v[92:93], v[54:55], v[44:45]
    v_pk_fma_f32 v[58:59], v[52:53], v[46:47], v[92:93]
    v_pk_fma_f32 v[56:57], v[52:53], v[44:45], v[90:91] neg_lo:[0,0,1] neg_hi:[0,0,1]
    v_cvt_pk_f16_f32 v94, v56, v58
    v_cvt_pk_f16_f32 v95, v57, v59
    ds_write_b64 v4, v[94:95] offset:544
    v_pk_mul_f32 v[90:91], v[58:59], v[46:47]
    v_pk_mul_f32 v[92:93], v[58:59], v[44:45]
    v_pk_fma_f32 v[54:55], v[56:57], v[46:47], v[92:93]
    v_pk_fma_f32 v[52:53], v[56:57], v[44:45], v[90:91] neg_lo:[0,0,1] neg_hi:[0,0,1]
    v_cvt_pk_f16_f32 v94, v52, v54
    v_cvt_pk_f16_f32 v95, v53, v55
    ds_write_b64 v4, v[94:95] offset:1088
    v_pk_mul_f32 v[90:91], v[54:55], v[46:47]
    v_pk_mul_f32 v[92:93], v[54:55], v[44:45]
    v_pk_fma_f32 v[58:59], v[52:53], v[46:47], v[92:93]
    v_pk_fma_f32 v[56:57], v[52:53], v[44:45], v[90:91] neg_lo:[0,0,1] neg_hi:[0,0,1]
    v_cvt_pk_f16_f32 v94, v56, v58
    v_cvt_pk_f16_f32 v95, v57, v59
    ds_write_b64 v4, v[94:95] offset:1632
    v_pk_mul_f32 v[90:91], v[58:59], v[46:47]
    v_pk_mul_f32 v[92:93], v[58:59], v[44:45]
    v_pk_fma_f32 v[54:55], v[56:57], v[46:47], v[92:93]
    v_pk_fma_f32 v[52:53], v[56:57], v[44:45], v[90:91] neg_lo:[0,0,1] neg_hi:[0,0,1]
    v_cvt_pk_f16_f32 v94, v52, v54
    v_cvt_pk_f16_f32 v95, v53, v55
    ds_write_b64 v4, v[94:95] offset:2176
    v_pk_mul_f32 v[90:91], v[54:55], v[46:47]
    v_pk_mul_f32 v[92:93], v[54:55], v[44:45]
    v_pk_fma_f32 v[58:59], v[52:53], v[46:47], v[92:93]
    v_pk_fma_f32 v[56:57], v[52:53], v[44:45], v[90:91] neg_lo:[0,0,1] neg_hi:[0,0,1]
    v_cvt_pk_f16_f32 v94, v56, v58
    v_cvt_pk_f16_f32 v95, v57, v59
    ds_write_b64 v4, v[94:95] offset:2720
    v_pk_mul_f32 v[90:91], v[58:59], v[46:47]
    v_pk_mul_f32 v[92:93], v[58:59], v[44:45]
    v_pk_fma_f32 v[54:55], v[56:57], v[46:47], v[92:93]
    v_pk_fma_f32 v[52:53], v[56:57], v[44:45], v[90:91] neg_lo:[0,0,1] neg_hi:[0,0,1]
    v_cvt_pk_f16_f32 v94, v52, v54
    v_cvt_pk_f16_f32 v95, v53, v55
    ds_write_b64 v4, v[94:95] offset:3264
    v_pk_mul_f32 v[90:91], v[54:55], v[46:47]
    v_pk_mul_f32 v[92:93], v[54:55], v[44:45]
    v_pk_fma_f32 v[58:59], v[52:53], v[46:47], v[92:93]
    v_pk_fma_f32 v[56:57], v[52:53], v[44:45], v[90:91] neg_lo:[0,0,1] neg_hi:[0,0,1]
    v_cvt_pk_f16_f32 v94, v56, v58
    v_cvt_pk_f16_f32 v95, v57, v59
    ds_write_b64 v4, v[94:95] offset:3808
    v_pk_mul_f32 v[90:91], v[58:59], v[46:47]
    v_pk_mul_f32 v[92:93], v[58:59], v[44:45]
    v_pk_fma_f32 v[54:55], v[56:57], v[46:47], v[92:93]
    v_pk_fma_f32 v[52:53], v[56:57], v[44:45], v[90:91] neg_lo:[0,0,1] neg_hi:[0,0,1]
    v_cvt_pk_f16_f32 v94, v52, v54
    v_cvt_pk_f16_f32 v95, v53, v55
    ds_write_b64 v4, v[94:95] offset:4352
    v_lshl_add_u32 v7, v6, 9, v7
    v_add_u32 v7, 0x400, v7
    v_mov_b32 v8, 0x80
    v_mov_b32 v9, 0x100
    s_branch K1_JOIN
K1_J3:
    v_mul_f32 v90, 0x41000000, v20
    v_mul_f32 v91, 0x41000000, v22
    v_exp_f32 v90, v90
    v_mul_f32 v92, s32, v91
    v_rndne_f32 v92, v92
    v_fma_f32 v92, v91, s32, -v92
    v_fma_f32 v92, v91, s33, v92
    v_cos_f32 v91, v92
    v_sin_f32 v92, v92
    v_mul_f32 v40, v90, v91
    v_mul_f32 v42, v90, -v92
    v_mul_f32 v90, 0x41000000, v21
    v_mul_f32 v91, 0x41000000, v23
    v_exp_f32 v90, v90
    v_mul_f32 v92, s32, v91
    v_rndne_f32 v92, v92
    v_fma_f32 v92, v91, s32, -v92
    v_fma_f32 v92, v91, s33, v92
    v_cos_f32 v91, v92
    v_sin_f32 v92, v92
    v_mul_f32 v41, v90, v91
    v_mul_f32 v43, v90, -v92
    v_mov_b32 v52, 0x47000000
    v_mov_b32 v53, 0x47000000
    v_mov_b32 v54, 0
    v_mov_b32 v55, 0
    v_cvt_pk_f16_f32 v94, v52, v54
    v_cvt_pk_f16_f32 v95, v53, v55
    ds_write_b64 v4, v[94:95] offset:0
    v_pk_mul_f32 v[90:91], v[54:55], v[42:43]
    v_pk_mul_f32 v[92:93], v[54:55], v[40:41]
    v_pk_fma_f32 v[58:59], v[52:53], v[42:43], v[92:93]
    v_pk_fma_f32 v[56:57], v[52:53], v[40:41], v[90:91] neg_lo:[0,0,1] neg_hi:[0,0,1]
    v_cvt_pk_f16_f32 v94, v56, v58
    v_cvt_pk_f16_f32 v95, v57, v59
    ds_write_b64 v4, v[94:95] offset:544
    v_pk_mul_f32 v[90:91], v[58:59], v[42:43]
    v_pk_mul_f32 v[92:93], v[58:59], v[40:41]
    v_pk_fma_f32 v[54:55], v[56:57], v[42:43], v[92:93]
    v_pk_fma_f32 v[52:53], v[56:57], v[40:41], v[90:91] neg_lo:[0,0,1] neg_hi:[0,0,1]
    v_cvt_pk_f16_f32 v94, v52, v54
    v_cvt_pk_f16_f32 v95, v53, v55
    ds_write_b64 v4, v[94:95] offset:1088
    v_pk_mul_f32 v[90:91], v[54:55], v[42:43]
    v_pk_mul_f32 v[92:93], v[54:55], v[40:41]
    v_pk_fma_f32 v[58:59], v[52:53], v[42:43], v[92:93]
    v_pk_fma_f32 v[56:57], v[52:53], v[40:41], v[90:91] neg_lo:[0,0,1] neg_hi:[0,0,1]
    v_cvt_pk_f16_f32 v94, v56, v58
    v_cvt_pk_f16_f32 v95, v57, v59
    ds_write_b64 v4, v[94:95] offset:1632
    v_pk_mul_f32 v[90:91], v[58:59], v[42:43]
    v_pk_mul_f32 v[92:93], v[58:59], v[40:41]
    v_pk_fma_f32 v[54:55], v[56:57], v[42:43], v[92:93]
    v_pk_fma_f32 v[52:53], v[56:57], v[40:41], v[90:91] neg_lo:[0,0,1] neg_hi:[0,0,1]
    v_cvt_pk_f16_f32 v94, v52, v54
    v_cvt_pk_f16_f32 v95, v53, v55
    ds_write_b64 v4, v[94:95] offset:2176
    v_pk_mul_f32 v[90:91], v[54:55], v[42:43]
    v_pk_mul_f32 v[92:93], v[54:55], v[40:41]
    v_pk_fma_f32 v[58:59], v[52:53], v[42:43], v[92:93]
    v_pk_fma_f32 v[56:57], v[52:53], v[40:41], v[90:91] neg_lo:[0,0,1] neg_hi:[0,0,1]
    v_cvt_pk_f16_f32 v94, v56, v58
    v_cvt_pk_f16_f32 v95, v57, v59
    ds_write_b64 v4, v[94:95] offset:2720
    v_pk_mul_f32 v[90:91], v[58:59], v[42:43]
    v_pk_mul_f32 v[92:93], v[58:59], v[40:41]
    v_pk_fma_f32 v[54:55], v[56:57], v[42:43], v[92:93]
    v_pk_fma_f32 v[52:53], v[56:57], v[40:41], v[90:91] neg_lo:[0,0,1] neg_hi:[0,0,1]
    v_cvt_pk_f16_f32 v94, v52, v54
    v_cvt_pk_f16_f32 v95, v53, v55
    ds_write_b64 v4, v[94:95] offset:3264
    v_pk_mul_f32 v[90:91], v[54:55], v[42:43]
    v_pk_mul_f32 v[92:93], v[54:55], v[40:41]
    v_pk_fma_f32 v[58:59], v[52:53], v[42:43], v[92:93]
    v_pk_fma_f32 v[56:57], v[52:53], v[40:41], v[90:91] neg_lo:[0,0,1] neg_hi:[0,0,1]
    v_cvt_pk_f16_f32 v94, v56, v58
    v_cvt_pk_f16_f32 v95, v57, v59
    ds_write_b64 v4, v[94:95] offset:3808
    v_pk_mul_f32 v[90:91], v[58:59], v[42:43]
    v_pk_mul_f32 v[92:93], v[58:59], v[40:41]
    v_pk_fma_f32 v[54:55], v[56:57], v[42:43], v[92:93]
    v_pk_fma_f32 v[52:53], v[56:57], v[40:41], v[90:91] neg_lo:[0,0,1] neg_hi:[0,0,1]
    v_cvt_pk_f16_f32 v94, v52, v54
    v_cvt_pk_f16_f32 v95, v53, v55
    ds_write_b64 v4, v[94:95] offset:4352
    v_pk_mul_f32 v[90:91], v[54:55], v[42:43]
    v_pk_mul_f32 v[92:93], v[54:55], v[40:41]
    v_pk_fma_f32 v[58:59], v[52:53], v[42:43], v[92:93]
    v_pk_fma_f32 v[56:57], v[52:53], v[40:41], v[90:91] neg_lo:[0,0,1] neg_hi:[0,0,1]
    v_cvt_pk_f16_f32 v94, v56, v58
    v_cvt_pk_f16_f32 v95, v57, v59
    ds_write_b64 v4, v[94:95] offset:4896
    v_pk_mul_f32 v[90:91], v[58:59], v[42:43]
    v_pk_mul_f32 v[92:93], v[58:59], v[40:41]
    v_pk_fma_f32 v[54:55], v[56:57], v[42:43], v[92:93]
    v_pk_fma_f32 v[52:53], v[56:57], v[40:41], v[90:91] neg_lo:[0,0,1] neg_hi:[0,0,1]
    v_cvt_pk_f16_f32 v94, v52, v54
    v_cvt_pk_f16_f32 v95, v53, v55
    ds_write_b64 v4, v[94:95] offset:5440
    v_pk_mul_f32 v[90:91], v[54:55], v[42:43]
    v_pk_mul_f32 v[92:93], v[54:55], v[40:41]
    v_pk_fma_f32 v[58:59], v[52:53], v[42:43], v[92:93]
    v_pk_fma_f32 v[56:57], v[52:53], v[40:41], v[90:91] neg_lo:[0,0,1] neg_hi:[0,0,1]
    v_cvt_pk_f16_f32 v94, v56, v58
    v_cvt_pk_f16_f32 v95, v57, v59
    ds_write_b64 v4, v[94:95] offset:5984
    v_pk_mul_f32 v[90:91], v[58:59], v[42:43]
    v_pk_mul_f32 v[92:93], v[58:59], v[40:41]
    v_pk_fma_f32 v[54:55], v[56:57], v[42:43], v[92:93]
    v_pk_fma_f32 v[52:53], v[56:57], v[40:41], v[90:91] neg_lo:[0,0,1] neg_hi:[0,0,1]
    v_cvt_pk_f16_f32 v94, v52, v54
    v_cvt_pk_f16_f32 v95, v53, v55
    ds_write_b64 v4, v[94:95] offset:6528
    v_pk_mul_f32 v[90:91], v[54:55], v[42:43]
    v_pk_mul_f32 v[92:93], v[54:55], v[40:41]
    v_pk_fma_f32 v[58:59], v[52:53], v[42:43], v[92:93]
    v_pk_fma_f32 v[56:57], v[52:53], v[40:41], v[90:91] neg_lo:[0,0,1] neg_hi:[0,0,1]
    v_cvt_pk_f16_f32 v94, v56, v58
    v_cvt_pk_f16_f32 v95, v57, v59
    ds_write_b64 v4, v[94:95] offset:7072
    v_pk_mul_f32 v[90:91], v[58:59], v[42:43]
    v_pk_mul_f32 v[92:93], v[58:59], v[40:41]
    v_pk_fma_f32 v[54:55], v[56:57], v[42:43], v[92:93]
    v_pk_fma_f32 v[52:53], v[56:57], v[40:41], v[90:91] neg_lo:[0,0,1] neg_hi:[0,0,1]
    v_cvt_pk_f16_f32 v94, v52, v54
    v_cvt_pk_f16_f32 v95, v53, v55
    ds_write_b64 v4, v[94:95] offset:7616
    v_pk_mul_f32 v[90:91], v[54:55], v[42:43]
    v_pk_mul_f32 v[92:93], v[54:55], v[40:41]
    v_pk_fma_f32 v[58:59], v[52:53], v[42:43], v[92:93]
    v_pk_fma_f32 v[56:57], v[52:53], v[40:41], v[90:91] neg_lo:[0,0,1] neg_hi:[0,0,1]
    v_cvt_pk_f16_f32 v94, v56, v58
    v_cvt_pk_f16_f32 v95, v57, v59
    ds_write_b64 v4, v[94:95] offset:8160
    v_mul_f32 v40, 0x45000000, v36
    v_max_f32 v40, 0, v40
    v_exp_f32 v40, v40
    v_mul_f32 v41, 0x38000000, v37
    v_mul_f32 v40, v40, v41
    s_lshl_b32 s4, s3, 2
    v_mov_b32 v41, s4
    s_mul_i32 s4, s3, 4112
    s_add_u32 s4, s4, 4096
    v_mov_b32 v42, s4
    v_mov_b32 v44, 0
    v_mov_b32 v45, 0
    v_mov_b32 v46, 0
    v_mov_b32 v47, 0
    s_mov_b64 s[34:35], exec
    s_mov_b64 exec, 1
    buffer_store_dword v40, v41, s[12:15], 0 offen
    buffer_store_dwordx4 v[44:47], v42, s[8:11], 0 offen
    s_mov_b64 exec, s[34:35]
K1_JOIN:
    s_nop 3
    s_waitcnt lgkmcnt(0)
    s_barrier
    s_cmp_eq_u32 s5, 3
    s_cbranch_scc1 K1_EXPAND
    v_mul_u32_u24 v10, 544, v5
    v_lshl_add_u32 v10, v6, 4, v10
    s_mul_i32 s4, s5, 8704
    v_add_u32 v11, s4, v10
    ds_read_b128 v[40:43], v11 offset:0
    ds_read_b128 v[72:75], v10 offset:26112
    ds_read_b128 v[44:47], v11 offset:64
    ds_read_b128 v[76:79], v10 offset:26176
    ds_read_b128 v[48:51], v11 offset:128
    ds_read_b128 v[80:83], v10 offset:26240
    ds_read_b128 v[52:55], v11 offset:192
    ds_read_b128 v[84:87], v10 offset:26304
    ds_read_b128 v[56:59], v11 offset:256
    ds_read_b128 v[60:63], v11 offset:320
    ds_read_b128 v[64:67], v11 offset:384
    ds_read_b128 v[68:71], v11 offset:448
    v_mov_b32 v12, 0
    v_mov_b32 v13, 0
    v_mov_b32 v14, 0
    v_mov_b32 v15, 0
    ds_read_b128 v[20:23], v10 offset:26368
    ds_read_b128 v[24:27], v10 offset:26432
    ds_read_b128 v[28:31], v10 offset:26496
    ds_read_b128 v[32:35], v10 offset:26560
    s_waitcnt lgkmcnt(0)
    v_mfma_f32_16x16x32_f16 v[12:15], v[40:43], v[72:75], v[12:15]
    v_mfma_f32_16x16x32_f16 v[12:15], v[44:47], v[76:79], v[12:15]
    v_mfma_f32_16x16x32_f16 v[12:15], v[48:51], v[80:83], v[12:15]
    v_mfma_f32_16x16x32_f16 v[12:15], v[52:55], v[84:87], v[12:15]
    v_mfma_f32_16x16x32_f16 v[12:15], v[56:59], v[20:23], v[12:15]
    v_mfma_f32_16x16x32_f16 v[12:15], v[60:63], v[24:27], v[12:15]
    v_mfma_f32_16x16x32_f16 v[12:15], v[64:67], v[28:31], v[12:15]
    v_mfma_f32_16x16x32_f16 v[12:15], v[68:71], v[32:35], v[12:15]
    v_mul_f32 v40, 0x45000000, v36
    v_max_f32 v40, 0, v40
    v_add_f32 v40, 0x41700000, v40
    v_mov_b32 v41, v7
    v_add_u32 v42, v7, v8
    v_add_u32 v43, v7, v9
    v_add_u32 v44, v42, v9
    v_cvt_f32_u32 v45, v41
    v_fma_f32 v46, v45, v36, -v40
    v_exp_f32 v46, v46
    v_lshrrev_b32 v45, 16, v45
    v_subrev_u32 v45, 0x4280, v45
    v_cmp_gt_u32 vcc, 128, v41
    s_nop 1
    v_cndmask_b32 v45, v45, v41, vcc
    v_cmp_lt_u32 vcc, 0x800, v41
    v_mov_b32 v47, 0x2f0
    s_nop 0
    v_cndmask_b32 v45, v45, v47, vcc
    v_mul_f32 v46, v46, v12
    v_cvt_f16_f32 v46, v46
    v_lshlrev_b32 v45, 1, v45
    ds_write_b16 v45, v46 offset:34816
    v_cvt_f32_u32 v45, v42
    v_fma_f32 v46, v45, v36, -v40
    v_exp_f32 v46, v46
    v_lshrrev_b32 v45, 16, v45
    v_subrev_u32 v45, 0x4280, v45
    v_cmp_gt_u32 vcc, 128, v42
    s_nop 1
    v_cndmask_b32 v45, v45, v42, vcc
    v_cmp_lt_u32 vcc, 0x800, v42
    v_mov_b32 v47, 0x2f0
    s_nop 0
    v_cndmask_b32 v45, v45, v47, vcc
    v_mul_f32 v46, v46, v13
    v_cvt_f16_f32 v46, v46
    v_lshlrev_b32 v45, 1, v45
    ds_write_b16 v45, v46 offset:34816
    v_cvt_f32_u32 v45, v43
    v_fma_f32 v46, v45, v36, -v40
    v_exp_f32 v46, v46
    v_lshrrev_b32 v45, 16, v45
    v_subrev_u32 v45, 0x4280, v45
    v_cmp_gt_u32 vcc, 128, v43
    s_nop 1
    v_cndmask_b32 v45, v45, v43, vcc
    v_cmp_lt_u32 vcc, 0x800, v43
    v_mov_b32 v47, 0x2f0
    s_nop 0
    v_cndmask_b32 v45, v45, v47, vcc
    v_mul_f32 v46, v46, v14
    v_cvt_f16_f32 v46, v46
    v_lshlrev_b32 v45, 1, v45
    ds_write_b16 v45, v46 offset:34816
    v_cvt_f32_u32 v45, v44
    v_fma_f32 v46, v45, v36, -v40
    v_exp_f32 v46, v46
    v_lshrrev_b32 v45, 16, v45
    v_subrev_u32 v45, 0x4280, v45
    v_cmp_gt_u32 vcc, 128, v44
    s_nop 1
    v_cndmask_b32 v45, v45, v44, vcc
    v_cmp_lt_u32 vcc, 0x800, v44
    v_mov_b32 v47, 0x2f0
    s_nop 0
    v_cndmask_b32 v45, v45, v47, vcc
    v_mul_f32 v46, v46, v15
    v_cvt_f16_f32 v46, v46
    v_lshlrev_b32 v45, 1, v45
    ds_write_b16 v45, v46 offset:34816
K1_EXPAND:
    s_nop 3
    s_waitcnt lgkmcnt(0)
    s_barrier
    ds_read_u16 v48, v100 offset:34816
    ds_read_u16 v49, v101 offset:34816
    ds_read_u16 v50, v102 offset:34816
    ds_read_u16 v51, v103 offset:34816
    ds_read_u16 v52, v104 offset:34816
    ds_read_u16 v53, v105 offset:34816
    ds_read_u16 v54, v106 offset:34816
    ds_read_u16 v55, v107 offset:34816
    s_mul_i32 s4, s3, 4112
    v_lshlrev_b32 v44, 4, v0
    s_waitcnt lgkmcnt(0)
    v_lshl_or_b32 v40, v49, 16, v48
    v_lshl_or_b32 v41, v51, 16, v50
    v_lshl_or_b32 v42, v53, 16, v52
    v_lshl_or_b32 v43, v55, 16, v54
    buffer_store_dwordx4 v[40:43], v44, s[8:11], s4 offen
K1_END:
    s_endpgm
.globl k2_kernel
.p2align 8
.type k2_kernel,@function
k2_kernel:
    s_cmp_ge_u32 s2, 576
    s_cbranch_scc1 K2_END
    s_load_dwordx2 s[6:7], s[0:1], 128
    s_load_dwordx2 s[4:5], s[0:1], 64
    s_load_dwordx4 s[32:35], s[0:1], 88
    s_load_dwordx2 s[36:37], s[0:1], 104
    s_and_b32 s16, s2, 7
    s_mul_i32 s16, s16, 72
    s_lshr_b32 s3, s2, 3
    s_add_u32 s3, s3, s16
    v_readfirstlane_b32 s17, v0
    s_lshr_b32 s17, s17, 6
    v_lshlrev_b32 v2, 4, v0
    s_lshl_b32 s18, s3, 12
    s_mul_i32 s19, s3, 4112
    s_waitcnt lgkmcnt(0)
    s_mov_b32 s8, s6
    s_mov_b32 s9, s7
    s_mov_b32 s10, 0x240000
    s_mov_b32 s11, 0x20000
    s_add_u32 s12, s6, 0x300000
    s_addc_u32 s13, s7, 0
    s_mov_b32 s14, 0x242400
    s_mov_b32 s15, 0x20000
    buffer_load_dwordx4 v[4:7], v2, s[12:15], s19 offen
    buffer_load_dwordx2 v[8:9], v2, s[12:15], s19 offen offset:16
    buffer_load_dwordx4 v[12:15], v2, s[8:11], s18 offen
    s_lshl_b32 s20, s3, 2
    s_add_u32 s20, s20, 0xc10000
    s_add_u32 s20, s6, s20
    s_addc_u32 s21, s7, 0
    s_load_dword s24, s[20:21], 0
    s_lshr_b32 s20, s3, 1
    s_lshl_b32 s20, s20, 2
    s_add_u32 s20, s4, s20
    s_addc_u32 s21, s5, 0
    s_load_dword s25, s[20:21], 0
    s_add_u32 s28, s6, 0x600000
    s_addc_u32 s29, s7, 0
    s_mov_b32 s30, 0x240000
    s_mov_b32 s31, 0x20000
    v_mov_b32 v16, 0
    v_mov_b32 v17, 0
    v_mov_b32 v18, 0
    v_mov_b32 v19, 0
    v_lshrrev_b32 v3, 5, v0
    v_and_b32 v10, 31, v0
    v_mul_u32_u24 v11, 4640, v3
    v_lshl_add_u32 v11, v10, 4, v11
    v_add_u32 v11, 4096, v11
    v_cmp_gt_u32 vcc, 4, v3
    v_cmp_gt_u32 s[22:23], 24, v10
    s_and_b64 vcc, vcc, s[22:23]
    s_and_saveexec_b64 s[22:23], vcc
    ds_write_b128 v11, v[16:19]
    s_mov_b64 exec, s[22:23]
    v_cmp_gt_u32 vcc, 8, v0
    s_and_saveexec_b64 s[22:23], vcc
    ds_write_b128 v2, v[16:19] offset:18560
    s_mov_b64 exec, s[22:23]
    v_and_b32 v3, 63, v0
    v_and_b32 v10, 15, v3
    v_lshrrev_b32 v11, 4, v3
    v_and_b32 v16, 3, v10
    v_mul_u32_u24 v16, 4640, v16
    v_lshrrev_b32 v17, 2, v10
    v_lshlrev_b32 v17, 7, v17
    v_sub_u32 v16, v16, v17
    v_lshl_add_u32 v16, v11, 4, v16
    s_lshl_b32 s20, s17, 7
    s_sub_u32 s20, 384, s20
    s_add_u32 s21, s20, 384
    v_add_u32 v16, s21, v16
    v_lshlrev_b32 v17, 3, v10
    v_lshl_add_u32 v17, v11, 4, v17
    s_add_u32 s21, s20, 18568
    v_add_u32 v17, s21, v17
    s_waitcnt vmcnt(1)
    v_alignbit_b32 v20, v5, v4, 16
    v_alignbit_b32 v21, v6, v5, 16
    v_alignbit_b32 v22, v7, v6, 16
    v_alignbit_b32 v23, v8, v7, 16
    v_alignbit_b32 v24, v9, v8, 16
    ds_write_b128 v2, v[4:7] offset:13920
    ds_write_b128 v2, v[20:23] offset:9280
    v_mov_b32 v26, v5
    v_mov_b32 v27, v6
    v_mov_b32 v28, v7
    v_mov_b32 v29, v8
    v_mov_b32 v30, v21
    v_mov_b32 v31, v22
    v_mov_b32 v32, v23
    v_mov_b32 v33, v24
    ds_write_b128 v2, v[26:29] offset:4640
    ds_write_b128 v2, v[30:33] offset:0
    s_waitcnt vmcnt(0)
    ds_write_b128 v2, v[12:15] offset:18688
    v_mul_u32_u24 v4, 3641, v0
    v_lshrrev_b32 v4, 16, v4
    v_mul_u32_u24 v5, 18, v4
    v_sub_u32 v5, v0, v5
    v_mul_u32_u24 v4, 9216, v4
    v_lshl_add_u32 v4, v5, 6, v4
    s_and_b32 s20, s2, 7
    s_lshr_b32 s21, s2, 3
    s_mul_i32 s22, s21, 73728
    s_mul_i32 s23, s20, 1152
    s_add_u32 s22, s22, s23
    v_add_u32 v4, s22, v4
    s_mul_i32 s22, s20, 663552
    s_mul_i32 s23, s21, 9216
    s_add_u32 s22, s22, s23
    v_lshl_add_u32 v5, v0, 6, s22
    v_cmp_gt_u32 vcc, 144, v0
    s_and_saveexec_b64 s[22:23], vcc
    s_cbranch_execz K2_NOPF
    global_load_dword v148, v4, s[32:33]
    global_load_dword v149, v4, s[34:35]
    global_load_dword v150, v5, s[36:37]
K2_NOPF:
    s_mov_b64 exec, s[22:23]
    s_waitcnt lgkmcnt(0)
    s_barrier
    v_mov_b32 v20, 0
    v_mov_b32 v21, 0
    v_mov_b32 v22, 0
    v_mov_b32 v23, 0
    v_mov_b32 v24, 0
    v_mov_b32 v25, 0
    v_mov_b32 v26, 0
    v_mov_b32 v27, 0
    v_mov_b32 v28, 0
    v_mov_b32 v29, 0
    v_mov_b32 v30, 0
    v_mov_b32 v31, 0
    v_mov_b32 v32, 0
    v_mov_b32 v33, 0
    v_mov_b32 v34, 0
    v_mov_b32 v35, 0
    v_mov_b32 v36, 0
    v_mov_b32 v37, 0
    v_mov_b32 v38, 0
    v_mov_b32 v39, 0
    v_mov_b32 v40, 0
    v_mov_b32 v41, 0
    v_mov_b32 v42, 0
    v_mov_b32 v43, 0
    v_mov_b32 v44, 0
    v_mov_b32 v45, 0
    v_mov_b32 v46, 0
    v_mov_b32 v47, 0
    v_mov_b32 v48, 0
    v_mov_b32 v49, 0
    v_mov_b32 v50, 0
    v_mov_b32 v51, 0
    ds_read_b128 v[80:83], v16 offset:64
    ds_read_b64 v[84:85], v17 offset:64
    ds_read_b64 v[86:87], v17 offset:72
    ds_read_b128 v[76:79], v16 offset:576
    ds_read_b64 v[88:89], v17 offset:576
    ds_read_b64 v[90:91], v17 offset:584
    ds_read_b128 v[72:75], v16 offset:1088
    ds_read_b64 v[92:93], v17 offset:1088
    ds_read_b64 v[94:95], v17 offset:1096
    ds_read_b128 v[68:71], v16 offset:1600
    ds_read_b64 v[96:97], v17 offset:1600
    ds_read_b64 v[98:99], v17 offset:1608
    s_waitcnt lgkmcnt(9)
    v_mfma_f32_16x16x32_f16 v[48:51], v[80:83], v[84:87], v[48:51]
    ds_read_b128 v[64:67], v16 offset:2112
    ds_read_b64 v[100:101], v17 offset:2112
    ds_read_b64 v[102:103], v17 offset:2120
    s_waitcnt lgkmcnt(9)
    v_mfma_f32_16x16x32_f16 v[44:47], v[76:79], v[84:87], v[44:47]
    ds_read_b128 v[60:63], v16 offset:2624
    ds_read_b64 v[104:105], v17 offset:2624
    ds_read_b64 v[106:107], v17 offset:2632
    v_mfma_f32_16x16x32_f16 v[48:51], v[76:79], v[88:91], v[48:51]
    s_waitcnt lgkmcnt(9)
    v_mfma_f32_16x16x32_f16 v[40:43], v[72:75], v[84:87], v[40:43]
    ds_read_b128 v[56:59], v16 offset:3136
    ds_read_b64 v[108:109], v17 offset:3136
    ds_read_b64 v[110:111], v17 offset:3144
    v_mfma_f32_16x16x32_f16 v[44:47], v[72:75], v[88:91], v[44:47]
    v_mfma_f32_16x16x32_f16 v[48:51], v[72:75], v[92:95], v[48:51]
    s_waitcnt lgkmcnt(9)
    v_mfma_f32_16x16x32_f16 v[36:39], v[68:71], v[84:87], v[36:39]
    ds_read_b128 v[52:55], v16 offset:3648
    ds_read_b64 v[112:113], v17 offset:3648
    ds_read_b64 v[114:115], v17 offset:3656
    v_mfma_f32_16x16x32_f16 v[40:43], v[68:71], v[88:91], v[40:43]
    v_mfma_f32_16x16x32_f16 v[44:47], v[68:71], v[92:95], v[44:47]
    v_mfma_f32_16x16x32_f16 v[48:51], v[68:71], v[96:99], v[48:51]
    s_waitcnt lgkmcnt(9)
    v_mfma_f32_16x16x32_f16 v[32:35], v[64:67], v[84:87], v[32:35]
    ds_read_b128 v[80:83], v16 offset:0
    ds_read_b64 v[116:117], v17 offset:0
    ds_read_b64 v[118:119], v17 offset:8
    v_mfma_f32_16x16x32_f16 v[36:39], v[64:67], v[88:91], v[36:39]
    v_mfma_f32_16x16x32_f16 v[40:43], v[64:67], v[92:95], v[40:43]
    v_mfma_f32_16x16x32_f16 v[44:47], v[64:67], v[96:99], v[44:47]
    v_mfma_f32_16x16x32_f16 v[48:51], v[64:67], v[100:103], v[48:51]
    s_waitcnt lgkmcnt(9)
    v_mfma_f32_16x16x32_f16 v[28:31], v[60:63], v[84:87], v[28:31]
    ds_read_b128 v[76:79], v16 offset:512
    ds_read_b64 v[120:121], v17 offset:512
    ds_read_b64 v[122:123], v17 offset:520
    v_mfma_f32_16x16x32_f16 v[32:35], v[60:63], v[88:91], v[32:35]
    v_mfma_f32_16x16x32_f16 v[36:39], v[60:63], v[92:95], v[36:39]
    v_mfma_f32_16x16x32_f16 v[40:43], v[60:63], v[96:99], v[40:43]
    v_mfma_f32_16x16x32_f16 v[44:47], v[60:63], v[100:103], v[44:47]
    v_mfma_f32_16x16x32_f16 v[48:51], v[60:63], v[104:107], v[48:51]
    s_waitcnt lgkmcnt(9)
    v_mfma_f32_16x16x32_f16 v[24:27], v[56:59], v[84:87], v[24:27]
    ds_read_b128 v[72:75], v16 offset:1024
    ds_read_b64 v[124:125], v17 offset:1024
    ds_read_b64 v[126:127], v17 offset:1032
    v_mfma_f32_16x16x32_f16 v[28:31], v[56:59], v[88:91], v[28:31]
    v_mfma_f32_16x16x32_f16 v[32:35], v[56:59], v[92:95], v[32:35]
    v_mfma_f32_16x16x32_f16 v[36:39], v[56:59], v[96:99], v[36:39]
    v_mfma_f32_16x16x32_f16 v[40:43], v[56:59], v[100:103], v[40:43]
    v_mfma_f32_16x16x32_f16 v[44:47], v[56:59], v[104:107], v[44:47]
    v_mfma_f32_16x16x32_f16 v[48:51], v[56:59], v[108:111], v[48:51]
    s_waitcnt lgkmcnt(9)
    v_mfma_f32_16x16x32_f16 v[20:23], v[52:55], v[84:87], v[20:23]
    ds_read_b128 v[68:71], v16 offset:1536
    ds_read_b64 v[128:129], v17 offset:1536
    ds_read_b64 v[130:131], v17 offset:1544
    v_mfma_f32_16x16x32_f16 v[24:27], v[52:55], v[88:91], v[24:27]
    v_mfma_f32_16x16x32_f16 v[28:31], v[52:55], v[92:95], v[28:31]
    v_mfma_f32_16x16x32_f16 v[32:35], v[52:55], v[96:99], v[32:35]
    v_mfma_f32_16x16x32_f16 v[36:39], v[52:55], v[100:103], v[36:39]
    v_mfma_f32_16x16x32_f16 v[40:43], v[52:55], v[104:107], v[40:43]
    v_mfma_f32_16x16x32_f16 v[44:47], v[52:55], v[108:111], v[44:47]
    v_mfma_f32_16x16x32_f16 v[48:51], v[52:55], v[112:115], v[48:51]
    s_waitcnt lgkmcnt(9)
    v_mfma_f32_16x16x32_f16 v[48:51], v[80:83], v[116:119], v[48:51]
    ds_read_b128 v[64:67], v16 offset:2048
    ds_read_b64 v[132:133], v17 offset:2048
    ds_read_b64 v[134:135], v17 offset:2056
    s_waitcnt lgkmcnt(9)
    v_mfma_f32_16x16x32_f16 v[44:47], v[76:79], v[116:119], v[44:47]
    ds_read_b128 v[60:63], v16 offset:2560
    ds_read_b64 v[136:137], v17 offset:2560
    ds_read_b64 v[138:139], v17 offset:2568
    v_mfma_f32_16x16x32_f16 v[48:51], v[76:79], v[120:123], v[48:51]
    s_waitcnt lgkmcnt(9)
    v_mfma_f32_16x16x32_f16 v[40:43], v[72:75], v[116:119], v[40:43]
    ds_read_b128 v[56:59], v16 offset:3072
    ds_read_b64 v[140:141], v17 offset:3072
    ds_read_b64 v[142:143], v17 offset:3080
    v_mfma_f32_16x16x32_f16 v[44:47], v[72:75], v[120:123], v[44:47]
    v_mfma_f32_16x16x32_f16 v[48:51], v[72:75], v[124:127], v[48:51]
    s_waitcnt lgkmcnt(9)
    v_mfma_f32_16x16x32_f16 v[36:39], v[68:71], v[116:119], v[36:39]
    ds_read_b128 v[52:55], v16 offset:3584
    ds_read_b64 v[144:145], v17 offset:3584
    ds_read_b64 v[146:147], v17 offset:3592
    v_mfma_f32_16x16x32_f16 v[40:43], v[68:71], v[120:123], v[40:43]
    v_mfma_f32_16x16x32_f16 v[44:47], v[68:71], v[124:127], v[44:47]
    v_mfma_f32_16x16x32_f16 v[48:51], v[68:71], v[128:131], v[48:51]
    s_waitcnt lgkmcnt(9)
    v_mfma_f32_16x16x32_f16 v[32:35], v[64:67], v[116:119], v[32:35]
    v_mfma_f32_16x16x32_f16 v[36:39], v[64:67], v[120:123], v[36:39]
    v_mfma_f32_16x16x32_f16 v[40:43], v[64:67], v[124:127], v[40:43]
    v_mfma_f32_16x16x32_f16 v[44:47], v[64:67], v[128:131], v[44:47]
    v_mfma_f32_16x16x32_f16 v[48:51], v[64:67], v[132:135], v[48:51]
    s_waitcnt lgkmcnt(6)
    v_mfma_f32_16x16x32_f16 v[28:31], v[60:63], v[116:119], v[28:31]
    v_mfma_f32_16x16x32_f16 v[32:35], v[60:63], v[120:123], v[32:35]
    v_mfma_f32_16x16x32_f16 v[36:39], v[60:63], v[124:127], v[36:39]
    v_mfma_f32_16x16x32_f16 v[40:43], v[60:63], v[128:131], v[40:43]
    v_mfma_f32_16x16x32_f16 v[44:47], v[60:63], v[132:135], v[44:47]
    v_mfma_f32_16x16x32_f16 v[48:51], v[60:63], v[136:139], v[48:51]
    s_waitcnt lgkmcnt(3)
    v_mfma_f32_16x16x32_f16 v[24:27], v[56:59], v[116:119], v[24:27]
    v_mfma_f32_16x16x32_f16 v[28:31], v[56:59], v[120:123], v[28:31]
    v_mfma_f32_16x16x32_f16 v[32:35], v[56:59], v[124:127], v[32:35]
    v_mfma_f32_16x16x32_f16 v[36:39], v[56:59], v[128:131], v[36:39]
    v_mfma_f32_16x16x32_f16 v[40:43], v[56:59], v[132:135], v[40:43]
    v_mfma_f32_16x16x32_f16 v[44:47], v[56:59], v[136:139], v[44:47]
    v_mfma_f32_16x16x32_f16 v[48:51], v[56:59], v[140:143], v[48:51]
    s_waitcnt lgkmcnt(0)
    v_mfma_f32_16x16x32_f16 v[20:23], v[52:55], v[116:119], v[20:23]
    v_mfma_f32_16x16x32_f16 v[24:27], v[52:55], v[120:123], v[24:27]
    v_mfma_f32_16x16x32_f16 v[28:31], v[52:55], v[124:127], v[28:31]
    v_mfma_f32_16x16x32_f16 v[32:35], v[52:55], v[128:131], v[32:35]
    v_mfma_f32_16x16x32_f16 v[36:39], v[52:55], v[132:135], v[36:39]
    v_mfma_f32_16x16x32_f16 v[40:43], v[52:55], v[136:139], v[40:43]
    v_mfma_f32_16x16x32_f16 v[44:47], v[52:55], v[140:143], v[44:47]
    v_mfma_f32_16x16x32_f16 v[48:51], v[52:55], v[144:147], v[48:51]
    v_lshlrev_b32 v4, 4, v3
    s_nop 9
    s_cmp_eq_u32 s17, 0
    s_cbranch_scc0 K2_R0
    ds_write_b128 v4, v[28:31] offset:33024
    ds_write_b128 v4, v[32:35] offset:34048
    ds_write_b128 v4, v[36:39] offset:37120
    ds_write_b128 v4, v[40:43] offset:38144
    ds_write_b128 v4, v[44:47] offset:41216
    ds_write_b128 v4, v[48:51] offset:42240
    v_mov_b32 v52, v20
    v_mov_b32 v53, v21
    v_mov_b32 v54, v22
    v_mov_b32 v55, v23
    v_mov_b32 v56, v24
    v_mov_b32 v57, v25
    v_mov_b32 v58, v26
    v_mov_b32 v59, v27
K2_R0:
    s_cmp_eq_u32 s17, 1
    s_cbranch_scc0 K2_R1
    ds_write_b128 v4, v[20:23] offset:22784
    ds_write_b128 v4, v[24:27] offset:23808
    ds_write_b128 v4, v[36:39] offset:39168
    ds_write_b128 v4, v[40:43] offset:40192
    ds_write_b128 v4, v[44:47] offset:43264
    ds_write_b128 v4, v[48:51] offset:44288
    v_mov_b32 v52, v28
    v_mov_b32 v53, v29
    v_mov_b32 v54, v30
    v_mov_b32 v55, v31
    v_mov_b32 v56, v32
    v_mov_b32 v57, v33
    v_mov_b32 v58, v34
    v_mov_b32 v59, v35
K2_R1:
    s_cmp_eq_u32 s17, 2
    s_cbranch_scc0 K2_R2
    ds_write_b128 v4, v[20:23] offset:24832
    ds_write_b128 v4, v[24:27] offset:25856
    ds_write_b128 v4, v[28:31] offset:28928
    ds_write_b128 v4, v[32:35] offset:29952
    ds_write_b128 v4, v[44:47] offset:45312
    ds_write_b128 v4, v[48:51] offset:46336
    v_mov_b32 v52, v36
    v_mov_b32 v53, v37
    v_mov_b32 v54, v38
    v_mov_b32 v55, v39
    v_mov_b32 v56, v40
    v_mov_b32 v57, v41
    v_mov_b32 v58, v42
    v_mov_b32 v59, v43
K2_R2:
    s_cmp_eq_u32 s17, 3
    s_cbranch_scc0 K2_R3
    ds_write_b128 v4, v[20:23] offset:26880
    ds_write_b128 v4, v[24:27] offset:27904
    ds_write_b128 v4, v[28:31] offset:30976
    ds_write_b128 v4, v[32:35] offset:32000
    ds_write_b128 v4, v[36:39] offset:35072
    ds_write_b128 v4, v[40:43] offset:36096
    v_mov_b32 v52, v44
    v_mov_b32 v53, v45
    v_mov_b32 v54, v46
    v_mov_b32 v55, v47
    v_mov_b32 v56, v48
    v_mov_b32 v57, v49
    v_mov_b32 v58, v50
    v_mov_b32 v59, v51
K2_R3:
    s_nop 7
    s_waitcnt lgkmcnt(0)
    s_barrier
    s_mul_i32 s20, s17, 6144
    v_add_u32 v4, s20, v4
    ds_read_b128 v[60:63], v4 offset:22784
    ds_read_b128 v[64:67], v4 offset:23808
    ds_read_b128 v[68:71], v4 offset:24832
    ds_read_b128 v[72:75], v4 offset:25856
    ds_read_b128 v[76:79], v4 offset:26880
    ds_read_b128 v[80:83], v4 offset:27904
    s_lshl_b32 s20, s17, 10
    v_lshl_add_u32 v5, v3, 3, s20
    ds_read_b64 v[84:85], v5 offset:18688
    ds_read_b64 v[86:87], v5 offset:19200
    s_waitcnt lgkmcnt(0)
    s_lshl_b32 s26, s25, 16
    s_and_b32 s27, s25, 0xffff0000
    s_bitcmp1_b32 s3, 0
    s_cselect_b32 s25, s27, s26
    v_pk_add_f32 v[52:53], v[52:53], v[60:61]
    v_pk_add_f32 v[54:55], v[54:55], v[62:63]
    v_pk_add_f32 v[56:57], v[56:57], v[64:65]
    v_pk_add_f32 v[58:59], v[58:59], v[66:67]
    v_pk_add_f32 v[52:53], v[52:53], v[68:69]
    v_pk_add_f32 v[54:55], v[54:55], v[70:71]
    v_pk_add_f32 v[56:57], v[56:57], v[72:73]
    v_pk_add_f32 v[58:59], v[58:59], v[74:75]
    v_pk_add_f32 v[52:53], v[52:53], v[76:77]
    v_pk_add_f32 v[54:55], v[54:55], v[78:79]
    v_pk_add_f32 v[56:57], v[56:57], v[80:81]
    v_pk_add_f32 v[58:59], v[58:59], v[82:83]
    v_mul_f32 v52, s24, v52
    v_mul_f32 v53, s24, v53
    v_cvt_pk_bf16_f32 v6, v52, v53
    v_lshlrev_b32 v52, 16, v6
    v_and_b32 v53, 0xffff0000, v6
    v_cvt_f32_f16 v8, v84
    v_cvt_f32_f16_sdwa v9, v84 dst_sel:DWORD dst_unused:UNUSED_PAD src0_sel:WORD_1
    v_mul_f32 v8, s25, v8
    v_mul_f32 v9, s25, v9
    v_cvt_pk_bf16_f32 v6, v8, v9
    v_lshlrev_b32 v8, 16, v6
    v_and_b32 v9, 0xffff0000, v6
    v_pk_add_f32 v[8:9], v[8:9], v[52:53]
    v_cvt_pk_bf16_f32 v88, v8, v9
    v_mul_f32 v54, s24, v54
    v_mul_f32 v55, s24, v55
    v_cvt_pk_bf16_f32 v6, v54, v55
    v_lshlrev_b32 v54, 16, v6
    v_and_b32 v55, 0xffff0000, v6
    v_cvt_f32_f16 v8, v85
    v_cvt_f32_f16_sdwa v9, v85 dst_sel:DWORD dst_unused:UNUSED_PAD src0_sel:WORD_1
    v_mul_f32 v8, s25, v8
    v_mul_f32 v9, s25, v9
    v_cvt_pk_bf16_f32 v6, v8, v9
    v_lshlrev_b32 v8, 16, v6
    v_and_b32 v9, 0xffff0000, v6
    v_pk_add_f32 v[8:9], v[8:9], v[54:55]
    v_cvt_pk_bf16_f32 v89, v8, v9
    v_mul_f32 v56, s24, v56
    v_mul_f32 v57, s24, v57
    v_cvt_pk_bf16_f32 v6, v56, v57
    v_lshlrev_b32 v56, 16, v6
    v_and_b32 v57, 0xffff0000, v6
    v_cvt_f32_f16 v8, v86
    v_cvt_f32_f16_sdwa v9, v86 dst_sel:DWORD dst_unused:UNUSED_PAD src0_sel:WORD_1
    v_mul_f32 v8, s25, v8
    v_mul_f32 v9, s25, v9
    v_cvt_pk_bf16_f32 v6, v8, v9
    v_lshlrev_b32 v8, 16, v6
    v_and_b32 v9, 0xffff0000, v6
    v_pk_add_f32 v[8:9], v[8:9], v[56:57]
    v_cvt_pk_bf16_f32 v90, v8, v9
    v_mul_f32 v58, s24, v58
    v_mul_f32 v59, s24, v59
    v_cvt_pk_bf16_f32 v6, v58, v59
    v_lshlrev_b32 v58, 16, v6
    v_and_b32 v59, 0xffff0000, v6
    v_cvt_f32_f16 v8, v87
    v_cvt_f32_f16_sdwa v9, v87 dst_sel:DWORD dst_unused:UNUSED_PAD src0_sel:WORD_1
    v_mul_f32 v8, s25, v8
    v_mul_f32 v9, s25, v9
    v_cvt_pk_bf16_f32 v6, v8, v9
    v_lshlrev_b32 v8, 16, v6
    v_and_b32 v9, 0xffff0000, v6
    v_pk_add_f32 v[8:9], v[8:9], v[58:59]
    v_cvt_pk_bf16_f32 v91, v8, v9
    v_and_b32 v6, 1, v3
    v_cmp_eq_u32 vcc, 1, v6
    s_nop 1
    v_cndmask_b32 v8, v90, v88, vcc
    v_cndmask_b32 v9, v91, v89, vcc
    v_lshrrev_b32 v7, 1, v3
    v_lshl_add_u32 v7, v6, 5, v7
    v_mul_u32_u24 v7, 9216, v7
    v_mov_b32_dpp v10, v8 quad_perm:[1,0,3,2] row_mask:0xf bank_mask:0xf
    v_mov_b32_dpp v11, v9 quad_perm:[1,0,3,2] row_mask:0xf bank_mask:0xf
    s_mul_i32 s20, s17, 589824
    s_lshl_b32 s21, s3, 4
    s_add_u32 s20, s20, s21
    v_cndmask_b32 v88, v88, v10, vcc
    v_cndmask_b32 v89, v89, v11, vcc
    v_cndmask_b32 v90, v10, v90, vcc
    v_cndmask_b32 v91, v11, v91, vcc
    buffer_store_dwordx4 v[88:91], v7, s[28:31], s20 offen
K2_END:
    s_endpgm
.globl k3_kernel
.p2align 8
.type k3_kernel,@function
k3_kernel:
    s_cmp_ge_u32 s2, 256
    s_cbranch_scc1 K3_END
    s_load_dwordx2 s[4:5], s[0:1], 0
    s_load_dwordx2 s[6:7], s[0:1], 128
    s_load_dwordx2 s[32:33], s[0:1], 80
    s_load_dwordx2 s[34:35], s[0:1], 112
    s_and_b32 s16, s2, 7
    s_lshl_b32 s16, s16, 5
    s_lshr_b32 s3, s2, 3
    s_add_u32 s16, s3, s16
    s_mul_i32 s3, s16, 9216
    s_lshl_b32 s17, s16, 4
    v_lshrrev_b32 v1, 5, v0
    v_and_b32 v2, 31, v0
    v_mul_u32_u24 v3, 1152, v1
    v_lshl_add_u32 v3, v2, 2, v3
    v_lshlrev_b32 v6, 4, v0
    v_lshlrev_b32 v7, 2, v2
    v_readfirstlane_b32 s18, v0
    s_waitcnt lgkmcnt(0)
    s_mov_b32 s8, s4
    s_mov_b32 s9, s5
    s_mov_b32 s10, 0x240000
    s_mov_b32 s11, 0x20000
    s_add_u32 s12, s6, 0x600000
    s_addc_u32 s13, s7, 0
    s_mov_b32 s14, 0x240000
    s_mov_b32 s15, 0x20000
    s_mov_b32 s20, s32
    s_mov_b32 s21, s33
    s_mov_b32 s22, 0x480
    s_mov_b32 s23, 0x20000
    s_add_u32 s19, s3, 4096
    buffer_load_dwordx4 v[60:63], v6, s[12:15], s3 offen
    buffer_load_dwordx4 v[64:67], v6, s[12:15], s19 offen
    s_add_u32 s19, s3, 8192
    v_and_b32 v9, 0x3ff, v6
    buffer_load_dwordx4 v[68:71], v9, s[12:15], s19 offen
    buffer_load_dword v10, v3, s[8:11], s3 offen offset:0
    buffer_load_dword v11, v3, s[8:11], s3 offen offset:128
    buffer_load_dword v12, v3, s[8:11], s3 offen offset:256
    buffer_load_dword v13, v3, s[8:11], s3 offen offset:384
    buffer_load_dword v14, v3, s[8:11], s3 offen offset:512
    buffer_load_dword v15, v3, s[8:11], s3 offen offset:640
    buffer_load_dword v16, v3, s[8:11], s3 offen offset:768
    buffer_load_dword v17, v3, s[8:11], s3 offen offset:896
    buffer_load_dword v18, v3, s[8:11], s3 offen offset:1024
    buffer_load_dword v50, v7, s[20:23], 0 offen offset:0
    buffer_load_dword v51, v7, s[20:23], 0 offen offset:128
    buffer_load_dword v52, v7, s[20:23], 0 offen offset:256
    buffer_load_dword v53, v7, s[20:23], 0 offen offset:384
    buffer_load_dword v54, v7, s[20:23], 0 offen offset:512
    buffer_load_dword v55, v7, s[20:23], 0 offen offset:640
    buffer_load_dword v56, v7, s[20:23], 0 offen offset:768
    buffer_load_dword v57, v7, s[20:23], 0 offen offset:896
    buffer_load_dword v58, v7, s[20:23], 0 offen offset:1024
    s_mov_b32 s24, s34
    s_mov_b32 s25, s35
    s_mov_b32 s26, 0x240000
    s_mov_b32 s27, 0x20000
    s_add_u32 s28, s6, 0x900000
    s_addc_u32 s29, s7, 0
    s_mov_b32 s30, 0x240000
    s_mov_b32 s31, 0x20000
    s_add_u32 s36, s6, 0xc00000
    s_addc_u32 s37, s7, 0
    s_mov_b32 s38, 0x2000
    s_mov_b32 s39, 0x20000
    v_lshrrev_b32 v4, 6, v0
    v_mul_u32_u24 v4, 2304, v4
    v_lshl_add_u32 v4, v2, 3, v4
    v_and_b32 v5, 1, v1
    v_mul_u32_u24 v5, 0x020202, v5
    v_lshlrev_b32 v8, 25, v1
    v_and_b32 v8, 0x02000000, v8
    v_or_b32 v5, v5, v8
    v_add_u32 v5, 0x05040100, v5
    v_lshlrev_b32 v8, 2, v0
    s_waitcnt vmcnt(19)
    ds_write2st64_b32 v8, v60, v61 offset0:0 offset1:9
    ds_write2st64_b32 v8, v62, v63 offset0:18 offset1:27
    ds_write2st64_b32 v8, v64, v65 offset0:4 offset1:13
    ds_write2st64_b32 v8, v66, v67 offset0:22 offset1:31
    s_waitcnt vmcnt(18)
    s_cmp_ge_u32 s18, 64
    s_cbranch_scc1 K3_SKIP
    ds_write2st64_b32 v8, v68, v69 offset0:8 offset1:17
    ds_write2st64_b32 v8, v70, v71 offset0:26 offset1:35
K3_SKIP:
    s_waitcnt lgkmcnt(0)
    s_barrier
    ds_read_b64 v[60:61], v4 offset:0
    ds_read_b64 v[62:63], v4 offset:256
    ds_read_b64 v[64:65], v4 offset:512
    ds_read_b64 v[66:67], v4 offset:768
    ds_read_b64 v[68:69], v4 offset:1024
    ds_read_b64 v[70:71], v4 offset:1280
    ds_read_b64 v[72:73], v4 offset:1536
    ds_read_b64 v[74:75], v4 offset:1792
    ds_read_b64 v[76:77], v4 offset:2048
    s_waitcnt vmcnt(9)
    s_waitcnt lgkmcnt(8)
    v_perm_b32 v44, v61, v60, v5
    v_lshlrev_b32 v46, 16, v44
    v_and_b32 v47, 0xffff0000, v44
    v_lshlrev_b32 v20, 16, v10
    v_and_b32 v21, 0xffff0000, v10
    v_pk_add_f32 v[46:47], v[46:47], v[20:21]
    v_cvt_pk_bf16_f32 v44, v46, v47
    v_lshlrev_b32 v20, 16, v44
    v_and_b32 v21, 0xffff0000, v44
    s_waitcnt lgkmcnt(7)
    v_perm_b32 v44, v63, v62, v5
    v_lshlrev_b32 v46, 16, v44
    v_and_b32 v47, 0xffff0000, v44
    v_lshlrev_b32 v22, 16, v11
    v_and_b32 v23, 0xffff0000, v11
    v_pk_add_f32 v[46:47], v[46:47], v[22:23]
    v_cvt_pk_bf16_f32 v44, v46, v47
    v_lshlrev_b32 v22, 16, v44
    v_and_b32 v23, 0xffff0000, v44
    s_waitcnt lgkmcnt(6)
    v_perm_b32 v44, v65, v64, v5
    v_lshlrev_b32 v46, 16, v44
    v_and_b32 v47, 0xffff0000, v44
    v_lshlrev_b32 v24, 16, v12
    v_and_b32 v25, 0xffff0000, v12
    v_pk_add_f32 v[46:47], v[46:47], v[24:25]
    v_cvt_pk_bf16_f32 v44, v46, v47
    v_lshlrev_b32 v24, 16, v44
    v_and_b32 v25, 0xffff0000, v44
    s_waitcnt lgkmcnt(5)
    v_perm_b32 v44, v67, v66, v5
    v_lshlrev_b32 v46, 16, v44
    v_and_b32 v47, 0xffff0000, v44
    v_lshlrev_b32 v26, 16, v13
    v_and_b32 v27, 0xffff0000, v13
    v_pk_add_f32 v[46:47], v[46:47], v[26:27]
    v_cvt_pk_bf16_f32 v44, v46, v47
    v_lshlrev_b32 v26, 16, v44
    v_and_b32 v27, 0xffff0000, v44
    s_waitcnt lgkmcnt(4)
    v_perm_b32 v44, v69, v68, v5
    v_lshlrev_b32 v46, 16, v44
    v_and_b32 v47, 0xffff0000, v44
    v_lshlrev_b32 v28, 16, v14
    v_and_b32 v29, 0xffff0000, v14
    v_pk_add_f32 v[46:47], v[46:47], v[28:29]
    v_cvt_pk_bf16_f32 v44, v46, v47
    v_lshlrev_b32 v28, 16, v44
    v_and_b32 v29, 0xffff0000, v44
    s_waitcnt lgkmcnt(3)
    v_perm_b32 v44, v71, v70, v5
    v_lshlrev_b32 v46, 16, v44
    v_and_b32 v47, 0xffff0000, v44
    v_lshlrev_b32 v30, 16, v15
    v_and_b32 v31, 0xffff0000, v15
    v_pk_add_f32 v[46:47], v[46:47], v[30:31]
    v_cvt_pk_bf16_f32 v44, v46, v47
    v_lshlrev_b32 v30, 16, v44
    v_and_b32 v31, 0xffff0000, v44
    s_waitcnt lgkmcnt(2)
    v_perm_b32 v44, v73, v72, v5
    v_lshlrev_b32 v46, 16, v44
    v_and_b32 v47, 0xffff0000, v44
    v_lshlrev_b32 v32, 16, v16
    v_and_b32 v33, 0xffff0000, v16
    v_pk_add_f32 v[46:47], v[46:47], v[32:33]
    v_cvt_pk_bf16_f32 v44, v46, v47
    v_lshlrev_b32 v32, 16, v44
    v_and_b32 v33, 0xffff0000, v44
    s_waitcnt lgkmcnt(1)
    v_perm_b32 v44, v75, v74, v5
    v_lshlrev_b32 v46, 16, v44
    v_and_b32 v47, 0xffff0000, v44
    v_lshlrev_b32 v34, 16, v17
    v_and_b32 v35, 0xffff0000, v17
    v_pk_add_f32 v[46:47], v[46:47], v[34:35]
    v_cvt_pk_bf16_f32 v44, v46, v47
    v_lshlrev_b32 v34, 16, v44
    v_and_b32 v35, 0xffff0000, v44
    s_waitcnt lgkmcnt(0)
    v_perm_b32 v44, v77, v76, v5
    v_lshlrev_b32 v46, 16, v44
    v_and_b32 v47, 0xffff0000, v44
    v_lshlrev_b32 v36, 16, v18
    v_and_b32 v37, 0xffff0000, v18
    v_pk_add_f32 v[46:47], v[46:47], v[36:37]
    v_cvt_pk_bf16_f32 v44, v46, v47
    v_lshlrev_b32 v36, 16, v44
    v_and_b32 v37, 0xffff0000, v44
    v_pk_add_f32 v[44:45], v[20:21], v[22:23]
    v_pk_add_f32 v[46:47], v[24:25], v[26:27]
    v_pk_add_f32 v[44:45], v[44:45], v[28:29]
    v_pk_add_f32 v[46:47], v[46:47], v[30:31]
    v_pk_add_f32 v[44:45], v[44:45], v[32:33]
    v_pk_add_f32 v[46:47], v[46:47], v[34:35]
    v_pk_add_f32 v[44:45], v[44:45], v[36:37]
    v_pk_add_f32 v[44:45], v[44:45], v[46:47]
    v_add_f32 v44, v44, v45
    s_nop 1
    v_add_f32_dpp v44, v44, v44 row_ror:8 row_mask:0xf bank_mask:0xf
    s_nop 1
    v_add_f32_dpp v44, v44, v44 row_ror:4 row_mask:0xf bank_mask:0xf
    s_nop 1
    v_add_f32_dpp v44, v44, v44 row_ror:2 row_mask:0xf bank_mask:0xf
    s_nop 1
    v_add_f32_dpp v44, v44, v44 row_ror:1 row_mask:0xf bank_mask:0xf
    v_mov_b32 v46, v44
    s_nop 1
    v_permlane16_swap_b32 v44, v46
    v_add_f32 v44, v44, v46
    v_mul_f32 v48, 0x3ae38e39, v44
    v_mov_b32 v49, v48
    v_cvt_pk_bf16_f32 v40, v48, v48
    v_and_b32 v40, 0xffff0000, v40
    v_mov_b32 v41, v40
    v_pk_add_f32 v[42:43], v[20:21], v[48:49] neg_lo:[0,1] neg_hi:[0,1]
    v_pk_mul_f32 v[44:45], v[42:43], v[42:43]
    v_pk_add_f32 v[42:43], v[22:23], v[48:49] neg_lo:[0,1] neg_hi:[0,1]
    v_pk_mul_f32 v[46:47], v[42:43], v[42:43]
    v_pk_add_f32 v[42:43], v[24:25], v[48:49] neg_lo:[0,1] neg_hi:[0,1]
    v_pk_fma_f32 v[44:45], v[42:43], v[42:43], v[44:45]
    v_pk_add_f32 v[42:43], v[26:27], v[48:49] neg_lo:[0,1] neg_hi:[0,1]
    v_pk_fma_f32 v[46:47], v[42:43], v[42:43], v[46:47]
    v_pk_add_f32 v[42:43], v[28:29], v[48:49] neg_lo:[0,1] neg_hi:[0,1]
    v_pk_fma_f32 v[44:45], v[42:43], v[42:43], v[44:45]
    v_pk_add_f32 v[42:43], v[30:31], v[48:49] neg_lo:[0,1] neg_hi:[0,1]
    v_pk_fma_f32 v[46:47], v[42:43], v[42:43], v[46:47]
    v_pk_add_f32 v[42:43], v[32:33], v[48:49] neg_lo:[0,1] neg_hi:[0,1]
    v_pk_fma_f32 v[44:45], v[42:43], v[42:43], v[44:45]
    v_pk_add_f32 v[42:43], v[34:35], v[48:49] neg_lo:[0,1] neg_hi:[0,1]
    v_pk_fma_f32 v[46:47], v[42:43], v[42:43], v[46:47]
    v_pk_add_f32 v[42:43], v[36:37], v[48:49] neg_lo:[0,1] neg_hi:[0,1]
    v_pk_fma_f32 v[44:45], v[42:43], v[42:43], v[44:45]
    v_pk_add_f32 v[44:45], v[44:45], v[46:47]
    v_add_f32 v44, v44, v45
    s_nop 1
    v_add_f32_dpp v44, v44, v44 row_ror:8 row_mask:0xf bank_mask:0xf
    s_nop 1
    v_add_f32_dpp v44, v44, v44 row_ror:4 row_mask:0xf bank_mask:0xf
    s_nop 1
    v_add_f32_dpp v44, v44, v44 row_ror:2 row_mask:0xf bank_mask:0xf
    s_nop 1
    v_add_f32_dpp v44, v44, v44 row_ror:1 row_mask:0xf bank_mask:0xf
    v_mov_b32 v46, v44
    s_nop 1
    v_permlane16_swap_b32 v44, v46
    v_add_f32 v44, v44, v46
    v_mul_f32 v44, 0x3ae38e39, v44
    v_cvt_pk_bf16_f32 v44, v44, v44
    v_and_b32 v44, 0xffff0000, v44
    v_add_f32 v44, 0x3727c5ac, v44
    v_cvt_pk_bf16_f32 v44, v44, v44
    v_and_b32 v44, 0xffff0000, v44
    v_sqrt_f32 v44, v44
    s_nop 0
    v_cvt_pk_bf16_f32 v44, v44, v44
    v_and_b32 v44, 0xffff0000, v44
    v_rcp_f32 v42, v44
    s_nop 0
    v_mov_b32 v43, v42
    s_waitcnt vmcnt(0)
    v_mov_b32 v60, 0
    v_mov_b32 v61, 0
    v_pk_add_f32 v[44:45], v[20:21], v[40:41] neg_lo:[0,1] neg_hi:[0,1]
    v_cvt_pk_bf16_f32 v10, v44, v45
    v_lshlrev_b32 v44, 16, v10
    v_and_b32 v45, 0xffff0000, v10
    v_pk_mul_f32 v[44:45], v[44:45], v[42:43]
    v_cvt_pk_bf16_f32 v10, v44, v45
    v_lshlrev_b32 v44, 16, v10
    v_and_b32 v45, 0xffff0000, v10
    buffer_store_dword v10, v3, s[28:31], s3 offen offset:0
    v_lshlrev_b32 v46, 16, v50
    v_and_b32 v47, 0xffff0000, v50
    v_pk_fma_f32 v[60:61], v[44:45], v[46:47], v[60:61]
    v_pk_add_f32 v[44:45], v[44:45], v[20:21]
    v_cvt_pk_bf16_f32 v50, v44, v45
    buffer_store_dword v50, v3, s[24:27], s3 offen offset:0
    v_pk_add_f32 v[44:45], v[22:23], v[40:41] neg_lo:[0,1] neg_hi:[0,1]
    v_cvt_pk_bf16_f32 v11, v44, v45
    v_lshlrev_b32 v44, 16, v11
    v_and_b32 v45, 0xffff0000, v11
    v_pk_mul_f32 v[44:45], v[44:45], v[42:43]
    v_cvt_pk_bf16_f32 v11, v44, v45
    v_lshlrev_b32 v44, 16, v11
    v_and_b32 v45, 0xffff0000, v11
    buffer_store_dword v11, v3, s[28:31], s3 offen offset:128
    v_lshlrev_b32 v46, 16, v51
    v_and_b32 v47, 0xffff0000, v51
    v_pk_fma_f32 v[60:61], v[44:45], v[46:47], v[60:61]
    v_pk_add_f32 v[44:45], v[44:45], v[22:23]
    v_cvt_pk_bf16_f32 v51, v44, v45
    buffer_store_dword v51, v3, s[24:27], s3 offen offset:128
    v_pk_add_f32 v[44:45], v[24:25], v[40:41] neg_lo:[0,1] neg_hi:[0,1]
    v_cvt_pk_bf16_f32 v12, v44, v45
    v_lshlrev_b32 v44, 16, v12
    v_and_b32 v45, 0xffff0000, v12
    v_pk_mul_f32 v[44:45], v[44:45], v[42:43]
    v_cvt_pk_bf16_f32 v12, v44, v45
    v_lshlrev_b32 v44, 16, v12
    v_and_b32 v45, 0xffff0000, v12
    buffer_store_dword v12, v3, s[28:31], s3 offen offset:256
    v_lshlrev_b32 v46, 16, v52
    v_and_b32 v47, 0xffff0000, v52
    v_pk_fma_f32 v[60:61], v[44:45], v[46:47], v[60:61]
    v_pk_add_f32 v[44:45], v[44:45], v[24:25]
    v_cvt_pk_bf16_f32 v52, v44, v45
    buffer_store_dword v52, v3, s[24:27], s3 offen offset:256
    v_pk_add_f32 v[44:45], v[26:27], v[40:41] neg_lo:[0,1] neg_hi:[0,1]
    v_cvt_pk_bf16_f32 v13, v44, v45
    v_lshlrev_b32 v44, 16, v13
    v_and_b32 v45, 0xffff0000, v13
    v_pk_mul_f32 v[44:45], v[44:45], v[42:43]
    v_cvt_pk_bf16_f32 v13, v44, v45
    v_lshlrev_b32 v44, 16, v13
    v_and_b32 v45, 0xffff0000, v13
    buffer_store_dword v13, v3, s[28:31], s3 offen offset:384
    v_lshlrev_b32 v46, 16, v53
    v_and_b32 v47, 0xffff0000, v53
    v_pk_fma_f32 v[60:61], v[44:45], v[46:47], v[60:61]
    v_pk_add_f32 v[44:45], v[44:45], v[26:27]
    v_cvt_pk_bf16_f32 v53, v44, v45
    buffer_store_dword v53, v3, s[24:27], s3 offen offset:384
    v_pk_add_f32 v[44:45], v[28:29], v[40:41] neg_lo:[0,1] neg_hi:[0,1]
    v_cvt_pk_bf16_f32 v14, v44, v45
    v_lshlrev_b32 v44, 16, v14
    v_and_b32 v45, 0xffff0000, v14
    v_pk_mul_f32 v[44:45], v[44:45], v[42:43]
    v_cvt_pk_bf16_f32 v14, v44, v45
    v_lshlrev_b32 v44, 16, v14
    v_and_b32 v45, 0xffff0000, v14
    buffer_store_dword v14, v3, s[28:31], s3 offen offset:512
    v_lshlrev_b32 v46, 16, v54
    v_and_b32 v47, 0xffff0000, v54
    v_pk_fma_f32 v[60:61], v[44:45], v[46:47], v[60:61]
    v_pk_add_f32 v[44:45], v[44:45], v[28:29]
    v_cvt_pk_bf16_f32 v54, v44, v45
    buffer_store_dword v54, v3, s[24:27], s3 offen offset:512
    v_pk_add_f32 v[44:45], v[30:31], v[40:41] neg_lo:[0,1] neg_hi:[0,1]
    v_cvt_pk_bf16_f32 v15, v44, v45
    v_lshlrev_b32 v44, 16, v15
    v_and_b32 v45, 0xffff0000, v15
    v_pk_mul_f32 v[44:45], v[44:45], v[42:43]
    v_cvt_pk_bf16_f32 v15, v44, v45
    v_lshlrev_b32 v44, 16, v15
    v_and_b32 v45, 0xffff0000, v15
    buffer_store_dword v15, v3, s[28:31], s3 offen offset:640
    v_lshlrev_b32 v46, 16, v55
    v_and_b32 v47, 0xffff0000, v55
    v_pk_fma_f32 v[60:61], v[44:45], v[46:47], v[60:61]
    v_pk_add_f32 v[44:45], v[44:45], v[30:31]
    v_cvt_pk_bf16_f32 v55, v44, v45
    buffer_store_dword v55, v3, s[24:27], s3 offen offset:640
    v_pk_add_f32 v[44:45], v[32:33], v[40:41] neg_lo:[0,1] neg_hi:[0,1]
    v_cvt_pk_bf16_f32 v16, v44, v45
    v_lshlrev_b32 v44, 16, v16
    v_and_b32 v45, 0xffff0000, v16
    v_pk_mul_f32 v[44:45], v[44:45], v[42:43]
    v_cvt_pk_bf16_f32 v16, v44, v45
    v_lshlrev_b32 v44, 16, v16
    v_and_b32 v45, 0xffff0000, v16
    buffer_store_dword v16, v3, s[28:31], s3 offen offset:768
    v_lshlrev_b32 v46, 16, v56
    v_and_b32 v47, 0xffff0000, v56
    v_pk_fma_f32 v[60:61], v[44:45], v[46:47], v[60:61]
    v_pk_add_f32 v[44:45], v[44:45], v[32:33]
    v_cvt_pk_bf16_f32 v56, v44, v45
    buffer_store_dword v56, v3, s[24:27], s3 offen offset:768
    v_pk_add_f32 v[44:45], v[34:35], v[40:41] neg_lo:[0,1] neg_hi:[0,1]
    v_cvt_pk_bf16_f32 v17, v44, v45
    v_lshlrev_b32 v44, 16, v17
    v_and_b32 v45, 0xffff0000, v17
    v_pk_mul_f32 v[44:45], v[44:45], v[42:43]
    v_cvt_pk_bf16_f32 v17, v44, v45
    v_lshlrev_b32 v44, 16, v17
    v_and_b32 v45, 0xffff0000, v17
    buffer_store_dword v17, v3, s[28:31], s3 offen offset:896
    v_lshlrev_b32 v46, 16, v57
    v_and_b32 v47, 0xffff0000, v57
    v_pk_fma_f32 v[60:61], v[44:45], v[46:47], v[60:61]
    v_pk_add_f32 v[44:45], v[44:45], v[34:35]
    v_cvt_pk_bf16_f32 v57, v44, v45
    buffer_store_dword v57, v3, s[24:27], s3 offen offset:896
    v_pk_add_f32 v[44:45], v[36:37], v[40:41] neg_lo:[0,1] neg_hi:[0,1]
    v_cvt_pk_bf16_f32 v18, v44, v45
    v_lshlrev_b32 v44, 16, v18
    v_and_b32 v45, 0xffff0000, v18
    v_pk_mul_f32 v[44:45], v[44:45], v[42:43]
    v_cvt_pk_bf16_f32 v18, v44, v45
    v_lshlrev_b32 v44, 16, v18
    v_and_b32 v45, 0xffff0000, v18
    buffer_store_dword v18, v3, s[28:31], s3 offen offset:1024
    v_lshlrev_b32 v46, 16, v58
    v_and_b32 v47, 0xffff0000, v58
    v_pk_fma_f32 v[60:61], v[44:45], v[46:47], v[60:61]
    v_pk_add_f32 v[44:45], v[44:45], v[36:37]
    v_cvt_pk_bf16_f32 v58, v44, v45
    buffer_store_dword v58, v3, s[24:27], s3 offen offset:1024
    v_add_f32 v60, v60, v61
    s_nop 1
    v_add_f32_dpp v60, v60, v60 row_ror:8 row_mask:0xf bank_mask:0xf
    s_nop 1
    v_add_f32_dpp v60, v60, v60 row_ror:4 row_mask:0xf bank_mask:0xf
    s_nop 1
    v_add_f32_dpp v60, v60, v60 row_ror:2 row_mask:0xf bank_mask:0xf
    s_nop 1
    v_add_f32_dpp v60, v60, v60 row_ror:1 row_mask:0xf bank_mask:0xf
    v_mov_b32 v61, v60
    s_nop 1
    v_permlane16_swap_b32 v60, v61
    v_add_f32 v60, v60, v61
    v_cvt_pk_bf16_f32 v60, v60, v60
    v_ashrrev_i32 v61, 31, v60
    v_or_b32 v61, 0x80000000, v61
    v_xor_b32 v60, v60, v61
    v_and_b32 v60, 0xffff0000, v60
    s_lshl_b32 s19, s16, 3
    v_add_u32 v61, s19, v1
    v_sub_u32 v62, 0x87ff, v61
    v_or_b32 v60, v60, v62
    v_lshlrev_b32 v61, 2, v61
    v_cmp_eq_u32 vcc, 0, v2
    s_and_saveexec_b64 s[40:41], vcc
    buffer_store_dword v60, v61, s[36:39], 0 offen
K3_END:
    s_endpgm
.globl k4_kernel
.p2align 8
.type k4_kernel,@function
k4_kernel:
    s_cmp_ge_u32 s2, 144
    s_cbranch_scc1 K4_END
    s_load_dwordx2 s[34:35], s[0:1], 128
    s_load_dwordx4 s[4:7], s[0:1], 88
    s_load_dwordx2 s[32:33], s[0:1], 104
    s_load_dwordx2 s[30:31], s[0:1], 0
    s_and_b32 s16, s2, 7
    s_lshr_b32 s3, s2, 3
    s_mul_i32 s2, s16, 18
    s_add_u32 s2, s2, s3
    v_readfirstlane_b32 s17, v0
    s_lshr_b32 s17, s17, 6
    v_and_b32 v1, 63, v0
    v_and_b32 v2, 15, v1
    v_lshrrev_b32 v3, 4, v1
    s_mov_b32 s28, 0x05040100
    s_mov_b32 s29, 0x07060302
    s_cmp_ge_u32 s17, 9
    s_cbranch_scc1 K4_G
    s_setprio 3
    v_mov_b32 v4, 0
    v_lshlrev_b32 v5, 2, v0
    v_min_u32 v5, 1084, v5
    ds_write_b32 v5, v4
    v_lshlrev_b32 v4, 4, v0
    v_and_b32 v6, 1, v1
    v_subrev_u32 v6, 1, v6
    s_waitcnt lgkmcnt(0)
    s_add_u32 s36, s34, 0xc00000
    s_addc_u32 s37, s35, 0
    s_mov_b32 s38, 0x2000
    s_mov_b32 s39, 0x20000
    buffer_load_dwordx4 v[8:11], v4, s[36:39], 0 offen
    s_barrier
    s_mov_b32 s8, s32
    s_mov_b32 s9, s33
    s_mov_b32 s10, 0x510000
    s_mov_b32 s11, 0x20000
    s_add_u32 s20, s34, 0xd00000
    s_addc_u32 s21, s35, 0
    s_mov_b32 s22, 0x288000
    s_mov_b32 s23, 0x20000
    v_mul_u32_u24 v5, 9216, v3
    v_lshl_add_u32 v5, v2, 3, v5
    s_mul_i32 s18, s2, 36864
    s_lshl_b32 s19, s17, 7
    s_add_u32 s18, s18, s19
    v_and_b32 v7, 7, v1
    v_lshlrev_b32 v7, 2, v7
    s_cmp_eq_u32 s17, 8
    s_cbranch_scc1 K4_B_POLL
    s_waitcnt vmcnt(0)
    v_max_u32 v12, v8, v9
    v_min_u32 v9, v8, v9
    v_max_u32 v13, v10, v11
    v_min_u32 v11, v10, v11
    v_max_u32 v14, v12, v13
    v_min_u32 v13, v12, v13
    v_max_u32 v15, v9, v11
    v_min_u32 v11, v9, v11
    v_max_u32 v16, v15, v13
    v_min_u32 v13, v15, v13
    v_mov_b32_dpp v17, v11 quad_perm:[1,0,3,2] row_mask:0xf bank_mask:0xf
    s_nop 0
    v_mov_b32_dpp v18, v13 quad_perm:[1,0,3,2] row_mask:0xf bank_mask:0xf
    v_mov_b32_dpp v19, v16 quad_perm:[1,0,3,2] row_mask:0xf bank_mask:0xf
    v_mov_b32_dpp v20, v14 quad_perm:[1,0,3,2] row_mask:0xf bank_mask:0xf
    v_med3_u32 v17, v14, v17, v6
    v_med3_u32 v18, v16, v18, v6
    v_med3_u32 v19, v13, v19, v6
    v_med3_u32 v20, v11, v20, v6
    v_max_u32 v21, v17, v19
    v_min_u32 v19, v17, v19
    v_max_u32 v22, v18, v20
    v_min_u32 v20, v18, v20
    v_max_u32 v23, v21, v22
    v_min_u32 v22, v21, v22
    v_max_u32 v8, v19, v20
    v_min_u32 v20, v19, v20
    s_nop 1
    v_max_u32_dpp v10, v20, v23 quad_perm:[3,2,1,0] row_mask:0xf bank_mask:0xf
    v_max_u32_dpp v12, v8, v22 quad_perm:[3,2,1,0] row_mask:0xf bank_mask:0xf
    v_max_u32_dpp v9, v22, v8 quad_perm:[3,2,1,0] row_mask:0xf bank_mask:0xf
    v_max_u32_dpp v15, v23, v20 quad_perm:[3,2,1,0] row_mask:0xf bank_mask:0xf
    v_mov_b32_dpp v14, v10 quad_perm:[1,0,3,2] row_mask:0xf bank_mask:0xf
    v_mov_b32_dpp v16, v12 quad_perm:[1,0,3,2] row_mask:0xf bank_mask:0xf
    v_mov_b32_dpp v13, v9 quad_perm:[1,0,3,2] row_mask:0xf bank_mask:0xf
    v_mov_b32_dpp v11, v15 quad_perm:[1,0,3,2] row_mask:0xf bank_mask:0xf
    v_med3_u32 v14, v10, v14, v6
    v_med3_u32 v16, v12, v16, v6
    v_med3_u32 v13, v9, v13, v6
    v_med3_u32 v11, v15, v11, v6
    v_max_u32 v17, v14, v13
    v_min_u32 v13, v14, v13
    v_max_u32 v18, v16, v11
    v_min_u32 v11, v16, v11
    v_max_u32 v21, v17, v18
    v_min_u32 v18, v17, v18
    v_max_u32 v19, v13, v11
    v_min_u32 v11, v13, v11
    s_nop 1
    v_max_u32_dpp v23, v11, v21 row_half_mirror row_mask:0xf bank_mask:0xf
    v_max_u32_dpp v22, v19, v18 row_half_mirror row_mask:0xf bank_mask:0xf
    v_max_u32_dpp v8, v18, v19 row_half_mirror row_mask:0xf bank_mask:0xf
    v_max_u32_dpp v20, v21, v11 row_half_mirror row_mask:0xf bank_mask:0xf
    v_mov_b32_dpp v10, v23 quad_perm:[1,0,3,2] row_mask:0xf bank_mask:0xf
    v_mov_b32_dpp v12, v22 quad_perm:[1,0,3,2] row_mask:0xf bank_mask:0xf
    v_mov_b32_dpp v9, v8 quad_perm:[1,0,3,2] row_mask:0xf bank_mask:0xf
    v_mov_b32_dpp v15, v20 quad_perm:[1,0,3,2] row_mask:0xf bank_mask:0xf
    v_med3_u32 v10, v23, v10, v6
    v_med3_u32 v12, v22, v12, v6
    v_med3_u32 v9, v8, v9, v6
    v_med3_u32 v15, v20, v15, v6
    v_max_u32 v14, v10, v9
    v_min_u32 v9, v10, v9
    v_max_u32 v16, v12, v15
    v_min_u32 v15, v12, v15
    v_max_u32 v17, v14, v16
    v_min_u32 v16, v14, v16
    v_max_u32 v13, v9, v15
    v_min_u32 v15, v9, v15
    s_nop 1
    v_max_u32_dpp v21, v15, v17 row_mirror row_mask:0xf bank_mask:0xf
    v_max_u32_dpp v18, v13, v16 row_mirror row_mask:0xf bank_mask:0xf
    v_max_u32_dpp v19, v16, v13 row_mirror row_mask:0xf bank_mask:0xf
    v_max_u32_dpp v11, v17, v15 row_mirror row_mask:0xf bank_mask:0xf
    v_mov_b32_dpp v23, v21 quad_perm:[1,0,3,2] row_mask:0xf bank_mask:0xf
    v_mov_b32_dpp v22, v18 quad_perm:[1,0,3,2] row_mask:0xf bank_mask:0xf
    v_mov_b32_dpp v8, v19 quad_perm:[1,0,3,2] row_mask:0xf bank_mask:0xf
    v_mov_b32_dpp v20, v11 quad_perm:[1,0,3,2] row_mask:0xf bank_mask:0xf
    v_med3_u32 v23, v21, v23, v6
    v_med3_u32 v22, v18, v22, v6
    v_med3_u32 v8, v19, v8, v6
    v_med3_u32 v20, v11, v20, v6
    v_max_u32 v10, v23, v8
    v_min_u32 v8, v23, v8
    v_max_u32 v12, v22, v20
    v_min_u32 v20, v22, v20
    v_max_u32 v14, v10, v12
    v_min_u32 v12, v10, v12
    v_max_u32 v9, v8, v20
    v_min_u32 v20, v8, v20
    v_mov_b32 v24, v14
    v_mov_b32 v25, v12
    v_mov_b32 v26, v9
    v_mov_b32 v27, v20
    s_lshl_b32 s19, s17, 7
    v_lshlrev_b32 v28, 4, v2
    v_lshl_add_u32 v28, v3, 5, v28
    v_add_u32 v28, s19, v28
    s_mov_b32 exec_lo, 0x00030003
    s_mov_b32 exec_hi, 0x00030003
    ds_write_b128 v28, v[24:27] offset:0
    s_mov_b64 exec, -1
    s_cmp_lg_u32 s17, 0
    s_cbranch_scc1 K4_B_POLL
    v_and_b32 v28, 1, v3
    v_sub_u32 v28, 0, v28
    v_not_b32 v29, v28
    v_xor_b32 v30, v6, v28
    v_lshrrev_b32 v31, 1, v3
    v_sub_u32 v31, 0, v31
    v_not_b32 v32, v31
    v_xor_b32 v33, v6, v31
K4_L2POLL:
    ds_read_b128 v[8:11], v4 offset:0
    s_waitcnt lgkmcnt(0)
    v_min3_u32 v12, v8, v9, v10
    v_min_u32 v12, v12, v11
    v_cmp_eq_u32 vcc, 0, v12
    s_cbranch_vccnz K4_L2POLL
    v_max_u32_dpp v12, v11, v8 quad_perm:[3,2,1,0] row_mask:0xf bank_mask:0xf
    v_max_u32_dpp v13, v10, v9 quad_perm:[3,2,1,0] row_mask:0xf bank_mask:0xf
    v_max_u32_dpp v14, v9, v10 quad_perm:[3,2,1,0] row_mask:0xf bank_mask:0xf
    v_max_u32_dpp v15, v8, v11 quad_perm:[3,2,1,0] row_mask:0xf bank_mask:0xf
    v_mov_b32_dpp v16, v12 quad_perm:[1,0,3,2] row_mask:0xf bank_mask:0xf
    v_mov_b32_dpp v17, v13 quad_perm:[1,0,3,2] row_mask:0xf bank_mask:0xf
    v_mov_b32_dpp v18, v14 quad_perm:[1,0,3,2] row_mask:0xf bank_mask:0xf
    v_mov_b32_dpp v19, v15 quad_perm:[1,0,3,2] row_mask:0xf bank_mask:0xf
    v_med3_u32 v16, v12, v16, v6
    v_med3_u32 v17, v13, v17, v6
    v_med3_u32 v18, v14, v18, v6
    v_med3_u32 v19, v15, v19, v6
    v_max_u32 v20, v16, v18
    v_min_u32 v18, v16, v18
    v_max_u32 v21, v17, v19
    v_min_u32 v19, v17, v19
    v_max_u32 v22, v20, v21
    v_min_u32 v21, v20, v21
    v_max_u32 v23, v18, v19
    v_min_u32 v19, v18, v19
    s_nop 1
    v_max_u32_dpp v8, v19, v22 row_half_mirror row_mask:0xf bank_mask:0xf
    v_max_u32_dpp v9, v23, v21 row_half_mirror row_mask:0xf bank_mask:0xf
    v_max_u32_dpp v10, v21, v23 row_half_mirror row_mask:0xf bank_mask:0xf
    v_max_u32_dpp v11, v22, v19 row_half_mirror row_mask:0xf bank_mask:0xf
    v_mov_b32_dpp v12, v8 quad_perm:[1,0,3,2] row_mask:0xf bank_mask:0xf
    v_mov_b32_dpp v13, v9 quad_perm:[1,0,3,2] row_mask:0xf bank_mask:0xf
    v_mov_b32_dpp v14, v10 quad_perm:[1,0,3,2] row_mask:0xf bank_mask:0xf
    v_mov_b32_dpp v15, v11 quad_perm:[1,0,3,2] row_mask:0xf bank_mask:0xf
    v_med3_u32 v12, v8, v12, v6
    v_med3_u32 v13, v9, v13, v6
    v_med3_u32 v14, v10, v14, v6
    v_med3_u32 v15, v11, v15, v6
    v_max_u32 v16, v12, v14
    v_min_u32 v14, v12, v14
    v_max_u32 v17, v13, v15
    v_min_u32 v15, v13, v15
    v_max_u32 v20, v16, v17
    v_min_u32 v17, v16, v17
    v_max_u32 v18, v14, v15
    v_min_u32 v15, v14, v15
    s_nop 1
    v_max_u32_dpp v22, v15, v20 row_mirror row_mask:0xf bank_mask:0xf
    v_max_u32_dpp v21, v18, v17 row_mirror row_mask:0xf bank_mask:0xf
    v_max_u32_dpp v23, v17, v18 row_mirror row_mask:0xf bank_mask:0xf
    v_max_u32_dpp v19, v20, v15 row_mirror row_mask:0xf bank_mask:0xf
    v_mov_b32_dpp v8, v22 quad_perm:[1,0,3,2] row_mask:0xf bank_mask:0xf
    v_mov_b32_dpp v9, v21 quad_perm:[1,0,3,2] row_mask:0xf bank_mask:0xf
    v_mov_b32_dpp v10, v23 quad_perm:[1,0,3,2] row_mask:0xf bank_mask:0xf
    v_mov_b32_dpp v11, v19 quad_perm:[1,0,3,2] row_mask:0xf bank_mask:0xf
    v_med3_u32 v8, v22, v8, v30
    v_med3_u32 v9, v21, v9, v30
    v_med3_u32 v10, v23, v10, v30
    v_med3_u32 v11, v19, v11, v30
    v_med3_u32 v12, v8, v10, v29
    v_med3_u32 v10, v8, v10, v28
    v_med3_u32 v13, v9, v11, v29
    v_med3_u32 v11, v9, v11, v28
    v_med3_u32 v16, v12, v13, v29
    v_med3_u32 v13, v12, v13, v28
    v_med3_u32 v14, v10, v11, v29
    v_med3_u32 v11, v10, v11, v28
    v_mov_b32 v20, v16
    v_mov_b32 v17, v13
    v_mov_b32 v18, v14
    v_mov_b32 v15, v11
    v_permlane16_swap_b32 v16, v20
    v_permlane16_swap_b32 v13, v17
    v_permlane16_swap_b32 v14, v18
    v_permlane16_swap_b32 v11, v15
    v_max_u32 v16, v16, v20
    v_max_u32 v13, v13, v17
    v_max_u32 v14, v14, v18
    v_max_u32 v11, v11, v15
    v_mov_b32_dpp v22, v16 quad_perm:[1,0,3,2] row_mask:0xf bank_mask:0xf
    v_mov_b32_dpp v21, v13 quad_perm:[1,0,3,2] row_mask:0xf bank_mask:0xf
    v_mov_b32_dpp v23, v14 quad_perm:[1,0,3,2] row_mask:0xf bank_mask:0xf
    v_mov_b32_dpp v19, v11 quad_perm:[1,0,3,2] row_mask:0xf bank_mask:0xf
    v_med3_u32 v22, v16, v22, v33
    v_med3_u32 v21, v13, v21, v33
    v_med3_u32 v23, v14, v23, v33
    v_med3_u32 v19, v11, v19, v33
    v_med3_u32 v8, v22, v23, v32
    v_med3_u32 v23, v22, v23, v31
    v_med3_u32 v9, v21, v19, v32
    v_med3_u32 v19, v21, v19, v31
    v_med3_u32 v12, v8, v9, v32
    v_med3_u32 v9, v8, v9, v31
    v_med3_u32 v10, v23, v19, v32
    v_med3_u32 v19, v23, v19, v31
    v_mov_b32 v20, v12
    v_mov_b32 v17, v9
    v_mov_b32 v18, v10
    v_mov_b32 v15, v19
    v_permlane32_swap_b32 v12, v20
    v_permlane32_swap_b32 v9, v17
    v_permlane32_swap_b32 v10, v18
    v_permlane32_swap_b32 v19, v15
    v_max_u32 v12, v12, v20
    v_max_u32 v9, v9, v17
    v_max_u32 v10, v10, v18
    v_max_u32 v19, v19, v15
    v_mov_b32 v24, v12
    v_mov_b32 v25, v9
    v_mov_b32 v26, v10
    v_mov_b32 v27, v19
    s_mov_b64 exec, 3
    ds_write_b128 v4, v[24:27] offset:1024
    s_mov_b64 exec, -1
K4_B_POLL:
    s_setprio 0
    ds_read_b32 v12, v7 offset:1024
    s_waitcnt lgkmcnt(0)
    v_cmp_eq_u32 vcc, 0, v12
    s_cbranch_vccnz K4_B_POLL
    buffer_load_dwordx2 v[32:33], v5, s[8:11], s18 offen offset:0
    buffer_load_dwordx2 v[34:35], v5, s[8:11], s18 offen offset:1152
    buffer_load_dwordx2 v[36:37], v5, s[8:11], s18 offen offset:2304
    buffer_load_dwordx2 v[38:39], v5, s[8:11], s18 offen offset:3456
    s_add_u32 s18, s18, 4608
    buffer_load_dwordx2 v[40:41], v5, s[8:11], s18 offen offset:0
    buffer_load_dwordx2 v[42:43], v5, s[8:11], s18 offen offset:1152
    buffer_load_dwordx2 v[44:45], v5, s[8:11], s18 offen offset:2304
    buffer_load_dwordx2 v[46:47], v5, s[8:11], s18 offen offset:3456
    s_cmp_lg_u32 s17, 8
    s_cbranch_scc1 K4_B_NOSIDE
    s_add_u32 s12, s34, 0x900000
    s_addc_u32 s13, s35, 0
    s_mov_b32 s14, 0x240000
    s_mov_b32 s15, 0x20000
    s_add_u32 s24, s34, 0x600000
    s_addc_u32 s25, s35, 0
    s_mov_b32 s26, 0x240000
    s_mov_b32 s27, 0x20000
    s_mov_b32 s36, s30
    s_mov_b32 s37, s31
    s_mov_b32 s38, 0x240000
    s_mov_b32 s39, 0x20000
    v_readlane_b32 s19, v12, s16
    s_and_b32 s19, s19, 0x7ff
    s_sub_u32 s19, 2047, s19
    v_and_b32 v13, 31, v1
    s_lshl_b32 s40, s3, 5
    v_add_u32 v13, s40, v13
    v_lshlrev_b32 v14, 1, v13
    v_lshlrev_b32 v15, 4, v13
    s_mul_i32 s40, s19, 1152
    s_lshr_b32 s41, s19, 3
    s_mul_i32 s41, s41, 9216
    s_and_b32 s19, s19, 7
    s_lshl_b32 s19, s19, 1
    s_add_u32 s41, s41, s19
    buffer_load_ushort v16, v14, s[12:15], s40 offen
    buffer_load_ushort v17, v14, s[36:39], s40 offen
    buffer_load_ushort v18, v15, s[24:27], s41 offen
    s_add_u32 s12, s34, 0xc20000
    s_addc_u32 s13, s35, 0
    s_mov_b32 s14, 0x4820
    s_mov_b32 s15, 0x20000
    v_lshlrev_b32 v14, 2, v13
    s_mul_i32 s40, s16, 2304
    s_add_u32 s40, s40, 32
    s_waitcnt vmcnt(0)
    v_lshlrev_b32 v17, 16, v17
    v_lshlrev_b32 v18, 16, v18
    v_add_f32 v17, v17, v18
    v_cvt_pk_bf16_f32 v17, v17, v17
    v_and_b32 v17, 0xffff0000, v17
    v_or_b32 v16, v16, v17
    buffer_store_dword v16, v14, s[12:15], s40 offen
    s_cmp_lg_u32 s2, 0
    s_cbranch_scc1 K4_B_NOSIDE
    buffer_store_dword v12, v7, s[12:15], 0 offen
K4_B_NOSIDE:
    s_barrier
    s_waitcnt vmcnt(0)
    v_perm_b32 v48, v34, v32, s28
    v_perm_b32 v49, v38, v36, s28
    v_perm_b32 v50, v42, v40, s28
    v_perm_b32 v51, v46, v44, s28
    v_perm_b32 v52, v34, v32, s29
    v_perm_b32 v53, v38, v36, s29
    v_perm_b32 v54, v42, v40, s29
    v_perm_b32 v55, v46, v44, s29
    v_perm_b32 v56, v35, v33, s28
    v_perm_b32 v57, v39, v37, s28
    v_perm_b32 v58, v43, v41, s28
    v_perm_b32 v59, v47, v45, s28
    v_perm_b32 v60, v35, v33, s29
    v_perm_b32 v61, v39, v37, s29
    v_perm_b32 v62, v43, v41, s29
    v_perm_b32 v63, v47, v45, s29
    v_and_b32 v16, 7, v2
    v_lshlrev_b32 v16, 6, v16
    v_lshl_add_u32 v16, v3, 4, v16
    s_mul_i32 s18, s2, 18432
    s_lshl_b32 s19, s17, 11
    s_add_u32 s18, s18, s19
    v_lshlrev_b32 v17, 4, v1
    s_barrier
    ds_read_b128 v[20:23], v16 offset:1088
    s_waitcnt lgkmcnt(0)
    v_mfma_f32_16x16x32_bf16 v[32:35], v[20:23], v[48:51], 0
    v_mfma_f32_16x16x32_bf16 v[36:39], v[20:23], v[52:55], 0
    v_mfma_f32_16x16x32_bf16 v[40:43], v[20:23], v[56:59], 0
    v_mfma_f32_16x16x32_bf16 v[44:47], v[20:23], v[60:63], 0
    s_mov_b32 exec_lo, -1
    s_mov_b32 exec_hi, 0
    s_nop 2
    buffer_store_dwordx4 v[32:35], v17, s[20:23], s18 offen offset:0
    buffer_store_dwordx4 v[36:39], v17, s[20:23], s18 offen offset:512
    buffer_store_dwordx4 v[40:43], v17, s[20:23], s18 offen offset:1024
    buffer_store_dwordx4 v[44:47], v17, s[20:23], s18 offen offset:1536
    s_endpgm
K4_G:
    s_sub_u32 s17, s17, 9
    s_mul_i32 s18, s17, 96
    v_lshl_add_u32 v5, v3, 3, s18
    v_mul_u32_u24 v5, 9216, v5
    v_and_b32 v6, 7, v2
    v_lshl_add_u32 v5, v6, 3, v5
    s_lshl_b32 s18, s2, 6
    v_add_u32 v5, s18, v5
    v_cmp_gt_u32 vcc, 8, v2
    s_mov_b32 s40, 9216
    s_mov_b32 s41, 0
    s_mov_b32 s38, 230400
    s_mov_b32 s39, 0
    v_lshlrev_b32 v7, 2, v6
    s_waitcnt lgkmcnt(0)
    v_mov_b32 v12, s4
    v_mov_b32 v13, s5
    v_mov_b32 v14, s6
    v_mov_b32 v15, s7
    v_cndmask_b32 v12, v14, v12, vcc
    v_cndmask_b32 v13, v15, v13, vcc
    v_add_co_u32 v12, vcc, v12, v5
    s_nop 1
    v_addc_co_u32 v13, vcc, 0, v13, vcc
    global_load_dwordx2 v[32:33], v[12:13], off
    v_lshl_add_u64 v[12:13], v[12:13], 0, s[40:41]
    global_load_dwordx2 v[34:35], v[12:13], off
    v_lshl_add_u64 v[12:13], v[12:13], 0, s[40:41]
    global_load_dwordx2 v[36:37], v[12:13], off
    v_lshl_add_u64 v[12:13], v[12:13], 0, s[40:41]
    global_load_dwordx2 v[38:39], v[12:13], off
    v_lshl_add_u64 v[12:13], v[12:13], 0, s[40:41]
    s_barrier
    global_load_dwordx2 v[40:41], v[12:13], off
    v_lshl_add_u64 v[12:13], v[12:13], 0, s[40:41]
    global_load_dwordx2 v[42:43], v[12:13], off
    v_lshl_add_u64 v[12:13], v[12:13], 0, s[40:41]
    global_load_dwordx2 v[44:45], v[12:13], off
    v_lshl_add_u64 v[12:13], v[12:13], 0, s[40:41]
    global_load_dwordx2 v[46:47], v[12:13], off
    v_lshl_add_u64 v[12:13], v[12:13], 0, s[38:39]
    global_load_dwordx2 v[48:49], v[12:13], off
    v_lshl_add_u64 v[12:13], v[12:13], 0, s[40:41]
    global_load_dwordx2 v[50:51], v[12:13], off
    v_lshl_add_u64 v[12:13], v[12:13], 0, s[40:41]
    global_load_dwordx2 v[52:53], v[12:13], off
    v_lshl_add_u64 v[12:13], v[12:13], 0, s[40:41]
    global_load_dwordx2 v[54:55], v[12:13], off
    v_lshl_add_u64 v[12:13], v[12:13], 0, s[40:41]
    global_load_dwordx2 v[56:57], v[12:13], off
    v_lshl_add_u64 v[12:13], v[12:13], 0, s[40:41]
    global_load_dwordx2 v[58:59], v[12:13], off
    v_lshl_add_u64 v[12:13], v[12:13], 0, s[40:41]
    global_load_dwordx2 v[60:61], v[12:13], off
    v_lshl_add_u64 v[12:13], v[12:13], 0, s[40:41]
    global_load_dwordx2 v[62:63], v[12:13], off
    v_lshl_add_u64 v[12:13], v[12:13], 0, s[38:39]
    global_load_dwordx2 v[64:65], v[12:13], off
    v_lshl_add_u64 v[12:13], v[12:13], 0, s[40:41]
    global_load_dwordx2 v[66:67], v[12:13], off
    v_lshl_add_u64 v[12:13], v[12:13], 0, s[40:41]
    global_load_dwordx2 v[68:69], v[12:13], off
    v_lshl_add_u64 v[12:13], v[12:13], 0, s[40:41]
    global_load_dwordx2 v[70:71], v[12:13], off
    v_lshl_add_u64 v[12:13], v[12:13], 0, s[40:41]
    global_load_dwordx2 v[72:73], v[12:13], off
    v_lshl_add_u64 v[12:13], v[12:13], 0, s[40:41]
    global_load_dwordx2 v[74:75], v[12:13], off
    v_lshl_add_u64 v[12:13], v[12:13], 0, s[40:41]
    global_load_dwordx2 v[76:77], v[12:13], off
    v_lshl_add_u64 v[12:13], v[12:13], 0, s[40:41]
    global_load_dwordx2 v[78:79], v[12:13], off
    s_add_u32 s12, s34, 0x900000
    s_addc_u32 s13, s35, 0
    s_mov_b32 s14, 0x240000
    s_mov_b32 s15, 0x20000
    s_waitcnt vmcnt(16)
    v_perm_b32 v80, v34, v32, s28
    v_perm_b32 v81, v38, v36, s28
    v_perm_b32 v82, v42, v40, s28
    v_perm_b32 v83, v46, v44, s28
    v_perm_b32 v84, v34, v32, s29
    v_perm_b32 v85, v38, v36, s29
    v_perm_b32 v86, v42, v40, s29
    v_perm_b32 v87, v46, v44, s29
    v_perm_b32 v88, v35, v33, s28
    v_perm_b32 v89, v39, v37, s28
    v_perm_b32 v90, v43, v41, s28
    v_perm_b32 v91, v47, v45, s28
    v_perm_b32 v92, v35, v33, s29
    v_perm_b32 v93, v39, v37, s29
    v_perm_b32 v94, v43, v41, s29
    v_perm_b32 v95, v47, v45, s29
    s_waitcnt vmcnt(8)
    v_perm_b32 v32, v50, v48, s28
    v_perm_b32 v33, v54, v52, s28
    v_perm_b32 v34, v58, v56, s28
    v_perm_b32 v35, v62, v60, s28
    v_perm_b32 v36, v50, v48, s29
    v_perm_b32 v37, v54, v52, s29
    v_perm_b32 v38, v58, v56, s29
    v_perm_b32 v39, v62, v60, s29
    v_perm_b32 v40, v51, v49, s28
    v_perm_b32 v41, v55, v53, s28
    v_perm_b32 v42, v59, v57, s28
    v_perm_b32 v43, v63, v61, s28
    v_perm_b32 v44, v51, v49, s29
    v_perm_b32 v45, v55, v53, s29
    v_perm_b32 v46, v59, v57, s29
    v_perm_b32 v47, v63, v61, s29
    s_setprio 2
K4_G_POLL:
    ds_read_b32 v18, v7 offset:1024
    s_waitcnt lgkmcnt(0)
    v_cmp_eq_u32 vcc, 0, v18
    s_cbranch_vccnz K4_G_POLL
    v_and_b32 v18, 0x7ff, v18
    v_sub_u32 v18, 2047, v18
    v_mul_u32_u24 v18, 1152, v18
    v_lshl_add_u32 v18, v3, 4, v18
    s_mul_i32 s18, s17, 192
    buffer_load_dwordx4 v[20:23], v18, s[12:15], s18 offen offset:0
    buffer_load_dwordx4 v[24:27], v18, s[12:15], s18 offen offset:64
    buffer_load_dwordx4 v[28:31], v18, s[12:15], s18 offen offset:128
    s_waitcnt vmcnt(3)
    v_perm_b32 v48, v66, v64, s28
    v_perm_b32 v49, v70, v68, s28
    v_perm_b32 v50, v74, v72, s28
    v_perm_b32 v51, v78, v76, s28
    v_perm_b32 v52, v66, v64, s29
    v_perm_b32 v53, v70, v68, s29
    v_perm_b32 v54, v74, v72, s29
    v_perm_b32 v55, v78, v76, s29
    v_perm_b32 v56, v67, v65, s28
    v_perm_b32 v57, v71, v69, s28
    v_perm_b32 v58, v75, v73, s28
    v_perm_b32 v59, v79, v77, s28
    v_perm_b32 v60, v67, v65, s29
    v_perm_b32 v61, v71, v69, s29
    v_perm_b32 v62, v75, v73, s29
    v_perm_b32 v63, v79, v77, s29
    s_lshl_b32 s18, s17, 11
    v_lshl_add_u32 v16, v1, 4, s18
    s_waitcnt vmcnt(2)
    v_mfma_f32_16x16x32_bf16 v[64:67], v[20:23], v[80:83], 0
    v_mfma_f32_16x16x32_bf16 v[68:71], v[20:23], v[84:87], 0
    v_mfma_f32_16x16x32_bf16 v[72:75], v[20:23], v[88:91], 0
    v_mfma_f32_16x16x32_bf16 v[76:79], v[20:23], v[92:95], 0
    s_waitcnt vmcnt(1)
    v_mfma_f32_16x16x32_bf16 v[64:67], v[24:27], v[32:35], v[64:67]
    v_mfma_f32_16x16x32_bf16 v[68:71], v[24:27], v[36:39], v[68:71]
    v_mfma_f32_16x16x32_bf16 v[72:75], v[24:27], v[40:43], v[72:75]
    v_mfma_f32_16x16x32_bf16 v[76:79], v[24:27], v[44:47], v[76:79]
    s_waitcnt vmcnt(0)
    v_mfma_f32_16x16x32_bf16 v[64:67], v[28:31], v[48:51], v[64:67]
    v_mfma_f32_16x16x32_bf16 v[68:71], v[28:31], v[52:55], v[68:71]
    v_mfma_f32_16x16x32_bf16 v[72:75], v[28:31], v[56:59], v[72:75]
    v_mfma_f32_16x16x32_bf16 v[76:79], v[28:31], v[60:63], v[76:79]
    s_lshl_b32 s18, s17, 6
    v_add_u32 v4, s18, v1
    v_lshrrev_b32 v8, 5, v4
    v_and_b32 v9, 31, v4
    v_and_b32 v10, 3, v9
    v_lshlrev_b32 v10, 9, v10
    v_lshrrev_b32 v11, 2, v9
    v_lshl_add_u32 v10, v11, 4, v10
    v_lshrrev_b32 v11, 2, v8
    v_lshl_add_u32 v10, v11, 8, v10
    v_and_b32 v11, 3, v8
    v_lshl_add_u32 v10, v11, 2, v10
    v_lshlrev_b32 v11, 1, v4
    s_mov_b32 exec_lo, -1
    s_mov_b32 exec_hi, 0
    ds_write_b128 v16, v[64:67] offset:2048
    ds_write_b128 v16, v[68:71] offset:2560
    ds_write_b128 v16, v[72:75] offset:3072
    ds_write_b128 v16, v[76:79] offset:3584
    s_mov_b64 exec, -1
    s_waitcnt lgkmcnt(0)
    s_barrier
    s_cmp_ge_u32 s17, 4
    s_cbranch_scc1 K4_NOACT
    ds_read_b32 v32, v10 offset:2048
    ds_read_b32 v33, v10 offset:2176
    ds_read_b32 v34, v10 offset:4096
    ds_read_b32 v35, v10 offset:4224
    ds_read_b32 v36, v10 offset:6144
    ds_read_b32 v37, v10 offset:6272
    ds_read_b32 v38, v10 offset:8192
    ds_read_b32 v39, v10 offset:8320
    ds_read_b32 v40, v10 offset:10240
    ds_read_b32 v41, v10 offset:10368
    ds_read_b32 v42, v10 offset:12288
    ds_read_b32 v43, v10 offset:12416
    s_waitcnt lgkmcnt(8)
    v_pk_add_f32 v[32:33], v[32:33], v[34:35]
    s_waitcnt lgkmcnt(4)
    v_pk_add_f32 v[36:37], v[36:37], v[38:39]
    s_waitcnt lgkmcnt(0)
    v_pk_add_f32 v[40:41], v[40:41], v[42:43]
    v_pk_add_f32 v[32:33], v[32:33], v[36:37]
    v_pk_add_f32 v[32:33], v[32:33], v[40:41]
    v_cvt_pk_bf16_f32 v34, v32, v33
    v_lshlrev_b32 v32, 16, v34
    v_and_b32 v33, 0xffff0000, v34
    v_mul_f32 v34, 0xbfb8aa3b, v32
    v_exp_f32 v34, v34
    s_nop 0
    v_add_f32 v34, 1.0, v34
    v_rcp_f32 v34, v34
    s_nop 0
    v_mul_f32 v34, v32, v34
    v_cvt_pk_bf16_f32 v34, v34, v34
    v_lshlrev_b32 v34, 16, v34
    v_mul_f32 v34, v34, v33
    v_cvt_pk_bf16_f32 v34, v34, v34
    ds_write_b16 v11, v34 offset:1088
    s_waitcnt lgkmcnt(0)
K4_NOACT:
    s_barrier
K4_END:
    s_endpgm
.globl k5_kernel
.p2align 8
.type k5_kernel,@function
k5_kernel:
    s_cmp_ge_u32 s2, 72
    s_cbranch_scc1 K5_END
    s_load_dwordx2 s[6:7], s[0:1], 128
    s_load_dwordx2 s[34:35], s[0:1], 112
    v_and_b32 v1, 15, v0
    v_lshrrev_b32 v2, 4, v0
    v_mul_u32_u24 v3, 165888, v2
    v_lshl_add_u32 v3, v1, 4, v3
    v_lshrrev_b32 v4, 2, v0
    s_lshl_b32 s3, s2, 4
    v_add_u32 v4, s3, v4
    v_and_b32 v5, 3, v0
    v_bfe_u32 v6, v4, 4, 1
    v_lshl_add_u32 v5, v6, 2, v5
    v_lshrrev_b32 v6, 7, v4
    v_lshlrev_b32 v6, 6, v6
    v_and_b32 v7, 15, v4
    v_lshl_add_u32 v6, v7, 2, v6
    v_bfe_u32 v7, v4, 5, 2
    v_add_u32 v6, v6, v7
    v_mul_u32_u24 v46, 2304, v5
    v_lshl_add_u32 v46, v6, 2, v46
    v_lshlrev_b32 v5, 2, v5
    s_lshl_b32 s3, s2, 8
    s_waitcnt lgkmcnt(0)
    s_add_u32 s8, s6, 0xd00000
    s_addc_u32 s9, s7, 0
    s_mov_b32 s10, 0x288000
    s_mov_b32 s11, 0x20000
    buffer_load_dwordx4 v[8:11], v3, s[8:11], s3 offen
    s_add_u32 s3, s3, 18432
    buffer_load_dwordx4 v[12:15], v3, s[8:11], s3 offen
    s_add_u32 s3, s3, 18432
    buffer_load_dwordx4 v[16:19], v3, s[8:11], s3 offen
    s_add_u32 s3, s3, 18432
    buffer_load_dwordx4 v[20:23], v3, s[8:11], s3 offen
    s_add_u32 s3, s3, 18432
    buffer_load_dwordx4 v[24:27], v3, s[8:11], s3 offen
    s_add_u32 s3, s3, 18432
    buffer_load_dwordx4 v[28:31], v3, s[8:11], s3 offen
    s_add_u32 s3, s3, 18432
    buffer_load_dwordx4 v[32:35], v3, s[8:11], s3 offen
    s_add_u32 s3, s3, 18432
    buffer_load_dwordx4 v[36:39], v3, s[8:11], s3 offen
    s_add_u32 s3, s3, 18432
    buffer_load_dwordx4 v[40:43], v3, s[8:11], s3 offen
    s_add_u32 s12, s6, 0xc20000
    s_addc_u32 s13, s7, 0
    s_mov_b32 s14, 0x4820
    s_mov_b32 s15, 0x20000
    s_mov_b32 s28, s34
    s_mov_b32 s29, s35
    s_mov_b32 s30, 0x240000
    s_mov_b32 s31, 0x20000
    buffer_load_dword v44, v5, s[12:15], 0 offen
    buffer_load_dword v48, v46, s[12:15], 0 offen offset:32
    v_lshlrev_b32 v7, 4, v0
    s_waitcnt vmcnt(9)
    v_pk_add_f32 v[8:9], v[8:9], v[12:13]
    v_pk_add_f32 v[10:11], v[10:11], v[14:15]
    s_waitcnt vmcnt(8)
    v_pk_add_f32 v[8:9], v[8:9], v[16:17]
    v_pk_add_f32 v[10:11], v[10:11], v[18:19]
    s_waitcnt vmcnt(7)
    v_pk_add_f32 v[8:9], v[8:9], v[20:21]
    v_pk_add_f32 v[10:11], v[10:11], v[22:23]
    s_waitcnt vmcnt(6)
    v_pk_add_f32 v[8:9], v[8:9], v[24:25]
    v_pk_add_f32 v[10:11], v[10:11], v[26:27]
    s_waitcnt vmcnt(5)
    v_pk_add_f32 v[8:9], v[8:9], v[28:29]
    v_pk_add_f32 v[10:11], v[10:11], v[30:31]
    s_waitcnt vmcnt(4)
    v_pk_add_f32 v[8:9], v[8:9], v[32:33]
    v_pk_add_f32 v[10:11], v[10:11], v[34:35]
    s_waitcnt vmcnt(3)
    v_pk_add_f32 v[8:9], v[8:9], v[36:37]
    v_pk_add_f32 v[10:11], v[10:11], v[38:39]
    s_waitcnt vmcnt(2)
    v_pk_add_f32 v[8:9], v[8:9], v[40:41]
    v_pk_add_f32 v[10:11], v[10:11], v[42:43]
    ds_write_b128 v7, v[8:11]
    s_waitcnt vmcnt(0)
    v_and_b32 v45, 0x7ff, v44
    v_sub_u32 v45, 2047, v45
    v_mul_u32_u24 v46, 1152, v45
    v_lshl_add_u32 v46, v6, 1, v46
    v_ashrrev_i32 v47, 31, v44
    v_not_b32 v47, v47
    v_or_b32 v47, 0x80000000, v47
    v_xor_b32 v47, v44, v47
    v_and_b32 v47, 0xffff0000, v47
    v_mul_f32 v47, 0xbfb8aa3b, v47
    v_exp_f32 v47, v47
    s_nop 0
    v_add_f32 v47, 1.0, v47
    v_rcp_f32 v47, v47
    s_nop 0
    v_cvt_pk_bf16_f32 v47, v47, v47
    v_lshlrev_b32 v47, 16, v47
    v_lshlrev_b32 v50, 16, v48
    v_and_b32 v51, 0xffff0000, v48
    v_lshlrev_b32 v7, 2, v0
    s_waitcnt lgkmcnt(0)
    s_barrier
    v_readfirstlane_b32 s3, v0
    s_cmp_ge_u32 s3, 64
    s_cbranch_scc1 K5_END1
    ds_read2st64_b32 v[8:9], v7 offset0:0 offset1:1
    ds_read2st64_b32 v[10:11], v7 offset0:2 offset1:3
    ds_read2st64_b32 v[12:13], v7 offset0:4 offset1:5
    ds_read2st64_b32 v[14:15], v7 offset0:6 offset1:7
    ds_read2st64_b32 v[16:17], v7 offset0:8 offset1:9
    ds_read2st64_b32 v[18:19], v7 offset0:10 offset1:11
    ds_read2st64_b32 v[20:21], v7 offset0:12 offset1:13
    ds_read2st64_b32 v[22:23], v7 offset0:14 offset1:15
    s_waitcnt lgkmcnt(6)
    v_pk_add_f32 v[8:9], v[8:9], v[10:11]
    s_waitcnt lgkmcnt(5)
    v_pk_add_f32 v[8:9], v[8:9], v[12:13]
    s_waitcnt lgkmcnt(4)
    v_pk_add_f32 v[8:9], v[8:9], v[14:15]
    s_waitcnt lgkmcnt(3)
    v_pk_add_f32 v[8:9], v[8:9], v[16:17]
    s_waitcnt lgkmcnt(2)
    v_pk_add_f32 v[8:9], v[8:9], v[18:19]
    s_waitcnt lgkmcnt(1)
    v_pk_add_f32 v[8:9], v[8:9], v[20:21]
    s_waitcnt lgkmcnt(0)
    v_pk_add_f32 v[8:9], v[8:9], v[22:23]
    v_add_f32 v8, v8, v9
    v_cvt_pk_bf16_f32 v8, v8, v8
    v_lshlrev_b32 v8, 16, v8
    v_mul_f32 v8, v8, v47
    v_cvt_pk_bf16_f32 v8, v8, v8
    v_lshlrev_b32 v8, 16, v8
    v_add_f32 v8, v8, v50
    v_cvt_pk_bf16_f32 v8, v8, v8
    v_lshlrev_b32 v8, 16, v8
    v_add_f32 v8, v8, v51
    v_cvt_pk_bf16_f32 v8, v8, v8
    buffer_store_short v8, v46, s[28:31], 0 offen
K5_END1:
K5_END:
    s_endpgm
.section .rodata,"a"
.p2align 6
.amdhsa_kernel k1_kernel
  .amdhsa_next_free_vgpr 108
  .amdhsa_next_free_sgpr 40
  .amdhsa_accum_offset 108
  .amdhsa_group_segment_fixed_size 0
  .amdhsa_kernarg_size 136
  .amdhsa_user_sgpr_count 2
  .amdhsa_user_sgpr_kernarg_segment_ptr 1
  .amdhsa_system_sgpr_workgroup_id_x 1
  .amdhsa_float_denorm_mode_32 3
.end_amdhsa_kernel
.p2align 6
.amdhsa_kernel k2_kernel
  .amdhsa_next_free_vgpr 152
  .amdhsa_next_free_sgpr 40
  .amdhsa_accum_offset 152
  .amdhsa_group_segment_fixed_size 0
  .amdhsa_kernarg_size 136
  .amdhsa_user_sgpr_count 2
  .amdhsa_user_sgpr_kernarg_segment_ptr 1
  .amdhsa_system_sgpr_workgroup_id_x 1
  .amdhsa_float_denorm_mode_32 3
.end_amdhsa_kernel
.p2align 6
.amdhsa_kernel k3_kernel
  .amdhsa_next_free_vgpr 80
  .amdhsa_next_free_sgpr 48
  .amdhsa_accum_offset 80
  .amdhsa_group_segment_fixed_size 0
  .amdhsa_kernarg_size 136
  .amdhsa_user_sgpr_count 2
  .amdhsa_user_sgpr_kernarg_segment_ptr 1
  .amdhsa_system_sgpr_workgroup_id_x 1
  .amdhsa_float_denorm_mode_32 3
.end_amdhsa_kernel
.p2align 6
.amdhsa_kernel k4_kernel
  .amdhsa_next_free_vgpr 96
  .amdhsa_next_free_sgpr 48
  .amdhsa_accum_offset 96
  .amdhsa_group_segment_fixed_size 0
  .amdhsa_kernarg_size 136
  .amdhsa_user_sgpr_count 2
  .amdhsa_user_sgpr_kernarg_segment_ptr 1
  .amdhsa_system_sgpr_workgroup_id_x 1
  .amdhsa_float_denorm_mode_32 3
.end_amdhsa_kernel
.p2align 6
.amdhsa_kernel k5_kernel
  .amdhsa_next_free_vgpr 52
  .amdhsa_next_free_sgpr 40
  .amdhsa_accum_offset 52
  .amdhsa_group_segment_fixed_size 0
  .amdhsa_kernarg_size 136
  .amdhsa_user_sgpr_count 2
  .amdhsa_user_sgpr_kernarg_segment_ptr 1
  .amdhsa_system_sgpr_workgroup_id_x 1
  .amdhsa_float_denorm_mode_32 3
.end_amdhsa_kernel
```

```asm
; @launch kernel=k1_kernel grid=(832,1,1) block=(256,1,1) lds=36352
; @launch kernel=k2_kernel grid=(576,1,1) block=(256,1,1) lds=47360
; @launch kernel=k3_kernel grid=(256,1,1) block=(256,1,1) lds=9216
; @launch kernel=k4_kernel grid=(144,1,1) block=(960,1,1) lds=23552
; @launch kernel=k5_kernel grid=(72,1,1) block=(256,1,1) lds=4096
.amdgcn_target "amdgcn-amd-amdhsa--gfx950"
.text
.globl k1_kernel
.p2align 8
.type k1_kernel,@function
k1_kernel:
    s_cmp_ge_u32 s2, 832
    s_cbranch_scc1 K1_END
    s_cmp_ge_u32 s2, 256
    s_cbranch_scc1 K1_KGEN
    s_load_dwordx2 s[4:5], s[0:1], 0
    s_load_dwordx2 s[6:7], s[0:1], 128
    v_lshrrev_b32 v1, 5, v0
    v_and_b32 v2, 31, v0
    v_mul_u32_u24 v3, 1152, v1
    v_lshl_add_u32 v3, v2, 2, v3
    s_and_b32 s16, s2, 7
    s_lshl_b32 s16, s16, 5
    s_lshr_b32 s3, s2, 3
    s_add_u32 s18, s3, s16
    s_mul_i32 s3, s18, 9216
    s_lshl_b32 s18, s18, 4
    s_waitcnt lgkmcnt(0)
    s_mov_b32 s8, s4
    s_mov_b32 s9, s5
    s_mov_b32 s10, 0x240000
    s_mov_b32 s11, 0x20000
    s_mov_b32 s12, s6
    s_mov_b32 s13, s7
    s_mov_b32 s14, 0x240000
    s_mov_b32 s15, 0x20000
    buffer_load_dword v10, v3, s[8:11], s3 offen offset:0
    buffer_load_dword v11, v3, s[8:11], s3 offen offset:128
    buffer_load_dword v12, v3, s[8:11], s3 offen offset:256
    buffer_load_dword v13, v3, s[8:11], s3 offen offset:384
    buffer_load_dword v14, v3, s[8:11], s3 offen offset:512
    buffer_load_dword v15, v3, s[8:11], s3 offen offset:640
    buffer_load_dword v16, v3, s[8:11], s3 offen offset:768
    buffer_load_dword v17, v3, s[8:11], s3 offen offset:896
    buffer_load_dword v18, v3, s[8:11], s3 offen offset:1024
    v_lshrrev_b32 v4, 6, v0
    v_mul_u32_u24 v4, 2304, v4
    v_lshl_add_u32 v4, v2, 3, v4
    v_and_b32 v5, 1, v1
    v_lshl_add_u32 v4, v5, 2, v4
    v_mul_u32_u24 v5, 0x020202, v5
    v_lshlrev_b32 v6, 25, v1
    v_and_b32 v6, 0x02000000, v6
    v_or_b32 v5, v5, v6
    v_add_u32 v5, 0x05040100, v5
    s_waitcnt vmcnt(8)
    v_lshlrev_b32 v20, 16, v10
    v_and_b32 v21, 0xffff0000, v10
    s_waitcnt vmcnt(7)
    v_lshlrev_b32 v22, 16, v11
    v_and_b32 v23, 0xffff0000, v11
    s_waitcnt vmcnt(6)
    v_lshlrev_b32 v24, 16, v12
    v_and_b32 v25, 0xffff0000, v12
    s_waitcnt vmcnt(5)
    v_lshlrev_b32 v26, 16, v13
    v_and_b32 v27, 0xffff0000, v13
    s_waitcnt vmcnt(4)
    v_lshlrev_b32 v28, 16, v14
    v_and_b32 v29, 0xffff0000, v14
    s_waitcnt vmcnt(3)
    v_lshlrev_b32 v30, 16, v15
    v_and_b32 v31, 0xffff0000, v15
    s_waitcnt vmcnt(2)
    v_lshlrev_b32 v32, 16, v16
    v_and_b32 v33, 0xffff0000, v16
    s_waitcnt vmcnt(1)
    v_lshlrev_b32 v34, 16, v17
    v_and_b32 v35, 0xffff0000, v17
    s_waitcnt vmcnt(0)
    v_lshlrev_b32 v36, 16, v18
    v_and_b32 v37, 0xffff0000, v18
    v_pk_add_f32 v[44:45], v[20:21], v[22:23]
    v_pk_add_f32 v[46:47], v[24:25], v[26:27]
    v_pk_add_f32 v[44:45], v[44:45], v[28:29]
    v_pk_add_f32 v[46:47], v[46:47], v[30:31]
    v_pk_add_f32 v[44:45], v[44:45], v[32:33]
    v_pk_add_f32 v[46:47], v[46:47], v[34:35]
    v_pk_add_f32 v[44:45], v[44:45], v[36:37]
    v_pk_add_f32 v[44:45], v[44:45], v[46:47]
    v_add_f32 v44, v44, v45
    s_nop 1
    v_add_f32_dpp v44, v44, v44 row_ror:8 row_mask:0xf bank_mask:0xf
    s_nop 1
    v_add_f32_dpp v44, v44, v44 row_ror:4 row_mask:0xf bank_mask:0xf
    s_nop 1
    v_add_f32_dpp v44, v44, v44 row_ror:2 row_mask:0xf bank_mask:0xf
    s_nop 1
    v_add_f32_dpp v44, v44, v44 row_ror:1 row_mask:0xf bank_mask:0xf
    v_mov_b32 v46, v44
    s_nop 1
    v_permlane16_swap_b32 v44, v46
    v_add_f32 v44, v44, v46
    v_mul_f32 v48, 0x3ae38e39, v44
    v_mov_b32 v49, v48
    v_cvt_pk_bf16_f32 v40, v48, v48
    v_and_b32 v40, 0xffff0000, v40
    v_mov_b32 v41, v40
    v_pk_add_f32 v[42:43], v[20:21], v[48:49] neg_lo:[0,1] neg_hi:[0,1]
    v_pk_mul_f32 v[44:45], v[42:43], v[42:43]
    v_pk_add_f32 v[42:43], v[22:23], v[48:49] neg_lo:[0,1] neg_hi:[0,1]
    v_pk_mul_f32 v[46:47], v[42:43], v[42:43]
    v_pk_add_f32 v[42:43], v[24:25], v[48:49] neg_lo:[0,1] neg_hi:[0,1]
    v_pk_fma_f32 v[44:45], v[42:43], v[42:43], v[44:45]
    v_pk_add_f32 v[42:43], v[26:27], v[48:49] neg_lo:[0,1] neg_hi:[0,1]
    v_pk_fma_f32 v[46:47], v[42:43], v[42:43], v[46:47]
    v_pk_add_f32 v[42:43], v[28:29], v[48:49] neg_lo:[0,1] neg_hi:[0,1]
    v_pk_fma_f32 v[44:45], v[42:43], v[42:43], v[44:45]
    v_pk_add_f32 v[42:43], v[30:31], v[48:49] neg_lo:[0,1] neg_hi:[0,1]
    v_pk_fma_f32 v[46:47], v[42:43], v[42:43], v[46:47]
    v_pk_add_f32 v[42:43], v[32:33], v[48:49] neg_lo:[0,1] neg_hi:[0,1]
    v_pk_fma_f32 v[44:45], v[42:43], v[42:43], v[44:45]
    v_pk_add_f32 v[42:43], v[34:35], v[48:49] neg_lo:[0,1] neg_hi:[0,1]
    v_pk_fma_f32 v[46:47], v[42:43], v[42:43], v[46:47]
    v_pk_add_f32 v[42:43], v[36:37], v[48:49] neg_lo:[0,1] neg_hi:[0,1]
    v_pk_fma_f32 v[44:45], v[42:43], v[42:43], v[44:45]
    v_pk_add_f32 v[44:45], v[44:45], v[46:47]
    v_add_f32 v44, v44, v45
    s_nop 1
    v_add_f32_dpp v44, v44, v44 row_ror:8 row_mask:0xf bank_mask:0xf
    s_nop 1
    v_add_f32_dpp v44, v44, v44 row_ror:4 row_mask:0xf bank_mask:0xf
    s_nop 1
    v_add_f32_dpp v44, v44, v44 row_ror:2 row_mask:0xf bank_mask:0xf
    s_nop 1
    v_add_f32_dpp v44, v44, v44 row_ror:1 row_mask:0xf bank_mask:0xf
    v_mov_b32 v46, v44
    s_nop 1
    v_permlane16_swap_b32 v44, v46
    v_add_f32 v44, v44, v46
    v_mul_f32 v44, 0x3ae38e39, v44
    v_cvt_pk_bf16_f32 v44, v44, v44
    v_and_b32 v44, 0xffff0000, v44
    v_add_f32 v44, 0x3727c5ac, v44
    v_cvt_pk_bf16_f32 v44, v44, v44
    v_and_b32 v44, 0xffff0000, v44
    v_sqrt_f32 v44, v44
    s_nop 0
    v_cvt_pk_bf16_f32 v44, v44, v44
    v_and_b32 v44, 0xffff0000, v44
    v_rcp_f32 v42, v44
    s_nop 0
    v_mov_b32 v43, v42
    v_pk_add_f32 v[44:45], v[20:21], v[40:41] neg_lo:[0,1] neg_hi:[0,1]
    v_cvt_pk_bf16_f32 v46, v44, v45
    v_lshlrev_b32 v44, 16, v46
    v_and_b32 v45, 0xffff0000, v46
    v_pk_mul_f32 v[44:45], v[44:45], v[42:43]
    v_cvt_pk_bf16_f32 v46, v44, v45
    v_lshlrev_b32 v44, 16, v46
    v_and_b32 v45, 0xffff0000, v46
    v_cvt_pk_f16_f32 v46, v44, v45
    v_mov_b32 v47, v46
    s_nop 1
    v_permlane32_swap_b32 v46, v47
    v_perm_b32 v10, v47, v46, v5
    ds_write_b32 v4, v10 offset:0
    v_pk_add_f32 v[44:45], v[22:23], v[40:41] neg_lo:[0,1] neg_hi:[0,1]
    v_cvt_pk_bf16_f32 v46, v44, v45
    v_lshlrev_b32 v44, 16, v46
    v_and_b32 v45, 0xffff0000, v46
    v_pk_mul_f32 v[44:45], v[44:45], v[42:43]
    v_cvt_pk_bf16_f32 v46, v44, v45
    v_lshlrev_b32 v44, 16, v46
    v_and_b32 v45, 0xffff0000, v46
    v_cvt_pk_f16_f32 v46, v44, v45
    v_mov_b32 v47, v46
    s_nop 1
    v_permlane32_swap_b32 v46, v47
    v_perm_b32 v11, v47, v46, v5
    ds_write_b32 v4, v11 offset:256
    v_pk_add_f32 v[44:45], v[24:25], v[40:41] neg_lo:[0,1] neg_hi:[0,1]
    v_cvt_pk_bf16_f32 v46, v44, v45
    v_lshlrev_b32 v44, 16, v46
    v_and_b32 v45, 0xffff0000, v46
    v_pk_mul_f32 v[44:45], v[44:45], v[42:43]
    v_cvt_pk_bf16_f32 v46, v44, v45
    v_lshlrev_b32 v44, 16, v46
    v_and_b32 v45, 0xffff0000, v46
    v_cvt_pk_f16_f32 v46, v44, v45
    v_mov_b32 v47, v46
    s_nop 1
    v_permlane32_swap_b32 v46, v47
    v_perm_b32 v12, v47, v46, v5
    ds_write_b32 v4, v12 offset:512
    v_pk_add_f32 v[44:45], v[26:27], v[40:41] neg_lo:[0,1] neg_hi:[0,1]
    v_cvt_pk_bf16_f32 v46, v44, v45
    v_lshlrev_b32 v44, 16, v46
    v_and_b32 v45, 0xffff0000, v46
    v_pk_mul_f32 v[44:45], v[44:45], v[42:43]
    v_cvt_pk_bf16_f32 v46, v44, v45
    v_lshlrev_b32 v44, 16, v46
    v_and_b32 v45, 0xffff0000, v46
    v_cvt_pk_f16_f32 v46, v44, v45
    v_mov_b32 v47, v46
    s_nop 1
    v_permlane32_swap_b32 v46, v47
    v_perm_b32 v13, v47, v46, v5
    ds_write_b32 v4, v13 offset:768
    v_pk_add_f32 v[44:45], v[28:29], v[40:41] neg_lo:[0,1] neg_hi:[0,1]
    v_cvt_pk_bf16_f32 v46, v44, v45
    v_lshlrev_b32 v44, 16, v46
    v_and_b32 v45, 0xffff0000, v46
    v_pk_mul_f32 v[44:45], v[44:45], v[42:43]
    v_cvt_pk_bf16_f32 v46, v44, v45
    v_lshlrev_b32 v44, 16, v46
    v_and_b32 v45, 0xffff0000, v46
    v_cvt_pk_f16_f32 v46, v44, v45
    v_mov_b32 v47, v46
    s_nop 1
    v_permlane32_swap_b32 v46, v47
    v_perm_b32 v14, v47, v46, v5
    ds_write_b32 v4, v14 offset:1024
    v_pk_add_f32 v[44:45], v[30:31], v[40:41] neg_lo:[0,1] neg_hi:[0,1]
    v_cvt_pk_bf16_f32 v46, v44, v45
    v_lshlrev_b32 v44, 16, v46
    v_and_b32 v45, 0xffff0000, v46
    v_pk_mul_f32 v[44:45], v[44:45], v[42:43]
    v_cvt_pk_bf16_f32 v46, v44, v45
    v_lshlrev_b32 v44, 16, v46
    v_and_b32 v45, 0xffff0000, v46
    v_cvt_pk_f16_f32 v46, v44, v45
    v_mov_b32 v47, v46
    s_nop 1
    v_permlane32_swap_b32 v46, v47
    v_perm_b32 v15, v47, v46, v5
    ds_write_b32 v4, v15 offset:1280
    v_pk_add_f32 v[44:45], v[32:33], v[40:41] neg_lo:[0,1] neg_hi:[0,1]
    v_cvt_pk_bf16_f32 v46, v44, v45
    v_lshlrev_b32 v44, 16, v46
    v_and_b32 v45, 0xffff0000, v46
    v_pk_mul_f32 v[44:45], v[44:45], v[42:43]
    v_cvt_pk_bf16_f32 v46, v44, v45
    v_lshlrev_b32 v44, 16, v46
    v_and_b32 v45, 0xffff0000, v46
    v_cvt_pk_f16_f32 v46, v44, v45
    v_mov_b32 v47, v46
    s_nop 1
    v_permlane32_swap_b32 v46, v47
    v_perm_b32 v16, v47, v46, v5
    ds_write_b32 v4, v16 offset:1536
    v_pk_add_f32 v[44:45], v[34:35], v[40:41] neg_lo:[0,1] neg_hi:[0,1]
    v_cvt_pk_bf16_f32 v46, v44, v45
    v_lshlrev_b32 v44, 16, v46
    v_and_b32 v45, 0xffff0000, v46
    v_pk_mul_f32 v[44:45], v[44:45], v[42:43]
    v_cvt_pk_bf16_f32 v46, v44, v45
    v_lshlrev_b32 v44, 16, v46
    v_and_b32 v45, 0xffff0000, v46
    v_cvt_pk_f16_f32 v46, v44, v45
    v_mov_b32 v47, v46
    s_nop 1
    v_permlane32_swap_b32 v46, v47
    v_perm_b32 v17, v47, v46, v5
    ds_write_b32 v4, v17 offset:1792
    v_pk_add_f32 v[44:45], v[36:37], v[40:41] neg_lo:[0,1] neg_hi:[0,1]
    v_cvt_pk_bf16_f32 v46, v44, v45
    v_lshlrev_b32 v44, 16, v46
    v_and_b32 v45, 0xffff0000, v46
    v_pk_mul_f32 v[44:45], v[44:45], v[42:43]
    v_cvt_pk_bf16_f32 v46, v44, v45
    v_lshlrev_b32 v44, 16, v46
    v_and_b32 v45, 0xffff0000, v46
    v_cvt_pk_f16_f32 v46, v44, v45
    v_mov_b32 v47, v46
    s_nop 1
    v_permlane32_swap_b32 v46, v47
    v_perm_b32 v18, v47, v46, v5
    ds_write_b32 v4, v18 offset:2048
    s_waitcnt lgkmcnt(0)
    s_barrier
    v_lshlrev_b32 v6, 2, v0
    v_lshlrev_b32 v7, 12, v0
    v_readfirstlane_b32 s16, v0
    ds_read2st64_b32 v[20:21], v6 offset0:0 offset1:9
    ds_read2st64_b32 v[22:23], v6 offset0:18 offset1:27
    ds_read2st64_b32 v[24:25], v6 offset0:4 offset1:13
    ds_read2st64_b32 v[26:27], v6 offset0:22 offset1:31
    s_cmp_ge_u32 s16, 64
    s_cbranch_scc1 K1_LN_SKIP
    ds_read2st64_b32 v[28:29], v6 offset0:8 offset1:17
    ds_read2st64_b32 v[30:31], v6 offset0:26 offset1:35
    s_add_u32 s17, s18, 0x200000
    s_waitcnt lgkmcnt(0)
    buffer_store_dwordx4 v[28:31], v7, s[12:15], s17 offen
K1_LN_SKIP:
    s_add_u32 s17, s18, 0x100000
    s_waitcnt lgkmcnt(0)
    buffer_store_dwordx4 v[20:23], v7, s[12:15], s18 offen
    buffer_store_dwordx4 v[24:27], v7, s[12:15], s17 offen
    s_endpgm
K1_KGEN:
    s_load_dwordx16 s[16:31], s[0:1], 0
    s_load_dwordx2 s[6:7], s[0:1], 128
    s_sub_u32 s3, s2, 256
    s_and_b32 s4, s3, 7
    s_mul_i32 s4, s4, 72
    s_lshr_b32 s3, s3, 3
    s_add_u32 s3, s3, s4
    v_and_b32 v1, 63, v0
    s_lshl_b32 s4, s3, 8
    v_lshl_add_u32 v2, v1, 2, s4
    s_lshl_b32 s4, s3, 1
    v_mov_b32 v3, s4
    v_readfirstlane_b32 s5, v0
    s_lshr_b32 s5, s5, 6
    s_waitcnt lgkmcnt(0)
    global_load_ushort v16, v3, s[30:31]
    global_load_dword v10, v2, s[18:19]
    global_load_dword v11, v2, s[20:21]
    global_load_dword v12, v2, s[22:23]
    global_load_dword v13, v2, s[24:25]
    global_load_dword v14, v2, s[26:27]
    global_load_dword v15, v2, s[28:29]
    s_add_u32 s8, s6, 0x300000
    s_addc_u32 s9, s7, 0
    s_mov_b32 s10, 0x242400
    s_mov_b32 s11, 0x20000
    s_add_u32 s12, s6, 0xc10000
    s_addc_u32 s13, s7, 0
    s_mov_b32 s14, 0x900
    s_mov_b32 s15, 0x20000
    v_lshlrev_b32 v4, 3, v0
    v_sub_u32 v4, 2047, v4
    v_subrev_u32 v5, 0, v4
    v_subrev_u32 v6, 1, v4
    v_cvt_f32_u32 v7, v5
    v_cvt_f32_u32 v8, v6
    v_cvt_pk_bf16_f32 v7, v7, v8
    v_and_b32 v8, 0xffff, v7
    v_lshrrev_b32 v7, 16, v7
    v_subrev_u32 v8, 0x4280, v8
    v_subrev_u32 v7, 0x4280, v7
    v_cmp_gt_u32 vcc, 128, v5
    s_nop 1
    v_cndmask_b32 v8, v8, v5, vcc
    v_cmp_gt_u32 vcc, 128, v6
    s_nop 1
    v_cndmask_b32 v7, v7, v6, vcc
    v_lshlrev_b32 v100, 1, v8
    v_lshlrev_b32 v101, 1, v7
    v_subrev_u32 v5, 2, v4
    v_subrev_u32 v6, 3, v4
    v_cvt_f32_u32 v7, v5
    v_cvt_f32_u32 v8, v6
    v_cvt_pk_bf16_f32 v7, v7, v8
    v_and_b32 v8, 0xffff, v7
    v_lshrrev_b32 v7, 16, v7
    v_subrev_u32 v8, 0x4280, v8
    v_subrev_u32 v7, 0x4280, v7
    v_cmp_gt_u32 vcc, 128, v5
    s_nop 1
    v_cndmask_b32 v8, v8, v5, vcc
    v_cmp_gt_u32 vcc, 128, v6
    s_nop 1
    v_cndmask_b32 v7, v7, v6, vcc
    v_lshlrev_b32 v102, 1, v8
    v_lshlrev_b32 v103, 1, v7
    v_subrev_u32 v5, 4, v4
    v_subrev_u32 v6, 5, v4
    v_cvt_f32_u32 v7, v5
    v_cvt_f32_u32 v8, v6
    v_cvt_pk_bf16_f32 v7, v7, v8
    v_and_b32 v8, 0xffff, v7
    v_lshrrev_b32 v7, 16, v7
    v_subrev_u32 v8, 0x4280, v8
    v_subrev_u32 v7, 0x4280, v7
    v_cmp_gt_u32 vcc, 128, v5
    s_nop 1
    v_cndmask_b32 v8, v8, v5, vcc
    v_cmp_gt_u32 vcc, 128, v6
    s_nop 1
    v_cndmask_b32 v7, v7, v6, vcc
    v_lshlrev_b32 v104, 1, v8
    v_lshlrev_b32 v105, 1, v7
    v_subrev_u32 v5, 6, v4
    v_subrev_u32 v6, 7, v4
    v_cvt_f32_u32 v7, v5
    v_cvt_f32_u32 v8, v6
    v_cvt_pk_bf16_f32 v7, v7, v8
    v_and_b32 v8, 0xffff, v7
    v_lshrrev_b32 v7, 16, v7
    v_subrev_u32 v8, 0x4280, v8
    v_subrev_u32 v7, 0x4280, v7
    v_cmp_gt_u32 vcc, 128, v5
    s_nop 1
    v_cndmask_b32 v8, v8, v5, vcc
    v_cmp_gt_u32 vcc, 128, v6
    s_nop 1
    v_cndmask_b32 v7, v7, v6, vcc
    v_lshlrev_b32 v106, 1, v8
    v_lshlrev_b32 v107, 1, v7
    s_waitcnt vmcnt(6)
    v_lshlrev_b32 v16, 16, v16
    v_mul_f32 v17, 0x3fb8aa3b, v16
    s_mov_b32 s32, 0x3fb8aa3b
    s_mov_b32 s33, 0x32a57060
    v_fma_f32 v18, v16, s32, -v17
    v_fma_f32 v18, v16, s33, v18
    v_exp_f32 v17, v17
    v_mul_f32 v18, 0x3f317218, v18
    v_fma_f32 v17, v17, v18, v17
    v_cvt_pk_bf16_f32 v17, v17, v17
    v_and_b32 v16, 0xffff0000, v17
    v_mov_b32 v17, v16
    s_waitcnt vmcnt(0)
    v_lshlrev_b32 v20, 16, v10
    v_and_b32 v21, 0xffff0000, v10
    v_lshlrev_b32 v22, 16, v11
    v_and_b32 v23, 0xffff0000, v11
    v_lshlrev_b32 v24, 16, v12
    v_and_b32 v25, 0xffff0000, v12
    v_lshlrev_b32 v26, 16, v13
    v_and_b32 v27, 0xffff0000, v13
    v_lshlrev_b32 v28, 16, v14
    v_and_b32 v29, 0xffff0000, v14
    v_lshlrev_b32 v30, 16, v15
    v_and_b32 v31, 0xffff0000, v15
    v_pk_mul_f32 v[20:21], v[20:21], v[16:17]
    v_pk_mul_f32 v[22:23], v[22:23], v[16:17]
    v_pk_mul_f32 v[24:25], v[24:25], v[16:17]
    v_pk_mul_f32 v[26:27], v[26:27], v[16:17]
    v_pk_mul_f32 v[90:91], v[30:31], v[26:27]
    v_pk_mul_f32 v[92:93], v[30:31], v[24:25]
    v_pk_fma_f32 v[34:35], v[28:29], v[26:27], v[92:93]
    v_pk_fma_f32 v[32:33], v[28:29], v[24:25], v[90:91] neg_lo:[0,0,1] neg_hi:[0,0,1]
    v_max_f32 v36, v20, v21
    s_nop 1
    v_max_f32_dpp v36, v36, v36 row_ror:8 row_mask:0xf bank_mask:0xf
    s_nop 1
    v_max_f32_dpp v36, v36, v36 row_ror:4 row_mask:0xf bank_mask:0xf
    s_nop 1
    v_max_f32_dpp v36, v36, v36 row_ror:2 row_mask:0xf bank_mask:0xf
    s_nop 1
    v_max_f32_dpp v36, v36, v36 row_ror:1 row_mask:0xf bank_mask:0xf
    v_mov_b32 v38, v36
    s_nop 1
    v_permlane16_swap_b32 v36, v38
    v_max_f32 v36, v36, v38
    v_mov_b32 v38, v36
    s_nop 1
    v_permlane32_swap_b32 v36, v38
    v_max_f32 v36, v36, v38
    v_add_f32 v37, abs(v32), abs(v33)
    v_add_f32 v38, abs(v34), abs(v35)
    v_add_f32 v37, v37, v38
    s_nop 1
    v_add_f32_dpp v37, v37, v37 row_ror:8 row_mask:0xf bank_mask:0xf
    s_nop 1
    v_add_f32_dpp v37, v37, v37 row_ror:4 row_mask:0xf bank_mask:0xf
    s_nop 1
    v_add_f32_dpp v37, v37, v37 row_ror:2 row_mask:0xf bank_mask:0xf
    s_nop 1
    v_add_f32_dpp v37, v37, v37 row_ror:1 row_mask:0xf bank_mask:0xf
    v_mov_b32 v38, v37
    s_nop 1
    v_permlane16_swap_b32 v37, v38
    v_add_f32 v37, v37, v38
    v_mov_b32 v38, v37
    s_nop 1
    v_permlane32_swap_b32 v37, v38
    v_add_f32 v37, v37, v38
    v_max_f32 v37, 0x03aa2425, v37
    v_rcp_f32 v38, v37
    s_nop 0
    v_mul_f32 v38, 0x47000000, v38
    v_mov_b32 v39, v38
    v_pk_mul_f32 v[32:33], v[32:33], v[38:39]
    v_pk_mul_f32 v[34:35], v[34:35], v[38:39]
    v_sub_f32 v20, v20, v36
    v_sub_f32 v21, v21, v36
    v_mul_f32 v20, 0x3fb8aa3b, v20
    v_mul_f32 v21, 0x3fb8aa3b, v21
    v_mul_f32 v36, 0x3fb8aa3b, v36
    s_mov_b32 s32, 0x3e22f983
    s_mov_b32 s33, 0x31dc9c88
    s_mul_i32 s4, s5, 8704
    v_lshl_add_u32 v4, v1, 3, s4
    v_and_b32 v5, 15, v1
    v_lshrrev_b32 v6, 4, v1
    v_lshlrev_b32 v7, 3, v5
    s_cmp_eq_u32 s5, 1
    s_cbranch_scc1 K1_J1
    s_cmp_eq_u32 s5, 2
    s_cbranch_scc1 K1_J2
    s_cmp_eq_u32 s5, 3
    s_cbranch_scc1 K1_J3
    v_mul_f32 v90, 0x3f800000, v20
    v_mul_f32 v91, 0x3f800000, v22
    v_exp_f32 v90, v90
    v_mul_f32 v92, s32, v91
    v_rndne_f32 v92, v92
    v_fma_f32 v92, v91, s32, -v92
    v_fma_f32 v92, v91, s33, v92
    v_cos_f32 v91, v92
    v_sin_f32 v92, v92
    v_mul_f32 v40, v90, v91
    v_mul_f32 v42, v90, v92
    v_mul_f32 v90, 0x3f800000, v21
    v_mul_f32 v91, 0x3f800000, v23
    v_exp_f32 v90, v90
    v_mul_f32 v92, s32, v91
    v_rndne_f32 v92, v92
    v_fma_f32 v92, v91, s32, -v92
    v_fma_f32 v92, v91, s33, v92
    v_cos_f32 v91, v92
    v_sin_f32 v92, v92
    v_mul_f32 v41, v90, v91
    v_mul_f32 v43, v90, v92
    v_mul_f32 v90, 0x43000000, v20
    v_mul_f32 v91, 0x43000000, v22
    v_exp_f32 v90, v90
    v_mul_f32 v92, s32, v91
    v_rndne_f32 v92, v92
    v_fma_f32 v92, v91, s32, -v92
    v_fma_f32 v92, v91, s33, v92
    v_cos_f32 v91, v92
    v_sin_f32 v92, v92
    v_mul_f32 v44, v90, v91
    v_mul_f32 v46, v90, v92
    v_mul_f32 v90, 0x43000000, v21
    v_mul_f32 v91, 0x43000000, v23
    v_exp_f32 v90, v90
    v_mul_f32 v92, s32, v91
    v_rndne_f32 v92, v92
    v_fma_f32 v92, v91, s32, -v92
    v_fma_f32 v92, v91, s33, v92
    v_cos_f32 v91, v92
    v_sin_f32 v92, v92
    v_mul_f32 v45, v90, v91
    v_mul_f32 v47, v90, v92
    v_cvt_pk_f16_f32 v94, v32, v34
    v_cvt_pk_f16_f32 v95, v33, v35
    ds_write_b64 v4, v[94:95] offset:0
    v_pk_mul_f32 v[90:91], v[34:35], v[46:47]
    v_pk_mul_f32 v[92:93], v[34:35], v[44:45]
    v_pk_fma_f32 v[62:63], v[32:33], v[46:47], v[92:93]
    v_pk_fma_f32 v[60:61], v[32:33], v[44:45], v[90:91] neg_lo:[0,0,1] neg_hi:[0,0,1]
    v_cvt_pk_f16_f32 v94, v60, v62
    v_cvt_pk_f16_f32 v95, v61, v63
    ds_write_b64 v4, v[94:95] offset:4352
    v_pk_mul_f32 v[90:91], v[34:35], v[42:43]
    v_pk_mul_f32 v[92:93], v[34:35], v[40:41]
    v_pk_fma_f32 v[54:55], v[32:33], v[42:43], v[92:93]
    v_pk_fma_f32 v[52:53], v[32:33], v[40:41], v[90:91] neg_lo:[0,0,1] neg_hi:[0,0,1]
    v_cvt_pk_f16_f32 v94, v52, v54
    v_cvt_pk_f16_f32 v95, v53, v55
    ds_write_b64 v4, v[94:95] offset:544
    v_pk_mul_f32 v[90:91], v[54:55], v[46:47]
    v_pk_mul_f32 v[92:93], v[54:55], v[44:45]
    v_pk_fma_f32 v[62:63], v[52:53], v[46:47], v[92:93]
    v_pk_fma_f32 v[60:61], v[52:53], v[44:45], v[90:91] neg_lo:[0,0,1] neg_hi:[0,0,1]
    v_cvt_pk_f16_f32 v94, v60, v62
    v_cvt_pk_f16_f32 v95, v61, v63
    ds_write_b64 v4, v[94:95] offset:4896
    v_pk_mul_f32 v[90:91], v[54:55], v[42:43]
    v_pk_mul_f32 v[92:93], v[54:55], v[40:41]
    v_pk_fma_f32 v[58:59], v[52:53], v[42:43], v[92:93]
    v_pk_fma_f32 v[56:57], v[52:53], v[40:41], v[90:91] neg_lo:[0,0,1] neg_hi:[0,0,1]
    v_cvt_pk_f16_f32 v94, v56, v58
    v_cvt_pk_f16_f32 v95, v57, v59
    ds_write_b64 v4, v[94:95] offset:1088
    v_pk_mul_f32 v[90:91], v[58:59], v[46:47]
    v_pk_mul_f32 v[92:93], v[58:59], v[44:45]
    v_pk_fma_f32 v[62:63], v[56:57], v[46:47], v[92:93]
    v_pk_fma_f32 v[60:61], v[56:57], v[44:45], v[90:91] neg_lo:[0,0,1] neg_hi:[0,0,1]
    v_cvt_pk_f16_f32 v94, v60, v62
    v_cvt_pk_f16_f32 v95, v61, v63
    ds_write_b64 v4, v[94:95] offset:5440
    v_pk_mul_f32 v[90:91], v[58:59], v[42:43]
    v_pk_mul_f32 v[92:93], v[58:59], v[40:41]
    v_pk_fma_f32 v[54:55], v[56:57], v[42:43], v[92:93]
    v_pk_fma_f32 v[52:53], v[56:57], v[40:41], v[90:91] neg_lo:[0,0,1] neg_hi:[0,0,1]
    v_cvt_pk_f16_f32 v94, v52, v54
    v_cvt_pk_f16_f32 v95, v53, v55
    ds_write_b64 v4, v[94:95] offset:1632
    v_pk_mul_f32 v[90:91], v[54:55], v[46:47]
    v_pk_mul_f32 v[92:93], v[54:55], v[44:45]
    v_pk_fma_f32 v[62:63], v[52:53], v[46:47], v[92:93]
    v_pk_fma_f32 v[60:61], v[52:53], v[44:45], v[90:91] neg_lo:[0,0,1] neg_hi:[0,0,1]
    v_cvt_pk_f16_f32 v94, v60, v62
    v_cvt_pk_f16_f32 v95, v61, v63
    ds_write_b64 v4, v[94:95] offset:5984
    v_pk_mul_f32 v[90:91], v[54:55], v[42:43]
    v_pk_mul_f32 v[92:93], v[54:55], v[40:41]
    v_pk_fma_f32 v[58:59], v[52:53], v[42:43], v[92:93]
    v_pk_fma_f32 v[56:57], v[52:53], v[40:41], v[90:91] neg_lo:[0,0,1] neg_hi:[0,0,1]
    v_cvt_pk_f16_f32 v94, v56, v58
    v_cvt_pk_f16_f32 v95, v57, v59
    ds_write_b64 v4, v[94:95] offset:2176
    v_pk_mul_f32 v[90:91], v[58:59], v[46:47]
    v_pk_mul_f32 v[92:93], v[58:59], v[44:45]
    v_pk_fma_f32 v[62:63], v[56:57], v[46:47], v[92:93]
    v_pk_fma_f32 v[60:61], v[56:57], v[44:45], v[90:91] neg_lo:[0,0,1] neg_hi:[0,0,1]
    v_cvt_pk_f16_f32 v94, v60, v62
    v_cvt_pk_f16_f32 v95, v61, v63
    ds_write_b64 v4, v[94:95] offset:6528
    v_pk_mul_f32 v[90:91], v[58:59], v[42:43]
    v_pk_mul_f32 v[92:93], v[58:59], v[40:41]
    v_pk_fma_f32 v[54:55], v[56:57], v[42:43], v[92:93]
    v_pk_fma_f32 v[52:53], v[56:57], v[40:41], v[90:91] neg_lo:[0,0,1] neg_hi:[0,0,1]
    v_cvt_pk_f16_f32 v94, v52, v54
    v_cvt_pk_f16_f32 v95, v53, v55
    ds_write_b64 v4, v[94:95] offset:2720
    v_pk_mul_f32 v[90:91], v[54:55], v[46:47]
    v_pk_mul_f32 v[92:93], v[54:55], v[44:45]
    v_pk_fma_f32 v[62:63], v[52:53], v[46:47], v[92:93]
    v_pk_fma_f32 v[60:61], v[52:53], v[44:45], v[90:91] neg_lo:[0,0,1] neg_hi:[0,0,1]
    v_cvt_pk_f16_f32 v94, v60, v62
    v_cvt_pk_f16_f32 v95, v61, v63
    ds_write_b64 v4, v[94:95] offset:7072
    v_pk_mul_f32 v[90:91], v[54:55], v[42:43]
    v_pk_mul_f32 v[92:93], v[54:55], v[40:41]
    v_pk_fma_f32 v[58:59], v[52:53], v[42:43], v[92:93]
    v_pk_fma_f32 v[56:57], v[52:53], v[40:41], v[90:91] neg_lo:[0,0,1] neg_hi:[0,0,1]
    v_cvt_pk_f16_f32 v94, v56, v58
    v_cvt_pk_f16_f32 v95, v57, v59
    ds_write_b64 v4, v[94:95] offset:3264
    v_pk_mul_f32 v[90:91], v[58:59], v[46:47]
    v_pk_mul_f32 v[92:93], v[58:59], v[44:45]
    v_pk_fma_f32 v[62:63], v[56:57], v[46:47], v[92:93]
    v_pk_fma_f32 v[60:61], v[56:57], v[44:45], v[90:91] neg_lo:[0,0,1] neg_hi:[0,0,1]
    v_cvt_pk_f16_f32 v94, v60, v62
    v_cvt_pk_f16_f32 v95, v61, v63
    ds_write_b64 v4, v[94:95] offset:7616
    v_pk_mul_f32 v[90:91], v[58:59], v[42:43]
    v_pk_mul_f32 v[92:93], v[58:59], v[40:41]
    v_pk_fma_f32 v[54:55], v[56:57], v[42:43], v[92:93]
    v_pk_fma_f32 v[52:53], v[56:57], v[40:41], v[90:91] neg_lo:[0,0,1] neg_hi:[0,0,1]
    v_cvt_pk_f16_f32 v94, v52, v54
    v_cvt_pk_f16_f32 v95, v53, v55
    ds_write_b64 v4, v[94:95] offset:3808
    v_pk_mul_f32 v[90:91], v[54:55], v[46:47]
    v_pk_mul_f32 v[92:93], v[54:55], v[44:45]
    v_pk_fma_f32 v[62:63], v[52:53], v[46:47], v[92:93]
    v_pk_fma_f32 v[60:61], v[52:53], v[44:45], v[90:91] neg_lo:[0,0,1] neg_hi:[0,0,1]
    v_cvt_pk_f16_f32 v94, v60, v62
    v_cvt_pk_f16_f32 v95, v61, v63
    ds_write_b64 v4, v[94:95] offset:8160
    v_lshrrev_b32 v8, 1, v6
    v_lshl_add_u32 v7, v8, 7, v7
    v_and_b32 v8, 1, v6
    v_lshl_add_u32 v7, v8, 2, v7
    v_mov_b32 v8, 1
    v_mov_b32 v9, 2
    s_branch K1_JOIN
K1_J1:
    v_mul_f32 v90, 0x40000000, v20
    v_mul_f32 v91, 0x40000000, v22
    v_exp_f32 v90, v90
    v_mul_f32 v92, s32, v91
    v_rndne_f32 v92, v92
    v_fma_f32 v92, v91, s32, -v92
    v_fma_f32 v92, v91, s33, v92
    v_cos_f32 v91, v92
    v_sin_f32 v92, v92
    v_mul_f32 v40, v90, v91
    v_mul_f32 v42, v90, v92
    v_mul_f32 v90, 0x40000000, v21
    v_mul_f32 v91, 0x40000000, v23
    v_exp_f32 v90, v90
    v_mul_f32 v92, s32, v91
    v_rndne_f32 v92, v92
    v_fma_f32 v92, v91, s32, -v92
    v_fma_f32 v92, v91, s33, v92
    v_cos_f32 v91, v92
    v_sin_f32 v92, v92
    v_mul_f32 v41, v90, v91
    v_mul_f32 v43, v90, v92
    v_mul_f32 v90, 0x43000000, v20
    v_mul_f32 v91, 0x43000000, v22
    v_exp_f32 v90, v90
    v_mul_f32 v92, s32, v91
    v_rndne_f32 v92, v92
    v_fma_f32 v92, v91, s32, -v92
    v_fma_f32 v92, v91, s33, v92
    v_cos_f32 v91, v92
    v_sin_f32 v92, v92
    v_mul_f32 v44, v90, v91
    v_mul_f32 v46, v90, v92
    v_mul_f32 v90, 0x43000000, v21
    v_mul_f32 v91, 0x43000000, v23
    v_exp_f32 v90, v90
    v_mul_f32 v92, s32, v91
    v_rndne_f32 v92, v92
    v_fma_f32 v92, v91, s32, -v92
    v_fma_f32 v92, v91, s33, v92
    v_cos_f32 v91, v92
    v_sin_f32 v92, v92
    v_mul_f32 v45, v90, v91
    v_mul_f32 v47, v90, v92
    v_mul_f32 v90, 0x43800000, v20
    v_mul_f32 v91, 0x43800000, v22
    v_exp_f32 v90, v90
    v_mul_f32 v92, s32, v91
    v_rndne_f32 v92, v92
    v_fma_f32 v92, v91, s32, -v92
    v_fma_f32 v92, v91, s33, v92
    v_cos_f32 v91, v92
    v_sin_f32 v92, v92
    v_mul_f32 v48, v90, v91
    v_mul_f32 v50, v90, v92
    v_mul_f32 v90, 0x43800000, v21
    v_mul_f32 v91, 0x43800000, v23
    v_exp_f32 v90, v90
    v_mul_f32 v92, s32, v91
    v_rndne_f32 v92, v92
    v_fma_f32 v92, v91, s32, -v92
    v_fma_f32 v92, v91, s33, v92
    v_cos_f32 v91, v92
    v_sin_f32 v92, v92
    v_mul_f32 v49, v90, v91
    v_mul_f32 v51, v90, v92
    v_pk_mul_f32 v[90:91], v[34:35], v[50:51]
    v_pk_mul_f32 v[92:93], v[34:35], v[48:49]
    v_pk_fma_f32 v[54:55], v[32:33], v[50:51], v[92:93]
    v_pk_fma_f32 v[52:53], v[32:33], v[48:49], v[90:91] neg_lo:[0,0,1] neg_hi:[0,0,1]
    v_pk_mul_f32 v[90:91], v[54:55], v[50:51]
    v_pk_mul_f32 v[92:93], v[54:55], v[48:49]
    v_pk_fma_f32 v[66:67], v[52:53], v[50:51], v[92:93]
    v_pk_fma_f32 v[64:65], v[52:53], v[48:49], v[90:91] neg_lo:[0,0,1] neg_hi:[0,0,1]
    v_cvt_pk_f16_f32 v94, v52, v54
    v_cvt_pk_f16_f32 v95, v53, v55
    ds_write_b64 v4, v[94:95] offset:0
    v_pk_mul_f32 v[90:91], v[54:55], v[46:47]
    v_pk_mul_f32 v[92:93], v[54:55], v[44:45]
    v_pk_fma_f32 v[62:63], v[52:53], v[46:47], v[92:93]
    v_pk_fma_f32 v[60:61], v[52:53], v[44:45], v[90:91] neg_lo:[0,0,1] neg_hi:[0,0,1]
    v_cvt_pk_f16_f32 v94, v60, v62
    v_cvt_pk_f16_f32 v95, v61, v63
    ds_write_b64 v4, v[94:95] offset:2176
    v_pk_mul_f32 v[90:91], v[54:55], v[42:43]
    v_pk_mul_f32 v[92:93], v[54:55], v[40:41]
    v_pk_fma_f32 v[58:59], v[52:53], v[42:43], v[92:93]
    v_pk_fma_f32 v[56:57], v[52:53], v[40:41], v[90:91] neg_lo:[0,0,1] neg_hi:[0,0,1]
    v_cvt_pk_f16_f32 v94, v56, v58
    v_cvt_pk_f16_f32 v95, v57, v59
    ds_write_b64 v4, v[94:95] offset:544
    v_pk_mul_f32 v[90:91], v[58:59], v[46:47]
    v_pk_mul_f32 v[92:93], v[58:59], v[44:45]
    v_pk_fma_f32 v[62:63], v[56:57], v[46:47], v[92:93]
    v_pk_fma_f32 v[60:61], v[56:57], v[44:45], v[90:91] neg_lo:[0,0,1] neg_hi:[0,0,1]
    v_cvt_pk_f16_f32 v94, v60, v62
    v_cvt_pk_f16_f32 v95, v61, v63
    ds_write_b64 v4, v[94:95] offset:2720
    v_pk_mul_f32 v[90:91], v[58:59], v[42:43]
    v_pk_mul_f32 v[92:93], v[58:59], v[40:41]
    v_pk_fma_f32 v[54:55], v[56:57], v[42:43], v[92:93]
    v_pk_fma_f32 v[52:53], v[56:57], v[40:41], v[90:91] neg_lo:[0,0,1] neg_hi:[0,0,1]
    v_cvt_pk_f16_f32 v94, v52, v54
    v_cvt_pk_f16_f32 v95, v53, v55
    ds_write_b64 v4, v[94:95] offset:1088
    v_pk_mul_f32 v[90:91], v[54:55], v[46:47]
    v_pk_mul_f32 v[92:93], v[54:55], v[44:45]
    v_pk_fma_f32 v[62:63], v[52:53], v[46:47], v[92:93]
    v_pk_fma_f32 v[60:61], v[52:53], v[44:45], v[90:91] neg_lo:[0,0,1] neg_hi:[0,0,1]
    v_cvt_pk_f16_f32 v94, v60, v62
    v_cvt_pk_f16_f32 v95, v61, v63
    ds_write_b64 v4, v[94:95] offset:3264
    v_pk_mul_f32 v[90:91], v[54:55], v[42:43]
    v_pk_mul_f32 v[92:93], v[54:55], v[40:41]
    v_pk_fma_f32 v[58:59], v[52:53], v[42:43], v[92:93]
    v_pk_fma_f32 v[56:57], v[52:53], v[40:41], v[90:91] neg_lo:[0,0,1] neg_hi:[0,0,1]
    v_cvt_pk_f16_f32 v94, v56, v58
    v_cvt_pk_f16_f32 v95, v57, v59
    ds_write_b64 v4, v[94:95] offset:1632
    v_pk_mul_f32 v[90:91], v[58:59], v[46:47]
    v_pk_mul_f32 v[92:93], v[58:59], v[44:45]
    v_pk_fma_f32 v[62:63], v[56:57], v[46:47], v[92:93]
    v_pk_fma_f32 v[60:61], v[56:57], v[44:45], v[90:91] neg_lo:[0,0,1] neg_hi:[0,0,1]
    v_cvt_pk_f16_f32 v94, v60, v62
    v_cvt_pk_f16_f32 v95, v61, v63
    ds_write_b64 v4, v[94:95] offset:3808
    v_pk_mul_f32 v[90:91], v[42:43], v[42:43]
    v_pk_mul_f32 v[92:93], v[42:43], v[40:41]
    v_pk_fma_f32 v[50:51], v[40:41], v[42:43], v[92:93]
    v_pk_fma_f32 v[48:49], v[40:41], v[40:41], v[90:91] neg_lo:[0,0,1] neg_hi:[0,0,1]
    v_cvt_pk_f16_f32 v94, v64, v66
    v_cvt_pk_f16_f32 v95, v65, v67
    ds_write_b64 v4, v[94:95] offset:4352
    v_pk_mul_f32 v[90:91], v[66:67], v[50:51]
    v_pk_mul_f32 v[92:93], v[66:67], v[48:49]
    v_pk_fma_f32 v[62:63], v[64:65], v[50:51], v[92:93]
    v_pk_fma_f32 v[60:61], v[64:65], v[48:49], v[90:91] neg_lo:[0,0,1] neg_hi:[0,0,1]
    v_cvt_pk_f16_f32 v94, v60, v62
    v_cvt_pk_f16_f32 v95, v61, v63
    ds_write_b64 v4, v[94:95] offset:4896
    v_pk_mul_f32 v[90:91], v[66:67], v[46:47]
    v_pk_mul_f32 v[92:93], v[66:67], v[44:45]
    v_pk_fma_f32 v[54:55], v[64:65], v[46:47], v[92:93]
    v_pk_fma_f32 v[52:53], v[64:65], v[44:45], v[90:91] neg_lo:[0,0,1] neg_hi:[0,0,1]
    v_cvt_pk_f16_f32 v94, v52, v54
    v_cvt_pk_f16_f32 v95, v53, v55
    ds_write_b64 v4, v[94:95] offset:5440
    v_pk_mul_f32 v[90:91], v[54:55], v[50:51]
    v_pk_mul_f32 v[92:93], v[54:55], v[48:49]
    v_pk_fma_f32 v[62:63], v[52:53], v[50:51], v[92:93]
    v_pk_fma_f32 v[60:61], v[52:53], v[48:49], v[90:91] neg_lo:[0,0,1] neg_hi:[0,0,1]
    v_cvt_pk_f16_f32 v94, v60, v62
    v_cvt_pk_f16_f32 v95, v61, v63
    ds_write_b64 v4, v[94:95] offset:5984
    v_pk_mul_f32 v[90:91], v[54:55], v[46:47]
    v_pk_mul_f32 v[92:93], v[54:55], v[44:45]
    v_pk_fma_f32 v[58:59], v[52:53], v[46:47], v[92:93]
    v_pk_fma_f32 v[56:57], v[52:53], v[44:45], v[90:91] neg_lo:[0,0,1] neg_hi:[0,0,1]
    v_cvt_pk_f16_f32 v94, v56, v58
    v_cvt_pk_f16_f32 v95, v57, v59
    ds_write_b64 v4, v[94:95] offset:6528
    v_pk_mul_f32 v[90:91], v[58:59], v[50:51]
    v_pk_mul_f32 v[92:93], v[58:59], v[48:49]
    v_pk_fma_f32 v[62:63], v[56:57], v[50:51], v[92:93]
    v_pk_fma_f32 v[60:61], v[56:57], v[48:49], v[90:91] neg_lo:[0,0,1] neg_hi:[0,0,1]
    v_cvt_pk_f16_f32 v94, v60, v62
    v_cvt_pk_f16_f32 v95, v61, v63
    ds_write_b64 v4, v[94:95] offset:7072
    v_pk_mul_f32 v[90:91], v[58:59], v[46:47]
    v_pk_mul_f32 v[92:93], v[58:59], v[44:45]
    v_pk_fma_f32 v[54:55], v[56:57], v[46:47], v[92:93]
    v_pk_fma_f32 v[52:53], v[56:57], v[44:45], v[90:91] neg_lo:[0,0,1] neg_hi:[0,0,1]
    v_cvt_pk_f16_f32 v94, v52, v54
    v_cvt_pk_f16_f32 v95, v53, v55
    ds_write_b64 v4, v[94:95] offset:7616
    v_pk_mul_f32 v[90:91], v[54:55], v[50:51]
    v_pk_mul_f32 v[92:93], v[54:55], v[48:49]
    v_pk_fma_f32 v[62:63], v[52:53], v[50:51], v[92:93]
    v_pk_fma_f32 v[60:61], v[52:53], v[48:49], v[90:91] neg_lo:[0,0,1] neg_hi:[0,0,1]
    v_cvt_pk_f16_f32 v94, v60, v62
    v_cvt_pk_f16_f32 v95, v61, v63
    ds_write_b64 v4, v[94:95] offset:8160
    v_lshl_add_u32 v8, v6, 7, v7
    v_add_u32 v8, 256, v8
    v_lshl_add_u32 v7, v6, 8, v7
    v_cmp_gt_u32 vcc, 2, v6
    s_nop 1
    v_cndmask_b32 v7, v7, v8, vcc
    v_mov_b32 v8, 4
    v_mov_b32 v9, 0x80
    v_cndmask_b32 v8, v8, 2, vcc
    v_cndmask_b32 v9, v9, 4, vcc
    s_branch K1_JOIN
K1_J2:
    v_mul_f32 v90, 0x43000000, v20
    v_mul_f32 v91, 0x43000000, v22
    v_exp_f32 v90, v90
    v_mul_f32 v92, s32, v91
    v_rndne_f32 v92, v92
    v_fma_f32 v92, v91, s32, -v92
    v_fma_f32 v92, v91, s33, v92
    v_cos_f32 v91, v92
    v_sin_f32 v92, v92
    v_mul_f32 v44, v90, v91
    v_mul_f32 v46, v90, v92
    v_mul_f32 v90, 0x43000000, v21
    v_mul_f32 v91, 0x43000000, v23
    v_exp_f32 v90, v90
    v_mul_f32 v92, s32, v91
    v_rndne_f32 v92, v92
    v_fma_f32 v92, v91, s32, -v92
    v_fma_f32 v92, v91, s33, v92
    v_cos_f32 v91, v92
    v_sin_f32 v92, v92
    v_mul_f32 v45, v90, v91
    v_mul_f32 v47, v90, v92
    v_mul_f32 v90, 0x44800000, v20
    v_mul_f32 v91, 0x44800000, v22
    v_exp_f32 v90, v90
    v_mul_f32 v92, s32, v91
    v_rndne_f32 v92, v92
    v_fma_f32 v92, v91, s32, -v92
    v_fma_f32 v92, v91, s33, v92
    v_cos_f32 v91, v92
    v_sin_f32 v92, v92
    v_mul_f32 v48, v90, v91
    v_mul_f32 v50, v90, v92
    v_mul_f32 v90, 0x44800000, v21
    v_mul_f32 v91, 0x44800000, v23
    v_exp_f32 v90, v90
    v_mul_f32 v92, s32, v91
    v_rndne_f32 v92, v92
    v_fma_f32 v92, v91, s32, -v92
    v_fma_f32 v92, v91, s33, v92
    v_cos_f32 v91, v92
    v_sin_f32 v92, v92
    v_mul_f32 v49, v90, v91
    v_mul_f32 v51, v90, v92
    v_pk_mul_f32 v[90:91], v[34:35], v[50:51]
    v_pk_mul_f32 v[92:93], v[34:35], v[48:49]
    v_pk_fma_f32 v[54:55], v[32:33], v[50:51], v[92:93]
    v_pk_fma_f32 v[52:53], v[32:33], v[48:49], v[90:91] neg_lo:[0,0,1] neg_hi:[0,0,1]
    v_cvt_pk_f16_f32 v94, v52, v54
    v_cvt_pk_f16_f32 v95, v53, v55
    ds_write_b64 v4, v[94:95] offset:0
    v_pk_mul_f32 v[90:91], v[54:55], v[46:47]
    v_pk_mul_f32 v[92:93], v[54:55], v[44:45]
    v_pk_fma_f32 v[58:59], v[52:53], v[46:47], v[92:93]
    v_pk_fma_f32 v[56:57], v[52:53], v[44:45], v[90:91] neg_lo:[0,0,1] neg_hi:[0,0,1]
    v_cvt_pk_f16_f32 v94, v56, v58
    v_cvt_pk_f16_f32 v95, v57, v59
    ds_write_b64 v4, v[94:95] offset:544
    v_pk_mul_f32 v[90:91], v[58:59], v[46:47]
    v_pk_mul_f32 v[92:93], v[58:59], v[44:45]
    v_pk_fma_f32 v[54:55], v[56:57], v[46:47], v[92:93]
    v_pk_fma_f32 v[52:53], v[56:57], v[44:45], v[90:91] neg_lo:[0,0,1] neg_hi:[0,0,1]
    v_cvt_pk_f16_f32 v94, v52, v54
    v_cvt_pk_f16_f32 v95, v53, v55
    ds_write_b64 v4, v[94:95] offset:1088
    v_pk_mul_f32 v[90:91], v[54:55], v[46:47]
    v_pk_mul_f32 v[92:93], v[54:55], v[44:45]
    v_pk_fma_f32 v[58:59], v[52:53], v[46:47], v[92:93]
    v_pk_fma_f32 v[56:57], v[52:53], v[44:45], v[90:91] neg_lo:[0,0,1] neg_hi:[0,0,1]
    v_cvt_pk_f16_f32 v94, v56, v58
    v_cvt_pk_f16_f32 v95, v57, v59
    ds_write_b64 v4, v[94:95] offset:1632
    v_pk_mul_f32 v[90:91], v[58:59], v[46:47]
    v_pk_mul_f32 v[92:93], v[58:59], v[44:45]
    v_pk_fma_f32 v[54:55], v[56:57], v[46:47], v[92:93]
    v_pk_fma_f32 v[52:53], v[56:57], v[44:45], v[90:91] neg_lo:[0,0,1] neg_hi:[0,0,1]
    v_cvt_pk_f16_f32 v94, v52, v54
    v_cvt_pk_f16_f32 v95, v53, v55
    ds_write_b64 v4, v[94:95] offset:2176
    v_pk_mul_f32 v[90:91], v[54:55], v[46:47]
    v_pk_mul_f32 v[92:93], v[54:55], v[44:45]
    v_pk_fma_f32 v[58:59], v[52:53], v[46:47], v[92:93]
    v_pk_fma_f32 v[56:57], v[52:53], v[44:45], v[90:91] neg_lo:[0,0,1] neg_hi:[0,0,1]
    v_cvt_pk_f16_f32 v94, v56, v58
    v_cvt_pk_f16_f32 v95, v57, v59
    ds_write_b64 v4, v[94:95] offset:2720
    v_pk_mul_f32 v[90:91], v[58:59], v[46:47]
    v_pk_mul_f32 v[92:93], v[58:59], v[44:45]
    v_pk_fma_f32 v[54:55], v[56:57], v[46:47], v[92:93]
    v_pk_fma_f32 v[52:53], v[56:57], v[44:45], v[90:91] neg_lo:[0,0,1] neg_hi:[0,0,1]
    v_cvt_pk_f16_f32 v94, v52, v54
    v_cvt_pk_f16_f32 v95, v53, v55
    ds_write_b64 v4, v[94:95] offset:3264
    v_pk_mul_f32 v[90:91], v[54:55], v[46:47]
    v_pk_mul_f32 v[92:93], v[54:55], v[44:45]
    v_pk_fma_f32 v[58:59], v[52:53], v[46:47], v[92:93]
    v_pk_fma_f32 v[56:57], v[52:53], v[44:45], v[90:91] neg_lo:[0,0,1] neg_hi:[0,0,1]
    v_cvt_pk_f16_f32 v94, v56, v58
    v_cvt_pk_f16_f32 v95, v57, v59
    ds_write_b64 v4, v[94:95] offset:3808
    v_pk_mul_f32 v[90:91], v[58:59], v[46:47]
    v_pk_mul_f32 v[92:93], v[58:59], v[44:45]
    v_pk_fma_f32 v[54:55], v[56:57], v[46:47], v[92:93]
    v_pk_fma_f32 v[52:53], v[56:57], v[44:45], v[90:91] neg_lo:[0,0,1] neg_hi:[0,0,1]
    v_cvt_pk_f16_f32 v94, v52, v54
    v_cvt_pk_f16_f32 v95, v53, v55
    ds_write_b64 v4, v[94:95] offset:4352
    v_lshl_add_u32 v7, v6, 9, v7
    v_add_u32 v7, 0x400, v7
    v_mov_b32 v8, 0x80
    v_mov_b32 v9, 0x100
    s_branch K1_JOIN
K1_J3:
    v_mul_f32 v90, 0x41000000, v20
    v_mul_f32 v91, 0x41000000, v22
    v_exp_f32 v90, v90
    v_mul_f32 v92, s32, v91
    v_rndne_f32 v92, v92
    v_fma_f32 v92, v91, s32, -v92
    v_fma_f32 v92, v91, s33, v92
    v_cos_f32 v91, v92
    v_sin_f32 v92, v92
    v_mul_f32 v40, v90, v91
    v_mul_f32 v42, v90, -v92
    v_mul_f32 v90, 0x41000000, v21
    v_mul_f32 v91, 0x41000000, v23
    v_exp_f32 v90, v90
    v_mul_f32 v92, s32, v91
    v_rndne_f32 v92, v92
    v_fma_f32 v92, v91, s32, -v92
    v_fma_f32 v92, v91, s33, v92
    v_cos_f32 v91, v92
    v_sin_f32 v92, v92
    v_mul_f32 v41, v90, v91
    v_mul_f32 v43, v90, -v92
    v_mov_b32 v52, 0x47000000
    v_mov_b32 v53, 0x47000000
    v_mov_b32 v54, 0
    v_mov_b32 v55, 0
    v_cvt_pk_f16_f32 v94, v52, v54
    v_cvt_pk_f16_f32 v95, v53, v55
    ds_write_b64 v4, v[94:95] offset:0
    v_pk_mul_f32 v[90:91], v[54:55], v[42:43]
    v_pk_mul_f32 v[92:93], v[54:55], v[40:41]
    v_pk_fma_f32 v[58:59], v[52:53], v[42:43], v[92:93]
    v_pk_fma_f32 v[56:57], v[52:53], v[40:41], v[90:91] neg_lo:[0,0,1] neg_hi:[0,0,1]
    v_cvt_pk_f16_f32 v94, v56, v58
    v_cvt_pk_f16_f32 v95, v57, v59
    ds_write_b64 v4, v[94:95] offset:544
    v_pk_mul_f32 v[90:91], v[58:59], v[42:43]
    v_pk_mul_f32 v[92:93], v[58:59], v[40:41]
    v_pk_fma_f32 v[54:55], v[56:57], v[42:43], v[92:93]
    v_pk_fma_f32 v[52:53], v[56:57], v[40:41], v[90:91] neg_lo:[0,0,1] neg_hi:[0,0,1]
    v_cvt_pk_f16_f32 v94, v52, v54
    v_cvt_pk_f16_f32 v95, v53, v55
    ds_write_b64 v4, v[94:95] offset:1088
    v_pk_mul_f32 v[90:91], v[54:55], v[42:43]
    v_pk_mul_f32 v[92:93], v[54:55], v[40:41]
    v_pk_fma_f32 v[58:59], v[52:53], v[42:43], v[92:93]
    v_pk_fma_f32 v[56:57], v[52:53], v[40:41], v[90:91] neg_lo:[0,0,1] neg_hi:[0,0,1]
    v_cvt_pk_f16_f32 v94, v56, v58
    v_cvt_pk_f16_f32 v95, v57, v59
    ds_write_b64 v4, v[94:95] offset:1632
    v_pk_mul_f32 v[90:91], v[58:59], v[42:43]
    v_pk_mul_f32 v[92:93], v[58:59], v[40:41]
    v_pk_fma_f32 v[54:55], v[56:57], v[42:43], v[92:93]
    v_pk_fma_f32 v[52:53], v[56:57], v[40:41], v[90:91] neg_lo:[0,0,1] neg_hi:[0,0,1]
    v_cvt_pk_f16_f32 v94, v52, v54
    v_cvt_pk_f16_f32 v95, v53, v55
    ds_write_b64 v4, v[94:95] offset:2176
    v_pk_mul_f32 v[90:91], v[54:55], v[42:43]
    v_pk_mul_f32 v[92:93], v[54:55], v[40:41]
    v_pk_fma_f32 v[58:59], v[52:53], v[42:43], v[92:93]
    v_pk_fma_f32 v[56:57], v[52:53], v[40:41], v[90:91] neg_lo:[0,0,1] neg_hi:[0,0,1]
    v_cvt_pk_f16_f32 v94, v56, v58
    v_cvt_pk_f16_f32 v95, v57, v59
    ds_write_b64 v4, v[94:95] offset:2720
    v_pk_mul_f32 v[90:91], v[58:59], v[42:43]
    v_pk_mul_f32 v[92:93], v[58:59], v[40:41]
    v_pk_fma_f32 v[54:55], v[56:57], v[42:43], v[92:93]
    v_pk_fma_f32 v[52:53], v[56:57], v[40:41], v[90:91] neg_lo:[0,0,1] neg_hi:[0,0,1]
    v_cvt_pk_f16_f32 v94, v52, v54
    v_cvt_pk_f16_f32 v95, v53, v55
    ds_write_b64 v4, v[94:95] offset:3264
    v_pk_mul_f32 v[90:91], v[54:55], v[42:43]
    v_pk_mul_f32 v[92:93], v[54:55], v[40:41]
    v_pk_fma_f32 v[58:59], v[52:53], v[42:43], v[92:93]
    v_pk_fma_f32 v[56:57], v[52:53], v[40:41], v[90:91] neg_lo:[0,0,1] neg_hi:[0,0,1]
    v_cvt_pk_f16_f32 v94, v56, v58
    v_cvt_pk_f16_f32 v95, v57, v59
    ds_write_b64 v4, v[94:95] offset:3808
    v_pk_mul_f32 v[90:91], v[58:59], v[42:43]
    v_pk_mul_f32 v[92:93], v[58:59], v[40:41]
    v_pk_fma_f32 v[54:55], v[56:57], v[42:43], v[92:93]
    v_pk_fma_f32 v[52:53], v[56:57], v[40:41], v[90:91] neg_lo:[0,0,1] neg_hi:[0,0,1]
    v_cvt_pk_f16_f32 v94, v52, v54
    v_cvt_pk_f16_f32 v95, v53, v55
    ds_write_b64 v4, v[94:95] offset:4352
    v_pk_mul_f32 v[90:91], v[54:55], v[42:43]
    v_pk_mul_f32 v[92:93], v[54:55], v[40:41]
    v_pk_fma_f32 v[58:59], v[52:53], v[42:43], v[92:93]
    v_pk_fma_f32 v[56:57], v[52:53], v[40:41], v[90:91] neg_lo:[0,0,1] neg_hi:[0,0,1]
    v_cvt_pk_f16_f32 v94, v56, v58
    v_cvt_pk_f16_f32 v95, v57, v59
    ds_write_b64 v4, v[94:95] offset:4896
    v_pk_mul_f32 v[90:91], v[58:59], v[42:43]
    v_pk_mul_f32 v[92:93], v[58:59], v[40:41]
    v_pk_fma_f32 v[54:55], v[56:57], v[42:43], v[92:93]
    v_pk_fma_f32 v[52:53], v[56:57], v[40:41], v[90:91] neg_lo:[0,0,1] neg_hi:[0,0,1]
    v_cvt_pk_f16_f32 v94, v52, v54
    v_cvt_pk_f16_f32 v95, v53, v55
    ds_write_b64 v4, v[94:95] offset:5440
    v_pk_mul_f32 v[90:91], v[54:55], v[42:43]
    v_pk_mul_f32 v[92:93], v[54:55], v[40:41]
    v_pk_fma_f32 v[58:59], v[52:53], v[42:43], v[92:93]
    v_pk_fma_f32 v[56:57], v[52:53], v[40:41], v[90:91] neg_lo:[0,0,1] neg_hi:[0,0,1]
    v_cvt_pk_f16_f32 v94, v56, v58
    v_cvt_pk_f16_f32 v95, v57, v59
    ds_write_b64 v4, v[94:95] offset:5984
    v_pk_mul_f32 v[90:91], v[58:59], v[42:43]
    v_pk_mul_f32 v[92:93], v[58:59], v[40:41]
    v_pk_fma_f32 v[54:55], v[56:57], v[42:43], v[92:93]
    v_pk_fma_f32 v[52:53], v[56:57], v[40:41], v[90:91] neg_lo:[0,0,1] neg_hi:[0,0,1]
    v_cvt_pk_f16_f32 v94, v52, v54
    v_cvt_pk_f16_f32 v95, v53, v55
    ds_write_b64 v4, v[94:95] offset:6528
    v_pk_mul_f32 v[90:91], v[54:55], v[42:43]
    v_pk_mul_f32 v[92:93], v[54:55], v[40:41]
    v_pk_fma_f32 v[58:59], v[52:53], v[42:43], v[92:93]
    v_pk_fma_f32 v[56:57], v[52:53], v[40:41], v[90:91] neg_lo:[0,0,1] neg_hi:[0,0,1]
    v_cvt_pk_f16_f32 v94, v56, v58
    v_cvt_pk_f16_f32 v95, v57, v59
    ds_write_b64 v4, v[94:95] offset:7072
    v_pk_mul_f32 v[90:91], v[58:59], v[42:43]
    v_pk_mul_f32 v[92:93], v[58:59], v[40:41]
    v_pk_fma_f32 v[54:55], v[56:57], v[42:43], v[92:93]
    v_pk_fma_f32 v[52:53], v[56:57], v[40:41], v[90:91] neg_lo:[0,0,1] neg_hi:[0,0,1]
    v_cvt_pk_f16_f32 v94, v52, v54
    v_cvt_pk_f16_f32 v95, v53, v55
    ds_write_b64 v4, v[94:95] offset:7616
    v_pk_mul_f32 v[90:91], v[54:55], v[42:43]
    v_pk_mul_f32 v[92:93], v[54:55], v[40:41]
    v_pk_fma_f32 v[58:59], v[52:53], v[42:43], v[92:93]
    v_pk_fma_f32 v[56:57], v[52:53], v[40:41], v[90:91] neg_lo:[0,0,1] neg_hi:[0,0,1]
    v_cvt_pk_f16_f32 v94, v56, v58
    v_cvt_pk_f16_f32 v95, v57, v59
    ds_write_b64 v4, v[94:95] offset:8160
    v_mul_f32 v40, 0x45000000, v36
    v_max_f32 v40, 0, v40
    v_exp_f32 v40, v40
    v_mul_f32 v41, 0x38000000, v37
    v_mul_f32 v40, v40, v41
    s_lshl_b32 s4, s3, 2
    v_mov_b32 v41, s4
    s_mul_i32 s4, s3, 4112
    s_add_u32 s4, s4, 4096
    v_mov_b32 v42, s4
    v_mov_b32 v44, 0
    v_mov_b32 v45, 0
    v_mov_b32 v46, 0
    v_mov_b32 v47, 0
    s_mov_b64 s[34:35], exec
    s_mov_b64 exec, 1
    buffer_store_dword v40, v41, s[12:15], 0 offen
    buffer_store_dwordx4 v[44:47], v42, s[8:11], 0 offen
    s_mov_b64 exec, s[34:35]
K1_JOIN:
    s_nop 3
    s_waitcnt lgkmcnt(0)
    s_barrier
    s_cmp_eq_u32 s5, 3
    s_cbranch_scc1 K1_EXPAND
    v_mul_u32_u24 v10, 544, v5
    v_lshl_add_u32 v10, v6, 4, v10
    s_mul_i32 s4, s5, 8704
    v_add_u32 v11, s4, v10
    ds_read_b128 v[40:43], v11 offset:0
    ds_read_b128 v[72:75], v10 offset:26112
    ds_read_b128 v[44:47], v11 offset:64
    ds_read_b128 v[76:79], v10 offset:26176
    ds_read_b128 v[48:51], v11 offset:128
    ds_read_b128 v[80:83], v10 offset:26240
    ds_read_b128 v[52:55], v11 offset:192
    ds_read_b128 v[84:87], v10 offset:26304
    ds_read_b128 v[56:59], v11 offset:256
    ds_read_b128 v[60:63], v11 offset:320
    ds_read_b128 v[64:67], v11 offset:384
    ds_read_b128 v[68:71], v11 offset:448
    v_mov_b32 v12, 0
    v_mov_b32 v13, 0
    v_mov_b32 v14, 0
    v_mov_b32 v15, 0
    ds_read_b128 v[20:23], v10 offset:26368
    ds_read_b128 v[24:27], v10 offset:26432
    ds_read_b128 v[28:31], v10 offset:26496
    ds_read_b128 v[32:35], v10 offset:26560
    s_waitcnt lgkmcnt(0)
    v_mfma_f32_16x16x32_f16 v[12:15], v[40:43], v[72:75], v[12:15]
    v_mfma_f32_16x16x32_f16 v[12:15], v[44:47], v[76:79], v[12:15]
    v_mfma_f32_16x16x32_f16 v[12:15], v[48:51], v[80:83], v[12:15]
    v_mfma_f32_16x16x32_f16 v[12:15], v[52:55], v[84:87], v[12:15]
    v_mfma_f32_16x16x32_f16 v[12:15], v[56:59], v[20:23], v[12:15]
    v_mfma_f32_16x16x32_f16 v[12:15], v[60:63], v[24:27], v[12:15]
    v_mfma_f32_16x16x32_f16 v[12:15], v[64:67], v[28:31], v[12:15]
    v_mfma_f32_16x16x32_f16 v[12:15], v[68:71], v[32:35], v[12:15]
    v_mul_f32 v40, 0x45000000, v36
    v_max_f32 v40, 0, v40
    v_add_f32 v40, 0x41700000, v40
    v_mov_b32 v41, v7
    v_add_u32 v42, v7, v8
    v_add_u32 v43, v7, v9
    v_add_u32 v44, v42, v9
    v_cvt_f32_u32 v45, v41
    v_fma_f32 v46, v45, v36, -v40
    v_exp_f32 v46, v46
    v_lshrrev_b32 v45, 16, v45
    v_subrev_u32 v45, 0x4280, v45
    v_cmp_gt_u32 vcc, 128, v41
    s_nop 1
    v_cndmask_b32 v45, v45, v41, vcc
    v_cmp_lt_u32 vcc, 0x800, v41
    v_mov_b32 v47, 0x2f0
    s_nop 0
    v_cndmask_b32 v45, v45, v47, vcc
    v_mul_f32 v46, v46, v12
    v_cvt_f16_f32 v46, v46
    v_lshlrev_b32 v45, 1, v45
    ds_write_b16 v45, v46 offset:34816
    v_cvt_f32_u32 v45, v42
    v_fma_f32 v46, v45, v36, -v40
    v_exp_f32 v46, v46
    v_lshrrev_b32 v45, 16, v45
    v_subrev_u32 v45, 0x4280, v45
    v_cmp_gt_u32 vcc, 128, v42
    s_nop 1
    v_cndmask_b32 v45, v45, v42, vcc
    v_cmp_lt_u32 vcc, 0x800, v42
    v_mov_b32 v47, 0x2f0
    s_nop 0
    v_cndmask_b32 v45, v45, v47, vcc
    v_mul_f32 v46, v46, v13
    v_cvt_f16_f32 v46, v46
    v_lshlrev_b32 v45, 1, v45
    ds_write_b16 v45, v46 offset:34816
    v_cvt_f32_u32 v45, v43
    v_fma_f32 v46, v45, v36, -v40
    v_exp_f32 v46, v46
    v_lshrrev_b32 v45, 16, v45
    v_subrev_u32 v45, 0x4280, v45
    v_cmp_gt_u32 vcc, 128, v43
    s_nop 1
    v_cndmask_b32 v45, v45, v43, vcc
    v_cmp_lt_u32 vcc, 0x800, v43
    v_mov_b32 v47, 0x2f0
    s_nop 0
    v_cndmask_b32 v45, v45, v47, vcc
    v_mul_f32 v46, v46, v14
    v_cvt_f16_f32 v46, v46
    v_lshlrev_b32 v45, 1, v45
    ds_write_b16 v45, v46 offset:34816
    v_cvt_f32_u32 v45, v44
    v_fma_f32 v46, v45, v36, -v40
    v_exp_f32 v46, v46
    v_lshrrev_b32 v45, 16, v45
    v_subrev_u32 v45, 0x4280, v45
    v_cmp_gt_u32 vcc, 128, v44
    s_nop 1
    v_cndmask_b32 v45, v45, v44, vcc
    v_cmp_lt_u32 vcc, 0x800, v44
    v_mov_b32 v47, 0x2f0
    s_nop 0
    v_cndmask_b32 v45, v45, v47, vcc
    v_mul_f32 v46, v46, v15
    v_cvt_f16_f32 v46, v46
    v_lshlrev_b32 v45, 1, v45
    ds_write_b16 v45, v46 offset:34816
K1_EXPAND:
    s_nop 3
    s_waitcnt lgkmcnt(0)
    s_barrier
    ds_read_u16 v48, v100 offset:34816
    ds_read_u16 v49, v101 offset:34816
    ds_read_u16 v50, v102 offset:34816
    ds_read_u16 v51, v103 offset:34816
    ds_read_u16 v52, v104 offset:34816
    ds_read_u16 v53, v105 offset:34816
    ds_read_u16 v54, v106 offset:34816
    ds_read_u16 v55, v107 offset:34816
    s_mul_i32 s4, s3, 4112
    v_lshlrev_b32 v44, 4, v0
    s_waitcnt lgkmcnt(0)
    v_lshl_or_b32 v40, v49, 16, v48
    v_lshl_or_b32 v41, v51, 16, v50
    v_lshl_or_b32 v42, v53, 16, v52
    v_lshl_or_b32 v43, v55, 16, v54
    buffer_store_dwordx4 v[40:43], v44, s[8:11], s4 offen
K1_END:
    s_endpgm
.globl k2_kernel
.p2align 8
.type k2_kernel,@function
k2_kernel:
    s_cmp_ge_u32 s2, 576
    s_cbranch_scc1 K2_END
    s_load_dwordx2 s[6:7], s[0:1], 128
    s_load_dwordx2 s[4:5], s[0:1], 64
    s_load_dwordx4 s[32:35], s[0:1], 88
    s_load_dwordx2 s[36:37], s[0:1], 104
    s_and_b32 s16, s2, 7
    s_mul_i32 s16, s16, 72
    s_lshr_b32 s3, s2, 3
    s_add_u32 s3, s3, s16
    v_readfirstlane_b32 s17, v0
    s_lshr_b32 s17, s17, 6
    v_lshlrev_b32 v2, 4, v0
    s_lshl_b32 s18, s3, 12
    s_mul_i32 s19, s3, 4112
    s_waitcnt lgkmcnt(0)
    s_mov_b32 s8, s6
    s_mov_b32 s9, s7
    s_mov_b32 s10, 0x240000
    s_mov_b32 s11, 0x20000
    s_add_u32 s12, s6, 0x300000
    s_addc_u32 s13, s7, 0
    s_mov_b32 s14, 0x242400
    s_mov_b32 s15, 0x20000
    buffer_load_dwordx4 v[4:7], v2, s[12:15], s19 offen
    buffer_load_dwordx2 v[8:9], v2, s[12:15], s19 offen offset:16
    buffer_load_dwordx4 v[12:15], v2, s[8:11], s18 offen
    s_lshl_b32 s20, s3, 2
    s_add_u32 s20, s20, 0xc10000
    s_add_u32 s20, s6, s20
    s_addc_u32 s21, s7, 0
    s_load_dword s24, s[20:21], 0
    s_lshr_b32 s20, s3, 1
    s_lshl_b32 s20, s20, 2
    s_add_u32 s20, s4, s20
    s_addc_u32 s21, s5, 0
    s_load_dword s25, s[20:21], 0
    s_add_u32 s28, s6, 0x600000
    s_addc_u32 s29, s7, 0
    s_mov_b32 s30, 0x240000
    s_mov_b32 s31, 0x20000
    v_mov_b32 v16, 0
    v_mov_b32 v17, 0
    v_mov_b32 v18, 0
    v_mov_b32 v19, 0
    v_lshrrev_b32 v3, 5, v0
    v_and_b32 v10, 31, v0
    v_mul_u32_u24 v11, 4640, v3
    v_lshl_add_u32 v11, v10, 4, v11
    v_add_u32 v11, 4096, v11
    v_cmp_gt_u32 vcc, 4, v3
    v_cmp_gt_u32 s[22:23], 24, v10
    s_and_b64 vcc, vcc, s[22:23]
    s_and_saveexec_b64 s[22:23], vcc
    ds_write_b128 v11, v[16:19]
    s_mov_b64 exec, s[22:23]
    v_cmp_gt_u32 vcc, 8, v0
    s_and_saveexec_b64 s[22:23], vcc
    ds_write_b128 v2, v[16:19] offset:18560
    s_mov_b64 exec, s[22:23]
    v_and_b32 v3, 63, v0
    v_and_b32 v10, 15, v3
    v_lshrrev_b32 v11, 4, v3
    v_and_b32 v16, 3, v10
    v_mul_u32_u24 v16, 4640, v16
    v_lshrrev_b32 v17, 2, v10
    v_lshlrev_b32 v17, 7, v17
    v_sub_u32 v16, v16, v17
    v_lshl_add_u32 v16, v11, 4, v16
    s_lshl_b32 s20, s17, 7
    s_sub_u32 s20, 384, s20
    s_add_u32 s21, s20, 384
    v_add_u32 v16, s21, v16
    v_lshlrev_b32 v17, 3, v10
    v_lshl_add_u32 v17, v11, 4, v17
    s_add_u32 s21, s20, 18568
    v_add_u32 v17, s21, v17
    s_waitcnt vmcnt(1)
    v_alignbit_b32 v20, v5, v4, 16
    v_alignbit_b32 v21, v6, v5, 16
    v_alignbit_b32 v22, v7, v6, 16
    v_alignbit_b32 v23, v8, v7, 16
    v_alignbit_b32 v24, v9, v8, 16
    ds_write_b128 v2, v[4:7] offset:13920
    ds_write_b128 v2, v[20:23] offset:9280
    v_mov_b32 v26, v5
    v_mov_b32 v27, v6
    v_mov_b32 v28, v7
    v_mov_b32 v29, v8
    v_mov_b32 v30, v21
    v_mov_b32 v31, v22
    v_mov_b32 v32, v23
    v_mov_b32 v33, v24
    ds_write_b128 v2, v[26:29] offset:4640
    ds_write_b128 v2, v[30:33] offset:0
    s_waitcnt vmcnt(0)
    ds_write_b128 v2, v[12:15] offset:18688
    v_mul_u32_u24 v4, 3641, v0
    v_lshrrev_b32 v4, 16, v4
    v_mul_u32_u24 v5, 18, v4
    v_sub_u32 v5, v0, v5
    v_mul_u32_u24 v4, 9216, v4
    v_lshl_add_u32 v4, v5, 6, v4
    s_and_b32 s20, s2, 7
    s_lshr_b32 s21, s2, 3
    s_mul_i32 s22, s21, 73728
    s_mul_i32 s23, s20, 1152
    s_add_u32 s22, s22, s23
    v_add_u32 v4, s22, v4
    s_mul_i32 s22, s20, 663552
    s_mul_i32 s23, s21, 9216
    s_add_u32 s22, s22, s23
    v_lshl_add_u32 v5, v0, 6, s22
    v_cmp_gt_u32 vcc, 144, v0
    s_and_saveexec_b64 s[22:23], vcc
    s_cbranch_execz K2_NOPF
    global_load_dword v148, v4, s[32:33]
    global_load_dword v149, v4, s[34:35]
    global_load_dword v150, v5, s[36:37]
K2_NOPF:
    s_mov_b64 exec, s[22:23]
    s_waitcnt lgkmcnt(0)
    s_barrier
    v_mov_b32 v20, 0
    v_mov_b32 v21, 0
    v_mov_b32 v22, 0
    v_mov_b32 v23, 0
    v_mov_b32 v24, 0
    v_mov_b32 v25, 0
    v_mov_b32 v26, 0
    v_mov_b32 v27, 0
    v_mov_b32 v28, 0
    v_mov_b32 v29, 0
    v_mov_b32 v30, 0
    v_mov_b32 v31, 0
    v_mov_b32 v32, 0
    v_mov_b32 v33, 0
    v_mov_b32 v34, 0
    v_mov_b32 v35, 0
    v_mov_b32 v36, 0
    v_mov_b32 v37, 0
    v_mov_b32 v38, 0
    v_mov_b32 v39, 0
    v_mov_b32 v40, 0
    v_mov_b32 v41, 0
    v_mov_b32 v42, 0
    v_mov_b32 v43, 0
    v_mov_b32 v44, 0
    v_mov_b32 v45, 0
    v_mov_b32 v46, 0
    v_mov_b32 v47, 0
    v_mov_b32 v48, 0
    v_mov_b32 v49, 0
    v_mov_b32 v50, 0
    v_mov_b32 v51, 0
    ds_read_b128 v[80:83], v16 offset:64
    ds_read_b64 v[84:85], v17 offset:64
    ds_read_b64 v[86:87], v17 offset:72
    ds_read_b128 v[76:79], v16 offset:576
    ds_read_b64 v[88:89], v17 offset:576
    ds_read_b64 v[90:91], v17 offset:584
    ds_read_b128 v[72:75], v16 offset:1088
    ds_read_b64 v[92:93], v17 offset:1088
    ds_read_b64 v[94:95], v17 offset:1096
    ds_read_b128 v[68:71], v16 offset:1600
    ds_read_b64 v[96:97], v17 offset:1600
    ds_read_b64 v[98:99], v17 offset:1608
    s_waitcnt lgkmcnt(9)
    v_mfma_f32_16x16x32_f16 v[48:51], v[80:83], v[84:87], v[48:51]
    ds_read_b128 v[64:67], v16 offset:2112
    ds_read_b64 v[100:101], v17 offset:2112
    ds_read_b64 v[102:103], v17 offset:2120
    s_waitcnt lgkmcnt(9)
    v_mfma_f32_16x16x32_f16 v[44:47], v[76:79], v[84:87], v[44:47]
    ds_read_b128 v[60:63], v16 offset:2624
    ds_read_b64 v[104:105], v17 offset:2624
    ds_read_b64 v[106:107], v17 offset:2632
    v_mfma_f32_16x16x32_f16 v[48:51], v[76:79], v[88:91], v[48:51]
    s_waitcnt lgkmcnt(9)
    v_mfma_f32_16x16x32_f16 v[40:43], v[72:75], v[84:87], v[40:43]
    ds_read_b128 v[56:59], v16 offset:3136
    ds_read_b64 v[108:109], v17 offset:3136
    ds_read_b64 v[110:111], v17 offset:3144
    v_mfma_f32_16x16x32_f16 v[44:47], v[72:75], v[88:91], v[44:47]
    v_mfma_f32_16x16x32_f16 v[48:51], v[72:75], v[92:95], v[48:51]
    s_waitcnt lgkmcnt(9)
    v_mfma_f32_16x16x32_f16 v[36:39], v[68:71], v[84:87], v[36:39]
    ds_read_b128 v[52:55], v16 offset:3648
    ds_read_b64 v[112:113], v17 offset:3648
    ds_read_b64 v[114:115], v17 offset:3656
    v_mfma_f32_16x16x32_f16 v[40:43], v[68:71], v[88:91], v[40:43]
    v_mfma_f32_16x16x32_f16 v[44:47], v[68:71], v[92:95], v[44:47]
    v_mfma_f32_16x16x32_f16 v[48:51], v[68:71], v[96:99], v[48:51]
    s_waitcnt lgkmcnt(9)
    v_mfma_f32_16x16x32_f16 v[32:35], v[64:67], v[84:87], v[32:35]
    ds_read_b128 v[80:83], v16 offset:0
    ds_read_b64 v[116:117], v17 offset:0
    ds_read_b64 v[118:119], v17 offset:8
    v_mfma_f32_16x16x32_f16 v[36:39], v[64:67], v[88:91], v[36:39]
    v_mfma_f32_16x16x32_f16 v[40:43], v[64:67], v[92:95], v[40:43]
    v_mfma_f32_16x16x32_f16 v[44:47], v[64:67], v[96:99], v[44:47]
    v_mfma_f32_16x16x32_f16 v[48:51], v[64:67], v[100:103], v[48:51]
    s_waitcnt lgkmcnt(9)
    v_mfma_f32_16x16x32_f16 v[28:31], v[60:63], v[84:87], v[28:31]
    ds_read_b128 v[76:79], v16 offset:512
    ds_read_b64 v[120:121], v17 offset:512
    ds_read_b64 v[122:123], v17 offset:520
    v_mfma_f32_16x16x32_f16 v[32:35], v[60:63], v[88:91], v[32:35]
    v_mfma_f32_16x16x32_f16 v[36:39], v[60:63], v[92:95], v[36:39]
    v_mfma_f32_16x16x32_f16 v[40:43], v[60:63], v[96:99], v[40:43]
    v_mfma_f32_16x16x32_f16 v[44:47], v[60:63], v[100:103], v[44:47]
    v_mfma_f32_16x16x32_f16 v[48:51], v[60:63], v[104:107], v[48:51]
    s_waitcnt lgkmcnt(9)
    v_mfma_f32_16x16x32_f16 v[24:27], v[56:59], v[84:87], v[24:27]
    ds_read_b128 v[72:75], v16 offset:1024
    ds_read_b64 v[124:125], v17 offset:1024
    ds_read_b64 v[126:127], v17 offset:1032
    v_mfma_f32_16x16x32_f16 v[28:31], v[56:59], v[88:91], v[28:31]
    v_mfma_f32_16x16x32_f16 v[32:35], v[56:59], v[92:95], v[32:35]
    v_mfma_f32_16x16x32_f16 v[36:39], v[56:59], v[96:99], v[36:39]
    v_mfma_f32_16x16x32_f16 v[40:43], v[56:59], v[100:103], v[40:43]
    v_mfma_f32_16x16x32_f16 v[44:47], v[56:59], v[104:107], v[44:47]
    v_mfma_f32_16x16x32_f16 v[48:51], v[56:59], v[108:111], v[48:51]
    s_waitcnt lgkmcnt(9)
    v_mfma_f32_16x16x32_f16 v[20:23], v[52:55], v[84:87], v[20:23]
    ds_read_b128 v[68:71], v16 offset:1536
    ds_read_b64 v[128:129], v17 offset:1536
    ds_read_b64 v[130:131], v17 offset:1544
    v_mfma_f32_16x16x32_f16 v[24:27], v[52:55], v[88:91], v[24:27]
    v_mfma_f32_16x16x32_f16 v[28:31], v[52:55], v[92:95], v[28:31]
    v_mfma_f32_16x16x32_f16 v[32:35], v[52:55], v[96:99], v[32:35]
    v_mfma_f32_16x16x32_f16 v[36:39], v[52:55], v[100:103], v[36:39]
    v_mfma_f32_16x16x32_f16 v[40:43], v[52:55], v[104:107], v[40:43]
    v_mfma_f32_16x16x32_f16 v[44:47], v[52:55], v[108:111], v[44:47]
    v_mfma_f32_16x16x32_f16 v[48:51], v[52:55], v[112:115], v[48:51]
    s_waitcnt lgkmcnt(9)
    v_mfma_f32_16x16x32_f16 v[48:51], v[80:83], v[116:119], v[48:51]
    ds_read_b128 v[64:67], v16 offset:2048
    ds_read_b64 v[132:133], v17 offset:2048
    ds_read_b64 v[134:135], v17 offset:2056
    s_waitcnt lgkmcnt(9)
    v_mfma_f32_16x16x32_f16 v[44:47], v[76:79], v[116:119], v[44:47]
    ds_read_b128 v[60:63], v16 offset:2560
    ds_read_b64 v[136:137], v17 offset:2560
    ds_read_b64 v[138:139], v17 offset:2568
    v_mfma_f32_16x16x32_f16 v[48:51], v[76:79], v[120:123], v[48:51]
    s_waitcnt lgkmcnt(9)
    v_mfma_f32_16x16x32_f16 v[40:43], v[72:75], v[116:119], v[40:43]
    ds_read_b128 v[56:59], v16 offset:3072
    ds_read_b64 v[140:141], v17 offset:3072
    ds_read_b64 v[142:143], v17 offset:3080
    v_mfma_f32_16x16x32_f16 v[44:47], v[72:75], v[120:123], v[44:47]
    v_mfma_f32_16x16x32_f16 v[48:51], v[72:75], v[124:127], v[48:51]
    s_waitcnt lgkmcnt(9)
    v_mfma_f32_16x16x32_f16 v[36:39], v[68:71], v[116:119], v[36:39]
    ds_read_b128 v[52:55], v16 offset:3584
    ds_read_b64 v[144:145], v17 offset:3584
    ds_read_b64 v[146:147], v17 offset:3592
    v_mfma_f32_16x16x32_f16 v[40:43], v[68:71], v[120:123], v[40:43]
    v_mfma_f32_16x16x32_f16 v[44:47], v[68:71], v[124:127], v[44:47]
    v_mfma_f32_16x16x32_f16 v[48:51], v[68:71], v[128:131], v[48:51]
    s_waitcnt lgkmcnt(9)
    v_mfma_f32_16x16x32_f16 v[32:35], v[64:67], v[116:119], v[32:35]
    v_mfma_f32_16x16x32_f16 v[36:39], v[64:67], v[120:123], v[36:39]
    v_mfma_f32_16x16x32_f16 v[40:43], v[64:67], v[124:127], v[40:43]
    v_mfma_f32_16x16x32_f16 v[44:47], v[64:67], v[128:131], v[44:47]
    v_mfma_f32_16x16x32_f16 v[48:51], v[64:67], v[132:135], v[48:51]
    s_waitcnt lgkmcnt(6)
    v_mfma_f32_16x16x32_f16 v[28:31], v[60:63], v[116:119], v[28:31]
    v_mfma_f32_16x16x32_f16 v[32:35], v[60:63], v[120:123], v[32:35]
    v_mfma_f32_16x16x32_f16 v[36:39], v[60:63], v[124:127], v[36:39]
    v_mfma_f32_16x16x32_f16 v[40:43], v[60:63], v[128:131], v[40:43]
    v_mfma_f32_16x16x32_f16 v[44:47], v[60:63], v[132:135], v[44:47]
    v_mfma_f32_16x16x32_f16 v[48:51], v[60:63], v[136:139], v[48:51]
    s_waitcnt lgkmcnt(3)
    v_mfma_f32_16x16x32_f16 v[24:27], v[56:59], v[116:119], v[24:27]
    v_mfma_f32_16x16x32_f16 v[28:31], v[56:59], v[120:123], v[28:31]
    v_mfma_f32_16x16x32_f16 v[32:35], v[56:59], v[124:127], v[32:35]
    v_mfma_f32_16x16x32_f16 v[36:39], v[56:59], v[128:131], v[36:39]
    v_mfma_f32_16x16x32_f16 v[40:43], v[56:59], v[132:135], v[40:43]
    v_mfma_f32_16x16x32_f16 v[44:47], v[56:59], v[136:139], v[44:47]
    v_mfma_f32_16x16x32_f16 v[48:51], v[56:59], v[140:143], v[48:51]
    s_waitcnt lgkmcnt(0)
    v_mfma_f32_16x16x32_f16 v[20:23], v[52:55], v[116:119], v[20:23]
    v_mfma_f32_16x16x32_f16 v[24:27], v[52:55], v[120:123], v[24:27]
    v_mfma_f32_16x16x32_f16 v[28:31], v[52:55], v[124:127], v[28:31]
    v_mfma_f32_16x16x32_f16 v[32:35], v[52:55], v[128:131], v[32:35]
    v_mfma_f32_16x16x32_f16 v[36:39], v[52:55], v[132:135], v[36:39]
    v_mfma_f32_16x16x32_f16 v[40:43], v[52:55], v[136:139], v[40:43]
    v_mfma_f32_16x16x32_f16 v[44:47], v[52:55], v[140:143], v[44:47]
    v_mfma_f32_16x16x32_f16 v[48:51], v[52:55], v[144:147], v[48:51]
    v_lshlrev_b32 v4, 4, v3
    s_nop 9
    s_cmp_eq_u32 s17, 0
    s_cbranch_scc0 K2_R0
    ds_write_b128 v4, v[28:31] offset:33024
    ds_write_b128 v4, v[32:35] offset:34048
    ds_write_b128 v4, v[36:39] offset:37120
    ds_write_b128 v4, v[40:43] offset:38144
    ds_write_b128 v4, v[44:47] offset:41216
    ds_write_b128 v4, v[48:51] offset:42240
    v_mov_b32 v52, v20
    v_mov_b32 v53, v21
    v_mov_b32 v54, v22
    v_mov_b32 v55, v23
    v_mov_b32 v56, v24
    v_mov_b32 v57, v25
    v_mov_b32 v58, v26
    v_mov_b32 v59, v27
K2_R0:
    s_cmp_eq_u32 s17, 1
    s_cbranch_scc0 K2_R1
    ds_write_b128 v4, v[20:23] offset:22784
    ds_write_b128 v4, v[24:27] offset:23808
    ds_write_b128 v4, v[36:39] offset:39168
    ds_write_b128 v4, v[40:43] offset:40192
    ds_write_b128 v4, v[44:47] offset:43264
    ds_write_b128 v4, v[48:51] offset:44288
    v_mov_b32 v52, v28
    v_mov_b32 v53, v29
    v_mov_b32 v54, v30
    v_mov_b32 v55, v31
    v_mov_b32 v56, v32
    v_mov_b32 v57, v33
    v_mov_b32 v58, v34
    v_mov_b32 v59, v35
K2_R1:
    s_cmp_eq_u32 s17, 2
    s_cbranch_scc0 K2_R2
    ds_write_b128 v4, v[20:23] offset:24832
    ds_write_b128 v4, v[24:27] offset:25856
    ds_write_b128 v4, v[28:31] offset:28928
    ds_write_b128 v4, v[32:35] offset:29952
    ds_write_b128 v4, v[44:47] offset:45312
    ds_write_b128 v4, v[48:51] offset:46336
    v_mov_b32 v52, v36
    v_mov_b32 v53, v37
    v_mov_b32 v54, v38
    v_mov_b32 v55, v39
    v_mov_b32 v56, v40
    v_mov_b32 v57, v41
    v_mov_b32 v58, v42
    v_mov_b32 v59, v43
K2_R2:
    s_cmp_eq_u32 s17, 3
    s_cbranch_scc0 K2_R3
    ds_write_b128 v4, v[20:23] offset:26880
    ds_write_b128 v4, v[24:27] offset:27904
    ds_write_b128 v4, v[28:31] offset:30976
    ds_write_b128 v4, v[32:35] offset:32000
    ds_write_b128 v4, v[36:39] offset:35072
    ds_write_b128 v4, v[40:43] offset:36096
    v_mov_b32 v52, v44
    v_mov_b32 v53, v45
    v_mov_b32 v54, v46
    v_mov_b32 v55, v47
    v_mov_b32 v56, v48
    v_mov_b32 v57, v49
    v_mov_b32 v58, v50
    v_mov_b32 v59, v51
K2_R3:
    s_nop 7
    s_waitcnt lgkmcnt(0)
    s_barrier
    s_mul_i32 s20, s17, 6144
    v_add_u32 v4, s20, v4
    ds_read_b128 v[60:63], v4 offset:22784
    ds_read_b128 v[64:67], v4 offset:23808
    ds_read_b128 v[68:71], v4 offset:24832
    ds_read_b128 v[72:75], v4 offset:25856
    ds_read_b128 v[76:79], v4 offset:26880
    ds_read_b128 v[80:83], v4 offset:27904
    s_lshl_b32 s20, s17, 10
    v_lshl_add_u32 v5, v3, 3, s20
    ds_read_b64 v[84:85], v5 offset:18688
    ds_read_b64 v[86:87], v5 offset:19200
    s_waitcnt lgkmcnt(0)
    s_lshl_b32 s26, s25, 16
    s_and_b32 s27, s25, 0xffff0000
    s_bitcmp1_b32 s3, 0
    s_cselect_b32 s25, s27, s26
    v_pk_add_f32 v[52:53], v[52:53], v[60:61]
    v_pk_add_f32 v[54:55], v[54:55], v[62:63]
    v_pk_add_f32 v[56:57], v[56:57], v[64:65]
    v_pk_add_f32 v[58:59], v[58:59], v[66:67]
    v_pk_add_f32 v[52:53], v[52:53], v[68:69]
    v_pk_add_f32 v[54:55], v[54:55], v[70:71]
    v_pk_add_f32 v[56:57], v[56:57], v[72:73]
    v_pk_add_f32 v[58:59], v[58:59], v[74:75]
    v_pk_add_f32 v[52:53], v[52:53], v[76:77]
    v_pk_add_f32 v[54:55], v[54:55], v[78:79]
    v_pk_add_f32 v[56:57], v[56:57], v[80:81]
    v_pk_add_f32 v[58:59], v[58:59], v[82:83]
    v_mul_f32 v52, s24, v52
    v_mul_f32 v53, s24, v53
    v_cvt_pk_bf16_f32 v6, v52, v53
    v_lshlrev_b32 v52, 16, v6
    v_and_b32 v53, 0xffff0000, v6
    v_cvt_f32_f16 v8, v84
    v_cvt_f32_f16_sdwa v9, v84 dst_sel:DWORD dst_unused:UNUSED_PAD src0_sel:WORD_1
    v_mul_f32 v8, s25, v8
    v_mul_f32 v9, s25, v9
    v_cvt_pk_bf16_f32 v6, v8, v9
    v_lshlrev_b32 v8, 16, v6
    v_and_b32 v9, 0xffff0000, v6
    v_pk_add_f32 v[8:9], v[8:9], v[52:53]
    v_cvt_pk_bf16_f32 v88, v8, v9
    v_mul_f32 v54, s24, v54
    v_mul_f32 v55, s24, v55
    v_cvt_pk_bf16_f32 v6, v54, v55
    v_lshlrev_b32 v54, 16, v6
    v_and_b32 v55, 0xffff0000, v6
    v_cvt_f32_f16 v8, v85
    v_cvt_f32_f16_sdwa v9, v85 dst_sel:DWORD dst_unused:UNUSED_PAD src0_sel:WORD_1
    v_mul_f32 v8, s25, v8
    v_mul_f32 v9, s25, v9
    v_cvt_pk_bf16_f32 v6, v8, v9
    v_lshlrev_b32 v8, 16, v6
    v_and_b32 v9, 0xffff0000, v6
    v_pk_add_f32 v[8:9], v[8:9], v[54:55]
    v_cvt_pk_bf16_f32 v89, v8, v9
    v_mul_f32 v56, s24, v56
    v_mul_f32 v57, s24, v57
    v_cvt_pk_bf16_f32 v6, v56, v57
    v_lshlrev_b32 v56, 16, v6
    v_and_b32 v57, 0xffff0000, v6
    v_cvt_f32_f16 v8, v86
    v_cvt_f32_f16_sdwa v9, v86 dst_sel:DWORD dst_unused:UNUSED_PAD src0_sel:WORD_1
    v_mul_f32 v8, s25, v8
    v_mul_f32 v9, s25, v9
    v_cvt_pk_bf16_f32 v6, v8, v9
    v_lshlrev_b32 v8, 16, v6
    v_and_b32 v9, 0xffff0000, v6
    v_pk_add_f32 v[8:9], v[8:9], v[56:57]
    v_cvt_pk_bf16_f32 v90, v8, v9
    v_mul_f32 v58, s24, v58
    v_mul_f32 v59, s24, v59
    v_cvt_pk_bf16_f32 v6, v58, v59
    v_lshlrev_b32 v58, 16, v6
    v_and_b32 v59, 0xffff0000, v6
    v_cvt_f32_f16 v8, v87
    v_cvt_f32_f16_sdwa v9, v87 dst_sel:DWORD dst_unused:UNUSED_PAD src0_sel:WORD_1
    v_mul_f32 v8, s25, v8
    v_mul_f32 v9, s25, v9
    v_cvt_pk_bf16_f32 v6, v8, v9
    v_lshlrev_b32 v8, 16, v6
    v_and_b32 v9, 0xffff0000, v6
    v_pk_add_f32 v[8:9], v[8:9], v[58:59]
    v_cvt_pk_bf16_f32 v91, v8, v9
    v_and_b32 v6, 1, v3
    v_cmp_eq_u32 vcc, 1, v6
    s_nop 1
    v_cndmask_b32 v8, v90, v88, vcc
    v_cndmask_b32 v9, v91, v89, vcc
    v_lshrrev_b32 v7, 1, v3
    v_lshl_add_u32 v7, v6, 5, v7
    v_mul_u32_u24 v7, 9216, v7
    v_mov_b32_dpp v10, v8 quad_perm:[1,0,3,2] row_mask:0xf bank_mask:0xf
    v_mov_b32_dpp v11, v9 quad_perm:[1,0,3,2] row_mask:0xf bank_mask:0xf
    s_mul_i32 s20, s17, 589824
    s_lshl_b32 s21, s3, 4
    s_add_u32 s20, s20, s21
    v_cndmask_b32 v88, v88, v10, vcc
    v_cndmask_b32 v89, v89, v11, vcc
    v_cndmask_b32 v90, v10, v90, vcc
    v_cndmask_b32 v91, v11, v91, vcc
    buffer_store_dwordx4 v[88:91], v7, s[28:31], s20 offen
K2_END:
    s_endpgm
.globl k3_kernel
.p2align 8
.type k3_kernel,@function
k3_kernel:
    s_cmp_ge_u32 s2, 256
    s_cbranch_scc1 K3_END
    s_load_dwordx2 s[4:5], s[0:1], 0
    s_load_dwordx2 s[6:7], s[0:1], 128
    s_load_dwordx2 s[32:33], s[0:1], 80
    s_load_dwordx2 s[34:35], s[0:1], 112
    s_and_b32 s16, s2, 7
    s_lshl_b32 s16, s16, 5
    s_lshr_b32 s3, s2, 3
    s_add_u32 s16, s3, s16
    s_mul_i32 s3, s16, 9216
    s_lshl_b32 s17, s16, 4
    v_lshrrev_b32 v1, 5, v0
    v_and_b32 v2, 31, v0
    v_mul_u32_u24 v3, 1152, v1
    v_lshl_add_u32 v3, v2, 2, v3
    v_lshlrev_b32 v6, 4, v0
    v_lshlrev_b32 v7, 2, v2
    v_readfirstlane_b32 s18, v0
    s_waitcnt lgkmcnt(0)
    s_mov_b32 s8, s4
    s_mov_b32 s9, s5
    s_mov_b32 s10, 0x240000
    s_mov_b32 s11, 0x20000
    s_add_u32 s12, s6, 0x600000
    s_addc_u32 s13, s7, 0
    s_mov_b32 s14, 0x240000
    s_mov_b32 s15, 0x20000
    s_mov_b32 s20, s32
    s_mov_b32 s21, s33
    s_mov_b32 s22, 0x480
    s_mov_b32 s23, 0x20000
    s_add_u32 s19, s3, 4096
    buffer_load_dwordx4 v[60:63], v6, s[12:15], s3 offen
    buffer_load_dwordx4 v[64:67], v6, s[12:15], s19 offen
    s_add_u32 s19, s3, 8192
    v_and_b32 v9, 0x3ff, v6
    buffer_load_dwordx4 v[68:71], v9, s[12:15], s19 offen
    buffer_load_dword v10, v3, s[8:11], s3 offen offset:0
    buffer_load_dword v11, v3, s[8:11], s3 offen offset:128
    buffer_load_dword v12, v3, s[8:11], s3 offen offset:256
    buffer_load_dword v13, v3, s[8:11], s3 offen offset:384
    buffer_load_dword v14, v3, s[8:11], s3 offen offset:512
    buffer_load_dword v15, v3, s[8:11], s3 offen offset:640
    buffer_load_dword v16, v3, s[8:11], s3 offen offset:768
    buffer_load_dword v17, v3, s[8:11], s3 offen offset:896
    buffer_load_dword v18, v3, s[8:11], s3 offen offset:1024
    buffer_load_dword v50, v7, s[20:23], 0 offen offset:0
    buffer_load_dword v51, v7, s[20:23], 0 offen offset:128
    buffer_load_dword v52, v7, s[20:23], 0 offen offset:256
    buffer_load_dword v53, v7, s[20:23], 0 offen offset:384
    buffer_load_dword v54, v7, s[20:23], 0 offen offset:512
    buffer_load_dword v55, v7, s[20:23], 0 offen offset:640
    buffer_load_dword v56, v7, s[20:23], 0 offen offset:768
    buffer_load_dword v57, v7, s[20:23], 0 offen offset:896
    buffer_load_dword v58, v7, s[20:23], 0 offen offset:1024
    s_mov_b32 s24, s34
    s_mov_b32 s25, s35
    s_mov_b32 s26, 0x240000
    s_mov_b32 s27, 0x20000
    s_add_u32 s28, s6, 0x900000
    s_addc_u32 s29, s7, 0
    s_mov_b32 s30, 0x240000
    s_mov_b32 s31, 0x20000
    s_add_u32 s36, s6, 0xc00000
    s_addc_u32 s37, s7, 0
    s_mov_b32 s38, 0x2000
    s_mov_b32 s39, 0x20000
    v_lshrrev_b32 v4, 6, v0
    v_mul_u32_u24 v4, 2304, v4
    v_lshl_add_u32 v4, v2, 3, v4
    v_and_b32 v5, 1, v1
    v_mul_u32_u24 v5, 0x020202, v5
    v_lshlrev_b32 v8, 25, v1
    v_and_b32 v8, 0x02000000, v8
    v_or_b32 v5, v5, v8
    v_add_u32 v5, 0x05040100, v5
    v_lshlrev_b32 v8, 2, v0
    s_waitcnt vmcnt(19)
    ds_write2st64_b32 v8, v60, v61 offset0:0 offset1:9
    ds_write2st64_b32 v8, v62, v63 offset0:18 offset1:27
    ds_write2st64_b32 v8, v64, v65 offset0:4 offset1:13
    ds_write2st64_b32 v8, v66, v67 offset0:22 offset1:31
    s_waitcnt vmcnt(18)
    s_cmp_ge_u32 s18, 64
    s_cbranch_scc1 K3_SKIP
    ds_write2st64_b32 v8, v68, v69 offset0:8 offset1:17
    ds_write2st64_b32 v8, v70, v71 offset0:26 offset1:35
K3_SKIP:
    s_waitcnt lgkmcnt(0)
    s_barrier
    ds_read_b64 v[60:61], v4 offset:0
    ds_read_b64 v[62:63], v4 offset:256
    ds_read_b64 v[64:65], v4 offset:512
    ds_read_b64 v[66:67], v4 offset:768
    ds_read_b64 v[68:69], v4 offset:1024
    ds_read_b64 v[70:71], v4 offset:1280
    ds_read_b64 v[72:73], v4 offset:1536
    ds_read_b64 v[74:75], v4 offset:1792
    ds_read_b64 v[76:77], v4 offset:2048
    s_waitcnt vmcnt(9)
    s_waitcnt lgkmcnt(8)
    v_perm_b32 v44, v61, v60, v5
    v_lshlrev_b32 v46, 16, v44
    v_and_b32 v47, 0xffff0000, v44
    v_lshlrev_b32 v20, 16, v10
    v_and_b32 v21, 0xffff0000, v10
    v_pk_add_f32 v[46:47], v[46:47], v[20:21]
    v_cvt_pk_bf16_f32 v44, v46, v47
    v_lshlrev_b32 v20, 16, v44
    v_and_b32 v21, 0xffff0000, v44
    s_waitcnt lgkmcnt(7)
    v_perm_b32 v44, v63, v62, v5
    v_lshlrev_b32 v46, 16, v44
    v_and_b32 v47, 0xffff0000, v44
    v_lshlrev_b32 v22, 16, v11
    v_and_b32 v23, 0xffff0000, v11
    v_pk_add_f32 v[46:47], v[46:47], v[22:23]
    v_cvt_pk_bf16_f32 v44, v46, v47
    v_lshlrev_b32 v22, 16, v44
    v_and_b32 v23, 0xffff0000, v44
    s_waitcnt lgkmcnt(6)
    v_perm_b32 v44, v65, v64, v5
    v_lshlrev_b32 v46, 16, v44
    v_and_b32 v47, 0xffff0000, v44
    v_lshlrev_b32 v24, 16, v12
    v_and_b32 v25, 0xffff0000, v12
    v_pk_add_f32 v[46:47], v[46:47], v[24:25]
    v_cvt_pk_bf16_f32 v44, v46, v47
    v_lshlrev_b32 v24, 16, v44
    v_and_b32 v25, 0xffff0000, v44
    s_waitcnt lgkmcnt(5)
    v_perm_b32 v44, v67, v66, v5
    v_lshlrev_b32 v46, 16, v44
    v_and_b32 v47, 0xffff0000, v44
    v_lshlrev_b32 v26, 16, v13
    v_and_b32 v27, 0xffff0000, v13
    v_pk_add_f32 v[46:47], v[46:47], v[26:27]
    v_cvt_pk_bf16_f32 v44, v46, v47
    v_lshlrev_b32 v26, 16, v44
    v_and_b32 v27, 0xffff0000, v44
    s_waitcnt lgkmcnt(4)
    v_perm_b32 v44, v69, v68, v5
    v_lshlrev_b32 v46, 16, v44
    v_and_b32 v47, 0xffff0000, v44
    v_lshlrev_b32 v28, 16, v14
    v_and_b32 v29, 0xffff0000, v14
    v_pk_add_f32 v[46:47], v[46:47], v[28:29]
    v_cvt_pk_bf16_f32 v44, v46, v47
    v_lshlrev_b32 v28, 16, v44
    v_and_b32 v29, 0xffff0000, v44
    s_waitcnt lgkmcnt(3)
    v_perm_b32 v44, v71, v70, v5
    v_lshlrev_b32 v46, 16, v44
    v_and_b32 v47, 0xffff0000, v44
    v_lshlrev_b32 v30, 16, v15
    v_and_b32 v31, 0xffff0000, v15
    v_pk_add_f32 v[46:47], v[46:47], v[30:31]
    v_cvt_pk_bf16_f32 v44, v46, v47
    v_lshlrev_b32 v30, 16, v44
    v_and_b32 v31, 0xffff0000, v44
    s_waitcnt lgkmcnt(2)
    v_perm_b32 v44, v73, v72, v5
    v_lshlrev_b32 v46, 16, v44
    v_and_b32 v47, 0xffff0000, v44
    v_lshlrev_b32 v32, 16, v16
    v_and_b32 v33, 0xffff0000, v16
    v_pk_add_f32 v[46:47], v[46:47], v[32:33]
    v_cvt_pk_bf16_f32 v44, v46, v47
    v_lshlrev_b32 v32, 16, v44
    v_and_b32 v33, 0xffff0000, v44
    s_waitcnt lgkmcnt(1)
    v_perm_b32 v44, v75, v74, v5
    v_lshlrev_b32 v46, 16, v44
    v_and_b32 v47, 0xffff0000, v44
    v_lshlrev_b32 v34, 16, v17
    v_and_b32 v35, 0xffff0000, v17
    v_pk_add_f32 v[46:47], v[46:47], v[34:35]
    v_cvt_pk_bf16_f32 v44, v46, v47
    v_lshlrev_b32 v34, 16, v44
    v_and_b32 v35, 0xffff0000, v44
    s_waitcnt lgkmcnt(0)
    v_perm_b32 v44, v77, v76, v5
    v_lshlrev_b32 v46, 16, v44
    v_and_b32 v47, 0xffff0000, v44
    v_lshlrev_b32 v36, 16, v18
    v_and_b32 v37, 0xffff0000, v18
    v_pk_add_f32 v[46:47], v[46:47], v[36:37]
    v_cvt_pk_bf16_f32 v44, v46, v47
    v_lshlrev_b32 v36, 16, v44
    v_and_b32 v37, 0xffff0000, v44
    v_pk_add_f32 v[44:45], v[20:21], v[22:23]
    v_pk_add_f32 v[46:47], v[24:25], v[26:27]
    v_pk_add_f32 v[44:45], v[44:45], v[28:29]
    v_pk_add_f32 v[46:47], v[46:47], v[30:31]
    v_pk_add_f32 v[44:45], v[44:45], v[32:33]
    v_pk_add_f32 v[46:47], v[46:47], v[34:35]
    v_pk_add_f32 v[44:45], v[44:45], v[36:37]
    v_pk_add_f32 v[44:45], v[44:45], v[46:47]
    v_add_f32 v44, v44, v45
    s_nop 1
    v_add_f32_dpp v44, v44, v44 row_ror:8 row_mask:0xf bank_mask:0xf
    s_nop 1
    v_add_f32_dpp v44, v44, v44 row_ror:4 row_mask:0xf bank_mask:0xf
    s_nop 1
    v_add_f32_dpp v44, v44, v44 row_ror:2 row_mask:0xf bank_mask:0xf
    s_nop 1
    v_add_f32_dpp v44, v44, v44 row_ror:1 row_mask:0xf bank_mask:0xf
    v_mov_b32 v46, v44
    s_nop 1
    v_permlane16_swap_b32 v44, v46
    v_add_f32 v44, v44, v46
    v_mul_f32 v48, 0x3ae38e39, v44
    v_mov_b32 v49, v48
    v_cvt_pk_bf16_f32 v40, v48, v48
    v_and_b32 v40, 0xffff0000, v40
    v_mov_b32 v41, v40
    v_pk_add_f32 v[42:43], v[20:21], v[48:49] neg_lo:[0,1] neg_hi:[0,1]
    v_pk_mul_f32 v[44:45], v[42:43], v[42:43]
    v_pk_add_f32 v[42:43], v[22:23], v[48:49] neg_lo:[0,1] neg_hi:[0,1]
    v_pk_mul_f32 v[46:47], v[42:43], v[42:43]
    v_pk_add_f32 v[42:43], v[24:25], v[48:49] neg_lo:[0,1] neg_hi:[0,1]
    v_pk_fma_f32 v[44:45], v[42:43], v[42:43], v[44:45]
    v_pk_add_f32 v[42:43], v[26:27], v[48:49] neg_lo:[0,1] neg_hi:[0,1]
    v_pk_fma_f32 v[46:47], v[42:43], v[42:43], v[46:47]
    v_pk_add_f32 v[42:43], v[28:29], v[48:49] neg_lo:[0,1] neg_hi:[0,1]
    v_pk_fma_f32 v[44:45], v[42:43], v[42:43], v[44:45]
    v_pk_add_f32 v[42:43], v[30:31], v[48:49] neg_lo:[0,1] neg_hi:[0,1]
    v_pk_fma_f32 v[46:47], v[42:43], v[42:43], v[46:47]
    v_pk_add_f32 v[42:43], v[32:33], v[48:49] neg_lo:[0,1] neg_hi:[0,1]
    v_pk_fma_f32 v[44:45], v[42:43], v[42:43], v[44:45]
    v_pk_add_f32 v[42:43], v[34:35], v[48:49] neg_lo:[0,1] neg_hi:[0,1]
    v_pk_fma_f32 v[46:47], v[42:43], v[42:43], v[46:47]
    v_pk_add_f32 v[42:43], v[36:37], v[48:49] neg_lo:[0,1] neg_hi:[0,1]
    v_pk_fma_f32 v[44:45], v[42:43], v[42:43], v[44:45]
    v_pk_add_f32 v[44:45], v[44:45], v[46:47]
    v_add_f32 v44, v44, v45
    s_nop 1
    v_add_f32_dpp v44, v44, v44 row_ror:8 row_mask:0xf bank_mask:0xf
    s_nop 1
    v_add_f32_dpp v44, v44, v44 row_ror:4 row_mask:0xf bank_mask:0xf
    s_nop 1
    v_add_f32_dpp v44, v44, v44 row_ror:2 row_mask:0xf bank_mask:0xf
    s_nop 1
    v_add_f32_dpp v44, v44, v44 row_ror:1 row_mask:0xf bank_mask:0xf
    v_mov_b32 v46, v44
    s_nop 1
    v_permlane16_swap_b32 v44, v46
    v_add_f32 v44, v44, v46
    v_mul_f32 v44, 0x3ae38e39, v44
    v_cvt_pk_bf16_f32 v44, v44, v44
    v_and_b32 v44, 0xffff0000, v44
    v_add_f32 v44, 0x3727c5ac, v44
    v_cvt_pk_bf16_f32 v44, v44, v44
    v_and_b32 v44, 0xffff0000, v44
    v_sqrt_f32 v44, v44
    s_nop 0
    v_cvt_pk_bf16_f32 v44, v44, v44
    v_and_b32 v44, 0xffff0000, v44
    v_rcp_f32 v42, v44
    s_nop 0
    v_mov_b32 v43, v42
    s_waitcnt vmcnt(0)
    v_mov_b32 v60, 0
    v_mov_b32 v61, 0
    v_pk_add_f32 v[44:45], v[20:21], v[40:41] neg_lo:[0,1] neg_hi:[0,1]
    v_cvt_pk_bf16_f32 v10, v44, v45
    v_lshlrev_b32 v44, 16, v10
    v_and_b32 v45, 0xffff0000, v10
    v_pk_mul_f32 v[44:45], v[44:45], v[42:43]
    v_cvt_pk_bf16_f32 v10, v44, v45
    v_lshlrev_b32 v44, 16, v10
    v_and_b32 v45, 0xffff0000, v10
    buffer_store_dword v10, v3, s[28:31], s3 offen offset:0 sc1
    v_lshlrev_b32 v46, 16, v50
    v_and_b32 v47, 0xffff0000, v50
    v_pk_fma_f32 v[60:61], v[44:45], v[46:47], v[60:61]
    v_pk_add_f32 v[44:45], v[44:45], v[20:21]
    v_cvt_pk_bf16_f32 v50, v44, v45
    buffer_store_dword v50, v3, s[24:27], s3 offen offset:0 sc1
    v_pk_add_f32 v[44:45], v[22:23], v[40:41] neg_lo:[0,1] neg_hi:[0,1]
    v_cvt_pk_bf16_f32 v11, v44, v45
    v_lshlrev_b32 v44, 16, v11
    v_and_b32 v45, 0xffff0000, v11
    v_pk_mul_f32 v[44:45], v[44:45], v[42:43]
    v_cvt_pk_bf16_f32 v11, v44, v45
    v_lshlrev_b32 v44, 16, v11
    v_and_b32 v45, 0xffff0000, v11
    buffer_store_dword v11, v3, s[28:31], s3 offen offset:128 sc1
    v_lshlrev_b32 v46, 16, v51
    v_and_b32 v47, 0xffff0000, v51
    v_pk_fma_f32 v[60:61], v[44:45], v[46:47], v[60:61]
    v_pk_add_f32 v[44:45], v[44:45], v[22:23]
    v_cvt_pk_bf16_f32 v51, v44, v45
    buffer_store_dword v51, v3, s[24:27], s3 offen offset:128 sc1
    v_pk_add_f32 v[44:45], v[24:25], v[40:41] neg_lo:[0,1] neg_hi:[0,1]
    v_cvt_pk_bf16_f32 v12, v44, v45
    v_lshlrev_b32 v44, 16, v12
    v_and_b32 v45, 0xffff0000, v12
    v_pk_mul_f32 v[44:45], v[44:45], v[42:43]
    v_cvt_pk_bf16_f32 v12, v44, v45
    v_lshlrev_b32 v44, 16, v12
    v_and_b32 v45, 0xffff0000, v12
    buffer_store_dword v12, v3, s[28:31], s3 offen offset:256 sc1
    v_lshlrev_b32 v46, 16, v52
    v_and_b32 v47, 0xffff0000, v52
    v_pk_fma_f32 v[60:61], v[44:45], v[46:47], v[60:61]
    v_pk_add_f32 v[44:45], v[44:45], v[24:25]
    v_cvt_pk_bf16_f32 v52, v44, v45
    buffer_store_dword v52, v3, s[24:27], s3 offen offset:256 sc1
    v_pk_add_f32 v[44:45], v[26:27], v[40:41] neg_lo:[0,1] neg_hi:[0,1]
    v_cvt_pk_bf16_f32 v13, v44, v45
    v_lshlrev_b32 v44, 16, v13
    v_and_b32 v45, 0xffff0000, v13
    v_pk_mul_f32 v[44:45], v[44:45], v[42:43]
    v_cvt_pk_bf16_f32 v13, v44, v45
    v_lshlrev_b32 v44, 16, v13
    v_and_b32 v45, 0xffff0000, v13
    buffer_store_dword v13, v3, s[28:31], s3 offen offset:384 sc1
    v_lshlrev_b32 v46, 16, v53
    v_and_b32 v47, 0xffff0000, v53
    v_pk_fma_f32 v[60:61], v[44:45], v[46:47], v[60:61]
    v_pk_add_f32 v[44:45], v[44:45], v[26:27]
    v_cvt_pk_bf16_f32 v53, v44, v45
    buffer_store_dword v53, v3, s[24:27], s3 offen offset:384 sc1
    v_pk_add_f32 v[44:45], v[28:29], v[40:41] neg_lo:[0,1] neg_hi:[0,1]
    v_cvt_pk_bf16_f32 v14, v44, v45
    v_lshlrev_b32 v44, 16, v14
    v_and_b32 v45, 0xffff0000, v14
    v_pk_mul_f32 v[44:45], v[44:45], v[42:43]
    v_cvt_pk_bf16_f32 v14, v44, v45
    v_lshlrev_b32 v44, 16, v14
    v_and_b32 v45, 0xffff0000, v14
    buffer_store_dword v14, v3, s[28:31], s3 offen offset:512 sc1
    v_lshlrev_b32 v46, 16, v54
    v_and_b32 v47, 0xffff0000, v54
    v_pk_fma_f32 v[60:61], v[44:45], v[46:47], v[60:61]
    v_pk_add_f32 v[44:45], v[44:45], v[28:29]
    v_cvt_pk_bf16_f32 v54, v44, v45
    buffer_store_dword v54, v3, s[24:27], s3 offen offset:512 sc1
    v_pk_add_f32 v[44:45], v[30:31], v[40:41] neg_lo:[0,1] neg_hi:[0,1]
    v_cvt_pk_bf16_f32 v15, v44, v45
    v_lshlrev_b32 v44, 16, v15
    v_and_b32 v45, 0xffff0000, v15
    v_pk_mul_f32 v[44:45], v[44:45], v[42:43]
    v_cvt_pk_bf16_f32 v15, v44, v45
    v_lshlrev_b32 v44, 16, v15
    v_and_b32 v45, 0xffff0000, v15
    buffer_store_dword v15, v3, s[28:31], s3 offen offset:640 sc1
    v_lshlrev_b32 v46, 16, v55
    v_and_b32 v47, 0xffff0000, v55
    v_pk_fma_f32 v[60:61], v[44:45], v[46:47], v[60:61]
    v_pk_add_f32 v[44:45], v[44:45], v[30:31]
    v_cvt_pk_bf16_f32 v55, v44, v45
    buffer_store_dword v55, v3, s[24:27], s3 offen offset:640 sc1
    v_pk_add_f32 v[44:45], v[32:33], v[40:41] neg_lo:[0,1] neg_hi:[0,1]
    v_cvt_pk_bf16_f32 v16, v44, v45
    v_lshlrev_b32 v44, 16, v16
    v_and_b32 v45, 0xffff0000, v16
    v_pk_mul_f32 v[44:45], v[44:45], v[42:43]
    v_cvt_pk_bf16_f32 v16, v44, v45
    v_lshlrev_b32 v44, 16, v16
    v_and_b32 v45, 0xffff0000, v16
    buffer_store_dword v16, v3, s[28:31], s3 offen offset:768 sc1
    v_lshlrev_b32 v46, 16, v56
    v_and_b32 v47, 0xffff0000, v56
    v_pk_fma_f32 v[60:61], v[44:45], v[46:47], v[60:61]
    v_pk_add_f32 v[44:45], v[44:45], v[32:33]
    v_cvt_pk_bf16_f32 v56, v44, v45
    buffer_store_dword v56, v3, s[24:27], s3 offen offset:768 sc1
    v_pk_add_f32 v[44:45], v[34:35], v[40:41] neg_lo:[0,1] neg_hi:[0,1]
    v_cvt_pk_bf16_f32 v17, v44, v45
    v_lshlrev_b32 v44, 16, v17
    v_and_b32 v45, 0xffff0000, v17
    v_pk_mul_f32 v[44:45], v[44:45], v[42:43]
    v_cvt_pk_bf16_f32 v17, v44, v45
    v_lshlrev_b32 v44, 16, v17
    v_and_b32 v45, 0xffff0000, v17
    buffer_store_dword v17, v3, s[28:31], s3 offen offset:896 sc1
    v_lshlrev_b32 v46, 16, v57
    v_and_b32 v47, 0xffff0000, v57
    v_pk_fma_f32 v[60:61], v[44:45], v[46:47], v[60:61]
    v_pk_add_f32 v[44:45], v[44:45], v[34:35]
    v_cvt_pk_bf16_f32 v57, v44, v45
    buffer_store_dword v57, v3, s[24:27], s3 offen offset:896 sc1
    v_pk_add_f32 v[44:45], v[36:37], v[40:41] neg_lo:[0,1] neg_hi:[0,1]
    v_cvt_pk_bf16_f32 v18, v44, v45
    v_lshlrev_b32 v44, 16, v18
    v_and_b32 v45, 0xffff0000, v18
    v_pk_mul_f32 v[44:45], v[44:45], v[42:43]
    v_cvt_pk_bf16_f32 v18, v44, v45
    v_lshlrev_b32 v44, 16, v18
    v_and_b32 v45, 0xffff0000, v18
    buffer_store_dword v18, v3, s[28:31], s3 offen offset:1024 sc1
    v_lshlrev_b32 v46, 16, v58
    v_and_b32 v47, 0xffff0000, v58
    v_pk_fma_f32 v[60:61], v[44:45], v[46:47], v[60:61]
    v_pk_add_f32 v[44:45], v[44:45], v[36:37]
    v_cvt_pk_bf16_f32 v58, v44, v45
    buffer_store_dword v58, v3, s[24:27], s3 offen offset:1024 sc1
    v_add_f32 v60, v60, v61
    s_nop 1
    v_add_f32_dpp v60, v60, v60 row_ror:8 row_mask:0xf bank_mask:0xf
    s_nop 1
    v_add_f32_dpp v60, v60, v60 row_ror:4 row_mask:0xf bank_mask:0xf
    s_nop 1
    v_add_f32_dpp v60, v60, v60 row_ror:2 row_mask:0xf bank_mask:0xf
    s_nop 1
    v_add_f32_dpp v60, v60, v60 row_ror:1 row_mask:0xf bank_mask:0xf
    v_mov_b32 v61, v60
    s_nop 1
    v_permlane16_swap_b32 v60, v61
    v_add_f32 v60, v60, v61
    v_cvt_pk_bf16_f32 v60, v60, v60
    v_ashrrev_i32 v61, 31, v60
    v_or_b32 v61, 0x80000000, v61
    v_xor_b32 v60, v60, v61
    v_and_b32 v60, 0xffff0000, v60
    s_lshl_b32 s19, s16, 3
    v_add_u32 v61, s19, v1
    v_sub_u32 v62, 0x87ff, v61
    v_or_b32 v60, v60, v62
    v_lshlrev_b32 v61, 2, v61
    v_cmp_eq_u32 vcc, 0, v2
    s_and_saveexec_b64 s[40:41], vcc
    buffer_store_dword v60, v61, s[36:39], 0 offen
K3_END:
    s_endpgm
.globl k4_kernel
.p2align 8
.type k4_kernel,@function
k4_kernel:
    s_cmp_ge_u32 s2, 144
    s_cbranch_scc1 K4_END
    s_load_dwordx2 s[34:35], s[0:1], 128
    s_load_dwordx4 s[4:7], s[0:1], 88
    s_load_dwordx2 s[32:33], s[0:1], 104
    s_load_dwordx2 s[30:31], s[0:1], 0
    s_and_b32 s16, s2, 7
    s_lshr_b32 s3, s2, 3
    s_mul_i32 s2, s16, 18
    s_add_u32 s2, s2, s3
    v_readfirstlane_b32 s17, v0
    s_lshr_b32 s17, s17, 6
    v_and_b32 v1, 63, v0
    v_and_b32 v2, 15, v1
    v_lshrrev_b32 v3, 4, v1
    s_mov_b32 s28, 0x05040100
    s_mov_b32 s29, 0x07060302
    s_cmp_ge_u32 s17, 9
    s_cbranch_scc1 K4_G
    s_setprio 3
    v_mov_b32 v4, 0
    v_lshlrev_b32 v5, 2, v0
    v_min_u32 v5, 1084, v5
    ds_write_b32 v5, v4
    v_lshlrev_b32 v4, 4, v0
    v_and_b32 v6, 1, v1
    v_subrev_u32 v6, 1, v6
    s_cmp_lt_u32 s17, 4
    s_cselect_b32 s38, 8192, 0
    s_waitcnt lgkmcnt(0)
    s_add_u32 s36, s34, 0xc00000
    s_addc_u32 s37, s35, 0
    s_mov_b32 s39, 0x20000
    buffer_load_dwordx4 v[8:11], v4, s[36:39], 0 offen
    s_movk_i32 s19, 4096
    buffer_load_dwordx4 v[12:15], v4, s[36:39], s19 offen
    s_barrier
    s_mov_b32 s8, s32
    s_mov_b32 s9, s33
    s_mov_b32 s10, 0x510000
    s_mov_b32 s11, 0x20000
    s_add_u32 s20, s34, 0xd00000
    s_addc_u32 s21, s35, 0
    s_mov_b32 s22, 0x288000
    s_mov_b32 s23, 0x20000
    v_mul_u32_u24 v5, 9216, v3
    v_lshl_add_u32 v5, v2, 3, v5
    s_mul_i32 s18, s2, 36864
    s_lshl_b32 s19, s17, 7
    s_add_u32 s18, s18, s19
    v_and_b32 v7, 7, v1
    v_lshlrev_b32 v7, 2, v7
    s_waitcnt vmcnt(0)
    s_cmp_eq_u32 s17, 8
    s_cbranch_scc1 K4_B_POLL
    s_cmp_eq_u32 s17, 4
    s_cbranch_scc1 K4_L2
    s_cmp_gt_u32 s17, 4
    s_cbranch_scc1 K4_B_LOW
    v_max_u32 v16, v8, v9
    v_min_u32 v9, v8, v9
    v_max_u32 v17, v12, v13
    v_min_u32 v13, v12, v13
    v_max_u32 v18, v10, v11
    v_min_u32 v11, v10, v11
    v_max_u32 v19, v14, v15
    v_min_u32 v15, v14, v15
    v_max_u32 v20, v16, v18
    v_min_u32 v18, v16, v18
    v_max_u32 v21, v17, v19
    v_min_u32 v19, v17, v19
    v_max_u32 v22, v9, v11
    v_min_u32 v11, v9, v11
    v_max_u32 v23, v13, v15
    v_min_u32 v15, v13, v15
    v_max_u32 v24, v22, v18
    v_min_u32 v18, v22, v18
    v_max_u32 v25, v23, v19
    v_min_u32 v19, v23, v19
    v_mov_b32_dpp v26, v11 quad_perm:[1,0,3,2] row_mask:0xf bank_mask:0xf
    v_mov_b32_dpp v27, v18 quad_perm:[1,0,3,2] row_mask:0xf bank_mask:0xf
    v_mov_b32_dpp v8, v24 quad_perm:[1,0,3,2] row_mask:0xf bank_mask:0xf
    v_mov_b32_dpp v12, v20 quad_perm:[1,0,3,2] row_mask:0xf bank_mask:0xf
    v_med3_u32 v26, v20, v26, v6
    v_med3_u32 v27, v24, v27, v6
    v_med3_u32 v8, v18, v8, v6
    v_med3_u32 v12, v11, v12, v6
    v_max_u32 v10, v26, v8
    v_min_u32 v8, v26, v8
    v_max_u32 v14, v27, v12
    v_min_u32 v12, v27, v12
    v_max_u32 v16, v10, v14
    v_min_u32 v14, v10, v14
    v_max_u32 v17, v8, v12
    v_min_u32 v12, v8, v12
    v_mov_b32_dpp v9, v15 quad_perm:[1,0,3,2] row_mask:0xf bank_mask:0xf
    v_mov_b32_dpp v13, v19 quad_perm:[1,0,3,2] row_mask:0xf bank_mask:0xf
    v_mov_b32_dpp v22, v25 quad_perm:[1,0,3,2] row_mask:0xf bank_mask:0xf
    v_mov_b32_dpp v23, v21 quad_perm:[1,0,3,2] row_mask:0xf bank_mask:0xf
    v_med3_u32 v9, v21, v9, v6
    v_med3_u32 v13, v25, v13, v6
    v_med3_u32 v22, v19, v22, v6
    v_med3_u32 v23, v15, v23, v6
    v_max_u32 v20, v9, v22
    v_min_u32 v22, v9, v22
    v_max_u32 v24, v13, v23
    v_min_u32 v23, v13, v23
    v_max_u32 v18, v20, v24
    v_min_u32 v24, v20, v24
    v_max_u32 v11, v22, v23
    v_min_u32 v23, v22, v23
    s_nop 1
    v_max_u32_dpp v16, v23, v16 quad_perm:[1,0,3,2] row_mask:0xf bank_mask:0xf
    v_max_u32_dpp v14, v11, v14 quad_perm:[1,0,3,2] row_mask:0xf bank_mask:0xf
    v_max_u32_dpp v17, v24, v17 quad_perm:[1,0,3,2] row_mask:0xf bank_mask:0xf
    v_max_u32_dpp v12, v18, v12 quad_perm:[1,0,3,2] row_mask:0xf bank_mask:0xf
    v_mov_b32_dpp v26, v16 quad_perm:[1,0,3,2] row_mask:0xf bank_mask:0xf
    v_mov_b32_dpp v27, v14 quad_perm:[1,0,3,2] row_mask:0xf bank_mask:0xf
    v_mov_b32_dpp v10, v17 quad_perm:[1,0,3,2] row_mask:0xf bank_mask:0xf
    v_mov_b32_dpp v8, v12 quad_perm:[1,0,3,2] row_mask:0xf bank_mask:0xf
    v_med3_u32 v26, v16, v26, v6
    v_med3_u32 v27, v14, v27, v6
    v_med3_u32 v10, v17, v10, v6
    v_med3_u32 v8, v12, v8, v6
    v_max_u32 v21, v26, v10
    v_min_u32 v10, v26, v10
    v_max_u32 v25, v27, v8
    v_min_u32 v8, v27, v8
    v_max_u32 v19, v21, v25
    v_min_u32 v25, v21, v25
    v_max_u32 v15, v10, v8
    v_min_u32 v8, v10, v8
    s_lshl_b32 s19, s17, 7
    v_lshlrev_b32 v32, 4, v2
    v_lshl_add_u32 v32, v3, 5, v32
    v_add_u32 v32, s19, v32
    v_max_u32_dpp v9, v8, v19 quad_perm:[3,2,1,0] row_mask:0xf bank_mask:0xf
    v_max_u32_dpp v13, v15, v25 quad_perm:[3,2,1,0] row_mask:0xf bank_mask:0xf
    v_max_u32_dpp v20, v25, v15 quad_perm:[3,2,1,0] row_mask:0xf bank_mask:0xf
    v_max_u32_dpp v22, v19, v8 quad_perm:[3,2,1,0] row_mask:0xf bank_mask:0xf
    v_mov_b32_dpp v18, v9 quad_perm:[1,0,3,2] row_mask:0xf bank_mask:0xf
    v_mov_b32_dpp v24, v13 quad_perm:[1,0,3,2] row_mask:0xf bank_mask:0xf
    v_mov_b32_dpp v11, v20 quad_perm:[1,0,3,2] row_mask:0xf bank_mask:0xf
    v_mov_b32_dpp v23, v22 quad_perm:[1,0,3,2] row_mask:0xf bank_mask:0xf
    v_med3_u32 v18, v9, v18, v6
    v_med3_u32 v24, v13, v24, v6
    v_med3_u32 v11, v20, v11, v6
    v_med3_u32 v23, v22, v23, v6
    v_max_u32 v16, v18, v11
    v_min_u32 v11, v18, v11
    v_max_u32 v14, v24, v23
    v_min_u32 v23, v24, v23
    v_max_u32 v17, v16, v14
    v_min_u32 v14, v16, v14
    v_max_u32 v12, v11, v23
    v_min_u32 v23, v11, v23
    s_nop 1
    v_max_u32_dpp v26, v23, v17 row_half_mirror row_mask:0xf bank_mask:0xf
    v_max_u32_dpp v27, v12, v14 row_half_mirror row_mask:0xf bank_mask:0xf
    v_max_u32_dpp v21, v14, v12 row_half_mirror row_mask:0xf bank_mask:0xf
    v_max_u32_dpp v10, v17, v23 row_half_mirror row_mask:0xf bank_mask:0xf
    v_mov_b32_dpp v19, v26 quad_perm:[1,0,3,2] row_mask:0xf bank_mask:0xf
    v_mov_b32_dpp v25, v27 quad_perm:[1,0,3,2] row_mask:0xf bank_mask:0xf
    v_mov_b32_dpp v15, v21 quad_perm:[1,0,3,2] row_mask:0xf bank_mask:0xf
    v_mov_b32_dpp v8, v10 quad_perm:[1,0,3,2] row_mask:0xf bank_mask:0xf
    v_med3_u32 v19, v26, v19, v6
    v_med3_u32 v25, v27, v25, v6
    v_med3_u32 v15, v21, v15, v6
    v_med3_u32 v8, v10, v8, v6
    v_max_u32 v9, v19, v15
    v_min_u32 v15, v19, v15
    v_max_u32 v13, v25, v8
    v_min_u32 v8, v25, v8
    v_max_u32 v20, v9, v13
    v_min_u32 v13, v9, v13
    v_max_u32 v22, v15, v8
    v_min_u32 v8, v15, v8
    s_nop 1
    v_max_u32_dpp v18, v8, v20 row_mirror row_mask:0xf bank_mask:0xf
    v_max_u32_dpp v24, v22, v13 row_mirror row_mask:0xf bank_mask:0xf
    v_max_u32_dpp v16, v13, v22 row_mirror row_mask:0xf bank_mask:0xf
    v_max_u32_dpp v11, v20, v8 row_mirror row_mask:0xf bank_mask:0xf
    v_mov_b32_dpp v17, v18 quad_perm:[1,0,3,2] row_mask:0xf bank_mask:0xf
    v_mov_b32_dpp v14, v24 quad_perm:[1,0,3,2] row_mask:0xf bank_mask:0xf
    v_mov_b32_dpp v12, v16 quad_perm:[1,0,3,2] row_mask:0xf bank_mask:0xf
    v_mov_b32_dpp v23, v11 quad_perm:[1,0,3,2] row_mask:0xf bank_mask:0xf
    v_med3_u32 v17, v18, v17, v6
    v_med3_u32 v14, v24, v14, v6
    v_med3_u32 v12, v16, v12, v6
    v_med3_u32 v23, v11, v23, v6
    v_max_u32 v26, v17, v12
    v_min_u32 v12, v17, v12
    v_max_u32 v27, v14, v23
    v_min_u32 v23, v14, v23
    v_max_u32 v21, v26, v27
    v_min_u32 v27, v26, v27
    v_max_u32 v10, v12, v23
    v_min_u32 v23, v12, v23
    v_mov_b32 v28, v21
    v_mov_b32 v29, v27
    v_mov_b32 v30, v10
    v_mov_b32 v31, v23
    s_mov_b32 exec_lo, 0x00030003
    s_mov_b32 exec_hi, 0x00030003
    ds_write_b128 v32, v[28:31] offset:0
    s_mov_b64 exec, -1
    s_branch K4_B_LOW
K4_L2:
    s_add_u32 s12, s34, 0x900000
    s_addc_u32 s13, s35, 0
    s_mov_b32 s14, 0x240000
    s_mov_b32 s15, 0x20000
    s_mov_b32 s24, 0xcccccccc
    s_mov_b32 s25, 0xcccccccc
    s_mov_b32 s26, 0xf0f0f0f0
    s_mov_b32 s27, 0xf0f0f0f0
    s_movk_i32 s40, 1152
    v_lshrrev_b32 v34, 3, v1
    v_lshlrev_b32 v34, 4, v34
    v_lshlrev_b32 v4, 4, v2
    v_mov_b32 v35, 1
    v_mov_b32 v36, 0
K4_L2POLL:
    ds_read_b128 v[8:11], v4 offset:0
    ds_read_b128 v[12:15], v4 offset:256
    s_waitcnt lgkmcnt(0)
    v_min3_u32 v16, v8, v9, v10
    v_min3_u32 v17, v11, v12, v13
    v_min3_u32 v16, v16, v14, v15
    v_min_u32 v16, v16, v17
    v_cmp_eq_u32 vcc, 0, v16
    s_cbranch_vccnz K4_L2POLL
    v_max_u32_dpp v8, v15, v8 quad_perm:[1,0,3,2] row_mask:0xf bank_mask:0xf
    v_max_u32_dpp v9, v14, v9 quad_perm:[1,0,3,2] row_mask:0xf bank_mask:0xf
    v_max_u32_dpp v10, v13, v10 quad_perm:[1,0,3,2] row_mask:0xf bank_mask:0xf
    v_max_u32_dpp v11, v12, v11 quad_perm:[1,0,3,2] row_mask:0xf bank_mask:0xf
    v_mov_b32_dpp v16, v8 quad_perm:[1,0,3,2] row_mask:0xf bank_mask:0xf
    v_mov_b32_dpp v17, v9 quad_perm:[1,0,3,2] row_mask:0xf bank_mask:0xf
    v_mov_b32_dpp v18, v10 quad_perm:[1,0,3,2] row_mask:0xf bank_mask:0xf
    v_mov_b32_dpp v19, v11 quad_perm:[1,0,3,2] row_mask:0xf bank_mask:0xf
    v_med3_u32 v16, v8, v16, v6
    v_med3_u32 v17, v9, v17, v6
    v_med3_u32 v18, v10, v18, v6
    v_med3_u32 v19, v11, v19, v6
    v_max_u32 v20, v16, v18
    v_min_u32 v18, v16, v18
    v_max_u32 v21, v17, v19
    v_min_u32 v19, v17, v19
    v_max_u32 v22, v20, v21
    v_min_u32 v21, v20, v21
    v_max_u32 v23, v18, v19
    v_min_u32 v19, v18, v19
    s_nop 1
    v_max_u32_dpp v24, v19, v22 quad_perm:[3,2,1,0] row_mask:0xf bank_mask:0xf
    v_max_u32_dpp v25, v23, v21 quad_perm:[3,2,1,0] row_mask:0xf bank_mask:0xf
    v_max_u32_dpp v26, v21, v23 quad_perm:[3,2,1,0] row_mask:0xf bank_mask:0xf
    v_max_u32_dpp v27, v22, v19 quad_perm:[3,2,1,0] row_mask:0xf bank_mask:0xf
    v_mov_b32_dpp v12, v24 quad_perm:[1,0,3,2] row_mask:0xf bank_mask:0xf
    v_mov_b32_dpp v13, v25 quad_perm:[1,0,3,2] row_mask:0xf bank_mask:0xf
    v_mov_b32_dpp v14, v26 quad_perm:[1,0,3,2] row_mask:0xf bank_mask:0xf
    v_mov_b32_dpp v15, v27 quad_perm:[1,0,3,2] row_mask:0xf bank_mask:0xf
    v_med3_u32 v12, v24, v12, v6
    v_med3_u32 v13, v25, v13, v6
    v_med3_u32 v14, v26, v14, v6
    v_med3_u32 v15, v27, v15, v6
    v_max_u32 v8, v12, v14
    v_min_u32 v14, v12, v14
    v_max_u32 v9, v13, v15
    v_min_u32 v15, v13, v15
    v_max_u32 v10, v8, v9
    v_min_u32 v9, v8, v9
    v_max_u32 v11, v14, v15
    v_min_u32 v15, v14, v15
    s_nop 1
    v_max_u32_dpp v16, v15, v10 row_half_mirror row_mask:0xf bank_mask:0xf
    v_max_u32_dpp v17, v11, v9 row_half_mirror row_mask:0xf bank_mask:0xf
    v_max_u32_dpp v20, v9, v11 row_half_mirror row_mask:0xf bank_mask:0xf
    v_max_u32_dpp v18, v10, v15 row_half_mirror row_mask:0xf bank_mask:0xf
    v_mov_b32_dpp v22, v16 quad_perm:[1,0,3,2] row_mask:0xf bank_mask:0xf
    v_mov_b32_dpp v21, v17 quad_perm:[1,0,3,2] row_mask:0xf bank_mask:0xf
    v_mov_b32_dpp v23, v20 quad_perm:[1,0,3,2] row_mask:0xf bank_mask:0xf
    v_mov_b32_dpp v19, v18 quad_perm:[1,0,3,2] row_mask:0xf bank_mask:0xf
    v_med3_u32 v22, v16, v22, v6
    v_med3_u32 v21, v17, v21, v6
    v_med3_u32 v23, v20, v23, v6
    v_med3_u32 v19, v18, v19, v6
    v_max_u32 v24, v22, v23
    v_min_u32 v23, v22, v23
    v_max_u32 v25, v21, v19
    v_min_u32 v19, v21, v19
    v_max_u32 v26, v24, v25
    v_min_u32 v25, v24, v25
    v_max_u32 v27, v23, v19
    v_min_u32 v19, v23, v19
    s_nop 1
    v_max_u32_dpp v12, v19, v26 row_mirror row_mask:0xf bank_mask:0xf
    v_max_u32_dpp v13, v27, v25 row_mirror row_mask:0xf bank_mask:0xf
    v_max_u32_dpp v8, v25, v27 row_mirror row_mask:0xf bank_mask:0xf
    v_max_u32_dpp v14, v26, v19 row_mirror row_mask:0xf bank_mask:0xf
    v_cndmask_b32 v30, v12, v13, s[24:25]
    v_cndmask_b32 v31, v8, v14, s[24:25]
    v_cndmask_b32 v30, v30, v31, s[26:27]
    s_nop 1
    v_mov_b32_dpp v30, v30 row_shr:8 row_mask:0xf bank_mask:0xc
    v_and_b32 v31, 0x7ff, v30
    v_sub_u32 v31, 2047, v31
    v_mad_u32_u24 v31, v31, s40, v34
    s_mov_b32 m0, 14336
    s_nop 0
    buffer_load_dwordx4 v31, s[12:15], 0 offen offset:0 lds
    s_mov_b32 m0, 15232
    s_nop 0
    buffer_load_dwordx4 v31, s[12:15], 0 offen offset:128 lds
    s_mov_b32 m0, 16128
    s_nop 0
    buffer_load_dwordx4 v31, s[12:15], 0 offen offset:256 lds
    s_mov_b32 m0, 17024
    s_nop 0
    buffer_load_dwordx4 v31, s[12:15], 0 offen offset:384 lds
    s_mov_b32 m0, 17920
    s_nop 0
    buffer_load_dwordx4 v31, s[12:15], 0 offen offset:512 lds
    s_mov_b32 m0, 18816
    s_nop 0
    buffer_load_dwordx4 v31, s[12:15], 0 offen offset:640 lds
    s_mov_b32 m0, 19712
    s_nop 0
    buffer_load_dwordx4 v31, s[12:15], 0 offen offset:768 lds
    s_mov_b32 m0, 20608
    s_nop 0
    buffer_load_dwordx4 v31, s[12:15], 0 offen offset:896 lds
    s_mov_b32 m0, 21504
    s_nop 0
    buffer_load_dwordx4 v31, s[12:15], 0 offen offset:1024 lds
    ds_write_b32 v7, v30 offset:1024
    ds_write_b32 v36, v35 offset:1080
    s_waitcnt vmcnt(0)
    ds_write_b32 v36, v35 offset:1084
K4_B_LOW:
    s_setprio 0
    s_branch K4_B_NOSIDE
K4_B_POLL:
    s_setprio 0
    s_sleep 1
    ds_read_b32 v12, v7 offset:1024
    s_waitcnt lgkmcnt(0)
    v_cmp_eq_u32 vcc, 0, v12
    s_cbranch_vccnz K4_B_POLL
    s_add_u32 s12, s34, 0x900000
    s_addc_u32 s13, s35, 0
    s_mov_b32 s14, 0x240000
    s_mov_b32 s15, 0x20000
    s_add_u32 s24, s34, 0x600000
    s_addc_u32 s25, s35, 0
    s_mov_b32 s26, 0x240000
    s_mov_b32 s27, 0x20000
    s_mov_b32 s36, s30
    s_mov_b32 s37, s31
    s_mov_b32 s38, 0x240000
    s_mov_b32 s39, 0x20000
    v_readlane_b32 s19, v12, s16
    s_and_b32 s19, s19, 0x7ff
    s_sub_u32 s19, 2047, s19
    v_and_b32 v13, 31, v1
    s_lshl_b32 s40, s3, 5
    v_add_u32 v13, s40, v13
    v_lshlrev_b32 v14, 1, v13
    v_lshlrev_b32 v15, 4, v13
    s_mul_i32 s40, s19, 1152
    s_lshr_b32 s41, s19, 3
    s_mul_i32 s41, s41, 9216
    s_and_b32 s19, s19, 7
    s_lshl_b32 s19, s19, 1
    s_add_u32 s41, s41, s19
    buffer_load_ushort v16, v14, s[12:15], s40 offen
    buffer_load_ushort v17, v14, s[36:39], s40 offen
    buffer_load_ushort v18, v15, s[24:27], s41 offen
    s_add_u32 s12, s34, 0xc20000
    s_addc_u32 s13, s35, 0
    s_mov_b32 s14, 0x4820
    s_mov_b32 s15, 0x20000
    v_lshlrev_b32 v14, 2, v13
    s_mul_i32 s40, s16, 2304
    s_add_u32 s40, s40, 32
    s_waitcnt vmcnt(0)
    v_lshlrev_b32 v17, 16, v17
    v_lshlrev_b32 v18, 16, v18
    v_add_f32 v17, v17, v18
    v_cvt_pk_bf16_f32 v17, v17, v17
    v_and_b32 v17, 0xffff0000, v17
    v_or_b32 v16, v16, v17
    buffer_store_dword v16, v14, s[12:15], s40 offen
    s_cmp_lg_u32 s2, 0
    s_cbranch_scc1 K4_B_NOSIDE
    buffer_store_dword v12, v7, s[12:15], 0 offen
K4_B_NOSIDE:
    v_min_u32 v13, 24, v7
K4_B_POLL2:
    s_sleep 1
    ds_read_b32 v14, v13 offset:1056
    s_waitcnt lgkmcnt(0)
    v_cmp_eq_u32 vcc, 0, v14
    s_cbranch_vccnz K4_B_POLL2
    buffer_load_dwordx2 v[32:33], v5, s[8:11], s18 offen offset:0
    buffer_load_dwordx2 v[34:35], v5, s[8:11], s18 offen offset:1152
    buffer_load_dwordx2 v[36:37], v5, s[8:11], s18 offen offset:2304
    buffer_load_dwordx2 v[38:39], v5, s[8:11], s18 offen offset:3456
    s_add_u32 s18, s18, 4608
    buffer_load_dwordx2 v[40:41], v5, s[8:11], s18 offen offset:0
    buffer_load_dwordx2 v[42:43], v5, s[8:11], s18 offen offset:1152
    buffer_load_dwordx2 v[44:45], v5, s[8:11], s18 offen offset:2304
    buffer_load_dwordx2 v[46:47], v5, s[8:11], s18 offen offset:3456
    s_barrier
    s_waitcnt vmcnt(0)
    v_perm_b32 v48, v34, v32, s28
    v_perm_b32 v49, v38, v36, s28
    v_perm_b32 v50, v42, v40, s28
    v_perm_b32 v51, v46, v44, s28
    v_perm_b32 v52, v34, v32, s29
    v_perm_b32 v53, v38, v36, s29
    v_perm_b32 v54, v42, v40, s29
    v_perm_b32 v55, v46, v44, s29
    v_perm_b32 v56, v35, v33, s28
    v_perm_b32 v57, v39, v37, s28
    v_perm_b32 v58, v43, v41, s28
    v_perm_b32 v59, v47, v45, s28
    v_perm_b32 v60, v35, v33, s29
    v_perm_b32 v61, v39, v37, s29
    v_perm_b32 v62, v43, v41, s29
    v_perm_b32 v63, v47, v45, s29
    v_and_b32 v16, 7, v2
    v_lshlrev_b32 v16, 6, v16
    v_lshl_add_u32 v16, v3, 4, v16
    s_mul_i32 s18, s2, 18432
    s_lshl_b32 s19, s17, 11
    s_add_u32 s18, s18, s19
    v_lshlrev_b32 v17, 4, v1
    s_barrier
    ds_read_b128 v[20:23], v16 offset:1088
    s_waitcnt lgkmcnt(0)
    v_mfma_f32_16x16x32_bf16 v[32:35], v[20:23], v[48:51], 0
    v_mfma_f32_16x16x32_bf16 v[36:39], v[20:23], v[52:55], 0
    v_mfma_f32_16x16x32_bf16 v[40:43], v[20:23], v[56:59], 0
    v_mfma_f32_16x16x32_bf16 v[44:47], v[20:23], v[60:63], 0
    s_nop 5
    v_permlane32_swap_b32 v32, v36
    v_permlane32_swap_b32 v33, v37
    v_permlane32_swap_b32 v34, v38
    v_permlane32_swap_b32 v35, v39
    buffer_store_dwordx4 v[32:35], v17, s[20:23], s18 offen offset:0
    v_permlane32_swap_b32 v40, v44
    v_permlane32_swap_b32 v41, v45
    v_permlane32_swap_b32 v42, v46
    v_permlane32_swap_b32 v43, v47
    buffer_store_dwordx4 v[40:43], v17, s[20:23], s18 offen offset:1024
    s_endpgm
K4_G:
    s_sub_u32 s17, s17, 9
    s_mul_i32 s18, s17, 96
    v_lshl_add_u32 v5, v3, 3, s18
    v_mul_u32_u24 v5, 9216, v5
    v_and_b32 v6, 7, v2
    v_lshl_add_u32 v5, v6, 3, v5
    s_lshl_b32 s18, s2, 6
    v_add_u32 v5, s18, v5
    v_cmp_gt_u32 vcc, 8, v2
    s_mov_b32 s40, 9216
    s_mov_b32 s41, 0
    s_mov_b32 s38, 230400
    s_mov_b32 s39, 0
    s_waitcnt lgkmcnt(0)
    v_mov_b32 v12, s4
    v_mov_b32 v13, s5
    v_mov_b32 v14, s6
    v_mov_b32 v15, s7
    v_cndmask_b32 v12, v14, v12, vcc
    v_cndmask_b32 v13, v15, v13, vcc
    v_add_co_u32 v12, vcc, v12, v5
    s_nop 1
    v_addc_co_u32 v13, vcc, 0, v13, vcc
    global_load_dwordx2 v[32:33], v[12:13], off
    v_lshl_add_u64 v[12:13], v[12:13], 0, s[40:41]
    global_load_dwordx2 v[34:35], v[12:13], off
    v_lshl_add_u64 v[12:13], v[12:13], 0, s[40:41]
    global_load_dwordx2 v[36:37], v[12:13], off
    v_lshl_add_u64 v[12:13], v[12:13], 0, s[40:41]
    global_load_dwordx2 v[38:39], v[12:13], off
    v_lshl_add_u64 v[12:13], v[12:13], 0, s[40:41]
    s_barrier
    global_load_dwordx2 v[40:41], v[12:13], off
    v_lshl_add_u64 v[12:13], v[12:13], 0, s[40:41]
    global_load_dwordx2 v[42:43], v[12:13], off
    v_lshl_add_u64 v[12:13], v[12:13], 0, s[40:41]
    global_load_dwordx2 v[44:45], v[12:13], off
    v_lshl_add_u64 v[12:13], v[12:13], 0, s[40:41]
    global_load_dwordx2 v[46:47], v[12:13], off
    v_lshl_add_u64 v[12:13], v[12:13], 0, s[38:39]
    global_load_dwordx2 v[48:49], v[12:13], off
    v_lshl_add_u64 v[12:13], v[12:13], 0, s[40:41]
    global_load_dwordx2 v[50:51], v[12:13], off
    v_lshl_add_u64 v[12:13], v[12:13], 0, s[40:41]
    global_load_dwordx2 v[52:53], v[12:13], off
    v_lshl_add_u64 v[12:13], v[12:13], 0, s[40:41]
    global_load_dwordx2 v[54:55], v[12:13], off
    v_lshl_add_u64 v[12:13], v[12:13], 0, s[40:41]
    global_load_dwordx2 v[56:57], v[12:13], off
    v_lshl_add_u64 v[12:13], v[12:13], 0, s[40:41]
    global_load_dwordx2 v[58:59], v[12:13], off
    v_lshl_add_u64 v[12:13], v[12:13], 0, s[40:41]
    global_load_dwordx2 v[60:61], v[12:13], off
    v_lshl_add_u64 v[12:13], v[12:13], 0, s[40:41]
    global_load_dwordx2 v[62:63], v[12:13], off
    v_lshl_add_u64 v[12:13], v[12:13], 0, s[38:39]
    global_load_dwordx2 v[64:65], v[12:13], off
    v_lshl_add_u64 v[12:13], v[12:13], 0, s[40:41]
    global_load_dwordx2 v[66:67], v[12:13], off
    v_lshl_add_u64 v[12:13], v[12:13], 0, s[40:41]
    global_load_dwordx2 v[68:69], v[12:13], off
    v_lshl_add_u64 v[12:13], v[12:13], 0, s[40:41]
    global_load_dwordx2 v[70:71], v[12:13], off
    v_lshl_add_u64 v[12:13], v[12:13], 0, s[40:41]
    global_load_dwordx2 v[72:73], v[12:13], off
    v_lshl_add_u64 v[12:13], v[12:13], 0, s[40:41]
    global_load_dwordx2 v[74:75], v[12:13], off
    v_lshl_add_u64 v[12:13], v[12:13], 0, s[40:41]
    global_load_dwordx2 v[76:77], v[12:13], off
    v_lshl_add_u64 v[12:13], v[12:13], 0, s[40:41]
    global_load_dwordx2 v[78:79], v[12:13], off
    s_lshl_b32 s18, s17, 2
    v_mov_b32 v16, s18
    v_mov_b32 v17, 1
    ds_write_b32 v16, v17 offset:1056
    s_mul_i32 s18, s17, 1536
    v_lshl_add_u32 v18, v6, 4, s18
    v_lshl_add_u32 v18, v3, 7, v18
    v_mov_b32 v7, 0
    s_waitcnt vmcnt(16)
    v_perm_b32 v80, v34, v32, s28
    v_perm_b32 v81, v38, v36, s28
    v_perm_b32 v82, v42, v40, s28
    v_perm_b32 v83, v46, v44, s28
    v_perm_b32 v84, v34, v32, s29
    v_perm_b32 v85, v38, v36, s29
    v_perm_b32 v86, v42, v40, s29
    v_perm_b32 v87, v46, v44, s29
    v_perm_b32 v88, v35, v33, s28
    v_perm_b32 v89, v39, v37, s28
    v_perm_b32 v90, v43, v41, s28
    v_perm_b32 v91, v47, v45, s28
    v_perm_b32 v92, v35, v33, s29
    v_perm_b32 v93, v39, v37, s29
    v_perm_b32 v94, v43, v41, s29
    v_perm_b32 v95, v47, v45, s29
    s_waitcnt vmcnt(8)
    v_perm_b32 v32, v50, v48, s28
    v_perm_b32 v33, v54, v52, s28
    v_perm_b32 v34, v58, v56, s28
    v_perm_b32 v35, v62, v60, s28
    v_perm_b32 v36, v50, v48, s29
    v_perm_b32 v37, v54, v52, s29
    v_perm_b32 v38, v58, v56, s29
    v_perm_b32 v39, v62, v60, s29
    v_perm_b32 v40, v51, v49, s28
    v_perm_b32 v41, v55, v53, s28
    v_perm_b32 v42, v59, v57, s28
    v_perm_b32 v43, v63, v61, s28
    v_perm_b32 v44, v51, v49, s29
    v_perm_b32 v45, v55, v53, s29
    v_perm_b32 v46, v59, v57, s29
    v_perm_b32 v47, v63, v61, s29
    s_lshl_b32 s18, s17, 6
    v_add_u32 v4, s18, v1
    v_lshrrev_b32 v8, 5, v4
    v_and_b32 v9, 31, v4
    v_and_b32 v10, 3, v9
    v_lshlrev_b32 v10, 9, v10
    v_lshrrev_b32 v11, 2, v9
    v_lshl_add_u32 v10, v11, 4, v10
    v_lshrrev_b32 v11, 2, v8
    v_lshl_add_u32 v10, v11, 8, v10
    v_and_b32 v11, 3, v8
    v_lshl_add_u32 v10, v11, 2, v10
    v_lshlrev_b32 v11, 1, v4
    s_setprio 2
K4_G_POLL:
    ds_read_b32 v17, v7 offset:1084
    s_waitcnt lgkmcnt(0)
    v_cmp_eq_u32 vcc, 0, v17
    s_cbranch_vccnz K4_G_POLL
    ds_read_b128 v[20:23], v18 offset:14336
    ds_read_b128 v[24:27], v18 offset:14848
    ds_read_b128 v[28:31], v18 offset:15360
    s_lshl_b32 s18, s17, 11
    v_lshl_add_u32 v16, v1, 4, s18
    s_waitcnt lgkmcnt(2)
    v_mfma_f32_16x16x32_bf16 v[96:99], v[20:23], v[80:83], 0
    v_mfma_f32_16x16x32_bf16 v[100:103], v[20:23], v[84:87], 0
    v_mfma_f32_16x16x32_bf16 v[104:107], v[20:23], v[88:91], 0
    v_mfma_f32_16x16x32_bf16 v[108:111], v[20:23], v[92:95], 0
    s_waitcnt lgkmcnt(1)
    v_mfma_f32_16x16x32_bf16 v[96:99], v[24:27], v[32:35], v[96:99]
    v_mfma_f32_16x16x32_bf16 v[100:103], v[24:27], v[36:39], v[100:103]
    v_mfma_f32_16x16x32_bf16 v[104:107], v[24:27], v[40:43], v[104:107]
    v_mfma_f32_16x16x32_bf16 v[108:111], v[24:27], v[44:47], v[108:111]
    s_waitcnt lgkmcnt(0)
    s_waitcnt vmcnt(6)
    v_perm_b32 v48, v66, v64, s28
    v_perm_b32 v52, v66, v64, s29
    v_perm_b32 v56, v67, v65, s28
    v_perm_b32 v60, v67, v65, s29
    s_waitcnt vmcnt(4)
    v_perm_b32 v49, v70, v68, s28
    v_perm_b32 v53, v70, v68, s29
    v_perm_b32 v57, v71, v69, s28
    v_perm_b32 v61, v71, v69, s29
    s_waitcnt vmcnt(2)
    v_perm_b32 v50, v74, v72, s28
    v_perm_b32 v54, v74, v72, s29
    v_perm_b32 v58, v75, v73, s28
    v_perm_b32 v62, v75, v73, s29
    s_waitcnt vmcnt(0)
    v_perm_b32 v51, v78, v76, s28
    v_perm_b32 v55, v78, v76, s29
    v_perm_b32 v59, v79, v77, s28
    v_perm_b32 v63, v79, v77, s29
    v_mfma_f32_16x16x32_bf16 v[96:99], v[28:31], v[48:51], v[96:99]
    v_mfma_f32_16x16x32_bf16 v[100:103], v[28:31], v[52:55], v[100:103]
    v_mfma_f32_16x16x32_bf16 v[104:107], v[28:31], v[56:59], v[104:107]
    v_mfma_f32_16x16x32_bf16 v[108:111], v[28:31], v[60:63], v[108:111]
    s_mov_b32 exec_lo, -1
    s_mov_b32 exec_hi, 0
    s_nop 2
    ds_write_b128 v16, v[96:99] offset:2048
    ds_write_b128 v16, v[100:103] offset:2560
    ds_write_b128 v16, v[104:107] offset:3072
    ds_write_b128 v16, v[108:111] offset:3584
    s_mov_b64 exec, -1
    s_waitcnt lgkmcnt(0)
    s_barrier
    s_cmp_ge_u32 s17, 4
    s_cbranch_scc1 K4_NOACT
    ds_read_b32 v32, v10 offset:2048
    ds_read_b32 v33, v10 offset:2176
    ds_read_b32 v34, v10 offset:4096
    ds_read_b32 v35, v10 offset:4224
    ds_read_b32 v36, v10 offset:6144
    ds_read_b32 v37, v10 offset:6272
    ds_read_b32 v38, v10 offset:8192
    ds_read_b32 v39, v10 offset:8320
    ds_read_b32 v40, v10 offset:10240
    ds_read_b32 v41, v10 offset:10368
    ds_read_b32 v42, v10 offset:12288
    ds_read_b32 v43, v10 offset:12416
    s_waitcnt lgkmcnt(8)
    v_pk_add_f32 v[32:33], v[32:33], v[34:35]
    s_waitcnt lgkmcnt(4)
    v_pk_add_f32 v[36:37], v[36:37], v[38:39]
    s_waitcnt lgkmcnt(0)
    v_pk_add_f32 v[40:41], v[40:41], v[42:43]
    v_pk_add_f32 v[32:33], v[32:33], v[36:37]
    v_pk_add_f32 v[32:33], v[32:33], v[40:41]
    v_cvt_pk_bf16_f32 v34, v32, v33
    v_lshlrev_b32 v32, 16, v34
    v_and_b32 v33, 0xffff0000, v34
    v_mul_f32 v34, 0xbfb8aa3b, v32
    v_exp_f32 v34, v34
    s_nop 0
    v_add_f32 v34, 1.0, v34
    v_rcp_f32 v34, v34
    s_nop 0
    v_mul_f32 v34, v32, v34
    v_cvt_pk_bf16_f32 v34, v34, v34
    v_lshlrev_b32 v34, 16, v34
    v_mul_f32 v34, v34, v33
    v_cvt_pk_bf16_f32 v34, v34, v34
    ds_write_b16 v11, v34 offset:1088
    s_waitcnt lgkmcnt(0)
K4_NOACT:
    s_barrier
K4_END:
    s_endpgm
.globl k5_kernel
.p2align 8
.type k5_kernel,@function
k5_kernel:
    s_cmp_ge_u32 s2, 72
    s_cbranch_scc1 K5_END
    s_load_dwordx2 s[6:7], s[0:1], 128
    s_load_dwordx2 s[34:35], s[0:1], 112
    v_and_b32 v1, 15, v0
    v_lshrrev_b32 v2, 4, v0
    v_mul_u32_u24 v3, 165888, v2
    v_lshl_add_u32 v3, v1, 4, v3
    v_lshrrev_b32 v4, 2, v0
    s_lshl_b32 s3, s2, 4
    v_add_u32 v4, s3, v4
    v_and_b32 v5, 3, v0
    v_bfe_u32 v6, v4, 4, 1
    v_lshl_add_u32 v5, v6, 2, v5
    v_lshrrev_b32 v6, 7, v4
    v_lshlrev_b32 v6, 6, v6
    v_and_b32 v7, 15, v4
    v_lshl_add_u32 v6, v7, 2, v6
    v_bfe_u32 v7, v4, 5, 2
    v_add_u32 v6, v6, v7
    v_mul_u32_u24 v46, 2304, v5
    v_lshl_add_u32 v46, v6, 2, v46
    v_lshlrev_b32 v5, 2, v5
    s_lshl_b32 s3, s2, 8
    s_waitcnt lgkmcnt(0)
    s_add_u32 s8, s6, 0xd00000
    s_addc_u32 s9, s7, 0
    s_mov_b32 s10, 0x288000
    s_mov_b32 s11, 0x20000
    buffer_load_dwordx4 v[8:11], v3, s[8:11], s3 offen
    s_add_u32 s3, s3, 18432
    buffer_load_dwordx4 v[12:15], v3, s[8:11], s3 offen
    s_add_u32 s3, s3, 18432
    buffer_load_dwordx4 v[16:19], v3, s[8:11], s3 offen
    s_add_u32 s3, s3, 18432
    buffer_load_dwordx4 v[20:23], v3, s[8:11], s3 offen
    s_add_u32 s3, s3, 18432
    buffer_load_dwordx4 v[24:27], v3, s[8:11], s3 offen
    s_add_u32 s3, s3, 18432
    buffer_load_dwordx4 v[28:31], v3, s[8:11], s3 offen
    s_add_u32 s3, s3, 18432
    buffer_load_dwordx4 v[32:35], v3, s[8:11], s3 offen
    s_add_u32 s3, s3, 18432
    buffer_load_dwordx4 v[36:39], v3, s[8:11], s3 offen
    s_add_u32 s3, s3, 18432
    buffer_load_dwordx4 v[40:43], v3, s[8:11], s3 offen
    s_add_u32 s12, s6, 0xc20000
    s_addc_u32 s13, s7, 0
    s_mov_b32 s14, 0x4820
    s_mov_b32 s15, 0x20000
    s_mov_b32 s28, s34
    s_mov_b32 s29, s35
    s_mov_b32 s30, 0x240000
    s_mov_b32 s31, 0x20000
    buffer_load_dword v44, v5, s[12:15], 0 offen
    buffer_load_dword v48, v46, s[12:15], 0 offen offset:32
    v_lshlrev_b32 v7, 4, v0
    s_waitcnt vmcnt(9)
    v_pk_add_f32 v[8:9], v[8:9], v[12:13]
    v_pk_add_f32 v[10:11], v[10:11], v[14:15]
    s_waitcnt vmcnt(8)
    v_pk_add_f32 v[8:9], v[8:9], v[16:17]
    v_pk_add_f32 v[10:11], v[10:11], v[18:19]
    s_waitcnt vmcnt(7)
    v_pk_add_f32 v[8:9], v[8:9], v[20:21]
    v_pk_add_f32 v[10:11], v[10:11], v[22:23]
    s_waitcnt vmcnt(6)
    v_pk_add_f32 v[8:9], v[8:9], v[24:25]
    v_pk_add_f32 v[10:11], v[10:11], v[26:27]
    s_waitcnt vmcnt(5)
    v_pk_add_f32 v[8:9], v[8:9], v[28:29]
    v_pk_add_f32 v[10:11], v[10:11], v[30:31]
    s_waitcnt vmcnt(4)
    v_pk_add_f32 v[8:9], v[8:9], v[32:33]
    v_pk_add_f32 v[10:11], v[10:11], v[34:35]
    s_waitcnt vmcnt(3)
    v_pk_add_f32 v[8:9], v[8:9], v[36:37]
    v_pk_add_f32 v[10:11], v[10:11], v[38:39]
    s_waitcnt vmcnt(2)
    v_pk_add_f32 v[8:9], v[8:9], v[40:41]
    v_pk_add_f32 v[10:11], v[10:11], v[42:43]
    ds_write_b128 v7, v[8:11]
    s_waitcnt vmcnt(0)
    v_and_b32 v45, 0x7ff, v44
    v_sub_u32 v45, 2047, v45
    v_mul_u32_u24 v46, 1152, v45
    v_lshl_add_u32 v46, v6, 1, v46
    v_ashrrev_i32 v47, 31, v44
    v_not_b32 v47, v47
    v_or_b32 v47, 0x80000000, v47
    v_xor_b32 v47, v44, v47
    v_and_b32 v47, 0xffff0000, v47
    v_mul_f32 v47, 0xbfb8aa3b, v47
    v_exp_f32 v47, v47
    s_nop 0
    v_add_f32 v47, 1.0, v47
    v_rcp_f32 v47, v47
    s_nop 0
    v_cvt_pk_bf16_f32 v47, v47, v47
    v_lshlrev_b32 v47, 16, v47
    v_lshlrev_b32 v50, 16, v48
    v_and_b32 v51, 0xffff0000, v48
    v_lshlrev_b32 v7, 2, v0
    s_waitcnt lgkmcnt(0)
    s_barrier
    v_readfirstlane_b32 s3, v0
    s_cmp_ge_u32 s3, 64
    s_cbranch_scc1 K5_END1
    ds_read2st64_b32 v[8:9], v7 offset0:0 offset1:1
    ds_read2st64_b32 v[10:11], v7 offset0:2 offset1:3
    ds_read2st64_b32 v[12:13], v7 offset0:4 offset1:5
    ds_read2st64_b32 v[14:15], v7 offset0:6 offset1:7
    ds_read2st64_b32 v[16:17], v7 offset0:8 offset1:9
    ds_read2st64_b32 v[18:19], v7 offset0:10 offset1:11
    ds_read2st64_b32 v[20:21], v7 offset0:12 offset1:13
    ds_read2st64_b32 v[22:23], v7 offset0:14 offset1:15
    s_waitcnt lgkmcnt(6)
    v_pk_add_f32 v[8:9], v[8:9], v[10:11]
    s_waitcnt lgkmcnt(5)
    v_pk_add_f32 v[8:9], v[8:9], v[12:13]
    s_waitcnt lgkmcnt(4)
    v_pk_add_f32 v[8:9], v[8:9], v[14:15]
    s_waitcnt lgkmcnt(3)
    v_pk_add_f32 v[8:9], v[8:9], v[16:17]
    s_waitcnt lgkmcnt(2)
    v_pk_add_f32 v[8:9], v[8:9], v[18:19]
    s_waitcnt lgkmcnt(1)
    v_pk_add_f32 v[8:9], v[8:9], v[20:21]
    s_waitcnt lgkmcnt(0)
    v_pk_add_f32 v[8:9], v[8:9], v[22:23]
    v_add_f32 v8, v8, v9
    v_cvt_pk_bf16_f32 v8, v8, v8
    v_lshlrev_b32 v8, 16, v8
    v_mul_f32 v8, v8, v47
    v_cvt_pk_bf16_f32 v8, v8, v8
    v_lshlrev_b32 v8, 16, v8
    v_add_f32 v8, v8, v50
    v_cvt_pk_bf16_f32 v8, v8, v8
    v_lshlrev_b32 v8, 16, v8
    v_add_f32 v8, v8, v51
    v_cvt_pk_bf16_f32 v8, v8, v8
    buffer_store_short v8, v46, s[28:31], 0 offen
K5_END1:
K5_END:
    s_endpgm
.section .rodata,"a"
.p2align 6
.amdhsa_kernel k1_kernel
  .amdhsa_next_free_vgpr 108
  .amdhsa_next_free_sgpr 40
  .amdhsa_accum_offset 108
  .amdhsa_group_segment_fixed_size 0
  .amdhsa_kernarg_size 136
  .amdhsa_user_sgpr_count 2
  .amdhsa_user_sgpr_kernarg_segment_ptr 1
  .amdhsa_system_sgpr_workgroup_id_x 1
  .amdhsa_float_denorm_mode_32 3
.end_amdhsa_kernel
.p2align 6
.amdhsa_kernel k2_kernel
  .amdhsa_next_free_vgpr 152
  .amdhsa_next_free_sgpr 40
  .amdhsa_accum_offset 152
  .amdhsa_group_segment_fixed_size 0
  .amdhsa_kernarg_size 136
  .amdhsa_user_sgpr_count 2
  .amdhsa_user_sgpr_kernarg_segment_ptr 1
  .amdhsa_system_sgpr_workgroup_id_x 1
  .amdhsa_float_denorm_mode_32 3
.end_amdhsa_kernel
.p2align 6
.amdhsa_kernel k3_kernel
  .amdhsa_next_free_vgpr 80
  .amdhsa_next_free_sgpr 48
  .amdhsa_accum_offset 80
  .amdhsa_group_segment_fixed_size 0
  .amdhsa_kernarg_size 136
  .amdhsa_user_sgpr_count 2
  .amdhsa_user_sgpr_kernarg_segment_ptr 1
  .amdhsa_system_sgpr_workgroup_id_x 1
  .amdhsa_float_denorm_mode_32 3
.end_amdhsa_kernel
.p2align 6
.amdhsa_kernel k4_kernel
  .amdhsa_next_free_vgpr 112
  .amdhsa_next_free_sgpr 48
  .amdhsa_accum_offset 112
  .amdhsa_group_segment_fixed_size 0
  .amdhsa_kernarg_size 136
  .amdhsa_user_sgpr_count 2
  .amdhsa_user_sgpr_kernarg_segment_ptr 1
  .amdhsa_system_sgpr_workgroup_id_x 1
  .amdhsa_float_denorm_mode_32 3
.end_amdhsa_kernel
.p2align 6
.amdhsa_kernel k5_kernel
  .amdhsa_next_free_vgpr 52
  .amdhsa_next_free_sgpr 40
  .amdhsa_accum_offset 52
  .amdhsa_group_segment_fixed_size 0
  .amdhsa_kernarg_size 136
  .amdhsa_user_sgpr_count 2
  .amdhsa_user_sgpr_kernarg_segment_ptr 1
  .amdhsa_system_sgpr_workgroup_id_x 1
  .amdhsa_float_denorm_mode_32 3
.end_amdhsa_kernel
```

```asm
; @launch kernel=k1_kernel grid=(832,1,1) block=(256,1,1) lds=36352
; @launch kernel=k2_kernel grid=(576,1,1) block=(256,1,1) lds=47360
; @launch kernel=k3_kernel grid=(256,1,1) block=(1024,1,1) lds=24832
.amdgcn_target "amdgcn-amd-amdhsa--gfx950"
.text
.globl k1_kernel
.p2align 8
.type k1_kernel,@function
k1_kernel:
    s_cmp_ge_u32 s2, 832
    s_cbranch_scc1 K1_END
    s_cmp_ge_u32 s2, 256
    s_cbranch_scc1 K1_KGEN
    s_load_dwordx2 s[4:5], s[0:1], 0
    s_load_dwordx2 s[6:7], s[0:1], 128
    v_lshrrev_b32 v1, 5, v0
    v_and_b32 v2, 31, v0
    v_mul_u32_u24 v3, 1152, v1
    v_lshl_add_u32 v3, v2, 2, v3
    s_and_b32 s16, s2, 7
    s_lshl_b32 s16, s16, 5
    s_lshr_b32 s3, s2, 3
    s_add_u32 s18, s3, s16
    s_mul_i32 s3, s18, 9216
    s_lshl_b32 s18, s18, 4
    s_waitcnt lgkmcnt(0)
    s_mov_b32 s8, s4
    s_mov_b32 s9, s5
    s_mov_b32 s10, 0x240000
    s_mov_b32 s11, 0x20000
    s_mov_b32 s12, s6
    s_mov_b32 s13, s7
    s_mov_b32 s14, 0x240000
    s_mov_b32 s15, 0x20000
    buffer_load_dword v10, v3, s[8:11], s3 offen offset:0
    buffer_load_dword v11, v3, s[8:11], s3 offen offset:128
    buffer_load_dword v12, v3, s[8:11], s3 offen offset:256
    buffer_load_dword v13, v3, s[8:11], s3 offen offset:384
    buffer_load_dword v14, v3, s[8:11], s3 offen offset:512
    buffer_load_dword v15, v3, s[8:11], s3 offen offset:640
    buffer_load_dword v16, v3, s[8:11], s3 offen offset:768
    buffer_load_dword v17, v3, s[8:11], s3 offen offset:896
    buffer_load_dword v18, v3, s[8:11], s3 offen offset:1024
    v_lshrrev_b32 v4, 6, v0
    v_mul_u32_u24 v4, 2304, v4
    v_lshl_add_u32 v4, v2, 3, v4
    v_and_b32 v5, 1, v1
    v_lshl_add_u32 v4, v5, 2, v4
    v_mul_u32_u24 v5, 0x020202, v5
    v_lshlrev_b32 v6, 25, v1
    v_and_b32 v6, 0x02000000, v6
    v_or_b32 v5, v5, v6
    v_add_u32 v5, 0x05040100, v5
    s_waitcnt vmcnt(8)
    v_lshlrev_b32 v20, 16, v10
    v_and_b32 v21, 0xffff0000, v10
    s_waitcnt vmcnt(7)
    v_lshlrev_b32 v22, 16, v11
    v_and_b32 v23, 0xffff0000, v11
    s_waitcnt vmcnt(6)
    v_lshlrev_b32 v24, 16, v12
    v_and_b32 v25, 0xffff0000, v12
    s_waitcnt vmcnt(5)
    v_lshlrev_b32 v26, 16, v13
    v_and_b32 v27, 0xffff0000, v13
    s_waitcnt vmcnt(4)
    v_lshlrev_b32 v28, 16, v14
    v_and_b32 v29, 0xffff0000, v14
    s_waitcnt vmcnt(3)
    v_lshlrev_b32 v30, 16, v15
    v_and_b32 v31, 0xffff0000, v15
    s_waitcnt vmcnt(2)
    v_lshlrev_b32 v32, 16, v16
    v_and_b32 v33, 0xffff0000, v16
    s_waitcnt vmcnt(1)
    v_lshlrev_b32 v34, 16, v17
    v_and_b32 v35, 0xffff0000, v17
    s_waitcnt vmcnt(0)
    v_lshlrev_b32 v36, 16, v18
    v_and_b32 v37, 0xffff0000, v18
    v_pk_add_f32 v[44:45], v[20:21], v[22:23]
    v_pk_add_f32 v[46:47], v[24:25], v[26:27]
    v_pk_add_f32 v[44:45], v[44:45], v[28:29]
    v_pk_add_f32 v[46:47], v[46:47], v[30:31]
    v_pk_add_f32 v[44:45], v[44:45], v[32:33]
    v_pk_add_f32 v[46:47], v[46:47], v[34:35]
    v_pk_add_f32 v[44:45], v[44:45], v[36:37]
    v_pk_add_f32 v[44:45], v[44:45], v[46:47]
    v_add_f32 v44, v44, v45
    s_nop 1
    v_add_f32_dpp v44, v44, v44 row_ror:8 row_mask:0xf bank_mask:0xf
    s_nop 1
    v_add_f32_dpp v44, v44, v44 row_ror:4 row_mask:0xf bank_mask:0xf
    s_nop 1
    v_add_f32_dpp v44, v44, v44 row_ror:2 row_mask:0xf bank_mask:0xf
    s_nop 1
    v_add_f32_dpp v44, v44, v44 row_ror:1 row_mask:0xf bank_mask:0xf
    v_mov_b32 v46, v44
    s_nop 1
    v_permlane16_swap_b32 v44, v46
    v_add_f32 v44, v44, v46
    v_mul_f32 v48, 0x3ae38e39, v44
    v_mov_b32 v49, v48
    v_cvt_pk_bf16_f32 v40, v48, v48
    v_and_b32 v40, 0xffff0000, v40
    v_mov_b32 v41, v40
    v_pk_add_f32 v[42:43], v[20:21], v[48:49] neg_lo:[0,1] neg_hi:[0,1]
    v_pk_mul_f32 v[44:45], v[42:43], v[42:43]
    v_pk_add_f32 v[42:43], v[22:23], v[48:49] neg_lo:[0,1] neg_hi:[0,1]
    v_pk_mul_f32 v[46:47], v[42:43], v[42:43]
    v_pk_add_f32 v[42:43], v[24:25], v[48:49] neg_lo:[0,1] neg_hi:[0,1]
    v_pk_fma_f32 v[44:45], v[42:43], v[42:43], v[44:45]
    v_pk_add_f32 v[42:43], v[26:27], v[48:49] neg_lo:[0,1] neg_hi:[0,1]
    v_pk_fma_f32 v[46:47], v[42:43], v[42:43], v[46:47]
    v_pk_add_f32 v[42:43], v[28:29], v[48:49] neg_lo:[0,1] neg_hi:[0,1]
    v_pk_fma_f32 v[44:45], v[42:43], v[42:43], v[44:45]
    v_pk_add_f32 v[42:43], v[30:31], v[48:49] neg_lo:[0,1] neg_hi:[0,1]
    v_pk_fma_f32 v[46:47], v[42:43], v[42:43], v[46:47]
    v_pk_add_f32 v[42:43], v[32:33], v[48:49] neg_lo:[0,1] neg_hi:[0,1]
    v_pk_fma_f32 v[44:45], v[42:43], v[42:43], v[44:45]
    v_pk_add_f32 v[42:43], v[34:35], v[48:49] neg_lo:[0,1] neg_hi:[0,1]
    v_pk_fma_f32 v[46:47], v[42:43], v[42:43], v[46:47]
    v_pk_add_f32 v[42:43], v[36:37], v[48:49] neg_lo:[0,1] neg_hi:[0,1]
    v_pk_fma_f32 v[44:45], v[42:43], v[42:43], v[44:45]
    v_pk_add_f32 v[44:45], v[44:45], v[46:47]
    v_add_f32 v44, v44, v45
    s_nop 1
    v_add_f32_dpp v44, v44, v44 row_ror:8 row_mask:0xf bank_mask:0xf
    s_nop 1
    v_add_f32_dpp v44, v44, v44 row_ror:4 row_mask:0xf bank_mask:0xf
    s_nop 1
    v_add_f32_dpp v44, v44, v44 row_ror:2 row_mask:0xf bank_mask:0xf
    s_nop 1
    v_add_f32_dpp v44, v44, v44 row_ror:1 row_mask:0xf bank_mask:0xf
    v_mov_b32 v46, v44
    s_nop 1
    v_permlane16_swap_b32 v44, v46
    v_add_f32 v44, v44, v46
    v_mul_f32 v44, 0x3ae38e39, v44
    v_cvt_pk_bf16_f32 v44, v44, v44
    v_and_b32 v44, 0xffff0000, v44
    v_add_f32 v44, 0x3727c5ac, v44
    v_cvt_pk_bf16_f32 v44, v44, v44
    v_and_b32 v44, 0xffff0000, v44
    v_sqrt_f32 v44, v44
    s_nop 0
    v_cvt_pk_bf16_f32 v44, v44, v44
    v_and_b32 v44, 0xffff0000, v44
    v_rcp_f32 v42, v44
    s_nop 0
    v_mov_b32 v43, v42
    v_pk_add_f32 v[44:45], v[20:21], v[40:41] neg_lo:[0,1] neg_hi:[0,1]
    v_cvt_pk_bf16_f32 v46, v44, v45
    v_lshlrev_b32 v44, 16, v46
    v_and_b32 v45, 0xffff0000, v46
    v_pk_mul_f32 v[44:45], v[44:45], v[42:43]
    v_cvt_pk_bf16_f32 v46, v44, v45
    v_lshlrev_b32 v44, 16, v46
    v_and_b32 v45, 0xffff0000, v46
    v_cvt_pk_f16_f32 v46, v44, v45
    v_mov_b32 v47, v46
    s_nop 1
    v_permlane32_swap_b32 v46, v47
    v_perm_b32 v10, v47, v46, v5
    ds_write_b32 v4, v10 offset:0
    v_pk_add_f32 v[44:45], v[22:23], v[40:41] neg_lo:[0,1] neg_hi:[0,1]
    v_cvt_pk_bf16_f32 v46, v44, v45
    v_lshlrev_b32 v44, 16, v46
    v_and_b32 v45, 0xffff0000, v46
    v_pk_mul_f32 v[44:45], v[44:45], v[42:43]
    v_cvt_pk_bf16_f32 v46, v44, v45
    v_lshlrev_b32 v44, 16, v46
    v_and_b32 v45, 0xffff0000, v46
    v_cvt_pk_f16_f32 v46, v44, v45
    v_mov_b32 v47, v46
    s_nop 1
    v_permlane32_swap_b32 v46, v47
    v_perm_b32 v11, v47, v46, v5
    ds_write_b32 v4, v11 offset:256
    v_pk_add_f32 v[44:45], v[24:25], v[40:41] neg_lo:[0,1] neg_hi:[0,1]
    v_cvt_pk_bf16_f32 v46, v44, v45
    v_lshlrev_b32 v44, 16, v46
    v_and_b32 v45, 0xffff0000, v46
    v_pk_mul_f32 v[44:45], v[44:45], v[42:43]
    v_cvt_pk_bf16_f32 v46, v44, v45
    v_lshlrev_b32 v44, 16, v46
    v_and_b32 v45, 0xffff0000, v46
    v_cvt_pk_f16_f32 v46, v44, v45
    v_mov_b32 v47, v46
    s_nop 1
    v_permlane32_swap_b32 v46, v47
    v_perm_b32 v12, v47, v46, v5
    ds_write_b32 v4, v12 offset:512
    v_pk_add_f32 v[44:45], v[26:27], v[40:41] neg_lo:[0,1] neg_hi:[0,1]
    v_cvt_pk_bf16_f32 v46, v44, v45
    v_lshlrev_b32 v44, 16, v46
    v_and_b32 v45, 0xffff0000, v46
    v_pk_mul_f32 v[44:45], v[44:45], v[42:43]
    v_cvt_pk_bf16_f32 v46, v44, v45
    v_lshlrev_b32 v44, 16, v46
    v_and_b32 v45, 0xffff0000, v46
    v_cvt_pk_f16_f32 v46, v44, v45
    v_mov_b32 v47, v46
    s_nop 1
    v_permlane32_swap_b32 v46, v47
    v_perm_b32 v13, v47, v46, v5
    ds_write_b32 v4, v13 offset:768
    v_pk_add_f32 v[44:45], v[28:29], v[40:41] neg_lo:[0,1] neg_hi:[0,1]
    v_cvt_pk_bf16_f32 v46, v44, v45
    v_lshlrev_b32 v44, 16, v46
    v_and_b32 v45, 0xffff0000, v46
    v_pk_mul_f32 v[44:45], v[44:45], v[42:43]
    v_cvt_pk_bf16_f32 v46, v44, v45
    v_lshlrev_b32 v44, 16, v46
    v_and_b32 v45, 0xffff0000, v46
    v_cvt_pk_f16_f32 v46, v44, v45
    v_mov_b32 v47, v46
    s_nop 1
    v_permlane32_swap_b32 v46, v47
    v_perm_b32 v14, v47, v46, v5
    ds_write_b32 v4, v14 offset:1024
    v_pk_add_f32 v[44:45], v[30:31], v[40:41] neg_lo:[0,1] neg_hi:[0,1]
    v_cvt_pk_bf16_f32 v46, v44, v45
    v_lshlrev_b32 v44, 16, v46
    v_and_b32 v45, 0xffff0000, v46
    v_pk_mul_f32 v[44:45], v[44:45], v[42:43]
    v_cvt_pk_bf16_f32 v46, v44, v45
    v_lshlrev_b32 v44, 16, v46
    v_and_b32 v45, 0xffff0000, v46
    v_cvt_pk_f16_f32 v46, v44, v45
    v_mov_b32 v47, v46
    s_nop 1
    v_permlane32_swap_b32 v46, v47
    v_perm_b32 v15, v47, v46, v5
    ds_write_b32 v4, v15 offset:1280
    v_pk_add_f32 v[44:45], v[32:33], v[40:41] neg_lo:[0,1] neg_hi:[0,1]
    v_cvt_pk_bf16_f32 v46, v44, v45
    v_lshlrev_b32 v44, 16, v46
    v_and_b32 v45, 0xffff0000, v46
    v_pk_mul_f32 v[44:45], v[44:45], v[42:43]
    v_cvt_pk_bf16_f32 v46, v44, v45
    v_lshlrev_b32 v44, 16, v46
    v_and_b32 v45, 0xffff0000, v46
    v_cvt_pk_f16_f32 v46, v44, v45
    v_mov_b32 v47, v46
    s_nop 1
    v_permlane32_swap_b32 v46, v47
    v_perm_b32 v16, v47, v46, v5
    ds_write_b32 v4, v16 offset:1536
    v_pk_add_f32 v[44:45], v[34:35], v[40:41] neg_lo:[0,1] neg_hi:[0,1]
    v_cvt_pk_bf16_f32 v46, v44, v45
    v_lshlrev_b32 v44, 16, v46
    v_and_b32 v45, 0xffff0000, v46
    v_pk_mul_f32 v[44:45], v[44:45], v[42:43]
    v_cvt_pk_bf16_f32 v46, v44, v45
    v_lshlrev_b32 v44, 16, v46
    v_and_b32 v45, 0xffff0000, v46
    v_cvt_pk_f16_f32 v46, v44, v45
    v_mov_b32 v47, v46
    s_nop 1
    v_permlane32_swap_b32 v46, v47
    v_perm_b32 v17, v47, v46, v5
    ds_write_b32 v4, v17 offset:1792
    v_pk_add_f32 v[44:45], v[36:37], v[40:41] neg_lo:[0,1] neg_hi:[0,1]
    v_cvt_pk_bf16_f32 v46, v44, v45
    v_lshlrev_b32 v44, 16, v46
    v_and_b32 v45, 0xffff0000, v46
    v_pk_mul_f32 v[44:45], v[44:45], v[42:43]
    v_cvt_pk_bf16_f32 v46, v44, v45
    v_lshlrev_b32 v44, 16, v46
    v_and_b32 v45, 0xffff0000, v46
    v_cvt_pk_f16_f32 v46, v44, v45
    v_mov_b32 v47, v46
    s_nop 1
    v_permlane32_swap_b32 v46, v47
    v_perm_b32 v18, v47, v46, v5
    ds_write_b32 v4, v18 offset:2048
    s_waitcnt lgkmcnt(0)
    s_barrier
    v_lshlrev_b32 v6, 2, v0
    v_lshlrev_b32 v7, 12, v0
    v_readfirstlane_b32 s16, v0
    ds_read2st64_b32 v[20:21], v6 offset0:0 offset1:9
    ds_read2st64_b32 v[22:23], v6 offset0:18 offset1:27
    ds_read2st64_b32 v[24:25], v6 offset0:4 offset1:13
    ds_read2st64_b32 v[26:27], v6 offset0:22 offset1:31
    s_cmp_ge_u32 s16, 64
    s_cbranch_scc1 K1_LN_SKIP
    ds_read2st64_b32 v[28:29], v6 offset0:8 offset1:17
    ds_read2st64_b32 v[30:31], v6 offset0:26 offset1:35
    s_add_u32 s17, s18, 0x200000
    s_waitcnt lgkmcnt(0)
    buffer_store_dwordx4 v[28:31], v7, s[12:15], s17 offen
K1_LN_SKIP:
    s_add_u32 s17, s18, 0x100000
    s_waitcnt lgkmcnt(0)
    buffer_store_dwordx4 v[20:23], v7, s[12:15], s18 offen
    buffer_store_dwordx4 v[24:27], v7, s[12:15], s17 offen
    s_mul_i32 s19, s2, 10368
    s_add_u32 s19, s19, 0xd00000
    s_add_u32 s20, s6, s19
    s_addc_u32 s21, s7, 0
    s_movk_i32 s22, 10368
    s_mov_b32 s23, 0x20000
    v_mov_b32 v52, -1
    v_mov_b32 v53, -1
    v_mov_b32 v54, -1
    v_mov_b32 v55, -1
    v_lshlrev_b32 v56, 4, v0
    s_movk_i32 s19, 4096
    s_movk_i32 s24, 8192
    buffer_store_dwordx4 v[52:55], v56, s[20:23], 0 offen sc1
    buffer_store_dwordx4 v[52:55], v56, s[20:23], s19 offen sc1
    buffer_store_dwordx4 v[52:55], v56, s[20:23], s24 offen sc1
    s_cmp_ge_u32 s2, 3
    s_cbranch_scc1 K1_NOCLR
    s_lshl_b32 s19, s2, 12
    s_add_u32 s19, s19, 0xc00000
    s_add_u32 s20, s6, s19
    s_addc_u32 s21, s7, 0
    v_mov_b32 v60, 0
    v_mov_b32 v61, 0
    v_mov_b32 v62, 0
    v_mov_b32 v63, 0
    buffer_store_dwordx4 v[60:63], v56, s[20:23], 0 offen sc1
K1_NOCLR:
    s_endpgm
K1_KGEN:
    s_load_dwordx16 s[16:31], s[0:1], 0
    s_load_dwordx2 s[6:7], s[0:1], 128
    s_sub_u32 s3, s2, 256
    s_and_b32 s4, s3, 7
    s_mul_i32 s4, s4, 72
    s_lshr_b32 s3, s3, 3
    s_add_u32 s3, s3, s4
    v_and_b32 v1, 63, v0
    s_lshl_b32 s4, s3, 8
    v_lshl_add_u32 v2, v1, 2, s4
    s_lshl_b32 s4, s3, 1
    v_mov_b32 v3, s4
    v_readfirstlane_b32 s5, v0
    s_lshr_b32 s5, s5, 6
    s_waitcnt lgkmcnt(0)
    global_load_ushort v16, v3, s[30:31]
    global_load_dword v10, v2, s[18:19]
    global_load_dword v11, v2, s[20:21]
    global_load_dword v12, v2, s[22:23]
    global_load_dword v13, v2, s[24:25]
    global_load_dword v14, v2, s[26:27]
    global_load_dword v15, v2, s[28:29]
    s_add_u32 s8, s6, 0x300000
    s_addc_u32 s9, s7, 0
    s_mov_b32 s10, 0x242400
    s_mov_b32 s11, 0x20000
    s_add_u32 s12, s6, 0xc10000
    s_addc_u32 s13, s7, 0
    s_mov_b32 s14, 0x900
    s_mov_b32 s15, 0x20000
    v_lshlrev_b32 v4, 3, v0
    v_sub_u32 v4, 2047, v4
    v_subrev_u32 v5, 0, v4
    v_subrev_u32 v6, 1, v4
    v_cvt_f32_u32 v7, v5
    v_cvt_f32_u32 v8, v6
    v_cvt_pk_bf16_f32 v7, v7, v8
    v_and_b32 v8, 0xffff, v7
    v_lshrrev_b32 v7, 16, v7
    v_subrev_u32 v8, 0x4280, v8
    v_subrev_u32 v7, 0x4280, v7
    v_cmp_gt_u32 vcc, 128, v5
    s_nop 1
    v_cndmask_b32 v8, v8, v5, vcc
    v_cmp_gt_u32 vcc, 128, v6
    s_nop 1
    v_cndmask_b32 v7, v7, v6, vcc
    v_lshlrev_b32 v100, 1, v8
    v_lshlrev_b32 v101, 1, v7
    v_subrev_u32 v5, 2, v4
    v_subrev_u32 v6, 3, v4
    v_cvt_f32_u32 v7, v5
    v_cvt_f32_u32 v8, v6
    v_cvt_pk_bf16_f32 v7, v7, v8
    v_and_b32 v8, 0xffff, v7
    v_lshrrev_b32 v7, 16, v7
    v_subrev_u32 v8, 0x4280, v8
    v_subrev_u32 v7, 0x4280, v7
    v_cmp_gt_u32 vcc, 128, v5
    s_nop 1
    v_cndmask_b32 v8, v8, v5, vcc
    v_cmp_gt_u32 vcc, 128, v6
    s_nop 1
    v_cndmask_b32 v7, v7, v6, vcc
    v_lshlrev_b32 v102, 1, v8
    v_lshlrev_b32 v103, 1, v7
    v_subrev_u32 v5, 4, v4
    v_subrev_u32 v6, 5, v4
    v_cvt_f32_u32 v7, v5
    v_cvt_f32_u32 v8, v6
    v_cvt_pk_bf16_f32 v7, v7, v8
    v_and_b32 v8, 0xffff, v7
    v_lshrrev_b32 v7, 16, v7
    v_subrev_u32 v8, 0x4280, v8
    v_subrev_u32 v7, 0x4280, v7
    v_cmp_gt_u32 vcc, 128, v5
    s_nop 1
    v_cndmask_b32 v8, v8, v5, vcc
    v_cmp_gt_u32 vcc, 128, v6
    s_nop 1
    v_cndmask_b32 v7, v7, v6, vcc
    v_lshlrev_b32 v104, 1, v8
    v_lshlrev_b32 v105, 1, v7
    v_subrev_u32 v5, 6, v4
    v_subrev_u32 v6, 7, v4
    v_cvt_f32_u32 v7, v5
    v_cvt_f32_u32 v8, v6
    v_cvt_pk_bf16_f32 v7, v7, v8
    v_and_b32 v8, 0xffff, v7
    v_lshrrev_b32 v7, 16, v7
    v_subrev_u32 v8, 0x4280, v8
    v_subrev_u32 v7, 0x4280, v7
    v_cmp_gt_u32 vcc, 128, v5
    s_nop 1
    v_cndmask_b32 v8, v8, v5, vcc
    v_cmp_gt_u32 vcc, 128, v6
    s_nop 1
    v_cndmask_b32 v7, v7, v6, vcc
    v_lshlrev_b32 v106, 1, v8
    v_lshlrev_b32 v107, 1, v7
    s_waitcnt vmcnt(6)
    v_lshlrev_b32 v16, 16, v16
    v_mul_f32 v17, 0x3fb8aa3b, v16
    s_mov_b32 s32, 0x3fb8aa3b
    s_mov_b32 s33, 0x32a57060
    v_fma_f32 v18, v16, s32, -v17
    v_fma_f32 v18, v16, s33, v18
    v_exp_f32 v17, v17
    v_mul_f32 v18, 0x3f317218, v18
    v_fma_f32 v17, v17, v18, v17
    v_cvt_pk_bf16_f32 v17, v17, v17
    v_and_b32 v16, 0xffff0000, v17
    v_mov_b32 v17, v16
    s_waitcnt vmcnt(0)
    v_lshlrev_b32 v20, 16, v10
    v_and_b32 v21, 0xffff0000, v10
    v_lshlrev_b32 v22, 16, v11
    v_and_b32 v23, 0xffff0000, v11
    v_lshlrev_b32 v24, 16, v12
    v_and_b32 v25, 0xffff0000, v12
    v_lshlrev_b32 v26, 16, v13
    v_and_b32 v27, 0xffff0000, v13
    v_lshlrev_b32 v28, 16, v14
    v_and_b32 v29, 0xffff0000, v14
    v_lshlrev_b32 v30, 16, v15
    v_and_b32 v31, 0xffff0000, v15
    v_pk_mul_f32 v[20:21], v[20:21], v[16:17]
    v_pk_mul_f32 v[22:23], v[22:23], v[16:17]
    v_pk_mul_f32 v[24:25], v[24:25], v[16:17]
    v_pk_mul_f32 v[26:27], v[26:27], v[16:17]
    v_pk_mul_f32 v[90:91], v[30:31], v[26:27]
    v_pk_mul_f32 v[92:93], v[30:31], v[24:25]
    v_pk_fma_f32 v[34:35], v[28:29], v[26:27], v[92:93]
    v_pk_fma_f32 v[32:33], v[28:29], v[24:25], v[90:91] neg_lo:[0,0,1] neg_hi:[0,0,1]
    v_max_f32 v36, v20, v21
    s_nop 1
    v_max_f32_dpp v36, v36, v36 row_ror:8 row_mask:0xf bank_mask:0xf
    s_nop 1
    v_max_f32_dpp v36, v36, v36 row_ror:4 row_mask:0xf bank_mask:0xf
    s_nop 1
    v_max_f32_dpp v36, v36, v36 row_ror:2 row_mask:0xf bank_mask:0xf
    s_nop 1
    v_max_f32_dpp v36, v36, v36 row_ror:1 row_mask:0xf bank_mask:0xf
    v_mov_b32 v38, v36
    s_nop 1
    v_permlane16_swap_b32 v36, v38
    v_max_f32 v36, v36, v38
    v_mov_b32 v38, v36
    s_nop 1
    v_permlane32_swap_b32 v36, v38
    v_max_f32 v36, v36, v38
    v_add_f32 v37, abs(v32), abs(v33)
    v_add_f32 v38, abs(v34), abs(v35)
    v_add_f32 v37, v37, v38
    s_nop 1
    v_add_f32_dpp v37, v37, v37 row_ror:8 row_mask:0xf bank_mask:0xf
    s_nop 1
    v_add_f32_dpp v37, v37, v37 row_ror:4 row_mask:0xf bank_mask:0xf
    s_nop 1
    v_add_f32_dpp v37, v37, v37 row_ror:2 row_mask:0xf bank_mask:0xf
    s_nop 1
    v_add_f32_dpp v37, v37, v37 row_ror:1 row_mask:0xf bank_mask:0xf
    v_mov_b32 v38, v37
    s_nop 1
    v_permlane16_swap_b32 v37, v38
    v_add_f32 v37, v37, v38
    v_mov_b32 v38, v37
    s_nop 1
    v_permlane32_swap_b32 v37, v38
    v_add_f32 v37, v37, v38
    v_max_f32 v37, 0x03aa2425, v37
    v_rcp_f32 v38, v37
    s_nop 0
    v_mul_f32 v38, 0x47000000, v38
    v_mov_b32 v39, v38
    v_pk_mul_f32 v[32:33], v[32:33], v[38:39]
    v_pk_mul_f32 v[34:35], v[34:35], v[38:39]
    v_sub_f32 v20, v20, v36
    v_sub_f32 v21, v21, v36
    v_mul_f32 v20, 0x3fb8aa3b, v20
    v_mul_f32 v21, 0x3fb8aa3b, v21
    v_mul_f32 v36, 0x3fb8aa3b, v36
    s_mov_b32 s32, 0x3e22f983
    s_mov_b32 s33, 0x31dc9c88
    s_mul_i32 s4, s5, 8704
    v_lshl_add_u32 v4, v1, 3, s4
    v_and_b32 v5, 15, v1
    v_lshrrev_b32 v6, 4, v1
    v_lshlrev_b32 v7, 3, v5
    s_cmp_eq_u32 s5, 1
    s_cbranch_scc1 K1_J1
    s_cmp_eq_u32 s5, 2
    s_cbranch_scc1 K1_J2
    s_cmp_eq_u32 s5, 3
    s_cbranch_scc1 K1_J3
    v_mul_f32 v90, 0x3f800000, v20
    v_mul_f32 v91, 0x3f800000, v22
    v_exp_f32 v90, v90
    v_mul_f32 v92, s32, v91
    v_rndne_f32 v92, v92
    v_fma_f32 v92, v91, s32, -v92
    v_fma_f32 v92, v91, s33, v92
    v_cos_f32 v91, v92
    v_sin_f32 v92, v92
    v_mul_f32 v40, v90, v91
    v_mul_f32 v42, v90, v92
    v_mul_f32 v90, 0x3f800000, v21
    v_mul_f32 v91, 0x3f800000, v23
    v_exp_f32 v90, v90
    v_mul_f32 v92, s32, v91
    v_rndne_f32 v92, v92
    v_fma_f32 v92, v91, s32, -v92
    v_fma_f32 v92, v91, s33, v92
    v_cos_f32 v91, v92
    v_sin_f32 v92, v92
    v_mul_f32 v41, v90, v91
    v_mul_f32 v43, v90, v92
    v_mul_f32 v90, 0x43000000, v20
    v_mul_f32 v91, 0x43000000, v22
    v_exp_f32 v90, v90
    v_mul_f32 v92, s32, v91
    v_rndne_f32 v92, v92
    v_fma_f32 v92, v91, s32, -v92
    v_fma_f32 v92, v91, s33, v92
    v_cos_f32 v91, v92
    v_sin_f32 v92, v92
    v_mul_f32 v44, v90, v91
    v_mul_f32 v46, v90, v92
    v_mul_f32 v90, 0x43000000, v21
    v_mul_f32 v91, 0x43000000, v23
    v_exp_f32 v90, v90
    v_mul_f32 v92, s32, v91
    v_rndne_f32 v92, v92
    v_fma_f32 v92, v91, s32, -v92
    v_fma_f32 v92, v91, s33, v92
    v_cos_f32 v91, v92
    v_sin_f32 v92, v92
    v_mul_f32 v45, v90, v91
    v_mul_f32 v47, v90, v92
    v_cvt_pk_f16_f32 v94, v32, v34
    v_cvt_pk_f16_f32 v95, v33, v35
    ds_write_b64 v4, v[94:95] offset:0
    v_pk_mul_f32 v[90:91], v[34:35], v[46:47]
    v_pk_mul_f32 v[92:93], v[34:35], v[44:45]
    v_pk_fma_f32 v[62:63], v[32:33], v[46:47], v[92:93]
    v_pk_fma_f32 v[60:61], v[32:33], v[44:45], v[90:91] neg_lo:[0,0,1] neg_hi:[0,0,1]
    v_cvt_pk_f16_f32 v94, v60, v62
    v_cvt_pk_f16_f32 v95, v61, v63
    ds_write_b64 v4, v[94:95] offset:4352
    v_pk_mul_f32 v[90:91], v[34:35], v[42:43]
    v_pk_mul_f32 v[92:93], v[34:35], v[40:41]
    v_pk_fma_f32 v[54:55], v[32:33], v[42:43], v[92:93]
    v_pk_fma_f32 v[52:53], v[32:33], v[40:41], v[90:91] neg_lo:[0,0,1] neg_hi:[0,0,1]
    v_cvt_pk_f16_f32 v94, v52, v54
    v_cvt_pk_f16_f32 v95, v53, v55
    ds_write_b64 v4, v[94:95] offset:544
    v_pk_mul_f32 v[90:91], v[54:55], v[46:47]
    v_pk_mul_f32 v[92:93], v[54:55], v[44:45]
    v_pk_fma_f32 v[62:63], v[52:53], v[46:47], v[92:93]
    v_pk_fma_f32 v[60:61], v[52:53], v[44:45], v[90:91] neg_lo:[0,0,1] neg_hi:[0,0,1]
    v_cvt_pk_f16_f32 v94, v60, v62
    v_cvt_pk_f16_f32 v95, v61, v63
    ds_write_b64 v4, v[94:95] offset:4896
    v_pk_mul_f32 v[90:91], v[54:55], v[42:43]
    v_pk_mul_f32 v[92:93], v[54:55], v[40:41]
    v_pk_fma_f32 v[58:59], v[52:53], v[42:43], v[92:93]
    v_pk_fma_f32 v[56:57], v[52:53], v[40:41], v[90:91] neg_lo:[0,0,1] neg_hi:[0,0,1]
    v_cvt_pk_f16_f32 v94, v56, v58
    v_cvt_pk_f16_f32 v95, v57, v59
    ds_write_b64 v4, v[94:95] offset:1088
    v_pk_mul_f32 v[90:91], v[58:59], v[46:47]
    v_pk_mul_f32 v[92:93], v[58:59], v[44:45]
    v_pk_fma_f32 v[62:63], v[56:57], v[46:47], v[92:93]
    v_pk_fma_f32 v[60:61], v[56:57], v[44:45], v[90:91] neg_lo:[0,0,1] neg_hi:[0,0,1]
    v_cvt_pk_f16_f32 v94, v60, v62
    v_cvt_pk_f16_f32 v95, v61, v63
    ds_write_b64 v4, v[94:95] offset:5440
    v_pk_mul_f32 v[90:91], v[58:59], v[42:43]
    v_pk_mul_f32 v[92:93], v[58:59], v[40:41]
    v_pk_fma_f32 v[54:55], v[56:57], v[42:43], v[92:93]
    v_pk_fma_f32 v[52:53], v[56:57], v[40:41], v[90:91] neg_lo:[0,0,1] neg_hi:[0,0,1]
    v_cvt_pk_f16_f32 v94, v52, v54
    v_cvt_pk_f16_f32 v95, v53, v55
    ds_write_b64 v4, v[94:95] offset:1632
    v_pk_mul_f32 v[90:91], v[54:55], v[46:47]
    v_pk_mul_f32 v[92:93], v[54:55], v[44:45]
    v_pk_fma_f32 v[62:63], v[52:53], v[46:47], v[92:93]
    v_pk_fma_f32 v[60:61], v[52:53], v[44:45], v[90:91] neg_lo:[0,0,1] neg_hi:[0,0,1]
    v_cvt_pk_f16_f32 v94, v60, v62
    v_cvt_pk_f16_f32 v95, v61, v63
    ds_write_b64 v4, v[94:95] offset:5984
    v_pk_mul_f32 v[90:91], v[54:55], v[42:43]
    v_pk_mul_f32 v[92:93], v[54:55], v[40:41]
    v_pk_fma_f32 v[58:59], v[52:53], v[42:43], v[92:93]
    v_pk_fma_f32 v[56:57], v[52:53], v[40:41], v[90:91] neg_lo:[0,0,1] neg_hi:[0,0,1]
    v_cvt_pk_f16_f32 v94, v56, v58
    v_cvt_pk_f16_f32 v95, v57, v59
    ds_write_b64 v4, v[94:95] offset:2176
    v_pk_mul_f32 v[90:91], v[58:59], v[46:47]
    v_pk_mul_f32 v[92:93], v[58:59], v[44:45]
    v_pk_fma_f32 v[62:63], v[56:57], v[46:47], v[92:93]
    v_pk_fma_f32 v[60:61], v[56:57], v[44:45], v[90:91] neg_lo:[0,0,1] neg_hi:[0,0,1]
    v_cvt_pk_f16_f32 v94, v60, v62
    v_cvt_pk_f16_f32 v95, v61, v63
    ds_write_b64 v4, v[94:95] offset:6528
    v_pk_mul_f32 v[90:91], v[58:59], v[42:43]
    v_pk_mul_f32 v[92:93], v[58:59], v[40:41]
    v_pk_fma_f32 v[54:55], v[56:57], v[42:43], v[92:93]
    v_pk_fma_f32 v[52:53], v[56:57], v[40:41], v[90:91] neg_lo:[0,0,1] neg_hi:[0,0,1]
    v_cvt_pk_f16_f32 v94, v52, v54
    v_cvt_pk_f16_f32 v95, v53, v55
    ds_write_b64 v4, v[94:95] offset:2720
    v_pk_mul_f32 v[90:91], v[54:55], v[46:47]
    v_pk_mul_f32 v[92:93], v[54:55], v[44:45]
    v_pk_fma_f32 v[62:63], v[52:53], v[46:47], v[92:93]
    v_pk_fma_f32 v[60:61], v[52:53], v[44:45], v[90:91] neg_lo:[0,0,1] neg_hi:[0,0,1]
    v_cvt_pk_f16_f32 v94, v60, v62
    v_cvt_pk_f16_f32 v95, v61, v63
    ds_write_b64 v4, v[94:95] offset:7072
    v_pk_mul_f32 v[90:91], v[54:55], v[42:43]
    v_pk_mul_f32 v[92:93], v[54:55], v[40:41]
    v_pk_fma_f32 v[58:59], v[52:53], v[42:43], v[92:93]
    v_pk_fma_f32 v[56:57], v[52:53], v[40:41], v[90:91] neg_lo:[0,0,1] neg_hi:[0,0,1]
    v_cvt_pk_f16_f32 v94, v56, v58
    v_cvt_pk_f16_f32 v95, v57, v59
    ds_write_b64 v4, v[94:95] offset:3264
    v_pk_mul_f32 v[90:91], v[58:59], v[46:47]
    v_pk_mul_f32 v[92:93], v[58:59], v[44:45]
    v_pk_fma_f32 v[62:63], v[56:57], v[46:47], v[92:93]
    v_pk_fma_f32 v[60:61], v[56:57], v[44:45], v[90:91] neg_lo:[0,0,1] neg_hi:[0,0,1]
    v_cvt_pk_f16_f32 v94, v60, v62
    v_cvt_pk_f16_f32 v95, v61, v63
    ds_write_b64 v4, v[94:95] offset:7616
    v_pk_mul_f32 v[90:91], v[58:59], v[42:43]
    v_pk_mul_f32 v[92:93], v[58:59], v[40:41]
    v_pk_fma_f32 v[54:55], v[56:57], v[42:43], v[92:93]
    v_pk_fma_f32 v[52:53], v[56:57], v[40:41], v[90:91] neg_lo:[0,0,1] neg_hi:[0,0,1]
    v_cvt_pk_f16_f32 v94, v52, v54
    v_cvt_pk_f16_f32 v95, v53, v55
    ds_write_b64 v4, v[94:95] offset:3808
    v_pk_mul_f32 v[90:91], v[54:55], v[46:47]
    v_pk_mul_f32 v[92:93], v[54:55], v[44:45]
    v_pk_fma_f32 v[62:63], v[52:53], v[46:47], v[92:93]
    v_pk_fma_f32 v[60:61], v[52:53], v[44:45], v[90:91] neg_lo:[0,0,1] neg_hi:[0,0,1]
    v_cvt_pk_f16_f32 v94, v60, v62
    v_cvt_pk_f16_f32 v95, v61, v63
    ds_write_b64 v4, v[94:95] offset:8160
    v_lshrrev_b32 v8, 1, v6
    v_lshl_add_u32 v7, v8, 7, v7
    v_and_b32 v8, 1, v6
    v_lshl_add_u32 v7, v8, 2, v7
    v_mov_b32 v8, 1
    v_mov_b32 v9, 2
    s_branch K1_JOIN
K1_J1:
    v_mul_f32 v90, 0x40000000, v20
    v_mul_f32 v91, 0x40000000, v22
    v_exp_f32 v90, v90
    v_mul_f32 v92, s32, v91
    v_rndne_f32 v92, v92
    v_fma_f32 v92, v91, s32, -v92
    v_fma_f32 v92, v91, s33, v92
    v_cos_f32 v91, v92
    v_sin_f32 v92, v92
    v_mul_f32 v40, v90, v91
    v_mul_f32 v42, v90, v92
    v_mul_f32 v90, 0x40000000, v21
    v_mul_f32 v91, 0x40000000, v23
    v_exp_f32 v90, v90
    v_mul_f32 v92, s32, v91
    v_rndne_f32 v92, v92
    v_fma_f32 v92, v91, s32, -v92
    v_fma_f32 v92, v91, s33, v92
    v_cos_f32 v91, v92
    v_sin_f32 v92, v92
    v_mul_f32 v41, v90, v91
    v_mul_f32 v43, v90, v92
    v_mul_f32 v90, 0x43000000, v20
    v_mul_f32 v91, 0x43000000, v22
    v_exp_f32 v90, v90
    v_mul_f32 v92, s32, v91
    v_rndne_f32 v92, v92
    v_fma_f32 v92, v91, s32, -v92
    v_fma_f32 v92, v91, s33, v92
    v_cos_f32 v91, v92
    v_sin_f32 v92, v92
    v_mul_f32 v44, v90, v91
    v_mul_f32 v46, v90, v92
    v_mul_f32 v90, 0x43000000, v21
    v_mul_f32 v91, 0x43000000, v23
    v_exp_f32 v90, v90
    v_mul_f32 v92, s32, v91
    v_rndne_f32 v92, v92
    v_fma_f32 v92, v91, s32, -v92
    v_fma_f32 v92, v91, s33, v92
    v_cos_f32 v91, v92
    v_sin_f32 v92, v92
    v_mul_f32 v45, v90, v91
    v_mul_f32 v47, v90, v92
    v_mul_f32 v90, 0x43800000, v20
    v_mul_f32 v91, 0x43800000, v22
    v_exp_f32 v90, v90
    v_mul_f32 v92, s32, v91
    v_rndne_f32 v92, v92
    v_fma_f32 v92, v91, s32, -v92
    v_fma_f32 v92, v91, s33, v92
    v_cos_f32 v91, v92
    v_sin_f32 v92, v92
    v_mul_f32 v48, v90, v91
    v_mul_f32 v50, v90, v92
    v_mul_f32 v90, 0x43800000, v21
    v_mul_f32 v91, 0x43800000, v23
    v_exp_f32 v90, v90
    v_mul_f32 v92, s32, v91
    v_rndne_f32 v92, v92
    v_fma_f32 v92, v91, s32, -v92
    v_fma_f32 v92, v91, s33, v92
    v_cos_f32 v91, v92
    v_sin_f32 v92, v92
    v_mul_f32 v49, v90, v91
    v_mul_f32 v51, v90, v92
    v_pk_mul_f32 v[90:91], v[34:35], v[50:51]
    v_pk_mul_f32 v[92:93], v[34:35], v[48:49]
    v_pk_fma_f32 v[54:55], v[32:33], v[50:51], v[92:93]
    v_pk_fma_f32 v[52:53], v[32:33], v[48:49], v[90:91] neg_lo:[0,0,1] neg_hi:[0,0,1]
    v_pk_mul_f32 v[90:91], v[54:55], v[50:51]
    v_pk_mul_f32 v[92:93], v[54:55], v[48:49]
    v_pk_fma_f32 v[66:67], v[52:53], v[50:51], v[92:93]
    v_pk_fma_f32 v[64:65], v[52:53], v[48:49], v[90:91] neg_lo:[0,0,1] neg_hi:[0,0,1]
    v_cvt_pk_f16_f32 v94, v52, v54
    v_cvt_pk_f16_f32 v95, v53, v55
    ds_write_b64 v4, v[94:95] offset:0
    v_pk_mul_f32 v[90:91], v[54:55], v[46:47]
    v_pk_mul_f32 v[92:93], v[54:55], v[44:45]
    v_pk_fma_f32 v[62:63], v[52:53], v[46:47], v[92:93]
    v_pk_fma_f32 v[60:61], v[52:53], v[44:45], v[90:91] neg_lo:[0,0,1] neg_hi:[0,0,1]
    v_cvt_pk_f16_f32 v94, v60, v62
    v_cvt_pk_f16_f32 v95, v61, v63
    ds_write_b64 v4, v[94:95] offset:2176
    v_pk_mul_f32 v[90:91], v[54:55], v[42:43]
    v_pk_mul_f32 v[92:93], v[54:55], v[40:41]
    v_pk_fma_f32 v[58:59], v[52:53], v[42:43], v[92:93]
    v_pk_fma_f32 v[56:57], v[52:53], v[40:41], v[90:91] neg_lo:[0,0,1] neg_hi:[0,0,1]
    v_cvt_pk_f16_f32 v94, v56, v58
    v_cvt_pk_f16_f32 v95, v57, v59
    ds_write_b64 v4, v[94:95] offset:544
    v_pk_mul_f32 v[90:91], v[58:59], v[46:47]
    v_pk_mul_f32 v[92:93], v[58:59], v[44:45]
    v_pk_fma_f32 v[62:63], v[56:57], v[46:47], v[92:93]
    v_pk_fma_f32 v[60:61], v[56:57], v[44:45], v[90:91] neg_lo:[0,0,1] neg_hi:[0,0,1]
    v_cvt_pk_f16_f32 v94, v60, v62
    v_cvt_pk_f16_f32 v95, v61, v63
    ds_write_b64 v4, v[94:95] offset:2720
    v_pk_mul_f32 v[90:91], v[58:59], v[42:43]
    v_pk_mul_f32 v[92:93], v[58:59], v[40:41]
    v_pk_fma_f32 v[54:55], v[56:57], v[42:43], v[92:93]
    v_pk_fma_f32 v[52:53], v[56:57], v[40:41], v[90:91] neg_lo:[0,0,1] neg_hi:[0,0,1]
    v_cvt_pk_f16_f32 v94, v52, v54
    v_cvt_pk_f16_f32 v95, v53, v55
    ds_write_b64 v4, v[94:95] offset:1088
    v_pk_mul_f32 v[90:91], v[54:55], v[46:47]
    v_pk_mul_f32 v[92:93], v[54:55], v[44:45]
    v_pk_fma_f32 v[62:63], v[52:53], v[46:47], v[92:93]
    v_pk_fma_f32 v[60:61], v[52:53], v[44:45], v[90:91] neg_lo:[0,0,1] neg_hi:[0,0,1]
    v_cvt_pk_f16_f32 v94, v60, v62
    v_cvt_pk_f16_f32 v95, v61, v63
    ds_write_b64 v4, v[94:95] offset:3264
    v_pk_mul_f32 v[90:91], v[54:55], v[42:43]
    v_pk_mul_f32 v[92:93], v[54:55], v[40:41]
    v_pk_fma_f32 v[58:59], v[52:53], v[42:43], v[92:93]
    v_pk_fma_f32 v[56:57], v[52:53], v[40:41], v[90:91] neg_lo:[0,0,1] neg_hi:[0,0,1]
    v_cvt_pk_f16_f32 v94, v56, v58
    v_cvt_pk_f16_f32 v95, v57, v59
    ds_write_b64 v4, v[94:95] offset:1632
    v_pk_mul_f32 v[90:91], v[58:59], v[46:47]
    v_pk_mul_f32 v[92:93], v[58:59], v[44:45]
    v_pk_fma_f32 v[62:63], v[56:57], v[46:47], v[92:93]
    v_pk_fma_f32 v[60:61], v[56:57], v[44:45], v[90:91] neg_lo:[0,0,1] neg_hi:[0,0,1]
    v_cvt_pk_f16_f32 v94, v60, v62
    v_cvt_pk_f16_f32 v95, v61, v63
    ds_write_b64 v4, v[94:95] offset:3808
    v_pk_mul_f32 v[90:91], v[42:43], v[42:43]
    v_pk_mul_f32 v[92:93], v[42:43], v[40:41]
    v_pk_fma_f32 v[50:51], v[40:41], v[42:43], v[92:93]
    v_pk_fma_f32 v[48:49], v[40:41], v[40:41], v[90:91] neg_lo:[0,0,1] neg_hi:[0,0,1]
    v_cvt_pk_f16_f32 v94, v64, v66
    v_cvt_pk_f16_f32 v95, v65, v67
    ds_write_b64 v4, v[94:95] offset:4352
    v_pk_mul_f32 v[90:91], v[66:67], v[50:51]
    v_pk_mul_f32 v[92:93], v[66:67], v[48:49]
    v_pk_fma_f32 v[62:63], v[64:65], v[50:51], v[92:93]
    v_pk_fma_f32 v[60:61], v[64:65], v[48:49], v[90:91] neg_lo:[0,0,1] neg_hi:[0,0,1]
    v_cvt_pk_f16_f32 v94, v60, v62
    v_cvt_pk_f16_f32 v95, v61, v63
    ds_write_b64 v4, v[94:95] offset:4896
    v_pk_mul_f32 v[90:91], v[66:67], v[46:47]
    v_pk_mul_f32 v[92:93], v[66:67], v[44:45]
    v_pk_fma_f32 v[54:55], v[64:65], v[46:47], v[92:93]
    v_pk_fma_f32 v[52:53], v[64:65], v[44:45], v[90:91] neg_lo:[0,0,1] neg_hi:[0,0,1]
    v_cvt_pk_f16_f32 v94, v52, v54
    v_cvt_pk_f16_f32 v95, v53, v55
    ds_write_b64 v4, v[94:95] offset:5440
    v_pk_mul_f32 v[90:91], v[54:55], v[50:51]
    v_pk_mul_f32 v[92:93], v[54:55], v[48:49]
    v_pk_fma_f32 v[62:63], v[52:53], v[50:51], v[92:93]
    v_pk_fma_f32 v[60:61], v[52:53], v[48:49], v[90:91] neg_lo:[0,0,1] neg_hi:[0,0,1]
    v_cvt_pk_f16_f32 v94, v60, v62
    v_cvt_pk_f16_f32 v95, v61, v63
    ds_write_b64 v4, v[94:95] offset:5984
    v_pk_mul_f32 v[90:91], v[54:55], v[46:47]
    v_pk_mul_f32 v[92:93], v[54:55], v[44:45]
    v_pk_fma_f32 v[58:59], v[52:53], v[46:47], v[92:93]
    v_pk_fma_f32 v[56:57], v[52:53], v[44:45], v[90:91] neg_lo:[0,0,1] neg_hi:[0,0,1]
    v_cvt_pk_f16_f32 v94, v56, v58
    v_cvt_pk_f16_f32 v95, v57, v59
    ds_write_b64 v4, v[94:95] offset:6528
    v_pk_mul_f32 v[90:91], v[58:59], v[50:51]
    v_pk_mul_f32 v[92:93], v[58:59], v[48:49]
    v_pk_fma_f32 v[62:63], v[56:57], v[50:51], v[92:93]
    v_pk_fma_f32 v[60:61], v[56:57], v[48:49], v[90:91] neg_lo:[0,0,1] neg_hi:[0,0,1]
    v_cvt_pk_f16_f32 v94, v60, v62
    v_cvt_pk_f16_f32 v95, v61, v63
    ds_write_b64 v4, v[94:95] offset:7072
    v_pk_mul_f32 v[90:91], v[58:59], v[46:47]
    v_pk_mul_f32 v[92:93], v[58:59], v[44:45]
    v_pk_fma_f32 v[54:55], v[56:57], v[46:47], v[92:93]
    v_pk_fma_f32 v[52:53], v[56:57], v[44:45], v[90:91] neg_lo:[0,0,1] neg_hi:[0,0,1]
    v_cvt_pk_f16_f32 v94, v52, v54
    v_cvt_pk_f16_f32 v95, v53, v55
    ds_write_b64 v4, v[94:95] offset:7616
    v_pk_mul_f32 v[90:91], v[54:55], v[50:51]
    v_pk_mul_f32 v[92:93], v[54:55], v[48:49]
    v_pk_fma_f32 v[62:63], v[52:53], v[50:51], v[92:93]
    v_pk_fma_f32 v[60:61], v[52:53], v[48:49], v[90:91] neg_lo:[0,0,1] neg_hi:[0,0,1]
    v_cvt_pk_f16_f32 v94, v60, v62
    v_cvt_pk_f16_f32 v95, v61, v63
    ds_write_b64 v4, v[94:95] offset:8160
    v_lshl_add_u32 v8, v6, 7, v7
    v_add_u32 v8, 256, v8
    v_lshl_add_u32 v7, v6, 8, v7
    v_cmp_gt_u32 vcc, 2, v6
    s_nop 1
    v_cndmask_b32 v7, v7, v8, vcc
    v_mov_b32 v8, 4
    v_mov_b32 v9, 0x80
    v_cndmask_b32 v8, v8, 2, vcc
    v_cndmask_b32 v9, v9, 4, vcc
    s_branch K1_JOIN
K1_J2:
    v_mul_f32 v90, 0x43000000, v20
    v_mul_f32 v91, 0x43000000, v22
    v_exp_f32 v90, v90
    v_mul_f32 v92, s32, v91
    v_rndne_f32 v92, v92
    v_fma_f32 v92, v91, s32, -v92
    v_fma_f32 v92, v91, s33, v92
    v_cos_f32 v91, v92
    v_sin_f32 v92, v92
    v_mul_f32 v44, v90, v91
    v_mul_f32 v46, v90, v92
    v_mul_f32 v90, 0x43000000, v21
    v_mul_f32 v91, 0x43000000, v23
    v_exp_f32 v90, v90
    v_mul_f32 v92, s32, v91
    v_rndne_f32 v92, v92
    v_fma_f32 v92, v91, s32, -v92
    v_fma_f32 v92, v91, s33, v92
    v_cos_f32 v91, v92
    v_sin_f32 v92, v92
    v_mul_f32 v45, v90, v91
    v_mul_f32 v47, v90, v92
    v_mul_f32 v90, 0x44800000, v20
    v_mul_f32 v91, 0x44800000, v22
    v_exp_f32 v90, v90
    v_mul_f32 v92, s32, v91
    v_rndne_f32 v92, v92
    v_fma_f32 v92, v91, s32, -v92
    v_fma_f32 v92, v91, s33, v92
    v_cos_f32 v91, v92
    v_sin_f32 v92, v92
    v_mul_f32 v48, v90, v91
    v_mul_f32 v50, v90, v92
    v_mul_f32 v90, 0x44800000, v21
    v_mul_f32 v91, 0x44800000, v23
    v_exp_f32 v90, v90
    v_mul_f32 v92, s32, v91
    v_rndne_f32 v92, v92
    v_fma_f32 v92, v91, s32, -v92
    v_fma_f32 v92, v91, s33, v92
    v_cos_f32 v91, v92
    v_sin_f32 v92, v92
    v_mul_f32 v49, v90, v91
    v_mul_f32 v51, v90, v92
    v_pk_mul_f32 v[90:91], v[34:35], v[50:51]
    v_pk_mul_f32 v[92:93], v[34:35], v[48:49]
    v_pk_fma_f32 v[54:55], v[32:33], v[50:51], v[92:93]
    v_pk_fma_f32 v[52:53], v[32:33], v[48:49], v[90:91] neg_lo:[0,0,1] neg_hi:[0,0,1]
    v_cvt_pk_f16_f32 v94, v52, v54
    v_cvt_pk_f16_f32 v95, v53, v55
    ds_write_b64 v4, v[94:95] offset:0
    v_pk_mul_f32 v[90:91], v[54:55], v[46:47]
    v_pk_mul_f32 v[92:93], v[54:55], v[44:45]
    v_pk_fma_f32 v[58:59], v[52:53], v[46:47], v[92:93]
    v_pk_fma_f32 v[56:57], v[52:53], v[44:45], v[90:91] neg_lo:[0,0,1] neg_hi:[0,0,1]
    v_cvt_pk_f16_f32 v94, v56, v58
    v_cvt_pk_f16_f32 v95, v57, v59
    ds_write_b64 v4, v[94:95] offset:544
    v_pk_mul_f32 v[90:91], v[58:59], v[46:47]
    v_pk_mul_f32 v[92:93], v[58:59], v[44:45]
    v_pk_fma_f32 v[54:55], v[56:57], v[46:47], v[92:93]
    v_pk_fma_f32 v[52:53], v[56:57], v[44:45], v[90:91] neg_lo:[0,0,1] neg_hi:[0,0,1]
    v_cvt_pk_f16_f32 v94, v52, v54
    v_cvt_pk_f16_f32 v95, v53, v55
    ds_write_b64 v4, v[94:95] offset:1088
    v_pk_mul_f32 v[90:91], v[54:55], v[46:47]
    v_pk_mul_f32 v[92:93], v[54:55], v[44:45]
    v_pk_fma_f32 v[58:59], v[52:53], v[46:47], v[92:93]
    v_pk_fma_f32 v[56:57], v[52:53], v[44:45], v[90:91] neg_lo:[0,0,1] neg_hi:[0,0,1]
    v_cvt_pk_f16_f32 v94, v56, v58
    v_cvt_pk_f16_f32 v95, v57, v59
    ds_write_b64 v4, v[94:95] offset:1632
    v_pk_mul_f32 v[90:91], v[58:59], v[46:47]
    v_pk_mul_f32 v[92:93], v[58:59], v[44:45]
    v_pk_fma_f32 v[54:55], v[56:57], v[46:47], v[92:93]
    v_pk_fma_f32 v[52:53], v[56:57], v[44:45], v[90:91] neg_lo:[0,0,1] neg_hi:[0,0,1]
    v_cvt_pk_f16_f32 v94, v52, v54
    v_cvt_pk_f16_f32 v95, v53, v55
    ds_write_b64 v4, v[94:95] offset:2176
    v_pk_mul_f32 v[90:91], v[54:55], v[46:47]
    v_pk_mul_f32 v[92:93], v[54:55], v[44:45]
    v_pk_fma_f32 v[58:59], v[52:53], v[46:47], v[92:93]
    v_pk_fma_f32 v[56:57], v[52:53], v[44:45], v[90:91] neg_lo:[0,0,1] neg_hi:[0,0,1]
    v_cvt_pk_f16_f32 v94, v56, v58
    v_cvt_pk_f16_f32 v95, v57, v59
    ds_write_b64 v4, v[94:95] offset:2720
    v_pk_mul_f32 v[90:91], v[58:59], v[46:47]
    v_pk_mul_f32 v[92:93], v[58:59], v[44:45]
    v_pk_fma_f32 v[54:55], v[56:57], v[46:47], v[92:93]
    v_pk_fma_f32 v[52:53], v[56:57], v[44:45], v[90:91] neg_lo:[0,0,1] neg_hi:[0,0,1]
    v_cvt_pk_f16_f32 v94, v52, v54
    v_cvt_pk_f16_f32 v95, v53, v55
    ds_write_b64 v4, v[94:95] offset:3264
    v_pk_mul_f32 v[90:91], v[54:55], v[46:47]
    v_pk_mul_f32 v[92:93], v[54:55], v[44:45]
    v_pk_fma_f32 v[58:59], v[52:53], v[46:47], v[92:93]
    v_pk_fma_f32 v[56:57], v[52:53], v[44:45], v[90:91] neg_lo:[0,0,1] neg_hi:[0,0,1]
    v_cvt_pk_f16_f32 v94, v56, v58
    v_cvt_pk_f16_f32 v95, v57, v59
    ds_write_b64 v4, v[94:95] offset:3808
    v_pk_mul_f32 v[90:91], v[58:59], v[46:47]
    v_pk_mul_f32 v[92:93], v[58:59], v[44:45]
    v_pk_fma_f32 v[54:55], v[56:57], v[46:47], v[92:93]
    v_pk_fma_f32 v[52:53], v[56:57], v[44:45], v[90:91] neg_lo:[0,0,1] neg_hi:[0,0,1]
    v_cvt_pk_f16_f32 v94, v52, v54
    v_cvt_pk_f16_f32 v95, v53, v55
    ds_write_b64 v4, v[94:95] offset:4352
    v_lshl_add_u32 v7, v6, 9, v7
    v_add_u32 v7, 0x400, v7
    v_mov_b32 v8, 0x80
    v_mov_b32 v9, 0x100
    s_branch K1_JOIN
K1_J3:
    v_mul_f32 v90, 0x41000000, v20
    v_mul_f32 v91, 0x41000000, v22
    v_exp_f32 v90, v90
    v_mul_f32 v92, s32, v91
    v_rndne_f32 v92, v92
    v_fma_f32 v92, v91, s32, -v92
    v_fma_f32 v92, v91, s33, v92
    v_cos_f32 v91, v92
    v_sin_f32 v92, v92
    v_mul_f32 v40, v90, v91
    v_mul_f32 v42, v90, -v92
    v_mul_f32 v90, 0x41000000, v21
    v_mul_f32 v91, 0x41000000, v23
    v_exp_f32 v90, v90
    v_mul_f32 v92, s32, v91
    v_rndne_f32 v92, v92
    v_fma_f32 v92, v91, s32, -v92
    v_fma_f32 v92, v91, s33, v92
    v_cos_f32 v91, v92
    v_sin_f32 v92, v92
    v_mul_f32 v41, v90, v91
    v_mul_f32 v43, v90, -v92
    v_mov_b32 v52, 0x47000000
    v_mov_b32 v53, 0x47000000
    v_mov_b32 v54, 0
    v_mov_b32 v55, 0
    v_cvt_pk_f16_f32 v94, v52, v54
    v_cvt_pk_f16_f32 v95, v53, v55
    ds_write_b64 v4, v[94:95] offset:0
    v_pk_mul_f32 v[90:91], v[54:55], v[42:43]
    v_pk_mul_f32 v[92:93], v[54:55], v[40:41]
    v_pk_fma_f32 v[58:59], v[52:53], v[42:43], v[92:93]
    v_pk_fma_f32 v[56:57], v[52:53], v[40:41], v[90:91] neg_lo:[0,0,1] neg_hi:[0,0,1]
    v_cvt_pk_f16_f32 v94, v56, v58
    v_cvt_pk_f16_f32 v95, v57, v59
    ds_write_b64 v4, v[94:95] offset:544
    v_pk_mul_f32 v[90:91], v[58:59], v[42:43]
    v_pk_mul_f32 v[92:93], v[58:59], v[40:41]
    v_pk_fma_f32 v[54:55], v[56:57], v[42:43], v[92:93]
    v_pk_fma_f32 v[52:53], v[56:57], v[40:41], v[90:91] neg_lo:[0,0,1] neg_hi:[0,0,1]
    v_cvt_pk_f16_f32 v94, v52, v54
    v_cvt_pk_f16_f32 v95, v53, v55
    ds_write_b64 v4, v[94:95] offset:1088
    v_pk_mul_f32 v[90:91], v[54:55], v[42:43]
    v_pk_mul_f32 v[92:93], v[54:55], v[40:41]
    v_pk_fma_f32 v[58:59], v[52:53], v[42:43], v[92:93]
    v_pk_fma_f32 v[56:57], v[52:53], v[40:41], v[90:91] neg_lo:[0,0,1] neg_hi:[0,0,1]
    v_cvt_pk_f16_f32 v94, v56, v58
    v_cvt_pk_f16_f32 v95, v57, v59
    ds_write_b64 v4, v[94:95] offset:1632
    v_pk_mul_f32 v[90:91], v[58:59], v[42:43]
    v_pk_mul_f32 v[92:93], v[58:59], v[40:41]
    v_pk_fma_f32 v[54:55], v[56:57], v[42:43], v[92:93]
    v_pk_fma_f32 v[52:53], v[56:57], v[40:41], v[90:91] neg_lo:[0,0,1] neg_hi:[0,0,1]
    v_cvt_pk_f16_f32 v94, v52, v54
    v_cvt_pk_f16_f32 v95, v53, v55
    ds_write_b64 v4, v[94:95] offset:2176
    v_pk_mul_f32 v[90:91], v[54:55], v[42:43]
    v_pk_mul_f32 v[92:93], v[54:55], v[40:41]
    v_pk_fma_f32 v[58:59], v[52:53], v[42:43], v[92:93]
    v_pk_fma_f32 v[56:57], v[52:53], v[40:41], v[90:91] neg_lo:[0,0,1] neg_hi:[0,0,1]
    v_cvt_pk_f16_f32 v94, v56, v58
    v_cvt_pk_f16_f32 v95, v57, v59
    ds_write_b64 v4, v[94:95] offset:2720
    v_pk_mul_f32 v[90:91], v[58:59], v[42:43]
    v_pk_mul_f32 v[92:93], v[58:59], v[40:41]
    v_pk_fma_f32 v[54:55], v[56:57], v[42:43], v[92:93]
    v_pk_fma_f32 v[52:53], v[56:57], v[40:41], v[90:91] neg_lo:[0,0,1] neg_hi:[0,0,1]
    v_cvt_pk_f16_f32 v94, v52, v54
    v_cvt_pk_f16_f32 v95, v53, v55
    ds_write_b64 v4, v[94:95] offset:3264
    v_pk_mul_f32 v[90:91], v[54:55], v[42:43]
    v_pk_mul_f32 v[92:93], v[54:55], v[40:41]
    v_pk_fma_f32 v[58:59], v[52:53], v[42:43], v[92:93]
    v_pk_fma_f32 v[56:57], v[52:53], v[40:41], v[90:91] neg_lo:[0,0,1] neg_hi:[0,0,1]
    v_cvt_pk_f16_f32 v94, v56, v58
    v_cvt_pk_f16_f32 v95, v57, v59
    ds_write_b64 v4, v[94:95] offset:3808
    v_pk_mul_f32 v[90:91], v[58:59], v[42:43]
    v_pk_mul_f32 v[92:93], v[58:59], v[40:41]
    v_pk_fma_f32 v[54:55], v[56:57], v[42:43], v[92:93]
    v_pk_fma_f32 v[52:53], v[56:57], v[40:41], v[90:91] neg_lo:[0,0,1] neg_hi:[0,0,1]
    v_cvt_pk_f16_f32 v94, v52, v54
    v_cvt_pk_f16_f32 v95, v53, v55
    ds_write_b64 v4, v[94:95] offset:4352
    v_pk_mul_f32 v[90:91], v[54:55], v[42:43]
    v_pk_mul_f32 v[92:93], v[54:55], v[40:41]
    v_pk_fma_f32 v[58:59], v[52:53], v[42:43], v[92:93]
    v_pk_fma_f32 v[56:57], v[52:53], v[40:41], v[90:91] neg_lo:[0,0,1] neg_hi:[0,0,1]
    v_cvt_pk_f16_f32 v94, v56, v58
    v_cvt_pk_f16_f32 v95, v57, v59
    ds_write_b64 v4, v[94:95] offset:4896
    v_pk_mul_f32 v[90:91], v[58:59], v[42:43]
    v_pk_mul_f32 v[92:93], v[58:59], v[40:41]
    v_pk_fma_f32 v[54:55], v[56:57], v[42:43], v[92:93]
    v_pk_fma_f32 v[52:53], v[56:57], v[40:41], v[90:91] neg_lo:[0,0,1] neg_hi:[0,0,1]
    v_cvt_pk_f16_f32 v94, v52, v54
    v_cvt_pk_f16_f32 v95, v53, v55
    ds_write_b64 v4, v[94:95] offset:5440
    v_pk_mul_f32 v[90:91], v[54:55], v[42:43]
    v_pk_mul_f32 v[92:93], v[54:55], v[40:41]
    v_pk_fma_f32 v[58:59], v[52:53], v[42:43], v[92:93]
    v_pk_fma_f32 v[56:57], v[52:53], v[40:41], v[90:91] neg_lo:[0,0,1] neg_hi:[0,0,1]
    v_cvt_pk_f16_f32 v94, v56, v58
    v_cvt_pk_f16_f32 v95, v57, v59
    ds_write_b64 v4, v[94:95] offset:5984
    v_pk_mul_f32 v[90:91], v[58:59], v[42:43]
    v_pk_mul_f32 v[92:93], v[58:59], v[40:41]
    v_pk_fma_f32 v[54:55], v[56:57], v[42:43], v[92:93]
    v_pk_fma_f32 v[52:53], v[56:57], v[40:41], v[90:91] neg_lo:[0,0,1] neg_hi:[0,0,1]
    v_cvt_pk_f16_f32 v94, v52, v54
    v_cvt_pk_f16_f32 v95, v53, v55
    ds_write_b64 v4, v[94:95] offset:6528
    v_pk_mul_f32 v[90:91], v[54:55], v[42:43]
    v_pk_mul_f32 v[92:93], v[54:55], v[40:41]
    v_pk_fma_f32 v[58:59], v[52:53], v[42:43], v[92:93]
    v_pk_fma_f32 v[56:57], v[52:53], v[40:41], v[90:91] neg_lo:[0,0,1] neg_hi:[0,0,1]
    v_cvt_pk_f16_f32 v94, v56, v58
    v_cvt_pk_f16_f32 v95, v57, v59
    ds_write_b64 v4, v[94:95] offset:7072
    v_pk_mul_f32 v[90:91], v[58:59], v[42:43]
    v_pk_mul_f32 v[92:93], v[58:59], v[40:41]
    v_pk_fma_f32 v[54:55], v[56:57], v[42:43], v[92:93]
    v_pk_fma_f32 v[52:53], v[56:57], v[40:41], v[90:91] neg_lo:[0,0,1] neg_hi:[0,0,1]
    v_cvt_pk_f16_f32 v94, v52, v54
    v_cvt_pk_f16_f32 v95, v53, v55
    ds_write_b64 v4, v[94:95] offset:7616
    v_pk_mul_f32 v[90:91], v[54:55], v[42:43]
    v_pk_mul_f32 v[92:93], v[54:55], v[40:41]
    v_pk_fma_f32 v[58:59], v[52:53], v[42:43], v[92:93]
    v_pk_fma_f32 v[56:57], v[52:53], v[40:41], v[90:91] neg_lo:[0,0,1] neg_hi:[0,0,1]
    v_cvt_pk_f16_f32 v94, v56, v58
    v_cvt_pk_f16_f32 v95, v57, v59
    ds_write_b64 v4, v[94:95] offset:8160
    v_mul_f32 v40, 0x45000000, v36
    v_max_f32 v40, 0, v40
    v_exp_f32 v40, v40
    v_mul_f32 v41, 0x38000000, v37
    v_mul_f32 v40, v40, v41
    s_lshl_b32 s4, s3, 2
    v_mov_b32 v41, s4
    s_mul_i32 s4, s3, 4112
    s_add_u32 s4, s4, 4096
    v_mov_b32 v42, s4
    v_mov_b32 v44, 0
    v_mov_b32 v45, 0
    v_mov_b32 v46, 0
    v_mov_b32 v47, 0
    s_mov_b64 s[34:35], exec
    s_mov_b64 exec, 1
    buffer_store_dword v40, v41, s[12:15], 0 offen
    buffer_store_dwordx4 v[44:47], v42, s[8:11], 0 offen
    s_mov_b64 exec, s[34:35]
K1_JOIN:
    s_nop 3
    s_waitcnt lgkmcnt(0)
    s_barrier
    s_cmp_eq_u32 s5, 3
    s_cbranch_scc1 K1_EXPAND
    v_mul_u32_u24 v10, 544, v5
    v_lshl_add_u32 v10, v6, 4, v10
    s_mul_i32 s4, s5, 8704
    v_add_u32 v11, s4, v10
    ds_read_b128 v[40:43], v11 offset:0
    ds_read_b128 v[72:75], v10 offset:26112
    ds_read_b128 v[44:47], v11 offset:64
    ds_read_b128 v[76:79], v10 offset:26176
    ds_read_b128 v[48:51], v11 offset:128
    ds_read_b128 v[80:83], v10 offset:26240
    ds_read_b128 v[52:55], v11 offset:192
    ds_read_b128 v[84:87], v10 offset:26304
    ds_read_b128 v[56:59], v11 offset:256
    ds_read_b128 v[60:63], v11 offset:320
    ds_read_b128 v[64:67], v11 offset:384
    ds_read_b128 v[68:71], v11 offset:448
    v_mov_b32 v12, 0
    v_mov_b32 v13, 0
    v_mov_b32 v14, 0
    v_mov_b32 v15, 0
    ds_read_b128 v[20:23], v10 offset:26368
    ds_read_b128 v[24:27], v10 offset:26432
    ds_read_b128 v[28:31], v10 offset:26496
    ds_read_b128 v[32:35], v10 offset:26560
    s_waitcnt lgkmcnt(0)
    v_mfma_f32_16x16x32_f16 v[12:15], v[40:43], v[72:75], v[12:15]
    v_mfma_f32_16x16x32_f16 v[12:15], v[44:47], v[76:79], v[12:15]
    v_mfma_f32_16x16x32_f16 v[12:15], v[48:51], v[80:83], v[12:15]
    v_mfma_f32_16x16x32_f16 v[12:15], v[52:55], v[84:87], v[12:15]
    v_mfma_f32_16x16x32_f16 v[12:15], v[56:59], v[20:23], v[12:15]
    v_mfma_f32_16x16x32_f16 v[12:15], v[60:63], v[24:27], v[12:15]
    v_mfma_f32_16x16x32_f16 v[12:15], v[64:67], v[28:31], v[12:15]
    v_mfma_f32_16x16x32_f16 v[12:15], v[68:71], v[32:35], v[12:15]
    v_mul_f32 v40, 0x45000000, v36
    v_max_f32 v40, 0, v40
    v_add_f32 v40, 0x41700000, v40
    v_mov_b32 v41, v7
    v_add_u32 v42, v7, v8
    v_add_u32 v43, v7, v9
    v_add_u32 v44, v42, v9
    v_cvt_f32_u32 v45, v41
    v_fma_f32 v46, v45, v36, -v40
    v_exp_f32 v46, v46
    v_lshrrev_b32 v45, 16, v45
    v_subrev_u32 v45, 0x4280, v45
    v_cmp_gt_u32 vcc, 128, v41
    s_nop 1
    v_cndmask_b32 v45, v45, v41, vcc
    v_cmp_lt_u32 vcc, 0x800, v41
    v_mov_b32 v47, 0x2f0
    s_nop 0
    v_cndmask_b32 v45, v45, v47, vcc
    v_mul_f32 v46, v46, v12
    v_cvt_f16_f32 v46, v46
    v_lshlrev_b32 v45, 1, v45
    ds_write_b16 v45, v46 offset:34816
    v_cvt_f32_u32 v45, v42
    v_fma_f32 v46, v45, v36, -v40
    v_exp_f32 v46, v46
    v_lshrrev_b32 v45, 16, v45
    v_subrev_u32 v45, 0x4280, v45
    v_cmp_gt_u32 vcc, 128, v42
    s_nop 1
    v_cndmask_b32 v45, v45, v42, vcc
    v_cmp_lt_u32 vcc, 0x800, v42
    v_mov_b32 v47, 0x2f0
    s_nop 0
    v_cndmask_b32 v45, v45, v47, vcc
    v_mul_f32 v46, v46, v13
    v_cvt_f16_f32 v46, v46
    v_lshlrev_b32 v45, 1, v45
    ds_write_b16 v45, v46 offset:34816
    v_cvt_f32_u32 v45, v43
    v_fma_f32 v46, v45, v36, -v40
    v_exp_f32 v46, v46
    v_lshrrev_b32 v45, 16, v45
    v_subrev_u32 v45, 0x4280, v45
    v_cmp_gt_u32 vcc, 128, v43
    s_nop 1
    v_cndmask_b32 v45, v45, v43, vcc
    v_cmp_lt_u32 vcc, 0x800, v43
    v_mov_b32 v47, 0x2f0
    s_nop 0
    v_cndmask_b32 v45, v45, v47, vcc
    v_mul_f32 v46, v46, v14
    v_cvt_f16_f32 v46, v46
    v_lshlrev_b32 v45, 1, v45
    ds_write_b16 v45, v46 offset:34816
    v_cvt_f32_u32 v45, v44
    v_fma_f32 v46, v45, v36, -v40
    v_exp_f32 v46, v46
    v_lshrrev_b32 v45, 16, v45
    v_subrev_u32 v45, 0x4280, v45
    v_cmp_gt_u32 vcc, 128, v44
    s_nop 1
    v_cndmask_b32 v45, v45, v44, vcc
    v_cmp_lt_u32 vcc, 0x800, v44
    v_mov_b32 v47, 0x2f0
    s_nop 0
    v_cndmask_b32 v45, v45, v47, vcc
    v_mul_f32 v46, v46, v15
    v_cvt_f16_f32 v46, v46
    v_lshlrev_b32 v45, 1, v45
    ds_write_b16 v45, v46 offset:34816
K1_EXPAND:
    s_nop 3
    s_waitcnt lgkmcnt(0)
    s_barrier
    ds_read_u16 v48, v100 offset:34816
    ds_read_u16 v49, v101 offset:34816
    ds_read_u16 v50, v102 offset:34816
    ds_read_u16 v51, v103 offset:34816
    ds_read_u16 v52, v104 offset:34816
    ds_read_u16 v53, v105 offset:34816
    ds_read_u16 v54, v106 offset:34816
    ds_read_u16 v55, v107 offset:34816
    s_mul_i32 s4, s3, 4112
    v_lshlrev_b32 v44, 4, v0
    s_waitcnt lgkmcnt(0)
    v_lshl_or_b32 v40, v49, 16, v48
    v_lshl_or_b32 v41, v51, 16, v50
    v_lshl_or_b32 v42, v53, 16, v52
    v_lshl_or_b32 v43, v55, 16, v54
    buffer_store_dwordx4 v[40:43], v44, s[8:11], s4 offen
K1_END:
    s_endpgm
.globl k2_kernel
.p2align 8
.type k2_kernel,@function
k2_kernel:
    s_cmp_ge_u32 s2, 576
    s_cbranch_scc1 K2_END
    s_load_dwordx2 s[6:7], s[0:1], 128
    s_load_dwordx2 s[4:5], s[0:1], 64
    s_load_dwordx4 s[32:35], s[0:1], 88
    s_load_dwordx2 s[36:37], s[0:1], 104
    s_and_b32 s16, s2, 7
    s_mul_i32 s16, s16, 72
    s_lshr_b32 s3, s2, 3
    s_add_u32 s3, s3, s16
    v_readfirstlane_b32 s17, v0
    s_lshr_b32 s17, s17, 6
    v_lshlrev_b32 v2, 4, v0
    s_lshl_b32 s18, s3, 12
    s_mul_i32 s19, s3, 4112
    s_waitcnt lgkmcnt(0)
    s_mov_b32 s8, s6
    s_mov_b32 s9, s7
    s_mov_b32 s10, 0x240000
    s_mov_b32 s11, 0x20000
    s_add_u32 s12, s6, 0x300000
    s_addc_u32 s13, s7, 0
    s_mov_b32 s14, 0x242400
    s_mov_b32 s15, 0x20000
    buffer_load_dwordx4 v[4:7], v2, s[12:15], s19 offen
    buffer_load_dwordx2 v[8:9], v2, s[12:15], s19 offen offset:16
    buffer_load_dwordx4 v[12:15], v2, s[8:11], s18 offen
    s_lshl_b32 s20, s3, 2
    s_add_u32 s20, s20, 0xc10000
    s_add_u32 s20, s6, s20
    s_addc_u32 s21, s7, 0
    s_load_dword s24, s[20:21], 0
    s_lshr_b32 s20, s3, 1
    s_lshl_b32 s20, s20, 2
    s_add_u32 s20, s4, s20
    s_addc_u32 s21, s5, 0
    s_load_dword s25, s[20:21], 0
    s_add_u32 s28, s6, 0x600000
    s_addc_u32 s29, s7, 0
    s_mov_b32 s30, 0x240000
    s_mov_b32 s31, 0x20000
    v_mov_b32 v16, 0
    v_mov_b32 v17, 0
    v_mov_b32 v18, 0
    v_mov_b32 v19, 0
    v_lshrrev_b32 v3, 5, v0
    v_and_b32 v10, 31, v0
    v_mul_u32_u24 v11, 4640, v3
    v_lshl_add_u32 v11, v10, 4, v11
    v_add_u32 v11, 4096, v11
    v_cmp_gt_u32 vcc, 4, v3
    v_cmp_gt_u32 s[22:23], 24, v10
    s_and_b64 vcc, vcc, s[22:23]
    s_and_saveexec_b64 s[22:23], vcc
    ds_write_b128 v11, v[16:19]
    s_mov_b64 exec, s[22:23]
    v_cmp_gt_u32 vcc, 8, v0
    s_and_saveexec_b64 s[22:23], vcc
    ds_write_b128 v2, v[16:19] offset:18560
    s_mov_b64 exec, s[22:23]
    v_and_b32 v3, 63, v0
    v_and_b32 v10, 15, v3
    v_lshrrev_b32 v11, 4, v3
    v_and_b32 v16, 3, v10
    v_mul_u32_u24 v16, 4640, v16
    v_lshrrev_b32 v17, 2, v10
    v_lshlrev_b32 v17, 7, v17
    v_sub_u32 v16, v16, v17
    v_lshl_add_u32 v16, v11, 4, v16
    s_lshl_b32 s20, s17, 7
    s_sub_u32 s20, 384, s20
    s_add_u32 s21, s20, 384
    v_add_u32 v16, s21, v16
    v_lshlrev_b32 v17, 3, v10
    v_lshl_add_u32 v17, v11, 4, v17
    s_add_u32 s21, s20, 18568
    v_add_u32 v17, s21, v17
    s_waitcnt vmcnt(1)
    v_alignbit_b32 v20, v5, v4, 16
    v_alignbit_b32 v21, v6, v5, 16
    v_alignbit_b32 v22, v7, v6, 16
    v_alignbit_b32 v23, v8, v7, 16
    v_alignbit_b32 v24, v9, v8, 16
    ds_write_b128 v2, v[4:7] offset:13920
    ds_write_b128 v2, v[20:23] offset:9280
    v_mov_b32 v26, v5
    v_mov_b32 v27, v6
    v_mov_b32 v28, v7
    v_mov_b32 v29, v8
    v_mov_b32 v30, v21
    v_mov_b32 v31, v22
    v_mov_b32 v32, v23
    v_mov_b32 v33, v24
    ds_write_b128 v2, v[26:29] offset:4640
    ds_write_b128 v2, v[30:33] offset:0
    s_waitcnt vmcnt(0)
    ds_write_b128 v2, v[12:15] offset:18688
    v_mul_u32_u24 v4, 3641, v0
    v_lshrrev_b32 v4, 16, v4
    v_mul_u32_u24 v5, 18, v4
    v_sub_u32 v5, v0, v5
    v_mul_u32_u24 v4, 9216, v4
    v_lshl_add_u32 v4, v5, 6, v4
    s_and_b32 s20, s2, 7
    s_lshr_b32 s21, s2, 3
    s_mul_i32 s22, s21, 73728
    s_mul_i32 s23, s20, 1152
    s_add_u32 s22, s22, s23
    v_add_u32 v4, s22, v4
    s_mul_i32 s22, s20, 663552
    s_mul_i32 s23, s21, 9216
    s_add_u32 s22, s22, s23
    v_lshl_add_u32 v5, v0, 6, s22
    v_cmp_gt_u32 vcc, 144, v0
    s_and_saveexec_b64 s[22:23], vcc
    s_cbranch_execz K2_NOPF
    global_load_dword v148, v4, s[32:33]
    global_load_dword v149, v4, s[34:35]
    global_load_dword v150, v5, s[36:37]
K2_NOPF:
    s_mov_b64 exec, s[22:23]
    s_waitcnt lgkmcnt(0)
    s_barrier
    v_mov_b32 v20, 0
    v_mov_b32 v21, 0
    v_mov_b32 v22, 0
    v_mov_b32 v23, 0
    v_mov_b32 v24, 0
    v_mov_b32 v25, 0
    v_mov_b32 v26, 0
    v_mov_b32 v27, 0
    v_mov_b32 v28, 0
    v_mov_b32 v29, 0
    v_mov_b32 v30, 0
    v_mov_b32 v31, 0
    v_mov_b32 v32, 0
    v_mov_b32 v33, 0
    v_mov_b32 v34, 0
    v_mov_b32 v35, 0
    v_mov_b32 v36, 0
    v_mov_b32 v37, 0
    v_mov_b32 v38, 0
    v_mov_b32 v39, 0
    v_mov_b32 v40, 0
    v_mov_b32 v41, 0
    v_mov_b32 v42, 0
    v_mov_b32 v43, 0
    v_mov_b32 v44, 0
    v_mov_b32 v45, 0
    v_mov_b32 v46, 0
    v_mov_b32 v47, 0
    v_mov_b32 v48, 0
    v_mov_b32 v49, 0
    v_mov_b32 v50, 0
    v_mov_b32 v51, 0
    ds_read_b128 v[80:83], v16 offset:64
    ds_read_b64 v[84:85], v17 offset:64
    ds_read_b64 v[86:87], v17 offset:72
    ds_read_b128 v[76:79], v16 offset:576
    ds_read_b64 v[88:89], v17 offset:576
    ds_read_b64 v[90:91], v17 offset:584
    ds_read_b128 v[72:75], v16 offset:1088
    ds_read_b64 v[92:93], v17 offset:1088
    ds_read_b64 v[94:95], v17 offset:1096
    ds_read_b128 v[68:71], v16 offset:1600
    ds_read_b64 v[96:97], v17 offset:1600
    ds_read_b64 v[98:99], v17 offset:1608
    s_waitcnt lgkmcnt(9)
    v_mfma_f32_16x16x32_f16 v[48:51], v[80:83], v[84:87], v[48:51]
    ds_read_b128 v[64:67], v16 offset:2112
    ds_read_b64 v[100:101], v17 offset:2112
    ds_read_b64 v[102:103], v17 offset:2120
    s_waitcnt lgkmcnt(9)
    v_mfma_f32_16x16x32_f16 v[44:47], v[76:79], v[84:87], v[44:47]
    ds_read_b128 v[60:63], v16 offset:2624
    ds_read_b64 v[104:105], v17 offset:2624
    ds_read_b64 v[106:107], v17 offset:2632
    v_mfma_f32_16x16x32_f16 v[48:51], v[76:79], v[88:91], v[48:51]
    s_waitcnt lgkmcnt(9)
    v_mfma_f32_16x16x32_f16 v[40:43], v[72:75], v[84:87], v[40:43]
    ds_read_b128 v[56:59], v16 offset:3136
    ds_read_b64 v[108:109], v17 offset:3136
    ds_read_b64 v[110:111], v17 offset:3144
    v_mfma_f32_16x16x32_f16 v[44:47], v[72:75], v[88:91], v[44:47]
    v_mfma_f32_16x16x32_f16 v[48:51], v[72:75], v[92:95], v[48:51]
    s_waitcnt lgkmcnt(9)
    v_mfma_f32_16x16x32_f16 v[36:39], v[68:71], v[84:87], v[36:39]
    ds_read_b128 v[52:55], v16 offset:3648
    ds_read_b64 v[112:113], v17 offset:3648
    ds_read_b64 v[114:115], v17 offset:3656
    v_mfma_f32_16x16x32_f16 v[40:43], v[68:71], v[88:91], v[40:43]
    v_mfma_f32_16x16x32_f16 v[44:47], v[68:71], v[92:95], v[44:47]
    v_mfma_f32_16x16x32_f16 v[48:51], v[68:71], v[96:99], v[48:51]
    s_waitcnt lgkmcnt(9)
    v_mfma_f32_16x16x32_f16 v[32:35], v[64:67], v[84:87], v[32:35]
    ds_read_b128 v[80:83], v16 offset:0
    ds_read_b64 v[116:117], v17 offset:0
    ds_read_b64 v[118:119], v17 offset:8
    v_mfma_f32_16x16x32_f16 v[36:39], v[64:67], v[88:91], v[36:39]
    v_mfma_f32_16x16x32_f16 v[40:43], v[64:67], v[92:95], v[40:43]
    v_mfma_f32_16x16x32_f16 v[44:47], v[64:67], v[96:99], v[44:47]
    v_mfma_f32_16x16x32_f16 v[48:51], v[64:67], v[100:103], v[48:51]
    s_waitcnt lgkmcnt(9)
    v_mfma_f32_16x16x32_f16 v[28:31], v[60:63], v[84:87], v[28:31]
    ds_read_b128 v[76:79], v16 offset:512
    ds_read_b64 v[120:121], v17 offset:512
    ds_read_b64 v[122:123], v17 offset:520
    v_mfma_f32_16x16x32_f16 v[32:35], v[60:63], v[88:91], v[32:35]
    v_mfma_f32_16x16x32_f16 v[36:39], v[60:63], v[92:95], v[36:39]
    v_mfma_f32_16x16x32_f16 v[40:43], v[60:63], v[96:99], v[40:43]
    v_mfma_f32_16x16x32_f16 v[44:47], v[60:63], v[100:103], v[44:47]
    v_mfma_f32_16x16x32_f16 v[48:51], v[60:63], v[104:107], v[48:51]
    s_waitcnt lgkmcnt(9)
    v_mfma_f32_16x16x32_f16 v[24:27], v[56:59], v[84:87], v[24:27]
    ds_read_b128 v[72:75], v16 offset:1024
    ds_read_b64 v[124:125], v17 offset:1024
    ds_read_b64 v[126:127], v17 offset:1032
    v_mfma_f32_16x16x32_f16 v[28:31], v[56:59], v[88:91], v[28:31]
    v_mfma_f32_16x16x32_f16 v[32:35], v[56:59], v[92:95], v[32:35]
    v_mfma_f32_16x16x32_f16 v[36:39], v[56:59], v[96:99], v[36:39]
    v_mfma_f32_16x16x32_f16 v[40:43], v[56:59], v[100:103], v[40:43]
    v_mfma_f32_16x16x32_f16 v[44:47], v[56:59], v[104:107], v[44:47]
    v_mfma_f32_16x16x32_f16 v[48:51], v[56:59], v[108:111], v[48:51]
    s_waitcnt lgkmcnt(9)
    v_mfma_f32_16x16x32_f16 v[20:23], v[52:55], v[84:87], v[20:23]
    ds_read_b128 v[68:71], v16 offset:1536
    ds_read_b64 v[128:129], v17 offset:1536
    ds_read_b64 v[130:131], v17 offset:1544
    v_mfma_f32_16x16x32_f16 v[24:27], v[52:55], v[88:91], v[24:27]
    v_mfma_f32_16x16x32_f16 v[28:31], v[52:55], v[92:95], v[28:31]
    v_mfma_f32_16x16x32_f16 v[32:35], v[52:55], v[96:99], v[32:35]
    v_mfma_f32_16x16x32_f16 v[36:39], v[52:55], v[100:103], v[36:39]
    v_mfma_f32_16x16x32_f16 v[40:43], v[52:55], v[104:107], v[40:43]
    v_mfma_f32_16x16x32_f16 v[44:47], v[52:55], v[108:111], v[44:47]
    v_mfma_f32_16x16x32_f16 v[48:51], v[52:55], v[112:115], v[48:51]
    s_waitcnt lgkmcnt(9)
    v_mfma_f32_16x16x32_f16 v[48:51], v[80:83], v[116:119], v[48:51]
    ds_read_b128 v[64:67], v16 offset:2048
    ds_read_b64 v[132:133], v17 offset:2048
    ds_read_b64 v[134:135], v17 offset:2056
    s_waitcnt lgkmcnt(9)
    v_mfma_f32_16x16x32_f16 v[44:47], v[76:79], v[116:119], v[44:47]
    ds_read_b128 v[60:63], v16 offset:2560
    ds_read_b64 v[136:137], v17 offset:2560
    ds_read_b64 v[138:139], v17 offset:2568
    v_mfma_f32_16x16x32_f16 v[48:51], v[76:79], v[120:123], v[48:51]
    s_waitcnt lgkmcnt(9)
    v_mfma_f32_16x16x32_f16 v[40:43], v[72:75], v[116:119], v[40:43]
    ds_read_b128 v[56:59], v16 offset:3072
    ds_read_b64 v[140:141], v17 offset:3072
    ds_read_b64 v[142:143], v17 offset:3080
    v_mfma_f32_16x16x32_f16 v[44:47], v[72:75], v[120:123], v[44:47]
    v_mfma_f32_16x16x32_f16 v[48:51], v[72:75], v[124:127], v[48:51]
    s_waitcnt lgkmcnt(9)
    v_mfma_f32_16x16x32_f16 v[36:39], v[68:71], v[116:119], v[36:39]
    ds_read_b128 v[52:55], v16 offset:3584
    ds_read_b64 v[144:145], v17 offset:3584
    ds_read_b64 v[146:147], v17 offset:3592
    v_mfma_f32_16x16x32_f16 v[40:43], v[68:71], v[120:123], v[40:43]
    v_mfma_f32_16x16x32_f16 v[44:47], v[68:71], v[124:127], v[44:47]
    v_mfma_f32_16x16x32_f16 v[48:51], v[68:71], v[128:131], v[48:51]
    s_waitcnt lgkmcnt(9)
    v_mfma_f32_16x16x32_f16 v[32:35], v[64:67], v[116:119], v[32:35]
    v_mfma_f32_16x16x32_f16 v[36:39], v[64:67], v[120:123], v[36:39]
    v_mfma_f32_16x16x32_f16 v[40:43], v[64:67], v[124:127], v[40:43]
    v_mfma_f32_16x16x32_f16 v[44:47], v[64:67], v[128:131], v[44:47]
    v_mfma_f32_16x16x32_f16 v[48:51], v[64:67], v[132:135], v[48:51]
    s_waitcnt lgkmcnt(6)
    v_mfma_f32_16x16x32_f16 v[28:31], v[60:63], v[116:119], v[28:31]
    v_mfma_f32_16x16x32_f16 v[32:35], v[60:63], v[120:123], v[32:35]
    v_mfma_f32_16x16x32_f16 v[36:39], v[60:63], v[124:127], v[36:39]
    v_mfma_f32_16x16x32_f16 v[40:43], v[60:63], v[128:131], v[40:43]
    v_mfma_f32_16x16x32_f16 v[44:47], v[60:63], v[132:135], v[44:47]
    v_mfma_f32_16x16x32_f16 v[48:51], v[60:63], v[136:139], v[48:51]
    s_waitcnt lgkmcnt(3)
    v_mfma_f32_16x16x32_f16 v[24:27], v[56:59], v[116:119], v[24:27]
    v_mfma_f32_16x16x32_f16 v[28:31], v[56:59], v[120:123], v[28:31]
    v_mfma_f32_16x16x32_f16 v[32:35], v[56:59], v[124:127], v[32:35]
    v_mfma_f32_16x16x32_f16 v[36:39], v[56:59], v[128:131], v[36:39]
    v_mfma_f32_16x16x32_f16 v[40:43], v[56:59], v[132:135], v[40:43]
    v_mfma_f32_16x16x32_f16 v[44:47], v[56:59], v[136:139], v[44:47]
    v_mfma_f32_16x16x32_f16 v[48:51], v[56:59], v[140:143], v[48:51]
    s_waitcnt lgkmcnt(0)
    v_mfma_f32_16x16x32_f16 v[20:23], v[52:55], v[116:119], v[20:23]
    v_mfma_f32_16x16x32_f16 v[24:27], v[52:55], v[120:123], v[24:27]
    v_mfma_f32_16x16x32_f16 v[28:31], v[52:55], v[124:127], v[28:31]
    v_mfma_f32_16x16x32_f16 v[32:35], v[52:55], v[128:131], v[32:35]
    v_mfma_f32_16x16x32_f16 v[36:39], v[52:55], v[132:135], v[36:39]
    v_mfma_f32_16x16x32_f16 v[40:43], v[52:55], v[136:139], v[40:43]
    v_mfma_f32_16x16x32_f16 v[44:47], v[52:55], v[140:143], v[44:47]
    v_mfma_f32_16x16x32_f16 v[48:51], v[52:55], v[144:147], v[48:51]
    v_lshlrev_b32 v4, 4, v3
    s_nop 9
    s_cmp_eq_u32 s17, 0
    s_cbranch_scc0 K2_R0
    ds_write_b128 v4, v[28:31] offset:33024
    ds_write_b128 v4, v[32:35] offset:34048
    ds_write_b128 v4, v[36:39] offset:37120
    ds_write_b128 v4, v[40:43] offset:38144
    ds_write_b128 v4, v[44:47] offset:41216
    ds_write_b128 v4, v[48:51] offset:42240
    v_mov_b32 v52, v20
    v_mov_b32 v53, v21
    v_mov_b32 v54, v22
    v_mov_b32 v55, v23
    v_mov_b32 v56, v24
    v_mov_b32 v57, v25
    v_mov_b32 v58, v26
    v_mov_b32 v59, v27
K2_R0:
    s_cmp_eq_u32 s17, 1
    s_cbranch_scc0 K2_R1
    ds_write_b128 v4, v[20:23] offset:22784
    ds_write_b128 v4, v[24:27] offset:23808
    ds_write_b128 v4, v[36:39] offset:39168
    ds_write_b128 v4, v[40:43] offset:40192
    ds_write_b128 v4, v[44:47] offset:43264
    ds_write_b128 v4, v[48:51] offset:44288
    v_mov_b32 v52, v28
    v_mov_b32 v53, v29
    v_mov_b32 v54, v30
    v_mov_b32 v55, v31
    v_mov_b32 v56, v32
    v_mov_b32 v57, v33
    v_mov_b32 v58, v34
    v_mov_b32 v59, v35
K2_R1:
    s_cmp_eq_u32 s17, 2
    s_cbranch_scc0 K2_R2
    ds_write_b128 v4, v[20:23] offset:24832
    ds_write_b128 v4, v[24:27] offset:25856
    ds_write_b128 v4, v[28:31] offset:28928
    ds_write_b128 v4, v[32:35] offset:29952
    ds_write_b128 v4, v[44:47] offset:45312
    ds_write_b128 v4, v[48:51] offset:46336
    v_mov_b32 v52, v36
    v_mov_b32 v53, v37
    v_mov_b32 v54, v38
    v_mov_b32 v55, v39
    v_mov_b32 v56, v40
    v_mov_b32 v57, v41
    v_mov_b32 v58, v42
    v_mov_b32 v59, v43
K2_R2:
    s_cmp_eq_u32 s17, 3
    s_cbranch_scc0 K2_R3
    ds_write_b128 v4, v[20:23] offset:26880
    ds_write_b128 v4, v[24:27] offset:27904
    ds_write_b128 v4, v[28:31] offset:30976
    ds_write_b128 v4, v[32:35] offset:32000
    ds_write_b128 v4, v[36:39] offset:35072
    ds_write_b128 v4, v[40:43] offset:36096
    v_mov_b32 v52, v44
    v_mov_b32 v53, v45
    v_mov_b32 v54, v46
    v_mov_b32 v55, v47
    v_mov_b32 v56, v48
    v_mov_b32 v57, v49
    v_mov_b32 v58, v50
    v_mov_b32 v59, v51
K2_R3:
    s_nop 7
    s_waitcnt lgkmcnt(0)
    s_barrier
    s_mul_i32 s20, s17, 6144
    v_add_u32 v4, s20, v4
    ds_read_b128 v[60:63], v4 offset:22784
    ds_read_b128 v[64:67], v4 offset:23808
    ds_read_b128 v[68:71], v4 offset:24832
    ds_read_b128 v[72:75], v4 offset:25856
    ds_read_b128 v[76:79], v4 offset:26880
    ds_read_b128 v[80:83], v4 offset:27904
    s_lshl_b32 s20, s17, 10
    v_lshl_add_u32 v5, v3, 3, s20
    ds_read_b64 v[84:85], v5 offset:18688
    ds_read_b64 v[86:87], v5 offset:19200
    s_waitcnt lgkmcnt(0)
    s_lshl_b32 s26, s25, 16
    s_and_b32 s27, s25, 0xffff0000
    s_bitcmp1_b32 s3, 0
    s_cselect_b32 s25, s27, s26
    v_pk_add_f32 v[52:53], v[52:53], v[60:61]
    v_pk_add_f32 v[54:55], v[54:55], v[62:63]
    v_pk_add_f32 v[56:57], v[56:57], v[64:65]
    v_pk_add_f32 v[58:59], v[58:59], v[66:67]
    v_pk_add_f32 v[52:53], v[52:53], v[68:69]
    v_pk_add_f32 v[54:55], v[54:55], v[70:71]
    v_pk_add_f32 v[56:57], v[56:57], v[72:73]
    v_pk_add_f32 v[58:59], v[58:59], v[74:75]
    v_pk_add_f32 v[52:53], v[52:53], v[76:77]
    v_pk_add_f32 v[54:55], v[54:55], v[78:79]
    v_pk_add_f32 v[56:57], v[56:57], v[80:81]
    v_pk_add_f32 v[58:59], v[58:59], v[82:83]
    v_mul_f32 v52, s24, v52
    v_mul_f32 v53, s24, v53
    v_cvt_pk_bf16_f32 v6, v52, v53
    v_lshlrev_b32 v52, 16, v6
    v_and_b32 v53, 0xffff0000, v6
    v_cvt_f32_f16 v8, v84
    v_cvt_f32_f16_sdwa v9, v84 dst_sel:DWORD dst_unused:UNUSED_PAD src0_sel:WORD_1
    v_mul_f32 v8, s25, v8
    v_mul_f32 v9, s25, v9
    v_cvt_pk_bf16_f32 v6, v8, v9
    v_lshlrev_b32 v8, 16, v6
    v_and_b32 v9, 0xffff0000, v6
    v_pk_add_f32 v[8:9], v[8:9], v[52:53]
    v_cvt_pk_bf16_f32 v88, v8, v9
    v_mul_f32 v54, s24, v54
    v_mul_f32 v55, s24, v55
    v_cvt_pk_bf16_f32 v6, v54, v55
    v_lshlrev_b32 v54, 16, v6
    v_and_b32 v55, 0xffff0000, v6
    v_cvt_f32_f16 v8, v85
    v_cvt_f32_f16_sdwa v9, v85 dst_sel:DWORD dst_unused:UNUSED_PAD src0_sel:WORD_1
    v_mul_f32 v8, s25, v8
    v_mul_f32 v9, s25, v9
    v_cvt_pk_bf16_f32 v6, v8, v9
    v_lshlrev_b32 v8, 16, v6
    v_and_b32 v9, 0xffff0000, v6
    v_pk_add_f32 v[8:9], v[8:9], v[54:55]
    v_cvt_pk_bf16_f32 v89, v8, v9
    v_mul_f32 v56, s24, v56
    v_mul_f32 v57, s24, v57
    v_cvt_pk_bf16_f32 v6, v56, v57
    v_lshlrev_b32 v56, 16, v6
    v_and_b32 v57, 0xffff0000, v6
    v_cvt_f32_f16 v8, v86
    v_cvt_f32_f16_sdwa v9, v86 dst_sel:DWORD dst_unused:UNUSED_PAD src0_sel:WORD_1
    v_mul_f32 v8, s25, v8
    v_mul_f32 v9, s25, v9
    v_cvt_pk_bf16_f32 v6, v8, v9
    v_lshlrev_b32 v8, 16, v6
    v_and_b32 v9, 0xffff0000, v6
    v_pk_add_f32 v[8:9], v[8:9], v[56:57]
    v_cvt_pk_bf16_f32 v90, v8, v9
    v_mul_f32 v58, s24, v58
    v_mul_f32 v59, s24, v59
    v_cvt_pk_bf16_f32 v6, v58, v59
    v_lshlrev_b32 v58, 16, v6
    v_and_b32 v59, 0xffff0000, v6
    v_cvt_f32_f16 v8, v87
    v_cvt_f32_f16_sdwa v9, v87 dst_sel:DWORD dst_unused:UNUSED_PAD src0_sel:WORD_1
    v_mul_f32 v8, s25, v8
    v_mul_f32 v9, s25, v9
    v_cvt_pk_bf16_f32 v6, v8, v9
    v_lshlrev_b32 v8, 16, v6
    v_and_b32 v9, 0xffff0000, v6
    v_pk_add_f32 v[8:9], v[8:9], v[58:59]
    v_cvt_pk_bf16_f32 v91, v8, v9
    v_and_b32 v6, 1, v3
    v_cmp_eq_u32 vcc, 1, v6
    s_nop 1
    v_cndmask_b32 v8, v90, v88, vcc
    v_cndmask_b32 v9, v91, v89, vcc
    v_lshrrev_b32 v7, 1, v3
    v_lshl_add_u32 v7, v6, 5, v7
    v_mul_u32_u24 v7, 9216, v7
    v_mov_b32_dpp v10, v8 quad_perm:[1,0,3,2] row_mask:0xf bank_mask:0xf
    v_mov_b32_dpp v11, v9 quad_perm:[1,0,3,2] row_mask:0xf bank_mask:0xf
    s_mul_i32 s20, s17, 589824
    s_lshl_b32 s21, s3, 4
    s_add_u32 s20, s20, s21
    v_cndmask_b32 v88, v88, v10, vcc
    v_cndmask_b32 v89, v89, v11, vcc
    v_cndmask_b32 v90, v10, v90, vcc
    v_cndmask_b32 v91, v11, v91, vcc
    buffer_store_dwordx4 v[88:91], v7, s[28:31], s20 offen
K2_END:
    s_endpgm
.globl k3_kernel
.p2align 8
.type k3_kernel,@function
k3_kernel:
    s_cmp_ge_u32 s2, 256
    s_cbranch_scc1 KF_END
    v_readfirstlane_b32 s17, v0
    s_lshr_b32 s17, s17, 6
    s_cmp_lt_u32 s2, 144
    s_cselect_b32 s41, 16, 4
    s_cmp_ge_u32 s17, s41
    s_cbranch_scc1 KF_END
    s_load_dwordx2 s[34:35], s[0:1], 128
    s_load_dwordx4 s[4:7], s[0:1], 88
    s_load_dwordx4 s[64:67], s[0:1], 104
    s_load_dwordx2 s[30:31], s[0:1], 0
    s_load_dwordx2 s[32:33], s[0:1], 80
    s_and_b32 s16, s2, 7
    s_lshr_b32 s3, s2, 3
    s_mul_i32 s68, s16, 18
    s_add_u32 s68, s68, s3
    s_lshl_b32 s16, s16, 5
    s_add_u32 s16, s16, s3
    s_cmp_lt_u32 s2, 144
    s_cselect_b32 s69, 5308416, 0
    v_and_b32 v1, 63, v0
    v_and_b32 v2, 15, v1
    v_lshrrev_b32 v3, 4, v1
    s_mov_b32 s28, 0x05040100
    s_mov_b32 s29, 0x07060302
    s_mov_b32 s70, 262144
    s_cmp_ge_u32 s17, 10
    s_cbranch_scc1 KF_G
    s_cmp_ge_u32 s17, 4
    s_cbranch_scc1 KF_T
    s_setprio 3
    s_mul_i32 s3, s16, 9216
    v_lshrrev_b32 v113, 5, v0
    v_and_b32 v114, 31, v0
    v_mul_u32_u24 v115, 1152, v113
    v_lshl_add_u32 v115, v114, 2, v115
    v_lshlrev_b32 v6, 4, v0
    v_lshlrev_b32 v7, 2, v114
    s_lshl_b32 s18, s17, 2
    v_mov_b32 v116, s18
    v_mov_b32 v4, 0
    ds_write_b32 v116, v4 offset:1056
    ds_write_b32 v116, v4 offset:1072
    s_waitcnt lgkmcnt(0)
    s_mov_b32 s8, s30
    s_mov_b32 s9, s31
    s_mov_b32 s10, 0x240000
    s_mov_b32 s11, 0x20000
    s_add_u32 s12, s34, 0x600000
    s_addc_u32 s13, s35, 0
    s_mov_b32 s14, 0x240000
    s_mov_b32 s15, 0x20000
    s_mov_b32 s20, s32
    s_mov_b32 s21, s33
    s_mov_b32 s22, 0x480
    s_mov_b32 s23, 0x20000
    s_add_u32 s19, s3, 4096
    buffer_load_dwordx4 v[60:63], v6, s[12:15], s3 offen
    buffer_load_dwordx4 v[64:67], v6, s[12:15], s19 offen
    s_add_u32 s19, s3, 8192
    v_and_b32 v9, 0x3ff, v6
    buffer_load_dwordx4 v[68:71], v9, s[12:15], s19 offen
    buffer_load_dword v10, v115, s[8:11], s3 offen offset:0
    buffer_load_dword v11, v115, s[8:11], s3 offen offset:128
    buffer_load_dword v12, v115, s[8:11], s3 offen offset:256
    buffer_load_dword v13, v115, s[8:11], s3 offen offset:384
    buffer_load_dword v14, v115, s[8:11], s3 offen offset:512
    buffer_load_dword v15, v115, s[8:11], s3 offen offset:640
    buffer_load_dword v16, v115, s[8:11], s3 offen offset:768
    buffer_load_dword v17, v115, s[8:11], s3 offen offset:896
    buffer_load_dword v18, v115, s[8:11], s3 offen offset:1024
    buffer_load_dword v50, v7, s[20:23], 0 offen offset:0
    buffer_load_dword v51, v7, s[20:23], 0 offen offset:128
    buffer_load_dword v52, v7, s[20:23], 0 offen offset:256
    buffer_load_dword v53, v7, s[20:23], 0 offen offset:384
    buffer_load_dword v54, v7, s[20:23], 0 offen offset:512
    buffer_load_dword v55, v7, s[20:23], 0 offen offset:640
    buffer_load_dword v56, v7, s[20:23], 0 offen offset:768
    buffer_load_dword v57, v7, s[20:23], 0 offen offset:896
    buffer_load_dword v58, v7, s[20:23], 0 offen offset:1024
    s_barrier
    s_mov_b32 s72, s64
    s_mov_b32 s73, s65
    s_mov_b32 s74, s69
    s_mov_b32 s75, 0x20000
    v_mul_u32_u24 v112, 9216, v3
    v_lshl_add_u32 v112, v2, 3, v112
    s_mul_i32 s18, s68, 36864
    s_lshl_b32 s19, s17, 7
    s_add_u32 s18, s18, s19
    s_add_u32 s19, s18, 4608
    buffer_load_dwordx2 v[80:81], v112, s[72:75], s18 offen offset:0
    buffer_load_dwordx2 v[82:83], v112, s[72:75], s18 offen offset:1152
    buffer_load_dwordx2 v[84:85], v112, s[72:75], s18 offen offset:2304
    buffer_load_dwordx2 v[86:87], v112, s[72:75], s18 offen offset:3456
    buffer_load_dwordx2 v[88:89], v112, s[72:75], s19 offen offset:0
    buffer_load_dwordx2 v[90:91], v112, s[72:75], s19 offen offset:1152
    buffer_load_dwordx2 v[92:93], v112, s[72:75], s19 offen offset:2304
    buffer_load_dwordx2 v[94:95], v112, s[72:75], s19 offen offset:3456
    s_mov_b32 s24, s66
    s_mov_b32 s25, s67
    s_mov_b32 s26, 0x240000
    s_mov_b32 s27, 0x20000
    s_add_u32 s8, s34, 0x900000
    s_addc_u32 s9, s35, 0
    s_mov_b32 s10, 0x240000
    s_mov_b32 s11, 0x20000
    s_add_u32 s36, s34, 0xc00000
    s_addc_u32 s37, s35, 0
    s_mov_b32 s38, 0x3000
    s_mov_b32 s39, 0x20000
    s_mul_i32 s18, s17, 2304
    v_lshl_add_u32 v4, v114, 3, s18
    v_and_b32 v5, 1, v113
    v_mul_u32_u24 v5, 0x020202, v5
    v_lshlrev_b32 v8, 25, v113
    v_and_b32 v8, 0x02000000, v8
    v_or_b32 v5, v5, v8
    v_add_u32 v5, 0x05040100, v5
    v_lshlrev_b32 v8, 2, v0
    v_add_u32 v8, 14336, v8
    v_mov_b32 v9, 1
    v_mov_b32 v117, 0
    s_waitcnt vmcnt(27)
    ds_write2st64_b32 v8, v60, v61 offset0:0 offset1:9
    ds_write2st64_b32 v8, v62, v63 offset0:18 offset1:27
    ds_write2st64_b32 v8, v64, v65 offset0:4 offset1:13
    ds_write2st64_b32 v8, v66, v67 offset0:22 offset1:31
    s_waitcnt vmcnt(26)
    s_cmp_ge_u32 s17, 1
    s_cbranch_scc1 KF_SKIP
    ds_write2st64_b32 v8, v68, v69 offset0:8 offset1:17
    ds_write2st64_b32 v8, v70, v71 offset0:26 offset1:35
KF_SKIP:
    ds_write_b32 v116, v9 offset:1056
KF_ZPOLL:
    ds_read_b128 v[60:63], v117 offset:1056
    s_waitcnt lgkmcnt(0)
    v_min3_u32 v60, v60, v61, v62
    v_min_u32 v60, v60, v63
    v_cmp_eq_u32 vcc, 0, v60
    s_cbranch_vccnz KF_ZPOLL
    ds_read_b64 v[60:61], v4 offset:14336
    ds_read_b64 v[62:63], v4 offset:14592
    ds_read_b64 v[64:65], v4 offset:14848
    ds_read_b64 v[66:67], v4 offset:15104
    ds_read_b64 v[68:69], v4 offset:15360
    ds_read_b64 v[70:71], v4 offset:15616
    ds_read_b64 v[72:73], v4 offset:15872
    ds_read_b64 v[74:75], v4 offset:16128
    ds_read_b64 v[76:77], v4 offset:16384
    s_waitcnt vmcnt(17)
    s_waitcnt lgkmcnt(8)
    v_perm_b32 v44, v61, v60, v5
    v_lshlrev_b32 v46, 16, v44
    v_and_b32 v47, 0xffff0000, v44
    v_lshlrev_b32 v20, 16, v10
    v_and_b32 v21, 0xffff0000, v10
    v_pk_add_f32 v[46:47], v[46:47], v[20:21]
    v_cvt_pk_bf16_f32 v44, v46, v47
    v_lshlrev_b32 v20, 16, v44
    v_and_b32 v21, 0xffff0000, v44
    s_waitcnt lgkmcnt(7)
    v_perm_b32 v44, v63, v62, v5
    v_lshlrev_b32 v46, 16, v44
    v_and_b32 v47, 0xffff0000, v44
    v_lshlrev_b32 v22, 16, v11
    v_and_b32 v23, 0xffff0000, v11
    v_pk_add_f32 v[46:47], v[46:47], v[22:23]
    v_cvt_pk_bf16_f32 v44, v46, v47
    v_lshlrev_b32 v22, 16, v44
    v_and_b32 v23, 0xffff0000, v44
    s_waitcnt lgkmcnt(6)
    v_perm_b32 v44, v65, v64, v5
    v_lshlrev_b32 v46, 16, v44
    v_and_b32 v47, 0xffff0000, v44
    v_lshlrev_b32 v24, 16, v12
    v_and_b32 v25, 0xffff0000, v12
    v_pk_add_f32 v[46:47], v[46:47], v[24:25]
    v_cvt_pk_bf16_f32 v44, v46, v47
    v_lshlrev_b32 v24, 16, v44
    v_and_b32 v25, 0xffff0000, v44
    s_waitcnt lgkmcnt(5)
    v_perm_b32 v44, v67, v66, v5
    v_lshlrev_b32 v46, 16, v44
    v_and_b32 v47, 0xffff0000, v44
    v_lshlrev_b32 v26, 16, v13
    v_and_b32 v27, 0xffff0000, v13
    v_pk_add_f32 v[46:47], v[46:47], v[26:27]
    v_cvt_pk_bf16_f32 v44, v46, v47
    v_lshlrev_b32 v26, 16, v44
    v_and_b32 v27, 0xffff0000, v44
    s_waitcnt lgkmcnt(4)
    v_perm_b32 v44, v69, v68, v5
    v_lshlrev_b32 v46, 16, v44
    v_and_b32 v47, 0xffff0000, v44
    v_lshlrev_b32 v28, 16, v14
    v_and_b32 v29, 0xffff0000, v14
    v_pk_add_f32 v[46:47], v[46:47], v[28:29]
    v_cvt_pk_bf16_f32 v44, v46, v47
    v_lshlrev_b32 v28, 16, v44
    v_and_b32 v29, 0xffff0000, v44
    s_waitcnt lgkmcnt(3)
    v_perm_b32 v44, v71, v70, v5
    v_lshlrev_b32 v46, 16, v44
    v_and_b32 v47, 0xffff0000, v44
    v_lshlrev_b32 v30, 16, v15
    v_and_b32 v31, 0xffff0000, v15
    v_pk_add_f32 v[46:47], v[46:47], v[30:31]
    v_cvt_pk_bf16_f32 v44, v46, v47
    v_lshlrev_b32 v30, 16, v44
    v_and_b32 v31, 0xffff0000, v44
    s_waitcnt lgkmcnt(2)
    v_perm_b32 v44, v73, v72, v5
    v_lshlrev_b32 v46, 16, v44
    v_and_b32 v47, 0xffff0000, v44
    v_lshlrev_b32 v32, 16, v16
    v_and_b32 v33, 0xffff0000, v16
    v_pk_add_f32 v[46:47], v[46:47], v[32:33]
    v_cvt_pk_bf16_f32 v44, v46, v47
    v_lshlrev_b32 v32, 16, v44
    v_and_b32 v33, 0xffff0000, v44
    s_waitcnt lgkmcnt(1)
    v_perm_b32 v44, v75, v74, v5
    v_lshlrev_b32 v46, 16, v44
    v_and_b32 v47, 0xffff0000, v44
    v_lshlrev_b32 v34, 16, v17
    v_and_b32 v35, 0xffff0000, v17
    v_pk_add_f32 v[46:47], v[46:47], v[34:35]
    v_cvt_pk_bf16_f32 v44, v46, v47
    v_lshlrev_b32 v34, 16, v44
    v_and_b32 v35, 0xffff0000, v44
    s_waitcnt lgkmcnt(0)
    v_perm_b32 v44, v77, v76, v5
    v_lshlrev_b32 v46, 16, v44
    v_and_b32 v47, 0xffff0000, v44
    v_lshlrev_b32 v36, 16, v18
    v_and_b32 v37, 0xffff0000, v18
    v_pk_add_f32 v[46:47], v[46:47], v[36:37]
    v_cvt_pk_bf16_f32 v44, v46, v47
    v_lshlrev_b32 v36, 16, v44
    v_and_b32 v37, 0xffff0000, v44
    v_pk_add_f32 v[44:45], v[20:21], v[22:23]
    v_pk_add_f32 v[46:47], v[24:25], v[26:27]
    v_pk_add_f32 v[44:45], v[44:45], v[28:29]
    v_pk_add_f32 v[46:47], v[46:47], v[30:31]
    v_pk_add_f32 v[44:45], v[44:45], v[32:33]
    v_pk_add_f32 v[46:47], v[46:47], v[34:35]
    v_pk_add_f32 v[44:45], v[44:45], v[36:37]
    v_pk_add_f32 v[44:45], v[44:45], v[46:47]
    v_add_f32 v44, v44, v45
    s_nop 1
    v_add_f32_dpp v44, v44, v44 row_ror:8 row_mask:0xf bank_mask:0xf
    s_nop 1
    v_add_f32_dpp v44, v44, v44 row_ror:4 row_mask:0xf bank_mask:0xf
    s_nop 1
    v_add_f32_dpp v44, v44, v44 row_ror:2 row_mask:0xf bank_mask:0xf
    s_nop 1
    v_add_f32_dpp v44, v44, v44 row_ror:1 row_mask:0xf bank_mask:0xf
    v_mov_b32 v46, v44
    s_nop 1
    v_permlane16_swap_b32 v44, v46
    v_add_f32 v44, v44, v46
    v_mul_f32 v48, 0x3ae38e39, v44
    v_mov_b32 v49, v48
    v_cvt_pk_bf16_f32 v40, v48, v48
    v_and_b32 v40, 0xffff0000, v40
    v_mov_b32 v41, v40
    v_pk_add_f32 v[42:43], v[20:21], v[48:49] neg_lo:[0,1] neg_hi:[0,1]
    v_pk_mul_f32 v[44:45], v[42:43], v[42:43]
    v_pk_add_f32 v[42:43], v[22:23], v[48:49] neg_lo:[0,1] neg_hi:[0,1]
    v_pk_mul_f32 v[46:47], v[42:43], v[42:43]
    v_pk_add_f32 v[42:43], v[24:25], v[48:49] neg_lo:[0,1] neg_hi:[0,1]
    v_pk_fma_f32 v[44:45], v[42:43], v[42:43], v[44:45]
    v_pk_add_f32 v[42:43], v[26:27], v[48:49] neg_lo:[0,1] neg_hi:[0,1]
    v_pk_fma_f32 v[46:47], v[42:43], v[42:43], v[46:47]
    v_pk_add_f32 v[42:43], v[28:29], v[48:49] neg_lo:[0,1] neg_hi:[0,1]
    v_pk_fma_f32 v[44:45], v[42:43], v[42:43], v[44:45]
    v_pk_add_f32 v[42:43], v[30:31], v[48:49] neg_lo:[0,1] neg_hi:[0,1]
    v_pk_fma_f32 v[46:47], v[42:43], v[42:43], v[46:47]
    v_pk_add_f32 v[42:43], v[32:33], v[48:49] neg_lo:[0,1] neg_hi:[0,1]
    v_pk_fma_f32 v[44:45], v[42:43], v[42:43], v[44:45]
    v_pk_add_f32 v[42:43], v[34:35], v[48:49] neg_lo:[0,1] neg_hi:[0,1]
    v_pk_fma_f32 v[46:47], v[42:43], v[42:43], v[46:47]
    v_pk_add_f32 v[42:43], v[36:37], v[48:49] neg_lo:[0,1] neg_hi:[0,1]
    v_pk_fma_f32 v[44:45], v[42:43], v[42:43], v[44:45]
    v_pk_add_f32 v[44:45], v[44:45], v[46:47]
    v_add_f32 v44, v44, v45
    s_nop 1
    v_add_f32_dpp v44, v44, v44 row_ror:8 row_mask:0xf bank_mask:0xf
    s_nop 1
    v_add_f32_dpp v44, v44, v44 row_ror:4 row_mask:0xf bank_mask:0xf
    s_nop 1
    v_add_f32_dpp v44, v44, v44 row_ror:2 row_mask:0xf bank_mask:0xf
    s_nop 1
    v_add_f32_dpp v44, v44, v44 row_ror:1 row_mask:0xf bank_mask:0xf
    v_mov_b32 v46, v44
    s_nop 1
    v_permlane16_swap_b32 v44, v46
    v_add_f32 v44, v44, v46
    v_mul_f32 v44, 0x3ae38e39, v44
    v_cvt_pk_bf16_f32 v44, v44, v44
    v_and_b32 v44, 0xffff0000, v44
    v_add_f32 v44, 0x3727c5ac, v44
    v_cvt_pk_bf16_f32 v44, v44, v44
    v_and_b32 v44, 0xffff0000, v44
    v_sqrt_f32 v44, v44
    s_nop 0
    v_cvt_pk_bf16_f32 v44, v44, v44
    v_and_b32 v44, 0xffff0000, v44
    v_rcp_f32 v42, v44
    s_nop 0
    v_mov_b32 v43, v42
    s_waitcnt vmcnt(8)
    v_mov_b32 v60, 0
    v_mov_b32 v61, 0
    v_pk_add_f32 v[44:45], v[20:21], v[40:41] neg_lo:[0,1] neg_hi:[0,1]
    v_cvt_pk_bf16_f32 v10, v44, v45
    v_lshlrev_b32 v44, 16, v10
    v_and_b32 v45, 0xffff0000, v10
    v_pk_mul_f32 v[44:45], v[44:45], v[42:43]
    v_cvt_pk_bf16_f32 v10, v44, v45
    v_lshlrev_b32 v44, 16, v10
    v_and_b32 v45, 0xffff0000, v10
    v_lshlrev_b32 v46, 16, v50
    v_and_b32 v47, 0xffff0000, v50
    v_pk_fma_f32 v[60:61], v[44:45], v[46:47], v[60:61]
    v_pk_add_f32 v[44:45], v[44:45], v[20:21]
    v_cvt_pk_bf16_f32 v50, v44, v45
    v_pk_add_f32 v[44:45], v[22:23], v[40:41] neg_lo:[0,1] neg_hi:[0,1]
    v_cvt_pk_bf16_f32 v11, v44, v45
    v_lshlrev_b32 v44, 16, v11
    v_and_b32 v45, 0xffff0000, v11
    v_pk_mul_f32 v[44:45], v[44:45], v[42:43]
    v_cvt_pk_bf16_f32 v11, v44, v45
    v_lshlrev_b32 v44, 16, v11
    v_and_b32 v45, 0xffff0000, v11
    v_lshlrev_b32 v46, 16, v51
    v_and_b32 v47, 0xffff0000, v51
    v_pk_fma_f32 v[60:61], v[44:45], v[46:47], v[60:61]
    v_pk_add_f32 v[44:45], v[44:45], v[22:23]
    v_cvt_pk_bf16_f32 v51, v44, v45
    v_pk_add_f32 v[44:45], v[24:25], v[40:41] neg_lo:[0,1] neg_hi:[0,1]
    v_cvt_pk_bf16_f32 v12, v44, v45
    v_lshlrev_b32 v44, 16, v12
    v_and_b32 v45, 0xffff0000, v12
    v_pk_mul_f32 v[44:45], v[44:45], v[42:43]
    v_cvt_pk_bf16_f32 v12, v44, v45
    v_lshlrev_b32 v44, 16, v12
    v_and_b32 v45, 0xffff0000, v12
    v_lshlrev_b32 v46, 16, v52
    v_and_b32 v47, 0xffff0000, v52
    v_pk_fma_f32 v[60:61], v[44:45], v[46:47], v[60:61]
    v_pk_add_f32 v[44:45], v[44:45], v[24:25]
    v_cvt_pk_bf16_f32 v52, v44, v45
    v_pk_add_f32 v[44:45], v[26:27], v[40:41] neg_lo:[0,1] neg_hi:[0,1]
    v_cvt_pk_bf16_f32 v13, v44, v45
    v_lshlrev_b32 v44, 16, v13
    v_and_b32 v45, 0xffff0000, v13
    v_pk_mul_f32 v[44:45], v[44:45], v[42:43]
    v_cvt_pk_bf16_f32 v13, v44, v45
    v_lshlrev_b32 v44, 16, v13
    v_and_b32 v45, 0xffff0000, v13
    v_lshlrev_b32 v46, 16, v53
    v_and_b32 v47, 0xffff0000, v53
    v_pk_fma_f32 v[60:61], v[44:45], v[46:47], v[60:61]
    v_pk_add_f32 v[44:45], v[44:45], v[26:27]
    v_cvt_pk_bf16_f32 v53, v44, v45
    v_pk_add_f32 v[44:45], v[28:29], v[40:41] neg_lo:[0,1] neg_hi:[0,1]
    v_cvt_pk_bf16_f32 v14, v44, v45
    v_lshlrev_b32 v44, 16, v14
    v_and_b32 v45, 0xffff0000, v14
    v_pk_mul_f32 v[44:45], v[44:45], v[42:43]
    v_cvt_pk_bf16_f32 v14, v44, v45
    v_lshlrev_b32 v44, 16, v14
    v_and_b32 v45, 0xffff0000, v14
    v_lshlrev_b32 v46, 16, v54
    v_and_b32 v47, 0xffff0000, v54
    v_pk_fma_f32 v[60:61], v[44:45], v[46:47], v[60:61]
    v_pk_add_f32 v[44:45], v[44:45], v[28:29]
    v_cvt_pk_bf16_f32 v54, v44, v45
    v_pk_add_f32 v[44:45], v[30:31], v[40:41] neg_lo:[0,1] neg_hi:[0,1]
    v_cvt_pk_bf16_f32 v15, v44, v45
    v_lshlrev_b32 v44, 16, v15
    v_and_b32 v45, 0xffff0000, v15
    v_pk_mul_f32 v[44:45], v[44:45], v[42:43]
    v_cvt_pk_bf16_f32 v15, v44, v45
    v_lshlrev_b32 v44, 16, v15
    v_and_b32 v45, 0xffff0000, v15
    v_lshlrev_b32 v46, 16, v55
    v_and_b32 v47, 0xffff0000, v55
    v_pk_fma_f32 v[60:61], v[44:45], v[46:47], v[60:61]
    v_pk_add_f32 v[44:45], v[44:45], v[30:31]
    v_cvt_pk_bf16_f32 v55, v44, v45
    v_pk_add_f32 v[44:45], v[32:33], v[40:41] neg_lo:[0,1] neg_hi:[0,1]
    v_cvt_pk_bf16_f32 v16, v44, v45
    v_lshlrev_b32 v44, 16, v16
    v_and_b32 v45, 0xffff0000, v16
    v_pk_mul_f32 v[44:45], v[44:45], v[42:43]
    v_cvt_pk_bf16_f32 v16, v44, v45
    v_lshlrev_b32 v44, 16, v16
    v_and_b32 v45, 0xffff0000, v16
    v_lshlrev_b32 v46, 16, v56
    v_and_b32 v47, 0xffff0000, v56
    v_pk_fma_f32 v[60:61], v[44:45], v[46:47], v[60:61]
    v_pk_add_f32 v[44:45], v[44:45], v[32:33]
    v_cvt_pk_bf16_f32 v56, v44, v45
    v_pk_add_f32 v[44:45], v[34:35], v[40:41] neg_lo:[0,1] neg_hi:[0,1]
    v_cvt_pk_bf16_f32 v17, v44, v45
    v_lshlrev_b32 v44, 16, v17
    v_and_b32 v45, 0xffff0000, v17
    v_pk_mul_f32 v[44:45], v[44:45], v[42:43]
    v_cvt_pk_bf16_f32 v17, v44, v45
    v_lshlrev_b32 v44, 16, v17
    v_and_b32 v45, 0xffff0000, v17
    v_lshlrev_b32 v46, 16, v57
    v_and_b32 v47, 0xffff0000, v57
    v_pk_fma_f32 v[60:61], v[44:45], v[46:47], v[60:61]
    v_pk_add_f32 v[44:45], v[44:45], v[34:35]
    v_cvt_pk_bf16_f32 v57, v44, v45
    v_pk_add_f32 v[44:45], v[36:37], v[40:41] neg_lo:[0,1] neg_hi:[0,1]
    v_cvt_pk_bf16_f32 v18, v44, v45
    v_lshlrev_b32 v44, 16, v18
    v_and_b32 v45, 0xffff0000, v18
    v_pk_mul_f32 v[44:45], v[44:45], v[42:43]
    v_cvt_pk_bf16_f32 v18, v44, v45
    v_lshlrev_b32 v44, 16, v18
    v_and_b32 v45, 0xffff0000, v18
    v_lshlrev_b32 v46, 16, v58
    v_and_b32 v47, 0xffff0000, v58
    v_pk_fma_f32 v[60:61], v[44:45], v[46:47], v[60:61]
    v_pk_add_f32 v[44:45], v[44:45], v[36:37]
    v_cvt_pk_bf16_f32 v58, v44, v45
    v_add_f32 v60, v60, v61
    s_nop 1
    v_add_f32_dpp v60, v60, v60 row_ror:8 row_mask:0xf bank_mask:0xf
    s_nop 1
    v_add_f32_dpp v60, v60, v60 row_ror:4 row_mask:0xf bank_mask:0xf
    s_nop 1
    v_add_f32_dpp v60, v60, v60 row_ror:2 row_mask:0xf bank_mask:0xf
    s_nop 1
    v_add_f32_dpp v60, v60, v60 row_ror:1 row_mask:0xf bank_mask:0xf
    v_mov_b32 v61, v60
    s_nop 1
    v_permlane16_swap_b32 v60, v61
    v_add_f32 v60, v60, v61
    v_cvt_pk_bf16_f32 v60, v60, v60
    v_ashrrev_i32 v61, 31, v60
    v_or_b32 v61, 0x80000000, v61
    v_xor_b32 v60, v60, v61
    v_and_b32 v60, 0xffff0000, v60
    s_lshl_b32 s19, s16, 3
    v_add_u32 v61, s19, v113
    v_sub_u32 v62, 0x87ff, v61
    v_or_b32 v60, v60, v62
    v_lshlrev_b32 v61, 2, v113
    s_mov_b32 exec_lo, 1
    s_mov_b32 exec_hi, 1
    ds_write_b32 v61, v60 offset:1120
    s_mov_b64 exec, 1
    ds_add_rtn_u32 v62, v117, v9 offset:1072
    s_mov_b64 exec, 3
    v_lshlrev_b32 v61, 4, v114
    s_lshl_b32 s19, s16, 5
    ds_read_b128 v[64:67], v61 offset:1120
    s_waitcnt lgkmcnt(1)
    v_readfirstlane_b32 s18, v62
    s_cmp_lg_u32 s18, 3
    s_cbranch_scc1 KF_NOKEY
    s_waitcnt lgkmcnt(0)
    buffer_store_dwordx4 v[64:67], v61, s[36:39], s19 offen sc1
KF_NOKEY:
    s_mov_b64 exec, -1
    buffer_store_dword v10, v115, s[8:11], s3 offen offset:0 sc1
    buffer_store_dword v11, v115, s[8:11], s3 offen offset:128 sc1
    buffer_store_dword v12, v115, s[8:11], s3 offen offset:256 sc1
    buffer_store_dword v13, v115, s[8:11], s3 offen offset:384 sc1
    buffer_store_dword v14, v115, s[8:11], s3 offen offset:512 sc1
    buffer_store_dword v15, v115, s[8:11], s3 offen offset:640 sc1
    buffer_store_dword v16, v115, s[8:11], s3 offen offset:768 sc1
    buffer_store_dword v17, v115, s[8:11], s3 offen offset:896 sc1
    buffer_store_dword v18, v115, s[8:11], s3 offen offset:1024 sc1
    buffer_store_dword v50, v115, s[24:27], s3 offen offset:0 sc1
    buffer_store_dword v51, v115, s[24:27], s3 offen offset:128 sc1
    buffer_store_dword v52, v115, s[24:27], s3 offen offset:256 sc1
    buffer_store_dword v53, v115, s[24:27], s3 offen offset:384 sc1
    buffer_store_dword v54, v115, s[24:27], s3 offen offset:512 sc1
    buffer_store_dword v55, v115, s[24:27], s3 offen offset:640 sc1
    buffer_store_dword v56, v115, s[24:27], s3 offen offset:768 sc1
    buffer_store_dword v57, v115, s[24:27], s3 offen offset:896 sc1
    buffer_store_dword v58, v115, s[24:27], s3 offen offset:1024 sc1
    s_lshl_b32 s19, s2, 4
    s_add_u32 s19, s19, 8192
    s_cmp_lg_u32 s18, 3
    s_cbranch_scc1 KF_NOKEY2
    s_waitcnt vmcnt(18)
    ds_write_b32 v117, v9 offset:1076
KF_NOKEY2:
    s_waitcnt vmcnt(0)
    s_mov_b64 exec, 1
    buffer_store_dword v9, v116, s[36:39], s19 offen sc1
    s_mov_b64 exec, -1
    s_setprio 0
    s_cmp_lt_u32 s2, 144
    s_cbranch_scc1 KF_B
    s_endpgm
KF_T:
    s_setprio 2
    v_mov_b32 v4, 0
    v_subrev_u32 v5, 256, v0
    v_lshlrev_b32 v5, 2, v5
    v_min_u32 v5, 1096, v5
    ds_write_b32 v5, v4
    v_and_b32 v6, 1, v1
    v_subrev_u32 v6, 1, v6
    v_and_b32 v7, 7, v1
    v_lshlrev_b32 v7, 2, v7
    v_mov_b32 v117, 0
    v_mov_b32 v35, 1
    s_waitcnt lgkmcnt(0)
    s_barrier
    s_add_u32 s36, s34, 0xc00000
    s_addc_u32 s37, s35, 0
    s_mov_b32 s38, 0x3000
    s_mov_b32 s39, 0x20000
    s_cmp_eq_u32 s17, 9
    s_cbranch_scc1 KF_W9
    s_mov_b32 s72, s64
    s_mov_b32 s73, s65
    s_mov_b32 s74, s69
    s_mov_b32 s75, 0x20000
    v_mul_u32_u24 v112, 9216, v3
    v_lshl_add_u32 v112, v2, 3, v112
    s_mul_i32 s18, s68, 36864
    s_lshl_b32 s19, s17, 7
    s_add_u32 s18, s18, s19
    s_add_u32 s19, s18, 4608
    buffer_load_dwordx2 v[80:81], v112, s[72:75], s18 offen offset:0
    buffer_load_dwordx2 v[82:83], v112, s[72:75], s18 offen offset:1152
    buffer_load_dwordx2 v[84:85], v112, s[72:75], s18 offen offset:2304
    buffer_load_dwordx2 v[86:87], v112, s[72:75], s18 offen offset:3456
    buffer_load_dwordx2 v[88:89], v112, s[72:75], s19 offen offset:0
    buffer_load_dwordx2 v[90:91], v112, s[72:75], s19 offen offset:1152
    buffer_load_dwordx2 v[92:93], v112, s[72:75], s19 offen offset:2304
    buffer_load_dwordx2 v[94:95], v112, s[72:75], s19 offen offset:3456
    s_cmp_eq_u32 s17, 8
    s_cbranch_scc1 KF_L2
    v_subrev_u32 v4, 256, v0
    v_lshlrev_b32 v4, 4, v4
    s_movk_i32 s19, 4096
KF_KD1:
    s_sleep 1
    ds_read_b32 v8, v117 offset:1076
    s_waitcnt lgkmcnt(0)
    v_cmp_eq_u32 vcc, 0, v8
    s_cbranch_vccnz KF_KD1
    s_branch KF_KPOLL1
KF_KPOLL:
    s_sleep 1
KF_KPOLL1:
    buffer_load_dwordx4 v[8:11], v4, s[36:39], 0 offen sc1
    buffer_load_dwordx4 v[12:15], v4, s[36:39], s19 offen sc1
    s_sub_u32 s70, s70, 1
    s_cbranch_scc1 KF_KGO
    s_waitcnt vmcnt(1)
    v_min3_u32 v16, v8, v9, v10
    v_min_u32 v16, v16, v11
    s_waitcnt vmcnt(0)
    v_min3_u32 v16, v16, v12, v13
    v_min3_u32 v16, v16, v14, v15
    v_cmp_eq_u32 vcc, 0, v16
    s_cbranch_vccnz KF_KPOLL
KF_KGO:
    s_waitcnt vmcnt(0)
    v_max_u32 v16, v8, v9
    v_min_u32 v9, v8, v9
    v_max_u32 v17, v12, v13
    v_min_u32 v13, v12, v13
    v_max_u32 v18, v10, v11
    v_min_u32 v11, v10, v11
    v_max_u32 v19, v14, v15
    v_min_u32 v15, v14, v15
    v_max_u32 v20, v16, v18
    v_min_u32 v18, v16, v18
    v_max_u32 v21, v17, v19
    v_min_u32 v19, v17, v19
    v_max_u32 v22, v9, v11
    v_min_u32 v11, v9, v11
    v_max_u32 v23, v13, v15
    v_min_u32 v15, v13, v15
    v_max_u32 v24, v22, v18
    v_min_u32 v18, v22, v18
    v_max_u32 v25, v23, v19
    v_min_u32 v19, v23, v19
    v_mov_b32_dpp v26, v11 quad_perm:[1,0,3,2] row_mask:0xf bank_mask:0xf
    v_mov_b32_dpp v27, v18 quad_perm:[1,0,3,2] row_mask:0xf bank_mask:0xf
    v_mov_b32_dpp v8, v24 quad_perm:[1,0,3,2] row_mask:0xf bank_mask:0xf
    v_mov_b32_dpp v12, v20 quad_perm:[1,0,3,2] row_mask:0xf bank_mask:0xf
    v_med3_u32 v26, v20, v26, v6
    v_med3_u32 v27, v24, v27, v6
    v_med3_u32 v8, v18, v8, v6
    v_med3_u32 v12, v11, v12, v6
    v_max_u32 v10, v26, v8
    v_min_u32 v8, v26, v8
    v_max_u32 v14, v27, v12
    v_min_u32 v12, v27, v12
    v_max_u32 v16, v10, v14
    v_min_u32 v14, v10, v14
    v_max_u32 v17, v8, v12
    v_min_u32 v12, v8, v12
    v_mov_b32_dpp v9, v15 quad_perm:[1,0,3,2] row_mask:0xf bank_mask:0xf
    v_mov_b32_dpp v13, v19 quad_perm:[1,0,3,2] row_mask:0xf bank_mask:0xf
    v_mov_b32_dpp v22, v25 quad_perm:[1,0,3,2] row_mask:0xf bank_mask:0xf
    v_mov_b32_dpp v23, v21 quad_perm:[1,0,3,2] row_mask:0xf bank_mask:0xf
    v_med3_u32 v9, v21, v9, v6
    v_med3_u32 v13, v25, v13, v6
    v_med3_u32 v22, v19, v22, v6
    v_med3_u32 v23, v15, v23, v6
    v_max_u32 v20, v9, v22
    v_min_u32 v22, v9, v22
    v_max_u32 v24, v13, v23
    v_min_u32 v23, v13, v23
    v_max_u32 v18, v20, v24
    v_min_u32 v24, v20, v24
    v_max_u32 v11, v22, v23
    v_min_u32 v23, v22, v23
    s_nop 1
    v_max_u32_dpp v16, v23, v16 quad_perm:[1,0,3,2] row_mask:0xf bank_mask:0xf
    v_max_u32_dpp v14, v11, v14 quad_perm:[1,0,3,2] row_mask:0xf bank_mask:0xf
    v_max_u32_dpp v17, v24, v17 quad_perm:[1,0,3,2] row_mask:0xf bank_mask:0xf
    v_max_u32_dpp v12, v18, v12 quad_perm:[1,0,3,2] row_mask:0xf bank_mask:0xf
    v_mov_b32_dpp v26, v16 quad_perm:[1,0,3,2] row_mask:0xf bank_mask:0xf
    v_mov_b32_dpp v27, v14 quad_perm:[1,0,3,2] row_mask:0xf bank_mask:0xf
    v_mov_b32_dpp v10, v17 quad_perm:[1,0,3,2] row_mask:0xf bank_mask:0xf
    v_mov_b32_dpp v8, v12 quad_perm:[1,0,3,2] row_mask:0xf bank_mask:0xf
    v_med3_u32 v26, v16, v26, v6
    v_med3_u32 v27, v14, v27, v6
    v_med3_u32 v10, v17, v10, v6
    v_med3_u32 v8, v12, v8, v6
    v_max_u32 v21, v26, v10
    v_min_u32 v10, v26, v10
    v_max_u32 v25, v27, v8
    v_min_u32 v8, v27, v8
    v_max_u32 v19, v21, v25
    v_min_u32 v25, v21, v25
    v_max_u32 v15, v10, v8
    v_min_u32 v8, v10, v8
    s_sub_u32 s19, s17, 4
    s_lshl_b32 s19, s19, 7
    v_lshlrev_b32 v32, 4, v2
    v_lshl_add_u32 v32, v3, 5, v32
    v_add_u32 v32, s19, v32
    v_max_u32_dpp v9, v8, v19 quad_perm:[3,2,1,0] row_mask:0xf bank_mask:0xf
    v_max_u32_dpp v13, v15, v25 quad_perm:[3,2,1,0] row_mask:0xf bank_mask:0xf
    v_max_u32_dpp v20, v25, v15 quad_perm:[3,2,1,0] row_mask:0xf bank_mask:0xf
    v_max_u32_dpp v22, v19, v8 quad_perm:[3,2,1,0] row_mask:0xf bank_mask:0xf
    v_mov_b32_dpp v18, v9 quad_perm:[1,0,3,2] row_mask:0xf bank_mask:0xf
    v_mov_b32_dpp v24, v13 quad_perm:[1,0,3,2] row_mask:0xf bank_mask:0xf
    v_mov_b32_dpp v11, v20 quad_perm:[1,0,3,2] row_mask:0xf bank_mask:0xf
    v_mov_b32_dpp v23, v22 quad_perm:[1,0,3,2] row_mask:0xf bank_mask:0xf
    v_med3_u32 v18, v9, v18, v6
    v_med3_u32 v24, v13, v24, v6
    v_med3_u32 v11, v20, v11, v6
    v_med3_u32 v23, v22, v23, v6
    v_max_u32 v16, v18, v11
    v_min_u32 v11, v18, v11
    v_max_u32 v14, v24, v23
    v_min_u32 v23, v24, v23
    v_max_u32 v17, v16, v14
    v_min_u32 v14, v16, v14
    v_max_u32 v12, v11, v23
    v_min_u32 v23, v11, v23
    s_nop 1
    v_max_u32_dpp v26, v23, v17 row_half_mirror row_mask:0xf bank_mask:0xf
    v_max_u32_dpp v27, v12, v14 row_half_mirror row_mask:0xf bank_mask:0xf
    v_max_u32_dpp v21, v14, v12 row_half_mirror row_mask:0xf bank_mask:0xf
    v_max_u32_dpp v10, v17, v23 row_half_mirror row_mask:0xf bank_mask:0xf
    v_mov_b32_dpp v19, v26 quad_perm:[1,0,3,2] row_mask:0xf bank_mask:0xf
    v_mov_b32_dpp v25, v27 quad_perm:[1,0,3,2] row_mask:0xf bank_mask:0xf
    v_mov_b32_dpp v15, v21 quad_perm:[1,0,3,2] row_mask:0xf bank_mask:0xf
    v_mov_b32_dpp v8, v10 quad_perm:[1,0,3,2] row_mask:0xf bank_mask:0xf
    v_med3_u32 v19, v26, v19, v6
    v_med3_u32 v25, v27, v25, v6
    v_med3_u32 v15, v21, v15, v6
    v_med3_u32 v8, v10, v8, v6
    v_max_u32 v9, v19, v15
    v_min_u32 v15, v19, v15
    v_max_u32 v13, v25, v8
    v_min_u32 v8, v25, v8
    v_max_u32 v20, v9, v13
    v_min_u32 v13, v9, v13
    v_max_u32 v22, v15, v8
    v_min_u32 v8, v15, v8
    s_nop 1
    v_max_u32_dpp v18, v8, v20 row_mirror row_mask:0xf bank_mask:0xf
    v_max_u32_dpp v24, v22, v13 row_mirror row_mask:0xf bank_mask:0xf
    v_max_u32_dpp v16, v13, v22 row_mirror row_mask:0xf bank_mask:0xf
    v_max_u32_dpp v11, v20, v8 row_mirror row_mask:0xf bank_mask:0xf
    v_mov_b32_dpp v17, v18 quad_perm:[1,0,3,2] row_mask:0xf bank_mask:0xf
    v_mov_b32_dpp v14, v24 quad_perm:[1,0,3,2] row_mask:0xf bank_mask:0xf
    v_mov_b32_dpp v12, v16 quad_perm:[1,0,3,2] row_mask:0xf bank_mask:0xf
    v_mov_b32_dpp v23, v11 quad_perm:[1,0,3,2] row_mask:0xf bank_mask:0xf
    v_med3_u32 v17, v18, v17, v6
    v_med3_u32 v14, v24, v14, v6
    v_med3_u32 v12, v16, v12, v6
    v_med3_u32 v23, v11, v23, v6
    v_max_u32 v26, v17, v12
    v_min_u32 v12, v17, v12
    v_max_u32 v27, v14, v23
    v_min_u32 v23, v14, v23
    v_max_u32 v21, v26, v27
    v_min_u32 v27, v26, v27
    v_max_u32 v10, v12, v23
    v_min_u32 v23, v12, v23
    v_or_b32 v28, 0x8000, v21
    v_or_b32 v29, 0x8000, v27
    v_or_b32 v30, 0x8000, v10
    v_or_b32 v31, 0x8000, v23
    s_mov_b32 exec_lo, 0x00030003
    s_mov_b32 exec_hi, 0x00030003
    ds_write_b128 v32, v[28:31] offset:0
    s_mov_b64 exec, -1
    s_setprio 0
    s_branch KF_B
KF_L2:
    s_add_u32 s12, s34, 0x900000
    s_addc_u32 s13, s35, 0
    s_mov_b32 s14, 0x240000
    s_mov_b32 s15, 0x20000
    s_mov_b32 s24, 0xcccccccc
    s_mov_b32 s25, 0xcccccccc
    s_mov_b32 s26, 0xf0f0f0f0
    s_mov_b32 s27, 0xf0f0f0f0
    s_movk_i32 s40, 1152
    v_lshrrev_b32 v34, 3, v1
    v_lshlrev_b32 v34, 4, v34
    v_lshlrev_b32 v4, 4, v2
KF_KD2:
    s_sleep 1
    ds_read_b32 v8, v117 offset:1076
    s_waitcnt lgkmcnt(0)
    v_cmp_eq_u32 vcc, 0, v8
    s_cbranch_vccnz KF_KD2
KF_L2POLL:
    ds_read_b128 v[8:11], v4 offset:0
    ds_read_b128 v[12:15], v4 offset:256
    s_waitcnt lgkmcnt(0)
    v_min3_u32 v16, v8, v9, v10
    v_min3_u32 v17, v11, v12, v13
    v_min3_u32 v16, v16, v14, v15
    v_min_u32 v16, v16, v17
    v_cmp_eq_u32 vcc, 0, v16
    s_cbranch_vccnz KF_L2POLL
    ds_read_b32 v33, v117 offset:1088
    v_max_u32_dpp v8, v15, v8 quad_perm:[1,0,3,2] row_mask:0xf bank_mask:0xf
    v_max_u32_dpp v9, v14, v9 quad_perm:[1,0,3,2] row_mask:0xf bank_mask:0xf
    v_max_u32_dpp v10, v13, v10 quad_perm:[1,0,3,2] row_mask:0xf bank_mask:0xf
    v_max_u32_dpp v11, v12, v11 quad_perm:[1,0,3,2] row_mask:0xf bank_mask:0xf
    v_mov_b32_dpp v16, v8 quad_perm:[1,0,3,2] row_mask:0xf bank_mask:0xf
    v_mov_b32_dpp v17, v9 quad_perm:[1,0,3,2] row_mask:0xf bank_mask:0xf
    v_mov_b32_dpp v18, v10 quad_perm:[1,0,3,2] row_mask:0xf bank_mask:0xf
    v_mov_b32_dpp v19, v11 quad_perm:[1,0,3,2] row_mask:0xf bank_mask:0xf
    v_med3_u32 v16, v8, v16, v6
    v_med3_u32 v17, v9, v17, v6
    v_med3_u32 v18, v10, v18, v6
    v_med3_u32 v19, v11, v19, v6
    v_max_u32 v20, v16, v18
    v_min_u32 v18, v16, v18
    v_max_u32 v21, v17, v19
    v_min_u32 v19, v17, v19
    v_max_u32 v22, v20, v21
    v_min_u32 v21, v20, v21
    v_max_u32 v23, v18, v19
    v_min_u32 v19, v18, v19
    s_nop 1
    v_max_u32_dpp v24, v19, v22 quad_perm:[3,2,1,0] row_mask:0xf bank_mask:0xf
    v_max_u32_dpp v25, v23, v21 quad_perm:[3,2,1,0] row_mask:0xf bank_mask:0xf
    v_max_u32_dpp v26, v21, v23 quad_perm:[3,2,1,0] row_mask:0xf bank_mask:0xf
    v_max_u32_dpp v27, v22, v19 quad_perm:[3,2,1,0] row_mask:0xf bank_mask:0xf
    v_mov_b32_dpp v12, v24 quad_perm:[1,0,3,2] row_mask:0xf bank_mask:0xf
    v_mov_b32_dpp v13, v25 quad_perm:[1,0,3,2] row_mask:0xf bank_mask:0xf
    v_mov_b32_dpp v14, v26 quad_perm:[1,0,3,2] row_mask:0xf bank_mask:0xf
    v_mov_b32_dpp v15, v27 quad_perm:[1,0,3,2] row_mask:0xf bank_mask:0xf
    v_med3_u32 v12, v24, v12, v6
    v_med3_u32 v13, v25, v13, v6
    v_med3_u32 v14, v26, v14, v6
    v_med3_u32 v15, v27, v15, v6
    v_max_u32 v8, v12, v14
    v_min_u32 v14, v12, v14
    v_max_u32 v9, v13, v15
    v_min_u32 v15, v13, v15
    v_max_u32 v10, v8, v9
    v_min_u32 v9, v8, v9
    v_max_u32 v11, v14, v15
    v_min_u32 v15, v14, v15
    s_nop 1
    v_max_u32_dpp v16, v15, v10 row_half_mirror row_mask:0xf bank_mask:0xf
    v_max_u32_dpp v17, v11, v9 row_half_mirror row_mask:0xf bank_mask:0xf
    v_max_u32_dpp v20, v9, v11 row_half_mirror row_mask:0xf bank_mask:0xf
    v_max_u32_dpp v18, v10, v15 row_half_mirror row_mask:0xf bank_mask:0xf
    v_mov_b32_dpp v22, v16 quad_perm:[1,0,3,2] row_mask:0xf bank_mask:0xf
    v_mov_b32_dpp v21, v17 quad_perm:[1,0,3,2] row_mask:0xf bank_mask:0xf
    v_mov_b32_dpp v23, v20 quad_perm:[1,0,3,2] row_mask:0xf bank_mask:0xf
    v_mov_b32_dpp v19, v18 quad_perm:[1,0,3,2] row_mask:0xf bank_mask:0xf
    v_med3_u32 v22, v16, v22, v6
    v_med3_u32 v21, v17, v21, v6
    v_med3_u32 v23, v20, v23, v6
    v_med3_u32 v19, v18, v19, v6
    v_max_u32 v24, v22, v23
    v_min_u32 v23, v22, v23
    v_max_u32 v25, v21, v19
    v_min_u32 v19, v21, v19
    v_max_u32 v26, v24, v25
    v_min_u32 v25, v24, v25
    v_max_u32 v27, v23, v19
    v_min_u32 v19, v23, v19
    s_nop 1
    v_max_u32_dpp v12, v19, v26 row_mirror row_mask:0xf bank_mask:0xf
    v_max_u32_dpp v13, v27, v25 row_mirror row_mask:0xf bank_mask:0xf
    v_max_u32_dpp v8, v25, v27 row_mirror row_mask:0xf bank_mask:0xf
    v_max_u32_dpp v14, v26, v19 row_mirror row_mask:0xf bank_mask:0xf
    v_cndmask_b32 v30, v12, v13, s[24:25]
    v_cndmask_b32 v31, v8, v14, s[24:25]
    v_cndmask_b32 v30, v30, v31, s[26:27]
    s_nop 1
    v_mov_b32_dpp v30, v30 row_shr:8 row_mask:0xf bank_mask:0xc
    v_and_b32 v31, 0x7ff, v30
    v_sub_u32 v31, 2047, v31
    v_mad_u32_u24 v31, v31, s40, v34
    s_branch KF_RW1
KF_RW:
    ds_read_b32 v33, v117 offset:1088
KF_RW1:
    s_waitcnt lgkmcnt(0)
    v_cmp_eq_u32 vcc, 0, v33
    s_cbranch_vccnz KF_RW
    s_mov_b32 m0, 14336
    s_nop 0
    buffer_load_dwordx4 v31, s[12:15], 0 offen offset:0 sc1 lds
    s_mov_b32 m0, 15232
    s_nop 0
    buffer_load_dwordx4 v31, s[12:15], 0 offen offset:128 sc1 lds
    s_mov_b32 m0, 16128
    s_nop 0
    buffer_load_dwordx4 v31, s[12:15], 0 offen offset:256 sc1 lds
    s_mov_b32 m0, 17024
    s_nop 0
    buffer_load_dwordx4 v31, s[12:15], 0 offen offset:384 sc1 lds
    s_mov_b32 m0, 17920
    s_nop 0
    buffer_load_dwordx4 v31, s[12:15], 0 offen offset:512 sc1 lds
    s_mov_b32 m0, 18816
    s_nop 0
    buffer_load_dwordx4 v31, s[12:15], 0 offen offset:640 sc1 lds
    s_mov_b32 m0, 19712
    s_nop 0
    buffer_load_dwordx4 v31, s[12:15], 0 offen offset:768 sc1 lds
    s_mov_b32 m0, 20608
    s_nop 0
    buffer_load_dwordx4 v31, s[12:15], 0 offen offset:896 sc1 lds
    s_mov_b32 m0, 21504
    s_nop 0
    buffer_load_dwordx4 v31, s[12:15], 0 offen offset:1024 sc1 lds
    ds_write_b32 v7, v30 offset:1024
    s_waitcnt vmcnt(0)
    ds_write_b32 v117, v35 offset:1092
    s_setprio 0
    s_branch KF_B
KF_W9:
    v_lshlrev_b32 v4, 4, v1
    s_movk_i32 s19, 0x2000
KF_KD3:
    s_sleep 1
    ds_read_b32 v8, v117 offset:0
    s_waitcnt lgkmcnt(0)
    v_cmp_eq_u32 vcc, 0, v8
    s_cbranch_vccnz KF_KD3
    s_branch KF_FPOLL1
KF_FPOLL:
    s_sleep 2
KF_FPOLL1:
    buffer_load_dwordx4 v[8:11], v4, s[36:39], s19 offen offset:0 sc1
    buffer_load_dwordx4 v[12:15], v4, s[36:39], s19 offen offset:1024 sc1
    buffer_load_dwordx4 v[16:19], v4, s[36:39], s19 offen offset:2048 sc1
    buffer_load_dwordx4 v[20:23], v4, s[36:39], s19 offen offset:3072 sc1
    s_sub_u32 s70, s70, 1
    s_cbranch_scc1 KF_FGO
    s_waitcnt vmcnt(0)
    v_min3_u32 v8, v8, v9, v10
    v_min3_u32 v8, v8, v11, v12
    v_min3_u32 v8, v8, v13, v14
    v_min3_u32 v8, v8, v15, v16
    v_min3_u32 v8, v8, v17, v18
    v_min3_u32 v8, v8, v19, v20
    v_min3_u32 v8, v8, v21, v22
    v_min_u32 v8, v8, v23
    v_cmp_eq_u32 vcc, 0, v8
    s_cbranch_vccnz KF_FPOLL
KF_FGO:
    ds_write_b32 v117, v35 offset:1088
    s_waitcnt vmcnt(0)
    s_setprio 0
    s_add_u32 s12, s34, 0x900000
    s_addc_u32 s13, s35, 0
    s_mov_b32 s14, 0x240000
    s_mov_b32 s15, 0x20000
    s_add_u32 s24, s34, 0x600000
    s_addc_u32 s25, s35, 0
    s_mov_b32 s26, 0x240000
    s_mov_b32 s27, 0x20000
    s_mov_b32 s36, s30
    s_mov_b32 s37, s31
    s_mov_b32 s38, 0x240000
    s_mov_b32 s39, 0x20000
    v_bfe_u32 v13, v1, 2, 3
    s_lshl_b32 s40, s68, 3
    v_add_u32 v13, s40, v13
    v_bfe_u32 v14, v13, 4, 1
    v_and_b32 v15, 3, v1
    v_lshl_add_u32 v14, v14, 2, v15
    v_lshlrev_b32 v14, 2, v14
    v_lshrrev_b32 v15, 7, v13
    v_lshlrev_b32 v15, 6, v15
    v_and_b32 v16, 15, v13
    v_lshl_add_u32 v15, v16, 2, v15
    v_bfe_u32 v16, v13, 5, 2
    v_add_u32 v15, v15, v16
KF_SPOLL:
    s_sleep 1
    ds_read_b32 v19, v14 offset:1024
    ds_read_b32 v12, v7 offset:1024
    s_waitcnt lgkmcnt(0)
    v_cmp_eq_u32 vcc, 0, v12
    s_cbranch_vccnz KF_SPOLL
    ds_read_b32 v19, v14 offset:1024
    s_waitcnt lgkmcnt(0)
    v_and_b32 v14, 0x7ff, v19
    v_sub_u32 v14, 2047, v14
    v_mul_u32_u24 v23, 1152, v14
    v_lshl_add_u32 v23, v15, 1, v23
    v_lshrrev_b32 v16, 3, v14
    v_mul_u32_u24 v16, 9216, v16
    v_lshl_add_u32 v16, v15, 4, v16
    v_and_b32 v14, 7, v14
    v_lshl_add_u32 v16, v14, 1, v16
    buffer_load_ushort v20, v23, s[12:15], 0 offen sc1
    buffer_load_ushort v17, v23, s[36:39], 0 offen
    buffer_load_ushort v18, v16, s[24:27], 0 offen
    s_add_u32 s12, s34, 0xc20000
    s_addc_u32 s13, s35, 0
    s_mov_b32 s14, 0x4820
    s_mov_b32 s15, 0x20000
    v_ashrrev_i32 v22, 31, v19
    v_not_b32 v22, v22
    v_or_b32 v22, 0x80000000, v22
    v_xor_b32 v22, v19, v22
    v_and_b32 v22, 0xffff0000, v22
    v_mul_f32 v22, 0xbfb8aa3b, v22
    v_exp_f32 v22, v22
    s_nop 0
    v_add_f32 v22, 1.0, v22
    v_rcp_f32 v22, v22
    s_nop 0
    v_cvt_pk_bf16_f32 v22, v22, v22
    v_lshlrev_b32 v22, 16, v22
    v_and_b32 v14, 31, v1
    v_lshlrev_b32 v14, 4, v14
    s_waitcnt vmcnt(0)
    v_lshlrev_b32 v17, 16, v17
    v_lshlrev_b32 v18, 16, v18
    v_add_f32 v17, v17, v18
    v_cvt_pk_bf16_f32 v17, v17, v17
    v_and_b32 v21, 0xffff0000, v17
    v_lshlrev_b32 v20, 16, v20
    ds_write_b128 v14, v[20:23] offset:23552
    s_cmp_lg_u32 s2, 0
    s_cbranch_scc1 KF_W9E
    buffer_store_dword v12, v7, s[12:15], 0 offen
KF_W9E:
    s_waitcnt lgkmcnt(0)
    s_endpgm
KF_B:
    v_and_b32 v1, 63, v0
    v_and_b32 v2, 15, v1
    v_lshrrev_b32 v3, 4, v1
    s_add_u32 s20, s34, 0xd00000
    s_addc_u32 s21, s35, 0
    s_mov_b32 s22, 0x288000
    s_mov_b32 s23, 0x20000
    s_waitcnt vmcnt(0)
    v_perm_b32 v96, v82, v80, s28
    v_perm_b32 v97, v86, v84, s28
    v_perm_b32 v98, v90, v88, s28
    v_perm_b32 v99, v94, v92, s28
    v_perm_b32 v100, v82, v80, s29
    v_perm_b32 v101, v86, v84, s29
    v_perm_b32 v102, v90, v88, s29
    v_perm_b32 v103, v94, v92, s29
    v_perm_b32 v104, v83, v81, s28
    v_perm_b32 v105, v87, v85, s28
    v_perm_b32 v106, v91, v89, s28
    v_perm_b32 v107, v95, v93, s28
    v_perm_b32 v108, v83, v81, s29
    v_perm_b32 v109, v87, v85, s29
    v_perm_b32 v110, v91, v89, s29
    v_perm_b32 v111, v95, v93, s29
    v_and_b32 v16, 7, v2
    v_lshlrev_b32 v16, 6, v16
    v_lshl_add_u32 v16, v3, 4, v16
    s_mul_i32 s18, s68, 18432
    s_lshl_b32 s19, s17, 11
    s_add_u32 s18, s18, s19
    v_lshlrev_b32 v17, 4, v1
    s_waitcnt lgkmcnt(0)
    s_barrier
    s_barrier
    ds_read_b128 v[20:23], v16 offset:1152
    s_waitcnt lgkmcnt(0)
    v_mfma_f32_16x16x32_bf16 v[32:35], v[20:23], v[96:99], 0
    v_mfma_f32_16x16x32_bf16 v[36:39], v[20:23], v[100:103], 0
    v_mfma_f32_16x16x32_bf16 v[40:43], v[20:23], v[104:107], 0
    v_mfma_f32_16x16x32_bf16 v[44:47], v[20:23], v[108:111], 0
    s_nop 5
    v_permlane32_swap_b32 v32, v36
    v_permlane32_swap_b32 v33, v37
    v_permlane32_swap_b32 v34, v38
    v_permlane32_swap_b32 v35, v39
    v_min_u32 v32, -2, v32
    v_min_u32 v33, -2, v33
    v_min_u32 v34, -2, v34
    v_min_u32 v35, -2, v35
    buffer_store_dwordx4 v[32:35], v17, s[20:23], s18 offen offset:0 sc1
    v_permlane32_swap_b32 v40, v44
    v_permlane32_swap_b32 v41, v45
    v_permlane32_swap_b32 v42, v46
    v_permlane32_swap_b32 v43, v47
    v_min_u32 v40, -2, v40
    v_min_u32 v41, -2, v41
    v_min_u32 v42, -2, v42
    v_min_u32 v43, -2, v43
    buffer_store_dwordx4 v[40:43], v17, s[20:23], s18 offen offset:1024 sc1
    s_waitcnt vmcnt(0)
    s_barrier
    s_endpgm
KF_G:
    s_sub_u32 s17, s17, 10
    s_mul_i32 s18, s17, 96
    v_lshl_add_u32 v5, v3, 3, s18
    v_mul_u32_u24 v5, 9216, v5
    v_and_b32 v6, 7, v2
    v_lshl_add_u32 v5, v6, 3, v5
    s_lshl_b32 s18, s68, 6
    v_add_u32 v5, s18, v5
    v_cmp_gt_u32 vcc, 8, v2
    s_mov_b32 s40, 9216
    s_mov_b32 s41, 0
    s_mov_b32 s38, 230400
    s_mov_b32 s39, 0
    s_waitcnt lgkmcnt(0)
    v_mov_b32 v12, s4
    v_mov_b32 v13, s5
    v_mov_b32 v14, s6
    v_mov_b32 v15, s7
    v_cndmask_b32 v12, v14, v12, vcc
    v_cndmask_b32 v13, v15, v13, vcc
    v_add_co_u32 v12, vcc, v12, v5
    s_nop 1
    v_addc_co_u32 v13, vcc, 0, v13, vcc
    s_barrier
    global_load_dwordx2 v[32:33], v[12:13], off
    v_lshl_add_u64 v[12:13], v[12:13], 0, s[40:41]
    global_load_dwordx2 v[34:35], v[12:13], off
    v_lshl_add_u64 v[12:13], v[12:13], 0, s[40:41]
    global_load_dwordx2 v[36:37], v[12:13], off
    v_lshl_add_u64 v[12:13], v[12:13], 0, s[40:41]
    global_load_dwordx2 v[38:39], v[12:13], off
    v_lshl_add_u64 v[12:13], v[12:13], 0, s[40:41]
    global_load_dwordx2 v[40:41], v[12:13], off
    v_lshl_add_u64 v[12:13], v[12:13], 0, s[40:41]
    global_load_dwordx2 v[42:43], v[12:13], off
    v_lshl_add_u64 v[12:13], v[12:13], 0, s[40:41]
    global_load_dwordx2 v[44:45], v[12:13], off
    v_lshl_add_u64 v[12:13], v[12:13], 0, s[40:41]
    global_load_dwordx2 v[46:47], v[12:13], off
    v_lshl_add_u64 v[12:13], v[12:13], 0, s[38:39]
    global_load_dwordx2 v[48:49], v[12:13], off
    v_lshl_add_u64 v[12:13], v[12:13], 0, s[40:41]
    global_load_dwordx2 v[50:51], v[12:13], off
    v_lshl_add_u64 v[12:13], v[12:13], 0, s[40:41]
    global_load_dwordx2 v[52:53], v[12:13], off
    v_lshl_add_u64 v[12:13], v[12:13], 0, s[40:41]
    global_load_dwordx2 v[54:55], v[12:13], off
    v_lshl_add_u64 v[12:13], v[12:13], 0, s[40:41]
    global_load_dwordx2 v[56:57], v[12:13], off
    v_lshl_add_u64 v[12:13], v[12:13], 0, s[40:41]
    global_load_dwordx2 v[58:59], v[12:13], off
    v_lshl_add_u64 v[12:13], v[12:13], 0, s[40:41]
    global_load_dwordx2 v[60:61], v[12:13], off
    v_lshl_add_u64 v[12:13], v[12:13], 0, s[40:41]
    global_load_dwordx2 v[62:63], v[12:13], off
    v_lshl_add_u64 v[12:13], v[12:13], 0, s[38:39]
    global_load_dwordx2 v[64:65], v[12:13], off
    v_lshl_add_u64 v[12:13], v[12:13], 0, s[40:41]
    global_load_dwordx2 v[66:67], v[12:13], off
    v_lshl_add_u64 v[12:13], v[12:13], 0, s[40:41]
    global_load_dwordx2 v[68:69], v[12:13], off
    v_lshl_add_u64 v[12:13], v[12:13], 0, s[40:41]
    global_load_dwordx2 v[70:71], v[12:13], off
    v_lshl_add_u64 v[12:13], v[12:13], 0, s[40:41]
    global_load_dwordx2 v[72:73], v[12:13], off
    v_lshl_add_u64 v[12:13], v[12:13], 0, s[40:41]
    global_load_dwordx2 v[74:75], v[12:13], off
    v_lshl_add_u64 v[12:13], v[12:13], 0, s[40:41]
    global_load_dwordx2 v[76:77], v[12:13], off
    v_lshl_add_u64 v[12:13], v[12:13], 0, s[40:41]
    global_load_dwordx2 v[78:79], v[12:13], off
    s_mul_i32 s18, s17, 1536
    v_lshl_add_u32 v18, v6, 4, s18
    v_lshl_add_u32 v18, v3, 7, v18
    v_mov_b32 v7, 0
    s_waitcnt vmcnt(16)
    v_perm_b32 v80, v34, v32, s28
    v_perm_b32 v81, v38, v36, s28
    v_perm_b32 v82, v42, v40, s28
    v_perm_b32 v83, v46, v44, s28
    v_perm_b32 v84, v34, v32, s29
    v_perm_b32 v85, v38, v36, s29
    v_perm_b32 v86, v42, v40, s29
    v_perm_b32 v87, v46, v44, s29
    v_perm_b32 v88, v35, v33, s28
    v_perm_b32 v89, v39, v37, s28
    v_perm_b32 v90, v43, v41, s28
    v_perm_b32 v91, v47, v45, s28
    v_perm_b32 v92, v35, v33, s29
    v_perm_b32 v93, v39, v37, s29
    v_perm_b32 v94, v43, v41, s29
    v_perm_b32 v95, v47, v45, s29
    s_waitcnt vmcnt(8)
    v_perm_b32 v32, v50, v48, s28
    v_perm_b32 v33, v54, v52, s28
    v_perm_b32 v34, v58, v56, s28
    v_perm_b32 v35, v62, v60, s28
    v_perm_b32 v36, v50, v48, s29
    v_perm_b32 v37, v54, v52, s29
    v_perm_b32 v38, v58, v56, s29
    v_perm_b32 v39, v62, v60, s29
    v_perm_b32 v40, v51, v49, s28
    v_perm_b32 v41, v55, v53, s28
    v_perm_b32 v42, v59, v57, s28
    v_perm_b32 v43, v63, v61, s28
    v_perm_b32 v44, v51, v49, s29
    v_perm_b32 v45, v55, v53, s29
    v_perm_b32 v46, v59, v57, s29
    v_perm_b32 v47, v63, v61, s29
    s_waitcnt vmcnt(0)
    v_perm_b32 v48, v66, v64, s28
    v_perm_b32 v49, v70, v68, s28
    v_perm_b32 v50, v74, v72, s28
    v_perm_b32 v51, v78, v76, s28
    v_perm_b32 v52, v66, v64, s29
    v_perm_b32 v53, v70, v68, s29
    v_perm_b32 v54, v74, v72, s29
    v_perm_b32 v55, v78, v76, s29
    v_perm_b32 v56, v67, v65, s28
    v_perm_b32 v57, v71, v69, s28
    v_perm_b32 v58, v75, v73, s28
    v_perm_b32 v59, v79, v77, s28
    v_perm_b32 v60, v67, v65, s29
    v_perm_b32 v61, v71, v69, s29
    v_perm_b32 v62, v75, v73, s29
    v_perm_b32 v63, v79, v77, s29
    s_lshl_b32 s18, s17, 6
    v_add_u32 v4, s18, v1
    v_lshrrev_b32 v8, 5, v4
    v_and_b32 v9, 31, v4
    v_and_b32 v10, 3, v9
    v_lshlrev_b32 v10, 9, v10
    v_lshrrev_b32 v11, 2, v9
    v_lshl_add_u32 v10, v11, 4, v10
    v_lshrrev_b32 v11, 2, v8
    v_lshl_add_u32 v10, v11, 8, v10
    v_and_b32 v11, 3, v8
    v_lshl_add_u32 v10, v11, 2, v10
    v_lshlrev_b32 v11, 1, v4
    s_lshl_b32 s18, s17, 11
    v_lshl_add_u32 v16, v1, 4, s18
    s_add_u32 s20, s34, 0xd00000
    s_addc_u32 s21, s35, 0
    s_mov_b32 s22, 0x288000
    s_mov_b32 s23, 0x20000
    s_mov_b32 s72, s66
    s_mov_b32 s73, s67
    s_mov_b32 s74, 0x240000
    s_mov_b32 s75, 0x20000
    v_lshrrev_b32 v4, 3, v1
    v_mul_u32_u24 v4, 18432, v4
    v_and_b32 v5, 7, v1
    v_lshl_add_u32 v4, v5, 4, v4
    s_mul_i32 s30, s17, 442368
    s_lshl_b32 s19, s68, 7
    s_add_u32 s30, s30, s19
    s_add_u32 s31, s30, 147456
    s_add_u32 s32, s30, 294912
    s_lshl_b32 s26, s17, 7
    v_lshl_add_u32 v6, v5, 4, s26
    v_lshl_add_u32 v6, v3, 2, v6
    v_lshlrev_b32 v12, 2, v1
    v_add_u32 v12, 24064, v12
    v_lshlrev_b32 v13, 4, v1
KF_G_POLL0:
    s_sleep 2
    ds_read_b32 v17, v7 offset:1024
    s_waitcnt lgkmcnt(0)
    v_cmp_eq_u32 vcc, 0, v17
    s_cbranch_vccnz KF_G_POLL0
    s_setprio 2
KF_G_POLL:
    ds_read_b32 v17, v7 offset:1092
    s_waitcnt lgkmcnt(0)
    v_cmp_eq_u32 vcc, 0, v17
    s_cbranch_vccnz KF_G_POLL
    ds_read_b128 v[20:23], v18 offset:14336
    ds_read_b128 v[24:27], v18 offset:14848
    ds_read_b128 v[28:31], v18 offset:15360
    s_waitcnt lgkmcnt(2)
    v_mfma_f32_16x16x32_bf16 v[96:99], v[20:23], v[80:83], 0
    v_mfma_f32_16x16x32_bf16 v[100:103], v[20:23], v[84:87], 0
    v_mfma_f32_16x16x32_bf16 v[104:107], v[20:23], v[88:91], 0
    v_mfma_f32_16x16x32_bf16 v[108:111], v[20:23], v[92:95], 0
    s_waitcnt lgkmcnt(1)
    v_mfma_f32_16x16x32_bf16 v[96:99], v[24:27], v[32:35], v[96:99]
    v_mfma_f32_16x16x32_bf16 v[100:103], v[24:27], v[36:39], v[100:103]
    v_mfma_f32_16x16x32_bf16 v[104:107], v[24:27], v[40:43], v[104:107]
    v_mfma_f32_16x16x32_bf16 v[108:111], v[24:27], v[44:47], v[108:111]
    s_waitcnt lgkmcnt(0)
    v_mfma_f32_16x16x32_bf16 v[96:99], v[28:31], v[48:51], v[96:99]
    v_mfma_f32_16x16x32_bf16 v[100:103], v[28:31], v[52:55], v[100:103]
    v_mfma_f32_16x16x32_bf16 v[104:107], v[28:31], v[56:59], v[104:107]
    v_mfma_f32_16x16x32_bf16 v[108:111], v[28:31], v[60:63], v[108:111]
    s_mov_b32 exec_lo, -1
    s_mov_b32 exec_hi, 0
    s_nop 2
    ds_write_b128 v16, v[96:99] offset:2048
    ds_write_b128 v16, v[100:103] offset:2560
    ds_write_b128 v16, v[104:107] offset:3072
    ds_write_b128 v16, v[108:111] offset:3584
    s_mov_b64 exec, -1
    s_waitcnt lgkmcnt(0)
    s_barrier
    s_cmp_ge_u32 s17, 4
    s_cbranch_scc1 KF_NOACT
    ds_read_b32 v32, v10 offset:2048
    ds_read_b32 v33, v10 offset:2176
    ds_read_b32 v34, v10 offset:4096
    ds_read_b32 v35, v10 offset:4224
    ds_read_b32 v36, v10 offset:6144
    ds_read_b32 v37, v10 offset:6272
    ds_read_b32 v38, v10 offset:8192
    ds_read_b32 v39, v10 offset:8320
    ds_read_b32 v40, v10 offset:10240
    ds_read_b32 v41, v10 offset:10368
    ds_read_b32 v42, v10 offset:12288
    ds_read_b32 v43, v10 offset:12416
    s_waitcnt lgkmcnt(8)
    v_pk_add_f32 v[32:33], v[32:33], v[34:35]
    s_waitcnt lgkmcnt(4)
    v_pk_add_f32 v[36:37], v[36:37], v[38:39]
    s_waitcnt lgkmcnt(0)
    v_pk_add_f32 v[40:41], v[40:41], v[42:43]
    v_pk_add_f32 v[32:33], v[32:33], v[36:37]
    v_pk_add_f32 v[32:33], v[32:33], v[40:41]
    v_cvt_pk_bf16_f32 v34, v32, v33
    v_lshlrev_b32 v32, 16, v34
    v_and_b32 v33, 0xffff0000, v34
    v_mul_f32 v34, 0xbfb8aa3b, v32
    v_exp_f32 v34, v34
    s_nop 0
    v_add_f32 v34, 1.0, v34
    v_rcp_f32 v34, v34
    s_nop 0
    v_mul_f32 v34, v32, v34
    v_cvt_pk_bf16_f32 v34, v34, v34
    v_lshlrev_b32 v34, 16, v34
    v_mul_f32 v34, v34, v33
    v_cvt_pk_bf16_f32 v34, v34, v34
    ds_write_b16 v11, v34 offset:1152
    s_waitcnt lgkmcnt(0)
KF_NOACT:
    s_barrier
    s_barrier
    s_branch KF_RPOLL1
KF_RPOLL:
    s_sleep 1
KF_RPOLL1:
    buffer_load_dwordx4 v[32:35], v4, s[20:23], s30 offen sc1
    buffer_load_dwordx4 v[36:39], v4, s[20:23], s31 offen sc1
    buffer_load_dwordx4 v[40:43], v4, s[20:23], s32 offen sc1
    s_sub_u32 s70, s70, 1
    s_cbranch_scc1 KF_RGO
    s_waitcnt vmcnt(2)
    v_max3_u32 v44, v32, v33, v34
    v_max_u32 v44, v44, v35
    s_waitcnt vmcnt(1)
    v_max3_u32 v44, v44, v36, v37
    v_max3_u32 v44, v44, v38, v39
    s_waitcnt vmcnt(0)
    v_max3_u32 v44, v44, v40, v41
    v_max3_u32 v44, v44, v42, v43
    v_cmp_eq_u32 vcc, -1, v44
    s_cbranch_vccnz KF_RPOLL
KF_RGO:
    s_waitcnt vmcnt(0)
    v_pk_add_f32 v[32:33], v[32:33], v[36:37]
    v_pk_add_f32 v[34:35], v[34:35], v[38:39]
    v_pk_add_f32 v[32:33], v[32:33], v[40:41]
    v_pk_add_f32 v[34:35], v[34:35], v[42:43]
    s_nop 0
    v_add_f32_dpp v32, v32, v32 row_ror:8 row_mask:0xf bank_mask:0xf
    v_add_f32_dpp v33, v33, v33 row_ror:8 row_mask:0xf bank_mask:0xf
    v_add_f32_dpp v34, v34, v34 row_ror:8 row_mask:0xf bank_mask:0xf
    v_add_f32_dpp v35, v35, v35 row_ror:8 row_mask:0xf bank_mask:0xf
    v_permlane16_swap_b32 v32, v33
    s_nop 0
    v_permlane16_swap_b32 v34, v35
    v_add_f32 v32, v32, v33
    v_add_f32 v34, v34, v35
    s_nop 1
    v_permlane32_swap_b32 v32, v34
    v_add_f32 v32, v32, v34
    ds_write_b32 v6, v32 offset:24064
    s_waitcnt lgkmcnt(0)
    s_barrier
    s_cmp_lg_u32 s17, 0
    s_cbranch_scc1 KF_GEND
    s_mov_b32 exec_lo, -1
    s_mov_b32 exec_hi, 0
    ds_read2_b32 v[32:33], v12 offset0:0 offset1:32
    ds_read2_b32 v[34:35], v12 offset0:64 offset1:96
    ds_read2_b32 v[36:37], v12 offset0:128 offset1:160
    ds_read_b128 v[40:43], v13 offset:23552
    s_waitcnt lgkmcnt(0)
    v_pk_add_f32 v[32:33], v[32:33], v[34:35]
    v_pk_add_f32 v[32:33], v[32:33], v[36:37]
    v_add_f32 v8, v32, v33
    v_cvt_pk_bf16_f32 v8, v8, v8
    v_lshlrev_b32 v8, 16, v8
    v_mul_f32 v8, v8, v42
    v_cvt_pk_bf16_f32 v8, v8, v8
    v_lshlrev_b32 v8, 16, v8
    v_add_f32 v8, v8, v40
    v_cvt_pk_bf16_f32 v8, v8, v8
    v_lshlrev_b32 v8, 16, v8
    v_add_f32 v8, v8, v41
    v_cvt_pk_bf16_f32 v8, v8, v8
    buffer_store_short v8, v43, s[72:75], 0 offen
KF_GEND:
KF_END:
    s_endpgm
.section .rodata,"a"
.p2align 6
.amdhsa_kernel k1_kernel
  .amdhsa_next_free_vgpr 108
  .amdhsa_next_free_sgpr 40
  .amdhsa_accum_offset 108
  .amdhsa_group_segment_fixed_size 0
  .amdhsa_kernarg_size 136
  .amdhsa_user_sgpr_count 2
  .amdhsa_user_sgpr_kernarg_segment_ptr 1
  .amdhsa_system_sgpr_workgroup_id_x 1
  .amdhsa_float_denorm_mode_32 3
.end_amdhsa_kernel
.p2align 6
.amdhsa_kernel k2_kernel
  .amdhsa_next_free_vgpr 152
  .amdhsa_next_free_sgpr 40
  .amdhsa_accum_offset 152
  .amdhsa_group_segment_fixed_size 0
  .amdhsa_kernarg_size 136
  .amdhsa_user_sgpr_count 2
  .amdhsa_user_sgpr_kernarg_segment_ptr 1
  .amdhsa_system_sgpr_workgroup_id_x 1
  .amdhsa_float_denorm_mode_32 3
.end_amdhsa_kernel
.p2align 6
.amdhsa_kernel k3_kernel
  .amdhsa_next_free_vgpr 120
  .amdhsa_next_free_sgpr 80
  .amdhsa_accum_offset 120
  .amdhsa_group_segment_fixed_size 0
  .amdhsa_kernarg_size 136
  .amdhsa_user_sgpr_count 2
  .amdhsa_user_sgpr_kernarg_segment_ptr 1
  .amdhsa_system_sgpr_workgroup_id_x 1
  .amdhsa_float_denorm_mode_32 3
.end_amdhsa_kernel
```

```asm
; @launch grid=(256,1,1) block=(1024,1,1) lds=145664
.amdgcn_target "amdgcn-amd-amdhsa--gfx950"
.text
.globl sequential_preLN__ssm_conv_s4__moe_arch_mod__prompt_kernel
.p2align 8
.type sequential_preLN__ssm_conv_s4__moe_arch_mod__prompt_kernel,@function
sequential_preLN__ssm_conv_s4__moe_arch_mod__prompt_kernel:
    s_cmp_ge_u32 s2, 256
    s_cbranch_scc1 KS_END
    s_load_dwordx16 s[4:19], s[0:1], 0
    s_load_dwordx16 s[20:35], s[0:1], 64
    s_load_dwordx2 s[36:37], s[0:1], 128
    v_readfirstlane_b32 s38, v0
    s_lshr_b32 s38, s38, 6
    s_and_b32 s40, s2, 7
    s_lshr_b32 s41, s2, 3
    s_add_u32 s92, s38, 8
    s_sub_u32 s93, s38, 4
    s_cmp_lt_u32 s38, 8
    s_cselect_b32 s92, s92, s93
    s_cmp_lt_u32 s38, 4
    s_cselect_b32 s38, s38, s92
    v_and_b32 v1, 63, v0
    v_and_b32 v2, 15, v1
    v_lshrrev_b32 v3, 4, v1
    v_mov_b32 v4, 0
    v_mov_b32 v5, 1
    s_mov_b32 s39, 524288
    s_mov_b32 s84, 0x01010101
    s_lshl_b32 s90, s40, 5
    s_add_u32 s90, s90, s41
    s_mul_i32 s89, s40, 18
    s_add_u32 s89, s89, s41
    s_cmp_lt_u32 s38, 4
    s_cbranch_scc1 KS_L
    s_cmp_ge_u32 s38, 12
    s_cbranch_scc1 KS_X
    s_setprio 2
    s_lshr_b32 s87, s38, 2
    s_sub_u32 s87, s87, 1
    s_lshl_b32 s86, s87, 1
    s_add_u32 s86, s86, s38
    s_and_b32 s86, s86, 3
    s_lshl_b32 s88, s90, 1
    s_add_u32 s88, s88, s87
KS_GRP:
    s_mul_i32 s85, s87, 36608
    s_add_u32 s85, s85, 35584
    s_lshl_b32 s92, s88, 8
    v_lshl_add_u32 v6, v1, 2, s92
    s_lshl_b32 s92, s88, 1
    v_mov_b32 v7, s92
    s_lshl_b32 s92, s87, 4
    s_add_u32 s92, s92, s86
    v_mov_b32 v15, s92
    s_lshl_b32 s92, s87, 4
    v_mov_b32 v14, s92
    s_waitcnt lgkmcnt(0)
    global_load_ushort v16, v7, s[18:19]
    global_load_dword v8, v6, s[6:7]
    global_load_dword v9, v6, s[8:9]
    global_load_dword v10, v6, s[10:11]
    global_load_dword v11, v6, s[12:13]
    global_load_dword v12, v6, s[14:15]
    global_load_dword v13, v6, s[16:17]
    global_load_ushort v107, v7, s[20:21]
    s_barrier
    s_add_u32 s93, s85, 31232
    s_lshl_b32 s92, s86, 6
    s_add_u32 s92, s92, 9
    v_add_u32 v94, s92, v1
    v_lshl_add_u32 v123, v94, 2, s85
    v_lshlrev_b32 v94, 1, v94
    v_sub_u32 v90, 544, v94
    v_cvt_f32_i32 v91, v90
    v_cvt_pk_bf16_f32 v91, v91, v91
    v_and_b32 v91, 0xffff, v91
    v_subrev_u32 v91, 0x4280, v91
    v_cmp_gt_u32 vcc, 0x100, v90
    s_nop 1
    v_cndmask_b32 v91, v91, v90, vcc
    v_mov_b32 v92, 641
    v_cmp_lt_u32 vcc, 0x20d, v90
    s_nop 1
    v_cndmask_b32 v91, v91, v92, vcc
    v_lshl_add_u32 v116, v91, 1, s93
    v_add_u32 v94, 1, v94
    v_sub_u32 v90, 544, v94
    v_cvt_f32_i32 v91, v90
    v_cvt_pk_bf16_f32 v91, v91, v91
    v_and_b32 v91, 0xffff, v91
    v_subrev_u32 v91, 0x4280, v91
    v_cmp_gt_u32 vcc, 0x100, v90
    s_nop 1
    v_cndmask_b32 v91, v91, v90, vcc
    v_mov_b32 v92, 641
    v_cmp_lt_u32 vcc, 0x20d, v90
    s_nop 1
    v_cndmask_b32 v91, v91, v92, vcc
    v_lshl_add_u32 v117, v91, 1, s93
    v_add_u32 v94, 1, v94
    v_sub_u32 v90, 544, v94
    v_cvt_f32_i32 v91, v90
    v_cvt_pk_bf16_f32 v91, v91, v91
    v_and_b32 v91, 0xffff, v91
    v_subrev_u32 v91, 0x4280, v91
    v_cmp_gt_u32 vcc, 0x100, v90
    s_nop 1
    v_cndmask_b32 v91, v91, v90, vcc
    v_mov_b32 v92, 641
    v_cmp_lt_u32 vcc, 0x20d, v90
    s_nop 1
    v_cndmask_b32 v91, v91, v92, vcc
    v_lshl_add_u32 v118, v91, 1, s93
    v_lshlrev_b32 v7, 3, v2
    s_cmp_eq_u32 s86, 1
    s_cbranch_scc1 PRE_2
    s_cmp_eq_u32 s86, 2
    s_cbranch_scc1 PRE_3
    s_cmp_eq_u32 s86, 3
    s_cbranch_scc1 PRE_4
    v_lshlrev_b32 v95, 1, v1
    v_sub_u32 v94, 93, v95
    v_lshlrev_b32 v91, 1, v94
    v_add_u32 v91, 389, v91
    v_mov_b32 v92, 641
    v_cmp_lt_u32 vcc, 61, v94
    s_nop 1
    v_cndmask_b32 v91, v91, v92, vcc
    v_lshl_add_u32 v119, v91, 1, s93
    v_sub_u32 v94, 92, v95
    v_lshlrev_b32 v91, 1, v94
    v_add_u32 v91, 389, v91
    v_mov_b32 v92, 641
    v_cmp_lt_u32 vcc, 61, v94
    s_nop 1
    v_cndmask_b32 v91, v91, v92, vcc
    v_lshl_add_u32 v120, v91, 1, s93
    v_sub_u32 v94, 94, v95
    v_lshlrev_b32 v91, 1, v94
    v_add_u32 v91, 388, v91
    v_mov_b32 v92, 641
    v_cmp_lt_u32 vcc, 62, v94
    s_nop 1
    v_cndmask_b32 v91, v91, v92, vcc
    v_lshl_add_u32 v121, v91, 1, s93
    v_sub_u32 v94, 93, v95
    v_lshlrev_b32 v91, 1, v94
    v_add_u32 v91, 388, v91
    v_mov_b32 v92, 641
    v_cmp_lt_u32 vcc, 62, v94
    s_nop 1
    v_cndmask_b32 v91, v91, v92, vcc
    v_lshl_add_u32 v122, v91, 1, s93
    v_lshl_add_u32 v124, v1, 2, s85
    v_add_u32 v125, 35344, v124
    v_add_u32 v124, 35088, v124
    v_lshrrev_b32 v94, 1, v3
    v_lshl_add_u32 v7, v94, 7, v7
    v_and_b32 v94, 1, v3
    v_lshl_add_u32 v7, v94, 2, v7
    v_mov_b32 v94, 1
    v_mov_b32 v95, 2
    v_mov_b32 v96, v7
    v_add_u32 v97, v7, v94
    v_add_u32 v98, v7, v95
    v_add_u32 v99, v97, v95
    v_cvt_f32_u32 v108, v96
    v_lshrrev_b32 v91, 16, v108
    v_subrev_u32 v91, 0x4280, v91
    v_cmp_gt_u32 vcc, 0x80, v96
    s_nop 1
    v_cndmask_b32 v91, v91, v96, vcc
    v_mov_b32 v92, 642
    v_cmp_lt_u32 vcc, 0x800, v96
    s_nop 1
    v_cndmask_b32 v91, v91, v92, vcc
    v_lshl_add_u32 v112, v91, 1, s93
    v_cvt_f32_u32 v109, v97
    v_lshrrev_b32 v91, 16, v109
    v_subrev_u32 v91, 0x4280, v91
    v_cmp_gt_u32 vcc, 0x80, v97
    s_nop 1
    v_cndmask_b32 v91, v91, v97, vcc
    v_mov_b32 v92, 642
    v_cmp_lt_u32 vcc, 0x800, v97
    s_nop 1
    v_cndmask_b32 v91, v91, v92, vcc
    v_lshl_add_u32 v113, v91, 1, s93
    v_cvt_f32_u32 v110, v98
    v_lshrrev_b32 v91, 16, v110
    v_subrev_u32 v91, 0x4280, v91
    v_cmp_gt_u32 vcc, 0x80, v98
    s_nop 1
    v_cndmask_b32 v91, v91, v98, vcc
    v_mov_b32 v92, 642
    v_cmp_lt_u32 vcc, 0x800, v98
    s_nop 1
    v_cndmask_b32 v91, v91, v92, vcc
    v_lshl_add_u32 v114, v91, 1, s93
    v_cvt_f32_u32 v111, v99
    v_lshrrev_b32 v91, 16, v111
    v_subrev_u32 v91, 0x4280, v91
    v_cmp_gt_u32 vcc, 0x80, v99
    s_nop 1
    v_cndmask_b32 v91, v91, v99, vcc
    v_mov_b32 v92, 642
    v_cmp_lt_u32 vcc, 0x800, v99
    s_nop 1
    v_cndmask_b32 v91, v91, v92, vcc
    v_lshl_add_u32 v115, v91, 1, s93
    s_branch PREJ_5
PRE_2:
    v_min_u32 v96, 47, v1
    v_lshlrev_b32 v95, 1, v96
    v_sub_u32 v94, 64, v95
    v_lshlrev_b32 v91, 1, v94
    v_add_u32 v91, 513, v91
    v_mov_b32 v92, 641
    v_cmp_lt_u32 vcc, 63, v94
    s_nop 1
    v_cndmask_b32 v91, v91, v92, vcc
    v_lshl_add_u32 v119, v91, 1, s93
    v_sub_u32 v94, 63, v95
    v_lshlrev_b32 v91, 1, v94
    v_add_u32 v91, 513, v91
    v_mov_b32 v92, 641
    v_cmp_lt_u32 vcc, 63, v94
    s_nop 1
    v_cndmask_b32 v91, v91, v92, vcc
    v_lshl_add_u32 v120, v91, 1, s93
    v_sub_u32 v94, 62, v95
    v_lshlrev_b32 v91, 1, v94
    v_add_u32 v91, 513, v91
    v_mov_b32 v92, 641
    v_cmp_lt_u32 vcc, 63, v94
    s_nop 1
    v_cndmask_b32 v91, v91, v92, vcc
    v_lshl_add_u32 v122, v91, 1, s93
    v_mov_b32 v121, v120
    v_lshl_add_u32 v124, v96, 2, s85
    v_add_u32 v125, 35792, v124
    v_add_u32 v124, 35600, v124
    v_lshl_add_u32 v94, v3, 7, v7
    v_add_u32 v94, 256, v94
    v_lshl_add_u32 v7, v3, 8, v7
    v_cmp_gt_u32 vcc, 2, v3
    s_nop 1
    v_cndmask_b32 v7, v7, v94, vcc
    v_mov_b32 v94, 4
    v_mov_b32 v95, 0x80
    v_cndmask_b32 v94, v94, 2, vcc
    v_cndmask_b32 v95, v95, 4, vcc
    v_mov_b32 v96, v7
    v_add_u32 v97, v7, v94
    v_add_u32 v98, v7, v95
    v_add_u32 v99, v97, v95
    v_cvt_f32_u32 v108, v96
    v_lshrrev_b32 v91, 16, v108
    v_subrev_u32 v91, 0x4280, v91
    v_cmp_gt_u32 vcc, 0x80, v96
    s_nop 1
    v_cndmask_b32 v91, v91, v96, vcc
    v_mov_b32 v92, 642
    v_cmp_lt_u32 vcc, 0x800, v96
    s_nop 1
    v_cndmask_b32 v91, v91, v92, vcc
    v_lshl_add_u32 v112, v91, 1, s93
    v_cvt_f32_u32 v109, v97
    v_lshrrev_b32 v91, 16, v109
    v_subrev_u32 v91, 0x4280, v91
    v_cmp_gt_u32 vcc, 0x80, v97
    s_nop 1
    v_cndmask_b32 v91, v91, v97, vcc
    v_mov_b32 v92, 642
    v_cmp_lt_u32 vcc, 0x800, v97
    s_nop 1
    v_cndmask_b32 v91, v91, v92, vcc
    v_lshl_add_u32 v113, v91, 1, s93
    v_cvt_f32_u32 v110, v98
    v_lshrrev_b32 v91, 16, v110
    v_subrev_u32 v91, 0x4280, v91
    v_cmp_gt_u32 vcc, 0x80, v98
    s_nop 1
    v_cndmask_b32 v91, v91, v98, vcc
    v_mov_b32 v92, 642
    v_cmp_lt_u32 vcc, 0x800, v98
    s_nop 1
    v_cndmask_b32 v91, v91, v92, vcc
    v_lshl_add_u32 v114, v91, 1, s93
    v_cvt_f32_u32 v111, v99
    v_lshrrev_b32 v91, 16, v111
    v_subrev_u32 v91, 0x4280, v91
    v_cmp_gt_u32 vcc, 0x80, v99
    s_nop 1
    v_cndmask_b32 v91, v91, v99, vcc
    v_mov_b32 v92, 642
    v_cmp_lt_u32 vcc, 0x800, v99
    s_nop 1
    v_cndmask_b32 v91, v91, v92, vcc
    v_lshl_add_u32 v115, v91, 1, s93
    s_branch PREJ_5
PRE_3:
    v_min_u32 v96, 47, v1
    v_lshlrev_b32 v95, 1, v96
    v_sub_u32 v94, 64, v95
    v_lshlrev_b32 v91, 1, v94
    v_add_u32 v91, 514, v91
    v_mov_b32 v92, 641
    v_cmp_lt_u32 vcc, 63, v94
    s_nop 1
    v_cndmask_b32 v91, v91, v92, vcc
    v_lshl_add_u32 v119, v91, 1, s93
    v_sub_u32 v94, 63, v95
    v_lshlrev_b32 v91, 1, v94
    v_add_u32 v91, 514, v91
    v_mov_b32 v92, 641
    v_cmp_lt_u32 vcc, 63, v94
    s_nop 1
    v_cndmask_b32 v91, v91, v92, vcc
    v_lshl_add_u32 v120, v91, 1, s93
    v_sub_u32 v94, 62, v95
    v_lshlrev_b32 v91, 1, v94
    v_add_u32 v91, 514, v91
    v_mov_b32 v92, 641
    v_cmp_lt_u32 vcc, 63, v94
    s_nop 1
    v_cndmask_b32 v91, v91, v92, vcc
    v_lshl_add_u32 v122, v91, 1, s93
    v_mov_b32 v121, v120
    v_lshl_add_u32 v124, v96, 2, s85
    v_add_u32 v125, 36176, v124
    v_add_u32 v124, 35984, v124
    v_lshl_add_u32 v7, v3, 9, v7
    v_add_u32 v7, 0x400, v7
    v_mov_b32 v94, 0x80
    v_mov_b32 v95, 0x100
    v_mov_b32 v96, v7
    v_add_u32 v97, v7, v94
    v_add_u32 v98, v7, v95
    v_add_u32 v99, v97, v95
    v_cvt_f32_u32 v108, v96
    v_lshrrev_b32 v91, 16, v108
    v_subrev_u32 v91, 0x4280, v91
    v_cmp_gt_u32 vcc, 0x80, v96
    s_nop 1
    v_cndmask_b32 v91, v91, v96, vcc
    v_mov_b32 v92, 642
    v_cmp_lt_u32 vcc, 0x800, v96
    s_nop 1
    v_cndmask_b32 v91, v91, v92, vcc
    v_lshl_add_u32 v112, v91, 1, s93
    v_cvt_f32_u32 v109, v97
    v_lshrrev_b32 v91, 16, v109
    v_subrev_u32 v91, 0x4280, v91
    v_cmp_gt_u32 vcc, 0x80, v97
    s_nop 1
    v_cndmask_b32 v91, v91, v97, vcc
    v_mov_b32 v92, 642
    v_cmp_lt_u32 vcc, 0x800, v97
    s_nop 1
    v_cndmask_b32 v91, v91, v92, vcc
    v_lshl_add_u32 v113, v91, 1, s93
    v_cvt_f32_u32 v110, v98
    v_lshrrev_b32 v91, 16, v110
    v_subrev_u32 v91, 0x4280, v91
    v_cmp_gt_u32 vcc, 0x80, v98
    s_nop 1
    v_cndmask_b32 v91, v91, v98, vcc
    v_mov_b32 v92, 642
    v_cmp_lt_u32 vcc, 0x800, v98
    s_nop 1
    v_cndmask_b32 v91, v91, v92, vcc
    v_lshl_add_u32 v114, v91, 1, s93
    v_cvt_f32_u32 v111, v99
    v_lshrrev_b32 v91, 16, v111
    v_subrev_u32 v91, 0x4280, v91
    v_cmp_gt_u32 vcc, 0x80, v99
    s_nop 1
    v_cndmask_b32 v91, v91, v99, vcc
    v_mov_b32 v92, 642
    v_cmp_lt_u32 vcc, 0x800, v99
    s_nop 1
    v_cndmask_b32 v91, v91, v92, vcc
    v_lshl_add_u32 v115, v91, 1, s93
    s_branch PREJ_5
PRE_4:
    v_add_u32 v96, 0x100, v1
    v_cmp_gt_u32 vcc, 9, v1
    s_nop 1
    v_cndmask_b32 v96, v96, v1, vcc
    v_lshlrev_b32 v94, 1, v96
    v_sub_u32 v90, 544, v94
    v_cvt_f32_i32 v91, v90
    v_cvt_pk_bf16_f32 v91, v91, v91
    v_and_b32 v91, 0xffff, v91
    v_subrev_u32 v91, 0x4280, v91
    v_cmp_gt_u32 vcc, 0x100, v90
    s_nop 1
    v_cndmask_b32 v91, v91, v90, vcc
    v_mov_b32 v92, 641
    v_cmp_lt_u32 vcc, 0x20d, v90
    s_nop 1
    v_cndmask_b32 v91, v91, v92, vcc
    v_or_b32 v90, 1, v94
    v_mov_b32 v92, 0x200
    v_cmp_eq_u32 vcc, 0x25d, v90
    s_nop 1
    v_cndmask_b32 v91, v91, v92, vcc
    v_lshl_add_u32 v119, v91, 1, s93
    v_add_u32 v94, 1, v94
    v_sub_u32 v90, 544, v94
    v_cvt_f32_i32 v91, v90
    v_cvt_pk_bf16_f32 v91, v91, v91
    v_and_b32 v91, 0xffff, v91
    v_subrev_u32 v91, 0x4280, v91
    v_cmp_gt_u32 vcc, 0x100, v90
    s_nop 1
    v_cndmask_b32 v91, v91, v90, vcc
    v_mov_b32 v92, 641
    v_cmp_lt_u32 vcc, 0x20d, v90
    s_nop 1
    v_cndmask_b32 v91, v91, v92, vcc
    v_or_b32 v90, 1, v94
    v_mov_b32 v92, 0x200
    v_cmp_eq_u32 vcc, 0x25d, v90
    s_nop 1
    v_cndmask_b32 v91, v91, v92, vcc
    v_lshl_add_u32 v120, v91, 1, s93
    v_add_u32 v94, 1, v94
    v_sub_u32 v90, 544, v94
    v_cvt_f32_i32 v91, v90
    v_cvt_pk_bf16_f32 v91, v91, v91
    v_and_b32 v91, 0xffff, v91
    v_subrev_u32 v91, 0x4280, v91
    v_cmp_gt_u32 vcc, 0x100, v90
    s_nop 1
    v_cndmask_b32 v91, v91, v90, vcc
    v_mov_b32 v92, 641
    v_cmp_lt_u32 vcc, 0x20d, v90
    s_nop 1
    v_cndmask_b32 v91, v91, v92, vcc
    v_or_b32 v90, 1, v94
    v_mov_b32 v92, 0x200
    v_cmp_eq_u32 vcc, 0x25d, v90
    s_nop 1
    v_cndmask_b32 v91, v91, v92, vcc
    v_lshl_add_u32 v122, v91, 1, s93
    v_mov_b32 v121, v120
    v_lshl_add_u32 v124, v96, 2, s85
    v_add_u32 v125, 33808, v124
    v_add_u32 v124, 32528, v124
    v_mov_b32 v94, s85
    ds_write_b16 v94, v4 offset:32514
PREJ_5:
    s_waitcnt vmcnt(7)
    v_lshlrev_b32 v16, 16, v16
    v_mul_f32 v17, 0x3fb8aa3b, v16
    s_mov_b32 s92, 0x3fb8aa3b
    s_mov_b32 s93, 0x32a57060
    v_fma_f32 v18, v16, s92, -v17
    v_fma_f32 v18, v16, s93, v18
    v_exp_f32 v17, v17
    v_mul_f32 v18, 0x3f317218, v18
    v_fma_f32 v17, v17, v18, v17
    v_cvt_pk_bf16_f32 v17, v17, v17
    v_and_b32 v16, 0xffff0000, v17
    v_mov_b32 v17, v16
    s_waitcnt vmcnt(1)
    ds_write_b32 v4, v5 offset:36
    v_lshlrev_b32 v20, 16, v8
    v_and_b32 v21, 0xffff0000, v8
    v_lshlrev_b32 v22, 16, v9
    v_and_b32 v23, 0xffff0000, v9
    v_lshlrev_b32 v24, 16, v10
    v_and_b32 v25, 0xffff0000, v10
    v_lshlrev_b32 v26, 16, v11
    v_and_b32 v27, 0xffff0000, v11
    v_lshlrev_b32 v28, 16, v12
    v_and_b32 v29, 0xffff0000, v12
    v_lshlrev_b32 v30, 16, v13
    v_and_b32 v31, 0xffff0000, v13
    v_pk_mul_f32 v[20:21], v[20:21], v[16:17]
    v_pk_mul_f32 v[22:23], v[22:23], v[16:17]
    v_pk_mul_f32 v[24:25], v[24:25], v[16:17]
    v_pk_mul_f32 v[26:27], v[26:27], v[16:17]
    v_pk_mul_f32 v[90:91], v[30:31], v[26:27]
    v_pk_mul_f32 v[92:93], v[30:31], v[24:25]
    v_pk_fma_f32 v[34:35], v[28:29], v[26:27], v[92:93]
    v_pk_fma_f32 v[32:33], v[28:29], v[24:25], v[90:91] neg_lo:[0,0,1] neg_hi:[0,0,1]
    v_max_f32 v36, v20, v21
    v_add_f32 v37, abs(v32), abs(v33)
    v_add_f32 v38, abs(v34), abs(v35)
    v_add_f32 v37, v37, v38
    v_max_f32_dpp v36, v36, v36 row_ror:8 row_mask:0xf bank_mask:0xf
    s_nop 0
    v_add_f32_dpp v37, v37, v37 row_ror:8 row_mask:0xf bank_mask:0xf
    v_max_f32_dpp v36, v36, v36 row_ror:4 row_mask:0xf bank_mask:0xf
    s_nop 0
    v_add_f32_dpp v37, v37, v37 row_ror:4 row_mask:0xf bank_mask:0xf
    v_max_f32_dpp v36, v36, v36 row_ror:2 row_mask:0xf bank_mask:0xf
    s_nop 0
    v_add_f32_dpp v37, v37, v37 row_ror:2 row_mask:0xf bank_mask:0xf
    v_max_f32_dpp v36, v36, v36 row_ror:1 row_mask:0xf bank_mask:0xf
    s_nop 0
    v_add_f32_dpp v37, v37, v37 row_ror:1 row_mask:0xf bank_mask:0xf
    v_mov_b32 v38, v36
    v_mov_b32 v39, v37
    s_nop 0
    v_permlane16_swap_b32 v36, v38
    v_permlane16_swap_b32 v37, v39
    v_max_f32 v36, v36, v38
    v_add_f32 v37, v37, v39
    v_mov_b32 v38, v36
    v_mov_b32 v39, v37
    s_nop 0
    v_permlane32_swap_b32 v36, v38
    v_permlane32_swap_b32 v37, v39
    v_max_f32 v36, v36, v38
    v_add_f32 v37, v37, v39
    v_max_f32 v37, 0x03aa2425, v37
    v_rcp_f32 v38, v37
    v_sub_f32 v20, v20, v36
    v_sub_f32 v21, v21, v36
    v_mul_f32 v38, 0x47000000, v38
    v_mov_b32 v39, v38
    v_mul_f32 v20, 0x3fb8aa3b, v20
    v_mul_f32 v21, 0x3fb8aa3b, v21
    v_mul_f32 v36, 0x3fb8aa3b, v36
    v_pk_mul_f32 v[32:33], v[32:33], v[38:39]
    v_pk_mul_f32 v[34:35], v[34:35], v[38:39]
    s_mov_b32 s92, 0x3e22f983
    s_mov_b32 s93, 0x31dc9c88
    v_lshl_add_u32 v6, v1, 3, s85
    s_cmp_eq_u32 s86, 1
    s_cbranch_scc1 JOB_7
    s_cmp_eq_u32 s86, 2
    s_cbranch_scc1 JOB_8
    s_cmp_eq_u32 s86, 3
    s_cbranch_scc1 JOB_9
    v_mul_f32 v90, 0x3f800000, v20
    v_mul_f32 v91, 0x3f800000, v22
    v_mul_f32 v94, 0x3f800000, v21
    v_mul_f32 v95, 0x3f800000, v23
    v_exp_f32 v90, v90
    v_mul_f32 v92, s92, v91
    v_exp_f32 v94, v94
    v_mul_f32 v96, s92, v95
    v_rndne_f32 v92, v92
    v_rndne_f32 v96, v96
    v_fma_f32 v92, v91, s92, -v92
    v_fma_f32 v96, v95, s92, -v96
    v_fma_f32 v92, v91, s93, v92
    v_fma_f32 v96, v95, s93, v96
    v_cos_f32 v91, v92
    v_sin_f32 v92, v92
    v_cos_f32 v95, v96
    v_sin_f32 v96, v96
    v_mul_f32 v40, v90, v91
    v_mul_f32 v42, v90, v92
    v_mul_f32 v41, v94, v95
    v_mul_f32 v43, v94, v96
    v_mul_f32 v90, 0x43000000, v20
    v_mul_f32 v91, 0x43000000, v22
    v_mul_f32 v94, 0x43000000, v21
    v_mul_f32 v95, 0x43000000, v23
    v_exp_f32 v90, v90
    v_mul_f32 v92, s92, v91
    v_exp_f32 v94, v94
    v_mul_f32 v96, s92, v95
    v_rndne_f32 v92, v92
    v_rndne_f32 v96, v96
    v_fma_f32 v92, v91, s92, -v92
    v_fma_f32 v96, v95, s92, -v96
    v_fma_f32 v92, v91, s93, v92
    v_fma_f32 v96, v95, s93, v96
    v_cos_f32 v91, v92
    v_sin_f32 v92, v92
    v_cos_f32 v95, v96
    v_sin_f32 v96, v96
    v_mul_f32 v44, v90, v91
    v_mul_f32 v46, v90, v92
    v_mul_f32 v45, v94, v95
    v_mul_f32 v47, v94, v96
    v_cvt_pk_f16_f32 v98, v32, v34
    v_cvt_pk_f16_f32 v99, v33, v35
    ds_write_b64 v6, v[98:99] offset:0
    v_pk_mul_f32 v[90:91], v[34:35], v[46:47]
    v_pk_mul_f32 v[92:93], v[34:35], v[44:45]
    v_pk_fma_f32 v[62:63], v[32:33], v[46:47], v[92:93]
    v_pk_fma_f32 v[60:61], v[32:33], v[44:45], v[90:91] neg_lo:[0,0,1] neg_hi:[0,0,1]
    v_pk_mul_f32 v[94:95], v[34:35], v[42:43]
    v_pk_mul_f32 v[96:97], v[34:35], v[40:41]
    v_pk_fma_f32 v[54:55], v[32:33], v[42:43], v[96:97]
    v_pk_fma_f32 v[52:53], v[32:33], v[40:41], v[94:95] neg_lo:[0,0,1] neg_hi:[0,0,1]
    v_cvt_pk_f16_f32 v100, v60, v62
    v_cvt_pk_f16_f32 v101, v61, v63
    ds_write_b64 v6, v[100:101] offset:4352
    v_cvt_pk_f16_f32 v98, v52, v54
    v_cvt_pk_f16_f32 v99, v53, v55
    ds_write_b64 v6, v[98:99] offset:544
    v_pk_mul_f32 v[90:91], v[54:55], v[46:47]
    v_pk_mul_f32 v[92:93], v[54:55], v[44:45]
    v_pk_fma_f32 v[62:63], v[52:53], v[46:47], v[92:93]
    v_pk_fma_f32 v[60:61], v[52:53], v[44:45], v[90:91] neg_lo:[0,0,1] neg_hi:[0,0,1]
    v_pk_mul_f32 v[94:95], v[54:55], v[42:43]
    v_pk_mul_f32 v[96:97], v[54:55], v[40:41]
    v_pk_fma_f32 v[58:59], v[52:53], v[42:43], v[96:97]
    v_pk_fma_f32 v[56:57], v[52:53], v[40:41], v[94:95] neg_lo:[0,0,1] neg_hi:[0,0,1]
    v_cvt_pk_f16_f32 v100, v60, v62
    v_cvt_pk_f16_f32 v101, v61, v63
    ds_write_b64 v6, v[100:101] offset:4896
    v_cvt_pk_f16_f32 v98, v56, v58
    v_cvt_pk_f16_f32 v99, v57, v59
    ds_write_b64 v6, v[98:99] offset:1088
    v_pk_mul_f32 v[90:91], v[58:59], v[46:47]
    v_pk_mul_f32 v[92:93], v[58:59], v[44:45]
    v_pk_fma_f32 v[62:63], v[56:57], v[46:47], v[92:93]
    v_pk_fma_f32 v[60:61], v[56:57], v[44:45], v[90:91] neg_lo:[0,0,1] neg_hi:[0,0,1]
    v_pk_mul_f32 v[94:95], v[58:59], v[42:43]
    v_pk_mul_f32 v[96:97], v[58:59], v[40:41]
    v_pk_fma_f32 v[54:55], v[56:57], v[42:43], v[96:97]
    v_pk_fma_f32 v[52:53], v[56:57], v[40:41], v[94:95] neg_lo:[0,0,1] neg_hi:[0,0,1]
    v_cvt_pk_f16_f32 v100, v60, v62
    v_cvt_pk_f16_f32 v101, v61, v63
    ds_write_b64 v6, v[100:101] offset:5440
    v_cvt_pk_f16_f32 v98, v52, v54
    v_cvt_pk_f16_f32 v99, v53, v55
    ds_write_b64 v6, v[98:99] offset:1632
    v_pk_mul_f32 v[90:91], v[54:55], v[46:47]
    v_pk_mul_f32 v[92:93], v[54:55], v[44:45]
    v_pk_fma_f32 v[62:63], v[52:53], v[46:47], v[92:93]
    v_pk_fma_f32 v[60:61], v[52:53], v[44:45], v[90:91] neg_lo:[0,0,1] neg_hi:[0,0,1]
    v_pk_mul_f32 v[94:95], v[54:55], v[42:43]
    v_pk_mul_f32 v[96:97], v[54:55], v[40:41]
    v_pk_fma_f32 v[58:59], v[52:53], v[42:43], v[96:97]
    v_pk_fma_f32 v[56:57], v[52:53], v[40:41], v[94:95] neg_lo:[0,0,1] neg_hi:[0,0,1]
    v_cvt_pk_f16_f32 v100, v60, v62
    v_cvt_pk_f16_f32 v101, v61, v63
    ds_write_b64 v6, v[100:101] offset:5984
    v_cvt_pk_f16_f32 v98, v56, v58
    v_cvt_pk_f16_f32 v99, v57, v59
    ds_write_b64 v6, v[98:99] offset:2176
    v_pk_mul_f32 v[90:91], v[58:59], v[46:47]
    v_pk_mul_f32 v[92:93], v[58:59], v[44:45]
    v_pk_fma_f32 v[62:63], v[56:57], v[46:47], v[92:93]
    v_pk_fma_f32 v[60:61], v[56:57], v[44:45], v[90:91] neg_lo:[0,0,1] neg_hi:[0,0,1]
    v_pk_mul_f32 v[94:95], v[58:59], v[42:43]
    v_pk_mul_f32 v[96:97], v[58:59], v[40:41]
    v_pk_fma_f32 v[54:55], v[56:57], v[42:43], v[96:97]
    v_pk_fma_f32 v[52:53], v[56:57], v[40:41], v[94:95] neg_lo:[0,0,1] neg_hi:[0,0,1]
    v_cvt_pk_f16_f32 v100, v60, v62
    v_cvt_pk_f16_f32 v101, v61, v63
    ds_write_b64 v6, v[100:101] offset:6528
    v_cvt_pk_f16_f32 v98, v52, v54
    v_cvt_pk_f16_f32 v99, v53, v55
    ds_write_b64 v6, v[98:99] offset:2720
    v_pk_mul_f32 v[90:91], v[54:55], v[46:47]
    v_pk_mul_f32 v[92:93], v[54:55], v[44:45]
    v_pk_fma_f32 v[62:63], v[52:53], v[46:47], v[92:93]
    v_pk_fma_f32 v[60:61], v[52:53], v[44:45], v[90:91] neg_lo:[0,0,1] neg_hi:[0,0,1]
    v_pk_mul_f32 v[94:95], v[54:55], v[42:43]
    v_pk_mul_f32 v[96:97], v[54:55], v[40:41]
    v_pk_fma_f32 v[58:59], v[52:53], v[42:43], v[96:97]
    v_pk_fma_f32 v[56:57], v[52:53], v[40:41], v[94:95] neg_lo:[0,0,1] neg_hi:[0,0,1]
    v_cvt_pk_f16_f32 v100, v60, v62
    v_cvt_pk_f16_f32 v101, v61, v63
    ds_write_b64 v6, v[100:101] offset:7072
    v_cvt_pk_f16_f32 v98, v56, v58
    v_cvt_pk_f16_f32 v99, v57, v59
    ds_write_b64 v6, v[98:99] offset:3264
    v_pk_mul_f32 v[90:91], v[58:59], v[46:47]
    v_pk_mul_f32 v[92:93], v[58:59], v[44:45]
    v_pk_fma_f32 v[62:63], v[56:57], v[46:47], v[92:93]
    v_pk_fma_f32 v[60:61], v[56:57], v[44:45], v[90:91] neg_lo:[0,0,1] neg_hi:[0,0,1]
    v_pk_mul_f32 v[94:95], v[58:59], v[42:43]
    v_pk_mul_f32 v[96:97], v[58:59], v[40:41]
    v_pk_fma_f32 v[54:55], v[56:57], v[42:43], v[96:97]
    v_pk_fma_f32 v[52:53], v[56:57], v[40:41], v[94:95] neg_lo:[0,0,1] neg_hi:[0,0,1]
    v_cvt_pk_f16_f32 v100, v60, v62
    v_cvt_pk_f16_f32 v101, v61, v63
    ds_write_b64 v6, v[100:101] offset:7616
    v_cvt_pk_f16_f32 v98, v52, v54
    v_cvt_pk_f16_f32 v99, v53, v55
    ds_write_b64 v6, v[98:99] offset:3808
    v_pk_mul_f32 v[90:91], v[54:55], v[46:47]
    v_pk_mul_f32 v[92:93], v[54:55], v[44:45]
    v_pk_fma_f32 v[62:63], v[52:53], v[46:47], v[92:93]
    v_pk_fma_f32 v[60:61], v[52:53], v[44:45], v[90:91] neg_lo:[0,0,1] neg_hi:[0,0,1]
    v_cvt_pk_f16_f32 v100, v60, v62
    v_cvt_pk_f16_f32 v101, v61, v63
    ds_write_b64 v6, v[100:101] offset:8160
    s_branch JOBJ_10
JOB_7:
    v_mul_f32 v90, 0x40000000, v20
    v_mul_f32 v91, 0x40000000, v22
    v_mul_f32 v94, 0x40000000, v21
    v_mul_f32 v95, 0x40000000, v23
    v_exp_f32 v90, v90
    v_mul_f32 v92, s92, v91
    v_exp_f32 v94, v94
    v_mul_f32 v96, s92, v95
    v_rndne_f32 v92, v92
    v_rndne_f32 v96, v96
    v_fma_f32 v92, v91, s92, -v92
    v_fma_f32 v96, v95, s92, -v96
    v_fma_f32 v92, v91, s93, v92
    v_fma_f32 v96, v95, s93, v96
    v_cos_f32 v91, v92
    v_sin_f32 v92, v92
    v_cos_f32 v95, v96
    v_sin_f32 v96, v96
    v_mul_f32 v40, v90, v91
    v_mul_f32 v42, v90, v92
    v_mul_f32 v41, v94, v95
    v_mul_f32 v43, v94, v96
    v_mul_f32 v90, 0x43000000, v20
    v_mul_f32 v91, 0x43000000, v22
    v_mul_f32 v94, 0x43000000, v21
    v_mul_f32 v95, 0x43000000, v23
    v_exp_f32 v90, v90
    v_mul_f32 v92, s92, v91
    v_exp_f32 v94, v94
    v_mul_f32 v96, s92, v95
    v_rndne_f32 v92, v92
    v_rndne_f32 v96, v96
    v_fma_f32 v92, v91, s92, -v92
    v_fma_f32 v96, v95, s92, -v96
    v_fma_f32 v92, v91, s93, v92
    v_fma_f32 v96, v95, s93, v96
    v_cos_f32 v91, v92
    v_sin_f32 v92, v92
    v_cos_f32 v95, v96
    v_sin_f32 v96, v96
    v_mul_f32 v44, v90, v91
    v_mul_f32 v46, v90, v92
    v_mul_f32 v45, v94, v95
    v_mul_f32 v47, v94, v96
    v_mul_f32 v90, 0x43800000, v20
    v_mul_f32 v91, 0x43800000, v22
    v_mul_f32 v94, 0x43800000, v21
    v_mul_f32 v95, 0x43800000, v23
    v_exp_f32 v90, v90
    v_mul_f32 v92, s92, v91
    v_exp_f32 v94, v94
    v_mul_f32 v96, s92, v95
    v_rndne_f32 v92, v92
    v_rndne_f32 v96, v96
    v_fma_f32 v92, v91, s92, -v92
    v_fma_f32 v96, v95, s92, -v96
    v_fma_f32 v92, v91, s93, v92
    v_fma_f32 v96, v95, s93, v96
    v_cos_f32 v91, v92
    v_sin_f32 v92, v92
    v_cos_f32 v95, v96
    v_sin_f32 v96, v96
    v_mul_f32 v48, v90, v91
    v_mul_f32 v50, v90, v92
    v_mul_f32 v49, v94, v95
    v_mul_f32 v51, v94, v96
    v_pk_mul_f32 v[90:91], v[34:35], v[50:51]
    v_pk_mul_f32 v[92:93], v[34:35], v[48:49]
    v_pk_fma_f32 v[54:55], v[32:33], v[50:51], v[92:93]
    v_pk_fma_f32 v[52:53], v[32:33], v[48:49], v[90:91] neg_lo:[0,0,1] neg_hi:[0,0,1]
    v_pk_mul_f32 v[94:95], v[54:55], v[50:51]
    v_pk_mul_f32 v[96:97], v[54:55], v[48:49]
    v_pk_fma_f32 v[66:67], v[52:53], v[50:51], v[96:97]
    v_pk_fma_f32 v[64:65], v[52:53], v[48:49], v[94:95] neg_lo:[0,0,1] neg_hi:[0,0,1]
    v_cvt_pk_f16_f32 v98, v52, v54
    v_cvt_pk_f16_f32 v99, v53, v55
    ds_write_b64 v6, v[98:99] offset:8704
    v_pk_mul_f32 v[90:91], v[54:55], v[46:47]
    v_pk_mul_f32 v[92:93], v[54:55], v[44:45]
    v_pk_fma_f32 v[62:63], v[52:53], v[46:47], v[92:93]
    v_pk_fma_f32 v[60:61], v[52:53], v[44:45], v[90:91] neg_lo:[0,0,1] neg_hi:[0,0,1]
    v_pk_mul_f32 v[94:95], v[54:55], v[42:43]
    v_pk_mul_f32 v[96:97], v[54:55], v[40:41]
    v_pk_fma_f32 v[58:59], v[52:53], v[42:43], v[96:97]
    v_pk_fma_f32 v[56:57], v[52:53], v[40:41], v[94:95] neg_lo:[0,0,1] neg_hi:[0,0,1]
    v_cvt_pk_f16_f32 v100, v60, v62
    v_cvt_pk_f16_f32 v101, v61, v63
    ds_write_b64 v6, v[100:101] offset:10880
    v_cvt_pk_f16_f32 v98, v56, v58
    v_cvt_pk_f16_f32 v99, v57, v59
    ds_write_b64 v6, v[98:99] offset:9248
    v_pk_mul_f32 v[90:91], v[58:59], v[46:47]
    v_pk_mul_f32 v[92:93], v[58:59], v[44:45]
    v_pk_fma_f32 v[62:63], v[56:57], v[46:47], v[92:93]
    v_pk_fma_f32 v[60:61], v[56:57], v[44:45], v[90:91] neg_lo:[0,0,1] neg_hi:[0,0,1]
    v_pk_mul_f32 v[94:95], v[58:59], v[42:43]
    v_pk_mul_f32 v[96:97], v[58:59], v[40:41]
    v_pk_fma_f32 v[54:55], v[56:57], v[42:43], v[96:97]
    v_pk_fma_f32 v[52:53], v[56:57], v[40:41], v[94:95] neg_lo:[0,0,1] neg_hi:[0,0,1]
    v_cvt_pk_f16_f32 v100, v60, v62
    v_cvt_pk_f16_f32 v101, v61, v63
    ds_write_b64 v6, v[100:101] offset:11424
    v_cvt_pk_f16_f32 v98, v52, v54
    v_cvt_pk_f16_f32 v99, v53, v55
    ds_write_b64 v6, v[98:99] offset:9792
    v_pk_mul_f32 v[90:91], v[54:55], v[46:47]
    v_pk_mul_f32 v[92:93], v[54:55], v[44:45]
    v_pk_fma_f32 v[62:63], v[52:53], v[46:47], v[92:93]
    v_pk_fma_f32 v[60:61], v[52:53], v[44:45], v[90:91] neg_lo:[0,0,1] neg_hi:[0,0,1]
    v_pk_mul_f32 v[94:95], v[54:55], v[42:43]
    v_pk_mul_f32 v[96:97], v[54:55], v[40:41]
    v_pk_fma_f32 v[58:59], v[52:53], v[42:43], v[96:97]
    v_pk_fma_f32 v[56:57], v[52:53], v[40:41], v[94:95] neg_lo:[0,0,1] neg_hi:[0,0,1]
    v_cvt_pk_f16_f32 v100, v60, v62
    v_cvt_pk_f16_f32 v101, v61, v63
    ds_write_b64 v6, v[100:101] offset:11968
    v_cvt_pk_f16_f32 v98, v56, v58
    v_cvt_pk_f16_f32 v99, v57, v59
    ds_write_b64 v6, v[98:99] offset:10336
    v_pk_mul_f32 v[90:91], v[58:59], v[46:47]
    v_pk_mul_f32 v[92:93], v[58:59], v[44:45]
    v_pk_fma_f32 v[62:63], v[56:57], v[46:47], v[92:93]
    v_pk_fma_f32 v[60:61], v[56:57], v[44:45], v[90:91] neg_lo:[0,0,1] neg_hi:[0,0,1]
    v_pk_mul_f32 v[94:95], v[42:43], v[42:43]
    v_pk_mul_f32 v[96:97], v[42:43], v[40:41]
    v_pk_fma_f32 v[50:51], v[40:41], v[42:43], v[96:97]
    v_pk_fma_f32 v[48:49], v[40:41], v[40:41], v[94:95] neg_lo:[0,0,1] neg_hi:[0,0,1]
    v_cvt_pk_f16_f32 v100, v60, v62
    v_cvt_pk_f16_f32 v101, v61, v63
    ds_write_b64 v6, v[100:101] offset:12512
    v_cvt_pk_f16_f32 v98, v64, v66
    v_cvt_pk_f16_f32 v99, v65, v67
    ds_write_b64 v6, v[98:99] offset:13056
    v_pk_mul_f32 v[90:91], v[66:67], v[50:51]
    v_pk_mul_f32 v[92:93], v[66:67], v[48:49]
    v_pk_fma_f32 v[62:63], v[64:65], v[50:51], v[92:93]
    v_pk_fma_f32 v[60:61], v[64:65], v[48:49], v[90:91] neg_lo:[0,0,1] neg_hi:[0,0,1]
    v_pk_mul_f32 v[94:95], v[66:67], v[46:47]
    v_pk_mul_f32 v[96:97], v[66:67], v[44:45]
    v_pk_fma_f32 v[54:55], v[64:65], v[46:47], v[96:97]
    v_pk_fma_f32 v[52:53], v[64:65], v[44:45], v[94:95] neg_lo:[0,0,1] neg_hi:[0,0,1]
    v_cvt_pk_f16_f32 v100, v60, v62
    v_cvt_pk_f16_f32 v101, v61, v63
    ds_write_b64 v6, v[100:101] offset:13600
    v_cvt_pk_f16_f32 v98, v52, v54
    v_cvt_pk_f16_f32 v99, v53, v55
    ds_write_b64 v6, v[98:99] offset:14144
    v_pk_mul_f32 v[90:91], v[54:55], v[50:51]
    v_pk_mul_f32 v[92:93], v[54:55], v[48:49]
    v_pk_fma_f32 v[62:63], v[52:53], v[50:51], v[92:93]
    v_pk_fma_f32 v[60:61], v[52:53], v[48:49], v[90:91] neg_lo:[0,0,1] neg_hi:[0,0,1]
    v_pk_mul_f32 v[94:95], v[54:55], v[46:47]
    v_pk_mul_f32 v[96:97], v[54:55], v[44:45]
    v_pk_fma_f32 v[58:59], v[52:53], v[46:47], v[96:97]
    v_pk_fma_f32 v[56:57], v[52:53], v[44:45], v[94:95] neg_lo:[0,0,1] neg_hi:[0,0,1]
    v_cvt_pk_f16_f32 v100, v60, v62
    v_cvt_pk_f16_f32 v101, v61, v63
    ds_write_b64 v6, v[100:101] offset:14688
    v_cvt_pk_f16_f32 v98, v56, v58
    v_cvt_pk_f16_f32 v99, v57, v59
    ds_write_b64 v6, v[98:99] offset:15232
    v_pk_mul_f32 v[90:91], v[58:59], v[50:51]
    v_pk_mul_f32 v[92:93], v[58:59], v[48:49]
    v_pk_fma_f32 v[62:63], v[56:57], v[50:51], v[92:93]
    v_pk_fma_f32 v[60:61], v[56:57], v[48:49], v[90:91] neg_lo:[0,0,1] neg_hi:[0,0,1]
    v_pk_mul_f32 v[94:95], v[58:59], v[46:47]
    v_pk_mul_f32 v[96:97], v[58:59], v[44:45]
    v_pk_fma_f32 v[54:55], v[56:57], v[46:47], v[96:97]
    v_pk_fma_f32 v[52:53], v[56:57], v[44:45], v[94:95] neg_lo:[0,0,1] neg_hi:[0,0,1]
    v_cvt_pk_f16_f32 v100, v60, v62
    v_cvt_pk_f16_f32 v101, v61, v63
    ds_write_b64 v6, v[100:101] offset:15776
    v_cvt_pk_f16_f32 v98, v52, v54
    v_cvt_pk_f16_f32 v99, v53, v55
    ds_write_b64 v6, v[98:99] offset:16320
    v_pk_mul_f32 v[90:91], v[54:55], v[50:51]
    v_pk_mul_f32 v[92:93], v[54:55], v[48:49]
    v_pk_fma_f32 v[62:63], v[52:53], v[50:51], v[92:93]
    v_pk_fma_f32 v[60:61], v[52:53], v[48:49], v[90:91] neg_lo:[0,0,1] neg_hi:[0,0,1]
    v_cvt_pk_f16_f32 v100, v60, v62
    v_cvt_pk_f16_f32 v101, v61, v63
    ds_write_b64 v6, v[100:101] offset:16864
    s_branch JOBJ_10
JOB_8:
    v_mul_f32 v90, 0x43000000, v20
    v_mul_f32 v91, 0x43000000, v22
    v_mul_f32 v94, 0x43000000, v21
    v_mul_f32 v95, 0x43000000, v23
    v_exp_f32 v90, v90
    v_mul_f32 v92, s92, v91
    v_exp_f32 v94, v94
    v_mul_f32 v96, s92, v95
    v_rndne_f32 v92, v92
    v_rndne_f32 v96, v96
    v_fma_f32 v92, v91, s92, -v92
    v_fma_f32 v96, v95, s92, -v96
    v_fma_f32 v92, v91, s93, v92
    v_fma_f32 v96, v95, s93, v96
    v_cos_f32 v91, v92
    v_sin_f32 v92, v92
    v_cos_f32 v95, v96
    v_sin_f32 v96, v96
    v_mul_f32 v44, v90, v91
    v_mul_f32 v46, v90, v92
    v_mul_f32 v45, v94, v95
    v_mul_f32 v47, v94, v96
    v_mul_f32 v90, 0x44800000, v20
    v_mul_f32 v91, 0x44800000, v22
    v_mul_f32 v94, 0x44800000, v21
    v_mul_f32 v95, 0x44800000, v23
    v_exp_f32 v90, v90
    v_mul_f32 v92, s92, v91
    v_exp_f32 v94, v94
    v_mul_f32 v96, s92, v95
    v_rndne_f32 v92, v92
    v_rndne_f32 v96, v96
    v_fma_f32 v92, v91, s92, -v92
    v_fma_f32 v96, v95, s92, -v96
    v_fma_f32 v92, v91, s93, v92
    v_fma_f32 v96, v95, s93, v96
    v_cos_f32 v91, v92
    v_sin_f32 v92, v92
    v_cos_f32 v95, v96
    v_sin_f32 v96, v96
    v_mul_f32 v48, v90, v91
    v_mul_f32 v50, v90, v92
    v_mul_f32 v49, v94, v95
    v_mul_f32 v51, v94, v96
    v_pk_mul_f32 v[90:91], v[34:35], v[50:51]
    v_pk_mul_f32 v[92:93], v[34:35], v[48:49]
    v_pk_fma_f32 v[54:55], v[32:33], v[50:51], v[92:93]
    v_pk_fma_f32 v[52:53], v[32:33], v[48:49], v[90:91] neg_lo:[0,0,1] neg_hi:[0,0,1]
    v_pk_mul_f32 v[90:91], v[54:55], v[46:47]
    v_pk_mul_f32 v[92:93], v[54:55], v[44:45]
    v_pk_fma_f32 v[58:59], v[52:53], v[46:47], v[92:93]
    v_pk_fma_f32 v[56:57], v[52:53], v[44:45], v[90:91] neg_lo:[0,0,1] neg_hi:[0,0,1]
    v_cvt_pk_f16_f32 v98, v52, v54
    v_cvt_pk_f16_f32 v99, v53, v55
    ds_write_b64 v6, v[98:99] offset:17408
    v_pk_mul_f32 v[90:91], v[58:59], v[46:47]
    v_pk_mul_f32 v[92:93], v[58:59], v[44:45]
    v_pk_fma_f32 v[54:55], v[56:57], v[46:47], v[92:93]
    v_pk_fma_f32 v[52:53], v[56:57], v[44:45], v[90:91] neg_lo:[0,0,1] neg_hi:[0,0,1]
    v_cvt_pk_f16_f32 v100, v56, v58
    v_cvt_pk_f16_f32 v101, v57, v59
    ds_write_b64 v6, v[100:101] offset:17952
    v_pk_mul_f32 v[90:91], v[54:55], v[46:47]
    v_pk_mul_f32 v[92:93], v[54:55], v[44:45]
    v_pk_fma_f32 v[58:59], v[52:53], v[46:47], v[92:93]
    v_pk_fma_f32 v[56:57], v[52:53], v[44:45], v[90:91] neg_lo:[0,0,1] neg_hi:[0,0,1]
    v_cvt_pk_f16_f32 v98, v52, v54
    v_cvt_pk_f16_f32 v99, v53, v55
    ds_write_b64 v6, v[98:99] offset:18496
    v_pk_mul_f32 v[90:91], v[58:59], v[46:47]
    v_pk_mul_f32 v[92:93], v[58:59], v[44:45]
    v_pk_fma_f32 v[54:55], v[56:57], v[46:47], v[92:93]
    v_pk_fma_f32 v[52:53], v[56:57], v[44:45], v[90:91] neg_lo:[0,0,1] neg_hi:[0,0,1]
    v_cvt_pk_f16_f32 v100, v56, v58
    v_cvt_pk_f16_f32 v101, v57, v59
    ds_write_b64 v6, v[100:101] offset:19040
    v_pk_mul_f32 v[90:91], v[54:55], v[46:47]
    v_pk_mul_f32 v[92:93], v[54:55], v[44:45]
    v_pk_fma_f32 v[58:59], v[52:53], v[46:47], v[92:93]
    v_pk_fma_f32 v[56:57], v[52:53], v[44:45], v[90:91] neg_lo:[0,0,1] neg_hi:[0,0,1]
    v_cvt_pk_f16_f32 v98, v52, v54
    v_cvt_pk_f16_f32 v99, v53, v55
    ds_write_b64 v6, v[98:99] offset:19584
    v_pk_mul_f32 v[90:91], v[58:59], v[46:47]
    v_pk_mul_f32 v[92:93], v[58:59], v[44:45]
    v_pk_fma_f32 v[54:55], v[56:57], v[46:47], v[92:93]
    v_pk_fma_f32 v[52:53], v[56:57], v[44:45], v[90:91] neg_lo:[0,0,1] neg_hi:[0,0,1]
    v_cvt_pk_f16_f32 v100, v56, v58
    v_cvt_pk_f16_f32 v101, v57, v59
    ds_write_b64 v6, v[100:101] offset:20128
    v_pk_mul_f32 v[90:91], v[54:55], v[46:47]
    v_pk_mul_f32 v[92:93], v[54:55], v[44:45]
    v_pk_fma_f32 v[58:59], v[52:53], v[46:47], v[92:93]
    v_pk_fma_f32 v[56:57], v[52:53], v[44:45], v[90:91] neg_lo:[0,0,1] neg_hi:[0,0,1]
    v_cvt_pk_f16_f32 v98, v52, v54
    v_cvt_pk_f16_f32 v99, v53, v55
    ds_write_b64 v6, v[98:99] offset:20672
    v_pk_mul_f32 v[90:91], v[58:59], v[46:47]
    v_pk_mul_f32 v[92:93], v[58:59], v[44:45]
    v_pk_fma_f32 v[54:55], v[56:57], v[46:47], v[92:93]
    v_pk_fma_f32 v[52:53], v[56:57], v[44:45], v[90:91] neg_lo:[0,0,1] neg_hi:[0,0,1]
    v_cvt_pk_f16_f32 v100, v56, v58
    v_cvt_pk_f16_f32 v101, v57, v59
    ds_write_b64 v6, v[100:101] offset:21216
    v_cvt_pk_f16_f32 v98, v52, v54
    v_cvt_pk_f16_f32 v99, v53, v55
    ds_write_b64 v6, v[98:99] offset:21760
    v_mul_f32 v40, 0x45000000, v36
    v_max_f32 v40, 0, v40
    v_exp_f32 v40, v40
    v_mul_f32 v41, 0x38000000, v37
    v_mul_f32 v40, v40, v41
    s_waitcnt vmcnt(0)
    v_lshlrev_b32 v41, 16, v107
    ds_write_b64 v14, v[40:41] offset:832
    s_branch JOBJ_10
JOB_9:
    v_mul_f32 v90, 0x41000000, v20
    v_mul_f32 v91, 0x41000000, v22
    v_mul_f32 v94, 0x41000000, v21
    v_mul_f32 v95, 0x41000000, v23
    v_exp_f32 v90, v90
    v_mul_f32 v92, s92, v91
    v_exp_f32 v94, v94
    v_mul_f32 v96, s92, v95
    v_rndne_f32 v92, v92
    v_rndne_f32 v96, v96
    v_fma_f32 v92, v91, s92, -v92
    v_fma_f32 v96, v95, s92, -v96
    v_fma_f32 v92, v91, s93, v92
    v_fma_f32 v96, v95, s93, v96
    v_cos_f32 v91, v92
    v_sin_f32 v92, v92
    v_cos_f32 v95, v96
    v_sin_f32 v96, v96
    v_mul_f32 v40, v90, v91
    v_mul_f32 v42, v90, -v92
    v_mul_f32 v41, v94, v95
    v_mul_f32 v43, v94, -v96
    v_pk_mul_f32 v[90:91], v[42:43], v[42:43]
    v_pk_mul_f32 v[92:93], v[42:43], v[40:41]
    v_pk_fma_f32 v[46:47], v[40:41], v[42:43], v[92:93]
    v_pk_fma_f32 v[44:45], v[40:41], v[40:41], v[90:91] neg_lo:[0,0,1] neg_hi:[0,0,1]
    v_mov_b32 v52, 0x47000000
    v_mov_b32 v53, 0x47000000
    v_mov_b32 v54, 0
    v_mov_b32 v55, 0
    v_pk_mul_f32 v[60:61], v[40:41], v[52:53]
    v_pk_mul_f32 v[62:63], v[42:43], v[52:53]
    v_pk_mul_f32 v[90:91], v[54:55], v[46:47]
    v_pk_mul_f32 v[92:93], v[54:55], v[44:45]
    v_pk_fma_f32 v[58:59], v[52:53], v[46:47], v[92:93]
    v_pk_fma_f32 v[56:57], v[52:53], v[44:45], v[90:91] neg_lo:[0,0,1] neg_hi:[0,0,1]
    v_pk_mul_f32 v[94:95], v[62:63], v[46:47]
    v_pk_mul_f32 v[96:97], v[62:63], v[44:45]
    v_pk_fma_f32 v[66:67], v[60:61], v[46:47], v[96:97]
    v_pk_fma_f32 v[64:65], v[60:61], v[44:45], v[94:95] neg_lo:[0,0,1] neg_hi:[0,0,1]
    v_cvt_pk_f16_f32 v100, v52, v54
    v_cvt_pk_f16_f32 v101, v53, v55
    ds_write_b64 v6, v[100:101] offset:22304
    v_cvt_pk_f16_f32 v98, v60, v62
    v_cvt_pk_f16_f32 v99, v61, v63
    ds_write_b64 v6, v[98:99] offset:22848
    v_pk_mul_f32 v[90:91], v[58:59], v[46:47]
    v_pk_mul_f32 v[92:93], v[58:59], v[44:45]
    v_pk_fma_f32 v[54:55], v[56:57], v[46:47], v[92:93]
    v_pk_fma_f32 v[52:53], v[56:57], v[44:45], v[90:91] neg_lo:[0,0,1] neg_hi:[0,0,1]
    v_pk_mul_f32 v[94:95], v[66:67], v[46:47]
    v_pk_mul_f32 v[96:97], v[66:67], v[44:45]
    v_pk_fma_f32 v[62:63], v[64:65], v[46:47], v[96:97]
    v_pk_fma_f32 v[60:61], v[64:65], v[44:45], v[94:95] neg_lo:[0,0,1] neg_hi:[0,0,1]
    v_cvt_pk_f16_f32 v100, v56, v58
    v_cvt_pk_f16_f32 v101, v57, v59
    ds_write_b64 v6, v[100:101] offset:23392
    v_cvt_pk_f16_f32 v98, v64, v66
    v_cvt_pk_f16_f32 v99, v65, v67
    ds_write_b64 v6, v[98:99] offset:23936
    v_pk_mul_f32 v[90:91], v[54:55], v[46:47]
    v_pk_mul_f32 v[92:93], v[54:55], v[44:45]
    v_pk_fma_f32 v[58:59], v[52:53], v[46:47], v[92:93]
    v_pk_fma_f32 v[56:57], v[52:53], v[44:45], v[90:91] neg_lo:[0,0,1] neg_hi:[0,0,1]
    v_pk_mul_f32 v[94:95], v[62:63], v[46:47]
    v_pk_mul_f32 v[96:97], v[62:63], v[44:45]
    v_pk_fma_f32 v[66:67], v[60:61], v[46:47], v[96:97]
    v_pk_fma_f32 v[64:65], v[60:61], v[44:45], v[94:95] neg_lo:[0,0,1] neg_hi:[0,0,1]
    v_cvt_pk_f16_f32 v100, v52, v54
    v_cvt_pk_f16_f32 v101, v53, v55
    ds_write_b64 v6, v[100:101] offset:24480
    v_cvt_pk_f16_f32 v98, v60, v62
    v_cvt_pk_f16_f32 v99, v61, v63
    ds_write_b64 v6, v[98:99] offset:25024
    v_pk_mul_f32 v[90:91], v[58:59], v[46:47]
    v_pk_mul_f32 v[92:93], v[58:59], v[44:45]
    v_pk_fma_f32 v[54:55], v[56:57], v[46:47], v[92:93]
    v_pk_fma_f32 v[52:53], v[56:57], v[44:45], v[90:91] neg_lo:[0,0,1] neg_hi:[0,0,1]
    v_pk_mul_f32 v[94:95], v[66:67], v[46:47]
    v_pk_mul_f32 v[96:97], v[66:67], v[44:45]
    v_pk_fma_f32 v[62:63], v[64:65], v[46:47], v[96:97]
    v_pk_fma_f32 v[60:61], v[64:65], v[44:45], v[94:95] neg_lo:[0,0,1] neg_hi:[0,0,1]
    v_cvt_pk_f16_f32 v100, v56, v58
    v_cvt_pk_f16_f32 v101, v57, v59
    ds_write_b64 v6, v[100:101] offset:25568
    v_cvt_pk_f16_f32 v98, v64, v66
    v_cvt_pk_f16_f32 v99, v65, v67
    ds_write_b64 v6, v[98:99] offset:26112
    v_pk_mul_f32 v[90:91], v[54:55], v[46:47]
    v_pk_mul_f32 v[92:93], v[54:55], v[44:45]
    v_pk_fma_f32 v[58:59], v[52:53], v[46:47], v[92:93]
    v_pk_fma_f32 v[56:57], v[52:53], v[44:45], v[90:91] neg_lo:[0,0,1] neg_hi:[0,0,1]
    v_pk_mul_f32 v[94:95], v[62:63], v[46:47]
    v_pk_mul_f32 v[96:97], v[62:63], v[44:45]
    v_pk_fma_f32 v[66:67], v[60:61], v[46:47], v[96:97]
    v_pk_fma_f32 v[64:65], v[60:61], v[44:45], v[94:95] neg_lo:[0,0,1] neg_hi:[0,0,1]
    v_cvt_pk_f16_f32 v100, v52, v54
    v_cvt_pk_f16_f32 v101, v53, v55
    ds_write_b64 v6, v[100:101] offset:26656
    v_cvt_pk_f16_f32 v98, v60, v62
    v_cvt_pk_f16_f32 v99, v61, v63
    ds_write_b64 v6, v[98:99] offset:27200
    v_pk_mul_f32 v[90:91], v[58:59], v[46:47]
    v_pk_mul_f32 v[92:93], v[58:59], v[44:45]
    v_pk_fma_f32 v[54:55], v[56:57], v[46:47], v[92:93]
    v_pk_fma_f32 v[52:53], v[56:57], v[44:45], v[90:91] neg_lo:[0,0,1] neg_hi:[0,0,1]
    v_pk_mul_f32 v[94:95], v[66:67], v[46:47]
    v_pk_mul_f32 v[96:97], v[66:67], v[44:45]
    v_pk_fma_f32 v[62:63], v[64:65], v[46:47], v[96:97]
    v_pk_fma_f32 v[60:61], v[64:65], v[44:45], v[94:95] neg_lo:[0,0,1] neg_hi:[0,0,1]
    v_cvt_pk_f16_f32 v100, v56, v58
    v_cvt_pk_f16_f32 v101, v57, v59
    ds_write_b64 v6, v[100:101] offset:27744
    v_cvt_pk_f16_f32 v98, v64, v66
    v_cvt_pk_f16_f32 v99, v65, v67
    ds_write_b64 v6, v[98:99] offset:28288
    v_pk_mul_f32 v[90:91], v[54:55], v[46:47]
    v_pk_mul_f32 v[92:93], v[54:55], v[44:45]
    v_pk_fma_f32 v[58:59], v[52:53], v[46:47], v[92:93]
    v_pk_fma_f32 v[56:57], v[52:53], v[44:45], v[90:91] neg_lo:[0,0,1] neg_hi:[0,0,1]
    v_pk_mul_f32 v[94:95], v[62:63], v[46:47]
    v_pk_mul_f32 v[96:97], v[62:63], v[44:45]
    v_pk_fma_f32 v[66:67], v[60:61], v[46:47], v[96:97]
    v_pk_fma_f32 v[64:65], v[60:61], v[44:45], v[94:95] neg_lo:[0,0,1] neg_hi:[0,0,1]
    v_cvt_pk_f16_f32 v100, v52, v54
    v_cvt_pk_f16_f32 v101, v53, v55
    ds_write_b64 v6, v[100:101] offset:28832
    v_cvt_pk_f16_f32 v98, v60, v62
    v_cvt_pk_f16_f32 v99, v61, v63
    ds_write_b64 v6, v[98:99] offset:29376
    v_cvt_pk_f16_f32 v100, v56, v58
    v_cvt_pk_f16_f32 v101, v57, v59
    ds_write_b64 v6, v[100:101] offset:29920
    v_cvt_pk_f16_f32 v98, v64, v66
    v_cvt_pk_f16_f32 v99, v65, v67
    ds_write_b64 v6, v[98:99] offset:30464
JOBJ_10:
    ds_write_b8 v15, v5 offset:64
    s_cmp_eq_u32 s86, 3
    s_cbranch_scc1 EXP_11
    v_mul_u32_u24 v10, 544, v2
    v_lshl_add_u32 v10, v3, 4, v10
    v_add_u32 v10, s85, v10
    s_mul_i32 s92, s86, 8704
    v_add_u32 v11, s92, v10
    v_mul_f32 v40, 0x45000000, v36
    v_max_f32 v40, 0, v40
    v_add_f32 v40, 0x41700000, v40
    v_fma_f32 v108, v108, v36, -v40
    v_fma_f32 v109, v109, v36, -v40
    v_fma_f32 v110, v110, v36, -v40
    v_fma_f32 v111, v111, v36, -v40
    v_exp_f32 v108, v108
    v_exp_f32 v109, v109
    v_exp_f32 v110, v110
    v_exp_f32 v111, v111
W_12:
    ds_read_b32 v12, v14 offset:64
    s_sub_u32 s39, s39, 1
    s_cbranch_scc1 KS_ABORT
    s_waitcnt lgkmcnt(0)
    v_cmp_ne_u32 vcc, s84, v12
    s_cbranch_vccnz W_12
    ds_read_b128 v[40:43], v11 offset:0
    ds_read_b128 v[72:75], v10 offset:22304
    ds_read_b128 v[44:47], v11 offset:64
    ds_read_b128 v[76:79], v10 offset:22368
    ds_read_b128 v[48:51], v11 offset:128
    ds_read_b128 v[80:83], v10 offset:22432
    ds_read_b128 v[52:55], v11 offset:192
    ds_read_b128 v[84:87], v10 offset:22496
    ds_read_b128 v[56:59], v11 offset:256
    ds_read_b128 v[88:91], v10 offset:22560
    ds_read_b128 v[60:63], v11 offset:320
    ds_read_b128 v[92:95], v10 offset:22624
    ds_read_b128 v[64:67], v11 offset:384
    ds_read_b128 v[96:99], v10 offset:22688
    ds_read_b128 v[68:71], v11 offset:448
    ds_read_b128 v[100:103], v10 offset:22752
    s_waitcnt lgkmcnt(14)
    v_mfma_f32_16x16x32_f16 v[20:23], v[40:43], v[72:75], 0
    s_waitcnt lgkmcnt(12)
    v_mfma_f32_16x16x32_f16 v[24:27], v[44:47], v[76:79], 0
    s_waitcnt lgkmcnt(10)
    v_mfma_f32_16x16x32_f16 v[20:23], v[48:51], v[80:83], v[20:23]
    s_waitcnt lgkmcnt(8)
    v_mfma_f32_16x16x32_f16 v[24:27], v[52:55], v[84:87], v[24:27]
    s_waitcnt lgkmcnt(6)
    v_mfma_f32_16x16x32_f16 v[20:23], v[56:59], v[88:91], v[20:23]
    s_waitcnt lgkmcnt(4)
    v_mfma_f32_16x16x32_f16 v[24:27], v[60:63], v[92:95], v[24:27]
    s_waitcnt lgkmcnt(2)
    v_mfma_f32_16x16x32_f16 v[20:23], v[64:67], v[96:99], v[20:23]
    s_waitcnt lgkmcnt(0)
    v_mfma_f32_16x16x32_f16 v[24:27], v[68:71], v[100:103], v[24:27]
    s_nop 7
    v_add_f32 v20, v20, v24
    v_add_f32 v21, v21, v25
    v_add_f32 v22, v22, v26
    v_add_f32 v23, v23, v27
    v_mul_f32 v20, v20, v108
    v_mul_f32 v21, v21, v109
    v_mul_f32 v22, v22, v110
    v_mul_f32 v23, v23, v111
    v_cvt_f16_f32 v20, v20
    ds_write_b16 v112, v20
    v_cvt_f16_f32 v21, v21
    ds_write_b16 v113, v21
    v_cvt_f16_f32 v22, v22
    ds_write_b16 v114, v22
    v_cvt_f16_f32 v23, v23
    ds_write_b16 v115, v23
EXP_11:
    ds_write_b8 v15, v5 offset:68
    s_waitcnt vmcnt(0)
    s_nop 1
    v_lshlrev_b32 v20, 3, v3
    v_sub_u32 v20, v20, v2
    v_add_u32 v21, 16, v20
    v_lshrrev_b32 v21, 1, v21
    v_and_b32 v22, 1, v2
    v_mul_u32_u24 v23, 1280, v22
    v_lshl_add_u32 v23, v21, 2, v23
    s_add_u32 s92, s85, 32528
    v_add_u32 v6, s92, v23
    v_add_u32 v7, 640, v6
    v_mul_u32_u24 v23, 192, v22
    v_lshl_add_u32 v23, v21, 2, v23
    s_add_u32 s92, s85, 35600
    v_add_u32 v13, s92, v23
    v_lshlrev_b32 v23, 2, v3
    v_sub_u32 v23, v23, v2
    v_add_u32 v23, 15, v23
    s_add_u32 s92, s85, 35088
    v_lshl_add_u32 v11, v23, 2, s92
    s_mul_i32 s94, s87, 4608
    s_add_u32 s94, s94, 3072
    v_lshlrev_b32 v23, 5, v2
    v_lshl_add_u32 v23, v3, 4, v23
    v_add_u32 v8, s94, v23
    v_bfe_u32 v20, v1, 2, 2
    v_and_b32 v21, 3, v1
    v_lshl_add_u32 v20, v3, 3, v20
    v_lshl_add_u32 v21, v21, 3, s85
    v_lshl_add_u32 v9, v20, 4, v21
    v_lshl_add_u32 v10, v20, 5, v21
W_13:
    ds_read_b32 v20, v14 offset:68
    s_sub_u32 s39, s39, 1
    s_cbranch_scc1 KS_ABORT
    s_waitcnt lgkmcnt(0)
    v_cmp_ne_u32 vcc, s84, v20
    s_cbranch_vccnz W_13
    ds_read_u16 v20, v116
    ds_read_u16 v21, v117
    ds_read_u16 v22, v118
    ds_read_u16 v23, v119
    ds_read_u16 v24, v120
    ds_read_u16 v25, v121
    ds_read_u16 v26, v122
    v_mov_b32 v28, 0
    v_mov_b32 v29, 0
    v_mov_b32 v30, 0
    v_mov_b32 v31, 0
    v_mov_b32 v32, s85
    s_mov_b64 exec, 1
    ds_write_b128 v32, v[28:31] offset:3088
    ds_write_b128 v32, v[28:31] offset:8224
    ds_write_b128 v32, v[28:31] offset:3072
    s_mov_b64 exec, -1
    s_waitcnt lgkmcnt(7)
    v_lshl_or_b32 v28, v21, 16, v20
    v_lshl_or_b32 v29, v22, 16, v21
    ds_write_b32 v123, v28 offset:32528
    ds_write_b32 v123, v29 offset:33808
    s_waitcnt lgkmcnt(5)
    v_lshl_or_b32 v30, v24, 16, v23
    v_lshl_or_b32 v31, v26, 16, v25
    ds_write_b32 v124, v30
    ds_write_b32 v125, v31
    ds_write_b8 v15, v5 offset:72
    v_lshlrev_b32 v12, 4, v1
W_14:
    ds_read_b32 v20, v14 offset:72
    s_sub_u32 s39, s39, 1
    s_cbranch_scc1 KS_ABORT
    s_waitcnt lgkmcnt(0)
    v_cmp_ne_u32 vcc, s84, v20
    s_cbranch_vccnz W_14
    s_cmp_eq_u32 s86, 1
    s_cbranch_scc1 CV_16
    s_cmp_eq_u32 s86, 2
    s_cbranch_scc1 CV_17
    s_cmp_eq_u32 s86, 3
    s_cbranch_scc1 CV_18
    ds_read2_b32 v[36:37], v7 offset0:96 offset1:97
    ds_read2_b32 v[38:39], v7 offset0:98 offset1:99
    ds_read2_b32 v[40:41], v6 offset0:224 offset1:225
    ds_read2_b32 v[42:43], v6 offset0:226 offset1:227
    ds_read2_b32 v[44:45], v6 offset0:192 offset1:193
    ds_read2_b32 v[46:47], v6 offset0:194 offset1:195
    ds_read2_b32 v[48:49], v6 offset0:160 offset1:161
    ds_read2_b32 v[50:51], v6 offset0:162 offset1:163
    ds_read2_b32 v[52:53], v6 offset0:128 offset1:129
    ds_read2_b32 v[54:55], v6 offset0:130 offset1:131
    ds_read2_b32 v[56:57], v6 offset0:96 offset1:97
    ds_read2_b32 v[58:59], v6 offset0:98 offset1:99
    ds_read2_b32 v[60:61], v6 offset0:64 offset1:65
    ds_read2_b32 v[62:63], v6 offset0:66 offset1:67
    ds_read2_b32 v[64:65], v6 offset0:32 offset1:33
    ds_read2_b32 v[66:67], v6 offset0:34 offset1:35
    ds_read2_b32 v[68:69], v6 offset0:0 offset1:1
    ds_read2_b32 v[70:71], v6 offset0:2 offset1:3
    ds_read2_b32 v[72:73], v7 offset0:128 offset1:129
    ds_read2_b32 v[74:75], v7 offset0:130 offset1:131
W_20:
    ds_read_b32 v92, v4 offset:16
    s_sub_u32 s39, s39, 1
    s_cbranch_scc1 KS_ABORT
    s_waitcnt lgkmcnt(0)
    v_cmp_ne_u32 vcc, s84, v92
    s_cbranch_vccnz W_20
    ds_read_b128 v[76:79], v8 offset:2496
    ds_read_b128 v[80:83], v8 offset:2368
    ds_read_b128 v[84:87], v8 offset:2240
    ds_read_b128 v[88:91], v8 offset:2112
    s_waitcnt lgkmcnt(3)
    v_mfma_f32_16x16x32_f16 v[32:35], v[36:39], v[76:79], 0
    ds_write_b8 v15, v5 offset:76
    ds_read_b128 v[76:79], v8 offset:1984
    s_waitcnt lgkmcnt(4)
    v_mfma_f32_16x16x32_f16 v[32:35], v[40:43], v[80:83], v[32:35]
    ds_read_b128 v[80:83], v8 offset:1856
    s_waitcnt lgkmcnt(4)
    v_mfma_f32_16x16x32_f16 v[32:35], v[44:47], v[84:87], v[32:35]
    ds_read_b128 v[84:87], v8 offset:1728
    s_waitcnt lgkmcnt(4)
    v_mfma_f32_16x16x32_f16 v[32:35], v[48:51], v[88:91], v[32:35]
    ds_read2_b32 v[92:93], v11 offset0:32 offset1:33
    ds_read_b128 v[88:91], v8 offset:1600
    s_waitcnt lgkmcnt(4)
    v_mfma_f32_16x16x32_f16 v[28:31], v[36:39], v[76:79], 0
    ds_read2_b32 v[94:95], v11 offset0:34 offset1:35
    v_mfma_f32_16x16x32_f16 v[32:35], v[52:55], v[76:79], v[32:35]
    ds_read2_b32 v[96:97], v11 offset0:16 offset1:17
    ds_read_b128 v[76:79], v8 offset:1472
    s_waitcnt lgkmcnt(6)
    v_mfma_f32_16x16x32_f16 v[28:31], v[40:43], v[80:83], v[28:31]
    ds_read2_b32 v[98:99], v11 offset0:18 offset1:19
    v_mfma_f32_16x16x32_f16 v[32:35], v[56:59], v[80:83], v[32:35]
    ds_read2_b32 v[100:101], v11 offset0:0 offset1:1
    ds_read_b128 v[80:83], v8 offset:1344
    s_waitcnt lgkmcnt(8)
    v_mfma_f32_16x16x32_f16 v[28:31], v[44:47], v[84:87], v[28:31]
    ds_read2_b32 v[102:103], v11 offset0:2 offset1:3
    v_mfma_f32_16x16x32_f16 v[32:35], v[60:63], v[84:87], v[32:35]
    ds_read_b128 v[84:87], v8 offset:1216
    s_waitcnt lgkmcnt(8)
    v_mfma_f32_16x16x32_f16 v[28:31], v[48:51], v[88:91], v[28:31]
    v_mfma_f32_16x16x32_f16 v[32:35], v[64:67], v[88:91], v[32:35]
    ds_read_b128 v[88:91], v8 offset:1088
    s_waitcnt lgkmcnt(6)
    v_mfma_f32_16x16x32_f16 v[24:27], v[36:39], v[76:79], 0
    v_mfma_f32_16x16x32_f16 v[28:31], v[52:55], v[76:79], v[28:31]
    v_mfma_f32_16x16x32_f16 v[32:35], v[68:71], v[76:79], v[32:35]
    ds_read_b128 v[76:79], v8 offset:960
    s_waitcnt lgkmcnt(4)
    v_mfma_f32_16x16x32_f16 v[24:27], v[40:43], v[80:83], v[24:27]
    v_mfma_f32_16x16x32_f16 v[28:31], v[56:59], v[80:83], v[28:31]
    ds_read_b128 v[80:83], v8 offset:832
    s_waitcnt lgkmcnt(3)
    v_mfma_f32_16x16x32_f16 v[24:27], v[44:47], v[84:87], v[24:27]
    v_mfma_f32_16x16x32_f16 v[28:31], v[60:63], v[84:87], v[28:31]
    ds_read_b128 v[84:87], v8 offset:704
    s_waitcnt lgkmcnt(3)
    v_mfma_f32_16x16x32_f16 v[24:27], v[48:51], v[88:91], v[24:27]
    v_mfma_f32_16x16x32_f16 v[28:31], v[64:67], v[88:91], v[28:31]
    ds_read_b128 v[88:91], v8 offset:576
    s_waitcnt lgkmcnt(3)
    v_mfma_f32_16x16x32_f16 v[20:23], v[36:39], v[76:79], 0
    v_mfma_f32_16x16x32_f16 v[24:27], v[52:55], v[76:79], v[24:27]
    v_mfma_f32_16x16x32_f16 v[28:31], v[68:71], v[76:79], v[28:31]
    ds_read_b128 v[76:79], v8 offset:448
    s_waitcnt lgkmcnt(3)
    v_mfma_f32_16x16x32_f16 v[20:23], v[40:43], v[80:83], v[20:23]
    v_mfma_f32_16x16x32_f16 v[24:27], v[56:59], v[80:83], v[24:27]
    ds_read_b128 v[80:83], v8 offset:320
    s_waitcnt lgkmcnt(3)
    v_mfma_f32_16x16x32_f16 v[20:23], v[44:47], v[84:87], v[20:23]
    v_mfma_f32_16x16x32_f16 v[24:27], v[60:63], v[84:87], v[24:27]
    ds_read_b128 v[84:87], v8 offset:192
    s_waitcnt lgkmcnt(3)
    v_mfma_f32_16x16x32_f16 v[20:23], v[48:51], v[88:91], v[20:23]
    v_mfma_f32_16x16x32_f16 v[24:27], v[64:67], v[88:91], v[24:27]
    ds_read_b128 v[88:91], v8 offset:64
    s_waitcnt lgkmcnt(3)
    v_mfma_f32_16x16x32_f16 v[16:19], v[36:39], v[76:79], 0
    v_mfma_f32_16x16x32_f16 v[20:23], v[52:55], v[76:79], v[20:23]
    v_mfma_f32_16x16x32_f16 v[24:27], v[68:71], v[76:79], v[24:27]
    v_mfma_f32_16x16x32_f16 v[32:35], v[72:75], v[76:79], v[32:35]
    s_waitcnt lgkmcnt(2)
    v_mfma_f32_16x16x32_f16 v[16:19], v[40:43], v[80:83], v[16:19]
    v_mfma_f32_16x16x32_f16 v[20:23], v[56:59], v[80:83], v[20:23]
    s_waitcnt lgkmcnt(1)
    v_mfma_f32_16x16x32_f16 v[16:19], v[44:47], v[84:87], v[16:19]
    v_mfma_f32_16x16x32_f16 v[20:23], v[60:63], v[84:87], v[20:23]
    s_waitcnt lgkmcnt(0)
    v_mfma_f32_16x16x32_f16 v[16:19], v[48:51], v[88:91], v[16:19]
    v_mfma_f32_16x16x32_f16 v[20:23], v[64:67], v[88:91], v[20:23]
W_21:
    ds_read_b32 v36, v14 offset:76
    s_sub_u32 s39, s39, 1
    s_cbranch_scc1 KS_ABORT
    s_waitcnt lgkmcnt(0)
    v_cmp_ne_u32 vcc, s84, v36
    s_cbranch_vccnz W_21
    ds_read_b64_tr_b16 v[36:37], v9 offset:0
    ds_read_b64_tr_b16 v[38:39], v9 offset:64
    ds_read_b64_tr_b16 v[40:41], v9 offset:512
    ds_read_b64_tr_b16 v[42:43], v9 offset:576
    ds_read_b64_tr_b16 v[44:45], v9 offset:1024
    ds_read_b64_tr_b16 v[46:47], v9 offset:1088
    s_waitcnt lgkmcnt(4)
    v_mfma_f32_16x16x32_f16 v[24:27], v[36:39], v[92:95], v[24:27]
    v_mfma_f32_16x16x32_f16 v[28:31], v[36:39], v[96:99], v[28:31]
    v_mfma_f32_16x16x32_f16 v[32:35], v[36:39], v[100:103], v[32:35]
    s_waitcnt lgkmcnt(2)
    v_mfma_f32_16x16x32_f16 v[28:31], v[40:43], v[92:95], v[28:31]
    v_mfma_f32_16x16x32_f16 v[32:35], v[40:43], v[96:99], v[32:35]
    s_waitcnt lgkmcnt(0)
    v_mfma_f32_16x16x32_f16 v[32:35], v[44:47], v[92:95], v[32:35]
    v_add_u32 v6, 35584, v12
    v_add_u32 v7, 72192, v12
    v_add_u32 v9, 108800, v12
    v_lshrrev_b32 v10, 2, v2
    v_lshl_add_u32 v10, v10, 2, v3
    v_and_b32 v11, 3, v2
    v_lshlrev_b32 v11, 4, v11
    v_lshlrev_b32 v13, 5, v2
    v_lshl_add_u32 v13, v3, 3, v13
    v_and_b32 v8, 1, v1
    v_cmp_eq_u32 s[98:99], 1, v8
    s_lshl_b32 s92, s87, 2
    s_add_u32 s92, s92, s86
    v_mov_b32 v8, s92
    s_cmp_eq_u32 s87, 1
    s_cbranch_scc1 EP_23
    s_cmp_eq_u32 s87, 2
    s_cbranch_scc1 EP_24
    s_nop 3
    ds_write_b128 v6, v[20:23] offset:10752
    ds_write_b128 v6, v[24:27] offset:11776
    ds_write_b128 v6, v[28:31] offset:12800
    ds_write_b128 v6, v[32:35] offset:13824
    ds_write_b8 v8, v5 offset:160
    s_add_u32 s64, s36, 0x600000
    s_addc_u32 s65, s37, 0
    s_mov_b32 s66, 0x200000
    s_mov_b32 s67, 0x20000
    v_lshl_add_u32 v10, v10, 15, v11
    s_lshl_b32 s92, s88, 5
    s_and_b32 s92, s92, 0xffffffc0
    s_add_u32 s92, s92, 0
    ds_read_b64 v[80:81], v4 offset:832
    ds_read_b64 v[88:89], v13 offset:3552
    ds_read_b64 v[82:83], v4 offset:848
    ds_read_b64 v[90:91], v13 offset:8160
W_25:
    ds_read_b64 v[40:41], v4 offset:160
    s_sub_u32 s39, s39, 1
    s_cbranch_scc1 KS_ABORT
    s_waitcnt lgkmcnt(0)
    v_and_b32 v40, v40, v41
    v_cmp_ne_u32 vcc, s84, v40
    s_cbranch_vccnz W_25
    ds_read_b128 v[40:43], v6 offset:14848
    ds_read_b128 v[44:47], v7 offset:10752
    ds_read_b128 v[48:51], v7 offset:14848
    v_cvt_f32_f16 v60, v88
    v_cvt_f32_f16_sdwa v61, v88 dst_sel:DWORD dst_unused:UNUSED_PAD src0_sel:WORD_1
    v_mul_f32 v60, v81, v60
    v_mul_f32 v61, v81, v61
    v_cvt_pk_bf16_f32 v88, v60, v61
    v_lshlrev_b32 v60, 16, v88
    v_and_b32 v61, 0xffff0000, v88
    v_cvt_f32_f16 v62, v89
    v_cvt_f32_f16_sdwa v63, v89 dst_sel:DWORD dst_unused:UNUSED_PAD src0_sel:WORD_1
    v_mul_f32 v62, v81, v62
    v_mul_f32 v63, v81, v63
    v_cvt_pk_bf16_f32 v89, v62, v63
    v_lshlrev_b32 v62, 16, v89
    v_and_b32 v63, 0xffff0000, v89
    v_cvt_f32_f16 v64, v90
    v_cvt_f32_f16_sdwa v65, v90 dst_sel:DWORD dst_unused:UNUSED_PAD src0_sel:WORD_1
    v_mul_f32 v64, v83, v64
    v_mul_f32 v65, v83, v65
    v_cvt_pk_bf16_f32 v90, v64, v65
    v_lshlrev_b32 v64, 16, v90
    v_and_b32 v65, 0xffff0000, v90
    v_cvt_f32_f16 v66, v91
    v_cvt_f32_f16_sdwa v67, v91 dst_sel:DWORD dst_unused:UNUSED_PAD src0_sel:WORD_1
    v_mul_f32 v66, v83, v66
    v_mul_f32 v67, v83, v67
    v_cvt_pk_bf16_f32 v91, v66, v67
    v_lshlrev_b32 v66, 16, v91
    v_and_b32 v67, 0xffff0000, v91
    s_waitcnt lgkmcnt(2)
    v_pk_add_f32 v[40:41], v[16:17], v[40:41]
    v_pk_add_f32 v[42:43], v[18:19], v[42:43]
    v_pk_mul_f32 v[40:41], v[40:41], v[80:81] op_sel_hi:[1,0]
    v_pk_mul_f32 v[42:43], v[42:43], v[80:81] op_sel_hi:[1,0]
    v_cvt_pk_bf16_f32 v72, v40, v41
    v_cvt_pk_bf16_f32 v73, v42, v43
    v_lshlrev_b32 v40, 16, v72
    v_and_b32 v41, 0xffff0000, v72
    v_lshlrev_b32 v42, 16, v73
    v_and_b32 v43, 0xffff0000, v73
    v_pk_add_f32 v[40:41], v[40:41], v[60:61]
    v_pk_add_f32 v[42:43], v[42:43], v[62:63]
    v_cvt_pk_bf16_f32 v72, v40, v41
    v_cvt_pk_bf16_f32 v73, v42, v43
    s_waitcnt lgkmcnt(0)
    v_pk_add_f32 v[44:45], v[44:45], v[48:49]
    v_pk_add_f32 v[46:47], v[46:47], v[50:51]
    v_pk_mul_f32 v[44:45], v[44:45], v[82:83] op_sel_hi:[1,0]
    v_pk_mul_f32 v[46:47], v[46:47], v[82:83] op_sel_hi:[1,0]
    v_cvt_pk_bf16_f32 v74, v44, v45
    v_cvt_pk_bf16_f32 v75, v46, v47
    v_lshlrev_b32 v44, 16, v74
    v_and_b32 v45, 0xffff0000, v74
    v_lshlrev_b32 v46, 16, v75
    v_and_b32 v47, 0xffff0000, v75
    v_pk_add_f32 v[44:45], v[44:45], v[64:65]
    v_pk_add_f32 v[46:47], v[46:47], v[66:67]
    v_cvt_pk_bf16_f32 v74, v44, v45
    v_cvt_pk_bf16_f32 v75, v46, v47
    s_branch CVE_19
EP_23:
    s_nop 3
    ds_write_b128 v7, v[16:19] offset:10752
    ds_write_b128 v7, v[20:23] offset:11776
    ds_write_b128 v7, v[28:31] offset:12800
    ds_write_b128 v7, v[32:35] offset:13824
    ds_write_b8 v8, v5 offset:160
    s_add_u32 s64, s36, 0x600000
    s_addc_u32 s65, s37, 0
    s_mov_b32 s66, 0x200000
    s_mov_b32 s67, 0x20000
    v_lshl_add_u32 v10, v10, 15, v11
    s_lshl_b32 s92, s88, 5
    s_and_b32 s92, s92, 0xffffffc0
    s_add_u32 s92, s92, 524288
    ds_read_b64 v[80:81], v4 offset:832
    ds_read_b64 v[88:89], v13 offset:4576
    ds_read_b64 v[82:83], v4 offset:848
    ds_read_b64 v[90:91], v13 offset:9184
W_26:
    ds_read_b64 v[40:41], v4 offset:160
    s_sub_u32 s39, s39, 1
    s_cbranch_scc1 KS_ABORT
    s_waitcnt lgkmcnt(0)
    v_and_b32 v40, v40, v41
    v_cmp_ne_u32 vcc, s84, v40
    s_cbranch_vccnz W_26
    ds_read_b128 v[40:43], v6 offset:11776
    ds_read_b128 v[44:47], v6 offset:15872
    ds_read_b128 v[48:51], v7 offset:16896
    v_cvt_f32_f16 v60, v88
    v_cvt_f32_f16_sdwa v61, v88 dst_sel:DWORD dst_unused:UNUSED_PAD src0_sel:WORD_1
    v_mul_f32 v60, v81, v60
    v_mul_f32 v61, v81, v61
    v_cvt_pk_bf16_f32 v88, v60, v61
    v_lshlrev_b32 v60, 16, v88
    v_and_b32 v61, 0xffff0000, v88
    v_cvt_f32_f16 v62, v89
    v_cvt_f32_f16_sdwa v63, v89 dst_sel:DWORD dst_unused:UNUSED_PAD src0_sel:WORD_1
    v_mul_f32 v62, v81, v62
    v_mul_f32 v63, v81, v63
    v_cvt_pk_bf16_f32 v89, v62, v63
    v_lshlrev_b32 v62, 16, v89
    v_and_b32 v63, 0xffff0000, v89
    v_cvt_f32_f16 v64, v90
    v_cvt_f32_f16_sdwa v65, v90 dst_sel:DWORD dst_unused:UNUSED_PAD src0_sel:WORD_1
    v_mul_f32 v64, v83, v64
    v_mul_f32 v65, v83, v65
    v_cvt_pk_bf16_f32 v90, v64, v65
    v_lshlrev_b32 v64, 16, v90
    v_and_b32 v65, 0xffff0000, v90
    v_cvt_f32_f16 v66, v91
    v_cvt_f32_f16_sdwa v67, v91 dst_sel:DWORD dst_unused:UNUSED_PAD src0_sel:WORD_1
    v_mul_f32 v66, v83, v66
    v_mul_f32 v67, v83, v67
    v_cvt_pk_bf16_f32 v91, v66, v67
    v_lshlrev_b32 v66, 16, v91
    v_and_b32 v67, 0xffff0000, v91
    s_waitcnt lgkmcnt(1)
    v_pk_add_f32 v[40:41], v[40:41], v[44:45]
    v_pk_add_f32 v[42:43], v[42:43], v[46:47]
    v_pk_mul_f32 v[40:41], v[40:41], v[80:81] op_sel_hi:[1,0]
    v_pk_mul_f32 v[42:43], v[42:43], v[80:81] op_sel_hi:[1,0]
    v_cvt_pk_bf16_f32 v72, v40, v41
    v_cvt_pk_bf16_f32 v73, v42, v43
    v_lshlrev_b32 v40, 16, v72
    v_and_b32 v41, 0xffff0000, v72
    v_lshlrev_b32 v42, 16, v73
    v_and_b32 v43, 0xffff0000, v73
    v_pk_add_f32 v[40:41], v[40:41], v[60:61]
    v_pk_add_f32 v[42:43], v[42:43], v[62:63]
    v_cvt_pk_bf16_f32 v72, v40, v41
    v_cvt_pk_bf16_f32 v73, v42, v43
    s_waitcnt lgkmcnt(0)
    v_pk_add_f32 v[48:49], v[24:25], v[48:49]
    v_pk_add_f32 v[50:51], v[26:27], v[50:51]
    v_pk_mul_f32 v[48:49], v[48:49], v[82:83] op_sel_hi:[1,0]
    v_pk_mul_f32 v[50:51], v[50:51], v[82:83] op_sel_hi:[1,0]
    v_cvt_pk_bf16_f32 v74, v48, v49
    v_cvt_pk_bf16_f32 v75, v50, v51
    v_lshlrev_b32 v48, 16, v74
    v_and_b32 v49, 0xffff0000, v74
    v_lshlrev_b32 v50, 16, v75
    v_and_b32 v51, 0xffff0000, v75
    v_pk_add_f32 v[48:49], v[48:49], v[64:65]
    v_pk_add_f32 v[50:51], v[50:51], v[66:67]
    v_cvt_pk_bf16_f32 v74, v48, v49
    v_cvt_pk_bf16_f32 v75, v50, v51
    s_branch CVE_19
EP_24:
    s_nop 3
    ds_write_b128 v9, v[24:27] offset:10752
    ds_write_b128 v9, v[28:31] offset:11776
    ds_write_b128 v9, v[32:35] offset:12800
    ds_write_b8 v8, v5 offset:160
    s_add_u32 s64, s36, 0x800000
    s_addc_u32 s65, s37, 0
    s_mov_b32 s66, 0x40000
    s_mov_b32 s67, 0x20000
    v_lshl_add_u32 v10, v10, 12, v11
    s_sub_u32 s92, s88, 512
    s_lshl_b32 s92, s92, 6
    s_add_u32 s92, s92, 0
    ds_read_b64 v[80:81], v4 offset:864
    ds_read_b64 v[88:89], v13 offset:12768
    ds_read_b64 v[82:83], v4 offset:864
    ds_read_b64 v[90:91], v13 offset:13280
W_27:
    ds_read_b32 v40, v4 offset:168
    s_sub_u32 s39, s39, 1
    s_cbranch_scc1 KS_ABORT
    s_waitcnt lgkmcnt(0)
    v_cmp_ne_u32 vcc, s84, v40
    s_cbranch_vccnz W_27
    ds_read_b128 v[40:43], v9 offset:13824
    ds_read_b128 v[44:47], v9 offset:14848
    v_cvt_f32_f16 v60, v88
    v_cvt_f32_f16_sdwa v61, v88 dst_sel:DWORD dst_unused:UNUSED_PAD src0_sel:WORD_1
    v_mul_f32 v60, v81, v60
    v_mul_f32 v61, v81, v61
    v_cvt_pk_bf16_f32 v88, v60, v61
    v_lshlrev_b32 v60, 16, v88
    v_and_b32 v61, 0xffff0000, v88
    v_cvt_f32_f16 v62, v89
    v_cvt_f32_f16_sdwa v63, v89 dst_sel:DWORD dst_unused:UNUSED_PAD src0_sel:WORD_1
    v_mul_f32 v62, v81, v62
    v_mul_f32 v63, v81, v63
    v_cvt_pk_bf16_f32 v89, v62, v63
    v_lshlrev_b32 v62, 16, v89
    v_and_b32 v63, 0xffff0000, v89
    v_cvt_f32_f16 v64, v90
    v_cvt_f32_f16_sdwa v65, v90 dst_sel:DWORD dst_unused:UNUSED_PAD src0_sel:WORD_1
    v_mul_f32 v64, v83, v64
    v_mul_f32 v65, v83, v65
    v_cvt_pk_bf16_f32 v90, v64, v65
    v_lshlrev_b32 v64, 16, v90
    v_and_b32 v65, 0xffff0000, v90
    v_cvt_f32_f16 v66, v91
    v_cvt_f32_f16_sdwa v67, v91 dst_sel:DWORD dst_unused:UNUSED_PAD src0_sel:WORD_1
    v_mul_f32 v66, v83, v66
    v_mul_f32 v67, v83, v67
    v_cvt_pk_bf16_f32 v91, v66, v67
    v_lshlrev_b32 v66, 16, v91
    v_and_b32 v67, 0xffff0000, v91
    s_waitcnt lgkmcnt(1)
    v_pk_add_f32 v[40:41], v[16:17], v[40:41]
    v_pk_add_f32 v[42:43], v[18:19], v[42:43]
    v_pk_mul_f32 v[40:41], v[40:41], v[80:81] op_sel_hi:[1,0]
    v_pk_mul_f32 v[42:43], v[42:43], v[80:81] op_sel_hi:[1,0]
    v_cvt_pk_bf16_f32 v72, v40, v41
    v_cvt_pk_bf16_f32 v73, v42, v43
    v_lshlrev_b32 v40, 16, v72
    v_and_b32 v41, 0xffff0000, v72
    v_lshlrev_b32 v42, 16, v73
    v_and_b32 v43, 0xffff0000, v73
    v_pk_add_f32 v[40:41], v[40:41], v[60:61]
    v_pk_add_f32 v[42:43], v[42:43], v[62:63]
    v_cvt_pk_bf16_f32 v72, v40, v41
    v_cvt_pk_bf16_f32 v73, v42, v43
    s_waitcnt lgkmcnt(0)
    v_pk_add_f32 v[44:45], v[20:21], v[44:45]
    v_pk_add_f32 v[46:47], v[22:23], v[46:47]
    v_pk_mul_f32 v[44:45], v[44:45], v[82:83] op_sel_hi:[1,0]
    v_pk_mul_f32 v[46:47], v[46:47], v[82:83] op_sel_hi:[1,0]
    v_cvt_pk_bf16_f32 v74, v44, v45
    v_cvt_pk_bf16_f32 v75, v46, v47
    v_lshlrev_b32 v44, 16, v74
    v_and_b32 v45, 0xffff0000, v74
    v_lshlrev_b32 v46, 16, v75
    v_and_b32 v47, 0xffff0000, v75
    v_pk_add_f32 v[44:45], v[44:45], v[64:65]
    v_pk_add_f32 v[46:47], v[46:47], v[66:67]
    v_cvt_pk_bf16_f32 v74, v44, v45
    v_cvt_pk_bf16_f32 v75, v46, v47
    s_branch CVE_19
CV_16:
    ds_read2_b32 v[36:37], v6 offset0:240 offset1:241
    ds_read2_b32 v[38:39], v6 offset0:242 offset1:243
    ds_read2_b32 v[40:41], v6 offset0:208 offset1:209
    ds_read2_b32 v[42:43], v6 offset0:210 offset1:211
    ds_read2_b32 v[44:45], v6 offset0:176 offset1:177
    ds_read2_b32 v[46:47], v6 offset0:178 offset1:179
    ds_read2_b32 v[48:49], v6 offset0:144 offset1:145
    ds_read2_b32 v[50:51], v6 offset0:146 offset1:147
    ds_read2_b32 v[52:53], v6 offset0:112 offset1:113
    ds_read2_b32 v[54:55], v6 offset0:114 offset1:115
    ds_read2_b32 v[56:57], v6 offset0:80 offset1:81
    ds_read2_b32 v[58:59], v6 offset0:82 offset1:83
    ds_read2_b32 v[60:61], v6 offset0:48 offset1:49
    ds_read2_b32 v[62:63], v6 offset0:50 offset1:51
    ds_read2_b32 v[64:65], v6 offset0:16 offset1:17
    ds_read2_b32 v[66:67], v6 offset0:18 offset1:19
W_28:
    ds_read_b32 v92, v4 offset:16
    s_sub_u32 s39, s39, 1
    s_cbranch_scc1 KS_ABORT
    s_waitcnt lgkmcnt(0)
    v_cmp_ne_u32 vcc, s84, v92
    s_cbranch_vccnz W_28
    ds_read_b128 v[76:79], v8 offset:2432
    ds_read_b128 v[80:83], v8 offset:2304
    ds_read_b128 v[84:87], v8 offset:2176
    ds_read_b128 v[88:91], v8 offset:2048
    s_waitcnt lgkmcnt(3)
    v_mfma_f32_16x16x32_f16 v[32:35], v[36:39], v[76:79], 0
    s_add_u32 s92, s94, 2496
    v_add_u32 v126, s92, v12
    ds_read_b128 v[76:79], v8 offset:1920
    s_waitcnt lgkmcnt(3)
    v_mfma_f32_16x16x32_f16 v[32:35], v[40:43], v[80:83], v[32:35]
    ds_read_b128 v[92:95], v126
    ds_read_b128 v[96:99], v126 offset:16
    ds_read_b128 v[80:83], v8 offset:1792
    s_waitcnt lgkmcnt(5)
    v_mfma_f32_16x16x32_f16 v[32:35], v[44:47], v[84:87], v[32:35]
    ds_read_b64 v[100:101], v126 offset:32
    s_add_u32 s92, s85, 2048
    ds_read_b128 v[84:87], v8 offset:1664
    s_waitcnt lgkmcnt(6)
    v_mfma_f32_16x16x32_f16 v[32:35], v[48:51], v[88:91], v[32:35]
    v_add_u32 v127, s92, v12
    ds_read_b128 v[88:91], v8 offset:1536
    s_waitcnt lgkmcnt(6)
    v_mfma_f32_16x16x32_f16 v[28:31], v[36:39], v[76:79], 0
    v_mfma_f32_16x16x32_f16 v[32:35], v[52:55], v[76:79], v[32:35]
    ds_read_b128 v[76:79], v8 offset:1408
    s_waitcnt lgkmcnt(4)
    v_mfma_f32_16x16x32_f16 v[28:31], v[40:43], v[80:83], v[28:31]
    s_waitcnt lgkmcnt(3)
    v_fma_mix_f32 v102, v93, 1.0, 0 op_sel:[1,0,0] op_sel_hi:[1,0,0]
    v_mfma_f32_16x16x32_f16 v[32:35], v[56:59], v[80:83], v[32:35]
    v_fma_mix_f32 v103, v94, 1.0, v102 op_sel_hi:[1,0,0]
    v_fma_mix_f32 v104, v94, 1.0, v103 op_sel:[1,0,0] op_sel_hi:[1,0,0]
    ds_read_b128 v[80:83], v8 offset:1280
    s_waitcnt lgkmcnt(3)
    v_mfma_f32_16x16x32_f16 v[28:31], v[44:47], v[84:87], v[28:31]
    v_fma_mix_f32 v105, v95, 1.0, v104 op_sel_hi:[1,0,0]
    v_fma_mix_f32 v106, v95, 1.0, v105 op_sel:[1,0,0] op_sel_hi:[1,0,0]
    v_mfma_f32_16x16x32_f16 v[32:35], v[60:63], v[84:87], v[32:35]
    v_fma_mix_f32 v107, v96, 1.0, v106 op_sel_hi:[1,0,0]
    v_fma_mix_f32 v108, v96, 1.0, v107 op_sel:[1,0,0] op_sel_hi:[1,0,0]
    ds_read_b128 v[84:87], v8 offset:1152
    s_waitcnt lgkmcnt(3)
    v_mfma_f32_16x16x32_f16 v[28:31], v[48:51], v[88:91], v[28:31]
    v_fma_mix_f32 v109, v97, 1.0, v108 op_sel_hi:[1,0,0]
    v_fma_mix_f32 v110, v97, 1.0, v109 op_sel:[1,0,0] op_sel_hi:[1,0,0]
    v_mfma_f32_16x16x32_f16 v[32:35], v[64:67], v[88:91], v[32:35]
    v_fma_mix_f32 v111, v98, 1.0, v110 op_sel_hi:[1,0,0]
    v_fma_mix_f32 v112, v98, 1.0, v111 op_sel:[1,0,0] op_sel_hi:[1,0,0]
    ds_read_b128 v[88:91], v8 offset:1024
    s_waitcnt lgkmcnt(3)
    v_mfma_f32_16x16x32_f16 v[24:27], v[36:39], v[76:79], 0
    v_fma_mix_f32 v113, v99, 1.0, v112 op_sel_hi:[1,0,0]
    v_fma_mix_f32 v114, v99, 1.0, v113 op_sel:[1,0,0] op_sel_hi:[1,0,0]
    v_mfma_f32_16x16x32_f16 v[28:31], v[52:55], v[76:79], v[28:31]
    v_fma_mix_f32 v115, v100, 1.0, v114 op_sel_hi:[1,0,0]
    v_fma_mix_f32 v116, v100, 1.0, v115 op_sel:[1,0,0] op_sel_hi:[1,0,0]
    ds_read_b128 v[76:79], v8 offset:896
    s_waitcnt lgkmcnt(3)
    v_mfma_f32_16x16x32_f16 v[24:27], v[40:43], v[80:83], v[24:27]
    v_sub_f32 v125, v105, v102
    v_cvt_pk_f16_f32 v120, v104, v125
    v_mfma_f32_16x16x32_f16 v[28:31], v[56:59], v[80:83], v[28:31]
    v_sub_f32 v124, v106, v103
    v_sub_f32 v125, v107, v104
    ds_read_b128 v[80:83], v8 offset:768
    s_waitcnt lgkmcnt(3)
    v_mfma_f32_16x16x32_f16 v[24:27], v[44:47], v[84:87], v[24:27]
    v_cvt_pk_f16_f32 v121, v124, v125
    v_sub_f32 v124, v108, v105
    v_mfma_f32_16x16x32_f16 v[28:31], v[60:63], v[84:87], v[28:31]
    v_sub_f32 v125, v109, v106
    v_cvt_pk_f16_f32 v122, v124, v125
    ds_read_b128 v[84:87], v8 offset:640
    s_waitcnt lgkmcnt(3)
    v_mfma_f32_16x16x32_f16 v[24:27], v[48:51], v[88:91], v[24:27]
    v_sub_f32 v124, v110, v107
    v_sub_f32 v125, v111, v108
    v_mfma_f32_16x16x32_f16 v[28:31], v[64:67], v[88:91], v[28:31]
    v_cvt_pk_f16_f32 v123, v124, v125
    ds_write_b128 v127, v[120:123] offset:0
    ds_read_b128 v[88:91], v8 offset:512
    s_waitcnt lgkmcnt(4)
    v_mfma_f32_16x16x32_f16 v[20:23], v[36:39], v[76:79], 0
    v_sub_f32 v124, v109, v104
    v_sub_f32 v125, v110, v105
    v_mfma_f32_16x16x32_f16 v[24:27], v[52:55], v[76:79], v[24:27]
    v_cvt_pk_f16_f32 v92, v124, v125
    v_sub_f32 v124, v111, v106
    ds_read_b128 v[76:79], v8 offset:384
    s_waitcnt lgkmcnt(4)
    v_mfma_f32_16x16x32_f16 v[20:23], v[40:43], v[80:83], v[20:23]
    v_sub_f32 v125, v112, v107
    v_cvt_pk_f16_f32 v93, v124, v125
    v_mfma_f32_16x16x32_f16 v[24:27], v[56:59], v[80:83], v[24:27]
    v_sub_f32 v124, v113, v108
    v_sub_f32 v125, v114, v109
    ds_read_b128 v[80:83], v8 offset:256
    s_waitcnt lgkmcnt(4)
    v_mfma_f32_16x16x32_f16 v[20:23], v[44:47], v[84:87], v[20:23]
    v_cvt_pk_f16_f32 v94, v124, v125
    v_sub_f32 v124, v115, v110
    v_mfma_f32_16x16x32_f16 v[24:27], v[60:63], v[84:87], v[24:27]
    v_sub_f32 v125, v116, v111
    v_cvt_pk_f16_f32 v95, v124, v125
    ds_read_b128 v[84:87], v8 offset:128
    s_waitcnt lgkmcnt(3)
    v_mfma_f32_16x16x32_f16 v[20:23], v[48:51], v[88:91], v[20:23]
    ds_write_b128 v127, v[92:95] offset:3104
    ds_write_b8 v15, v5 offset:76
    v_mfma_f32_16x16x32_f16 v[24:27], v[64:67], v[88:91], v[24:27]
    ds_read_b128 v[88:91], v8 offset:0
    s_waitcnt lgkmcnt(5)
    v_mfma_f32_16x16x32_f16 v[16:19], v[36:39], v[76:79], 0
    ds_read2_b32 v[92:93], v11 offset0:96 offset1:97
    ds_read2_b32 v[94:95], v11 offset0:98 offset1:99
    v_mfma_f32_16x16x32_f16 v[20:23], v[52:55], v[76:79], v[20:23]
    ds_read2_b32 v[96:97], v11 offset0:80 offset1:81
    ds_read2_b32 v[98:99], v11 offset0:82 offset1:83
    s_waitcnt lgkmcnt(8)
    v_mfma_f32_16x16x32_f16 v[16:19], v[40:43], v[80:83], v[16:19]
    ds_read2_b32 v[100:101], v11 offset0:64 offset1:65
    ds_read2_b32 v[102:103], v11 offset0:66 offset1:67
    v_mfma_f32_16x16x32_f16 v[20:23], v[56:59], v[80:83], v[20:23]
    ds_read2_b32 v[104:105], v13 offset0:24 offset1:25
    ds_read2_b32 v[106:107], v13 offset0:26 offset1:27
    s_waitcnt lgkmcnt(11)
    v_mfma_f32_16x16x32_f16 v[16:19], v[44:47], v[84:87], v[16:19]
    ds_read2_b32 v[108:109], v13 offset0:120 offset1:121
    ds_read2_b32 v[110:111], v13 offset0:122 offset1:123
    v_mfma_f32_16x16x32_f16 v[20:23], v[60:63], v[84:87], v[20:23]
    s_waitcnt lgkmcnt(10)
    v_mfma_f32_16x16x32_f16 v[16:19], v[48:51], v[88:91], v[16:19]
    v_mfma_f32_16x16x32_f16 v[20:23], v[64:67], v[88:91], v[20:23]
W_29:
    ds_read_b32 v36, v14 offset:76
    s_sub_u32 s39, s39, 1
    s_cbranch_scc1 KS_ABORT
    s_waitcnt lgkmcnt(0)
    v_cmp_ne_u32 vcc, s84, v36
    s_cbranch_vccnz W_29
    ds_read_b64_tr_b16 v[36:37], v9 offset:3088
    ds_read_b64_tr_b16 v[38:39], v9 offset:3152
    ds_read_b64_tr_b16 v[40:41], v9 offset:3600
    ds_read_b64_tr_b16 v[42:43], v9 offset:3664
    ds_read_b64_tr_b16 v[44:45], v9 offset:4112
    ds_read_b64_tr_b16 v[46:47], v9 offset:4176
    ds_read_b64_tr_b16 v[48:49], v10 offset:6176
    ds_read_b64_tr_b16 v[50:51], v10 offset:6304
    ds_read_b64_tr_b16 v[52:53], v10 offset:8224
    ds_read_b64_tr_b16 v[54:55], v10 offset:8352
    s_waitcnt lgkmcnt(8)
    v_mfma_f32_16x16x32_f16 v[24:27], v[36:39], v[92:95], v[24:27]
    v_mfma_f32_16x16x32_f16 v[28:31], v[36:39], v[96:99], v[28:31]
    v_mfma_f32_16x16x32_f16 v[32:35], v[36:39], v[100:103], v[32:35]
    s_waitcnt lgkmcnt(6)
    v_mfma_f32_16x16x32_f16 v[28:31], v[40:43], v[92:95], v[28:31]
    v_mfma_f32_16x16x32_f16 v[32:35], v[40:43], v[96:99], v[32:35]
    s_waitcnt lgkmcnt(4)
    v_mfma_f32_16x16x32_f16 v[32:35], v[44:47], v[92:95], v[32:35]
    s_waitcnt lgkmcnt(2)
    v_mfma_f32_16x16x32_f16 v[32:35], v[48:51], v[104:107], v[32:35]
    s_waitcnt lgkmcnt(0)
    v_mfma_f32_16x16x32_f16 v[32:35], v[52:55], v[108:111], v[32:35]
    v_add_u32 v6, 35584, v12
    v_add_u32 v7, 72192, v12
    v_add_u32 v9, 108800, v12
    v_lshrrev_b32 v10, 2, v2
    v_lshl_add_u32 v10, v10, 2, v3
    v_and_b32 v11, 3, v2
    v_lshlrev_b32 v11, 4, v11
    v_lshlrev_b32 v13, 5, v2
    v_lshl_add_u32 v13, v3, 3, v13
    v_and_b32 v8, 1, v1
    v_cmp_eq_u32 s[98:99], 1, v8
    s_lshl_b32 s92, s87, 2
    s_add_u32 s92, s92, s86
    v_mov_b32 v8, s92
    s_cmp_eq_u32 s87, 1
    s_cbranch_scc1 EP_31
    s_cmp_eq_u32 s87, 2
    s_cbranch_scc1 EP_32
    s_nop 3
    ds_write_b128 v6, v[16:19] offset:14848
    ds_write_b128 v6, v[24:27] offset:15872
    ds_write_b128 v6, v[28:31] offset:16896
    ds_write_b128 v6, v[32:35] offset:17920
    ds_write_b8 v8, v5 offset:160
    s_add_u32 s64, s36, 0x600000
    s_addc_u32 s65, s37, 0
    s_mov_b32 s66, 0x200000
    s_mov_b32 s67, 0x20000
    v_lshl_add_u32 v10, v10, 15, v11
    s_lshl_b32 s92, s88, 5
    s_and_b32 s92, s92, 0xffffffc0
    s_add_u32 s92, s92, 16384
    ds_read_b64 v[80:81], v4 offset:832
    ds_read_b64 v[88:89], v13 offset:4064
    ds_read_b64 v[82:83], v4 offset:848
    ds_read_b64 v[90:91], v13 offset:8672
W_33:
    ds_read_b64 v[40:41], v4 offset:160
    s_sub_u32 s39, s39, 1
    s_cbranch_scc1 KS_ABORT
    s_waitcnt lgkmcnt(0)
    v_and_b32 v40, v40, v41
    v_cmp_ne_u32 vcc, s84, v40
    s_cbranch_vccnz W_33
    ds_read_b128 v[40:43], v6 offset:10752
    ds_read_b128 v[44:47], v7 offset:11776
    ds_read_b128 v[48:51], v7 offset:15872
    v_cvt_f32_f16 v60, v88
    v_cvt_f32_f16_sdwa v61, v88 dst_sel:DWORD dst_unused:UNUSED_PAD src0_sel:WORD_1
    v_mul_f32 v60, v81, v60
    v_mul_f32 v61, v81, v61
    v_cvt_pk_bf16_f32 v88, v60, v61
    v_lshlrev_b32 v60, 16, v88
    v_and_b32 v61, 0xffff0000, v88
    v_cvt_f32_f16 v62, v89
    v_cvt_f32_f16_sdwa v63, v89 dst_sel:DWORD dst_unused:UNUSED_PAD src0_sel:WORD_1
    v_mul_f32 v62, v81, v62
    v_mul_f32 v63, v81, v63
    v_cvt_pk_bf16_f32 v89, v62, v63
    v_lshlrev_b32 v62, 16, v89
    v_and_b32 v63, 0xffff0000, v89
    v_cvt_f32_f16 v64, v90
    v_cvt_f32_f16_sdwa v65, v90 dst_sel:DWORD dst_unused:UNUSED_PAD src0_sel:WORD_1
    v_mul_f32 v64, v83, v64
    v_mul_f32 v65, v83, v65
    v_cvt_pk_bf16_f32 v90, v64, v65
    v_lshlrev_b32 v64, 16, v90
    v_and_b32 v65, 0xffff0000, v90
    v_cvt_f32_f16 v66, v91
    v_cvt_f32_f16_sdwa v67, v91 dst_sel:DWORD dst_unused:UNUSED_PAD src0_sel:WORD_1
    v_mul_f32 v66, v83, v66
    v_mul_f32 v67, v83, v67
    v_cvt_pk_bf16_f32 v91, v66, v67
    v_lshlrev_b32 v66, 16, v91
    v_and_b32 v67, 0xffff0000, v91
    s_waitcnt lgkmcnt(2)
    v_pk_add_f32 v[40:41], v[40:41], v[20:21]
    v_pk_add_f32 v[42:43], v[42:43], v[22:23]
    v_pk_mul_f32 v[40:41], v[40:41], v[80:81] op_sel_hi:[1,0]
    v_pk_mul_f32 v[42:43], v[42:43], v[80:81] op_sel_hi:[1,0]
    v_cvt_pk_bf16_f32 v72, v40, v41
    v_cvt_pk_bf16_f32 v73, v42, v43
    v_lshlrev_b32 v40, 16, v72
    v_and_b32 v41, 0xffff0000, v72
    v_lshlrev_b32 v42, 16, v73
    v_and_b32 v43, 0xffff0000, v73
    v_pk_add_f32 v[40:41], v[40:41], v[60:61]
    v_pk_add_f32 v[42:43], v[42:43], v[62:63]
    v_cvt_pk_bf16_f32 v72, v40, v41
    v_cvt_pk_bf16_f32 v73, v42, v43
    s_waitcnt lgkmcnt(0)
    v_pk_add_f32 v[44:45], v[44:45], v[48:49]
    v_pk_add_f32 v[46:47], v[46:47], v[50:51]
    v_pk_mul_f32 v[44:45], v[44:45], v[82:83] op_sel_hi:[1,0]
    v_pk_mul_f32 v[46:47], v[46:47], v[82:83] op_sel_hi:[1,0]
    v_cvt_pk_bf16_f32 v74, v44, v45
    v_cvt_pk_bf16_f32 v75, v46, v47
    v_lshlrev_b32 v44, 16, v74
    v_and_b32 v45, 0xffff0000, v74
    v_lshlrev_b32 v46, 16, v75
    v_and_b32 v47, 0xffff0000, v75
    v_pk_add_f32 v[44:45], v[44:45], v[64:65]
    v_pk_add_f32 v[46:47], v[46:47], v[66:67]
    v_cvt_pk_bf16_f32 v74, v44, v45
    v_cvt_pk_bf16_f32 v75, v46, v47
    s_branch CVE_19
EP_31:
    s_nop 3
    ds_write_b128 v7, v[16:19] offset:14848
    ds_write_b128 v7, v[20:23] offset:15872
    ds_write_b128 v7, v[24:27] offset:16896
    ds_write_b128 v7, v[32:35] offset:17920
    ds_write_b8 v8, v5 offset:160
    s_add_u32 s64, s36, 0x600000
    s_addc_u32 s65, s37, 0
    s_mov_b32 s66, 0x200000
    s_mov_b32 s67, 0x20000
    v_lshl_add_u32 v10, v10, 15, v11
    s_lshl_b32 s92, s88, 5
    s_and_b32 s92, s92, 0xffffffc0
    s_add_u32 s92, s92, 540672
    ds_read_b64 v[80:81], v4 offset:832
    ds_read_b64 v[88:89], v13 offset:5088
    ds_read_b64 v[82:83], v4 offset:848
    ds_read_b64 v[90:91], v13 offset:9696
W_34:
    ds_read_b64 v[40:41], v4 offset:160
    s_sub_u32 s39, s39, 1
    s_cbranch_scc1 KS_ABORT
    s_waitcnt lgkmcnt(0)
    v_and_b32 v40, v40, v41
    v_cmp_ne_u32 vcc, s84, v40
    s_cbranch_vccnz W_34
    ds_read_b128 v[40:43], v6 offset:12800
    ds_read_b128 v[44:47], v6 offset:16896
    ds_read_b128 v[48:51], v7 offset:12800
    v_cvt_f32_f16 v60, v88
    v_cvt_f32_f16_sdwa v61, v88 dst_sel:DWORD dst_unused:UNUSED_PAD src0_sel:WORD_1
    v_mul_f32 v60, v81, v60
    v_mul_f32 v61, v81, v61
    v_cvt_pk_bf16_f32 v88, v60, v61
    v_lshlrev_b32 v60, 16, v88
    v_and_b32 v61, 0xffff0000, v88
    v_cvt_f32_f16 v62, v89
    v_cvt_f32_f16_sdwa v63, v89 dst_sel:DWORD dst_unused:UNUSED_PAD src0_sel:WORD_1
    v_mul_f32 v62, v81, v62
    v_mul_f32 v63, v81, v63
    v_cvt_pk_bf16_f32 v89, v62, v63
    v_lshlrev_b32 v62, 16, v89
    v_and_b32 v63, 0xffff0000, v89
    v_cvt_f32_f16 v64, v90
    v_cvt_f32_f16_sdwa v65, v90 dst_sel:DWORD dst_unused:UNUSED_PAD src0_sel:WORD_1
    v_mul_f32 v64, v83, v64
    v_mul_f32 v65, v83, v65
    v_cvt_pk_bf16_f32 v90, v64, v65
    v_lshlrev_b32 v64, 16, v90
    v_and_b32 v65, 0xffff0000, v90
    v_cvt_f32_f16 v66, v91
    v_cvt_f32_f16_sdwa v67, v91 dst_sel:DWORD dst_unused:UNUSED_PAD src0_sel:WORD_1
    v_mul_f32 v66, v83, v66
    v_mul_f32 v67, v83, v67
    v_cvt_pk_bf16_f32 v91, v66, v67
    v_lshlrev_b32 v66, 16, v91
    v_and_b32 v67, 0xffff0000, v91
    s_waitcnt lgkmcnt(1)
    v_pk_add_f32 v[40:41], v[40:41], v[44:45]
    v_pk_add_f32 v[42:43], v[42:43], v[46:47]
    v_pk_mul_f32 v[40:41], v[40:41], v[80:81] op_sel_hi:[1,0]
    v_pk_mul_f32 v[42:43], v[42:43], v[80:81] op_sel_hi:[1,0]
    v_cvt_pk_bf16_f32 v72, v40, v41
    v_cvt_pk_bf16_f32 v73, v42, v43
    v_lshlrev_b32 v40, 16, v72
    v_and_b32 v41, 0xffff0000, v72
    v_lshlrev_b32 v42, 16, v73
    v_and_b32 v43, 0xffff0000, v73
    v_pk_add_f32 v[40:41], v[40:41], v[60:61]
    v_pk_add_f32 v[42:43], v[42:43], v[62:63]
    v_cvt_pk_bf16_f32 v72, v40, v41
    v_cvt_pk_bf16_f32 v73, v42, v43
    s_waitcnt lgkmcnt(0)
    v_pk_add_f32 v[48:49], v[48:49], v[28:29]
    v_pk_add_f32 v[50:51], v[50:51], v[30:31]
    v_pk_mul_f32 v[48:49], v[48:49], v[82:83] op_sel_hi:[1,0]
    v_pk_mul_f32 v[50:51], v[50:51], v[82:83] op_sel_hi:[1,0]
    v_cvt_pk_bf16_f32 v74, v48, v49
    v_cvt_pk_bf16_f32 v75, v50, v51
    v_lshlrev_b32 v48, 16, v74
    v_and_b32 v49, 0xffff0000, v74
    v_lshlrev_b32 v50, 16, v75
    v_and_b32 v51, 0xffff0000, v75
    v_pk_add_f32 v[48:49], v[48:49], v[64:65]
    v_pk_add_f32 v[50:51], v[50:51], v[66:67]
    v_cvt_pk_bf16_f32 v74, v48, v49
    v_cvt_pk_bf16_f32 v75, v50, v51
    s_branch CVE_19
EP_32:
    s_nop 3
    ds_write_b128 v9, v[16:19] offset:13824
    ds_write_b128 v9, v[20:23] offset:14848
    ds_write_b128 v9, v[32:35] offset:15872
    ds_write_b8 v8, v5 offset:160
    s_add_u32 s64, s36, 0x800000
    s_addc_u32 s65, s37, 0
    s_mov_b32 s66, 0x40000
    s_mov_b32 s67, 0x20000
    v_lshl_add_u32 v10, v10, 12, v11
    s_sub_u32 s92, s88, 512
    s_lshl_b32 s92, s92, 6
    s_add_u32 s92, s92, 65536
    ds_read_b64 v[80:81], v4 offset:864
    ds_read_b64 v[88:89], v13 offset:13792
    ds_read_b64 v[82:83], v4 offset:864
    ds_read_b64 v[90:91], v13 offset:14304
W_35:
    ds_read_b32 v40, v4 offset:168
    s_sub_u32 s39, s39, 1
    s_cbranch_scc1 KS_ABORT
    s_waitcnt lgkmcnt(0)
    v_cmp_ne_u32 vcc, s84, v40
    s_cbranch_vccnz W_35
    ds_read_b128 v[40:43], v9 offset:10752
    ds_read_b128 v[44:47], v9 offset:11776
    v_cvt_f32_f16 v60, v88
    v_cvt_f32_f16_sdwa v61, v88 dst_sel:DWORD dst_unused:UNUSED_PAD src0_sel:WORD_1
    v_mul_f32 v60, v81, v60
    v_mul_f32 v61, v81, v61
    v_cvt_pk_bf16_f32 v88, v60, v61
    v_lshlrev_b32 v60, 16, v88
    v_and_b32 v61, 0xffff0000, v88
    v_cvt_f32_f16 v62, v89
    v_cvt_f32_f16_sdwa v63, v89 dst_sel:DWORD dst_unused:UNUSED_PAD src0_sel:WORD_1
    v_mul_f32 v62, v81, v62
    v_mul_f32 v63, v81, v63
    v_cvt_pk_bf16_f32 v89, v62, v63
    v_lshlrev_b32 v62, 16, v89
    v_and_b32 v63, 0xffff0000, v89
    v_cvt_f32_f16 v64, v90
    v_cvt_f32_f16_sdwa v65, v90 dst_sel:DWORD dst_unused:UNUSED_PAD src0_sel:WORD_1
    v_mul_f32 v64, v83, v64
    v_mul_f32 v65, v83, v65
    v_cvt_pk_bf16_f32 v90, v64, v65
    v_lshlrev_b32 v64, 16, v90
    v_and_b32 v65, 0xffff0000, v90
    v_cvt_f32_f16 v66, v91
    v_cvt_f32_f16_sdwa v67, v91 dst_sel:DWORD dst_unused:UNUSED_PAD src0_sel:WORD_1
    v_mul_f32 v66, v83, v66
    v_mul_f32 v67, v83, v67
    v_cvt_pk_bf16_f32 v91, v66, v67
    v_lshlrev_b32 v66, 16, v91
    v_and_b32 v67, 0xffff0000, v91
    s_waitcnt lgkmcnt(1)
    v_pk_add_f32 v[40:41], v[40:41], v[24:25]
    v_pk_add_f32 v[42:43], v[42:43], v[26:27]
    v_pk_mul_f32 v[40:41], v[40:41], v[80:81] op_sel_hi:[1,0]
    v_pk_mul_f32 v[42:43], v[42:43], v[80:81] op_sel_hi:[1,0]
    v_cvt_pk_bf16_f32 v72, v40, v41
    v_cvt_pk_bf16_f32 v73, v42, v43
    v_lshlrev_b32 v40, 16, v72
    v_and_b32 v41, 0xffff0000, v72
    v_lshlrev_b32 v42, 16, v73
    v_and_b32 v43, 0xffff0000, v73
    v_pk_add_f32 v[40:41], v[40:41], v[60:61]
    v_pk_add_f32 v[42:43], v[42:43], v[62:63]
    v_cvt_pk_bf16_f32 v72, v40, v41
    v_cvt_pk_bf16_f32 v73, v42, v43
    s_waitcnt lgkmcnt(0)
    v_pk_add_f32 v[44:45], v[44:45], v[28:29]
    v_pk_add_f32 v[46:47], v[46:47], v[30:31]
    v_pk_mul_f32 v[44:45], v[44:45], v[82:83] op_sel_hi:[1,0]
    v_pk_mul_f32 v[46:47], v[46:47], v[82:83] op_sel_hi:[1,0]
    v_cvt_pk_bf16_f32 v74, v44, v45
    v_cvt_pk_bf16_f32 v75, v46, v47
    v_lshlrev_b32 v44, 16, v74
    v_and_b32 v45, 0xffff0000, v74
    v_lshlrev_b32 v46, 16, v75
    v_and_b32 v47, 0xffff0000, v75
    v_pk_add_f32 v[44:45], v[44:45], v[64:65]
    v_pk_add_f32 v[46:47], v[46:47], v[66:67]
    v_cvt_pk_bf16_f32 v74, v44, v45
    v_cvt_pk_bf16_f32 v75, v46, v47
    s_branch CVE_19
CV_17:
    ds_read2_b32 v[36:37], v7 offset0:96 offset1:97
    ds_read2_b32 v[38:39], v7 offset0:98 offset1:99
    ds_read2_b32 v[40:41], v6 offset0:224 offset1:225
    ds_read2_b32 v[42:43], v6 offset0:226 offset1:227
    ds_read2_b32 v[44:45], v6 offset0:192 offset1:193
    ds_read2_b32 v[46:47], v6 offset0:194 offset1:195
    ds_read2_b32 v[48:49], v6 offset0:160 offset1:161
    ds_read2_b32 v[50:51], v6 offset0:162 offset1:163
    ds_read2_b32 v[52:53], v6 offset0:128 offset1:129
    ds_read2_b32 v[54:55], v6 offset0:130 offset1:131
    ds_read2_b32 v[56:57], v6 offset0:96 offset1:97
    ds_read2_b32 v[58:59], v6 offset0:98 offset1:99
    ds_read2_b32 v[60:61], v6 offset0:64 offset1:65
    ds_read2_b32 v[62:63], v6 offset0:66 offset1:67
    ds_read2_b32 v[64:65], v6 offset0:32 offset1:33
    ds_read2_b32 v[66:67], v6 offset0:34 offset1:35
    ds_read2_b32 v[68:69], v6 offset0:0 offset1:1
    ds_read2_b32 v[70:71], v6 offset0:2 offset1:3
    ds_read2_b32 v[72:73], v7 offset0:128 offset1:129
    ds_read2_b32 v[74:75], v7 offset0:130 offset1:131
W_36:
    ds_read_b32 v92, v4 offset:16
    s_sub_u32 s39, s39, 1
    s_cbranch_scc1 KS_ABORT
    s_waitcnt lgkmcnt(0)
    v_cmp_ne_u32 vcc, s84, v92
    s_cbranch_vccnz W_36
    ds_read_b128 v[76:79], v8 offset:4032
    ds_read_b128 v[80:83], v8 offset:3904
    ds_read_b128 v[84:87], v8 offset:3776
    ds_read_b128 v[88:91], v8 offset:3648
    s_waitcnt lgkmcnt(3)
    v_mfma_f32_16x16x32_f16 v[24:27], v[36:39], v[76:79], 0
    s_add_u32 s92, s94, 448
    v_add_u32 v126, s92, v12
    ds_read_b128 v[92:95], v126
    ds_read_b128 v[96:99], v126 offset:16
    ds_read_b128 v[76:79], v8 offset:3520
    s_waitcnt lgkmcnt(5)
    v_mfma_f32_16x16x32_f16 v[24:27], v[40:43], v[80:83], v[24:27]
    ds_read_b64 v[100:101], v126 offset:32
    s_add_u32 s92, s85, 0
    v_add_u32 v127, s92, v12
    ds_read_b128 v[80:83], v8 offset:3392
    s_waitcnt lgkmcnt(6)
    v_mfma_f32_16x16x32_f16 v[24:27], v[44:47], v[84:87], v[24:27]
    ds_read_b128 v[84:87], v8 offset:3264
    s_waitcnt lgkmcnt(6)
    v_mfma_f32_16x16x32_f16 v[24:27], v[48:51], v[88:91], v[24:27]
    s_waitcnt lgkmcnt(2)
    v_fma_mix_f32 v102, v93, 1.0, 0 op_sel:[1,0,0] op_sel_hi:[1,0,0]
    v_fma_mix_f32 v103, v94, 1.0, v102 op_sel_hi:[1,0,0]
    v_fma_mix_f32 v104, v94, 1.0, v103 op_sel:[1,0,0] op_sel_hi:[1,0,0]
    ds_read_b128 v[88:91], v8 offset:3136
    s_waitcnt lgkmcnt(4)
    v_mfma_f32_16x16x32_f16 v[20:23], v[36:39], v[76:79], 0
    v_fma_mix_f32 v105, v95, 1.0, v104 op_sel_hi:[1,0,0]
    v_fma_mix_f32 v106, v95, 1.0, v105 op_sel:[1,0,0] op_sel_hi:[1,0,0]
    v_fma_mix_f32 v107, v96, 1.0, v106 op_sel_hi:[1,0,0]
    v_fma_mix_f32 v108, v96, 1.0, v107 op_sel:[1,0,0] op_sel_hi:[1,0,0]
    v_mfma_f32_16x16x32_f16 v[24:27], v[52:55], v[76:79], v[24:27]
    v_fma_mix_f32 v109, v97, 1.0, v108 op_sel_hi:[1,0,0]
    v_fma_mix_f32 v110, v97, 1.0, v109 op_sel:[1,0,0] op_sel_hi:[1,0,0]
    v_fma_mix_f32 v111, v98, 1.0, v110 op_sel_hi:[1,0,0]
    v_fma_mix_f32 v112, v98, 1.0, v111 op_sel:[1,0,0] op_sel_hi:[1,0,0]
    ds_read_b128 v[76:79], v8 offset:3008
    s_waitcnt lgkmcnt(3)
    v_mfma_f32_16x16x32_f16 v[20:23], v[40:43], v[80:83], v[20:23]
    v_fma_mix_f32 v113, v99, 1.0, v112 op_sel_hi:[1,0,0]
    v_fma_mix_f32 v114, v99, 1.0, v113 op_sel:[1,0,0] op_sel_hi:[1,0,0]
    v_fma_mix_f32 v115, v100, 1.0, v114 op_sel_hi:[1,0,0]
    v_fma_mix_f32 v116, v100, 1.0, v115 op_sel:[1,0,0] op_sel_hi:[1,0,0]
    v_mfma_f32_16x16x32_f16 v[24:27], v[56:59], v[80:83], v[24:27]
    v_fma_mix_f32 v117, v101, 1.0, v116 op_sel_hi:[1,0,0]
    v_fma_mix_f32 v118, v101, 1.0, v117 op_sel:[1,0,0] op_sel_hi:[1,0,0]
    v_sub_f32 v125, v105, v102
    v_cvt_pk_f16_f32 v120, v104, v125
    ds_read_b128 v[80:83], v8 offset:2880
    s_waitcnt lgkmcnt(3)
    v_mfma_f32_16x16x32_f16 v[20:23], v[44:47], v[84:87], v[20:23]
    v_sub_f32 v124, v106, v103
    v_sub_f32 v125, v107, v104
    v_cvt_pk_f16_f32 v121, v124, v125
    v_sub_f32 v124, v108, v105
    v_mfma_f32_16x16x32_f16 v[24:27], v[60:63], v[84:87], v[24:27]
    v_sub_f32 v125, v109, v106
    v_cvt_pk_f16_f32 v122, v124, v125
    v_sub_f32 v124, v110, v107
    v_sub_f32 v125, v111, v108
    ds_read_b128 v[84:87], v8 offset:2752
    s_waitcnt lgkmcnt(3)
    v_mfma_f32_16x16x32_f16 v[20:23], v[48:51], v[88:91], v[20:23]
    v_cvt_pk_f16_f32 v123, v124, v125
    ds_write_b128 v127, v[120:123] offset:0
    v_sub_f32 v124, v109, v104
    v_sub_f32 v125, v110, v105
    v_mfma_f32_16x16x32_f16 v[24:27], v[64:67], v[88:91], v[24:27]
    v_cvt_pk_f16_f32 v92, v124, v125
    v_sub_f32 v124, v111, v106
    v_sub_f32 v125, v112, v107
    v_cvt_pk_f16_f32 v93, v124, v125
    ds_read_b128 v[88:91], v8 offset:2624
    s_waitcnt lgkmcnt(4)
    v_mfma_f32_16x16x32_f16 v[16:19], v[36:39], v[76:79], 0
    v_sub_f32 v124, v113, v108
    v_sub_f32 v125, v114, v109
    v_cvt_pk_f16_f32 v94, v124, v125
    v_sub_f32 v124, v115, v110
    v_mfma_f32_16x16x32_f16 v[20:23], v[52:55], v[76:79], v[20:23]
    v_sub_f32 v125, v116, v111
    v_cvt_pk_f16_f32 v95, v124, v125
    ds_write_b128 v127, v[92:95] offset:3104
    v_sub_f32 v124, v110, v103
    v_mfma_f32_16x16x32_f16 v[24:27], v[68:71], v[76:79], v[24:27]
    v_sub_f32 v125, v111, v104
    v_cvt_pk_f16_f32 v120, v124, v125
    v_sub_f32 v124, v112, v105
    v_sub_f32 v125, v113, v106
    ds_read_b128 v[76:79], v8 offset:2496
    s_waitcnt lgkmcnt(5)
    v_mfma_f32_16x16x32_f16 v[16:19], v[40:43], v[80:83], v[16:19]
    v_cvt_pk_f16_f32 v121, v124, v125
    v_sub_f32 v124, v114, v107
    v_sub_f32 v125, v115, v108
    v_cvt_pk_f16_f32 v122, v124, v125
    v_mfma_f32_16x16x32_f16 v[20:23], v[56:59], v[80:83], v[20:23]
    v_sub_f32 v124, v116, v109
    v_sub_f32 v125, v117, v110
    v_cvt_pk_f16_f32 v123, v124, v125
    ds_write_b128 v127, v[120:123] offset:6176
    ds_read_b128 v[80:83], v8 offset:2368
    s_waitcnt lgkmcnt(6)
    v_mfma_f32_16x16x32_f16 v[16:19], v[44:47], v[84:87], v[16:19]
    v_sub_f32 v124, v111, v102
    v_sub_f32 v125, v112, v103
    v_cvt_pk_f16_f32 v92, v124, v125
    v_sub_f32 v124, v113, v104
    v_mfma_f32_16x16x32_f16 v[20:23], v[60:63], v[84:87], v[20:23]
    v_sub_f32 v125, v114, v105
    v_cvt_pk_f16_f32 v93, v124, v125
    v_sub_f32 v124, v115, v106
    v_sub_f32 v125, v116, v107
    ds_read_b128 v[84:87], v8 offset:2240
    s_waitcnt lgkmcnt(5)
    v_mfma_f32_16x16x32_f16 v[16:19], v[48:51], v[88:91], v[16:19]
    v_cvt_pk_f16_f32 v94, v124, v125
    v_sub_f32 v124, v117, v108
    v_sub_f32 v125, v118, v109
    v_cvt_pk_f16_f32 v95, v124, v125
    v_mfma_f32_16x16x32_f16 v[20:23], v[64:67], v[88:91], v[20:23]
    ds_write_b128 v127, v[92:95] offset:8240
    ds_write_b8 v15, v5 offset:76
    ds_read_b128 v[88:91], v8 offset:2112
    s_waitcnt lgkmcnt(6)
    v_mfma_f32_16x16x32_f16 v[16:19], v[52:55], v[76:79], v[16:19]
    ds_read2_b32 v[92:93], v13 offset0:24 offset1:25
    ds_read2_b32 v[94:95], v13 offset0:26 offset1:27
    ds_read2_b32 v[96:97], v13 offset0:16 offset1:17
    ds_read2_b32 v[98:99], v13 offset0:18 offset1:19
    v_mfma_f32_16x16x32_f16 v[20:23], v[68:71], v[76:79], v[20:23]
    ds_read2_b32 v[100:101], v13 offset0:8 offset1:9
    ds_read2_b32 v[102:103], v13 offset0:10 offset1:11
    ds_read2_b32 v[104:105], v13 offset0:0 offset1:1
    ds_read2_b32 v[106:107], v13 offset0:2 offset1:3
    ds_read_b128 v[76:79], v8 offset:1984
    s_waitcnt lgkmcnt(13)
    v_mfma_f32_16x16x32_f16 v[16:19], v[56:59], v[80:83], v[16:19]
    ds_read2_b32 v[108:109], v13 offset0:120 offset1:121
    ds_read2_b32 v[110:111], v13 offset0:122 offset1:123
    ds_read2_b32 v[112:113], v13 offset0:112 offset1:113
    ds_read2_b32 v[114:115], v13 offset0:114 offset1:115
    ds_read_b128 v[80:83], v8 offset:1472
    v_mfma_f32_16x16x32_f16 v[16:19], v[60:63], v[84:87], v[16:19]
    ds_read2_b32 v[116:117], v13 offset0:104 offset1:105
    ds_read2_b32 v[118:119], v13 offset0:106 offset1:107
    ds_read2_b32 v[120:121], v13 offset0:96 offset1:97
    ds_read2_b32 v[122:123], v13 offset0:98 offset1:99
    ds_read_b128 v[84:87], v8 offset:960
    v_mfma_f32_16x16x32_f16 v[16:19], v[64:67], v[88:91], v[16:19]
    s_waitcnt lgkmcnt(10)
    v_mfma_f32_16x16x32_f16 v[16:19], v[68:71], v[76:79], v[16:19]
    v_mfma_f32_16x16x32_f16 v[24:27], v[72:75], v[76:79], v[24:27]
    s_waitcnt lgkmcnt(5)
    v_mfma_f32_16x16x32_f16 v[20:23], v[72:75], v[80:83], v[20:23]
    s_waitcnt lgkmcnt(0)
    v_mfma_f32_16x16x32_f16 v[16:19], v[72:75], v[84:87], v[16:19]
W_37:
    ds_read_b32 v36, v14 offset:76
    s_sub_u32 s39, s39, 1
    s_cbranch_scc1 KS_ABORT
    s_waitcnt lgkmcnt(0)
    v_cmp_ne_u32 vcc, s84, v36
    s_cbranch_vccnz W_37
    ds_read_b64_tr_b16 v[36:37], v10 offset:6176
    ds_read_b64_tr_b16 v[38:39], v10 offset:6304
    ds_read_b64_tr_b16 v[40:41], v10 offset:7200
    ds_read_b64_tr_b16 v[42:43], v10 offset:7328
    ds_read_b64_tr_b16 v[44:45], v10 offset:8224
    ds_read_b64_tr_b16 v[46:47], v10 offset:8352
    ds_read_b64_tr_b16 v[48:49], v10 offset:9248
    ds_read_b64_tr_b16 v[50:51], v10 offset:9376
    s_waitcnt lgkmcnt(6)
    v_mfma_f32_16x16x32_f16 v[16:19], v[36:39], v[96:99], v[16:19]
    v_mfma_f32_16x16x32_f16 v[20:23], v[36:39], v[100:103], v[20:23]
    v_mfma_f32_16x16x32_f16 v[24:27], v[36:39], v[104:107], v[24:27]
    s_waitcnt lgkmcnt(4)
    v_mfma_f32_16x16x32_f16 v[20:23], v[40:43], v[92:95], v[20:23]
    v_mfma_f32_16x16x32_f16 v[24:27], v[40:43], v[96:99], v[24:27]
    s_waitcnt lgkmcnt(2)
    v_mfma_f32_16x16x32_f16 v[16:19], v[44:47], v[112:115], v[16:19]
    v_mfma_f32_16x16x32_f16 v[20:23], v[44:47], v[116:119], v[20:23]
    v_mfma_f32_16x16x32_f16 v[24:27], v[44:47], v[120:123], v[24:27]
    s_waitcnt lgkmcnt(0)
    v_mfma_f32_16x16x32_f16 v[20:23], v[48:51], v[108:111], v[20:23]
    v_mfma_f32_16x16x32_f16 v[24:27], v[48:51], v[112:115], v[24:27]
    v_add_u32 v6, 35584, v12
    v_add_u32 v7, 72192, v12
    v_add_u32 v9, 108800, v12
    v_lshrrev_b32 v10, 2, v2
    v_lshl_add_u32 v10, v10, 2, v3
    v_and_b32 v11, 3, v2
    v_lshlrev_b32 v11, 4, v11
    v_lshlrev_b32 v13, 5, v2
    v_lshl_add_u32 v13, v3, 3, v13
    v_and_b32 v8, 1, v1
    v_cmp_eq_u32 s[98:99], 1, v8
    s_lshl_b32 s92, s87, 2
    s_add_u32 s92, s92, s86
    v_mov_b32 v8, s92
    s_cmp_eq_u32 s87, 1
    s_cbranch_scc1 EP_39
    s_cmp_eq_u32 s87, 2
    s_cbranch_scc1 EP_40
    s_nop 3
    ds_write_b128 v6, v[20:23] offset:18944
    ds_write_b128 v6, v[24:27] offset:19968
    ds_write_b8 v8, v5 offset:160
    s_add_u32 s64, s36, 0x600000
    s_addc_u32 s65, s37, 0
    s_mov_b32 s66, 0x200000
    s_mov_b32 s67, 0x20000
    v_lshl_add_u32 v10, v10, 15, v11
    s_lshl_b32 s92, s88, 5
    s_and_b32 s92, s92, 0xffffffc0
    s_add_u32 s92, s92, 1064960
    ds_read_b64 v[80:81], v4 offset:832
    ds_read_b64 v[88:89], v13 offset:6112
    ds_read_b64 v[82:83], v4 offset:848
    ds_read_b64 v[90:91], v13 offset:10720
W_41:
    ds_read_b64 v[40:41], v4 offset:160
    s_sub_u32 s39, s39, 1
    s_cbranch_scc1 KS_ABORT
    s_waitcnt lgkmcnt(0)
    v_and_b32 v40, v40, v41
    v_cmp_ne_u32 vcc, s84, v40
    s_cbranch_vccnz W_41
    ds_read_b128 v[40:43], v6 offset:20992
    ds_read_b128 v[44:47], v7 offset:18944
    ds_read_b128 v[48:51], v7 offset:20992
    v_cvt_f32_f16 v60, v88
    v_cvt_f32_f16_sdwa v61, v88 dst_sel:DWORD dst_unused:UNUSED_PAD src0_sel:WORD_1
    v_mul_f32 v60, v81, v60
    v_mul_f32 v61, v81, v61
    v_cvt_pk_bf16_f32 v88, v60, v61
    v_lshlrev_b32 v60, 16, v88
    v_and_b32 v61, 0xffff0000, v88
    v_cvt_f32_f16 v62, v89
    v_cvt_f32_f16_sdwa v63, v89 dst_sel:DWORD dst_unused:UNUSED_PAD src0_sel:WORD_1
    v_mul_f32 v62, v81, v62
    v_mul_f32 v63, v81, v63
    v_cvt_pk_bf16_f32 v89, v62, v63
    v_lshlrev_b32 v62, 16, v89
    v_and_b32 v63, 0xffff0000, v89
    v_cvt_f32_f16 v64, v90
    v_cvt_f32_f16_sdwa v65, v90 dst_sel:DWORD dst_unused:UNUSED_PAD src0_sel:WORD_1
    v_mul_f32 v64, v83, v64
    v_mul_f32 v65, v83, v65
    v_cvt_pk_bf16_f32 v90, v64, v65
    v_lshlrev_b32 v64, 16, v90
    v_and_b32 v65, 0xffff0000, v90
    v_cvt_f32_f16 v66, v91
    v_cvt_f32_f16_sdwa v67, v91 dst_sel:DWORD dst_unused:UNUSED_PAD src0_sel:WORD_1
    v_mul_f32 v66, v83, v66
    v_mul_f32 v67, v83, v67
    v_cvt_pk_bf16_f32 v91, v66, v67
    v_lshlrev_b32 v66, 16, v91
    v_and_b32 v67, 0xffff0000, v91
    s_waitcnt lgkmcnt(2)
    v_pk_add_f32 v[40:41], v[16:17], v[40:41]
    v_pk_add_f32 v[42:43], v[18:19], v[42:43]
    v_pk_mul_f32 v[40:41], v[40:41], v[80:81] op_sel_hi:[1,0]
    v_pk_mul_f32 v[42:43], v[42:43], v[80:81] op_sel_hi:[1,0]
    v_cvt_pk_bf16_f32 v72, v40, v41
    v_cvt_pk_bf16_f32 v73, v42, v43
    v_lshlrev_b32 v40, 16, v72
    v_and_b32 v41, 0xffff0000, v72
    v_lshlrev_b32 v42, 16, v73
    v_and_b32 v43, 0xffff0000, v73
    v_pk_add_f32 v[40:41], v[40:41], v[60:61]
    v_pk_add_f32 v[42:43], v[42:43], v[62:63]
    v_cvt_pk_bf16_f32 v72, v40, v41
    v_cvt_pk_bf16_f32 v73, v42, v43
    s_waitcnt lgkmcnt(0)
    v_pk_add_f32 v[44:45], v[44:45], v[48:49]
    v_pk_add_f32 v[46:47], v[46:47], v[50:51]
    v_pk_mul_f32 v[44:45], v[44:45], v[82:83] op_sel_hi:[1,0]
    v_pk_mul_f32 v[46:47], v[46:47], v[82:83] op_sel_hi:[1,0]
    v_cvt_pk_bf16_f32 v74, v44, v45
    v_cvt_pk_bf16_f32 v75, v46, v47
    v_lshlrev_b32 v44, 16, v74
    v_and_b32 v45, 0xffff0000, v74
    v_lshlrev_b32 v46, 16, v75
    v_and_b32 v47, 0xffff0000, v75
    v_pk_add_f32 v[44:45], v[44:45], v[64:65]
    v_pk_add_f32 v[46:47], v[46:47], v[66:67]
    v_cvt_pk_bf16_f32 v74, v44, v45
    v_cvt_pk_bf16_f32 v75, v46, v47
    s_branch CVE_19
EP_39:
    s_nop 3
    ds_write_b128 v7, v[16:19] offset:18944
    ds_write_b128 v7, v[20:23] offset:19968
    ds_write_b8 v8, v5 offset:160
    s_add_u32 s64, s36, 0x600000
    s_addc_u32 s65, s37, 0
    s_mov_b32 s66, 0x200000
    s_mov_b32 s67, 0x20000
    v_lshl_add_u32 v10, v10, 15, v11
    s_lshl_b32 s92, s88, 5
    s_and_b32 s92, s92, 0xffffffc0
    s_add_u32 s92, s92, 1589248
    ds_read_b64 v[80:81], v4 offset:832
    ds_read_b64 v[88:89], v13 offset:7136
    ds_read_b64 v[82:83], v4 offset:848
    ds_read_b64 v[90:91], v13 offset:11744
W_42:
    ds_read_b64 v[40:41], v4 offset:160
    s_sub_u32 s39, s39, 1
    s_cbranch_scc1 KS_ABORT
    s_waitcnt lgkmcnt(0)
    v_and_b32 v40, v40, v41
    v_cmp_ne_u32 vcc, s84, v40
    s_cbranch_vccnz W_42
    ds_read_b128 v[40:43], v6 offset:19968
    ds_read_b128 v[44:47], v6 offset:22016
    ds_read_b128 v[48:51], v7 offset:23040
    v_cvt_f32_f16 v60, v88
    v_cvt_f32_f16_sdwa v61, v88 dst_sel:DWORD dst_unused:UNUSED_PAD src0_sel:WORD_1
    v_mul_f32 v60, v81, v60
    v_mul_f32 v61, v81, v61
    v_cvt_pk_bf16_f32 v88, v60, v61
    v_lshlrev_b32 v60, 16, v88
    v_and_b32 v61, 0xffff0000, v88
    v_cvt_f32_f16 v62, v89
    v_cvt_f32_f16_sdwa v63, v89 dst_sel:DWORD dst_unused:UNUSED_PAD src0_sel:WORD_1
    v_mul_f32 v62, v81, v62
    v_mul_f32 v63, v81, v63
    v_cvt_pk_bf16_f32 v89, v62, v63
    v_lshlrev_b32 v62, 16, v89
    v_and_b32 v63, 0xffff0000, v89
    v_cvt_f32_f16 v64, v90
    v_cvt_f32_f16_sdwa v65, v90 dst_sel:DWORD dst_unused:UNUSED_PAD src0_sel:WORD_1
    v_mul_f32 v64, v83, v64
    v_mul_f32 v65, v83, v65
    v_cvt_pk_bf16_f32 v90, v64, v65
    v_lshlrev_b32 v64, 16, v90
    v_and_b32 v65, 0xffff0000, v90
    v_cvt_f32_f16 v66, v91
    v_cvt_f32_f16_sdwa v67, v91 dst_sel:DWORD dst_unused:UNUSED_PAD src0_sel:WORD_1
    v_mul_f32 v66, v83, v66
    v_mul_f32 v67, v83, v67
    v_cvt_pk_bf16_f32 v91, v66, v67
    v_lshlrev_b32 v66, 16, v91
    v_and_b32 v67, 0xffff0000, v91
    s_waitcnt lgkmcnt(1)
    v_pk_add_f32 v[40:41], v[40:41], v[44:45]
    v_pk_add_f32 v[42:43], v[42:43], v[46:47]
    v_pk_mul_f32 v[40:41], v[40:41], v[80:81] op_sel_hi:[1,0]
    v_pk_mul_f32 v[42:43], v[42:43], v[80:81] op_sel_hi:[1,0]
    v_cvt_pk_bf16_f32 v72, v40, v41
    v_cvt_pk_bf16_f32 v73, v42, v43
    v_lshlrev_b32 v40, 16, v72
    v_and_b32 v41, 0xffff0000, v72
    v_lshlrev_b32 v42, 16, v73
    v_and_b32 v43, 0xffff0000, v73
    v_pk_add_f32 v[40:41], v[40:41], v[60:61]
    v_pk_add_f32 v[42:43], v[42:43], v[62:63]
    v_cvt_pk_bf16_f32 v72, v40, v41
    v_cvt_pk_bf16_f32 v73, v42, v43
    s_waitcnt lgkmcnt(0)
    v_pk_add_f32 v[48:49], v[24:25], v[48:49]
    v_pk_add_f32 v[50:51], v[26:27], v[50:51]
    v_pk_mul_f32 v[48:49], v[48:49], v[82:83] op_sel_hi:[1,0]
    v_pk_mul_f32 v[50:51], v[50:51], v[82:83] op_sel_hi:[1,0]
    v_cvt_pk_bf16_f32 v74, v48, v49
    v_cvt_pk_bf16_f32 v75, v50, v51
    v_lshlrev_b32 v48, 16, v74
    v_and_b32 v49, 0xffff0000, v74
    v_lshlrev_b32 v50, 16, v75
    v_and_b32 v51, 0xffff0000, v75
    v_pk_add_f32 v[48:49], v[48:49], v[64:65]
    v_pk_add_f32 v[50:51], v[50:51], v[66:67]
    v_cvt_pk_bf16_f32 v74, v48, v49
    v_cvt_pk_bf16_f32 v75, v50, v51
    s_branch CVE_19
EP_40:
    s_nop 3
    ds_write_b128 v9, v[20:23] offset:16896
    ds_write_b128 v9, v[24:27] offset:17920
    ds_write_b8 v8, v5 offset:160
    s_add_u32 s64, s36, 0x800000
    s_addc_u32 s65, s37, 0
    s_mov_b32 s66, 0x40000
    s_mov_b32 s67, 0x20000
    v_lshl_add_u32 v10, v10, 12, v11
    s_sub_u32 s92, s88, 512
    s_lshl_b32 s92, s92, 6
    s_add_u32 s92, s92, 131072
    ds_read_b64 v[80:81], v4 offset:864
    ds_read_b64 v[88:89], v13 offset:14816
    ds_read_b64 v[82:83], v4 offset:864
    ds_read_b64 v[90:91], v13 offset:15328
W_43:
    ds_read_b32 v40, v4 offset:168
    s_sub_u32 s39, s39, 1
    s_cbranch_scc1 KS_ABORT
    s_waitcnt lgkmcnt(0)
    v_cmp_ne_u32 vcc, s84, v40
    s_cbranch_vccnz W_43
    ds_read_b128 v[40:43], v9 offset:12800
    ds_read_b128 v[44:47], v9 offset:15872
    ds_read_b128 v[48:51], v9 offset:18944
    v_cvt_f32_f16 v60, v88
    v_cvt_f32_f16_sdwa v61, v88 dst_sel:DWORD dst_unused:UNUSED_PAD src0_sel:WORD_1
    v_mul_f32 v60, v81, v60
    v_mul_f32 v61, v81, v61
    v_cvt_pk_bf16_f32 v88, v60, v61
    v_lshlrev_b32 v60, 16, v88
    v_and_b32 v61, 0xffff0000, v88
    v_cvt_f32_f16 v62, v89
    v_cvt_f32_f16_sdwa v63, v89 dst_sel:DWORD dst_unused:UNUSED_PAD src0_sel:WORD_1
    v_mul_f32 v62, v81, v62
    v_mul_f32 v63, v81, v63
    v_cvt_pk_bf16_f32 v89, v62, v63
    v_lshlrev_b32 v62, 16, v89
    v_and_b32 v63, 0xffff0000, v89
    v_cvt_f32_f16 v64, v90
    v_cvt_f32_f16_sdwa v65, v90 dst_sel:DWORD dst_unused:UNUSED_PAD src0_sel:WORD_1
    v_mul_f32 v64, v83, v64
    v_mul_f32 v65, v83, v65
    v_cvt_pk_bf16_f32 v90, v64, v65
    v_lshlrev_b32 v64, 16, v90
    v_and_b32 v65, 0xffff0000, v90
    v_cvt_f32_f16 v66, v91
    v_cvt_f32_f16_sdwa v67, v91 dst_sel:DWORD dst_unused:UNUSED_PAD src0_sel:WORD_1
    v_mul_f32 v66, v83, v66
    v_mul_f32 v67, v83, v67
    v_cvt_pk_bf16_f32 v91, v66, v67
    v_lshlrev_b32 v66, 16, v91
    v_and_b32 v67, 0xffff0000, v91
    s_waitcnt lgkmcnt(1)
    v_pk_add_f32 v[40:41], v[40:41], v[44:45]
    v_pk_add_f32 v[42:43], v[42:43], v[46:47]
    v_pk_mul_f32 v[40:41], v[40:41], v[80:81] op_sel_hi:[1,0]
    v_pk_mul_f32 v[42:43], v[42:43], v[80:81] op_sel_hi:[1,0]
    v_cvt_pk_bf16_f32 v72, v40, v41
    v_cvt_pk_bf16_f32 v73, v42, v43
    v_lshlrev_b32 v40, 16, v72
    v_and_b32 v41, 0xffff0000, v72
    v_lshlrev_b32 v42, 16, v73
    v_and_b32 v43, 0xffff0000, v73
    v_pk_add_f32 v[40:41], v[40:41], v[60:61]
    v_pk_add_f32 v[42:43], v[42:43], v[62:63]
    v_cvt_pk_bf16_f32 v72, v40, v41
    v_cvt_pk_bf16_f32 v73, v42, v43
    s_waitcnt lgkmcnt(0)
    v_pk_add_f32 v[48:49], v[16:17], v[48:49]
    v_pk_add_f32 v[50:51], v[18:19], v[50:51]
    v_pk_mul_f32 v[48:49], v[48:49], v[82:83] op_sel_hi:[1,0]
    v_pk_mul_f32 v[50:51], v[50:51], v[82:83] op_sel_hi:[1,0]
    v_cvt_pk_bf16_f32 v74, v48, v49
    v_cvt_pk_bf16_f32 v75, v50, v51
    v_lshlrev_b32 v48, 16, v74
    v_and_b32 v49, 0xffff0000, v74
    v_lshlrev_b32 v50, 16, v75
    v_and_b32 v51, 0xffff0000, v75
    v_pk_add_f32 v[48:49], v[48:49], v[64:65]
    v_pk_add_f32 v[50:51], v[50:51], v[66:67]
    v_cvt_pk_bf16_f32 v74, v48, v49
    v_cvt_pk_bf16_f32 v75, v50, v51
    s_branch CVE_19
CV_18:
    ds_read2_b32 v[36:37], v6 offset0:240 offset1:241
    ds_read2_b32 v[38:39], v6 offset0:242 offset1:243
    ds_read2_b32 v[40:41], v6 offset0:208 offset1:209
    ds_read2_b32 v[42:43], v6 offset0:210 offset1:211
    ds_read2_b32 v[44:45], v6 offset0:176 offset1:177
    ds_read2_b32 v[46:47], v6 offset0:178 offset1:179
    ds_read2_b32 v[48:49], v6 offset0:144 offset1:145
    ds_read2_b32 v[50:51], v6 offset0:146 offset1:147
    ds_read2_b32 v[52:53], v6 offset0:112 offset1:113
    ds_read2_b32 v[54:55], v6 offset0:114 offset1:115
    ds_read2_b32 v[56:57], v6 offset0:80 offset1:81
    ds_read2_b32 v[58:59], v6 offset0:82 offset1:83
    ds_read2_b32 v[60:61], v6 offset0:48 offset1:49
    ds_read2_b32 v[62:63], v6 offset0:50 offset1:51
    ds_read2_b32 v[64:65], v6 offset0:16 offset1:17
    ds_read2_b32 v[66:67], v6 offset0:18 offset1:19
W_44:
    ds_read_b32 v92, v4 offset:16
    s_sub_u32 s39, s39, 1
    s_cbranch_scc1 KS_ABORT
    s_waitcnt lgkmcnt(0)
    v_cmp_ne_u32 vcc, s84, v92
    s_cbranch_vccnz W_44
    ds_read_b128 v[76:79], v8 offset:3968
    ds_read_b128 v[80:83], v8 offset:3840
    ds_read_b128 v[84:87], v8 offset:3712
    ds_read_b128 v[88:91], v8 offset:3584
    s_waitcnt lgkmcnt(3)
    v_mfma_f32_16x16x32_f16 v[24:27], v[36:39], v[76:79], 0
    s_add_u32 s92, s94, 1472
    v_add_u32 v126, s92, v12
    ds_read_b128 v[92:95], v126
    ds_read_b128 v[96:99], v126 offset:16
    ds_read_b64 v[100:101], v126 offset:32
    ds_read_b128 v[76:79], v8 offset:3456
    s_waitcnt lgkmcnt(6)
    v_mfma_f32_16x16x32_f16 v[24:27], v[40:43], v[80:83], v[24:27]
    s_add_u32 s92, s85, 1024
    v_add_u32 v127, s92, v12
    ds_read_b128 v[80:83], v8 offset:3328
    s_waitcnt lgkmcnt(6)
    v_mfma_f32_16x16x32_f16 v[24:27], v[44:47], v[84:87], v[24:27]
    s_waitcnt lgkmcnt(2)
    v_fma_mix_f32 v102, v93, 1.0, 0 op_sel:[1,0,0] op_sel_hi:[1,0,0]
    v_fma_mix_f32 v103, v94, 1.0, v102 op_sel_hi:[1,0,0]
    ds_read_b128 v[84:87], v8 offset:3200
    s_waitcnt lgkmcnt(6)
    v_mfma_f32_16x16x32_f16 v[24:27], v[48:51], v[88:91], v[24:27]
    v_fma_mix_f32 v104, v94, 1.0, v103 op_sel:[1,0,0] op_sel_hi:[1,0,0]
    v_fma_mix_f32 v105, v95, 1.0, v104 op_sel_hi:[1,0,0]
    v_fma_mix_f32 v106, v95, 1.0, v105 op_sel:[1,0,0] op_sel_hi:[1,0,0]
    v_fma_mix_f32 v107, v96, 1.0, v106 op_sel_hi:[1,0,0]
    v_fma_mix_f32 v108, v96, 1.0, v107 op_sel:[1,0,0] op_sel_hi:[1,0,0]
    ds_read_b128 v[88:91], v8 offset:3072
    s_waitcnt lgkmcnt(3)
    v_mfma_f32_16x16x32_f16 v[20:23], v[36:39], v[76:79], 0
    v_fma_mix_f32 v109, v97, 1.0, v108 op_sel_hi:[1,0,0]
    v_fma_mix_f32 v110, v97, 1.0, v109 op_sel:[1,0,0] op_sel_hi:[1,0,0]
    v_fma_mix_f32 v111, v98, 1.0, v110 op_sel_hi:[1,0,0]
    v_fma_mix_f32 v112, v98, 1.0, v111 op_sel:[1,0,0] op_sel_hi:[1,0,0]
    v_fma_mix_f32 v113, v99, 1.0, v112 op_sel_hi:[1,0,0]
    v_mfma_f32_16x16x32_f16 v[24:27], v[52:55], v[76:79], v[24:27]
    v_fma_mix_f32 v114, v99, 1.0, v113 op_sel:[1,0,0] op_sel_hi:[1,0,0]
    v_fma_mix_f32 v115, v100, 1.0, v114 op_sel_hi:[1,0,0]
    v_fma_mix_f32 v116, v100, 1.0, v115 op_sel:[1,0,0] op_sel_hi:[1,0,0]
    v_fma_mix_f32 v117, v101, 1.0, v116 op_sel_hi:[1,0,0]
    v_fma_mix_f32 v118, v101, 1.0, v117 op_sel:[1,0,0] op_sel_hi:[1,0,0]
    ds_read_b128 v[76:79], v8 offset:2944
    s_waitcnt lgkmcnt(3)
    v_mfma_f32_16x16x32_f16 v[20:23], v[40:43], v[80:83], v[20:23]
    v_sub_f32 v125, v105, v102
    v_cvt_pk_f16_f32 v120, v104, v125
    v_sub_f32 v124, v106, v103
    v_sub_f32 v125, v107, v104
    v_cvt_pk_f16_f32 v121, v124, v125
    v_mfma_f32_16x16x32_f16 v[24:27], v[56:59], v[80:83], v[24:27]
    v_sub_f32 v124, v108, v105
    v_sub_f32 v125, v109, v106
    v_cvt_pk_f16_f32 v122, v124, v125
    v_sub_f32 v124, v110, v107
    v_sub_f32 v125, v111, v108
    ds_read_b128 v[80:83], v8 offset:2816
    s_waitcnt lgkmcnt(3)
    v_mfma_f32_16x16x32_f16 v[20:23], v[44:47], v[84:87], v[20:23]
    v_cvt_pk_f16_f32 v123, v124, v125
    ds_write_b128 v127, v[120:123] offset:0
    v_sub_f32 v124, v109, v104
    v_sub_f32 v125, v110, v105
    v_cvt_pk_f16_f32 v92, v124, v125
    v_mfma_f32_16x16x32_f16 v[24:27], v[60:63], v[84:87], v[24:27]
    v_sub_f32 v124, v111, v106
    v_sub_f32 v125, v112, v107
    v_cvt_pk_f16_f32 v93, v124, v125
    v_sub_f32 v124, v113, v108
    v_sub_f32 v125, v114, v109
    ds_read_b128 v[84:87], v8 offset:2688
    s_waitcnt lgkmcnt(4)
    v_mfma_f32_16x16x32_f16 v[20:23], v[48:51], v[88:91], v[20:23]
    v_cvt_pk_f16_f32 v94, v124, v125
    v_sub_f32 v124, v115, v110
    v_sub_f32 v125, v116, v111
    v_cvt_pk_f16_f32 v95, v124, v125
    ds_write_b128 v127, v[92:95] offset:3104
    v_mfma_f32_16x16x32_f16 v[24:27], v[64:67], v[88:91], v[24:27]
    v_sub_f32 v124, v110, v103
    v_sub_f32 v125, v111, v104
    v_cvt_pk_f16_f32 v120, v124, v125
    v_sub_f32 v124, v112, v105
    v_sub_f32 v125, v113, v106
    ds_read_b128 v[88:91], v8 offset:2560
    s_waitcnt lgkmcnt(5)
    v_mfma_f32_16x16x32_f16 v[16:19], v[36:39], v[76:79], 0
    v_cvt_pk_f16_f32 v121, v124, v125
    v_sub_f32 v124, v114, v107
    v_sub_f32 v125, v115, v108
    v_cvt_pk_f16_f32 v122, v124, v125
    v_sub_f32 v124, v116, v109
    v_mfma_f32_16x16x32_f16 v[20:23], v[52:55], v[76:79], v[20:23]
    v_sub_f32 v125, v117, v110
    v_cvt_pk_f16_f32 v123, v124, v125
    ds_write_b128 v127, v[120:123] offset:6176
    v_sub_f32 v124, v111, v102
    v_sub_f32 v125, v112, v103
    ds_read_b128 v[76:79], v8 offset:2432
    s_waitcnt lgkmcnt(6)
    v_mfma_f32_16x16x32_f16 v[16:19], v[40:43], v[80:83], v[16:19]
    v_cvt_pk_f16_f32 v92, v124, v125
    v_sub_f32 v124, v113, v104
    v_sub_f32 v125, v114, v105
    v_cvt_pk_f16_f32 v93, v124, v125
    v_sub_f32 v124, v115, v106
    v_mfma_f32_16x16x32_f16 v[20:23], v[56:59], v[80:83], v[20:23]
    v_sub_f32 v125, v116, v107
    v_cvt_pk_f16_f32 v94, v124, v125
    v_sub_f32 v124, v117, v108
    v_sub_f32 v125, v118, v109
    v_cvt_pk_f16_f32 v95, v124, v125
    ds_read_b128 v[80:83], v8 offset:2304
    s_waitcnt lgkmcnt(5)
    v_mfma_f32_16x16x32_f16 v[16:19], v[44:47], v[84:87], v[16:19]
    ds_write_b128 v127, v[92:95] offset:8240
    ds_write_b8 v15, v5 offset:76
    ds_read2_b32 v[92:93], v11 offset0:32 offset1:33
    v_mfma_f32_16x16x32_f16 v[20:23], v[60:63], v[84:87], v[20:23]
    ds_read2_b32 v[94:95], v11 offset0:34 offset1:35
    ds_read2_b32 v[96:97], v11 offset0:16 offset1:17
    ds_read2_b32 v[98:99], v11 offset0:18 offset1:19
    ds_read2_b32 v[100:101], v11 offset0:0 offset1:1
    ds_read2_b32 v[102:103], v11 offset0:2 offset1:3
    ds_read_b128 v[84:87], v8 offset:2176
    s_waitcnt lgkmcnt(12)
    v_mfma_f32_16x16x32_f16 v[16:19], v[48:51], v[88:91], v[16:19]
    ds_read2_b32 v[104:105], v11 offset0:96 offset1:97
    ds_read2_b32 v[106:107], v11 offset0:98 offset1:99
    ds_read2_b32 v[108:109], v11 offset0:80 offset1:81
    ds_read2_b32 v[110:111], v11 offset0:82 offset1:83
    ds_read2_b32 v[112:113], v11 offset0:64 offset1:65
    v_mfma_f32_16x16x32_f16 v[20:23], v[64:67], v[88:91], v[20:23]
    ds_read2_b32 v[114:115], v11 offset0:66 offset1:67
    ds_read_b128 v[88:91], v8 offset:2048
    v_mfma_f32_16x16x32_f16 v[16:19], v[52:55], v[76:79], v[16:19]
    v_mfma_f32_16x16x32_f16 v[16:19], v[56:59], v[80:83], v[16:19]
    s_waitcnt lgkmcnt(7)
    v_mfma_f32_16x16x32_f16 v[16:19], v[60:63], v[84:87], v[16:19]
    s_waitcnt lgkmcnt(0)
    v_mfma_f32_16x16x32_f16 v[16:19], v[64:67], v[88:91], v[16:19]
W_45:
    ds_read_b32 v36, v14 offset:76
    s_sub_u32 s39, s39, 1
    s_cbranch_scc1 KS_ABORT
    s_waitcnt lgkmcnt(0)
    v_cmp_ne_u32 vcc, s84, v36
    s_cbranch_vccnz W_45
    ds_read_b64_tr_b16 v[36:37], v9 offset:512
    ds_read_b64_tr_b16 v[38:39], v9 offset:576
    ds_read_b64_tr_b16 v[40:41], v9 offset:1024
    ds_read_b64_tr_b16 v[42:43], v9 offset:1088
    ds_read_b64_tr_b16 v[44:45], v9 offset:1536
    ds_read_b64_tr_b16 v[46:47], v9 offset:1600
    ds_read_b64_tr_b16 v[48:49], v9 offset:2048
    ds_read_b64_tr_b16 v[50:51], v9 offset:2112
    ds_read_b64_tr_b16 v[52:53], v9 offset:2560
    ds_read_b64_tr_b16 v[54:55], v9 offset:2624
    ds_read_b64_tr_b16 v[56:57], v9 offset:3600
    ds_read_b64_tr_b16 v[58:59], v9 offset:3664
    ds_read_b64_tr_b16 v[60:61], v9 offset:4112
    ds_read_b64_tr_b16 v[62:63], v9 offset:4176
    ds_read_b64_tr_b16 v[64:65], v9 offset:4624
    ds_read_b64_tr_b16 v[66:67], v9 offset:4688
    ds_read_b64_tr_b16 v[68:69], v9 offset:5136
    ds_read_b64_tr_b16 v[70:71], v9 offset:5200
    ds_read_b64_tr_b16 v[72:73], v9 offset:5648
    ds_read_b64_tr_b16 v[74:75], v9 offset:5712
    v_mfma_f32_16x16x32_f16 v[16:19], v[36:39], v[100:103], v[16:19]
    v_mfma_f32_16x16x32_f16 v[16:19], v[40:43], v[96:99], v[16:19]
    v_mfma_f32_16x16x32_f16 v[20:23], v[40:43], v[100:103], v[20:23]
    s_waitcnt lgkmcnt(14)
    v_mfma_f32_16x16x32_f16 v[16:19], v[44:47], v[92:95], v[16:19]
    v_mfma_f32_16x16x32_f16 v[20:23], v[44:47], v[96:99], v[20:23]
    v_mfma_f32_16x16x32_f16 v[24:27], v[44:47], v[100:103], v[24:27]
    s_waitcnt lgkmcnt(12)
    v_mfma_f32_16x16x32_f16 v[20:23], v[48:51], v[92:95], v[20:23]
    v_mfma_f32_16x16x32_f16 v[24:27], v[48:51], v[96:99], v[24:27]
    s_waitcnt lgkmcnt(10)
    v_mfma_f32_16x16x32_f16 v[24:27], v[52:55], v[92:95], v[24:27]
    s_waitcnt lgkmcnt(8)
    v_mfma_f32_16x16x32_f16 v[16:19], v[56:59], v[112:115], v[16:19]
    s_waitcnt lgkmcnt(6)
    v_mfma_f32_16x16x32_f16 v[16:19], v[60:63], v[108:111], v[16:19]
    v_mfma_f32_16x16x32_f16 v[20:23], v[60:63], v[112:115], v[20:23]
    s_waitcnt lgkmcnt(4)
    v_mfma_f32_16x16x32_f16 v[16:19], v[64:67], v[104:107], v[16:19]
    v_mfma_f32_16x16x32_f16 v[20:23], v[64:67], v[108:111], v[20:23]
    v_mfma_f32_16x16x32_f16 v[24:27], v[64:67], v[112:115], v[24:27]
    s_waitcnt lgkmcnt(2)
    v_mfma_f32_16x16x32_f16 v[20:23], v[68:71], v[104:107], v[20:23]
    v_mfma_f32_16x16x32_f16 v[24:27], v[68:71], v[108:111], v[24:27]
    s_waitcnt lgkmcnt(0)
    v_mfma_f32_16x16x32_f16 v[24:27], v[72:75], v[104:107], v[24:27]
    v_add_u32 v6, 35584, v12
    v_add_u32 v7, 72192, v12
    v_add_u32 v9, 108800, v12
    v_lshrrev_b32 v10, 2, v2
    v_lshl_add_u32 v10, v10, 2, v3
    v_and_b32 v11, 3, v2
    v_lshlrev_b32 v11, 4, v11
    v_lshlrev_b32 v13, 5, v2
    v_lshl_add_u32 v13, v3, 3, v13
    v_and_b32 v8, 1, v1
    v_cmp_eq_u32 s[98:99], 1, v8
    s_lshl_b32 s92, s87, 2
    s_add_u32 s92, s92, s86
    v_mov_b32 v8, s92
    s_cmp_eq_u32 s87, 1
    s_cbranch_scc1 EP_47
    s_cmp_eq_u32 s87, 2
    s_cbranch_scc1 EP_48
    s_nop 3
    ds_write_b128 v6, v[16:19] offset:20992
    ds_write_b128 v6, v[24:27] offset:22016
    ds_write_b8 v8, v5 offset:160
    s_add_u32 s64, s36, 0x600000
    s_addc_u32 s65, s37, 0
    s_mov_b32 s66, 0x200000
    s_mov_b32 s67, 0x20000
    v_lshl_add_u32 v10, v10, 15, v11
    s_lshl_b32 s92, s88, 5
    s_and_b32 s92, s92, 0xffffffc0
    s_add_u32 s92, s92, 1572864
    ds_read_b64 v[80:81], v4 offset:832
    ds_read_b64 v[88:89], v13 offset:6624
    ds_read_b64 v[82:83], v4 offset:848
    ds_read_b64 v[90:91], v13 offset:11232
W_49:
    ds_read_b64 v[40:41], v4 offset:160
    s_sub_u32 s39, s39, 1
    s_cbranch_scc1 KS_ABORT
    s_waitcnt lgkmcnt(0)
    v_and_b32 v40, v40, v41
    v_cmp_ne_u32 vcc, s84, v40
    s_cbranch_vccnz W_49
    ds_read_b128 v[40:43], v6 offset:18944
    ds_read_b128 v[44:47], v7 offset:19968
    ds_read_b128 v[48:51], v7 offset:22016
    v_cvt_f32_f16 v60, v88
    v_cvt_f32_f16_sdwa v61, v88 dst_sel:DWORD dst_unused:UNUSED_PAD src0_sel:WORD_1
    v_mul_f32 v60, v81, v60
    v_mul_f32 v61, v81, v61
    v_cvt_pk_bf16_f32 v88, v60, v61
    v_lshlrev_b32 v60, 16, v88
    v_and_b32 v61, 0xffff0000, v88
    v_cvt_f32_f16 v62, v89
    v_cvt_f32_f16_sdwa v63, v89 dst_sel:DWORD dst_unused:UNUSED_PAD src0_sel:WORD_1
    v_mul_f32 v62, v81, v62
    v_mul_f32 v63, v81, v63
    v_cvt_pk_bf16_f32 v89, v62, v63
    v_lshlrev_b32 v62, 16, v89
    v_and_b32 v63, 0xffff0000, v89
    v_cvt_f32_f16 v64, v90
    v_cvt_f32_f16_sdwa v65, v90 dst_sel:DWORD dst_unused:UNUSED_PAD src0_sel:WORD_1
    v_mul_f32 v64, v83, v64
    v_mul_f32 v65, v83, v65
    v_cvt_pk_bf16_f32 v90, v64, v65
    v_lshlrev_b32 v64, 16, v90
    v_and_b32 v65, 0xffff0000, v90
    v_cvt_f32_f16 v66, v91
    v_cvt_f32_f16_sdwa v67, v91 dst_sel:DWORD dst_unused:UNUSED_PAD src0_sel:WORD_1
    v_mul_f32 v66, v83, v66
    v_mul_f32 v67, v83, v67
    v_cvt_pk_bf16_f32 v91, v66, v67
    v_lshlrev_b32 v66, 16, v91
    v_and_b32 v67, 0xffff0000, v91
    s_waitcnt lgkmcnt(2)
    v_pk_add_f32 v[40:41], v[40:41], v[20:21]
    v_pk_add_f32 v[42:43], v[42:43], v[22:23]
    v_pk_mul_f32 v[40:41], v[40:41], v[80:81] op_sel_hi:[1,0]
    v_pk_mul_f32 v[42:43], v[42:43], v[80:81] op_sel_hi:[1,0]
    v_cvt_pk_bf16_f32 v72, v40, v41
    v_cvt_pk_bf16_f32 v73, v42, v43
    v_lshlrev_b32 v40, 16, v72
    v_and_b32 v41, 0xffff0000, v72
    v_lshlrev_b32 v42, 16, v73
    v_and_b32 v43, 0xffff0000, v73
    v_pk_add_f32 v[40:41], v[40:41], v[60:61]
    v_pk_add_f32 v[42:43], v[42:43], v[62:63]
    v_cvt_pk_bf16_f32 v72, v40, v41
    v_cvt_pk_bf16_f32 v73, v42, v43
    s_waitcnt lgkmcnt(0)
    v_pk_add_f32 v[44:45], v[44:45], v[48:49]
    v_pk_add_f32 v[46:47], v[46:47], v[50:51]
    v_pk_mul_f32 v[44:45], v[44:45], v[82:83] op_sel_hi:[1,0]
    v_pk_mul_f32 v[46:47], v[46:47], v[82:83] op_sel_hi:[1,0]
    v_cvt_pk_bf16_f32 v74, v44, v45
    v_cvt_pk_bf16_f32 v75, v46, v47
    v_lshlrev_b32 v44, 16, v74
    v_and_b32 v45, 0xffff0000, v74
    v_lshlrev_b32 v46, 16, v75
    v_and_b32 v47, 0xffff0000, v75
    v_pk_add_f32 v[44:45], v[44:45], v[64:65]
    v_pk_add_f32 v[46:47], v[46:47], v[66:67]
    v_cvt_pk_bf16_f32 v74, v44, v45
    v_cvt_pk_bf16_f32 v75, v46, v47
    s_branch CVE_19
EP_47:
    s_nop 3
    ds_write_b128 v7, v[16:19] offset:20992
    ds_write_b128 v7, v[20:23] offset:22016
    ds_write_b128 v7, v[24:27] offset:23040
    ds_write_b8 v8, v5 offset:160
    s_add_u32 s64, s36, 0x600000
    s_addc_u32 s65, s37, 0
    s_mov_b32 s66, 0x200000
    s_mov_b32 s67, 0x20000
    v_lshl_add_u32 v10, v10, 15, v11
    s_lshl_b32 s92, s88, 5
    s_and_b32 s92, s92, 0xffffffc0
    s_add_u32 s92, s92, 1048576
    ds_read_b64 v[80:81], v4 offset:832
    ds_read_b64 v[88:89], v13 offset:5600
    ds_read_b64 v[82:83], v4 offset:848
    ds_read_b64 v[90:91], v13 offset:10208
W_50:
    ds_read_b64 v[40:41], v4 offset:160
    s_sub_u32 s39, s39, 1
    s_cbranch_scc1 KS_ABORT
    s_waitcnt lgkmcnt(0)
    v_and_b32 v40, v40, v41
    v_cmp_ne_u32 vcc, s84, v40
    s_cbranch_vccnz W_50
    ds_read_b128 v[40:43], v6 offset:13824
    ds_read_b128 v[44:47], v6 offset:17920
    ds_read_b128 v[48:51], v7 offset:13824
    ds_read_b128 v[52:55], v7 offset:17920
    v_cvt_f32_f16 v60, v88
    v_cvt_f32_f16_sdwa v61, v88 dst_sel:DWORD dst_unused:UNUSED_PAD src0_sel:WORD_1
    v_mul_f32 v60, v81, v60
    v_mul_f32 v61, v81, v61
    v_cvt_pk_bf16_f32 v88, v60, v61
    v_lshlrev_b32 v60, 16, v88
    v_and_b32 v61, 0xffff0000, v88
    v_cvt_f32_f16 v62, v89
    v_cvt_f32_f16_sdwa v63, v89 dst_sel:DWORD dst_unused:UNUSED_PAD src0_sel:WORD_1
    v_mul_f32 v62, v81, v62
    v_mul_f32 v63, v81, v63
    v_cvt_pk_bf16_f32 v89, v62, v63
    v_lshlrev_b32 v62, 16, v89
    v_and_b32 v63, 0xffff0000, v89
    v_cvt_f32_f16 v64, v90
    v_cvt_f32_f16_sdwa v65, v90 dst_sel:DWORD dst_unused:UNUSED_PAD src0_sel:WORD_1
    v_mul_f32 v64, v83, v64
    v_mul_f32 v65, v83, v65
    v_cvt_pk_bf16_f32 v90, v64, v65
    v_lshlrev_b32 v64, 16, v90
    v_and_b32 v65, 0xffff0000, v90
    v_cvt_f32_f16 v66, v91
    v_cvt_f32_f16_sdwa v67, v91 dst_sel:DWORD dst_unused:UNUSED_PAD src0_sel:WORD_1
    v_mul_f32 v66, v83, v66
    v_mul_f32 v67, v83, v67
    v_cvt_pk_bf16_f32 v91, v66, v67
    v_lshlrev_b32 v66, 16, v91
    v_and_b32 v67, 0xffff0000, v91
    s_waitcnt lgkmcnt(2)
    v_pk_add_f32 v[40:41], v[40:41], v[44:45]
    v_pk_add_f32 v[42:43], v[42:43], v[46:47]
    v_pk_mul_f32 v[40:41], v[40:41], v[80:81] op_sel_hi:[1,0]
    v_pk_mul_f32 v[42:43], v[42:43], v[80:81] op_sel_hi:[1,0]
    v_cvt_pk_bf16_f32 v72, v40, v41
    v_cvt_pk_bf16_f32 v73, v42, v43
    v_lshlrev_b32 v40, 16, v72
    v_and_b32 v41, 0xffff0000, v72
    v_lshlrev_b32 v42, 16, v73
    v_and_b32 v43, 0xffff0000, v73
    v_pk_add_f32 v[40:41], v[40:41], v[60:61]
    v_pk_add_f32 v[42:43], v[42:43], v[62:63]
    v_cvt_pk_bf16_f32 v72, v40, v41
    v_cvt_pk_bf16_f32 v73, v42, v43
    s_waitcnt lgkmcnt(0)
    v_pk_add_f32 v[48:49], v[48:49], v[52:53]
    v_pk_add_f32 v[50:51], v[50:51], v[54:55]
    v_pk_mul_f32 v[48:49], v[48:49], v[82:83] op_sel_hi:[1,0]
    v_pk_mul_f32 v[50:51], v[50:51], v[82:83] op_sel_hi:[1,0]
    v_cvt_pk_bf16_f32 v74, v48, v49
    v_cvt_pk_bf16_f32 v75, v50, v51
    v_lshlrev_b32 v48, 16, v74
    v_and_b32 v49, 0xffff0000, v74
    v_lshlrev_b32 v50, 16, v75
    v_and_b32 v51, 0xffff0000, v75
    v_pk_add_f32 v[48:49], v[48:49], v[64:65]
    v_pk_add_f32 v[50:51], v[50:51], v[66:67]
    v_cvt_pk_bf16_f32 v74, v48, v49
    v_cvt_pk_bf16_f32 v75, v50, v51
    s_branch CVE_19
EP_48:
    s_nop 3
    ds_write_b128 v9, v[16:19] offset:18944
    ds_write_b8 v8, v5 offset:160
    s_add_u32 s64, s36, 0x800000
    s_addc_u32 s65, s37, 0
    s_mov_b32 s66, 0x40000
    s_mov_b32 s67, 0x20000
    v_lshl_add_u32 v10, v10, 12, v11
    s_sub_u32 s92, s88, 512
    s_lshl_b32 s92, s92, 6
    s_add_u32 s92, s92, 196608
    ds_read_b64 v[80:81], v4 offset:864
    ds_read_b64 v[88:89], v13 offset:15840
    ds_read_b64 v[82:83], v4 offset:864
    ds_read_b64 v[90:91], v13 offset:16352
W_51:
    ds_read_b32 v40, v4 offset:168
    s_sub_u32 s39, s39, 1
    s_cbranch_scc1 KS_ABORT
    s_waitcnt lgkmcnt(0)
    v_cmp_ne_u32 vcc, s84, v40
    s_cbranch_vccnz W_51
    ds_read_b128 v[40:43], v9 offset:16896
    ds_read_b128 v[44:47], v9 offset:17920
    v_cvt_f32_f16 v60, v88
    v_cvt_f32_f16_sdwa v61, v88 dst_sel:DWORD dst_unused:UNUSED_PAD src0_sel:WORD_1
    v_mul_f32 v60, v81, v60
    v_mul_f32 v61, v81, v61
    v_cvt_pk_bf16_f32 v88, v60, v61
    v_lshlrev_b32 v60, 16, v88
    v_and_b32 v61, 0xffff0000, v88
    v_cvt_f32_f16 v62, v89
    v_cvt_f32_f16_sdwa v63, v89 dst_sel:DWORD dst_unused:UNUSED_PAD src0_sel:WORD_1
    v_mul_f32 v62, v81, v62
    v_mul_f32 v63, v81, v63
    v_cvt_pk_bf16_f32 v89, v62, v63
    v_lshlrev_b32 v62, 16, v89
    v_and_b32 v63, 0xffff0000, v89
    v_cvt_f32_f16 v64, v90
    v_cvt_f32_f16_sdwa v65, v90 dst_sel:DWORD dst_unused:UNUSED_PAD src0_sel:WORD_1
    v_mul_f32 v64, v83, v64
    v_mul_f32 v65, v83, v65
    v_cvt_pk_bf16_f32 v90, v64, v65
    v_lshlrev_b32 v64, 16, v90
    v_and_b32 v65, 0xffff0000, v90
    v_cvt_f32_f16 v66, v91
    v_cvt_f32_f16_sdwa v67, v91 dst_sel:DWORD dst_unused:UNUSED_PAD src0_sel:WORD_1
    v_mul_f32 v66, v83, v66
    v_mul_f32 v67, v83, v67
    v_cvt_pk_bf16_f32 v91, v66, v67
    v_lshlrev_b32 v66, 16, v91
    v_and_b32 v67, 0xffff0000, v91
    s_waitcnt lgkmcnt(1)
    v_pk_add_f32 v[40:41], v[40:41], v[20:21]
    v_pk_add_f32 v[42:43], v[42:43], v[22:23]
    v_pk_mul_f32 v[40:41], v[40:41], v[80:81] op_sel_hi:[1,0]
    v_pk_mul_f32 v[42:43], v[42:43], v[80:81] op_sel_hi:[1,0]
    v_cvt_pk_bf16_f32 v72, v40, v41
    v_cvt_pk_bf16_f32 v73, v42, v43
    v_lshlrev_b32 v40, 16, v72
    v_and_b32 v41, 0xffff0000, v72
    v_lshlrev_b32 v42, 16, v73
    v_and_b32 v43, 0xffff0000, v73
    v_pk_add_f32 v[40:41], v[40:41], v[60:61]
    v_pk_add_f32 v[42:43], v[42:43], v[62:63]
    v_cvt_pk_bf16_f32 v72, v40, v41
    v_cvt_pk_bf16_f32 v73, v42, v43
    s_waitcnt lgkmcnt(0)
    v_pk_add_f32 v[44:45], v[44:45], v[24:25]
    v_pk_add_f32 v[46:47], v[46:47], v[26:27]
    v_pk_mul_f32 v[44:45], v[44:45], v[82:83] op_sel_hi:[1,0]
    v_pk_mul_f32 v[46:47], v[46:47], v[82:83] op_sel_hi:[1,0]
    v_cvt_pk_bf16_f32 v74, v44, v45
    v_cvt_pk_bf16_f32 v75, v46, v47
    v_lshlrev_b32 v44, 16, v74
    v_and_b32 v45, 0xffff0000, v74
    v_lshlrev_b32 v46, 16, v75
    v_and_b32 v47, 0xffff0000, v75
    v_pk_add_f32 v[44:45], v[44:45], v[64:65]
    v_pk_add_f32 v[46:47], v[46:47], v[66:67]
    v_cvt_pk_bf16_f32 v74, v44, v45
    v_cvt_pk_bf16_f32 v75, v46, v47
    s_branch CVE_19
CVE_19:
    v_min_u32 v72, -2, v72
    v_min_u32 v73, -2, v73
    v_min_u32 v74, -2, v74
    v_min_u32 v75, -2, v75
    v_cndmask_b32 v60, v74, v72, s[98:99]
    v_cndmask_b32 v61, v75, v73, s[98:99]
    s_nop 0
    v_mov_b32_dpp v62, v60 quad_perm:[1,0,3,2] row_mask:0xf bank_mask:0xf
    v_mov_b32_dpp v63, v61 quad_perm:[1,0,3,2] row_mask:0xf bank_mask:0xf
    v_cndmask_b32 v72, v72, v62, s[98:99]
    v_cndmask_b32 v73, v73, v63, s[98:99]
    v_cndmask_b32 v74, v62, v74, s[98:99]
    v_cndmask_b32 v75, v63, v75, s[98:99]
W_52:
    ds_read_b32 v60, v4 offset:188
    s_sub_u32 s39, s39, 1
    s_cbranch_scc1 KS_ABORT
    s_waitcnt lgkmcnt(0)
    v_cmp_ne_u32 vcc, s84, v60
    s_cbranch_vccnz W_52
    buffer_store_dwordx4 v[72:75], v10, s[64:67], s92 offen sc1
    s_waitcnt vmcnt(0)
    ds_write_b8 v8, v5 offset:48
    s_cmp_lt_u32 s41, 18
    s_cbranch_scc1 KS_T
    s_waitcnt lgkmcnt(0)
    s_endpgm
KS_X:
    s_cmp_lt_u32 s41, 24
    s_cbranch_scc1 KS_X2
    s_setprio 1
    s_mov_b32 s87, 2
    s_add_u32 s86, s38, 1
    s_and_b32 s86, s86, 3
    s_lshl_b32 s88, s40, 3
    s_add_u32 s88, s88, s41
    s_add_u32 s88, s88, 488
    s_branch KS_GRP
KS_X2:
    s_cmp_lt_u32 s41, 8
    s_cbranch_scc1 KS_X3
    s_sub_u32 s97, s38, 8
    s_branch KS_LN1
KS_X3:
    s_waitcnt lgkmcnt(0)
    s_barrier
    s_branch KS_G
KS_X4:
    s_cmp_lt_u32 s41, 18
    s_cbranch_scc1 KS_G
    s_waitcnt vmcnt(0) lgkmcnt(0)
    s_endpgm
KS_L:
    v_lshlrev_b32 v6, 2, v0
    ds_write_b32 v6, v4
    v_mov_b32 v8, 0
    v_mov_b32 v9, 0
    s_min_u32 s92, s38, 2
    s_mul_i32 s92, s92, 4608
    v_min_u32 v6, 59, v1
    v_lshl_add_u32 v6, v6, 3, s92
    ds_write_b64 v6, v[8:9] offset:3072
    s_mov_b32 s97, s38
    s_sub_u32 s92, s41, 8
    s_cmp_lt_u32 s92, 16
    s_cbranch_scc0 KS_L0
KS_LN1:
    s_setprio 3
    s_sub_u32 s92, s41, 8
    s_and_b32 s88, s92, 7
    s_lshr_b32 s92, s92, 3
    s_lshl_b32 s92, s92, 4
    s_add_u32 s88, s88, s92
    s_and_b32 s92, s40, 1
    s_lshl_b32 s92, s92, 3
    s_add_u32 s88, s88, s92
    s_lshr_b32 s92, s40, 1
    s_lshl_b32 s92, s92, 5
    s_add_u32 s88, s88, s92
    v_lshrrev_b32 v36, 5, v1
    v_and_b32 v37, 31, v1
    v_mul_u32_u24 v38, 1152, v36
    v_lshl_add_u32 v39, v37, 2, v38
    v_lshl_add_u32 v38, v37, 4, v38
    s_mul_i32 s93, s88, 18432
    s_mul_i32 s94, s97, 2304
    s_add_u32 s93, s93, s94
    s_waitcnt lgkmcnt(0)
    s_mov_b32 s64, s4
    s_mov_b32 s65, s5
    s_mov_b32 s66, 0x240000
    s_mov_b32 s67, 0x20000
    buffer_load_dwordx4 v[26:29], v38, s[64:67], s93 offen
    buffer_load_dwordx4 v[30:33], v38, s[64:67], s93 offen offset:512
    buffer_load_dword v34, v39, s[64:67], s93 offen offset:1024
    s_barrier
    s_lshr_b32 s93, s97, 2
    s_lshl_b32 s93, s93, 6
    s_add_u32 s94, s94, s93
    s_add_u32 s94, s94, 16896
    v_lshl_add_u32 v35, v37, 1, v36
    s_mov_b32 s98, 0x05040100
    s_mov_b32 s99, 0x07060302
    s_waitcnt vmcnt(2)
    v_lshlrev_b32 v8, 16, v26
    v_and_b32 v9, 0xffff0000, v26
    v_lshlrev_b32 v10, 16, v27
    v_and_b32 v11, 0xffff0000, v27
    v_lshlrev_b32 v12, 16, v28
    v_and_b32 v13, 0xffff0000, v28
    v_lshlrev_b32 v14, 16, v29
    v_and_b32 v15, 0xffff0000, v29
    s_waitcnt vmcnt(1)
    v_lshlrev_b32 v16, 16, v30
    v_and_b32 v17, 0xffff0000, v30
    v_lshlrev_b32 v18, 16, v31
    v_and_b32 v19, 0xffff0000, v31
    v_lshlrev_b32 v20, 16, v32
    v_and_b32 v21, 0xffff0000, v32
    v_lshlrev_b32 v22, 16, v33
    v_and_b32 v23, 0xffff0000, v33
    s_waitcnt vmcnt(0)
    v_lshlrev_b32 v24, 16, v34
    v_and_b32 v25, 0xffff0000, v34
    v_lshl_add_u32 v6, v35, 4, s94
    v_lshl_add_u32 v7, v35, 2, s94
    v_mul_u32_u24 v35, 0x20202, v36
    v_lshl_add_u32 v35, v36, 25, v35
    v_add_u32 v35, 0x05040100, v35
    v_pk_add_f32 v[40:41], v[8:9], v[10:11]
    v_pk_add_f32 v[42:43], v[12:13], v[14:15]
    v_pk_add_f32 v[40:41], v[40:41], v[16:17]
    v_pk_add_f32 v[42:43], v[42:43], v[18:19]
    v_pk_add_f32 v[40:41], v[40:41], v[20:21]
    v_pk_add_f32 v[42:43], v[42:43], v[22:23]
    v_pk_add_f32 v[40:41], v[40:41], v[24:25]
    v_pk_add_f32 v[40:41], v[40:41], v[42:43]
    v_add_f32 v40, v40, v41
    s_nop 1
    v_add_f32_dpp v40, v40, v40 row_ror:8 row_mask:0xf bank_mask:0xf
    s_nop 1
    v_add_f32_dpp v40, v40, v40 row_ror:4 row_mask:0xf bank_mask:0xf
    s_nop 1
    v_add_f32_dpp v40, v40, v40 row_ror:2 row_mask:0xf bank_mask:0xf
    s_nop 1
    v_add_f32_dpp v40, v40, v40 row_ror:1 row_mask:0xf bank_mask:0xf
    v_mov_b32 v42, v40
    s_nop 1
    v_permlane16_swap_b32 v40, v42
    v_add_f32 v40, v40, v42
    v_mul_f32 v44, 0x3ae38e39, v40
    v_mov_b32 v45, v44
    v_cvt_pk_bf16_f32 v36, v44, v44
    v_and_b32 v36, 0xffff0000, v36
    v_mov_b32 v37, v36
    v_pk_add_f32 v[38:39], v[8:9], v[44:45] neg_lo:[0,1] neg_hi:[0,1]
    v_pk_mul_f32 v[40:41], v[38:39], v[38:39]
    v_pk_add_f32 v[38:39], v[10:11], v[44:45] neg_lo:[0,1] neg_hi:[0,1]
    v_pk_mul_f32 v[42:43], v[38:39], v[38:39]
    v_pk_add_f32 v[38:39], v[12:13], v[44:45] neg_lo:[0,1] neg_hi:[0,1]
    v_pk_fma_f32 v[40:41], v[38:39], v[38:39], v[40:41]
    v_pk_add_f32 v[38:39], v[14:15], v[44:45] neg_lo:[0,1] neg_hi:[0,1]
    v_pk_fma_f32 v[42:43], v[38:39], v[38:39], v[42:43]
    v_pk_add_f32 v[38:39], v[16:17], v[44:45] neg_lo:[0,1] neg_hi:[0,1]
    v_pk_fma_f32 v[40:41], v[38:39], v[38:39], v[40:41]
    v_pk_add_f32 v[38:39], v[18:19], v[44:45] neg_lo:[0,1] neg_hi:[0,1]
    v_pk_fma_f32 v[42:43], v[38:39], v[38:39], v[42:43]
    v_pk_add_f32 v[38:39], v[20:21], v[44:45] neg_lo:[0,1] neg_hi:[0,1]
    v_pk_fma_f32 v[40:41], v[38:39], v[38:39], v[40:41]
    v_pk_add_f32 v[38:39], v[22:23], v[44:45] neg_lo:[0,1] neg_hi:[0,1]
    v_pk_fma_f32 v[42:43], v[38:39], v[38:39], v[42:43]
    v_pk_add_f32 v[38:39], v[24:25], v[44:45] neg_lo:[0,1] neg_hi:[0,1]
    v_pk_fma_f32 v[40:41], v[38:39], v[38:39], v[40:41]
    v_pk_add_f32 v[40:41], v[40:41], v[42:43]
    v_add_f32 v40, v40, v41
    s_nop 1
    v_add_f32_dpp v40, v40, v40 row_ror:8 row_mask:0xf bank_mask:0xf
    s_nop 1
    v_add_f32_dpp v40, v40, v40 row_ror:4 row_mask:0xf bank_mask:0xf
    s_nop 1
    v_add_f32_dpp v40, v40, v40 row_ror:2 row_mask:0xf bank_mask:0xf
    s_nop 1
    v_add_f32_dpp v40, v40, v40 row_ror:1 row_mask:0xf bank_mask:0xf
    v_mov_b32 v42, v40
    s_nop 1
    v_permlane16_swap_b32 v40, v42
    v_add_f32 v40, v40, v42
    v_mul_f32 v40, 0x3ae38e39, v40
    v_cvt_pk_bf16_f32 v40, v40, v40
    v_and_b32 v40, 0xffff0000, v40
    v_add_f32 v40, 0x3727c5ac, v40
    v_cvt_pk_bf16_f32 v40, v40, v40
    v_and_b32 v40, 0xffff0000, v40
    v_sqrt_f32 v40, v40
    s_nop 0
    v_cvt_pk_bf16_f32 v40, v40, v40
    v_and_b32 v40, 0xffff0000, v40
    v_rcp_f32 v38, v40
    s_nop 0
    v_mov_b32 v39, v38
    v_pk_add_f32 v[40:41], v[8:9], v[36:37] neg_lo:[0,1] neg_hi:[0,1]
    v_cvt_pk_bf16_f32 v42, v40, v41
    v_lshlrev_b32 v40, 16, v42
    v_and_b32 v41, 0xffff0000, v42
    v_pk_mul_f32 v[40:41], v[40:41], v[38:39]
    v_cvt_pk_bf16_f32 v42, v40, v41
    v_lshlrev_b32 v40, 16, v42
    v_and_b32 v41, 0xffff0000, v42
    v_cvt_pk_f16_f32 v26, v40, v41
    v_pk_add_f32 v[40:41], v[10:11], v[36:37] neg_lo:[0,1] neg_hi:[0,1]
    v_cvt_pk_bf16_f32 v42, v40, v41
    v_lshlrev_b32 v40, 16, v42
    v_and_b32 v41, 0xffff0000, v42
    v_pk_mul_f32 v[40:41], v[40:41], v[38:39]
    v_cvt_pk_bf16_f32 v42, v40, v41
    v_lshlrev_b32 v40, 16, v42
    v_and_b32 v41, 0xffff0000, v42
    v_cvt_pk_f16_f32 v27, v40, v41
    v_pk_add_f32 v[40:41], v[12:13], v[36:37] neg_lo:[0,1] neg_hi:[0,1]
    v_cvt_pk_bf16_f32 v42, v40, v41
    v_lshlrev_b32 v40, 16, v42
    v_and_b32 v41, 0xffff0000, v42
    v_pk_mul_f32 v[40:41], v[40:41], v[38:39]
    v_cvt_pk_bf16_f32 v42, v40, v41
    v_lshlrev_b32 v40, 16, v42
    v_and_b32 v41, 0xffff0000, v42
    v_cvt_pk_f16_f32 v28, v40, v41
    v_pk_add_f32 v[40:41], v[14:15], v[36:37] neg_lo:[0,1] neg_hi:[0,1]
    v_cvt_pk_bf16_f32 v42, v40, v41
    v_lshlrev_b32 v40, 16, v42
    v_and_b32 v41, 0xffff0000, v42
    v_pk_mul_f32 v[40:41], v[40:41], v[38:39]
    v_cvt_pk_bf16_f32 v42, v40, v41
    v_lshlrev_b32 v40, 16, v42
    v_and_b32 v41, 0xffff0000, v42
    v_cvt_pk_f16_f32 v29, v40, v41
    v_permlane32_swap_b32 v26, v28
    s_nop 0
    v_permlane32_swap_b32 v27, v29
    v_perm_b32 v8, v28, v26, s98
    v_perm_b32 v9, v28, v26, s99
    v_perm_b32 v10, v29, v27, s98
    v_perm_b32 v11, v29, v27, s99
    ds_write_b128 v6, v[8:11] offset:0
    v_pk_add_f32 v[40:41], v[16:17], v[36:37] neg_lo:[0,1] neg_hi:[0,1]
    v_cvt_pk_bf16_f32 v42, v40, v41
    v_lshlrev_b32 v40, 16, v42
    v_and_b32 v41, 0xffff0000, v42
    v_pk_mul_f32 v[40:41], v[40:41], v[38:39]
    v_cvt_pk_bf16_f32 v42, v40, v41
    v_lshlrev_b32 v40, 16, v42
    v_and_b32 v41, 0xffff0000, v42
    v_cvt_pk_f16_f32 v30, v40, v41
    v_pk_add_f32 v[40:41], v[18:19], v[36:37] neg_lo:[0,1] neg_hi:[0,1]
    v_cvt_pk_bf16_f32 v42, v40, v41
    v_lshlrev_b32 v40, 16, v42
    v_and_b32 v41, 0xffff0000, v42
    v_pk_mul_f32 v[40:41], v[40:41], v[38:39]
    v_cvt_pk_bf16_f32 v42, v40, v41
    v_lshlrev_b32 v40, 16, v42
    v_and_b32 v41, 0xffff0000, v42
    v_cvt_pk_f16_f32 v31, v40, v41
    v_pk_add_f32 v[40:41], v[20:21], v[36:37] neg_lo:[0,1] neg_hi:[0,1]
    v_cvt_pk_bf16_f32 v42, v40, v41
    v_lshlrev_b32 v40, 16, v42
    v_and_b32 v41, 0xffff0000, v42
    v_pk_mul_f32 v[40:41], v[40:41], v[38:39]
    v_cvt_pk_bf16_f32 v42, v40, v41
    v_lshlrev_b32 v40, 16, v42
    v_and_b32 v41, 0xffff0000, v42
    v_cvt_pk_f16_f32 v32, v40, v41
    v_pk_add_f32 v[40:41], v[22:23], v[36:37] neg_lo:[0,1] neg_hi:[0,1]
    v_cvt_pk_bf16_f32 v42, v40, v41
    v_lshlrev_b32 v40, 16, v42
    v_and_b32 v41, 0xffff0000, v42
    v_pk_mul_f32 v[40:41], v[40:41], v[38:39]
    v_cvt_pk_bf16_f32 v42, v40, v41
    v_lshlrev_b32 v40, 16, v42
    v_and_b32 v41, 0xffff0000, v42
    v_cvt_pk_f16_f32 v33, v40, v41
    v_permlane32_swap_b32 v30, v32
    s_nop 0
    v_permlane32_swap_b32 v31, v33
    v_perm_b32 v16, v32, v30, s98
    v_perm_b32 v17, v32, v30, s99
    v_perm_b32 v18, v33, v31, s98
    v_perm_b32 v19, v33, v31, s99
    ds_write_b128 v6, v[16:19] offset:1024
    v_pk_add_f32 v[40:41], v[24:25], v[36:37] neg_lo:[0,1] neg_hi:[0,1]
    v_cvt_pk_bf16_f32 v42, v40, v41
    v_lshlrev_b32 v40, 16, v42
    v_and_b32 v41, 0xffff0000, v42
    v_pk_mul_f32 v[40:41], v[40:41], v[38:39]
    v_cvt_pk_bf16_f32 v42, v40, v41
    v_lshlrev_b32 v40, 16, v42
    v_and_b32 v41, 0xffff0000, v42
    v_cvt_pk_f16_f32 v34, v40, v41
    v_mov_b32 v40, v34
    s_nop 1
    v_permlane32_swap_b32 v34, v40
    v_perm_b32 v40, v40, v34, v35
    ds_write_b32 v7, v40 offset:2048
    v_mov_b32 v6, s97
    ds_write_b8 v6, v5 offset:0
    s_setprio 0
    s_cmp_ge_u32 s97, 4
    s_cbranch_scc1 KS_X4
    s_setprio 3
    s_mov_b32 s72, s36
    s_mov_b32 s73, s37
    s_mov_b32 s74, 0x240000
    s_mov_b32 s75, 0x20000
    v_and_b32 v6, 1, v0
    v_mul_u32_u24 v6, 9280, v6
    v_lshrrev_b32 v7, 1, v0
    v_lshl_add_u32 v6, v7, 2, v6
    v_add_u32 v6, 16896, v6
    v_lshrrev_b32 v7, 2, v0
    v_lshlrev_b32 v7, 13, v7
    v_and_b32 v8, 3, v0
    v_lshl_add_u32 v7, v8, 4, v7
    s_lshl_b32 s92, s88, 6
    s_add_u32 s93, s92, 524288
    s_add_u32 s94, s92, 1048576
    s_add_u32 s95, s92, 1572864
    s_add_u32 s96, s92, 2097152
W_55:
    ds_read_b64 v[20:21], v4 offset:0
    s_sub_u32 s39, s39, 1
    s_cbranch_scc1 KS_ABORT
    s_waitcnt lgkmcnt(0)
    v_and_b32 v20, v20, v21
    v_cmp_ne_u32 vcc, s84, v20
    s_cbranch_vccnz W_55
    ds_read2st64_b32 v[20:21], v6 offset0:0 offset1:9
    ds_read2st64_b32 v[22:23], v6 offset0:18 offset1:27
    ds_read2st64_b32 v[24:25], v6 offset0:2 offset1:11
    ds_read2st64_b32 v[26:27], v6 offset0:20 offset1:29
    ds_read2st64_b32 v[28:29], v6 offset0:4 offset1:13
    ds_read2st64_b32 v[30:31], v6 offset0:22 offset1:31
    ds_read2st64_b32 v[32:33], v6 offset0:6 offset1:15
    ds_read2st64_b32 v[34:35], v6 offset0:24 offset1:33
    ds_read2st64_b32 v[36:37], v6 offset0:8 offset1:17
    ds_read2st64_b32 v[38:39], v6 offset0:26 offset1:35
    s_waitcnt lgkmcnt(8)
    buffer_store_dwordx4 v[20:23], v7, s[72:75], s92 offen sc1
    s_waitcnt lgkmcnt(6)
    buffer_store_dwordx4 v[24:27], v7, s[72:75], s93 offen sc1
    s_waitcnt lgkmcnt(4)
    buffer_store_dwordx4 v[28:31], v7, s[72:75], s94 offen sc1
    s_waitcnt lgkmcnt(2)
    buffer_store_dwordx4 v[32:35], v7, s[72:75], s95 offen sc1
    s_waitcnt lgkmcnt(0)
    buffer_store_dwordx4 v[36:39], v7, s[72:75], s96 offen sc1
    global_load_dword v58, v4, s[34:35] sc1
    s_lshl_b32 s93, s88, 6
    s_add_u32 s93, s93, 0xb00000
    v_mov_b32 v7, s93
    s_branch KS_L1
KS_L0:
    s_and_b32 s92, s41, 15
    s_lshl_b32 s93, s40, 4
    s_add_u32 s92, s92, s93
    s_lshl_b32 s93, s92, 6
    s_add_u32 s93, s93, 0xb02000
    v_mov_b32 v7, s93
    s_mul_i32 s93, s92, 18560
    s_add_u32 s93, s93, 0x600000
    v_lshlrev_b32 v6, 4, v0
    v_mov_b32 v10, 0
    v_mov_b32 v11, 0
    v_mov_b32 v12, -1
    v_mov_b32 v13, -1
    v_mov_b32 v14, -1
    v_mov_b32 v15, -1
    v_mov_b32 v58, 0
    s_setprio 3
    v_mul_u32_u24 v16, 57, v1
    v_lshrrev_b32 v16, 9, v16
    v_mul_u32_u24 v17, 9, v16
    v_sub_u32 v17, v1, v17
    v_mul_u32_u24 v16, 9216, v16
    v_lshl_add_u32 v16, v17, 7, v16
    s_and_b32 s94, s41, 15
    s_lshl_b32 s94, s94, 2
    s_add_u32 s94, s94, s38
    s_mul_i32 s94, s94, 82944
    s_mul_i32 s95, s40, 1152
    s_add_u32 s94, s94, s95
    s_add_u32 s95, s94, 64512
    s_waitcnt lgkmcnt(0)
    s_add_u32 s68, s36, s93
    s_addc_u32 s69, s37, 0
    s_mov_b32 s70, 18560
    s_mov_b32 s71, 0x20000
    s_mov_b32 s72, s26
    s_mov_b32 s73, s27
    s_mov_b32 s74, 0x510000
    s_mov_b32 s75, 0x20000
    s_mov_b32 s76, s28
    s_mov_b32 s77, s29
    s_mov_b32 s78, 0x510000
    s_mov_b32 s79, 0x20000
    s_cmp_lg_u32 s2, 0
    s_cbranch_scc1 KS_L0B
    s_add_u32 s64, s36, 0xb00000
    s_addc_u32 s65, s37, 0
    s_mov_b32 s66, 0x4000
    s_mov_b32 s67, 0x20000
    s_movk_i32 s92, 0
    buffer_store_dwordx4 v[8:11], v6, s[64:67], s92 offen sc1
    s_movk_i32 s92, 4096
    buffer_store_dwordx4 v[8:11], v6, s[64:67], s92 offen sc1
    s_movk_i32 s92, 8192
    buffer_store_dwordx4 v[8:11], v6, s[64:67], s92 offen sc1
    s_movk_i32 s92, 12288
    buffer_store_dwordx4 v[8:11], v6, s[64:67], s92 offen sc1
    s_barrier
    s_waitcnt vmcnt(0)
    s_mov_b64 exec, 1
    ds_add_rtn_u32 v8, v4, v5 offset:180
    s_waitcnt lgkmcnt(0)
    v_cmp_eq_u32 vcc, 3, v8
    s_and_b64 exec, exec, vcc
    s_cbranch_execz KS_L0A
    global_store_dword v4, v5, s[34:35] sc1
    ds_write_b32 v4, v5 offset:184
KS_L0A:
    s_mov_b64 exec, -1
W_56:
    s_sleep 1
    ds_read_b32 v8, v4 offset:184
    s_sub_u32 s39, s39, 1
    s_cbranch_scc1 KS_ABORT
    s_waitcnt lgkmcnt(0)
    v_cmp_eq_u32 vcc, 0, v8
    s_cbranch_vccnz W_56
    s_branch KS_L0C
KS_L0B:
    s_barrier
KS_L0C:
    s_movk_i32 s92, 0
    buffer_store_dwordx4 v[12:15], v6, s[68:71], s92 offen sc1
    s_movk_i32 s92, 4096
    buffer_store_dwordx4 v[12:15], v6, s[68:71], s92 offen sc1
    s_movk_i32 s92, 8192
    buffer_store_dwordx4 v[12:15], v6, s[68:71], s92 offen sc1
    s_movk_i32 s92, 12288
    buffer_store_dwordx4 v[12:15], v6, s[68:71], s92 offen sc1
    s_movk_i32 s92, 16384
    buffer_store_dwordx4 v[12:15], v6, s[68:71], s92 offen sc1
    s_mov_b32 exec_hi, 0x7fffffff
    buffer_load_dword v18, v16, s[72:75], s94 offen
    buffer_load_dword v19, v16, s[76:79], s94 offen
    s_mov_b64 exec, 0x3ffff
    buffer_load_dword v20, v16, s[72:75], s95 offen
    buffer_load_dword v21, v16, s[76:79], s95 offen
    s_mov_b64 exec, -1
    s_setprio 0
W_57:
    s_sleep 2
    ds_read_b32 v6, v4 offset:68
    s_sub_u32 s39, s39, 1
    s_cbranch_scc1 KS_ABORT
    s_waitcnt lgkmcnt(0)
    v_cmp_ne_u32 vcc, s84, v6
    s_cbranch_vccnz W_57
KS_L1:
    s_waitcnt vmcnt(0)
    s_mov_b64 exec, 1
    ds_add_rtn_u32 v6, v4, v5 offset:8
    s_mov_b64 exec, -1
LN1P_58:
    v_readfirstlane_b32 s94, v58
    s_cmp_lg_u32 s94, 0
    s_cbranch_scc1 LN1G_59
    s_sleep 1
    global_load_dword v58, v4, s[34:35] sc1
    s_sub_u32 s39, s39, 1
    s_cbranch_scc1 KS_ABORT
    s_waitcnt vmcnt(0)
    s_branch LN1P_58
LN1G_59:
    s_waitcnt lgkmcnt(0)
    v_readfirstlane_b32 s94, v6
    s_cmp_lg_u32 s94, 3
    s_cbranch_scc1 LN1E_60
    s_mov_b64 exec, 1
    global_store_dword v7, v5, s[36:37] sc1
    s_mov_b64 exec, -1
LN1E_60:
KS_L2:
    s_setprio 3
    v_and_b32 v6, 31, v1
    s_lshl_b32 s92, s38, 11
    s_add_u32 s92, s92, 0xb00000
    v_lshl_add_u32 v6, v6, 6, s92
    s_lshl_b32 s93, s40, 8
    s_add_u32 s92, s92, s93
    v_mov_b32 v9, s92
    s_mov_b32 s64, s36
    s_mov_b32 s65, s37
    s_mov_b32 s66, 0x240000
    s_mov_b32 s67, 0x20000
    v_lshrrev_b32 v7, 1, v1
    v_lshlrev_b32 v7, 6, v7
    v_and_b32 v8, 1, v1
    v_lshl_add_u32 v7, v8, 4, v7
    s_lshl_b32 s92, s38, 11
    s_lshl_b32 s93, s90, 13
    s_add_u32 s93, s93, s92
    s_add_u32 s94, s93, 32
    s_lshl_b32 s95, s40, 3
    s_add_u32 s95, s95, s41
    s_add_u32 s95, s95, 488
    s_lshr_b32 s96, s95, 1
    s_lshl_b32 s96, s96, 13
    s_and_b32 s95, s95, 1
    s_lshl_b32 s95, s95, 5
    s_add_u32 s95, s95, s96
    s_add_u32 s95, s95, s92
    s_lshl_b32 s96, s38, 10
    s_add_u32 s96, s96, 3552
F1S_61:
    s_sleep 2
    global_load_dword v8, v9, s[36:37] sc1
    s_sub_u32 s39, s39, 1
    s_cbranch_scc1 KS_ABORT
    s_waitcnt vmcnt(0)
    v_cmp_ne_u32 vcc, 1, v8
    s_cbranch_vccnz F1S_61
    s_branch F1E_63
F1_62:
    s_sleep 2
F1E_63:
    global_load_dword v8, v6, s[36:37] sc1
    s_sub_u32 s39, s39, 1
    s_cbranch_scc1 KS_ABORT
    s_waitcnt vmcnt(0)
    v_cmp_ne_u32 vcc, 1, v8
    s_cbranch_vccnz F1_62
    s_mov_b32 m0, s96
    s_nop 0
    buffer_load_dwordx4 v7, s[64:67], s93 offen sc1 lds
    s_add_u32 m0, s96, 4608
    s_nop 0
    buffer_load_dwordx4 v7, s[64:67], s94 offen sc1 lds
    s_cmp_lt_u32 s41, 24
    s_cbranch_scc1 KS_L3
    s_add_u32 m0, s96, 9216
    s_nop 0
    buffer_load_dwordx4 v7, s[64:67], s95 offen sc1 lds
KS_L3:
    v_mov_b32 v116, s38
    s_waitcnt vmcnt(0)
    ds_write_b8 v116, v5 offset:16
    s_setprio 0
F1C_64:
    v_add_u32 v9, 8192, v6
    global_load_dword v8, v9, s[36:37] sc1
    s_sub_u32 s39, s39, 1
    s_cbranch_scc1 KS_ABORT
    s_waitcnt vmcnt(0)
    v_cmp_ne_u32 vcc, 1, v8
    s_cbranch_vccnz F1C_64
    ds_write_b8 v116, v5 offset:188
W_65:
    s_sleep 1
    ds_read_b32 v8, v4 offset:16
    s_sub_u32 s39, s39, 1
    s_cbranch_scc1 KS_ABORT
    s_waitcnt lgkmcnt(0)
    v_cmp_ne_u32 vcc, s84, v8
    s_cbranch_vccnz W_65
    s_lshr_b32 s92, s90, 6
    s_lshl_b32 s92, s92, 9
    s_bfe_u32 s93, s90, 0x10001
    s_lshl_b32 s93, s93, 8
    s_add_u32 s92, s92, s93
    s_bfe_u32 s93, s90, 0x20004
    s_lshl_b32 s93, s93, 6
    s_add_u32 s92, s92, s93
    s_and_b32 s93, s90, 1
    s_lshl_b32 s93, s93, 5
    s_add_u32 s92, s92, s93
    s_bfe_u32 s93, s90, 0x20002
    s_lshl_b32 s93, s93, 2
    s_add_u32 s92, s92, s93
    s_lshr_b32 s93, s38, 1
    s_lshl_b32 s93, s93, 4
    s_add_u32 s92, s92, s93
    s_and_b32 s93, s38, 1
    s_lshl_b32 s93, s93, 1
    s_add_u32 s92, s92, s93
    v_lshrrev_b32 v113, 5, v1
    v_and_b32 v114, 31, v1
    v_add_u32 v112, s92, v113
    v_mul_u32_u24 v115, 1152, v112
    v_lshl_add_u32 v8, v114, 2, v115
    v_lshl_add_u32 v115, v114, 4, v115
    v_lshlrev_b32 v7, 2, v114
    v_lshlrev_b32 v6, 4, v114
    v_bfe_u32 v111, v1, 3, 1
    v_add_u32 v111, s92, v111
    v_mul_u32_u24 v111, 1152, v111
    v_and_b32 v9, 7, v1
    v_lshl_add_u32 v111, v9, 4, v111
    s_mov_b32 s64, s4
    s_mov_b32 s65, s5
    s_mov_b32 s66, 0x240000
    s_mov_b32 s67, 0x20000
    s_mov_b32 s68, s24
    s_mov_b32 s69, s25
    s_mov_b32 s70, 0x480
    s_mov_b32 s71, 0x20000
    buffer_load_dwordx4 v[10:13], v115, s[64:67], 0 offen
    buffer_load_dwordx4 v[14:17], v115, s[64:67], 0 offen offset:512
    buffer_load_dword v18, v8, s[64:67], 0 offen offset:1024
    buffer_load_dwordx4 v[50:53], v6, s[68:71], 0 offen
    buffer_load_dwordx4 v[54:57], v6, s[68:71], 0 offen offset:512
    buffer_load_dword v58, v7, s[68:71], 0 offen offset:1024
    s_cmp_lt_u32 s41, 18
    s_cbranch_scc1 KS_L3B
    s_mul_i32 s92, s40, 14
    s_add_u32 s92, s92, s41
    s_mul_i32 s92, s92, 23744
    s_add_u32 s92, s92, 0x7e7a80
    s_add_u32 s68, s36, s92
    s_addc_u32 s69, s37, 0
    s_mov_b32 s70, 23744
    s_mov_b32 s71, 0x20000
    s_mov_b32 s72, s30
    s_mov_b32 s73, s31
    s_mov_b32 s74, 0x510000
    s_mov_b32 s75, 0x20000
    s_sub_u32 s92, s41, 18
    s_lshl_b32 s92, s92, 2
    s_add_u32 s92, s92, s38
    s_mul_i32 s92, s92, 11904
    s_mul_i32 s93, s40, 663552
    s_add_u32 s92, s92, s93
    v_lshlrev_b32 v6, 7, v1
    buffer_load_dword v64, v6, s[72:75], s92 offen
    buffer_load_dword v65, v6, s[72:75], s92 offen offset:3712
    v_lshlrev_b32 v6, 4, v0
    v_mov_b32 v60, -1
    v_mov_b32 v61, -1
    v_mov_b32 v62, -1
    v_mov_b32 v63, -1
    s_movk_i32 s92, 0
    buffer_store_dwordx4 v[60:63], v6, s[68:71], s92 offen sc1
    s_movk_i32 s92, 4096
    buffer_store_dwordx4 v[60:63], v6, s[68:71], s92 offen sc1
    s_movk_i32 s92, 8192
    buffer_store_dwordx4 v[60:63], v6, s[68:71], s92 offen sc1
    s_movk_i32 s92, 12288
    buffer_store_dwordx4 v[60:63], v6, s[68:71], s92 offen sc1
    s_movk_i32 s92, 16384
    buffer_store_dwordx4 v[60:63], v6, s[68:71], s92 offen sc1
    s_movk_i32 s92, 20480
    buffer_store_dwordx4 v[60:63], v6, s[68:71], s92 offen sc1
    s_branch KS_L4
KS_L3B:
W_66:
    s_sleep 2
    ds_read_b32 v6, v4 offset:192
    s_sub_u32 s39, s39, 1
    s_cbranch_scc1 KS_ABORT
    s_waitcnt lgkmcnt(0)
    v_cmp_ne_u32 vcc, s84, v6
    s_cbranch_vccnz W_66
    s_mov_b32 s68, s30
    s_mov_b32 s69, s31
    s_mov_b32 s70, 0x510000
    s_mov_b32 s71, 0x20000
    v_lshlrev_b32 v6, 4, v1
    s_mul_i32 s92, s89, 36864
    s_mul_i32 s93, s38, 9216
    s_add_u32 s92, s92, s93
    s_add_u32 s93, s93, 108800
    s_add_u32 m0, s93, 0
    s_nop 0
    buffer_load_dwordx4 v6, s[68:71], s92 offen offset:0 lds
    buffer_load_dwordx4 v6, s[68:71], s92 offen offset:1024 lds
    buffer_load_dwordx4 v6, s[68:71], s92 offen offset:2048 lds
    buffer_load_dwordx4 v6, s[68:71], s92 offen offset:3072 lds
    s_add_u32 m0, s93, 4096
    s_add_u32 s92, s92, 4096
    buffer_load_dwordx4 v6, s[68:71], s92 offen offset:0 lds
    buffer_load_dwordx4 v6, s[68:71], s92 offen offset:1024 lds
    buffer_load_dwordx4 v6, s[68:71], s92 offen offset:2048 lds
    buffer_load_dwordx4 v6, s[68:71], s92 offen offset:3072 lds
    s_add_u32 m0, s93, 8192
    s_add_u32 s92, s92, 4096
    buffer_load_dwordx4 v6, s[68:71], s92 offen offset:0 lds
KS_L4:
    s_add_u32 s64, s36, 0x600000
    s_addc_u32 s65, s37, 0
    s_mov_b32 s66, 0x240000
    s_mov_b32 s67, 0x20000
    s_mov_b32 s68, s32
    s_mov_b32 s69, s33
    s_mov_b32 s70, 0x240000
    s_mov_b32 s71, 0x20000
    s_add_u32 s72, s36, 0x300000
    s_addc_u32 s73, s37, 0
    s_mov_b32 s74, 0x240000
    s_mov_b32 s75, 0x20000
    s_add_u32 s76, s36, 0x840000
    s_addc_u32 s77, s37, 0
    s_mov_b32 s78, 0x3000
    s_mov_b32 s79, 0x20000
    v_lshrrev_b32 v6, 1, v0
    v_lshlrev_b32 v6, 6, v6
    v_and_b32 v8, 1, v0
    v_lshl_add_u32 v6, v8, 4, v6
    s_lshr_b32 s92, s90, 1
    s_lshl_b32 s92, s92, 14
    s_and_b32 s93, s90, 1
    s_lshl_b32 s93, s93, 5
    s_add_u32 s92, s92, s93
    s_lshr_b32 s94, s90, 2
    s_lshl_b32 s94, s94, 12
    s_add_u32 s94, s94, s93
    s_bfe_u32 s93, s90, 0x10001
    s_lshl_b32 s93, s93, 4
    s_add_u32 s94, s94, s93
    s_lshl_b32 s93, s38, 10
    s_add_u32 s94, s94, s93
    s_add_u32 s94, s94, 0x200000
    s_add_u32 s93, s92, 8192
    v_lshlrev_b32 v9, 6, v2
    s_mul_i32 s95, s38, 2304
    s_add_u32 s95, s95, 16896
    v_lshl_add_u32 v117, v114, 5, s95
    v_lshl_add_u32 v110, v114, 3, s95
    s_lshl_b32 s95, s38, 9
    s_add_u32 s95, s95, 26176
    v_lshl_add_u32 v108, v1, 2, s95
    v_lshl_add_u32 v109, v1, 4, s95
    s_mov_b32 s95, 0x02020202
    v_mul_lo_u32 v118, v113, s95
    v_add_u32 v118, 0x05040100, v118
    v_lshlrev_b32 v8, 2, v0
    v_add_u32 v8, 16896, v8
    s_lshl_b32 s95, s38, 6
    s_add_u32 s95, s95, 18944
    v_lshl_add_u32 v119, v2, 2, s95
    s_waitcnt vmcnt(0)
    ds_write_b8 v116, v5 offset:40
    v_lshlrev_b32 v20, 16, v10
    v_and_b32 v21, 0xffff0000, v10
    v_lshlrev_b32 v22, 16, v11
    v_and_b32 v23, 0xffff0000, v11
    v_lshlrev_b32 v24, 16, v12
    v_and_b32 v25, 0xffff0000, v12
    v_lshlrev_b32 v26, 16, v13
    v_and_b32 v27, 0xffff0000, v13
    v_lshlrev_b32 v28, 16, v14
    v_and_b32 v29, 0xffff0000, v14
    v_lshlrev_b32 v30, 16, v15
    v_and_b32 v31, 0xffff0000, v15
    v_lshlrev_b32 v32, 16, v16
    v_and_b32 v33, 0xffff0000, v16
    v_lshlrev_b32 v34, 16, v17
    v_and_b32 v35, 0xffff0000, v17
    v_lshlrev_b32 v36, 16, v18
    v_and_b32 v37, 0xffff0000, v18
W_67:
    s_sleep 1
    ds_read_b64 v[60:61], v4 offset:48
    s_sub_u32 s39, s39, 1
    s_cbranch_scc1 KS_ABORT
    s_waitcnt lgkmcnt(0)
    v_and_b32 v60, v60, v61
    v_cmp_ne_u32 vcc, s84, v60
    s_cbranch_vccnz W_67
    s_setprio 3
    s_branch ZPE_69
ZP_68:
    s_sleep 1
ZPE_69:
    buffer_load_dwordx4 v[68:71], v4, s[64:67], s94 offen sc1
    s_sub_u32 s39, s39, 1
    s_cbranch_scc1 KS_ABORT
    s_waitcnt vmcnt(0)
    v_max3_u32 v44, v68, v69, v70
    v_max_u32 v44, v44, v71
    v_cmp_eq_u32 vcc, -1, v44
    s_cbranch_vccnz ZP_68
    s_branch ZPE_71
ZP_70:
    s_sleep 1
ZPE_71:
    buffer_load_dwordx4 v[60:63], v6, s[64:67], s92 offen sc1
    buffer_load_dwordx4 v[64:67], v6, s[64:67], s93 offen sc1
    buffer_load_dwordx4 v[68:71], v9, s[64:67], s94 offen sc1
    s_sub_u32 s39, s39, 1
    s_cbranch_scc1 KS_ABORT
    s_waitcnt vmcnt(0)
    v_max3_u32 v44, v60, v61, v62
    v_max3_u32 v44, v44, v63, v64
    v_max3_u32 v44, v44, v65, v66
    v_max3_u32 v44, v44, v67, v68
    v_max3_u32 v44, v44, v69, v70
    v_max_u32 v44, v44, v71
    v_cmp_eq_u32 vcc, -1, v44
    s_cbranch_vccnz ZP_70
    ds_write2st64_b32 v8, v60, v61 offset0:0 offset1:9
    ds_write2st64_b32 v8, v62, v63 offset0:18 offset1:27
    ds_write2st64_b32 v8, v64, v65 offset0:4 offset1:13
    ds_write2st64_b32 v8, v66, v67 offset0:22 offset1:31
    ds_write2st64_b32 v119, v68, v69 offset0:0 offset1:9
    ds_write2st64_b32 v119, v70, v71 offset0:18 offset1:27
    ds_write_b8 v116, v5 offset:20
W_72:
    ds_read_b32 v60, v4 offset:20
    s_sub_u32 s39, s39, 1
    s_cbranch_scc1 KS_ABORT
    s_waitcnt lgkmcnt(0)
    v_cmp_ne_u32 vcc, s84, v60
    s_cbranch_vccnz W_72
    ds_read_b128 v[60:63], v117 offset:0
    ds_read_b128 v[64:67], v117 offset:16
    ds_read_b128 v[68:71], v117 offset:1024
    ds_read_b128 v[72:75], v117 offset:1040
    ds_read_b64 v[76:77], v110 offset:2048
    s_waitcnt lgkmcnt(4)
    v_perm_b32 v44, v61, v60, v118
    v_lshlrev_b32 v46, 16, v44
    v_and_b32 v47, 0xffff0000, v44
    v_pk_add_f32 v[46:47], v[46:47], v[20:21]
    v_cvt_pk_bf16_f32 v44, v46, v47
    v_lshlrev_b32 v20, 16, v44
    v_and_b32 v21, 0xffff0000, v44
    v_perm_b32 v44, v63, v62, v118
    v_lshlrev_b32 v46, 16, v44
    v_and_b32 v47, 0xffff0000, v44
    v_pk_add_f32 v[46:47], v[46:47], v[22:23]
    v_cvt_pk_bf16_f32 v44, v46, v47
    v_lshlrev_b32 v22, 16, v44
    v_and_b32 v23, 0xffff0000, v44
    s_waitcnt lgkmcnt(3)
    v_perm_b32 v44, v65, v64, v118
    v_lshlrev_b32 v46, 16, v44
    v_and_b32 v47, 0xffff0000, v44
    v_pk_add_f32 v[46:47], v[46:47], v[24:25]
    v_cvt_pk_bf16_f32 v44, v46, v47
    v_lshlrev_b32 v24, 16, v44
    v_and_b32 v25, 0xffff0000, v44
    v_perm_b32 v44, v67, v66, v118
    v_lshlrev_b32 v46, 16, v44
    v_and_b32 v47, 0xffff0000, v44
    v_pk_add_f32 v[46:47], v[46:47], v[26:27]
    v_cvt_pk_bf16_f32 v44, v46, v47
    v_lshlrev_b32 v26, 16, v44
    v_and_b32 v27, 0xffff0000, v44
    s_waitcnt lgkmcnt(2)
    v_perm_b32 v44, v69, v68, v118
    v_lshlrev_b32 v46, 16, v44
    v_and_b32 v47, 0xffff0000, v44
    v_pk_add_f32 v[46:47], v[46:47], v[28:29]
    v_cvt_pk_bf16_f32 v44, v46, v47
    v_lshlrev_b32 v28, 16, v44
    v_and_b32 v29, 0xffff0000, v44
    v_perm_b32 v44, v71, v70, v118
    v_lshlrev_b32 v46, 16, v44
    v_and_b32 v47, 0xffff0000, v44
    v_pk_add_f32 v[46:47], v[46:47], v[30:31]
    v_cvt_pk_bf16_f32 v44, v46, v47
    v_lshlrev_b32 v30, 16, v44
    v_and_b32 v31, 0xffff0000, v44
    s_waitcnt lgkmcnt(1)
    v_perm_b32 v44, v73, v72, v118
    v_lshlrev_b32 v46, 16, v44
    v_and_b32 v47, 0xffff0000, v44
    v_pk_add_f32 v[46:47], v[46:47], v[32:33]
    v_cvt_pk_bf16_f32 v44, v46, v47
    v_lshlrev_b32 v32, 16, v44
    v_and_b32 v33, 0xffff0000, v44
    v_perm_b32 v44, v75, v74, v118
    v_lshlrev_b32 v46, 16, v44
    v_and_b32 v47, 0xffff0000, v44
    v_pk_add_f32 v[46:47], v[46:47], v[34:35]
    v_cvt_pk_bf16_f32 v44, v46, v47
    v_lshlrev_b32 v34, 16, v44
    v_and_b32 v35, 0xffff0000, v44
    s_waitcnt lgkmcnt(0)
    v_perm_b32 v44, v77, v76, v118
    v_lshlrev_b32 v46, 16, v44
    v_and_b32 v47, 0xffff0000, v44
    v_pk_add_f32 v[46:47], v[46:47], v[36:37]
    v_cvt_pk_bf16_f32 v44, v46, v47
    v_lshlrev_b32 v36, 16, v44
    v_and_b32 v37, 0xffff0000, v44
    v_pk_add_f32 v[44:45], v[20:21], v[22:23]
    v_pk_add_f32 v[46:47], v[24:25], v[26:27]
    v_pk_add_f32 v[44:45], v[44:45], v[28:29]
    v_pk_add_f32 v[46:47], v[46:47], v[30:31]
    v_pk_add_f32 v[44:45], v[44:45], v[32:33]
    v_pk_add_f32 v[46:47], v[46:47], v[34:35]
    v_pk_add_f32 v[44:45], v[44:45], v[36:37]
    v_pk_add_f32 v[44:45], v[44:45], v[46:47]
    v_add_f32 v44, v44, v45
    s_nop 1
    v_add_f32_dpp v44, v44, v44 row_ror:8 row_mask:0xf bank_mask:0xf
    s_nop 1
    v_add_f32_dpp v44, v44, v44 row_ror:4 row_mask:0xf bank_mask:0xf
    s_nop 1
    v_add_f32_dpp v44, v44, v44 row_ror:2 row_mask:0xf bank_mask:0xf
    s_nop 1
    v_add_f32_dpp v44, v44, v44 row_ror:1 row_mask:0xf bank_mask:0xf
    v_mov_b32 v46, v44
    s_nop 1
    v_permlane16_swap_b32 v44, v46
    v_add_f32 v44, v44, v46
    v_mul_f32 v48, 0x3ae38e39, v44
    v_mov_b32 v49, v48
    v_cvt_pk_bf16_f32 v40, v48, v48
    v_and_b32 v40, 0xffff0000, v40
    v_mov_b32 v41, v40
    v_pk_add_f32 v[42:43], v[20:21], v[48:49] neg_lo:[0,1] neg_hi:[0,1]
    v_pk_mul_f32 v[44:45], v[42:43], v[42:43]
    v_pk_add_f32 v[42:43], v[22:23], v[48:49] neg_lo:[0,1] neg_hi:[0,1]
    v_pk_mul_f32 v[46:47], v[42:43], v[42:43]
    v_pk_add_f32 v[42:43], v[24:25], v[48:49] neg_lo:[0,1] neg_hi:[0,1]
    v_pk_fma_f32 v[44:45], v[42:43], v[42:43], v[44:45]
    v_pk_add_f32 v[42:43], v[26:27], v[48:49] neg_lo:[0,1] neg_hi:[0,1]
    v_pk_fma_f32 v[46:47], v[42:43], v[42:43], v[46:47]
    v_pk_add_f32 v[42:43], v[28:29], v[48:49] neg_lo:[0,1] neg_hi:[0,1]
    v_pk_fma_f32 v[44:45], v[42:43], v[42:43], v[44:45]
    v_pk_add_f32 v[42:43], v[30:31], v[48:49] neg_lo:[0,1] neg_hi:[0,1]
    v_pk_fma_f32 v[46:47], v[42:43], v[42:43], v[46:47]
    v_pk_add_f32 v[42:43], v[32:33], v[48:49] neg_lo:[0,1] neg_hi:[0,1]
    v_pk_fma_f32 v[44:45], v[42:43], v[42:43], v[44:45]
    v_pk_add_f32 v[42:43], v[34:35], v[48:49] neg_lo:[0,1] neg_hi:[0,1]
    v_pk_fma_f32 v[46:47], v[42:43], v[42:43], v[46:47]
    v_pk_add_f32 v[42:43], v[36:37], v[48:49] neg_lo:[0,1] neg_hi:[0,1]
    v_pk_fma_f32 v[44:45], v[42:43], v[42:43], v[44:45]
    v_pk_add_f32 v[44:45], v[44:45], v[46:47]
    v_add_f32 v44, v44, v45
    s_nop 1
    v_add_f32_dpp v44, v44, v44 row_ror:8 row_mask:0xf bank_mask:0xf
    s_nop 1
    v_add_f32_dpp v44, v44, v44 row_ror:4 row_mask:0xf bank_mask:0xf
    s_nop 1
    v_add_f32_dpp v44, v44, v44 row_ror:2 row_mask:0xf bank_mask:0xf
    s_nop 1
    v_add_f32_dpp v44, v44, v44 row_ror:1 row_mask:0xf bank_mask:0xf
    v_mov_b32 v46, v44
    s_nop 1
    v_permlane16_swap_b32 v44, v46
    v_add_f32 v44, v44, v46
    v_mul_f32 v44, 0x3ae38e39, v44
    v_cvt_pk_bf16_f32 v44, v44, v44
    v_and_b32 v44, 0xffff0000, v44
    v_add_f32 v44, 0x3727c5ac, v44
    v_cvt_pk_bf16_f32 v44, v44, v44
    v_and_b32 v44, 0xffff0000, v44
    v_sqrt_f32 v44, v44
    s_nop 0
    v_cvt_pk_bf16_f32 v44, v44, v44
    v_and_b32 v44, 0xffff0000, v44
    v_rcp_f32 v42, v44
    s_nop 0
    v_mov_b32 v43, v42
    v_mov_b32 v60, 0
    v_mov_b32 v61, 0
    v_pk_add_f32 v[44:45], v[20:21], v[40:41] neg_lo:[0,1] neg_hi:[0,1]
    v_cvt_pk_bf16_f32 v10, v44, v45
    v_lshlrev_b32 v44, 16, v10
    v_and_b32 v45, 0xffff0000, v10
    v_pk_mul_f32 v[44:45], v[44:45], v[42:43]
    v_cvt_pk_bf16_f32 v10, v44, v45
    v_lshlrev_b32 v44, 16, v10
    v_and_b32 v45, 0xffff0000, v10
    v_lshlrev_b32 v46, 16, v50
    v_and_b32 v47, 0xffff0000, v50
    v_pk_fma_f32 v[60:61], v[44:45], v[46:47], v[60:61]
    v_pk_add_f32 v[20:21], v[44:45], v[20:21]
    v_pk_add_f32 v[44:45], v[22:23], v[40:41] neg_lo:[0,1] neg_hi:[0,1]
    v_cvt_pk_bf16_f32 v11, v44, v45
    v_lshlrev_b32 v44, 16, v11
    v_and_b32 v45, 0xffff0000, v11
    v_pk_mul_f32 v[44:45], v[44:45], v[42:43]
    v_cvt_pk_bf16_f32 v11, v44, v45
    v_lshlrev_b32 v44, 16, v11
    v_and_b32 v45, 0xffff0000, v11
    v_lshlrev_b32 v46, 16, v51
    v_and_b32 v47, 0xffff0000, v51
    v_pk_fma_f32 v[60:61], v[44:45], v[46:47], v[60:61]
    v_pk_add_f32 v[22:23], v[44:45], v[22:23]
    v_pk_add_f32 v[44:45], v[24:25], v[40:41] neg_lo:[0,1] neg_hi:[0,1]
    v_cvt_pk_bf16_f32 v12, v44, v45
    v_lshlrev_b32 v44, 16, v12
    v_and_b32 v45, 0xffff0000, v12
    v_pk_mul_f32 v[44:45], v[44:45], v[42:43]
    v_cvt_pk_bf16_f32 v12, v44, v45
    v_lshlrev_b32 v44, 16, v12
    v_and_b32 v45, 0xffff0000, v12
    v_lshlrev_b32 v46, 16, v52
    v_and_b32 v47, 0xffff0000, v52
    v_pk_fma_f32 v[60:61], v[44:45], v[46:47], v[60:61]
    v_pk_add_f32 v[24:25], v[44:45], v[24:25]
    v_pk_add_f32 v[44:45], v[26:27], v[40:41] neg_lo:[0,1] neg_hi:[0,1]
    v_cvt_pk_bf16_f32 v13, v44, v45
    v_lshlrev_b32 v44, 16, v13
    v_and_b32 v45, 0xffff0000, v13
    v_pk_mul_f32 v[44:45], v[44:45], v[42:43]
    v_cvt_pk_bf16_f32 v13, v44, v45
    v_lshlrev_b32 v44, 16, v13
    v_and_b32 v45, 0xffff0000, v13
    v_lshlrev_b32 v46, 16, v53
    v_and_b32 v47, 0xffff0000, v53
    v_pk_fma_f32 v[60:61], v[44:45], v[46:47], v[60:61]
    v_pk_add_f32 v[26:27], v[44:45], v[26:27]
    v_pk_add_f32 v[44:45], v[28:29], v[40:41] neg_lo:[0,1] neg_hi:[0,1]
    v_cvt_pk_bf16_f32 v14, v44, v45
    v_lshlrev_b32 v44, 16, v14
    v_and_b32 v45, 0xffff0000, v14
    v_pk_mul_f32 v[44:45], v[44:45], v[42:43]
    v_cvt_pk_bf16_f32 v14, v44, v45
    v_lshlrev_b32 v44, 16, v14
    v_and_b32 v45, 0xffff0000, v14
    v_lshlrev_b32 v46, 16, v54
    v_and_b32 v47, 0xffff0000, v54
    v_pk_fma_f32 v[60:61], v[44:45], v[46:47], v[60:61]
    v_pk_add_f32 v[28:29], v[44:45], v[28:29]
    v_pk_add_f32 v[44:45], v[30:31], v[40:41] neg_lo:[0,1] neg_hi:[0,1]
    v_cvt_pk_bf16_f32 v15, v44, v45
    v_lshlrev_b32 v44, 16, v15
    v_and_b32 v45, 0xffff0000, v15
    v_pk_mul_f32 v[44:45], v[44:45], v[42:43]
    v_cvt_pk_bf16_f32 v15, v44, v45
    v_lshlrev_b32 v44, 16, v15
    v_and_b32 v45, 0xffff0000, v15
    v_lshlrev_b32 v46, 16, v55
    v_and_b32 v47, 0xffff0000, v55
    v_pk_fma_f32 v[60:61], v[44:45], v[46:47], v[60:61]
    v_pk_add_f32 v[30:31], v[44:45], v[30:31]
    v_pk_add_f32 v[44:45], v[32:33], v[40:41] neg_lo:[0,1] neg_hi:[0,1]
    v_cvt_pk_bf16_f32 v16, v44, v45
    v_lshlrev_b32 v44, 16, v16
    v_and_b32 v45, 0xffff0000, v16
    v_pk_mul_f32 v[44:45], v[44:45], v[42:43]
    v_cvt_pk_bf16_f32 v16, v44, v45
    v_lshlrev_b32 v44, 16, v16
    v_and_b32 v45, 0xffff0000, v16
    v_lshlrev_b32 v46, 16, v56
    v_and_b32 v47, 0xffff0000, v56
    v_pk_fma_f32 v[60:61], v[44:45], v[46:47], v[60:61]
    v_pk_add_f32 v[32:33], v[44:45], v[32:33]
    v_pk_add_f32 v[44:45], v[34:35], v[40:41] neg_lo:[0,1] neg_hi:[0,1]
    v_cvt_pk_bf16_f32 v17, v44, v45
    v_lshlrev_b32 v44, 16, v17
    v_and_b32 v45, 0xffff0000, v17
    v_pk_mul_f32 v[44:45], v[44:45], v[42:43]
    v_cvt_pk_bf16_f32 v17, v44, v45
    v_lshlrev_b32 v44, 16, v17
    v_and_b32 v45, 0xffff0000, v17
    v_lshlrev_b32 v46, 16, v57
    v_and_b32 v47, 0xffff0000, v57
    v_pk_fma_f32 v[60:61], v[44:45], v[46:47], v[60:61]
    v_pk_add_f32 v[34:35], v[44:45], v[34:35]
    v_pk_add_f32 v[44:45], v[36:37], v[40:41] neg_lo:[0,1] neg_hi:[0,1]
    v_cvt_pk_bf16_f32 v18, v44, v45
    v_lshlrev_b32 v44, 16, v18
    v_and_b32 v45, 0xffff0000, v18
    v_pk_mul_f32 v[44:45], v[44:45], v[42:43]
    v_cvt_pk_bf16_f32 v18, v44, v45
    v_lshlrev_b32 v44, 16, v18
    v_and_b32 v45, 0xffff0000, v18
    v_lshlrev_b32 v46, 16, v58
    v_and_b32 v47, 0xffff0000, v58
    v_pk_fma_f32 v[60:61], v[44:45], v[46:47], v[60:61]
    v_pk_add_f32 v[36:37], v[44:45], v[36:37]
    v_add_f32 v60, v60, v61
    s_nop 1
    v_add_f32_dpp v60, v60, v60 row_ror:8 row_mask:0xf bank_mask:0xf
    s_nop 1
    v_add_f32_dpp v60, v60, v60 row_ror:4 row_mask:0xf bank_mask:0xf
    s_nop 1
    v_add_f32_dpp v60, v60, v60 row_ror:2 row_mask:0xf bank_mask:0xf
    s_nop 1
    v_add_f32_dpp v60, v60, v60 row_ror:1 row_mask:0xf bank_mask:0xf
    v_mov_b32 v61, v60
    s_nop 1
    v_permlane16_swap_b32 v60, v61
    v_add_f32 v60, v60, v61
    v_cvt_pk_bf16_f32 v60, v60, v60
    v_ashrrev_i32 v61, 31, v60
    v_or_b32 v61, 0x80000000, v61
    v_xor_b32 v60, v60, v61
    v_and_b32 v60, 0xffff0000, v60
    v_sub_u32 v62, 0x87ff, v112
    v_or_b32 v60, v60, v62
    v_lshl_add_u32 v61, v116, 1, v113
    v_lshlrev_b32 v61, 2, v61
    s_mov_b32 exec_lo, 1
    s_mov_b32 exec_hi, 1
    ds_write_b32 v61, v60 offset:800
    s_mov_b64 exec, 1
    ds_add_rtn_u32 v62, v4, v5 offset:12
    s_mov_b64 exec, 3
    v_lshlrev_b32 v61, 4, v114
    s_lshl_b32 s92, s90, 5
    ds_read_b128 v[64:67], v61 offset:800
    s_waitcnt lgkmcnt(1)
    v_readfirstlane_b32 s93, v62
    s_cmp_lg_u32 s93, 3
    s_cbranch_scc1 KS_NOKEY
    s_waitcnt lgkmcnt(0)
    buffer_store_dwordx4 v[64:67], v61, s[76:79], s92 offen sc1
KS_NOKEY:
    s_mov_b64 exec, -1
    v_cvt_pk_bf16_f32 v58, v36, v37
    ds_write_b32 v108, v18
    ds_write_b32 v108, v58 offset:256
    ds_read_b128 v[64:67], v109
    buffer_store_dwordx4 v[10:13], v115, s[72:75], 0 offen sc1
    buffer_store_dwordx4 v[14:17], v115, s[72:75], 0 offen offset:512 sc1
    v_cvt_pk_bf16_f32 v50, v20, v21
    v_cvt_pk_bf16_f32 v51, v22, v23
    v_cvt_pk_bf16_f32 v52, v24, v25
    v_cvt_pk_bf16_f32 v53, v26, v27
    v_cvt_pk_bf16_f32 v54, v28, v29
    v_cvt_pk_bf16_f32 v55, v30, v31
    v_cvt_pk_bf16_f32 v56, v32, v33
    v_cvt_pk_bf16_f32 v57, v34, v35
    s_mov_b64 exec, 0xffff
    s_waitcnt lgkmcnt(0)
    buffer_store_dwordx4 v[64:67], v111, s[72:75], 0 offen offset:1024 sc1
    s_mov_b64 exec, 0xffff0000
    buffer_store_dwordx4 v[64:67], v111, s[68:71], 0 offen offset:1024 sc1
    s_mov_b64 exec, -1
    buffer_store_dwordx4 v[50:53], v115, s[68:71], 0 offen sc1
    buffer_store_dwordx4 v[54:57], v115, s[68:71], 0 offen offset:512 sc1
    s_cmp_lg_u32 s93, 3
    s_cbranch_scc1 KS_NOKEY2
    s_waitcnt vmcnt(6)
    ds_write_b32 v4, v5 offset:24
KS_NOKEY2:
    s_waitcnt vmcnt(0)
    s_mov_b64 exec, 1
    ds_add_rtn_u32 v62, v4, v5 offset:176
    s_waitcnt lgkmcnt(0)
    v_cmp_eq_u32 vcc, 3, v62
    s_and_b64 exec, exec, vcc
    s_cbranch_execz KS_NOF2
    s_lshl_b32 s92, s2, 4
    s_add_u32 s92, s92, 8192
    buffer_store_dword v5, v4, s[76:79], s92 offen sc1
KS_NOF2:
    s_mov_b64 exec, -1
    s_setprio 0
    s_cmp_lt_u32 s41, 18
    s_cbranch_scc1 KS_B
    s_waitcnt lgkmcnt(0)
    s_endpgm
KS_T:
    s_setprio 0
    s_cmp_ge_u32 s38, 10
    s_cbranch_scc1 KS_P
    v_and_b32 v6, 1, v1
    v_subrev_u32 v6, 1, v6
    v_and_b32 v7, 7, v1
    v_lshlrev_b32 v7, 2, v7
    s_add_u32 s76, s36, 0x840000
    s_addc_u32 s77, s37, 0
    s_mov_b32 s78, 0x3000
    s_mov_b32 s79, 0x20000
    s_cmp_eq_u32 s38, 9
    s_cbranch_scc1 KS_W9
    s_cmp_eq_u32 s38, 8
    s_cbranch_scc1 KS_L2W
    s_sub_u32 s93, s38, 4
    s_lshl_b32 s92, s93, 10
    v_lshl_add_u32 v33, v1, 4, s92
    s_movk_i32 s92, 4096
    s_lshl_b32 s93, s93, 7
    v_lshlrev_b32 v32, 4, v2
    v_lshl_add_u32 v32, v3, 5, v32
    v_add_u32 v32, s93, v32
W_73:
    s_sleep 1
    ds_read_b32 v8, v4 offset:24
    s_sub_u32 s39, s39, 1
    s_cbranch_scc1 KS_ABORT
    s_waitcnt lgkmcnt(0)
    v_cmp_eq_u32 vcc, 0, v8
    s_cbranch_vccnz W_73
    s_setprio 2
    s_sleep 20
    s_branch ZPE_75
ZP_74:
    s_sleep 4
ZPE_75:
    buffer_load_dwordx4 v[8:11], v33, s[76:79], 0 offen sc1
    buffer_load_dwordx4 v[12:15], v33, s[76:79], s92 offen sc1
    s_sub_u32 s39, s39, 1
    s_cbranch_scc1 KS_ABORT
    s_waitcnt vmcnt(0)
    v_max3_u32 v44, v8, v9, v10
    v_max3_u32 v44, v44, v11, v12
    v_max3_u32 v44, v44, v13, v14
    v_max_u32 v44, v44, v15
    v_cmp_eq_u32 vcc, -1, v44
    s_cbranch_vccnz ZP_74
    ds_write_b32 v4, v5 offset:196
    v_max_u32 v16, v8, v9
    v_min_u32 v9, v8, v9
    v_max_u32 v17, v12, v13
    v_min_u32 v13, v12, v13
    v_max_u32 v18, v10, v11
    v_min_u32 v11, v10, v11
    v_max_u32 v19, v14, v15
    v_min_u32 v15, v14, v15
    v_max_u32 v20, v16, v18
    v_min_u32 v18, v16, v18
    v_max_u32 v21, v17, v19
    v_min_u32 v19, v17, v19
    v_max_u32 v22, v9, v11
    v_min_u32 v11, v9, v11
    v_max_u32 v23, v13, v15
    v_min_u32 v15, v13, v15
    v_max_u32 v24, v22, v18
    v_min_u32 v18, v22, v18
    v_max_u32 v25, v23, v19
    v_min_u32 v19, v23, v19
    v_mov_b32_dpp v26, v11 quad_perm:[1,0,3,2] row_mask:0xf bank_mask:0xf
    v_mov_b32_dpp v27, v18 quad_perm:[1,0,3,2] row_mask:0xf bank_mask:0xf
    v_mov_b32_dpp v8, v24 quad_perm:[1,0,3,2] row_mask:0xf bank_mask:0xf
    v_mov_b32_dpp v12, v20 quad_perm:[1,0,3,2] row_mask:0xf bank_mask:0xf
    v_med3_u32 v26, v20, v26, v6
    v_med3_u32 v27, v24, v27, v6
    v_med3_u32 v8, v18, v8, v6
    v_med3_u32 v12, v11, v12, v6
    v_max_u32 v10, v26, v8
    v_min_u32 v8, v26, v8
    v_max_u32 v14, v27, v12
    v_min_u32 v12, v27, v12
    v_max_u32 v16, v10, v14
    v_min_u32 v14, v10, v14
    v_max_u32 v17, v8, v12
    v_min_u32 v12, v8, v12
    v_mov_b32_dpp v9, v15 quad_perm:[1,0,3,2] row_mask:0xf bank_mask:0xf
    v_mov_b32_dpp v13, v19 quad_perm:[1,0,3,2] row_mask:0xf bank_mask:0xf
    v_mov_b32_dpp v22, v25 quad_perm:[1,0,3,2] row_mask:0xf bank_mask:0xf
    v_mov_b32_dpp v23, v21 quad_perm:[1,0,3,2] row_mask:0xf bank_mask:0xf
    v_med3_u32 v9, v21, v9, v6
    v_med3_u32 v13, v25, v13, v6
    v_med3_u32 v22, v19, v22, v6
    v_med3_u32 v23, v15, v23, v6
    v_max_u32 v20, v9, v22
    v_min_u32 v22, v9, v22
    v_max_u32 v24, v13, v23
    v_min_u32 v23, v13, v23
    v_max_u32 v18, v20, v24
    v_min_u32 v24, v20, v24
    v_max_u32 v11, v22, v23
    v_min_u32 v23, v22, v23
    s_nop 1
    v_max_u32_dpp v16, v23, v16 quad_perm:[1,0,3,2] row_mask:0xf bank_mask:0xf
    v_max_u32_dpp v14, v11, v14 quad_perm:[1,0,3,2] row_mask:0xf bank_mask:0xf
    v_max_u32_dpp v17, v24, v17 quad_perm:[1,0,3,2] row_mask:0xf bank_mask:0xf
    v_max_u32_dpp v12, v18, v12 quad_perm:[1,0,3,2] row_mask:0xf bank_mask:0xf
    v_mov_b32_dpp v26, v16 quad_perm:[1,0,3,2] row_mask:0xf bank_mask:0xf
    v_mov_b32_dpp v27, v14 quad_perm:[1,0,3,2] row_mask:0xf bank_mask:0xf
    v_mov_b32_dpp v10, v17 quad_perm:[1,0,3,2] row_mask:0xf bank_mask:0xf
    v_mov_b32_dpp v8, v12 quad_perm:[1,0,3,2] row_mask:0xf bank_mask:0xf
    v_med3_u32 v26, v16, v26, v6
    v_med3_u32 v27, v14, v27, v6
    v_med3_u32 v10, v17, v10, v6
    v_med3_u32 v8, v12, v8, v6
    v_max_u32 v21, v26, v10
    v_min_u32 v10, v26, v10
    v_max_u32 v25, v27, v8
    v_min_u32 v8, v27, v8
    v_max_u32 v19, v21, v25
    v_min_u32 v25, v21, v25
    v_max_u32 v15, v10, v8
    v_min_u32 v8, v10, v8
    s_nop 1
    v_max_u32_dpp v9, v8, v19 quad_perm:[3,2,1,0] row_mask:0xf bank_mask:0xf
    v_max_u32_dpp v13, v15, v25 quad_perm:[3,2,1,0] row_mask:0xf bank_mask:0xf
    v_max_u32_dpp v20, v25, v15 quad_perm:[3,2,1,0] row_mask:0xf bank_mask:0xf
    v_max_u32_dpp v22, v19, v8 quad_perm:[3,2,1,0] row_mask:0xf bank_mask:0xf
    v_mov_b32_dpp v18, v9 quad_perm:[1,0,3,2] row_mask:0xf bank_mask:0xf
    v_mov_b32_dpp v24, v13 quad_perm:[1,0,3,2] row_mask:0xf bank_mask:0xf
    v_mov_b32_dpp v11, v20 quad_perm:[1,0,3,2] row_mask:0xf bank_mask:0xf
    v_mov_b32_dpp v23, v22 quad_perm:[1,0,3,2] row_mask:0xf bank_mask:0xf
    v_med3_u32 v18, v9, v18, v6
    v_med3_u32 v24, v13, v24, v6
    v_med3_u32 v11, v20, v11, v6
    v_med3_u32 v23, v22, v23, v6
    v_max_u32 v16, v18, v11
    v_min_u32 v11, v18, v11
    v_max_u32 v14, v24, v23
    v_min_u32 v23, v24, v23
    v_max_u32 v17, v16, v14
    v_min_u32 v14, v16, v14
    v_max_u32 v12, v11, v23
    v_min_u32 v23, v11, v23
    s_nop 1
    v_max_u32_dpp v26, v23, v17 row_half_mirror row_mask:0xf bank_mask:0xf
    v_max_u32_dpp v27, v12, v14 row_half_mirror row_mask:0xf bank_mask:0xf
    v_max_u32_dpp v21, v14, v12 row_half_mirror row_mask:0xf bank_mask:0xf
    v_max_u32_dpp v10, v17, v23 row_half_mirror row_mask:0xf bank_mask:0xf
    v_mov_b32_dpp v19, v26 quad_perm:[1,0,3,2] row_mask:0xf bank_mask:0xf
    v_mov_b32_dpp v25, v27 quad_perm:[1,0,3,2] row_mask:0xf bank_mask:0xf
    v_mov_b32_dpp v15, v21 quad_perm:[1,0,3,2] row_mask:0xf bank_mask:0xf
    v_mov_b32_dpp v8, v10 quad_perm:[1,0,3,2] row_mask:0xf bank_mask:0xf
    v_med3_u32 v19, v26, v19, v6
    v_med3_u32 v25, v27, v25, v6
    v_med3_u32 v15, v21, v15, v6
    v_med3_u32 v8, v10, v8, v6
    v_max_u32 v9, v19, v15
    v_min_u32 v15, v19, v15
    v_max_u32 v13, v25, v8
    v_min_u32 v8, v25, v8
    v_max_u32 v20, v9, v13
    v_min_u32 v13, v9, v13
    v_max_u32 v22, v15, v8
    v_min_u32 v8, v15, v8
    s_nop 1
    v_max_u32_dpp v18, v8, v20 row_mirror row_mask:0xf bank_mask:0xf
    v_max_u32_dpp v24, v22, v13 row_mirror row_mask:0xf bank_mask:0xf
    v_max_u32_dpp v16, v13, v22 row_mirror row_mask:0xf bank_mask:0xf
    v_max_u32_dpp v11, v20, v8 row_mirror row_mask:0xf bank_mask:0xf
    v_mov_b32_dpp v17, v18 quad_perm:[1,0,3,2] row_mask:0xf bank_mask:0xf
    v_mov_b32_dpp v14, v24 quad_perm:[1,0,3,2] row_mask:0xf bank_mask:0xf
    v_mov_b32_dpp v12, v16 quad_perm:[1,0,3,2] row_mask:0xf bank_mask:0xf
    v_mov_b32_dpp v23, v11 quad_perm:[1,0,3,2] row_mask:0xf bank_mask:0xf
    v_med3_u32 v17, v18, v17, v6
    v_med3_u32 v14, v24, v14, v6
    v_med3_u32 v12, v16, v12, v6
    v_med3_u32 v23, v11, v23, v6
    v_max_u32 v26, v17, v12
    v_min_u32 v12, v17, v12
    v_max_u32 v27, v14, v23
    v_min_u32 v23, v14, v23
    v_max_u32 v21, v26, v27
    v_min_u32 v27, v26, v27
    v_max_u32 v10, v12, v23
    v_min_u32 v23, v12, v23
    v_mov_b32 v28, v21
    v_mov_b32 v29, v27
    v_mov_b32 v30, v10
    v_mov_b32 v31, v23
    s_mov_b32 exec_lo, 0x00030003
    s_mov_b32 exec_hi, 0x00030003
    ds_write_b128 v32, v[28:31] offset:256
    s_mov_b64 exec, -1
    s_setprio 0
    s_branch KS_B
KS_L2W:
    s_add_u32 s72, s36, 0x300000
    s_addc_u32 s73, s37, 0
    s_mov_b32 s74, 0x240000
    s_mov_b32 s75, 0x20000
    s_mov_b32 s92, 0xcccccccc
    s_mov_b32 s93, 0xcccccccc
    s_mov_b32 s94, 0xf0f0f0f0
    s_mov_b32 s95, 0xf0f0f0f0
    s_movk_i32 s96, 1152
    v_lshrrev_b32 v34, 3, v1
    v_lshlrev_b32 v34, 4, v34
    v_lshlrev_b32 v33, 4, v2
W_76:
    s_sleep 1
    ds_read_b32 v8, v4 offset:24
    s_sub_u32 s39, s39, 1
    s_cbranch_scc1 KS_ABORT
    s_waitcnt lgkmcnt(0)
    v_cmp_eq_u32 vcc, 0, v8
    s_cbranch_vccnz W_76
    s_setprio 2
KS_L2POLL:
    ds_read_b128 v[8:11], v33 offset:256
    ds_read_b128 v[12:15], v33 offset:512
    s_sub_u32 s39, s39, 1
    s_cbranch_scc1 KS_ABORT
    s_waitcnt lgkmcnt(0)
    v_min3_u32 v16, v8, v9, v10
    v_min3_u32 v17, v11, v12, v13
    v_min3_u32 v16, v16, v14, v15
    v_min_u32 v16, v16, v17
    v_cmp_eq_u32 vcc, 0, v16
    s_cbranch_vccnz KS_L2POLL
    v_max_u32_dpp v8, v15, v8 quad_perm:[1,0,3,2] row_mask:0xf bank_mask:0xf
    v_max_u32_dpp v9, v14, v9 quad_perm:[1,0,3,2] row_mask:0xf bank_mask:0xf
    v_max_u32_dpp v10, v13, v10 quad_perm:[1,0,3,2] row_mask:0xf bank_mask:0xf
    v_max_u32_dpp v11, v12, v11 quad_perm:[1,0,3,2] row_mask:0xf bank_mask:0xf
    v_mov_b32_dpp v16, v8 quad_perm:[1,0,3,2] row_mask:0xf bank_mask:0xf
    v_mov_b32_dpp v17, v9 quad_perm:[1,0,3,2] row_mask:0xf bank_mask:0xf
    v_mov_b32_dpp v18, v10 quad_perm:[1,0,3,2] row_mask:0xf bank_mask:0xf
    v_mov_b32_dpp v19, v11 quad_perm:[1,0,3,2] row_mask:0xf bank_mask:0xf
    v_med3_u32 v16, v8, v16, v6
    v_med3_u32 v17, v9, v17, v6
    v_med3_u32 v18, v10, v18, v6
    v_med3_u32 v19, v11, v19, v6
    v_max_u32 v20, v16, v18
    v_min_u32 v18, v16, v18
    v_max_u32 v21, v17, v19
    v_min_u32 v19, v17, v19
    v_max_u32 v22, v20, v21
    v_min_u32 v21, v20, v21
    v_max_u32 v23, v18, v19
    v_min_u32 v19, v18, v19
    s_nop 1
    v_max_u32_dpp v24, v19, v22 quad_perm:[3,2,1,0] row_mask:0xf bank_mask:0xf
    v_max_u32_dpp v25, v23, v21 quad_perm:[3,2,1,0] row_mask:0xf bank_mask:0xf
    v_max_u32_dpp v26, v21, v23 quad_perm:[3,2,1,0] row_mask:0xf bank_mask:0xf
    v_max_u32_dpp v27, v22, v19 quad_perm:[3,2,1,0] row_mask:0xf bank_mask:0xf
    v_mov_b32_dpp v12, v24 quad_perm:[1,0,3,2] row_mask:0xf bank_mask:0xf
    v_mov_b32_dpp v13, v25 quad_perm:[1,0,3,2] row_mask:0xf bank_mask:0xf
    v_mov_b32_dpp v14, v26 quad_perm:[1,0,3,2] row_mask:0xf bank_mask:0xf
    v_mov_b32_dpp v15, v27 quad_perm:[1,0,3,2] row_mask:0xf bank_mask:0xf
    v_med3_u32 v12, v24, v12, v6
    v_med3_u32 v13, v25, v13, v6
    v_med3_u32 v14, v26, v14, v6
    v_med3_u32 v15, v27, v15, v6
    v_max_u32 v8, v12, v14
    v_min_u32 v14, v12, v14
    v_max_u32 v9, v13, v15
    v_min_u32 v15, v13, v15
    v_max_u32 v10, v8, v9
    v_min_u32 v9, v8, v9
    v_max_u32 v11, v14, v15
    v_min_u32 v15, v14, v15
    s_nop 1
    v_max_u32_dpp v16, v15, v10 row_half_mirror row_mask:0xf bank_mask:0xf
    v_max_u32_dpp v17, v11, v9 row_half_mirror row_mask:0xf bank_mask:0xf
    v_max_u32_dpp v20, v9, v11 row_half_mirror row_mask:0xf bank_mask:0xf
    v_max_u32_dpp v18, v10, v15 row_half_mirror row_mask:0xf bank_mask:0xf
    v_mov_b32_dpp v22, v16 quad_perm:[1,0,3,2] row_mask:0xf bank_mask:0xf
    v_mov_b32_dpp v21, v17 quad_perm:[1,0,3,2] row_mask:0xf bank_mask:0xf
    v_mov_b32_dpp v23, v20 quad_perm:[1,0,3,2] row_mask:0xf bank_mask:0xf
    v_mov_b32_dpp v19, v18 quad_perm:[1,0,3,2] row_mask:0xf bank_mask:0xf
    v_med3_u32 v22, v16, v22, v6
    v_med3_u32 v21, v17, v21, v6
    v_med3_u32 v23, v20, v23, v6
    v_med3_u32 v19, v18, v19, v6
    v_max_u32 v24, v22, v23
    v_min_u32 v23, v22, v23
    v_max_u32 v25, v21, v19
    v_min_u32 v19, v21, v19
    v_max_u32 v26, v24, v25
    v_min_u32 v25, v24, v25
    v_max_u32 v27, v23, v19
    v_min_u32 v19, v23, v19
    s_nop 1
    v_max_u32_dpp v12, v19, v26 row_mirror row_mask:0xf bank_mask:0xf
    v_max_u32_dpp v13, v27, v25 row_mirror row_mask:0xf bank_mask:0xf
    v_max_u32_dpp v8, v25, v27 row_mirror row_mask:0xf bank_mask:0xf
    v_max_u32_dpp v14, v26, v19 row_mirror row_mask:0xf bank_mask:0xf
    ds_read_b32 v35, v4 offset:28
    v_cndmask_b32 v30, v12, v13, s[92:93]
    v_cndmask_b32 v31, v8, v14, s[92:93]
    v_cndmask_b32 v30, v30, v31, s[94:95]
    s_nop 1
    v_mov_b32_dpp v30, v30 row_shr:8 row_mask:0xf bank_mask:0xc
    v_and_b32 v31, 0x7ff, v30
    v_sub_u32 v31, 2047, v31
    v_mad_u32_u24 v31, v31, s96, v34
    s_waitcnt lgkmcnt(0)
    v_cmp_ne_u32 vcc, 0, v35
    s_cbranch_vccnz KS_RW1
W_77:
    ds_read_b32 v35, v4 offset:28
    s_sub_u32 s39, s39, 1
    s_cbranch_scc1 KS_ABORT
    s_waitcnt lgkmcnt(0)
    v_cmp_eq_u32 vcc, 0, v35
    s_cbranch_vccnz W_77
KS_RW1:
    s_mov_b32 m0, 16896
    s_nop 0
    buffer_load_dwordx4 v31, s[72:75], 0 offen offset:0 sc1 lds
    s_mov_b32 m0, 17792
    s_nop 0
    buffer_load_dwordx4 v31, s[72:75], 0 offen offset:128 sc1 lds
    s_mov_b32 m0, 18688
    s_nop 0
    buffer_load_dwordx4 v31, s[72:75], 0 offen offset:256 sc1 lds
    s_mov_b32 m0, 19584
    s_nop 0
    buffer_load_dwordx4 v31, s[72:75], 0 offen offset:384 sc1 lds
    s_mov_b32 m0, 20480
    s_nop 0
    buffer_load_dwordx4 v31, s[72:75], 0 offen offset:512 sc1 lds
    s_mov_b32 m0, 21376
    s_nop 0
    buffer_load_dwordx4 v31, s[72:75], 0 offen offset:640 sc1 lds
    s_mov_b32 m0, 22272
    s_nop 0
    buffer_load_dwordx4 v31, s[72:75], 0 offen offset:768 sc1 lds
    s_mov_b32 m0, 23168
    s_nop 0
    buffer_load_dwordx4 v31, s[72:75], 0 offen offset:896 sc1 lds
    s_mov_b32 m0, 24064
    s_nop 0
    buffer_load_dwordx4 v31, s[72:75], 0 offen offset:1024 sc1 lds
    ds_write_b32 v7, v30 offset:768
    s_waitcnt vmcnt(0)
    ds_write_b32 v4, v5 offset:32
    s_setprio 0
    s_branch KS_B
KS_W9:
    v_lshlrev_b32 v33, 4, v1
    s_movk_i32 s92, 0x2000
    s_add_u32 s72, s36, 0x300000
    s_addc_u32 s73, s37, 0
    s_mov_b32 s74, 0x240000
    s_mov_b32 s75, 0x20000
    s_add_u32 s64, s36, 0x600000
    s_addc_u32 s65, s37, 0
    s_mov_b32 s66, 0x240000
    s_mov_b32 s67, 0x20000
    s_mov_b32 s68, s4
    s_mov_b32 s69, s5
    s_mov_b32 s70, 0x240000
    s_mov_b32 s71, 0x20000
    v_bfe_u32 v43, v1, 2, 3
    s_lshl_b32 s93, s89, 3
    v_add_u32 v43, s93, v43
    v_bfe_u32 v40, v43, 4, 1
    v_and_b32 v41, 3, v1
    v_lshl_add_u32 v40, v40, 2, v41
    v_lshlrev_b32 v40, 2, v40
    v_lshrrev_b32 v41, 5, v43
    v_lshlrev_b32 v41, 4, v41
    v_and_b32 v42, 15, v43
    v_add_u32 v41, v41, v42
W_78:
    s_sleep 1
    ds_read_b32 v8, v4 offset:196
    s_sub_u32 s39, s39, 1
    s_cbranch_scc1 KS_ABORT
    s_waitcnt lgkmcnt(0)
    v_cmp_eq_u32 vcc, 0, v8
    s_cbranch_vccnz W_78
    s_sleep 8
    s_setprio 2
    s_branch ZPE_80
ZP_79:
    s_sleep 4
ZPE_80:
    buffer_load_dword v8, v33, s[76:79], s92 offen offset:0 sc1
    buffer_load_dword v9, v33, s[76:79], s92 offen offset:1024 sc1
    buffer_load_dword v10, v33, s[76:79], s92 offen offset:2048 sc1
    buffer_load_dword v11, v33, s[76:79], s92 offen offset:3072 sc1
    s_sub_u32 s39, s39, 1
    s_cbranch_scc1 KS_ABORT
    s_waitcnt vmcnt(0)
    v_max3_u32 v44, v8, v9, v10
    v_max_u32 v44, v44, v11
    v_cmp_eq_u32 vcc, -1, v44
    s_cbranch_vccnz ZP_79
    ds_write_b32 v4, v5 offset:28
    s_setprio 0
W_81:
    s_sleep 1
    ds_read_b32 v12, v7 offset:768
    s_sub_u32 s39, s39, 1
    s_cbranch_scc1 KS_ABORT
    s_waitcnt lgkmcnt(0)
    v_cmp_eq_u32 vcc, 0, v12
    s_cbranch_vccnz W_81
    ds_read_b32 v19, v40 offset:768
    s_waitcnt lgkmcnt(0)
    v_and_b32 v14, 0x7ff, v19
    v_sub_u32 v14, 2047, v14
    v_mul_u32_u24 v23, 1152, v14
    v_lshl_add_u32 v23, v41, 1, v23
    buffer_load_ushort v20, v23, s[72:75], 0 offen sc1
    buffer_load_ushort v17, v23, s[68:71], 0 offen
    v_lshrrev_b32 v15, 9, v14
    v_bfe_u32 v16, v14, 6, 2
    v_lshl_add_u32 v15, v15, 2, v16
    v_bfe_u32 v16, v14, 2, 2
    v_lshl_add_u32 v15, v15, 2, v16
    v_bfe_u32 v16, v14, 8, 1
    v_bfe_u32 v24, v14, 4, 1
    v_and_b32 v25, 3, v14
    v_lshl_add_u32 v24, v24, 2, v25
    v_lshlrev_b32 v24, 1, v24
    v_bfe_u32 v25, v14, 5, 1
    v_lshl_add_u32 v24, v25, 5, v24
    v_lshl_add_u32 v25, v15, 1, v16
    v_lshl_add_u32 v25, v25, 14, v24
    v_lshrrev_b32 v26, 1, v41
    v_lshl_add_u32 v25, v26, 6, v25
    v_and_b32 v26, 1, v41
    v_lshl_add_u32 v25, v26, 4, v25
    v_lshl_add_u32 v26, v15, 12, v24
    v_lshl_add_u32 v26, v16, 4, v26
    v_lshl_add_u32 v26, v41, 6, v26
    v_add_u32 v26, 2064384, v26
    v_cmp_gt_u32 vcc, 0x200, v41
    s_nop 1
    v_cndmask_b32 v25, v26, v25, vcc
    buffer_load_ushort v18, v25, s[64:67], 0 offen sc1
    s_add_u32 s72, s36, 0xb10000
    s_addc_u32 s73, s37, 0
    s_mov_b32 s74, 0x40
    s_mov_b32 s75, 0x20000
    v_ashrrev_i32 v22, 31, v19
    v_not_b32 v22, v22
    v_or_b32 v22, 0x80000000, v22
    v_xor_b32 v22, v19, v22
    v_and_b32 v22, 0xffff0000, v22
    v_mul_f32 v22, 0xbfb8aa3b, v22
    v_exp_f32 v22, v22
    s_nop 0
    v_add_f32 v22, 1.0, v22
    v_rcp_f32 v22, v22
    s_nop 0
    v_cvt_pk_bf16_f32 v22, v22, v22
    v_lshlrev_b32 v22, 16, v22
    v_and_b32 v14, 31, v1
    v_lshlrev_b32 v14, 4, v14
    s_waitcnt vmcnt(0)
    v_lshlrev_b32 v17, 16, v17
    v_lshlrev_b32 v18, 16, v18
    v_add_f32 v17, v17, v18
    v_cvt_pk_bf16_f32 v17, v17, v17
    v_and_b32 v21, 0xffff0000, v17
    v_lshlrev_b32 v20, 16, v20
    ds_write_b128 v14, v[20:23] offset:1536
    s_cmp_lg_u32 s2, 0
    s_cbranch_scc1 KS_W9E
    buffer_store_dword v12, v7, s[72:75], 0 offen
KS_W9E:
    s_waitcnt lgkmcnt(0)
    s_endpgm
KS_B:
    s_add_u32 s64, s36, 0x850000
    s_addc_u32 s65, s37, 0
    s_mov_b32 s66, 0x288000
    s_mov_b32 s67, 0x20000
    v_bfe_u32 v16, v1, 2, 2
    v_lshl_add_u32 v16, v3, 3, v16
    v_mul_u32_u24 v16, 1152, v16
    v_and_b32 v17, 3, v1
    v_lshl_add_u32 v16, v17, 3, v16
    s_lshl_b32 s92, s38, 7
    s_add_u32 s92, s92, 108800
    v_add_u32 v16, s92, v16
W_82:
    ds_read_b32 v17, v4 offset:40
    s_sub_u32 s39, s39, 1
    s_cbranch_scc1 KS_ABORT
    s_waitcnt lgkmcnt(0)
    v_cmp_ne_u32 vcc, s84, v17
    s_cbranch_vccnz W_82
    ds_read_b64_tr_b16 v[48:49], v16 offset:0
    ds_read_b64_tr_b16 v[50:51], v16 offset:4608
    ds_read_b64_tr_b16 v[52:53], v16 offset:32
    ds_read_b64_tr_b16 v[54:55], v16 offset:4640
    ds_read_b64_tr_b16 v[56:57], v16 offset:64
    ds_read_b64_tr_b16 v[58:59], v16 offset:4672
    ds_read_b64_tr_b16 v[60:61], v16 offset:96
    ds_read_b64_tr_b16 v[62:63], v16 offset:4704
    v_and_b32 v16, 7, v2
    v_lshlrev_b32 v16, 6, v16
    v_lshl_add_u32 v16, v3, 4, v16
    s_mul_i32 s92, s89, 18432
    s_lshl_b32 s93, s38, 11
    s_add_u32 s92, s92, s93
    v_lshlrev_b32 v17, 4, v1
    s_waitcnt lgkmcnt(0)
    s_barrier
    s_barrier
    ds_read_b128 v[20:23], v16 offset:1024
    s_waitcnt lgkmcnt(0)
    v_mfma_f32_16x16x32_bf16 v[32:35], v[20:23], v[48:51], 0
    v_mfma_f32_16x16x32_bf16 v[36:39], v[20:23], v[52:55], 0
    v_mfma_f32_16x16x32_bf16 v[40:43], v[20:23], v[56:59], 0
    v_mfma_f32_16x16x32_bf16 v[44:47], v[20:23], v[60:63], 0
    s_nop 5
    v_permlane32_swap_b32 v32, v36
    v_permlane32_swap_b32 v33, v37
    v_permlane32_swap_b32 v34, v38
    v_permlane32_swap_b32 v35, v39
    v_min_u32 v32, -2, v32
    v_min_u32 v33, -2, v33
    v_min_u32 v34, -2, v34
    v_min_u32 v35, -2, v35
    buffer_store_dwordx4 v[32:35], v17, s[64:67], s92 offen offset:0 sc1
    v_permlane32_swap_b32 v40, v44
    v_permlane32_swap_b32 v41, v45
    v_permlane32_swap_b32 v42, v46
    v_permlane32_swap_b32 v43, v47
    v_min_u32 v40, -2, v40
    v_min_u32 v41, -2, v41
    v_min_u32 v42, -2, v42
    v_min_u32 v43, -2, v43
    buffer_store_dwordx4 v[40:43], v17, s[64:67], s92 offen offset:1024 sc1
    s_waitcnt vmcnt(0)
    s_barrier
    s_endpgm
KS_G:
    s_mov_b32 s98, 0x05040100
    s_mov_b32 s99, 0x07060302
    s_waitcnt vmcnt(0)
    s_sub_u32 s87, s38, 12
    s_mul_i32 s92, s87, 9
    s_add_u32 s92, s92, 1
    s_lshr_b32 s86, s92, 1
    s_lshl_b32 s92, s86, 5
    v_lshl_add_u32 v7, v3, 3, s92
    v_mul_u32_u24 v7, 9216, v7
    v_and_b32 v6, 7, v2
    v_lshl_add_u32 v7, v6, 3, v7
    s_lshl_b32 s92, s89, 6
    v_add_u32 v7, s92, v7
    v_cmp_gt_u32 vcc, 8, v2
    s_mov_b32 s76, 9216
    s_mov_b32 s77, 0
    s_mov_b32 s78, 230400
    s_mov_b32 s79, 0
    v_mov_b32 v46, s26
    v_mov_b32 v47, s27
    v_mov_b32 v6, s28
    v_cndmask_b32 v46, v6, v46, vcc
    v_mov_b32 v6, s29
    v_cndmask_b32 v47, v6, v47, vcc
    v_add_co_u32 v46, vcc, v46, v7
    s_nop 1
    v_addc_co_u32 v47, vcc, 0, v47, vcc
W_83:
    s_sleep 2
    ds_read_b32 v10, v4 offset:16
    s_sub_u32 s39, s39, 1
    s_cbranch_scc1 KS_ABORT
    s_waitcnt lgkmcnt(0)
    v_cmp_ne_u32 vcc, s84, v10
    s_cbranch_vccnz W_83
    global_load_dwordx2 v[48:49], v[46:47], off
    v_lshl_add_u64 v[46:47], v[46:47], 0, s[76:77]
    global_load_dwordx2 v[50:51], v[46:47], off
    v_lshl_add_u64 v[46:47], v[46:47], 0, s[76:77]
    global_load_dwordx2 v[52:53], v[46:47], off
    v_lshl_add_u64 v[46:47], v[46:47], 0, s[76:77]
    global_load_dwordx2 v[54:55], v[46:47], off
    v_lshl_add_u64 v[46:47], v[46:47], 0, s[76:77]
    global_load_dwordx2 v[56:57], v[46:47], off
    v_lshl_add_u64 v[46:47], v[46:47], 0, s[76:77]
    global_load_dwordx2 v[58:59], v[46:47], off
    v_lshl_add_u64 v[46:47], v[46:47], 0, s[76:77]
    global_load_dwordx2 v[60:61], v[46:47], off
    v_lshl_add_u64 v[46:47], v[46:47], 0, s[76:77]
    global_load_dwordx2 v[62:63], v[46:47], off
    v_lshl_add_u64 v[46:47], v[46:47], 0, s[78:79]
    global_load_dwordx2 v[64:65], v[46:47], off
    v_lshl_add_u64 v[46:47], v[46:47], 0, s[76:77]
    global_load_dwordx2 v[66:67], v[46:47], off
    v_lshl_add_u64 v[46:47], v[46:47], 0, s[76:77]
    global_load_dwordx2 v[68:69], v[46:47], off
    v_lshl_add_u64 v[46:47], v[46:47], 0, s[76:77]
    global_load_dwordx2 v[70:71], v[46:47], off
    v_lshl_add_u64 v[46:47], v[46:47], 0, s[76:77]
    global_load_dwordx2 v[72:73], v[46:47], off
    v_lshl_add_u64 v[46:47], v[46:47], 0, s[76:77]
    global_load_dwordx2 v[74:75], v[46:47], off
    v_lshl_add_u64 v[46:47], v[46:47], 0, s[76:77]
    global_load_dwordx2 v[76:77], v[46:47], off
    v_lshl_add_u64 v[46:47], v[46:47], 0, s[76:77]
    global_load_dwordx2 v[78:79], v[46:47], off
    v_lshl_add_u64 v[46:47], v[46:47], 0, s[78:79]
    global_load_dwordx2 v[80:81], v[46:47], off
    v_lshl_add_u64 v[46:47], v[46:47], 0, s[76:77]
    global_load_dwordx2 v[82:83], v[46:47], off
    v_lshl_add_u64 v[46:47], v[46:47], 0, s[76:77]
    global_load_dwordx2 v[84:85], v[46:47], off
    v_lshl_add_u64 v[46:47], v[46:47], 0, s[76:77]
    global_load_dwordx2 v[86:87], v[46:47], off
    v_lshl_add_u64 v[46:47], v[46:47], 0, s[76:77]
    global_load_dwordx2 v[88:89], v[46:47], off
    v_lshl_add_u64 v[46:47], v[46:47], 0, s[76:77]
    global_load_dwordx2 v[90:91], v[46:47], off
    v_lshl_add_u64 v[46:47], v[46:47], 0, s[76:77]
    global_load_dwordx2 v[92:93], v[46:47], off
    v_lshl_add_u64 v[46:47], v[46:47], 0, s[76:77]
    global_load_dwordx2 v[94:95], v[46:47], off
    v_lshl_add_u64 v[46:47], v[46:47], 0, s[78:79]
    global_load_dwordx2 v[96:97], v[46:47], off
    v_lshl_add_u64 v[46:47], v[46:47], 0, s[76:77]
    global_load_dwordx2 v[98:99], v[46:47], off
    v_lshl_add_u64 v[46:47], v[46:47], 0, s[76:77]
    global_load_dwordx2 v[100:101], v[46:47], off
    v_lshl_add_u64 v[46:47], v[46:47], 0, s[76:77]
    global_load_dwordx2 v[102:103], v[46:47], off
    v_lshl_add_u64 v[46:47], v[46:47], 0, s[76:77]
    global_load_dwordx2 v[104:105], v[46:47], off
    v_lshl_add_u64 v[46:47], v[46:47], 0, s[76:77]
    global_load_dwordx2 v[106:107], v[46:47], off
    v_lshl_add_u64 v[46:47], v[46:47], 0, s[76:77]
    global_load_dwordx2 v[108:109], v[46:47], off
    v_lshl_add_u64 v[46:47], v[46:47], 0, s[76:77]
    global_load_dwordx2 v[110:111], v[46:47], off
    v_lshl_add_u64 v[46:47], v[46:47], 0, s[78:79]
    s_bitcmp1_b32 s87, 0
    s_cbranch_scc1 KS_G4
    global_load_dwordx2 v[112:113], v[46:47], off
    v_lshl_add_u64 v[46:47], v[46:47], 0, s[76:77]
    global_load_dwordx2 v[114:115], v[46:47], off
    v_lshl_add_u64 v[46:47], v[46:47], 0, s[76:77]
    global_load_dwordx2 v[116:117], v[46:47], off
    v_lshl_add_u64 v[46:47], v[46:47], 0, s[76:77]
    global_load_dwordx2 v[118:119], v[46:47], off
    v_lshl_add_u64 v[46:47], v[46:47], 0, s[76:77]
    global_load_dwordx2 v[120:121], v[46:47], off
    v_lshl_add_u64 v[46:47], v[46:47], 0, s[76:77]
    global_load_dwordx2 v[122:123], v[46:47], off
    v_lshl_add_u64 v[46:47], v[46:47], 0, s[76:77]
    global_load_dwordx2 v[124:125], v[46:47], off
    v_lshl_add_u64 v[46:47], v[46:47], 0, s[76:77]
    global_load_dwordx2 v[126:127], v[46:47], off
KS_G4:
    v_mov_b32 v6, s87
    ds_write_b8 v6, v5 offset:192
    s_waitcnt vmcnt(0)
    v_perm_b32 v32, v50, v48, s98
    v_perm_b32 v33, v54, v52, s98
    v_perm_b32 v34, v58, v56, s98
    v_perm_b32 v35, v62, v60, s98
    v_perm_b32 v36, v50, v48, s99
    v_perm_b32 v37, v54, v52, s99
    v_perm_b32 v38, v58, v56, s99
    v_perm_b32 v39, v62, v60, s99
    v_perm_b32 v40, v51, v49, s98
    v_perm_b32 v41, v55, v53, s98
    v_perm_b32 v42, v59, v57, s98
    v_perm_b32 v43, v63, v61, s98
    v_perm_b32 v44, v51, v49, s99
    v_perm_b32 v45, v55, v53, s99
    v_perm_b32 v46, v59, v57, s99
    v_perm_b32 v47, v63, v61, s99
    v_perm_b32 v48, v66, v64, s98
    v_perm_b32 v49, v70, v68, s98
    v_perm_b32 v50, v74, v72, s98
    v_perm_b32 v51, v78, v76, s98
    v_perm_b32 v52, v66, v64, s99
    v_perm_b32 v53, v70, v68, s99
    v_perm_b32 v54, v74, v72, s99
    v_perm_b32 v55, v78, v76, s99
    v_perm_b32 v56, v67, v65, s98
    v_perm_b32 v57, v71, v69, s98
    v_perm_b32 v58, v75, v73, s98
    v_perm_b32 v59, v79, v77, s98
    v_perm_b32 v60, v67, v65, s99
    v_perm_b32 v61, v71, v69, s99
    v_perm_b32 v62, v75, v73, s99
    v_perm_b32 v63, v79, v77, s99
    v_perm_b32 v64, v82, v80, s98
    v_perm_b32 v65, v86, v84, s98
    v_perm_b32 v66, v90, v88, s98
    v_perm_b32 v67, v94, v92, s98
    v_perm_b32 v68, v82, v80, s99
    v_perm_b32 v69, v86, v84, s99
    v_perm_b32 v70, v90, v88, s99
    v_perm_b32 v71, v94, v92, s99
    v_perm_b32 v72, v83, v81, s98
    v_perm_b32 v73, v87, v85, s98
    v_perm_b32 v74, v91, v89, s98
    v_perm_b32 v75, v95, v93, s98
    v_perm_b32 v76, v83, v81, s99
    v_perm_b32 v77, v87, v85, s99
    v_perm_b32 v78, v91, v89, s99
    v_perm_b32 v79, v95, v93, s99
    v_perm_b32 v80, v98, v96, s98
    v_perm_b32 v81, v102, v100, s98
    v_perm_b32 v82, v106, v104, s98
    v_perm_b32 v83, v110, v108, s98
    v_perm_b32 v84, v98, v96, s99
    v_perm_b32 v85, v102, v100, s99
    v_perm_b32 v86, v106, v104, s99
    v_perm_b32 v87, v110, v108, s99
    v_perm_b32 v88, v99, v97, s98
    v_perm_b32 v89, v103, v101, s98
    v_perm_b32 v90, v107, v105, s98
    v_perm_b32 v91, v111, v109, s98
    v_perm_b32 v92, v99, v97, s99
    v_perm_b32 v93, v103, v101, s99
    v_perm_b32 v94, v107, v105, s99
    v_perm_b32 v95, v111, v109, s99
    v_perm_b32 v96, v114, v112, s98
    v_perm_b32 v97, v118, v116, s98
    v_perm_b32 v98, v122, v120, s98
    v_perm_b32 v99, v126, v124, s98
    v_perm_b32 v100, v114, v112, s99
    v_perm_b32 v101, v118, v116, s99
    v_perm_b32 v102, v122, v120, s99
    v_perm_b32 v103, v126, v124, s99
    v_perm_b32 v104, v115, v113, s98
    v_perm_b32 v105, v119, v117, s98
    v_perm_b32 v106, v123, v121, s98
    v_perm_b32 v107, v127, v125, s98
    v_perm_b32 v108, v115, v113, s99
    v_perm_b32 v109, v119, v117, s99
    v_perm_b32 v110, v123, v121, s99
    v_perm_b32 v111, v127, v125, s99
    s_lshl_b32 s92, s86, 9
    s_add_u32 s92, s92, 16896
    v_and_b32 v6, 7, v2
    v_lshl_add_u32 v7, v6, 4, s92
    v_lshl_add_u32 v7, v3, 7, v7
    s_lshl_b32 s92, s87, 6
    v_add_u32 v11, s92, v1
    v_lshrrev_b32 v8, 5, v11
    v_and_b32 v9, 31, v11
    v_and_b32 v10, 3, v9
    v_lshlrev_b32 v10, 9, v10
    v_lshrrev_b32 v9, 2, v9
    v_lshl_add_u32 v10, v9, 4, v10
    v_lshrrev_b32 v9, 2, v8
    v_lshl_add_u32 v10, v9, 8, v10
    v_and_b32 v9, 3, v8
    v_lshl_add_u32 v10, v9, 2, v10
    v_lshlrev_b32 v11, 1, v11
    s_lshl_b32 s92, s87, 11
    v_lshl_add_u32 v9, v1, 4, s92
W_84:
    s_sleep 2
    ds_read_b32 v12, v4 offset:768
    s_sub_u32 s39, s39, 1
    s_cbranch_scc1 KS_ABORT
    s_waitcnt lgkmcnt(0)
    v_cmp_eq_u32 vcc, 0, v12
    s_cbranch_vccnz W_84
    s_setprio 2
W_85:
    ds_read_b32 v12, v4 offset:32
    s_sub_u32 s39, s39, 1
    s_cbranch_scc1 KS_ABORT
    s_waitcnt lgkmcnt(0)
    v_cmp_eq_u32 vcc, 0, v12
    s_cbranch_vccnz W_85
    ds_read_b128 v[12:15], v7 offset:0
    ds_read_b128 v[16:19], v7 offset:512
    ds_read_b128 v[20:23], v7 offset:1024
    ds_read_b128 v[24:27], v7 offset:1536
    ds_read_b128 v[28:31], v7 offset:2048
    s_waitcnt lgkmcnt(4)
    v_mfma_f32_16x16x32_bf16 v[112:115], v[12:15], v[32:35], 0
    v_mfma_f32_16x16x32_bf16 v[116:119], v[12:15], v[36:39], 0
    v_mfma_f32_16x16x32_bf16 v[120:123], v[12:15], v[40:43], 0
    v_mfma_f32_16x16x32_bf16 v[124:127], v[12:15], v[44:47], 0
    s_waitcnt lgkmcnt(3)
    v_mfma_f32_16x16x32_bf16 v[112:115], v[16:19], v[48:51], v[112:115]
    v_mfma_f32_16x16x32_bf16 v[116:119], v[16:19], v[52:55], v[116:119]
    v_mfma_f32_16x16x32_bf16 v[120:123], v[16:19], v[56:59], v[120:123]
    v_mfma_f32_16x16x32_bf16 v[124:127], v[16:19], v[60:63], v[124:127]
    s_waitcnt lgkmcnt(2)
    v_mfma_f32_16x16x32_bf16 v[112:115], v[20:23], v[64:67], v[112:115]
    v_mfma_f32_16x16x32_bf16 v[116:119], v[20:23], v[68:71], v[116:119]
    v_mfma_f32_16x16x32_bf16 v[120:123], v[20:23], v[72:75], v[120:123]
    v_mfma_f32_16x16x32_bf16 v[124:127], v[20:23], v[76:79], v[124:127]
    s_waitcnt lgkmcnt(1)
    v_mfma_f32_16x16x32_bf16 v[112:115], v[24:27], v[80:83], v[112:115]
    v_mfma_f32_16x16x32_bf16 v[116:119], v[24:27], v[84:87], v[116:119]
    v_mfma_f32_16x16x32_bf16 v[120:123], v[24:27], v[88:91], v[120:123]
    v_mfma_f32_16x16x32_bf16 v[124:127], v[24:27], v[92:95], v[124:127]
    s_bitcmp1_b32 s87, 0
    s_cbranch_scc1 KS_G5
    s_waitcnt lgkmcnt(0)
    v_mfma_f32_16x16x32_bf16 v[112:115], v[28:31], v[96:99], v[112:115]
    v_mfma_f32_16x16x32_bf16 v[116:119], v[28:31], v[100:103], v[116:119]
    v_mfma_f32_16x16x32_bf16 v[120:123], v[28:31], v[104:107], v[120:123]
    v_mfma_f32_16x16x32_bf16 v[124:127], v[28:31], v[108:111], v[124:127]
KS_G5:
    s_mov_b32 exec_lo, -1
    s_mov_b32 exec_hi, 0
    s_nop 5
    ds_write_b128 v9, v[112:115] offset:26176
    ds_write_b128 v9, v[116:119] offset:26688
    ds_write_b128 v9, v[120:123] offset:27200
    ds_write_b128 v9, v[124:127] offset:27712
    s_mov_b64 exec, -1
    s_waitcnt lgkmcnt(0)
    s_barrier
    ds_read_b32 v32, v10 offset:26176
    ds_read_b32 v33, v10 offset:26304
    ds_read_b32 v34, v10 offset:28224
    ds_read_b32 v35, v10 offset:28352
    ds_read_b32 v36, v10 offset:30272
    ds_read_b32 v37, v10 offset:30400
    ds_read_b32 v38, v10 offset:32320
    ds_read_b32 v39, v10 offset:32448
    s_waitcnt lgkmcnt(4)
    v_pk_add_f32 v[32:33], v[32:33], v[34:35]
    s_waitcnt lgkmcnt(0)
    v_pk_add_f32 v[36:37], v[36:37], v[38:39]
    v_pk_add_f32 v[32:33], v[32:33], v[36:37]
    v_cvt_pk_bf16_f32 v34, v32, v33
    v_lshlrev_b32 v32, 16, v34
    v_and_b32 v33, 0xffff0000, v34
    v_mul_f32 v34, 0xbfb8aa3b, v32
    v_exp_f32 v34, v34
    s_nop 0
    v_add_f32 v34, 1.0, v34
    v_rcp_f32 v34, v34
    s_nop 0
    v_mul_f32 v34, v32, v34
    v_cvt_pk_bf16_f32 v34, v34, v34
    v_lshlrev_b32 v34, 16, v34
    v_mul_f32 v34, v34, v33
    v_cvt_pk_bf16_f32 v34, v34, v34
    ds_write_b16 v11, v34 offset:1024
    s_waitcnt lgkmcnt(0)
    s_barrier
    s_branch KS_P2
KS_P:
    s_waitcnt lgkmcnt(0)
    s_barrier
    s_barrier
    s_setprio 2
KS_P2:
    s_sub_u32 s87, s38, 10
    s_add_u32 s64, s36, 0x850000
    s_addc_u32 s65, s37, 0
    s_mov_b32 s66, 0x288000
    s_mov_b32 s67, 0x20000
    s_mov_b32 s68, s32
    s_mov_b32 s69, s33
    s_mov_b32 s70, 0x240000
    s_mov_b32 s71, 0x20000
    v_lshrrev_b32 v8, 3, v1
    v_mul_u32_u24 v8, 18432, v8
    v_and_b32 v9, 7, v1
    v_lshl_add_u32 v8, v9, 4, v8
    s_mul_i32 s92, s87, 442368
    s_lshl_b32 s93, s89, 7
    s_add_u32 s92, s92, s93
    s_add_u32 s93, s92, 147456
    s_add_u32 s94, s92, 294912
    s_lshl_b32 s95, s87, 7
    v_lshl_add_u32 v6, v9, 4, s95
    v_lshl_add_u32 v6, v3, 2, v6
    v_lshlrev_b32 v12, 2, v1
    v_add_u32 v12, 2048, v12
    v_lshlrev_b32 v13, 4, v1
    s_barrier
    s_branch ZPE_87
ZP_86:
    s_sleep 1
ZPE_87:
    buffer_load_dwordx4 v[32:35], v8, s[64:67], s92 offen sc1
    buffer_load_dwordx4 v[36:39], v8, s[64:67], s93 offen sc1
    buffer_load_dwordx4 v[40:43], v8, s[64:67], s94 offen sc1
    s_sub_u32 s39, s39, 1
    s_cbranch_scc1 KS_ABORT
    s_waitcnt vmcnt(0)
    v_max3_u32 v44, v32, v33, v34
    v_max3_u32 v44, v44, v35, v36
    v_max3_u32 v44, v44, v37, v38
    v_max3_u32 v44, v44, v39, v40
    v_max3_u32 v44, v44, v41, v42
    v_max_u32 v44, v44, v43
    v_cmp_eq_u32 vcc, -1, v44
    s_cbranch_vccnz ZP_86
    v_pk_add_f32 v[32:33], v[32:33], v[36:37]
    v_pk_add_f32 v[34:35], v[34:35], v[38:39]
    v_pk_add_f32 v[32:33], v[32:33], v[40:41]
    v_pk_add_f32 v[34:35], v[34:35], v[42:43]
    s_nop 0
    v_add_f32_dpp v32, v32, v32 row_ror:8 row_mask:0xf bank_mask:0xf
    v_add_f32_dpp v33, v33, v33 row_ror:8 row_mask:0xf bank_mask:0xf
    v_add_f32_dpp v34, v34, v34 row_ror:8 row_mask:0xf bank_mask:0xf
    v_add_f32_dpp v35, v35, v35 row_ror:8 row_mask:0xf bank_mask:0xf
    v_permlane16_swap_b32 v32, v33
    s_nop 0
    v_permlane16_swap_b32 v34, v35
    v_add_f32 v32, v32, v33
    v_add_f32 v34, v34, v35
    s_nop 1
    v_permlane32_swap_b32 v32, v34
    v_add_f32 v32, v32, v34
    ds_write_b32 v6, v32 offset:2048
    s_waitcnt lgkmcnt(0)
    s_barrier
    s_cmp_lg_u32 s87, 0
    s_cbranch_scc1 KS_PEND
    s_mov_b32 exec_lo, -1
    s_mov_b32 exec_hi, 0
    ds_read2_b32 v[32:33], v12 offset0:0 offset1:32
    ds_read2_b32 v[34:35], v12 offset0:64 offset1:96
    ds_read2_b32 v[36:37], v12 offset0:128 offset1:160
    ds_read_b128 v[40:43], v13 offset:1536
    s_waitcnt lgkmcnt(0)
    v_pk_add_f32 v[32:33], v[32:33], v[34:35]
    v_pk_add_f32 v[32:33], v[32:33], v[36:37]
    v_add_f32 v8, v32, v33
    v_cvt_pk_bf16_f32 v8, v8, v8
    v_lshlrev_b32 v8, 16, v8
    v_mul_f32 v8, v8, v42
    v_cvt_pk_bf16_f32 v8, v8, v8
    v_lshlrev_b32 v8, 16, v8
    v_add_f32 v8, v8, v40
    v_cvt_pk_bf16_f32 v8, v8, v8
    v_lshlrev_b32 v8, 16, v8
    v_add_f32 v8, v8, v41
    v_cvt_pk_bf16_f32 v8, v8, v8
    buffer_store_short v8, v43, s[68:71], 0 offen
KS_PEND:
KS_ABORT:
KS_END:
    s_endpgm
.section .rodata,"a"
.p2align 6
.amdhsa_kernel sequential_preLN__ssm_conv_s4__moe_arch_mod__prompt_kernel
  .amdhsa_next_free_vgpr 128
  .amdhsa_next_free_sgpr 100
  .amdhsa_accum_offset 128
  .amdhsa_group_segment_fixed_size 0
  .amdhsa_kernarg_size 136
  .amdhsa_user_sgpr_count 2
  .amdhsa_user_sgpr_kernarg_segment_ptr 1
  .amdhsa_system_sgpr_workgroup_id_x 1
  .amdhsa_float_denorm_mode_32 3
.end_amdhsa_kernel
```

```asm
; @launch grid=(256,1,1) block=(1024,1,1) lds=146048
.amdgcn_target "amdgcn-amd-amdhsa--gfx950"
.text
.globl sequential_preLN__ssm_conv_s4__moe_arch_mod__prompt_kernel
.p2align 8
.type sequential_preLN__ssm_conv_s4__moe_arch_mod__prompt_kernel,@function
sequential_preLN__ssm_conv_s4__moe_arch_mod__prompt_kernel:
    s_cmp_ge_u32 s2, 256
    s_cbranch_scc1 KS_END
    s_load_dwordx16 s[4:19], s[0:1], 0
    s_load_dwordx16 s[20:35], s[0:1], 64
    s_load_dwordx2 s[36:37], s[0:1], 128
    v_readfirstlane_b32 s38, v0
    s_lshr_b32 s38, s38, 6
    s_and_b32 s40, s2, 7
    s_lshr_b32 s41, s2, 3
    s_add_u32 s92, s38, 8
    s_sub_u32 s93, s38, 4
    s_cmp_lt_u32 s38, 8
    s_cselect_b32 s92, s92, s93
    s_cmp_lt_u32 s38, 4
    s_cselect_b32 s38, s38, s92
    v_and_b32 v1, 63, v0
    v_and_b32 v2, 15, v1
    v_lshrrev_b32 v3, 4, v1
    v_mov_b32 v4, 0
    v_mov_b32 v5, 1
    s_mov_b32 s39, 524288
    s_mov_b32 s84, 0x01010101
    s_lshl_b32 s90, s40, 5
    s_add_u32 s90, s90, s41
    s_mul_i32 s89, s40, 18
    s_add_u32 s89, s89, s41
    s_cmp_lt_u32 s38, 4
    s_cbranch_scc1 KS_L
    s_cmp_ge_u32 s38, 12
    s_cbranch_scc1 KS_X
    s_setprio 2
    s_lshr_b32 s87, s38, 2
    s_sub_u32 s87, s87, 1
    s_mul_i32 s86, s87, 3
    s_xor_b32 s86, s86, s38
    s_and_b32 s86, s86, 3
    s_lshl_b32 s88, s90, 1
    s_add_u32 s88, s88, s87
KS_GRP:
    s_mul_i32 s85, s87, 36672
    s_add_u32 s85, s85, 35840
    s_lshl_b32 s92, s88, 8
    v_lshl_add_u32 v6, v1, 2, s92
    s_lshl_b32 s92, s88, 1
    v_mov_b32 v7, s92
    s_lshl_b32 s92, s87, 4
    s_add_u32 s92, s92, s86
    v_mov_b32 v15, s92
    s_lshl_b32 s92, s87, 4
    v_mov_b32 v14, s92
    s_waitcnt lgkmcnt(0)
    global_load_ushort v16, v7, s[18:19]
    global_load_dword v8, v6, s[6:7]
    global_load_dword v9, v6, s[8:9]
    global_load_dword v10, v6, s[10:11]
    global_load_dword v11, v6, s[12:13]
    global_load_dword v12, v6, s[14:15]
    global_load_dword v13, v6, s[16:17]
    global_load_ushort v107, v7, s[20:21]
    s_barrier
    s_add_u32 s93, s85, 31232
    s_lshl_b32 s92, s86, 6
    s_add_u32 s92, s92, 9
    v_add_u32 v94, s92, v1
    v_lshl_add_u32 v123, v94, 2, s85
    v_lshlrev_b32 v94, 1, v94
    v_sub_u32 v90, 544, v94
    v_cvt_f32_i32 v91, v90
    v_cvt_pk_bf16_f32 v91, v91, v91
    v_and_b32 v91, 0xffff, v91
    v_subrev_u32 v91, 0x4280, v91
    v_cmp_gt_u32 vcc, 0x100, v90
    s_nop 1
    v_cndmask_b32 v91, v91, v90, vcc
    v_mov_b32 v92, 641
    v_cmp_lt_u32 vcc, 0x20d, v90
    s_nop 1
    v_cndmask_b32 v91, v91, v92, vcc
    v_lshl_add_u32 v116, v91, 1, s93
    v_add_u32 v94, 1, v94
    v_sub_u32 v90, 544, v94
    v_cvt_f32_i32 v91, v90
    v_cvt_pk_bf16_f32 v91, v91, v91
    v_and_b32 v91, 0xffff, v91
    v_subrev_u32 v91, 0x4280, v91
    v_cmp_gt_u32 vcc, 0x100, v90
    s_nop 1
    v_cndmask_b32 v91, v91, v90, vcc
    v_mov_b32 v92, 641
    v_cmp_lt_u32 vcc, 0x20d, v90
    s_nop 1
    v_cndmask_b32 v91, v91, v92, vcc
    v_lshl_add_u32 v117, v91, 1, s93
    v_add_u32 v94, 1, v94
    v_sub_u32 v90, 544, v94
    v_cvt_f32_i32 v91, v90
    v_cvt_pk_bf16_f32 v91, v91, v91
    v_and_b32 v91, 0xffff, v91
    v_subrev_u32 v91, 0x4280, v91
    v_cmp_gt_u32 vcc, 0x100, v90
    s_nop 1
    v_cndmask_b32 v91, v91, v90, vcc
    v_mov_b32 v92, 641
    v_cmp_lt_u32 vcc, 0x20d, v90
    s_nop 1
    v_cndmask_b32 v91, v91, v92, vcc
    v_lshl_add_u32 v118, v91, 1, s93
    v_lshlrev_b32 v7, 3, v2
    s_cmp_eq_u32 s86, 1
    s_cbranch_scc1 PRE_2
    s_cmp_eq_u32 s86, 2
    s_cbranch_scc1 PRE_3
    s_cmp_eq_u32 s86, 3
    s_cbranch_scc1 PRE_4
    v_lshlrev_b32 v95, 1, v1
    v_sub_u32 v94, 93, v95
    v_lshlrev_b32 v91, 1, v94
    v_add_u32 v91, 389, v91
    v_mov_b32 v92, 641
    v_cmp_lt_u32 vcc, 61, v94
    s_nop 1
    v_cndmask_b32 v91, v91, v92, vcc
    v_lshl_add_u32 v119, v91, 1, s93
    v_sub_u32 v94, 92, v95
    v_lshlrev_b32 v91, 1, v94
    v_add_u32 v91, 389, v91
    v_mov_b32 v92, 641
    v_cmp_lt_u32 vcc, 61, v94
    s_nop 1
    v_cndmask_b32 v91, v91, v92, vcc
    v_lshl_add_u32 v120, v91, 1, s93
    v_sub_u32 v94, 94, v95
    v_lshlrev_b32 v91, 1, v94
    v_add_u32 v91, 388, v91
    v_mov_b32 v92, 641
    v_cmp_lt_u32 vcc, 62, v94
    s_nop 1
    v_cndmask_b32 v91, v91, v92, vcc
    v_lshl_add_u32 v121, v91, 1, s93
    v_sub_u32 v94, 93, v95
    v_lshlrev_b32 v91, 1, v94
    v_add_u32 v91, 388, v91
    v_mov_b32 v92, 641
    v_cmp_lt_u32 vcc, 62, v94
    s_nop 1
    v_cndmask_b32 v91, v91, v92, vcc
    v_lshl_add_u32 v122, v91, 1, s93
    v_lshl_add_u32 v124, v1, 2, s85
    v_add_u32 v125, 35408, v124
    v_add_u32 v124, 35152, v124
    v_lshrrev_b32 v94, 1, v3
    v_lshl_add_u32 v7, v94, 7, v7
    v_and_b32 v94, 1, v3
    v_lshl_add_u32 v7, v94, 2, v7
    v_mov_b32 v94, 1
    v_mov_b32 v95, 2
    v_mov_b32 v96, v7
    v_add_u32 v97, v7, v94
    v_add_u32 v98, v7, v95
    v_add_u32 v99, v97, v95
    v_cvt_f32_u32 v108, v96
    v_lshrrev_b32 v91, 16, v108
    v_subrev_u32 v91, 0x4280, v91
    v_cmp_gt_u32 vcc, 0x80, v96
    s_nop 1
    v_cndmask_b32 v91, v91, v96, vcc
    v_mov_b32 v92, 642
    v_cmp_lt_u32 vcc, 0x800, v96
    s_nop 1
    v_cndmask_b32 v91, v91, v92, vcc
    v_lshl_add_u32 v112, v91, 1, s93
    v_cvt_f32_u32 v109, v97
    v_lshrrev_b32 v91, 16, v109
    v_subrev_u32 v91, 0x4280, v91
    v_cmp_gt_u32 vcc, 0x80, v97
    s_nop 1
    v_cndmask_b32 v91, v91, v97, vcc
    v_mov_b32 v92, 642
    v_cmp_lt_u32 vcc, 0x800, v97
    s_nop 1
    v_cndmask_b32 v91, v91, v92, vcc
    v_lshl_add_u32 v113, v91, 1, s93
    v_cvt_f32_u32 v110, v98
    v_lshrrev_b32 v91, 16, v110
    v_subrev_u32 v91, 0x4280, v91
    v_cmp_gt_u32 vcc, 0x80, v98
    s_nop 1
    v_cndmask_b32 v91, v91, v98, vcc
    v_mov_b32 v92, 642
    v_cmp_lt_u32 vcc, 0x800, v98
    s_nop 1
    v_cndmask_b32 v91, v91, v92, vcc
    v_lshl_add_u32 v114, v91, 1, s93
    v_cvt_f32_u32 v111, v99
    v_lshrrev_b32 v91, 16, v111
    v_subrev_u32 v91, 0x4280, v91
    v_cmp_gt_u32 vcc, 0x80, v99
    s_nop 1
    v_cndmask_b32 v91, v91, v99, vcc
    v_mov_b32 v92, 642
    v_cmp_lt_u32 vcc, 0x800, v99
    s_nop 1
    v_cndmask_b32 v91, v91, v92, vcc
    v_lshl_add_u32 v115, v91, 1, s93
    s_branch PREJ_5
PRE_2:
    v_min_u32 v96, 47, v1
    v_lshlrev_b32 v95, 1, v96
    v_sub_u32 v94, 64, v95
    v_lshlrev_b32 v91, 1, v94
    v_add_u32 v91, 513, v91
    v_mov_b32 v92, 641
    v_cmp_lt_u32 vcc, 63, v94
    s_nop 1
    v_cndmask_b32 v91, v91, v92, vcc
    v_lshl_add_u32 v119, v91, 1, s93
    v_sub_u32 v94, 63, v95
    v_lshlrev_b32 v91, 1, v94
    v_add_u32 v91, 513, v91
    v_mov_b32 v92, 641
    v_cmp_lt_u32 vcc, 63, v94
    s_nop 1
    v_cndmask_b32 v91, v91, v92, vcc
    v_lshl_add_u32 v120, v91, 1, s93
    v_sub_u32 v94, 62, v95
    v_lshlrev_b32 v91, 1, v94
    v_add_u32 v91, 513, v91
    v_mov_b32 v92, 641
    v_cmp_lt_u32 vcc, 63, v94
    s_nop 1
    v_cndmask_b32 v91, v91, v92, vcc
    v_lshl_add_u32 v122, v91, 1, s93
    v_mov_b32 v121, v120
    v_lshl_add_u32 v124, v96, 2, s85
    v_add_u32 v125, 35856, v124
    v_add_u32 v124, 35664, v124
    v_lshl_add_u32 v94, v3, 7, v7
    v_add_u32 v94, 256, v94
    v_lshl_add_u32 v7, v3, 8, v7
    v_cmp_gt_u32 vcc, 2, v3
    s_nop 1
    v_cndmask_b32 v7, v7, v94, vcc
    v_mov_b32 v94, 4
    v_mov_b32 v95, 0x80
    v_cndmask_b32 v94, v94, 2, vcc
    v_cndmask_b32 v95, v95, 4, vcc
    v_mov_b32 v96, v7
    v_add_u32 v97, v7, v94
    v_add_u32 v98, v7, v95
    v_add_u32 v99, v97, v95
    v_cvt_f32_u32 v108, v96
    v_lshrrev_b32 v91, 16, v108
    v_subrev_u32 v91, 0x4280, v91
    v_cmp_gt_u32 vcc, 0x80, v96
    s_nop 1
    v_cndmask_b32 v91, v91, v96, vcc
    v_mov_b32 v92, 642
    v_cmp_lt_u32 vcc, 0x800, v96
    s_nop 1
    v_cndmask_b32 v91, v91, v92, vcc
    v_lshl_add_u32 v112, v91, 1, s93
    v_cvt_f32_u32 v109, v97
    v_lshrrev_b32 v91, 16, v109
    v_subrev_u32 v91, 0x4280, v91
    v_cmp_gt_u32 vcc, 0x80, v97
    s_nop 1
    v_cndmask_b32 v91, v91, v97, vcc
    v_mov_b32 v92, 642
    v_cmp_lt_u32 vcc, 0x800, v97
    s_nop 1
    v_cndmask_b32 v91, v91, v92, vcc
    v_lshl_add_u32 v113, v91, 1, s93
    v_cvt_f32_u32 v110, v98
    v_lshrrev_b32 v91, 16, v110
    v_subrev_u32 v91, 0x4280, v91
    v_cmp_gt_u32 vcc, 0x80, v98
    s_nop 1
    v_cndmask_b32 v91, v91, v98, vcc
    v_mov_b32 v92, 642
    v_cmp_lt_u32 vcc, 0x800, v98
    s_nop 1
    v_cndmask_b32 v91, v91, v92, vcc
    v_lshl_add_u32 v114, v91, 1, s93
    v_cvt_f32_u32 v111, v99
    v_lshrrev_b32 v91, 16, v111
    v_subrev_u32 v91, 0x4280, v91
    v_cmp_gt_u32 vcc, 0x80, v99
    s_nop 1
    v_cndmask_b32 v91, v91, v99, vcc
    v_mov_b32 v92, 642
    v_cmp_lt_u32 vcc, 0x800, v99
    s_nop 1
    v_cndmask_b32 v91, v91, v92, vcc
    v_lshl_add_u32 v115, v91, 1, s93
    s_branch PREJ_5
PRE_3:
    v_min_u32 v96, 47, v1
    v_lshlrev_b32 v95, 1, v96
    v_sub_u32 v94, 64, v95
    v_lshlrev_b32 v91, 1, v94
    v_add_u32 v91, 514, v91
    v_mov_b32 v92, 641
    v_cmp_lt_u32 vcc, 63, v94
    s_nop 1
    v_cndmask_b32 v91, v91, v92, vcc
    v_lshl_add_u32 v119, v91, 1, s93
    v_sub_u32 v94, 63, v95
    v_lshlrev_b32 v91, 1, v94
    v_add_u32 v91, 514, v91
    v_mov_b32 v92, 641
    v_cmp_lt_u32 vcc, 63, v94
    s_nop 1
    v_cndmask_b32 v91, v91, v92, vcc
    v_lshl_add_u32 v120, v91, 1, s93
    v_sub_u32 v94, 62, v95
    v_lshlrev_b32 v91, 1, v94
    v_add_u32 v91, 514, v91
    v_mov_b32 v92, 641
    v_cmp_lt_u32 vcc, 63, v94
    s_nop 1
    v_cndmask_b32 v91, v91, v92, vcc
    v_lshl_add_u32 v122, v91, 1, s93
    v_mov_b32 v121, v120
    v_lshl_add_u32 v124, v96, 2, s85
    v_add_u32 v125, 36240, v124
    v_add_u32 v124, 36048, v124
    v_lshl_add_u32 v7, v3, 9, v7
    v_add_u32 v7, 0x400, v7
    v_mov_b32 v94, 0x80
    v_mov_b32 v95, 0x100
    v_mov_b32 v96, v7
    v_add_u32 v97, v7, v94
    v_add_u32 v98, v7, v95
    v_add_u32 v99, v97, v95
    v_cvt_f32_u32 v108, v96
    v_lshrrev_b32 v91, 16, v108
    v_subrev_u32 v91, 0x4280, v91
    v_cmp_gt_u32 vcc, 0x80, v96
    s_nop 1
    v_cndmask_b32 v91, v91, v96, vcc
    v_mov_b32 v92, 642
    v_cmp_lt_u32 vcc, 0x800, v96
    s_nop 1
    v_cndmask_b32 v91, v91, v92, vcc
    v_lshl_add_u32 v112, v91, 1, s93
    v_cvt_f32_u32 v109, v97
    v_lshrrev_b32 v91, 16, v109
    v_subrev_u32 v91, 0x4280, v91
    v_cmp_gt_u32 vcc, 0x80, v97
    s_nop 1
    v_cndmask_b32 v91, v91, v97, vcc
    v_mov_b32 v92, 642
    v_cmp_lt_u32 vcc, 0x800, v97
    s_nop 1
    v_cndmask_b32 v91, v91, v92, vcc
    v_lshl_add_u32 v113, v91, 1, s93
    v_cvt_f32_u32 v110, v98
    v_lshrrev_b32 v91, 16, v110
    v_subrev_u32 v91, 0x4280, v91
    v_cmp_gt_u32 vcc, 0x80, v98
    s_nop 1
    v_cndmask_b32 v91, v91, v98, vcc
    v_mov_b32 v92, 642
    v_cmp_lt_u32 vcc, 0x800, v98
    s_nop 1
    v_cndmask_b32 v91, v91, v92, vcc
    v_lshl_add_u32 v114, v91, 1, s93
    v_cvt_f32_u32 v111, v99
    v_lshrrev_b32 v91, 16, v111
    v_subrev_u32 v91, 0x4280, v91
    v_cmp_gt_u32 vcc, 0x80, v99
    s_nop 1
    v_cndmask_b32 v91, v91, v99, vcc
    v_mov_b32 v92, 642
    v_cmp_lt_u32 vcc, 0x800, v99
    s_nop 1
    v_cndmask_b32 v91, v91, v92, vcc
    v_lshl_add_u32 v115, v91, 1, s93
    s_branch PREJ_5
PRE_4:
    v_add_u32 v96, 0x100, v1
    v_cmp_gt_u32 vcc, 9, v1
    s_nop 1
    v_cndmask_b32 v96, v96, v1, vcc
    v_lshlrev_b32 v94, 1, v96
    v_sub_u32 v90, 544, v94
    v_cvt_f32_i32 v91, v90
    v_cvt_pk_bf16_f32 v91, v91, v91
    v_and_b32 v91, 0xffff, v91
    v_subrev_u32 v91, 0x4280, v91
    v_cmp_gt_u32 vcc, 0x100, v90
    s_nop 1
    v_cndmask_b32 v91, v91, v90, vcc
    v_mov_b32 v92, 641
    v_cmp_lt_u32 vcc, 0x20d, v90
    s_nop 1
    v_cndmask_b32 v91, v91, v92, vcc
    v_or_b32 v90, 1, v94
    v_mov_b32 v92, 0x200
    v_cmp_eq_u32 vcc, 0x25d, v90
    s_nop 1
    v_cndmask_b32 v91, v91, v92, vcc
    v_lshl_add_u32 v119, v91, 1, s93
    v_add_u32 v94, 1, v94
    v_sub_u32 v90, 544, v94
    v_cvt_f32_i32 v91, v90
    v_cvt_pk_bf16_f32 v91, v91, v91
    v_and_b32 v91, 0xffff, v91
    v_subrev_u32 v91, 0x4280, v91
    v_cmp_gt_u32 vcc, 0x100, v90
    s_nop 1
    v_cndmask_b32 v91, v91, v90, vcc
    v_mov_b32 v92, 641
    v_cmp_lt_u32 vcc, 0x20d, v90
    s_nop 1
    v_cndmask_b32 v91, v91, v92, vcc
    v_or_b32 v90, 1, v94
    v_mov_b32 v92, 0x200
    v_cmp_eq_u32 vcc, 0x25d, v90
    s_nop 1
    v_cndmask_b32 v91, v91, v92, vcc
    v_lshl_add_u32 v120, v91, 1, s93
    v_add_u32 v94, 1, v94
    v_sub_u32 v90, 544, v94
    v_cvt_f32_i32 v91, v90
    v_cvt_pk_bf16_f32 v91, v91, v91
    v_and_b32 v91, 0xffff, v91
    v_subrev_u32 v91, 0x4280, v91
    v_cmp_gt_u32 vcc, 0x100, v90
    s_nop 1
    v_cndmask_b32 v91, v91, v90, vcc
    v_mov_b32 v92, 641
    v_cmp_lt_u32 vcc, 0x20d, v90
    s_nop 1
    v_cndmask_b32 v91, v91, v92, vcc
    v_or_b32 v90, 1, v94
    v_mov_b32 v92, 0x200
    v_cmp_eq_u32 vcc, 0x25d, v90
    s_nop 1
    v_cndmask_b32 v91, v91, v92, vcc
    v_lshl_add_u32 v122, v91, 1, s93
    v_mov_b32 v121, v120
    v_lshl_add_u32 v124, v96, 2, s85
    v_add_u32 v125, 33872, v124
    v_add_u32 v124, 32528, v124
    v_mov_b32 v94, s85
    ds_write_b16 v94, v4 offset:32514
PREJ_5:
    s_waitcnt vmcnt(7)
    v_lshlrev_b32 v16, 16, v16
    v_mul_f32 v17, 0x3fb8aa3b, v16
    s_mov_b32 s92, 0x3fb8aa3b
    s_mov_b32 s93, 0x32a57060
    v_fma_f32 v18, v16, s92, -v17
    v_fma_f32 v18, v16, s93, v18
    v_exp_f32 v17, v17
    v_mul_f32 v18, 0x3f317218, v18
    v_fma_f32 v17, v17, v18, v17
    v_cvt_pk_bf16_f32 v17, v17, v17
    v_and_b32 v16, 0xffff0000, v17
    v_mov_b32 v17, v16
    s_waitcnt vmcnt(1)
    ds_write_b32 v4, v5 offset:36
    v_lshlrev_b32 v20, 16, v8
    v_and_b32 v21, 0xffff0000, v8
    v_lshlrev_b32 v22, 16, v9
    v_and_b32 v23, 0xffff0000, v9
    v_lshlrev_b32 v24, 16, v10
    v_and_b32 v25, 0xffff0000, v10
    v_lshlrev_b32 v26, 16, v11
    v_and_b32 v27, 0xffff0000, v11
    v_lshlrev_b32 v28, 16, v12
    v_and_b32 v29, 0xffff0000, v12
    v_lshlrev_b32 v30, 16, v13
    v_and_b32 v31, 0xffff0000, v13
    v_pk_mul_f32 v[20:21], v[20:21], v[16:17]
    v_pk_mul_f32 v[22:23], v[22:23], v[16:17]
    v_pk_mul_f32 v[24:25], v[24:25], v[16:17]
    v_pk_mul_f32 v[26:27], v[26:27], v[16:17]
    v_pk_mul_f32 v[90:91], v[30:31], v[26:27]
    v_pk_mul_f32 v[92:93], v[30:31], v[24:25]
    v_pk_fma_f32 v[34:35], v[28:29], v[26:27], v[92:93]
    v_pk_fma_f32 v[32:33], v[28:29], v[24:25], v[90:91] neg_lo:[0,0,1] neg_hi:[0,0,1]
    v_max_f32 v36, v20, v21
    v_add_f32 v37, abs(v32), abs(v33)
    v_add_f32 v38, abs(v34), abs(v35)
    v_add_f32 v37, v37, v38
    v_max_f32_dpp v36, v36, v36 row_ror:8 row_mask:0xf bank_mask:0xf
    s_nop 0
    v_add_f32_dpp v37, v37, v37 row_ror:8 row_mask:0xf bank_mask:0xf
    v_max_f32_dpp v36, v36, v36 row_ror:4 row_mask:0xf bank_mask:0xf
    s_nop 0
    v_add_f32_dpp v37, v37, v37 row_ror:4 row_mask:0xf bank_mask:0xf
    v_max_f32_dpp v36, v36, v36 row_ror:2 row_mask:0xf bank_mask:0xf
    s_nop 0
    v_add_f32_dpp v37, v37, v37 row_ror:2 row_mask:0xf bank_mask:0xf
    v_max_f32_dpp v36, v36, v36 row_ror:1 row_mask:0xf bank_mask:0xf
    s_nop 0
    v_add_f32_dpp v37, v37, v37 row_ror:1 row_mask:0xf bank_mask:0xf
    v_mov_b32 v38, v36
    v_mov_b32 v39, v37
    s_nop 0
    v_permlane16_swap_b32 v36, v38
    v_permlane16_swap_b32 v37, v39
    v_max_f32 v36, v36, v38
    v_add_f32 v37, v37, v39
    v_mov_b32 v38, v36
    v_mov_b32 v39, v37
    s_nop 0
    v_permlane32_swap_b32 v36, v38
    v_permlane32_swap_b32 v37, v39
    v_max_f32 v36, v36, v38
    v_add_f32 v37, v37, v39
    v_max_f32 v37, 0x03aa2425, v37
    v_rcp_f32 v38, v37
    v_sub_f32 v20, v20, v36
    v_sub_f32 v21, v21, v36
    v_mul_f32 v38, 0x47000000, v38
    v_mov_b32 v39, v38
    v_mul_f32 v20, 0x3fb8aa3b, v20
    v_mul_f32 v21, 0x3fb8aa3b, v21
    v_mul_f32 v36, 0x3fb8aa3b, v36
    v_pk_mul_f32 v[32:33], v[32:33], v[38:39]
    v_pk_mul_f32 v[34:35], v[34:35], v[38:39]
    s_mov_b32 s92, 0x3e22f983
    s_mov_b32 s93, 0x31dc9c88
    v_lshl_add_u32 v6, v1, 3, s85
    s_cmp_eq_u32 s86, 1
    s_cbranch_scc1 JOB_7
    s_cmp_eq_u32 s86, 2
    s_cbranch_scc1 JOB_8
    s_cmp_eq_u32 s86, 3
    s_cbranch_scc1 JOB_9
    v_mul_f32 v90, 0x3f800000, v20
    v_mul_f32 v91, 0x3f800000, v22
    v_mul_f32 v94, 0x3f800000, v21
    v_mul_f32 v95, 0x3f800000, v23
    v_exp_f32 v90, v90
    v_mul_f32 v92, s92, v91
    v_exp_f32 v94, v94
    v_mul_f32 v96, s92, v95
    v_rndne_f32 v92, v92
    v_rndne_f32 v96, v96
    v_fma_f32 v92, v91, s92, -v92
    v_fma_f32 v96, v95, s92, -v96
    v_fma_f32 v92, v91, s93, v92
    v_fma_f32 v96, v95, s93, v96
    v_cos_f32 v91, v92
    v_sin_f32 v92, v92
    v_cos_f32 v95, v96
    v_sin_f32 v96, v96
    v_mul_f32 v40, v90, v91
    v_mul_f32 v42, v90, v92
    v_mul_f32 v41, v94, v95
    v_mul_f32 v43, v94, v96
    v_mul_f32 v90, 0x43000000, v20
    v_mul_f32 v91, 0x43000000, v22
    v_mul_f32 v94, 0x43000000, v21
    v_mul_f32 v95, 0x43000000, v23
    v_exp_f32 v90, v90
    v_mul_f32 v92, s92, v91
    v_exp_f32 v94, v94
    v_mul_f32 v96, s92, v95
    v_rndne_f32 v92, v92
    v_rndne_f32 v96, v96
    v_fma_f32 v92, v91, s92, -v92
    v_fma_f32 v96, v95, s92, -v96
    v_fma_f32 v92, v91, s93, v92
    v_fma_f32 v96, v95, s93, v96
    v_cos_f32 v91, v92
    v_sin_f32 v92, v92
    v_cos_f32 v95, v96
    v_sin_f32 v96, v96
    v_mul_f32 v44, v90, v91
    v_mul_f32 v46, v90, v92
    v_mul_f32 v45, v94, v95
    v_mul_f32 v47, v94, v96
    v_cvt_pk_f16_f32 v98, v32, v34
    v_cvt_pk_f16_f32 v99, v33, v35
    ds_write_b64 v6, v[98:99] offset:0
    v_pk_mul_f32 v[90:91], v[34:35], v[46:47]
    v_pk_mul_f32 v[92:93], v[34:35], v[44:45]
    v_pk_fma_f32 v[62:63], v[32:33], v[46:47], v[92:93]
    v_pk_fma_f32 v[60:61], v[32:33], v[44:45], v[90:91] neg_lo:[0,0,1] neg_hi:[0,0,1]
    v_pk_mul_f32 v[94:95], v[34:35], v[42:43]
    v_pk_mul_f32 v[96:97], v[34:35], v[40:41]
    v_pk_fma_f32 v[54:55], v[32:33], v[42:43], v[96:97]
    v_pk_fma_f32 v[52:53], v[32:33], v[40:41], v[94:95] neg_lo:[0,0,1] neg_hi:[0,0,1]
    v_cvt_pk_f16_f32 v100, v60, v62
    v_cvt_pk_f16_f32 v101, v61, v63
    ds_write_b64 v6, v[100:101] offset:4352
    v_cvt_pk_f16_f32 v98, v52, v54
    v_cvt_pk_f16_f32 v99, v53, v55
    ds_write_b64 v6, v[98:99] offset:544
    v_pk_mul_f32 v[90:91], v[54:55], v[46:47]
    v_pk_mul_f32 v[92:93], v[54:55], v[44:45]
    v_pk_fma_f32 v[62:63], v[52:53], v[46:47], v[92:93]
    v_pk_fma_f32 v[60:61], v[52:53], v[44:45], v[90:91] neg_lo:[0,0,1] neg_hi:[0,0,1]
    v_pk_mul_f32 v[94:95], v[54:55], v[42:43]
    v_pk_mul_f32 v[96:97], v[54:55], v[40:41]
    v_pk_fma_f32 v[58:59], v[52:53], v[42:43], v[96:97]
    v_pk_fma_f32 v[56:57], v[52:53], v[40:41], v[94:95] neg_lo:[0,0,1] neg_hi:[0,0,1]
    v_cvt_pk_f16_f32 v100, v60, v62
    v_cvt_pk_f16_f32 v101, v61, v63
    ds_write_b64 v6, v[100:101] offset:4896
    v_cvt_pk_f16_f32 v98, v56, v58
    v_cvt_pk_f16_f32 v99, v57, v59
    ds_write_b64 v6, v[98:99] offset:1088
    v_pk_mul_f32 v[90:91], v[58:59], v[46:47]
    v_pk_mul_f32 v[92:93], v[58:59], v[44:45]
    v_pk_fma_f32 v[62:63], v[56:57], v[46:47], v[92:93]
    v_pk_fma_f32 v[60:61], v[56:57], v[44:45], v[90:91] neg_lo:[0,0,1] neg_hi:[0,0,1]
    v_pk_mul_f32 v[94:95], v[58:59], v[42:43]
    v_pk_mul_f32 v[96:97], v[58:59], v[40:41]
    v_pk_fma_f32 v[54:55], v[56:57], v[42:43], v[96:97]
    v_pk_fma_f32 v[52:53], v[56:57], v[40:41], v[94:95] neg_lo:[0,0,1] neg_hi:[0,0,1]
    v_cvt_pk_f16_f32 v100, v60, v62
    v_cvt_pk_f16_f32 v101, v61, v63
    ds_write_b64 v6, v[100:101] offset:5440
    v_cvt_pk_f16_f32 v98, v52, v54
    v_cvt_pk_f16_f32 v99, v53, v55
    ds_write_b64 v6, v[98:99] offset:1632
    v_pk_mul_f32 v[90:91], v[54:55], v[46:47]
    v_pk_mul_f32 v[92:93], v[54:55], v[44:45]
    v_pk_fma_f32 v[62:63], v[52:53], v[46:47], v[92:93]
    v_pk_fma_f32 v[60:61], v[52:53], v[44:45], v[90:91] neg_lo:[0,0,1] neg_hi:[0,0,1]
    v_pk_mul_f32 v[94:95], v[54:55], v[42:43]
    v_pk_mul_f32 v[96:97], v[54:55], v[40:41]
    v_pk_fma_f32 v[58:59], v[52:53], v[42:43], v[96:97]
    v_pk_fma_f32 v[56:57], v[52:53], v[40:41], v[94:95] neg_lo:[0,0,1] neg_hi:[0,0,1]
    v_cvt_pk_f16_f32 v100, v60, v62
    v_cvt_pk_f16_f32 v101, v61, v63
    ds_write_b64 v6, v[100:101] offset:5984
    v_cvt_pk_f16_f32 v98, v56, v58
    v_cvt_pk_f16_f32 v99, v57, v59
    ds_write_b64 v6, v[98:99] offset:2176
    v_pk_mul_f32 v[90:91], v[58:59], v[46:47]
    v_pk_mul_f32 v[92:93], v[58:59], v[44:45]
    v_pk_fma_f32 v[62:63], v[56:57], v[46:47], v[92:93]
    v_pk_fma_f32 v[60:61], v[56:57], v[44:45], v[90:91] neg_lo:[0,0,1] neg_hi:[0,0,1]
    v_pk_mul_f32 v[94:95], v[58:59], v[42:43]
    v_pk_mul_f32 v[96:97], v[58:59], v[40:41]
    v_pk_fma_f32 v[54:55], v[56:57], v[42:43], v[96:97]
    v_pk_fma_f32 v[52:53], v[56:57], v[40:41], v[94:95] neg_lo:[0,0,1] neg_hi:[0,0,1]
    v_cvt_pk_f16_f32 v100, v60, v62
    v_cvt_pk_f16_f32 v101, v61, v63
    ds_write_b64 v6, v[100:101] offset:6528
    v_cvt_pk_f16_f32 v98, v52, v54
    v_cvt_pk_f16_f32 v99, v53, v55
    ds_write_b64 v6, v[98:99] offset:2720
    v_pk_mul_f32 v[90:91], v[54:55], v[46:47]
    v_pk_mul_f32 v[92:93], v[54:55], v[44:45]
    v_pk_fma_f32 v[62:63], v[52:53], v[46:47], v[92:93]
    v_pk_fma_f32 v[60:61], v[52:53], v[44:45], v[90:91] neg_lo:[0,0,1] neg_hi:[0,0,1]
    v_pk_mul_f32 v[94:95], v[54:55], v[42:43]
    v_pk_mul_f32 v[96:97], v[54:55], v[40:41]
    v_pk_fma_f32 v[58:59], v[52:53], v[42:43], v[96:97]
    v_pk_fma_f32 v[56:57], v[52:53], v[40:41], v[94:95] neg_lo:[0,0,1] neg_hi:[0,0,1]
    v_cvt_pk_f16_f32 v100, v60, v62
    v_cvt_pk_f16_f32 v101, v61, v63
    ds_write_b64 v6, v[100:101] offset:7072
    v_cvt_pk_f16_f32 v98, v56, v58
    v_cvt_pk_f16_f32 v99, v57, v59
    ds_write_b64 v6, v[98:99] offset:3264
    v_pk_mul_f32 v[90:91], v[58:59], v[46:47]
    v_pk_mul_f32 v[92:93], v[58:59], v[44:45]
    v_pk_fma_f32 v[62:63], v[56:57], v[46:47], v[92:93]
    v_pk_fma_f32 v[60:61], v[56:57], v[44:45], v[90:91] neg_lo:[0,0,1] neg_hi:[0,0,1]
    v_pk_mul_f32 v[94:95], v[58:59], v[42:43]
    v_pk_mul_f32 v[96:97], v[58:59], v[40:41]
    v_pk_fma_f32 v[54:55], v[56:57], v[42:43], v[96:97]
    v_pk_fma_f32 v[52:53], v[56:57], v[40:41], v[94:95] neg_lo:[0,0,1] neg_hi:[0,0,1]
    v_cvt_pk_f16_f32 v100, v60, v62
    v_cvt_pk_f16_f32 v101, v61, v63
    ds_write_b64 v6, v[100:101] offset:7616
    v_cvt_pk_f16_f32 v98, v52, v54
    v_cvt_pk_f16_f32 v99, v53, v55
    ds_write_b64 v6, v[98:99] offset:3808
    v_pk_mul_f32 v[90:91], v[54:55], v[46:47]
    v_pk_mul_f32 v[92:93], v[54:55], v[44:45]
    v_pk_fma_f32 v[62:63], v[52:53], v[46:47], v[92:93]
    v_pk_fma_f32 v[60:61], v[52:53], v[44:45], v[90:91] neg_lo:[0,0,1] neg_hi:[0,0,1]
    v_cvt_pk_f16_f32 v100, v60, v62
    v_cvt_pk_f16_f32 v101, v61, v63
    ds_write_b64 v6, v[100:101] offset:8160
    s_branch JOBJ_10
JOB_7:
    v_mul_f32 v90, 0x40000000, v20
    v_mul_f32 v91, 0x40000000, v22
    v_mul_f32 v94, 0x40000000, v21
    v_mul_f32 v95, 0x40000000, v23
    v_exp_f32 v90, v90
    v_mul_f32 v92, s92, v91
    v_exp_f32 v94, v94
    v_mul_f32 v96, s92, v95
    v_rndne_f32 v92, v92
    v_rndne_f32 v96, v96
    v_fma_f32 v92, v91, s92, -v92
    v_fma_f32 v96, v95, s92, -v96
    v_fma_f32 v92, v91, s93, v92
    v_fma_f32 v96, v95, s93, v96
    v_cos_f32 v91, v92
    v_sin_f32 v92, v92
    v_cos_f32 v95, v96
    v_sin_f32 v96, v96
    v_mul_f32 v40, v90, v91
    v_mul_f32 v42, v90, v92
    v_mul_f32 v41, v94, v95
    v_mul_f32 v43, v94, v96
    v_mul_f32 v90, 0x43000000, v20
    v_mul_f32 v91, 0x43000000, v22
    v_mul_f32 v94, 0x43000000, v21
    v_mul_f32 v95, 0x43000000, v23
    v_exp_f32 v90, v90
    v_mul_f32 v92, s92, v91
    v_exp_f32 v94, v94
    v_mul_f32 v96, s92, v95
    v_rndne_f32 v92, v92
    v_rndne_f32 v96, v96
    v_fma_f32 v92, v91, s92, -v92
    v_fma_f32 v96, v95, s92, -v96
    v_fma_f32 v92, v91, s93, v92
    v_fma_f32 v96, v95, s93, v96
    v_cos_f32 v91, v92
    v_sin_f32 v92, v92
    v_cos_f32 v95, v96
    v_sin_f32 v96, v96
    v_mul_f32 v44, v90, v91
    v_mul_f32 v46, v90, v92
    v_mul_f32 v45, v94, v95
    v_mul_f32 v47, v94, v96
    v_mul_f32 v90, 0x43800000, v20
    v_mul_f32 v91, 0x43800000, v22
    v_mul_f32 v94, 0x43800000, v21
    v_mul_f32 v95, 0x43800000, v23
    v_exp_f32 v90, v90
    v_mul_f32 v92, s92, v91
    v_exp_f32 v94, v94
    v_mul_f32 v96, s92, v95
    v_rndne_f32 v92, v92
    v_rndne_f32 v96, v96
    v_fma_f32 v92, v91, s92, -v92
    v_fma_f32 v96, v95, s92, -v96
    v_fma_f32 v92, v91, s93, v92
    v_fma_f32 v96, v95, s93, v96
    v_cos_f32 v91, v92
    v_sin_f32 v92, v92
    v_cos_f32 v95, v96
    v_sin_f32 v96, v96
    v_mul_f32 v48, v90, v91
    v_mul_f32 v50, v90, v92
    v_mul_f32 v49, v94, v95
    v_mul_f32 v51, v94, v96
    v_pk_mul_f32 v[90:91], v[34:35], v[50:51]
    v_pk_mul_f32 v[92:93], v[34:35], v[48:49]
    v_pk_fma_f32 v[54:55], v[32:33], v[50:51], v[92:93]
    v_pk_fma_f32 v[52:53], v[32:33], v[48:49], v[90:91] neg_lo:[0,0,1] neg_hi:[0,0,1]
    v_pk_mul_f32 v[94:95], v[54:55], v[50:51]
    v_pk_mul_f32 v[96:97], v[54:55], v[48:49]
    v_pk_fma_f32 v[66:67], v[52:53], v[50:51], v[96:97]
    v_pk_fma_f32 v[64:65], v[52:53], v[48:49], v[94:95] neg_lo:[0,0,1] neg_hi:[0,0,1]
    v_cvt_pk_f16_f32 v98, v52, v54
    v_cvt_pk_f16_f32 v99, v53, v55
    ds_write_b64 v6, v[98:99] offset:8704
    v_pk_mul_f32 v[90:91], v[54:55], v[46:47]
    v_pk_mul_f32 v[92:93], v[54:55], v[44:45]
    v_pk_fma_f32 v[62:63], v[52:53], v[46:47], v[92:93]
    v_pk_fma_f32 v[60:61], v[52:53], v[44:45], v[90:91] neg_lo:[0,0,1] neg_hi:[0,0,1]
    v_pk_mul_f32 v[94:95], v[54:55], v[42:43]
    v_pk_mul_f32 v[96:97], v[54:55], v[40:41]
    v_pk_fma_f32 v[58:59], v[52:53], v[42:43], v[96:97]
    v_pk_fma_f32 v[56:57], v[52:53], v[40:41], v[94:95] neg_lo:[0,0,1] neg_hi:[0,0,1]
    v_cvt_pk_f16_f32 v100, v60, v62
    v_cvt_pk_f16_f32 v101, v61, v63
    ds_write_b64 v6, v[100:101] offset:10880
    v_cvt_pk_f16_f32 v98, v56, v58
    v_cvt_pk_f16_f32 v99, v57, v59
    ds_write_b64 v6, v[98:99] offset:9248
    v_pk_mul_f32 v[90:91], v[58:59], v[46:47]
    v_pk_mul_f32 v[92:93], v[58:59], v[44:45]
    v_pk_fma_f32 v[62:63], v[56:57], v[46:47], v[92:93]
    v_pk_fma_f32 v[60:61], v[56:57], v[44:45], v[90:91] neg_lo:[0,0,1] neg_hi:[0,0,1]
    v_pk_mul_f32 v[94:95], v[58:59], v[42:43]
    v_pk_mul_f32 v[96:97], v[58:59], v[40:41]
    v_pk_fma_f32 v[54:55], v[56:57], v[42:43], v[96:97]
    v_pk_fma_f32 v[52:53], v[56:57], v[40:41], v[94:95] neg_lo:[0,0,1] neg_hi:[0,0,1]
    v_cvt_pk_f16_f32 v100, v60, v62
    v_cvt_pk_f16_f32 v101, v61, v63
    ds_write_b64 v6, v[100:101] offset:11424
    v_cvt_pk_f16_f32 v98, v52, v54
    v_cvt_pk_f16_f32 v99, v53, v55
    ds_write_b64 v6, v[98:99] offset:9792
    v_pk_mul_f32 v[90:91], v[54:55], v[46:47]
    v_pk_mul_f32 v[92:93], v[54:55], v[44:45]
    v_pk_fma_f32 v[62:63], v[52:53], v[46:47], v[92:93]
    v_pk_fma_f32 v[60:61], v[52:53], v[44:45], v[90:91] neg_lo:[0,0,1] neg_hi:[0,0,1]
    v_pk_mul_f32 v[94:95], v[54:55], v[42:43]
    v_pk_mul_f32 v[96:97], v[54:55], v[40:41]
    v_pk_fma_f32 v[58:59], v[52:53], v[42:43], v[96:97]
    v_pk_fma_f32 v[56:57], v[52:53], v[40:41], v[94:95] neg_lo:[0,0,1] neg_hi:[0,0,1]
    v_cvt_pk_f16_f32 v100, v60, v62
    v_cvt_pk_f16_f32 v101, v61, v63
    ds_write_b64 v6, v[100:101] offset:11968
    v_cvt_pk_f16_f32 v98, v56, v58
    v_cvt_pk_f16_f32 v99, v57, v59
    ds_write_b64 v6, v[98:99] offset:10336
    v_pk_mul_f32 v[90:91], v[58:59], v[46:47]
    v_pk_mul_f32 v[92:93], v[58:59], v[44:45]
    v_pk_fma_f32 v[62:63], v[56:57], v[46:47], v[92:93]
    v_pk_fma_f32 v[60:61], v[56:57], v[44:45], v[90:91] neg_lo:[0,0,1] neg_hi:[0,0,1]
    v_pk_mul_f32 v[94:95], v[42:43], v[42:43]
    v_pk_mul_f32 v[96:97], v[42:43], v[40:41]
    v_pk_fma_f32 v[50:51], v[40:41], v[42:43], v[96:97]
    v_pk_fma_f32 v[48:49], v[40:41], v[40:41], v[94:95] neg_lo:[0,0,1] neg_hi:[0,0,1]
    v_cvt_pk_f16_f32 v100, v60, v62
    v_cvt_pk_f16_f32 v101, v61, v63
    ds_write_b64 v6, v[100:101] offset:12512
    v_cvt_pk_f16_f32 v98, v64, v66
    v_cvt_pk_f16_f32 v99, v65, v67
    ds_write_b64 v6, v[98:99] offset:13056
    v_pk_mul_f32 v[90:91], v[66:67], v[50:51]
    v_pk_mul_f32 v[92:93], v[66:67], v[48:49]
    v_pk_fma_f32 v[62:63], v[64:65], v[50:51], v[92:93]
    v_pk_fma_f32 v[60:61], v[64:65], v[48:49], v[90:91] neg_lo:[0,0,1] neg_hi:[0,0,1]
    v_pk_mul_f32 v[94:95], v[66:67], v[46:47]
    v_pk_mul_f32 v[96:97], v[66:67], v[44:45]
    v_pk_fma_f32 v[54:55], v[64:65], v[46:47], v[96:97]
    v_pk_fma_f32 v[52:53], v[64:65], v[44:45], v[94:95] neg_lo:[0,0,1] neg_hi:[0,0,1]
    v_cvt_pk_f16_f32 v100, v60, v62
    v_cvt_pk_f16_f32 v101, v61, v63
    ds_write_b64 v6, v[100:101] offset:13600
    v_cvt_pk_f16_f32 v98, v52, v54
    v_cvt_pk_f16_f32 v99, v53, v55
    ds_write_b64 v6, v[98:99] offset:14144
    v_pk_mul_f32 v[90:91], v[54:55], v[50:51]
    v_pk_mul_f32 v[92:93], v[54:55], v[48:49]
    v_pk_fma_f32 v[62:63], v[52:53], v[50:51], v[92:93]
    v_pk_fma_f32 v[60:61], v[52:53], v[48:49], v[90:91] neg_lo:[0,0,1] neg_hi:[0,0,1]
    v_pk_mul_f32 v[94:95], v[54:55], v[46:47]
    v_pk_mul_f32 v[96:97], v[54:55], v[44:45]
    v_pk_fma_f32 v[58:59], v[52:53], v[46:47], v[96:97]
    v_pk_fma_f32 v[56:57], v[52:53], v[44:45], v[94:95] neg_lo:[0,0,1] neg_hi:[0,0,1]
    v_cvt_pk_f16_f32 v100, v60, v62
    v_cvt_pk_f16_f32 v101, v61, v63
    ds_write_b64 v6, v[100:101] offset:14688
    v_cvt_pk_f16_f32 v98, v56, v58
    v_cvt_pk_f16_f32 v99, v57, v59
    ds_write_b64 v6, v[98:99] offset:15232
    v_pk_mul_f32 v[90:91], v[58:59], v[50:51]
    v_pk_mul_f32 v[92:93], v[58:59], v[48:49]
    v_pk_fma_f32 v[62:63], v[56:57], v[50:51], v[92:93]
    v_pk_fma_f32 v[60:61], v[56:57], v[48:49], v[90:91] neg_lo:[0,0,1] neg_hi:[0,0,1]
    v_pk_mul_f32 v[94:95], v[58:59], v[46:47]
    v_pk_mul_f32 v[96:97], v[58:59], v[44:45]
    v_pk_fma_f32 v[54:55], v[56:57], v[46:47], v[96:97]
    v_pk_fma_f32 v[52:53], v[56:57], v[44:45], v[94:95] neg_lo:[0,0,1] neg_hi:[0,0,1]
    v_cvt_pk_f16_f32 v100, v60, v62
    v_cvt_pk_f16_f32 v101, v61, v63
    ds_write_b64 v6, v[100:101] offset:15776
    v_cvt_pk_f16_f32 v98, v52, v54
    v_cvt_pk_f16_f32 v99, v53, v55
    ds_write_b64 v6, v[98:99] offset:16320
    v_pk_mul_f32 v[90:91], v[54:55], v[50:51]
    v_pk_mul_f32 v[92:93], v[54:55], v[48:49]
    v_pk_fma_f32 v[62:63], v[52:53], v[50:51], v[92:93]
    v_pk_fma_f32 v[60:61], v[52:53], v[48:49], v[90:91] neg_lo:[0,0,1] neg_hi:[0,0,1]
    v_cvt_pk_f16_f32 v100, v60, v62
    v_cvt_pk_f16_f32 v101, v61, v63
    ds_write_b64 v6, v[100:101] offset:16864
    s_branch JOBJ_10
JOB_8:
    v_mul_f32 v90, 0x43000000, v20
    v_mul_f32 v91, 0x43000000, v22
    v_mul_f32 v94, 0x43000000, v21
    v_mul_f32 v95, 0x43000000, v23
    v_exp_f32 v90, v90
    v_mul_f32 v92, s92, v91
    v_exp_f32 v94, v94
    v_mul_f32 v96, s92, v95
    v_rndne_f32 v92, v92
    v_rndne_f32 v96, v96
    v_fma_f32 v92, v91, s92, -v92
    v_fma_f32 v96, v95, s92, -v96
    v_fma_f32 v92, v91, s93, v92
    v_fma_f32 v96, v95, s93, v96
    v_cos_f32 v91, v92
    v_sin_f32 v92, v92
    v_cos_f32 v95, v96
    v_sin_f32 v96, v96
    v_mul_f32 v44, v90, v91
    v_mul_f32 v46, v90, v92
    v_mul_f32 v45, v94, v95
    v_mul_f32 v47, v94, v96
    v_mul_f32 v90, 0x44800000, v20
    v_mul_f32 v91, 0x44800000, v22
    v_mul_f32 v94, 0x44800000, v21
    v_mul_f32 v95, 0x44800000, v23
    v_exp_f32 v90, v90
    v_mul_f32 v92, s92, v91
    v_exp_f32 v94, v94
    v_mul_f32 v96, s92, v95
    v_rndne_f32 v92, v92
    v_rndne_f32 v96, v96
    v_fma_f32 v92, v91, s92, -v92
    v_fma_f32 v96, v95, s92, -v96
    v_fma_f32 v92, v91, s93, v92
    v_fma_f32 v96, v95, s93, v96
    v_cos_f32 v91, v92
    v_sin_f32 v92, v92
    v_cos_f32 v95, v96
    v_sin_f32 v96, v96
    v_mul_f32 v48, v90, v91
    v_mul_f32 v50, v90, v92
    v_mul_f32 v49, v94, v95
    v_mul_f32 v51, v94, v96
    v_pk_mul_f32 v[90:91], v[34:35], v[50:51]
    v_pk_mul_f32 v[92:93], v[34:35], v[48:49]
    v_pk_fma_f32 v[54:55], v[32:33], v[50:51], v[92:93]
    v_pk_fma_f32 v[52:53], v[32:33], v[48:49], v[90:91] neg_lo:[0,0,1] neg_hi:[0,0,1]
    v_pk_mul_f32 v[90:91], v[54:55], v[46:47]
    v_pk_mul_f32 v[92:93], v[54:55], v[44:45]
    v_pk_fma_f32 v[58:59], v[52:53], v[46:47], v[92:93]
    v_pk_fma_f32 v[56:57], v[52:53], v[44:45], v[90:91] neg_lo:[0,0,1] neg_hi:[0,0,1]
    v_cvt_pk_f16_f32 v98, v52, v54
    v_cvt_pk_f16_f32 v99, v53, v55
    ds_write_b64 v6, v[98:99] offset:17408
    v_pk_mul_f32 v[90:91], v[58:59], v[46:47]
    v_pk_mul_f32 v[92:93], v[58:59], v[44:45]
    v_pk_fma_f32 v[54:55], v[56:57], v[46:47], v[92:93]
    v_pk_fma_f32 v[52:53], v[56:57], v[44:45], v[90:91] neg_lo:[0,0,1] neg_hi:[0,0,1]
    v_cvt_pk_f16_f32 v100, v56, v58
    v_cvt_pk_f16_f32 v101, v57, v59
    ds_write_b64 v6, v[100:101] offset:17952
    v_pk_mul_f32 v[90:91], v[54:55], v[46:47]
    v_pk_mul_f32 v[92:93], v[54:55], v[44:45]
    v_pk_fma_f32 v[58:59], v[52:53], v[46:47], v[92:93]
    v_pk_fma_f32 v[56:57], v[52:53], v[44:45], v[90:91] neg_lo:[0,0,1] neg_hi:[0,0,1]
    v_cvt_pk_f16_f32 v98, v52, v54
    v_cvt_pk_f16_f32 v99, v53, v55
    ds_write_b64 v6, v[98:99] offset:18496
    v_pk_mul_f32 v[90:91], v[58:59], v[46:47]
    v_pk_mul_f32 v[92:93], v[58:59], v[44:45]
    v_pk_fma_f32 v[54:55], v[56:57], v[46:47], v[92:93]
    v_pk_fma_f32 v[52:53], v[56:57], v[44:45], v[90:91] neg_lo:[0,0,1] neg_hi:[0,0,1]
    v_cvt_pk_f16_f32 v100, v56, v58
    v_cvt_pk_f16_f32 v101, v57, v59
    ds_write_b64 v6, v[100:101] offset:19040
    v_pk_mul_f32 v[90:91], v[54:55], v[46:47]
    v_pk_mul_f32 v[92:93], v[54:55], v[44:45]
    v_pk_fma_f32 v[58:59], v[52:53], v[46:47], v[92:93]
    v_pk_fma_f32 v[56:57], v[52:53], v[44:45], v[90:91] neg_lo:[0,0,1] neg_hi:[0,0,1]
    v_cvt_pk_f16_f32 v98, v52, v54
    v_cvt_pk_f16_f32 v99, v53, v55
    ds_write_b64 v6, v[98:99] offset:19584
    v_pk_mul_f32 v[90:91], v[58:59], v[46:47]
    v_pk_mul_f32 v[92:93], v[58:59], v[44:45]
    v_pk_fma_f32 v[54:55], v[56:57], v[46:47], v[92:93]
    v_pk_fma_f32 v[52:53], v[56:57], v[44:45], v[90:91] neg_lo:[0,0,1] neg_hi:[0,0,1]
    v_cvt_pk_f16_f32 v100, v56, v58
    v_cvt_pk_f16_f32 v101, v57, v59
    ds_write_b64 v6, v[100:101] offset:20128
    v_pk_mul_f32 v[90:91], v[54:55], v[46:47]
    v_pk_mul_f32 v[92:93], v[54:55], v[44:45]
    v_pk_fma_f32 v[58:59], v[52:53], v[46:47], v[92:93]
    v_pk_fma_f32 v[56:57], v[52:53], v[44:45], v[90:91] neg_lo:[0,0,1] neg_hi:[0,0,1]
    v_cvt_pk_f16_f32 v98, v52, v54
    v_cvt_pk_f16_f32 v99, v53, v55
    ds_write_b64 v6, v[98:99] offset:20672
    v_pk_mul_f32 v[90:91], v[58:59], v[46:47]
    v_pk_mul_f32 v[92:93], v[58:59], v[44:45]
    v_pk_fma_f32 v[54:55], v[56:57], v[46:47], v[92:93]
    v_pk_fma_f32 v[52:53], v[56:57], v[44:45], v[90:91] neg_lo:[0,0,1] neg_hi:[0,0,1]
    v_cvt_pk_f16_f32 v100, v56, v58
    v_cvt_pk_f16_f32 v101, v57, v59
    ds_write_b64 v6, v[100:101] offset:21216
    v_cvt_pk_f16_f32 v98, v52, v54
    v_cvt_pk_f16_f32 v99, v53, v55
    ds_write_b64 v6, v[98:99] offset:21760
    v_mul_f32 v40, 0x45000000, v36
    v_max_f32 v40, 0, v40
    v_exp_f32 v40, v40
    v_mul_f32 v41, 0x38000000, v37
    v_mul_f32 v40, v40, v41
    s_waitcnt vmcnt(0)
    v_lshlrev_b32 v41, 16, v107
    ds_write_b64 v14, v[40:41] offset:832
    s_branch JOBJ_10
JOB_9:
    v_mul_f32 v90, 0x41000000, v20
    v_mul_f32 v91, 0x41000000, v22
    v_mul_f32 v94, 0x41000000, v21
    v_mul_f32 v95, 0x41000000, v23
    v_exp_f32 v90, v90
    v_mul_f32 v92, s92, v91
    v_exp_f32 v94, v94
    v_mul_f32 v96, s92, v95
    v_rndne_f32 v92, v92
    v_rndne_f32 v96, v96
    v_fma_f32 v92, v91, s92, -v92
    v_fma_f32 v96, v95, s92, -v96
    v_fma_f32 v92, v91, s93, v92
    v_fma_f32 v96, v95, s93, v96
    v_cos_f32 v91, v92
    v_sin_f32 v92, v92
    v_cos_f32 v95, v96
    v_sin_f32 v96, v96
    v_mul_f32 v40, v90, v91
    v_mul_f32 v42, v90, -v92
    v_mul_f32 v41, v94, v95
    v_mul_f32 v43, v94, -v96
    v_pk_mul_f32 v[90:91], v[42:43], v[42:43]
    v_pk_mul_f32 v[92:93], v[42:43], v[40:41]
    v_pk_fma_f32 v[46:47], v[40:41], v[42:43], v[92:93]
    v_pk_fma_f32 v[44:45], v[40:41], v[40:41], v[90:91] neg_lo:[0,0,1] neg_hi:[0,0,1]
    v_mov_b32 v52, 0x47000000
    v_mov_b32 v53, 0x47000000
    v_mov_b32 v54, 0
    v_mov_b32 v55, 0
    v_pk_mul_f32 v[60:61], v[40:41], v[52:53]
    v_pk_mul_f32 v[62:63], v[42:43], v[52:53]
    v_pk_mul_f32 v[90:91], v[54:55], v[46:47]
    v_pk_mul_f32 v[92:93], v[54:55], v[44:45]
    v_pk_fma_f32 v[58:59], v[52:53], v[46:47], v[92:93]
    v_pk_fma_f32 v[56:57], v[52:53], v[44:45], v[90:91] neg_lo:[0,0,1] neg_hi:[0,0,1]
    v_pk_mul_f32 v[94:95], v[62:63], v[46:47]
    v_pk_mul_f32 v[96:97], v[62:63], v[44:45]
    v_pk_fma_f32 v[66:67], v[60:61], v[46:47], v[96:97]
    v_pk_fma_f32 v[64:65], v[60:61], v[44:45], v[94:95] neg_lo:[0,0,1] neg_hi:[0,0,1]
    v_cvt_pk_f16_f32 v100, v52, v54
    v_cvt_pk_f16_f32 v101, v53, v55
    ds_write_b64 v6, v[100:101] offset:22304
    v_cvt_pk_f16_f32 v98, v60, v62
    v_cvt_pk_f16_f32 v99, v61, v63
    ds_write_b64 v6, v[98:99] offset:22848
    v_pk_mul_f32 v[90:91], v[58:59], v[46:47]
    v_pk_mul_f32 v[92:93], v[58:59], v[44:45]
    v_pk_fma_f32 v[54:55], v[56:57], v[46:47], v[92:93]
    v_pk_fma_f32 v[52:53], v[56:57], v[44:45], v[90:91] neg_lo:[0,0,1] neg_hi:[0,0,1]
    v_pk_mul_f32 v[94:95], v[66:67], v[46:47]
    v_pk_mul_f32 v[96:97], v[66:67], v[44:45]
    v_pk_fma_f32 v[62:63], v[64:65], v[46:47], v[96:97]
    v_pk_fma_f32 v[60:61], v[64:65], v[44:45], v[94:95] neg_lo:[0,0,1] neg_hi:[0,0,1]
    v_cvt_pk_f16_f32 v100, v56, v58
    v_cvt_pk_f16_f32 v101, v57, v59
    ds_write_b64 v6, v[100:101] offset:23392
    v_cvt_pk_f16_f32 v98, v64, v66
    v_cvt_pk_f16_f32 v99, v65, v67
    ds_write_b64 v6, v[98:99] offset:23936
    v_pk_mul_f32 v[90:91], v[54:55], v[46:47]
    v_pk_mul_f32 v[92:93], v[54:55], v[44:45]
    v_pk_fma_f32 v[58:59], v[52:53], v[46:47], v[92:93]
    v_pk_fma_f32 v[56:57], v[52:53], v[44:45], v[90:91] neg_lo:[0,0,1] neg_hi:[0,0,1]
    v_pk_mul_f32 v[94:95], v[62:63], v[46:47]
    v_pk_mul_f32 v[96:97], v[62:63], v[44:45]
    v_pk_fma_f32 v[66:67], v[60:61], v[46:47], v[96:97]
    v_pk_fma_f32 v[64:65], v[60:61], v[44:45], v[94:95] neg_lo:[0,0,1] neg_hi:[0,0,1]
    v_cvt_pk_f16_f32 v100, v52, v54
    v_cvt_pk_f16_f32 v101, v53, v55
    ds_write_b64 v6, v[100:101] offset:24480
    v_cvt_pk_f16_f32 v98, v60, v62
    v_cvt_pk_f16_f32 v99, v61, v63
    ds_write_b64 v6, v[98:99] offset:25024
    v_pk_mul_f32 v[90:91], v[58:59], v[46:47]
    v_pk_mul_f32 v[92:93], v[58:59], v[44:45]
    v_pk_fma_f32 v[54:55], v[56:57], v[46:47], v[92:93]
    v_pk_fma_f32 v[52:53], v[56:57], v[44:45], v[90:91] neg_lo:[0,0,1] neg_hi:[0,0,1]
    v_pk_mul_f32 v[94:95], v[66:67], v[46:47]
    v_pk_mul_f32 v[96:97], v[66:67], v[44:45]
    v_pk_fma_f32 v[62:63], v[64:65], v[46:47], v[96:97]
    v_pk_fma_f32 v[60:61], v[64:65], v[44:45], v[94:95] neg_lo:[0,0,1] neg_hi:[0,0,1]
    v_cvt_pk_f16_f32 v100, v56, v58
    v_cvt_pk_f16_f32 v101, v57, v59
    ds_write_b64 v6, v[100:101] offset:25568
    v_cvt_pk_f16_f32 v98, v64, v66
    v_cvt_pk_f16_f32 v99, v65, v67
    ds_write_b64 v6, v[98:99] offset:26112
    v_pk_mul_f32 v[90:91], v[54:55], v[46:47]
    v_pk_mul_f32 v[92:93], v[54:55], v[44:45]
    v_pk_fma_f32 v[58:59], v[52:53], v[46:47], v[92:93]
    v_pk_fma_f32 v[56:57], v[52:53], v[44:45], v[90:91] neg_lo:[0,0,1] neg_hi:[0,0,1]
    v_pk_mul_f32 v[94:95], v[62:63], v[46:47]
    v_pk_mul_f32 v[96:97], v[62:63], v[44:45]
    v_pk_fma_f32 v[66:67], v[60:61], v[46:47], v[96:97]
    v_pk_fma_f32 v[64:65], v[60:61], v[44:45], v[94:95] neg_lo:[0,0,1] neg_hi:[0,0,1]
    v_cvt_pk_f16_f32 v100, v52, v54
    v_cvt_pk_f16_f32 v101, v53, v55
    ds_write_b64 v6, v[100:101] offset:26656
    v_cvt_pk_f16_f32 v98, v60, v62
    v_cvt_pk_f16_f32 v99, v61, v63
    ds_write_b64 v6, v[98:99] offset:27200
    v_pk_mul_f32 v[90:91], v[58:59], v[46:47]
    v_pk_mul_f32 v[92:93], v[58:59], v[44:45]
    v_pk_fma_f32 v[54:55], v[56:57], v[46:47], v[92:93]
    v_pk_fma_f32 v[52:53], v[56:57], v[44:45], v[90:91] neg_lo:[0,0,1] neg_hi:[0,0,1]
    v_pk_mul_f32 v[94:95], v[66:67], v[46:47]
    v_pk_mul_f32 v[96:97], v[66:67], v[44:45]
    v_pk_fma_f32 v[62:63], v[64:65], v[46:47], v[96:97]
    v_pk_fma_f32 v[60:61], v[64:65], v[44:45], v[94:95] neg_lo:[0,0,1] neg_hi:[0,0,1]
    v_cvt_pk_f16_f32 v100, v56, v58
    v_cvt_pk_f16_f32 v101, v57, v59
    ds_write_b64 v6, v[100:101] offset:27744
    v_cvt_pk_f16_f32 v98, v64, v66
    v_cvt_pk_f16_f32 v99, v65, v67
    ds_write_b64 v6, v[98:99] offset:28288
    v_pk_mul_f32 v[90:91], v[54:55], v[46:47]
    v_pk_mul_f32 v[92:93], v[54:55], v[44:45]
    v_pk_fma_f32 v[58:59], v[52:53], v[46:47], v[92:93]
    v_pk_fma_f32 v[56:57], v[52:53], v[44:45], v[90:91] neg_lo:[0,0,1] neg_hi:[0,0,1]
    v_pk_mul_f32 v[94:95], v[62:63], v[46:47]
    v_pk_mul_f32 v[96:97], v[62:63], v[44:45]
    v_pk_fma_f32 v[66:67], v[60:61], v[46:47], v[96:97]
    v_pk_fma_f32 v[64:65], v[60:61], v[44:45], v[94:95] neg_lo:[0,0,1] neg_hi:[0,0,1]
    v_cvt_pk_f16_f32 v100, v52, v54
    v_cvt_pk_f16_f32 v101, v53, v55
    ds_write_b64 v6, v[100:101] offset:28832
    v_cvt_pk_f16_f32 v98, v60, v62
    v_cvt_pk_f16_f32 v99, v61, v63
    ds_write_b64 v6, v[98:99] offset:29376
    v_cvt_pk_f16_f32 v100, v56, v58
    v_cvt_pk_f16_f32 v101, v57, v59
    ds_write_b64 v6, v[100:101] offset:29920
    v_cvt_pk_f16_f32 v98, v64, v66
    v_cvt_pk_f16_f32 v99, v65, v67
    ds_write_b64 v6, v[98:99] offset:30464
JOBJ_10:
    ds_write_b8 v15, v5 offset:64
    s_cmp_eq_u32 s86, 3
    s_cbranch_scc1 EXP_11
    v_mul_u32_u24 v10, 544, v2
    v_lshl_add_u32 v10, v3, 4, v10
    v_add_u32 v10, s85, v10
    s_mul_i32 s92, s86, 8704
    v_add_u32 v11, s92, v10
    v_mul_f32 v40, 0x45000000, v36
    v_max_f32 v40, 0, v40
    v_add_f32 v40, 0x41700000, v40
    v_fma_f32 v108, v108, v36, -v40
    v_fma_f32 v109, v109, v36, -v40
    v_fma_f32 v110, v110, v36, -v40
    v_fma_f32 v111, v111, v36, -v40
    v_exp_f32 v108, v108
    v_exp_f32 v109, v109
    v_exp_f32 v110, v110
    v_exp_f32 v111, v111
W_12:
    ds_read_b32 v12, v14 offset:64
    s_sub_u32 s39, s39, 1
    s_cbranch_scc1 KS_ABORT
    s_waitcnt lgkmcnt(0)
    v_cmp_ne_u32 vcc, s84, v12
    s_cbranch_vccnz W_12
    ds_read_b128 v[40:43], v11 offset:0
    ds_read_b128 v[72:75], v10 offset:22304
    ds_read_b128 v[44:47], v11 offset:64
    ds_read_b128 v[76:79], v10 offset:22368
    ds_read_b128 v[48:51], v11 offset:128
    ds_read_b128 v[80:83], v10 offset:22432
    ds_read_b128 v[52:55], v11 offset:192
    ds_read_b128 v[84:87], v10 offset:22496
    ds_read_b128 v[56:59], v11 offset:256
    ds_read_b128 v[88:91], v10 offset:22560
    ds_read_b128 v[60:63], v11 offset:320
    ds_read_b128 v[92:95], v10 offset:22624
    ds_read_b128 v[64:67], v11 offset:384
    ds_read_b128 v[96:99], v10 offset:22688
    ds_read_b128 v[68:71], v11 offset:448
    ds_read_b128 v[100:103], v10 offset:22752
    s_waitcnt lgkmcnt(14)
    v_mfma_f32_16x16x32_f16 v[20:23], v[40:43], v[72:75], 0
    s_waitcnt lgkmcnt(12)
    v_mfma_f32_16x16x32_f16 v[24:27], v[44:47], v[76:79], 0
    s_waitcnt lgkmcnt(10)
    v_mfma_f32_16x16x32_f16 v[20:23], v[48:51], v[80:83], v[20:23]
    s_waitcnt lgkmcnt(8)
    v_mfma_f32_16x16x32_f16 v[24:27], v[52:55], v[84:87], v[24:27]
    s_waitcnt lgkmcnt(6)
    v_mfma_f32_16x16x32_f16 v[20:23], v[56:59], v[88:91], v[20:23]
    s_waitcnt lgkmcnt(4)
    v_mfma_f32_16x16x32_f16 v[24:27], v[60:63], v[92:95], v[24:27]
    s_waitcnt lgkmcnt(2)
    v_mfma_f32_16x16x32_f16 v[20:23], v[64:67], v[96:99], v[20:23]
    s_waitcnt lgkmcnt(0)
    v_mfma_f32_16x16x32_f16 v[24:27], v[68:71], v[100:103], v[24:27]
    s_nop 7
    v_add_f32 v20, v20, v24
    v_add_f32 v21, v21, v25
    v_add_f32 v22, v22, v26
    v_add_f32 v23, v23, v27
    v_mul_f32 v20, v20, v108
    v_mul_f32 v21, v21, v109
    v_mul_f32 v22, v22, v110
    v_mul_f32 v23, v23, v111
    v_cvt_f16_f32 v20, v20
    ds_write_b16 v112, v20
    v_cvt_f16_f32 v21, v21
    ds_write_b16 v113, v21
    v_cvt_f16_f32 v22, v22
    ds_write_b16 v114, v22
    v_cvt_f16_f32 v23, v23
    ds_write_b16 v115, v23
EXP_11:
    ds_write_b8 v15, v5 offset:68
    s_waitcnt vmcnt(0)
    s_nop 1
    v_lshlrev_b32 v20, 3, v3
    v_sub_u32 v20, v20, v2
    v_add_u32 v21, 16, v20
    v_lshrrev_b32 v21, 1, v21
    v_and_b32 v22, 1, v2
    v_mul_u32_u24 v23, 1344, v22
    v_lshl_add_u32 v23, v21, 2, v23
    s_add_u32 s92, s85, 32528
    v_add_u32 v6, s92, v23
    v_add_u32 v7, 640, v6
    v_mul_u32_u24 v23, 192, v22
    v_lshl_add_u32 v23, v21, 2, v23
    s_add_u32 s92, s85, 35664
    v_add_u32 v13, s92, v23
    v_lshlrev_b32 v23, 2, v3
    v_sub_u32 v23, v23, v2
    v_add_u32 v23, 15, v23
    s_add_u32 s92, s85, 35152
    v_lshl_add_u32 v11, v23, 2, s92
    s_mul_i32 s94, s87, 4672
    s_add_u32 s94, s94, 3072
    v_lshlrev_b32 v23, 5, v2
    v_lshl_add_u32 v23, v3, 4, v23
    v_add_u32 v8, s94, v23
    v_bfe_u32 v20, v1, 2, 2
    v_and_b32 v21, 3, v1
    v_lshl_add_u32 v20, v3, 3, v20
    v_lshl_add_u32 v21, v21, 3, s85
    v_lshl_add_u32 v9, v20, 4, v21
    v_lshl_add_u32 v10, v20, 5, v21
W_13:
    ds_read_b32 v20, v14 offset:68
    s_sub_u32 s39, s39, 1
    s_cbranch_scc1 KS_ABORT
    s_waitcnt lgkmcnt(0)
    v_cmp_ne_u32 vcc, s84, v20
    s_cbranch_vccnz W_13
    ds_read_u16 v20, v116
    ds_read_u16 v21, v117
    ds_read_u16 v22, v118
    ds_read_u16 v23, v119
    ds_read_u16 v24, v120
    ds_read_u16 v25, v121
    ds_read_u16 v26, v122
    v_mov_b32 v28, 0
    v_mov_b32 v29, 0
    v_mov_b32 v30, 0
    v_mov_b32 v31, 0
    v_mov_b32 v32, s85
    s_mov_b64 exec, 1
    ds_write_b128 v32, v[28:31] offset:3088
    ds_write_b128 v32, v[28:31] offset:8224
    ds_write_b128 v32, v[28:31] offset:3072
    s_mov_b64 exec, -1
    s_waitcnt lgkmcnt(7)
    v_lshl_or_b32 v28, v21, 16, v20
    v_lshl_or_b32 v29, v22, 16, v21
    ds_write_b32 v123, v28 offset:32528
    ds_write_b32 v123, v29 offset:33872
    s_waitcnt lgkmcnt(5)
    v_lshl_or_b32 v30, v24, 16, v23
    v_lshl_or_b32 v31, v26, 16, v25
    ds_write_b32 v124, v30
    ds_write_b32 v125, v31
    ds_write_b8 v15, v5 offset:72
    v_lshlrev_b32 v12, 4, v1
    s_add_u32 s64, s36, 0x600000
    s_addc_u32 s65, s37, 0
    s_mov_b32 s66, 0x240000
    s_mov_b32 s67, 0x20000
    s_lshl_b32 s92, s86, 19
    s_lshl_b32 s93, s90, 6
    s_add_u32 s92, s92, s93
    s_lshl_b32 s93, s86, 16
    s_lshl_b32 s95, s88, 6
    s_add_u32 s93, s93, s95
    s_add_u32 s93, s93, 2064384
    s_cmp_eq_u32 s87, 2
    s_cselect_b32 s92, s93, s92
    s_cselect_b32 s95, 12, 15
    s_add_u32 s93, s92, 16384
    s_and_b32 s96, s87, 1
    s_lshl_b32 s96, s96, 4
    s_mov_b32 s97, 0x01010103
    s_mov_b32 s98, 0x55555555
    s_mov_b32 s99, 0x55555555
W_14:
    ds_read_b32 v20, v14 offset:72
    s_sub_u32 s39, s39, 1
    s_cbranch_scc1 KS_ABORT
    s_waitcnt lgkmcnt(0)
    v_cmp_ne_u32 vcc, s84, v20
    s_cbranch_vccnz W_14
    ds_read_b64 v[16:17], v14 offset:832
    s_cmp_eq_u32 s86, 1
    s_cbranch_scc1 CV_16
    s_cmp_eq_u32 s86, 2
    s_cbranch_scc1 CV_17
    s_cmp_eq_u32 s86, 3
    s_cbranch_scc1 CV_18
    ds_read2_b32 v[32:33], v6 offset0:144 offset1:145
    ds_read2_b32 v[34:35], v6 offset0:146 offset1:147
    ds_read2_b32 v[36:37], v6 offset0:16 offset1:17
    ds_read2_b32 v[38:39], v6 offset0:18 offset1:19
    ds_read2_b32 v[40:41], v6 offset0:160 offset1:161
    ds_read2_b32 v[42:43], v6 offset0:162 offset1:163
    ds_read2_b32 v[44:45], v6 offset0:32 offset1:33
    ds_read2_b32 v[46:47], v6 offset0:34 offset1:35
    ds_read2_b32 v[48:49], v6 offset0:176 offset1:177
    ds_read2_b32 v[50:51], v6 offset0:178 offset1:179
    ds_read2_b32 v[52:53], v6 offset0:48 offset1:49
    ds_read2_b32 v[54:55], v6 offset0:50 offset1:51
    ds_read2_b32 v[56:57], v6 offset0:192 offset1:193
    ds_read2_b32 v[58:59], v6 offset0:194 offset1:195
    ds_read2_b32 v[60:61], v6 offset0:64 offset1:65
    ds_read2_b32 v[62:63], v6 offset0:66 offset1:67
    ds_read2_b32 v[64:65], v6 offset0:208 offset1:209
    ds_read2_b32 v[66:67], v6 offset0:210 offset1:211
    ds_read2_b32 v[68:69], v6 offset0:80 offset1:81
    ds_read2_b32 v[70:71], v6 offset0:82 offset1:83
    ds_read2_b32 v[72:73], v6 offset0:224 offset1:225
    ds_read2_b32 v[74:75], v6 offset0:226 offset1:227
    ds_read2_b32 v[76:77], v6 offset0:96 offset1:97
    ds_read2_b32 v[78:79], v6 offset0:98 offset1:99
    ds_read2_b32 v[80:81], v6 offset0:240 offset1:241
    ds_read2_b32 v[82:83], v6 offset0:242 offset1:243
    ds_read2_b32 v[84:85], v6 offset0:112 offset1:113
    ds_read2_b32 v[86:87], v6 offset0:114 offset1:115
    ds_read2_b32 v[88:89], v7 offset0:96 offset1:97
    ds_read2_b32 v[90:91], v7 offset0:98 offset1:99
    ds_read2_b32 v[92:93], v6 offset0:128 offset1:129
    ds_read2_b32 v[94:95], v6 offset0:130 offset1:131
    v_lshlrev_b32 v18, 3, v3
    v_sub_u32 v18, v8, v18
    v_lshrrev_b32 v19, 2, v2
    v_lshl_add_u32 v19, v19, 2, v3
    v_and_b32 v28, 3, v2
    v_lshlrev_b32 v28, 4, v28
    v_lshlrev_b32 v19, s95, v19
    s_waitcnt lgkmcnt(0)
    v_mov_b32 v7, v18
    v_add_u32 v6, v19, v28
    v_xor_b32 v12, s96, v12
W_20:
    ds_read_b32 v18, v4 offset:16
    s_sub_u32 s39, s39, 1
    s_cbranch_scc1 KS_ABORT
    s_waitcnt lgkmcnt(0)
    v_cmp_ne_u32 vcc, s84, v18
    s_cbranch_vccnz W_20
    s_setprio 2
    ds_read_b128 v[96:99], v8 offset:0
    ds_read_b128 v[100:103], v8 offset:64
    ds_read_b128 v[104:107], v8 offset:128
    ds_read_b128 v[108:111], v8 offset:192
    s_waitcnt lgkmcnt(3)
    v_mfma_f32_16x16x32_f16 v[20:23], v[32:35], v[96:99], 0
    v_mfma_f32_16x16x32_f16 v[24:27], v[36:39], v[96:99], 0
    ds_read_b128 v[112:115], v8 offset:256
    s_waitcnt lgkmcnt(3)
    v_mfma_f32_16x16x32_f16 v[20:23], v[40:43], v[100:103], v[20:23]
    ds_read_b64 v[28:29], v7 offset:480
    ds_read_b64 v[30:31], v7 offset:992
    v_mfma_f32_16x16x32_f16 v[24:27], v[44:47], v[100:103], v[24:27]
    ds_read_b128 v[116:119], v8 offset:320
    s_waitcnt lgkmcnt(5)
    v_mfma_f32_16x16x32_f16 v[20:23], v[48:51], v[104:107], v[20:23]
    v_mfma_f32_16x16x32_f16 v[24:27], v[52:55], v[104:107], v[24:27]
    ds_read_b128 v[120:123], v8 offset:384
    s_waitcnt lgkmcnt(2)
    v_fma_mix_f32 v104, v28, v17, 0 op_sel_hi:[1,0,0]
    v_fma_mix_f32 v105, v28, v17, 0 op_sel:[1,0,0] op_sel_hi:[1,0,0]
    v_mfma_f32_16x16x32_f16 v[20:23], v[56:59], v[108:111], v[20:23]
    v_fma_mix_f32 v106, v29, v17, 0 op_sel_hi:[1,0,0]
    v_fma_mix_f32 v107, v29, v17, 0 op_sel:[1,0,0] op_sel_hi:[1,0,0]
    v_mfma_f32_16x16x32_f16 v[24:27], v[60:63], v[108:111], v[24:27]
    ds_read_b128 v[124:127], v8 offset:448
    v_cvt_pk_bf16_f32 v28, v104, v105
    v_cvt_pk_bf16_f32 v29, v106, v107
    v_mfma_f32_16x16x32_f16 v[20:23], v[64:67], v[112:115], v[20:23]
    v_lshlrev_b32 v104, 16, v28
    v_and_b32 v105, 0xffff0000, v28
    v_mfma_f32_16x16x32_f16 v[24:27], v[68:71], v[112:115], v[24:27]
    ds_read_b128 v[36:39], v8 offset:512
    v_lshlrev_b32 v106, 16, v29
    v_and_b32 v107, 0xffff0000, v29
    s_waitcnt lgkmcnt(3)
    v_mfma_f32_16x16x32_f16 v[20:23], v[72:75], v[116:119], v[20:23]
    ds_read_b128 v[96:99], v8 offset:576
    v_fma_mix_f32 v112, v30, v17, 0 op_sel_hi:[1,0,0]
    v_fma_mix_f32 v113, v30, v17, 0 op_sel:[1,0,0] op_sel_hi:[1,0,0]
    v_mfma_f32_16x16x32_f16 v[24:27], v[76:79], v[116:119], v[24:27]
    ds_read_b128 v[44:47], v8 offset:640
    v_fma_mix_f32 v114, v31, v17, 0 op_sel_hi:[1,0,0]
    v_fma_mix_f32 v115, v31, v17, 0 op_sel:[1,0,0] op_sel_hi:[1,0,0]
    s_waitcnt lgkmcnt(4)
    v_mfma_f32_16x16x32_f16 v[20:23], v[80:83], v[120:123], v[20:23]
    ds_read_b128 v[100:103], v8 offset:704
    v_cvt_pk_bf16_f32 v30, v112, v113
    v_cvt_pk_bf16_f32 v31, v114, v115
    v_mfma_f32_16x16x32_f16 v[24:27], v[84:87], v[120:123], v[24:27]
    ds_read_b128 v[52:55], v8 offset:768
    v_lshlrev_b32 v112, 16, v30
    v_and_b32 v113, 0xffff0000, v30
    s_waitcnt lgkmcnt(5)
    v_mfma_f32_16x16x32_f16 v[20:23], v[88:91], v[124:127], v[20:23]
    ds_read_b128 v[60:63], v8 offset:832
    v_lshlrev_b32 v114, 16, v31
    v_and_b32 v115, 0xffff0000, v31
    v_mfma_f32_16x16x32_f16 v[24:27], v[92:95], v[124:127], v[24:27]
    ds_read_b128 v[108:111], v8 offset:896
    s_waitcnt lgkmcnt(6)
    v_mfma_f32_16x16x32_f16 v[24:27], v[32:35], v[36:39], v[24:27]
    ds_read_b128 v[68:71], v8 offset:960
    v_mul_f32 v20, v20, v16
    v_mul_f32 v21, v21, v16
    s_waitcnt lgkmcnt(6)
    v_mfma_f32_16x16x32_f16 v[24:27], v[40:43], v[96:99], v[24:27]
    v_mul_f32 v22, v22, v16
    v_mul_f32 v23, v23, v16
    s_waitcnt lgkmcnt(5)
    v_mfma_f32_16x16x32_f16 v[24:27], v[48:51], v[44:47], v[24:27]
    v_cvt_pk_bf16_f32 v28, v20, v21
    v_cvt_pk_bf16_f32 v29, v22, v23
    s_waitcnt lgkmcnt(4)
    v_mfma_f32_16x16x32_f16 v[24:27], v[56:59], v[100:103], v[24:27]
    v_lshlrev_b32 v20, 16, v28
    v_and_b32 v21, 0xffff0000, v28
    s_waitcnt lgkmcnt(3)
    v_mfma_f32_16x16x32_f16 v[24:27], v[64:67], v[52:55], v[24:27]
    v_lshlrev_b32 v22, 16, v29
    v_and_b32 v23, 0xffff0000, v29
    s_waitcnt lgkmcnt(2)
    v_mfma_f32_16x16x32_f16 v[24:27], v[72:75], v[60:63], v[24:27]
    v_add_f32 v20, v20, v104
    v_add_f32 v21, v21, v105
    s_waitcnt lgkmcnt(1)
    v_mfma_f32_16x16x32_f16 v[24:27], v[80:83], v[108:111], v[24:27]
    v_add_f32 v22, v22, v106
    v_add_f32 v23, v23, v107
    s_waitcnt lgkmcnt(0)
    v_mfma_f32_16x16x32_f16 v[24:27], v[88:91], v[68:71], v[24:27]
    v_cvt_pk_bf16_f32 v28, v20, v21
    v_cvt_pk_bf16_f32 v29, v22, v23
    v_min_u32 v28, -2, v28
    v_min_u32 v29, -2, v29
    ds_read_b32 v19, v4 offset:188
    ds_read_u8 v18, v4 offset:160
    ds_read_b128 v[20:23], v12 offset:46592
    s_nop 0
    v_mul_f32 v24, v24, v16
    v_mul_f32 v25, v25, v16
    v_mul_f32 v26, v26, v16
    v_mul_f32 v27, v27, v16
    v_cvt_pk_bf16_f32 v30, v24, v25
    v_cvt_pk_bf16_f32 v31, v26, v27
    v_lshlrev_b32 v24, 16, v30
    v_and_b32 v25, 0xffff0000, v30
    v_lshlrev_b32 v26, 16, v31
    v_and_b32 v27, 0xffff0000, v31
    v_add_f32 v24, v24, v112
    v_add_f32 v25, v25, v113
    v_add_f32 v26, v26, v114
    v_add_f32 v27, v27, v115
    v_cvt_pk_bf16_f32 v30, v24, v25
    v_cvt_pk_bf16_f32 v31, v26, v27
    v_min_u32 v30, -2, v30
    v_min_u32 v31, -2, v31
    s_branch CVE_19
CV_16:
    ds_read2_b32 v[32:33], v6 offset0:0 offset1:1
    ds_read2_b32 v[34:35], v6 offset0:2 offset1:3
    ds_read2_b32 v[36:37], v6 offset0:16 offset1:17
    ds_read2_b32 v[38:39], v6 offset0:18 offset1:19
    ds_read2_b32 v[40:41], v6 offset0:32 offset1:33
    ds_read2_b32 v[42:43], v6 offset0:34 offset1:35
    ds_read2_b32 v[44:45], v6 offset0:48 offset1:49
    ds_read2_b32 v[46:47], v6 offset0:50 offset1:51
    ds_read2_b32 v[48:49], v6 offset0:64 offset1:65
    ds_read2_b32 v[50:51], v6 offset0:66 offset1:67
    ds_read2_b32 v[52:53], v6 offset0:80 offset1:81
    ds_read2_b32 v[54:55], v6 offset0:82 offset1:83
    ds_read2_b32 v[56:57], v6 offset0:96 offset1:97
    ds_read2_b32 v[58:59], v6 offset0:98 offset1:99
    ds_read2_b32 v[60:61], v6 offset0:112 offset1:113
    ds_read2_b32 v[62:63], v6 offset0:114 offset1:115
    ds_read2_b32 v[64:65], v6 offset0:128 offset1:129
    ds_read2_b32 v[66:67], v6 offset0:130 offset1:131
    ds_read2_b32 v[68:69], v6 offset0:144 offset1:145
    ds_read2_b32 v[70:71], v6 offset0:146 offset1:147
    ds_read2_b32 v[72:73], v6 offset0:160 offset1:161
    ds_read2_b32 v[74:75], v6 offset0:162 offset1:163
    ds_read2_b32 v[76:77], v6 offset0:176 offset1:177
    ds_read2_b32 v[78:79], v6 offset0:178 offset1:179
    ds_read2_b32 v[80:81], v6 offset0:192 offset1:193
    ds_read2_b32 v[82:83], v6 offset0:194 offset1:195
    ds_read2_b32 v[84:85], v6 offset0:208 offset1:209
    ds_read2_b32 v[86:87], v6 offset0:210 offset1:211
    ds_read2_b32 v[88:89], v6 offset0:224 offset1:225
    ds_read2_b32 v[90:91], v6 offset0:226 offset1:227
    ds_read2_b32 v[92:93], v6 offset0:240 offset1:241
    ds_read2_b32 v[94:95], v6 offset0:242 offset1:243
    ds_read2_b32 v[96:97], v7 offset0:96 offset1:97
    ds_read2_b32 v[98:99], v7 offset0:98 offset1:99
    ds_read2_b32 v[100:101], v11 offset0:32 offset1:33
    ds_read2_b32 v[102:103], v11 offset0:34 offset1:35
    ds_read2_b32 v[104:105], v11 offset0:96 offset1:97
    ds_read2_b32 v[106:107], v11 offset0:98 offset1:99
    v_lshlrev_b32 v18, 3, v3
    v_sub_u32 v18, v8, v18
    v_lshrrev_b32 v19, 2, v2
    v_lshl_add_u32 v19, v19, 2, v3
    v_and_b32 v28, 3, v2
    v_lshlrev_b32 v28, 4, v28
    v_lshlrev_b32 v19, s95, v19
    s_waitcnt lgkmcnt(0)
    v_mov_b32 v7, v18
    v_add_u32 v6, v19, v28
    v_xor_b32 v12, s96, v12
W_21:
    ds_read_b32 v18, v4 offset:16
    s_sub_u32 s39, s39, 1
    s_cbranch_scc1 KS_ABORT
    s_waitcnt lgkmcnt(0)
    v_cmp_ne_u32 vcc, s84, v18
    s_cbranch_vccnz W_21
    s_setprio 2
    ds_read_b128 v[108:111], v8 offset:448
    ds_read_b128 v[112:115], v8 offset:512
    ds_read_b128 v[116:119], v8 offset:576
    ds_read_b128 v[120:123], v8 offset:640
    ds_read_b128 v[124:127], v8 offset:704
    s_waitcnt lgkmcnt(4)
    v_mfma_f32_16x16x32_f16 v[20:23], v[32:35], v[108:111], 0
    ds_read_b128 v[108:111], v8 offset:768
    s_waitcnt lgkmcnt(4)
    v_mfma_f32_16x16x32_f16 v[20:23], v[36:39], v[112:115], v[20:23]
    ds_read_b128 v[112:115], v8 offset:832
    s_waitcnt lgkmcnt(4)
    v_mfma_f32_16x16x32_f16 v[20:23], v[40:43], v[116:119], v[20:23]
    ds_read_b128 v[116:119], v8 offset:896
    ds_read_b64 v[28:29], v7 offset:1504
    ds_read_b64 v[30:31], v7 offset:2016
    s_waitcnt lgkmcnt(6)
    v_mfma_f32_16x16x32_f16 v[20:23], v[44:47], v[120:123], v[20:23]
    ds_read_b128 v[120:123], v8 offset:960
    s_waitcnt lgkmcnt(6)
    v_mfma_f32_16x16x32_f16 v[20:23], v[48:51], v[124:127], v[20:23]
    ds_read_b128 v[124:127], v8 offset:1024
    s_waitcnt lgkmcnt(6)
    v_mfma_f32_16x16x32_f16 v[20:23], v[52:55], v[108:111], v[20:23]
    ds_read_b128 v[108:111], v8 offset:1088
    s_waitcnt lgkmcnt(6)
    v_mfma_f32_16x16x32_f16 v[20:23], v[56:59], v[112:115], v[20:23]
    s_waitcnt lgkmcnt(5)
    v_mfma_f32_16x16x32_f16 v[20:23], v[60:63], v[116:119], v[20:23]
    ds_read_b128 v[112:115], v8 offset:1152
    s_waitcnt lgkmcnt(3)
    v_mfma_f32_16x16x32_f16 v[20:23], v[64:67], v[120:123], v[20:23]
    v_mfma_f32_16x16x32_f16 v[24:27], v[32:35], v[120:123], 0
    ds_read_b128 v[116:119], v8 offset:1216
    v_fma_mix_f32 v120, v28, v17, 0 op_sel_hi:[1,0,0]
    v_fma_mix_f32 v121, v28, v17, 0 op_sel:[1,0,0] op_sel_hi:[1,0,0]
    s_waitcnt lgkmcnt(3)
    v_mfma_f32_16x16x32_f16 v[20:23], v[68:71], v[124:127], v[20:23]
    v_fma_mix_f32 v122, v29, v17, 0 op_sel_hi:[1,0,0]
    v_fma_mix_f32 v123, v29, v17, 0 op_sel:[1,0,0] op_sel_hi:[1,0,0]
    v_mfma_f32_16x16x32_f16 v[24:27], v[36:39], v[124:127], v[24:27]
    ds_read_b128 v[32:35], v8 offset:1280
    v_cvt_pk_bf16_f32 v28, v120, v121
    v_cvt_pk_bf16_f32 v29, v122, v123
    s_waitcnt lgkmcnt(3)
    v_mfma_f32_16x16x32_f16 v[20:23], v[72:75], v[108:111], v[20:23]
    v_lshlrev_b32 v120, 16, v28
    v_and_b32 v121, 0xffff0000, v28
    v_mfma_f32_16x16x32_f16 v[24:27], v[40:43], v[108:111], v[24:27]
    ds_read_b128 v[36:39], v8 offset:1344
    v_lshlrev_b32 v122, 16, v29
    v_and_b32 v123, 0xffff0000, v29
    s_waitcnt lgkmcnt(3)
    v_mfma_f32_16x16x32_f16 v[20:23], v[76:79], v[112:115], v[20:23]
    v_fma_mix_f32 v108, v30, v17, 0 op_sel_hi:[1,0,0]
    v_fma_mix_f32 v109, v30, v17, 0 op_sel:[1,0,0] op_sel_hi:[1,0,0]
    v_mfma_f32_16x16x32_f16 v[24:27], v[44:47], v[112:115], v[24:27]
    ds_read_b128 v[124:127], v8 offset:1408
    v_fma_mix_f32 v110, v31, v17, 0 op_sel_hi:[1,0,0]
    v_fma_mix_f32 v111, v31, v17, 0 op_sel:[1,0,0] op_sel_hi:[1,0,0]
    s_waitcnt lgkmcnt(3)
    v_mfma_f32_16x16x32_f16 v[20:23], v[80:83], v[116:119], v[20:23]
    v_cvt_pk_bf16_f32 v30, v108, v109
    v_cvt_pk_bf16_f32 v31, v110, v111
    v_mfma_f32_16x16x32_f16 v[24:27], v[48:51], v[116:119], v[24:27]
    ds_read_b128 v[40:43], v8 offset:1472
    v_lshlrev_b32 v108, 16, v30
    v_and_b32 v109, 0xffff0000, v30
    s_waitcnt lgkmcnt(3)
    v_mfma_f32_16x16x32_f16 v[20:23], v[84:87], v[32:35], v[20:23]
    v_lshlrev_b32 v110, 16, v31
    v_and_b32 v111, 0xffff0000, v31
    v_mfma_f32_16x16x32_f16 v[24:27], v[52:55], v[32:35], v[24:27]
    ds_read_b128 v[44:47], v8 offset:1536
    s_waitcnt lgkmcnt(3)
    v_mfma_f32_16x16x32_f16 v[20:23], v[88:91], v[36:39], v[20:23]
    ds_read_b128 v[112:115], v8 offset:1600
    v_mfma_f32_16x16x32_f16 v[24:27], v[56:59], v[36:39], v[24:27]
    ds_read_b128 v[48:51], v8 offset:1664
    s_waitcnt lgkmcnt(4)
    v_mfma_f32_16x16x32_f16 v[20:23], v[92:95], v[124:127], v[20:23]
    ds_read_b128 v[116:119], v8 offset:1728
    v_mfma_f32_16x16x32_f16 v[24:27], v[60:63], v[124:127], v[24:27]
    ds_read_b128 v[52:55], v8 offset:1792
    s_waitcnt lgkmcnt(5)
    v_mfma_f32_16x16x32_f16 v[20:23], v[96:99], v[40:43], v[20:23]
    ds_read_b128 v[32:35], v8 offset:1856
    v_mfma_f32_16x16x32_f16 v[24:27], v[64:67], v[40:43], v[24:27]
    ds_read_b32 v18, v14 offset:76
    ds_read_b128 v[56:59], v8 offset:1920
    s_waitcnt lgkmcnt(7)
    v_mfma_f32_16x16x32_f16 v[24:27], v[68:71], v[44:47], v[24:27]
    ds_read_b128 v[36:39], v8 offset:1984
    s_waitcnt lgkmcnt(7)
    v_mfma_f32_16x16x32_f16 v[24:27], v[72:75], v[112:115], v[24:27]
    ds_read2_b32 v[60:61], v11 offset0:16 offset1:17
    ds_read2_b32 v[62:63], v11 offset0:18 offset1:19
    s_waitcnt lgkmcnt(8)
    v_mfma_f32_16x16x32_f16 v[24:27], v[76:79], v[48:51], v[24:27]
    s_waitcnt lgkmcnt(4)
    v_cmp_ne_u32 vcc, s84, v18
    s_cbranch_vccnz WS_22
WB_23:
    ds_read_b64_tr_b16 v[124:125], v9 offset:0
    ds_read_b64_tr_b16 v[126:127], v9 offset:64
    ds_read_b64_tr_b16 v[64:65], v9 offset:3088
    ds_read_b64_tr_b16 v[66:67], v9 offset:3152
    v_mfma_f32_16x16x32_f16 v[24:27], v[80:83], v[116:119], v[24:27]
    v_mfma_f32_16x16x32_f16 v[24:27], v[84:87], v[52:55], v[24:27]
    ds_read_b64_tr_b16 v[40:41], v9 offset:512
    ds_read_b64_tr_b16 v[42:43], v9 offset:576
    ds_read2_b32 v[68:69], v11 offset0:80 offset1:81
    ds_read2_b32 v[70:71], v11 offset0:82 offset1:83
    v_mfma_f32_16x16x32_f16 v[24:27], v[88:91], v[32:35], v[24:27]
    s_waitcnt lgkmcnt(11)
    v_mfma_f32_16x16x32_f16 v[24:27], v[92:95], v[56:59], v[24:27]
    ds_read_b64_tr_b16 v[44:45], v9 offset:3600
    ds_read_b64_tr_b16 v[46:47], v9 offset:3664
    s_waitcnt lgkmcnt(12)
    v_mfma_f32_16x16x32_f16 v[24:27], v[96:99], v[36:39], v[24:27]
    s_waitcnt lgkmcnt(8)
    v_mfma_f32_16x16x32_f16 v[20:23], v[124:127], v[100:103], v[20:23]
    s_waitcnt lgkmcnt(6)
    v_mfma_f32_16x16x32_f16 v[20:23], v[64:67], v[104:107], v[20:23]
    v_mfma_f32_16x16x32_f16 v[24:27], v[124:127], v[60:63], v[24:27]
    s_waitcnt lgkmcnt(4)
    v_mfma_f32_16x16x32_f16 v[24:27], v[40:43], v[100:103], v[24:27]
    s_nop 4
    v_mul_f32 v20, v20, v16
    v_mul_f32 v21, v21, v16
    s_waitcnt lgkmcnt(2)
    v_mfma_f32_16x16x32_f16 v[24:27], v[64:67], v[68:71], v[24:27]
    v_mul_f32 v22, v22, v16
    v_mul_f32 v23, v23, v16
    s_waitcnt lgkmcnt(0)
    v_mfma_f32_16x16x32_f16 v[24:27], v[44:47], v[104:107], v[24:27]
    v_cvt_pk_bf16_f32 v28, v20, v21
    v_cvt_pk_bf16_f32 v29, v22, v23
    v_lshlrev_b32 v20, 16, v28
    v_and_b32 v21, 0xffff0000, v28
    v_lshlrev_b32 v22, 16, v29
    v_and_b32 v23, 0xffff0000, v29
    v_add_f32 v20, v20, v120
    v_add_f32 v21, v21, v121
    v_add_f32 v22, v22, v122
    v_add_f32 v23, v23, v123
    v_cvt_pk_bf16_f32 v28, v20, v21
    v_cvt_pk_bf16_f32 v29, v22, v23
    v_min_u32 v28, -2, v28
    v_min_u32 v29, -2, v29
    ds_read_b32 v19, v4 offset:188
    ds_read_u8 v18, v4 offset:161
    ds_read_b128 v[20:23], v12 offset:47616
    v_mul_f32 v24, v24, v16
    v_mul_f32 v25, v25, v16
    v_mul_f32 v26, v26, v16
    v_mul_f32 v27, v27, v16
    v_cvt_pk_bf16_f32 v30, v24, v25
    v_cvt_pk_bf16_f32 v31, v26, v27
    v_lshlrev_b32 v24, 16, v30
    v_and_b32 v25, 0xffff0000, v30
    v_lshlrev_b32 v26, 16, v31
    v_and_b32 v27, 0xffff0000, v31
    v_add_f32 v24, v24, v108
    v_add_f32 v25, v25, v109
    v_add_f32 v26, v26, v110
    v_add_f32 v27, v27, v111
    v_cvt_pk_bf16_f32 v30, v24, v25
    v_cvt_pk_bf16_f32 v31, v26, v27
    v_min_u32 v30, -2, v30
    v_min_u32 v31, -2, v31
    s_branch CVE_19
CV_17:
    ds_read2_b32 v[32:33], v7 offset0:128 offset1:129
    ds_read2_b32 v[34:35], v7 offset0:130 offset1:131
    ds_read2_b32 v[36:37], v6 offset0:0 offset1:1
    ds_read2_b32 v[38:39], v6 offset0:2 offset1:3
    ds_read2_b32 v[40:41], v6 offset0:16 offset1:17
    ds_read2_b32 v[42:43], v6 offset0:18 offset1:19
    ds_read2_b32 v[44:45], v6 offset0:32 offset1:33
    ds_read2_b32 v[46:47], v6 offset0:34 offset1:35
    ds_read2_b32 v[48:49], v6 offset0:48 offset1:49
    ds_read2_b32 v[50:51], v6 offset0:50 offset1:51
    ds_read2_b32 v[52:53], v6 offset0:64 offset1:65
    ds_read2_b32 v[54:55], v6 offset0:66 offset1:67
    ds_read2_b32 v[56:57], v6 offset0:80 offset1:81
    ds_read2_b32 v[58:59], v6 offset0:82 offset1:83
    ds_read2_b32 v[60:61], v6 offset0:96 offset1:97
    ds_read2_b32 v[62:63], v6 offset0:98 offset1:99
    ds_read2_b32 v[64:65], v6 offset0:112 offset1:113
    ds_read2_b32 v[66:67], v6 offset0:114 offset1:115
    ds_read2_b32 v[68:69], v6 offset0:128 offset1:129
    ds_read2_b32 v[70:71], v6 offset0:130 offset1:131
    ds_read2_b32 v[72:73], v6 offset0:144 offset1:145
    ds_read2_b32 v[74:75], v6 offset0:146 offset1:147
    ds_read2_b32 v[76:77], v6 offset0:160 offset1:161
    ds_read2_b32 v[78:79], v6 offset0:162 offset1:163
    ds_read2_b32 v[80:81], v6 offset0:176 offset1:177
    ds_read2_b32 v[82:83], v6 offset0:178 offset1:179
    ds_read2_b32 v[84:85], v6 offset0:192 offset1:193
    ds_read2_b32 v[86:87], v6 offset0:194 offset1:195
    ds_read2_b32 v[88:89], v6 offset0:208 offset1:209
    ds_read2_b32 v[90:91], v6 offset0:210 offset1:211
    ds_read2_b32 v[92:93], v6 offset0:224 offset1:225
    ds_read2_b32 v[94:95], v6 offset0:226 offset1:227
    ds_read2_b32 v[96:97], v6 offset0:240 offset1:241
    ds_read2_b32 v[98:99], v6 offset0:242 offset1:243
    ds_read2_b32 v[100:101], v7 offset0:96 offset1:97
    ds_read2_b32 v[102:103], v7 offset0:98 offset1:99
    ds_read2_b32 v[104:105], v11 offset0:0 offset1:1
    ds_read2_b32 v[106:107], v11 offset0:2 offset1:3
    v_lshlrev_b32 v18, 3, v3
    v_sub_u32 v18, v8, v18
    v_lshrrev_b32 v19, 2, v2
    v_lshl_add_u32 v19, v19, 2, v3
    v_and_b32 v28, 3, v2
    v_lshlrev_b32 v28, 4, v28
    v_lshlrev_b32 v19, s95, v19
    s_waitcnt lgkmcnt(0)
    v_mov_b32 v7, v18
    v_add_u32 v6, v19, v28
    v_xor_b32 v12, s96, v12
W_24:
    ds_read_b32 v18, v4 offset:16
    s_sub_u32 s39, s39, 1
    s_cbranch_scc1 KS_ABORT
    s_waitcnt lgkmcnt(0)
    v_cmp_ne_u32 vcc, s84, v18
    s_cbranch_vccnz W_24
    s_setprio 2
    ds_read_b128 v[108:111], v8 offset:448
    ds_read_b128 v[112:115], v8 offset:960
    ds_read_b128 v[116:119], v8 offset:1472
    ds_read_b128 v[120:123], v8 offset:1536
    ds_read_b128 v[124:127], v8 offset:1600
    s_waitcnt lgkmcnt(4)
    v_mfma_f32_16x16x32_f16 v[20:23], v[32:35], v[108:111], 0
    ds_read_b128 v[108:111], v8 offset:1664
    s_waitcnt lgkmcnt(4)
    v_mfma_f32_16x16x32_f16 v[24:27], v[32:35], v[112:115], 0
    ds_read_b128 v[32:35], v8 offset:1728
    ds_read_b128 v[112:115], v8 offset:1792
    s_waitcnt lgkmcnt(5)
    v_mfma_f32_16x16x32_f16 v[20:23], v[36:39], v[116:119], v[20:23]
    ds_read_b128 v[116:119], v8 offset:1856
    ds_read_b64 v[28:29], v7 offset:2528
    ds_read_b64 v[30:31], v7 offset:3040
    s_waitcnt lgkmcnt(7)
    v_mfma_f32_16x16x32_f16 v[20:23], v[40:43], v[120:123], v[20:23]
    ds_read_b128 v[120:123], v8 offset:1920
    s_waitcnt lgkmcnt(7)
    v_mfma_f32_16x16x32_f16 v[20:23], v[44:47], v[124:127], v[20:23]
    ds_read_b128 v[124:127], v8 offset:1984
    s_waitcnt lgkmcnt(7)
    v_mfma_f32_16x16x32_f16 v[20:23], v[48:51], v[108:111], v[20:23]
    ds_read_b128 v[108:111], v8 offset:2048
    s_waitcnt lgkmcnt(7)
    v_mfma_f32_16x16x32_f16 v[20:23], v[52:55], v[32:35], v[20:23]
    s_waitcnt lgkmcnt(6)
    v_mfma_f32_16x16x32_f16 v[20:23], v[56:59], v[112:115], v[20:23]
    ds_read_b128 v[32:35], v8 offset:2112
    s_waitcnt lgkmcnt(6)
    v_mfma_f32_16x16x32_f16 v[20:23], v[60:63], v[116:119], v[20:23]
    s_waitcnt lgkmcnt(4)
    v_fma_mix_f32 v116, v28, v17, 0 op_sel_hi:[1,0,0]
    v_fma_mix_f32 v117, v28, v17, 0 op_sel:[1,0,0] op_sel_hi:[1,0,0]
    s_waitcnt lgkmcnt(3)
    v_mfma_f32_16x16x32_f16 v[20:23], v[64:67], v[120:123], v[20:23]
    ds_read_b128 v[112:115], v8 offset:2176
    v_fma_mix_f32 v118, v29, v17, 0 op_sel_hi:[1,0,0]
    v_fma_mix_f32 v119, v29, v17, 0 op_sel:[1,0,0] op_sel_hi:[1,0,0]
    s_waitcnt lgkmcnt(3)
    v_mfma_f32_16x16x32_f16 v[20:23], v[68:71], v[124:127], v[20:23]
    v_cvt_pk_bf16_f32 v28, v116, v117
    v_cvt_pk_bf16_f32 v29, v118, v119
    v_mfma_f32_16x16x32_f16 v[24:27], v[36:39], v[124:127], v[24:27]
    ds_read_b128 v[120:123], v8 offset:2240
    v_lshlrev_b32 v116, 16, v28
    v_and_b32 v117, 0xffff0000, v28
    s_waitcnt lgkmcnt(3)
    v_mfma_f32_16x16x32_f16 v[20:23], v[72:75], v[108:111], v[20:23]
    v_lshlrev_b32 v118, 16, v29
    v_and_b32 v119, 0xffff0000, v29
    v_mfma_f32_16x16x32_f16 v[24:27], v[40:43], v[108:111], v[24:27]
    ds_read_b128 v[36:39], v8 offset:2304
    v_fma_mix_f32 v108, v30, v17, 0 op_sel_hi:[1,0,0]
    v_fma_mix_f32 v109, v30, v17, 0 op_sel:[1,0,0] op_sel_hi:[1,0,0]
    s_waitcnt lgkmcnt(3)
    v_mfma_f32_16x16x32_f16 v[20:23], v[76:79], v[32:35], v[20:23]
    v_fma_mix_f32 v110, v31, v17, 0 op_sel_hi:[1,0,0]
    v_fma_mix_f32 v111, v31, v17, 0 op_sel:[1,0,0] op_sel_hi:[1,0,0]
    v_mfma_f32_16x16x32_f16 v[24:27], v[44:47], v[32:35], v[24:27]
    ds_read_b128 v[124:127], v8 offset:2368
    v_cvt_pk_bf16_f32 v30, v108, v109
    v_cvt_pk_bf16_f32 v31, v110, v111
    s_waitcnt lgkmcnt(3)
    v_mfma_f32_16x16x32_f16 v[20:23], v[80:83], v[112:115], v[20:23]
    v_lshlrev_b32 v108, 16, v30
    v_and_b32 v109, 0xffff0000, v30
    v_mfma_f32_16x16x32_f16 v[24:27], v[48:51], v[112:115], v[24:27]
    ds_read_b128 v[40:43], v8 offset:2432
    v_lshlrev_b32 v110, 16, v31
    v_and_b32 v111, 0xffff0000, v31
    s_waitcnt lgkmcnt(3)
    v_mfma_f32_16x16x32_f16 v[20:23], v[84:87], v[120:123], v[20:23]
    v_mfma_f32_16x16x32_f16 v[24:27], v[52:55], v[120:123], v[24:27]
    ds_read_b128 v[44:47], v8 offset:2496
    s_waitcnt lgkmcnt(3)
    v_mfma_f32_16x16x32_f16 v[20:23], v[88:91], v[36:39], v[20:23]
    v_mfma_f32_16x16x32_f16 v[24:27], v[56:59], v[36:39], v[24:27]
    ds_read_b128 v[32:35], v8 offset:2560
    s_waitcnt lgkmcnt(3)
    v_mfma_f32_16x16x32_f16 v[20:23], v[92:95], v[124:127], v[20:23]
    ds_read_b128 v[48:51], v8 offset:2624
    v_mfma_f32_16x16x32_f16 v[24:27], v[60:63], v[124:127], v[24:27]
    ds_read_b128 v[112:115], v8 offset:2688
    s_waitcnt lgkmcnt(4)
    v_mfma_f32_16x16x32_f16 v[20:23], v[96:99], v[40:43], v[20:23]
    ds_read_b128 v[52:55], v8 offset:2752
    v_mfma_f32_16x16x32_f16 v[24:27], v[64:67], v[40:43], v[24:27]
    ds_read_b128 v[120:123], v8 offset:2816
    s_waitcnt lgkmcnt(5)
    v_mfma_f32_16x16x32_f16 v[20:23], v[100:103], v[44:47], v[20:23]
    ds_read_b128 v[56:59], v8 offset:2880
    v_mfma_f32_16x16x32_f16 v[24:27], v[68:71], v[44:47], v[24:27]
    ds_read_b32 v18, v14 offset:76
    ds_read_b128 v[36:39], v8 offset:2944
    s_waitcnt lgkmcnt(7)
    v_mfma_f32_16x16x32_f16 v[24:27], v[72:75], v[32:35], v[24:27]
    ds_read_b128 v[60:63], v8 offset:3008
    s_waitcnt lgkmcnt(7)
    v_mfma_f32_16x16x32_f16 v[24:27], v[76:79], v[48:51], v[24:27]
    ds_read2_b32 v[124:125], v11 offset0:16 offset1:17
    ds_read2_b32 v[126:127], v11 offset0:18 offset1:19
    ds_read2_b32 v[64:65], v11 offset0:32 offset1:33
    ds_read2_b32 v[66:67], v11 offset0:34 offset1:35
    s_waitcnt lgkmcnt(10)
    v_mfma_f32_16x16x32_f16 v[24:27], v[80:83], v[112:115], v[24:27]
    s_waitcnt lgkmcnt(6)
    v_cmp_ne_u32 vcc, s84, v18
    s_cbranch_vccnz WS_25
WB_26:
    ds_read_b64_tr_b16 v[40:41], v9 offset:0
    ds_read_b64_tr_b16 v[42:43], v9 offset:64
    ds_read_b64_tr_b16 v[68:69], v9 offset:512
    ds_read_b64_tr_b16 v[70:71], v9 offset:576
    v_mfma_f32_16x16x32_f16 v[24:27], v[84:87], v[52:55], v[24:27]
    ds_read_b64_tr_b16 v[44:45], v9 offset:1024
    ds_read_b64_tr_b16 v[46:47], v9 offset:1088
    v_mfma_f32_16x16x32_f16 v[24:27], v[88:91], v[120:123], v[24:27]
    ds_read_b64_tr_b16 v[72:73], v9 offset:3088
    ds_read_b64_tr_b16 v[74:75], v9 offset:3152
    ds_read2_b32 v[32:33], v11 offset0:64 offset1:65
    ds_read2_b32 v[34:35], v11 offset0:66 offset1:67
    v_mfma_f32_16x16x32_f16 v[24:27], v[92:95], v[56:59], v[24:27]
    ds_read_b64_tr_b16 v[76:77], v9 offset:3600
    ds_read_b64_tr_b16 v[78:79], v9 offset:3664
    ds_read2_b32 v[48:49], v11 offset0:80 offset1:81
    ds_read2_b32 v[50:51], v11 offset0:82 offset1:83
    v_mfma_f32_16x16x32_f16 v[24:27], v[96:99], v[36:39], v[24:27]
    ds_read_b64_tr_b16 v[80:81], v9 offset:4112
    ds_read_b64_tr_b16 v[82:83], v9 offset:4176
    ds_read2_b32 v[112:113], v11 offset0:96 offset1:97
    ds_read2_b32 v[114:115], v11 offset0:98 offset1:99
    v_mfma_f32_16x16x32_f16 v[24:27], v[100:103], v[60:63], v[24:27]
    ds_read_b64_tr_b16 v[84:85], v10 offset:6176
    ds_read_b64_tr_b16 v[86:87], v10 offset:6304
    ds_read2_b32 v[52:53], v13 offset0:24 offset1:25
    ds_read2_b32 v[54:55], v13 offset0:26 offset1:27
    v_mfma_f32_16x16x32_f16 v[20:23], v[40:43], v[104:107], v[20:23]
    ds_read_b64_tr_b16 v[88:89], v10 offset:8224
    ds_read_b64_tr_b16 v[90:91], v10 offset:8352
    ds_read2_b32 v[120:121], v13 offset0:120 offset1:121
    ds_read2_b32 v[122:123], v13 offset0:122 offset1:123
    v_mfma_f32_16x16x32_f16 v[20:23], v[68:71], v[124:127], v[20:23]
    v_mfma_f32_16x16x32_f16 v[20:23], v[44:47], v[64:67], v[20:23]
    v_mfma_f32_16x16x32_f16 v[20:23], v[72:75], v[32:35], v[20:23]
    ds_read_b64_tr_b16 v[92:93], v9 offset:1536
    ds_read_b64_tr_b16 v[94:95], v9 offset:1600
    s_waitcnt lgkmcnt(14)
    v_mfma_f32_16x16x32_f16 v[20:23], v[76:79], v[48:51], v[20:23]
    s_waitcnt lgkmcnt(10)
    v_mfma_f32_16x16x32_f16 v[20:23], v[80:83], v[112:115], v[20:23]
    s_waitcnt lgkmcnt(6)
    v_mfma_f32_16x16x32_f16 v[20:23], v[84:87], v[52:55], v[20:23]
    ds_read_b64_tr_b16 v[56:57], v9 offset:4624
    ds_read_b64_tr_b16 v[58:59], v9 offset:4688
    ds_read2_b32 v[96:97], v13 offset0:16 offset1:17
    ds_read2_b32 v[98:99], v13 offset0:18 offset1:19
    s_waitcnt lgkmcnt(6)
    v_mfma_f32_16x16x32_f16 v[20:23], v[88:91], v[120:123], v[20:23]
    ds_read2_b32 v[36:37], v13 offset0:112 offset1:113
    ds_read2_b32 v[38:39], v13 offset0:114 offset1:115
    v_mfma_f32_16x16x32_f16 v[24:27], v[68:71], v[104:107], v[24:27]
    v_mfma_f32_16x16x32_f16 v[24:27], v[44:47], v[124:127], v[24:27]
    s_nop 3
    v_mul_f32 v20, v20, v16
    v_mul_f32 v21, v21, v16
    s_waitcnt lgkmcnt(6)
    v_mfma_f32_16x16x32_f16 v[24:27], v[92:95], v[64:67], v[24:27]
    v_mul_f32 v22, v22, v16
    v_mul_f32 v23, v23, v16
    v_mfma_f32_16x16x32_f16 v[24:27], v[76:79], v[32:35], v[24:27]
    v_cvt_pk_bf16_f32 v28, v20, v21
    v_cvt_pk_bf16_f32 v29, v22, v23
    v_mfma_f32_16x16x32_f16 v[24:27], v[80:83], v[48:51], v[24:27]
    v_lshlrev_b32 v20, 16, v28
    v_and_b32 v21, 0xffff0000, v28
    s_waitcnt lgkmcnt(4)
    v_mfma_f32_16x16x32_f16 v[24:27], v[56:59], v[112:115], v[24:27]
    v_lshlrev_b32 v22, 16, v29
    v_and_b32 v23, 0xffff0000, v29
    s_waitcnt lgkmcnt(2)
    v_mfma_f32_16x16x32_f16 v[24:27], v[84:87], v[96:99], v[24:27]
    v_add_f32 v20, v20, v116
    v_add_f32 v21, v21, v117
    s_waitcnt lgkmcnt(0)
    v_mfma_f32_16x16x32_f16 v[24:27], v[88:91], v[36:39], v[24:27]
    v_add_f32 v22, v22, v118
    v_add_f32 v23, v23, v119
    v_cvt_pk_bf16_f32 v28, v20, v21
    v_cvt_pk_bf16_f32 v29, v22, v23
    v_min_u32 v28, -2, v28
    v_min_u32 v29, -2, v29
    ds_read_b32 v19, v4 offset:188
    ds_read_u8 v18, v4 offset:162
    ds_read_b128 v[20:23], v12 offset:48640
    v_mul_f32 v24, v24, v16
    v_mul_f32 v25, v25, v16
    v_mul_f32 v26, v26, v16
    v_mul_f32 v27, v27, v16
    v_cvt_pk_bf16_f32 v30, v24, v25
    v_cvt_pk_bf16_f32 v31, v26, v27
    v_lshlrev_b32 v24, 16, v30
    v_and_b32 v25, 0xffff0000, v30
    v_lshlrev_b32 v26, 16, v31
    v_and_b32 v27, 0xffff0000, v31
    v_add_f32 v24, v24, v108
    v_add_f32 v25, v25, v109
    v_add_f32 v26, v26, v110
    v_add_f32 v27, v27, v111
    v_cvt_pk_bf16_f32 v30, v24, v25
    v_cvt_pk_bf16_f32 v31, v26, v27
    v_min_u32 v30, -2, v30
    v_min_u32 v31, -2, v31
    s_branch CVE_19
CV_18:
    ds_read2_b32 v[32:33], v7 offset0:128 offset1:129
    ds_read2_b32 v[34:35], v7 offset0:130 offset1:131
    ds_read2_b32 v[36:37], v6 offset0:0 offset1:1
    ds_read2_b32 v[38:39], v6 offset0:2 offset1:3
    ds_read2_b32 v[40:41], v6 offset0:16 offset1:17
    ds_read2_b32 v[42:43], v6 offset0:18 offset1:19
    ds_read2_b32 v[44:45], v6 offset0:32 offset1:33
    ds_read2_b32 v[46:47], v6 offset0:34 offset1:35
    ds_read2_b32 v[48:49], v6 offset0:48 offset1:49
    ds_read2_b32 v[50:51], v6 offset0:50 offset1:51
    ds_read2_b32 v[52:53], v6 offset0:64 offset1:65
    ds_read2_b32 v[54:55], v6 offset0:66 offset1:67
    ds_read2_b32 v[56:57], v6 offset0:80 offset1:81
    ds_read2_b32 v[58:59], v6 offset0:82 offset1:83
    ds_read2_b32 v[60:61], v6 offset0:96 offset1:97
    ds_read2_b32 v[62:63], v6 offset0:98 offset1:99
    ds_read2_b32 v[64:65], v6 offset0:112 offset1:113
    ds_read2_b32 v[66:67], v6 offset0:114 offset1:115
    ds_read2_b32 v[68:69], v6 offset0:128 offset1:129
    ds_read2_b32 v[70:71], v6 offset0:130 offset1:131
    ds_read2_b32 v[72:73], v6 offset0:144 offset1:145
    ds_read2_b32 v[74:75], v6 offset0:146 offset1:147
    ds_read2_b32 v[76:77], v6 offset0:160 offset1:161
    ds_read2_b32 v[78:79], v6 offset0:162 offset1:163
    ds_read2_b32 v[80:81], v6 offset0:176 offset1:177
    ds_read2_b32 v[82:83], v6 offset0:178 offset1:179
    ds_read2_b32 v[84:85], v6 offset0:192 offset1:193
    ds_read2_b32 v[86:87], v6 offset0:194 offset1:195
    ds_read2_b32 v[88:89], v6 offset0:208 offset1:209
    ds_read2_b32 v[90:91], v6 offset0:210 offset1:211
    ds_read2_b32 v[92:93], v6 offset0:224 offset1:225
    ds_read2_b32 v[94:95], v6 offset0:226 offset1:227
    ds_read2_b32 v[96:97], v6 offset0:240 offset1:241
    ds_read2_b32 v[98:99], v6 offset0:242 offset1:243
    ds_read2_b32 v[100:101], v7 offset0:96 offset1:97
    ds_read2_b32 v[102:103], v7 offset0:98 offset1:99
    ds_read2_b32 v[104:105], v11 offset0:0 offset1:1
    ds_read2_b32 v[106:107], v11 offset0:2 offset1:3
    v_lshlrev_b32 v18, 3, v3
    v_sub_u32 v18, v8, v18
    v_lshrrev_b32 v19, 2, v2
    v_lshl_add_u32 v19, v19, 2, v3
    v_and_b32 v28, 3, v2
    v_lshlrev_b32 v28, 4, v28
    v_lshlrev_b32 v19, s95, v19
    s_waitcnt lgkmcnt(0)
    v_mov_b32 v7, v18
    v_add_u32 v6, v19, v28
    v_xor_b32 v12, s96, v12
W_27:
    ds_read_b32 v18, v4 offset:16
    s_sub_u32 s39, s39, 1
    s_cbranch_scc1 KS_ABORT
    s_waitcnt lgkmcnt(0)
    v_cmp_ne_u32 vcc, s84, v18
    s_cbranch_vccnz W_27
    s_setprio 2
    ds_read_b128 v[108:111], v8 offset:1472
    ds_read_b128 v[112:115], v8 offset:1984
    ds_read_b128 v[116:119], v8 offset:2496
    ds_read_b128 v[120:123], v8 offset:2560
    ds_read_b128 v[124:127], v8 offset:2624
    s_waitcnt lgkmcnt(4)
    v_mfma_f32_16x16x32_f16 v[20:23], v[32:35], v[108:111], 0
    ds_read_b128 v[108:111], v8 offset:2688
    s_waitcnt lgkmcnt(4)
    v_mfma_f32_16x16x32_f16 v[24:27], v[32:35], v[112:115], 0
    ds_read_b128 v[32:35], v8 offset:2752
    ds_read_b128 v[112:115], v8 offset:2816
    s_waitcnt lgkmcnt(5)
    v_mfma_f32_16x16x32_f16 v[20:23], v[36:39], v[116:119], v[20:23]
    ds_read_b128 v[116:119], v8 offset:2880
    ds_read_b64 v[28:29], v7 offset:3552
    ds_read_b64 v[30:31], v7 offset:4064
    s_waitcnt lgkmcnt(7)
    v_mfma_f32_16x16x32_f16 v[20:23], v[40:43], v[120:123], v[20:23]
    ds_read_b128 v[120:123], v8 offset:2944
    s_waitcnt lgkmcnt(7)
    v_mfma_f32_16x16x32_f16 v[20:23], v[44:47], v[124:127], v[20:23]
    ds_read_b128 v[124:127], v8 offset:3008
    s_waitcnt lgkmcnt(7)
    v_mfma_f32_16x16x32_f16 v[20:23], v[48:51], v[108:111], v[20:23]
    ds_read_b128 v[108:111], v8 offset:3072
    s_waitcnt lgkmcnt(7)
    v_mfma_f32_16x16x32_f16 v[20:23], v[52:55], v[32:35], v[20:23]
    s_waitcnt lgkmcnt(6)
    v_mfma_f32_16x16x32_f16 v[20:23], v[56:59], v[112:115], v[20:23]
    ds_read_b128 v[32:35], v8 offset:3136
    s_waitcnt lgkmcnt(6)
    v_mfma_f32_16x16x32_f16 v[20:23], v[60:63], v[116:119], v[20:23]
    s_waitcnt lgkmcnt(4)
    v_fma_mix_f32 v116, v28, v17, 0 op_sel_hi:[1,0,0]
    v_fma_mix_f32 v117, v28, v17, 0 op_sel:[1,0,0] op_sel_hi:[1,0,0]
    s_waitcnt lgkmcnt(3)
    v_mfma_f32_16x16x32_f16 v[20:23], v[64:67], v[120:123], v[20:23]
    ds_read_b128 v[112:115], v8 offset:3200
    v_fma_mix_f32 v118, v29, v17, 0 op_sel_hi:[1,0,0]
    v_fma_mix_f32 v119, v29, v17, 0 op_sel:[1,0,0] op_sel_hi:[1,0,0]
    s_waitcnt lgkmcnt(3)
    v_mfma_f32_16x16x32_f16 v[20:23], v[68:71], v[124:127], v[20:23]
    v_cvt_pk_bf16_f32 v28, v116, v117
    v_cvt_pk_bf16_f32 v29, v118, v119
    v_mfma_f32_16x16x32_f16 v[24:27], v[36:39], v[124:127], v[24:27]
    ds_read_b128 v[120:123], v8 offset:3264
    v_lshlrev_b32 v116, 16, v28
    v_and_b32 v117, 0xffff0000, v28
    s_waitcnt lgkmcnt(3)
    v_mfma_f32_16x16x32_f16 v[20:23], v[72:75], v[108:111], v[20:23]
    v_lshlrev_b32 v118, 16, v29
    v_and_b32 v119, 0xffff0000, v29
    v_mfma_f32_16x16x32_f16 v[24:27], v[40:43], v[108:111], v[24:27]
    ds_read_b128 v[36:39], v8 offset:3328
    v_fma_mix_f32 v108, v30, v17, 0 op_sel_hi:[1,0,0]
    v_fma_mix_f32 v109, v30, v17, 0 op_sel:[1,0,0] op_sel_hi:[1,0,0]
    s_waitcnt lgkmcnt(3)
    v_mfma_f32_16x16x32_f16 v[20:23], v[76:79], v[32:35], v[20:23]
    v_fma_mix_f32 v110, v31, v17, 0 op_sel_hi:[1,0,0]
    v_fma_mix_f32 v111, v31, v17, 0 op_sel:[1,0,0] op_sel_hi:[1,0,0]
    v_mfma_f32_16x16x32_f16 v[24:27], v[44:47], v[32:35], v[24:27]
    ds_read_b128 v[124:127], v8 offset:3392
    v_cvt_pk_bf16_f32 v30, v108, v109
    v_cvt_pk_bf16_f32 v31, v110, v111
    s_waitcnt lgkmcnt(3)
    v_mfma_f32_16x16x32_f16 v[20:23], v[80:83], v[112:115], v[20:23]
    v_lshlrev_b32 v108, 16, v30
    v_and_b32 v109, 0xffff0000, v30
    v_mfma_f32_16x16x32_f16 v[24:27], v[48:51], v[112:115], v[24:27]
    ds_read_b128 v[40:43], v8 offset:3456
    v_lshlrev_b32 v110, 16, v31
    v_and_b32 v111, 0xffff0000, v31
    s_waitcnt lgkmcnt(3)
    v_mfma_f32_16x16x32_f16 v[20:23], v[84:87], v[120:123], v[20:23]
    v_mfma_f32_16x16x32_f16 v[24:27], v[52:55], v[120:123], v[24:27]
    ds_read_b128 v[44:47], v8 offset:3520
    s_waitcnt lgkmcnt(3)
    v_mfma_f32_16x16x32_f16 v[20:23], v[88:91], v[36:39], v[20:23]
    v_mfma_f32_16x16x32_f16 v[24:27], v[56:59], v[36:39], v[24:27]
    ds_read_b128 v[32:35], v8 offset:3584
    s_waitcnt lgkmcnt(3)
    v_mfma_f32_16x16x32_f16 v[20:23], v[92:95], v[124:127], v[20:23]
    ds_read_b128 v[48:51], v8 offset:3648
    v_mfma_f32_16x16x32_f16 v[24:27], v[60:63], v[124:127], v[24:27]
    ds_read_b128 v[112:115], v8 offset:3712
    s_waitcnt lgkmcnt(4)
    v_mfma_f32_16x16x32_f16 v[20:23], v[96:99], v[40:43], v[20:23]
    ds_read_b128 v[52:55], v8 offset:3776
    v_mfma_f32_16x16x32_f16 v[24:27], v[64:67], v[40:43], v[24:27]
    ds_read_b128 v[120:123], v8 offset:3840
    s_waitcnt lgkmcnt(5)
    v_mfma_f32_16x16x32_f16 v[20:23], v[100:103], v[44:47], v[20:23]
    ds_read_b128 v[56:59], v8 offset:3904
    v_mfma_f32_16x16x32_f16 v[24:27], v[68:71], v[44:47], v[24:27]
    ds_read_b32 v18, v14 offset:76
    ds_read_b128 v[36:39], v8 offset:3968
    s_waitcnt lgkmcnt(7)
    v_mfma_f32_16x16x32_f16 v[24:27], v[72:75], v[32:35], v[24:27]
    ds_read_b128 v[60:63], v8 offset:4032
    s_waitcnt lgkmcnt(7)
    v_mfma_f32_16x16x32_f16 v[24:27], v[76:79], v[48:51], v[24:27]
    ds_read2_b32 v[124:125], v11 offset0:16 offset1:17
    ds_read2_b32 v[126:127], v11 offset0:18 offset1:19
    ds_read2_b32 v[64:65], v11 offset0:32 offset1:33
    ds_read2_b32 v[66:67], v11 offset0:34 offset1:35
    s_waitcnt lgkmcnt(10)
    v_mfma_f32_16x16x32_f16 v[24:27], v[80:83], v[112:115], v[24:27]
    s_waitcnt lgkmcnt(6)
    v_cmp_ne_u32 vcc, s84, v18
    s_cbranch_vccnz WS_28
WB_29:
    ds_read_b64_tr_b16 v[40:41], v9 offset:1024
    ds_read_b64_tr_b16 v[42:43], v9 offset:1088
    ds_read_b64_tr_b16 v[68:69], v9 offset:1536
    ds_read_b64_tr_b16 v[70:71], v9 offset:1600
    v_mfma_f32_16x16x32_f16 v[24:27], v[84:87], v[52:55], v[24:27]
    ds_read_b64_tr_b16 v[44:45], v9 offset:2048
    ds_read_b64_tr_b16 v[46:47], v9 offset:2112
    v_mfma_f32_16x16x32_f16 v[24:27], v[88:91], v[120:123], v[24:27]
    ds_read_b64_tr_b16 v[72:73], v9 offset:4112
    ds_read_b64_tr_b16 v[74:75], v9 offset:4176
    ds_read2_b32 v[32:33], v11 offset0:64 offset1:65
    ds_read2_b32 v[34:35], v11 offset0:66 offset1:67
    v_mfma_f32_16x16x32_f16 v[24:27], v[92:95], v[56:59], v[24:27]
    ds_read_b64_tr_b16 v[76:77], v9 offset:4624
    ds_read_b64_tr_b16 v[78:79], v9 offset:4688
    ds_read2_b32 v[48:49], v11 offset0:80 offset1:81
    ds_read2_b32 v[50:51], v11 offset0:82 offset1:83
    v_mfma_f32_16x16x32_f16 v[24:27], v[96:99], v[36:39], v[24:27]
    ds_read_b64_tr_b16 v[80:81], v9 offset:5136
    ds_read_b64_tr_b16 v[82:83], v9 offset:5200
    ds_read2_b32 v[112:113], v11 offset0:96 offset1:97
    ds_read2_b32 v[114:115], v11 offset0:98 offset1:99
    v_mfma_f32_16x16x32_f16 v[24:27], v[100:103], v[60:63], v[24:27]
    ds_read_b64_tr_b16 v[84:85], v10 offset:6176
    ds_read_b64_tr_b16 v[86:87], v10 offset:6304
    ds_read2_b32 v[52:53], v13 offset0:8 offset1:9
    ds_read2_b32 v[54:55], v13 offset0:10 offset1:11
    v_mfma_f32_16x16x32_f16 v[20:23], v[40:43], v[104:107], v[20:23]
    ds_read_b64_tr_b16 v[88:89], v10 offset:7200
    ds_read_b64_tr_b16 v[90:91], v10 offset:7328
    ds_read2_b32 v[120:121], v13 offset0:24 offset1:25
    ds_read2_b32 v[122:123], v13 offset0:26 offset1:27
    v_mfma_f32_16x16x32_f16 v[20:23], v[68:71], v[124:127], v[20:23]
    ds_read_b64_tr_b16 v[92:93], v10 offset:8224
    ds_read_b64_tr_b16 v[94:95], v10 offset:8352
    ds_read2_b32 v[56:57], v13 offset0:104 offset1:105
    ds_read2_b32 v[58:59], v13 offset0:106 offset1:107
    v_mfma_f32_16x16x32_f16 v[20:23], v[44:47], v[64:67], v[20:23]
    ds_read_b64_tr_b16 v[96:97], v10 offset:9248
    ds_read_b64_tr_b16 v[98:99], v10 offset:9376
    ds_read2_b32 v[36:37], v13 offset0:120 offset1:121
    ds_read2_b32 v[38:39], v13 offset0:122 offset1:123
    v_mfma_f32_16x16x32_f16 v[20:23], v[72:75], v[32:35], v[20:23]
    v_mfma_f32_16x16x32_f16 v[20:23], v[76:79], v[48:51], v[20:23]
    v_mfma_f32_16x16x32_f16 v[20:23], v[80:83], v[112:115], v[20:23]
    ds_read_b64_tr_b16 v[100:101], v9 offset:2560
    ds_read_b64_tr_b16 v[102:103], v9 offset:2624
    s_waitcnt lgkmcnt(14)
    v_mfma_f32_16x16x32_f16 v[20:23], v[84:87], v[52:55], v[20:23]
    s_waitcnt lgkmcnt(10)
    v_mfma_f32_16x16x32_f16 v[20:23], v[88:91], v[120:123], v[20:23]
    s_waitcnt lgkmcnt(6)
    v_mfma_f32_16x16x32_f16 v[20:23], v[92:95], v[56:59], v[20:23]
    ds_read_b64_tr_b16 v[60:61], v9 offset:5648
    ds_read_b64_tr_b16 v[62:63], v9 offset:5712
    ds_read2_b32 v[40:41], v13 offset0:0 offset1:1
    ds_read2_b32 v[42:43], v13 offset0:2 offset1:3
    s_waitcnt lgkmcnt(6)
    v_mfma_f32_16x16x32_f16 v[20:23], v[96:99], v[36:39], v[20:23]
    ds_read2_b32 v[72:73], v13 offset0:16 offset1:17
    ds_read2_b32 v[74:75], v13 offset0:18 offset1:19
    ds_read2_b32 v[52:53], v13 offset0:96 offset1:97
    ds_read2_b32 v[54:55], v13 offset0:98 offset1:99
    v_mfma_f32_16x16x32_f16 v[24:27], v[68:71], v[104:107], v[24:27]
    ds_read2_b32 v[120:121], v13 offset0:112 offset1:113
    ds_read2_b32 v[122:123], v13 offset0:114 offset1:115
    v_mfma_f32_16x16x32_f16 v[24:27], v[44:47], v[124:127], v[24:27]
    v_mul_f32 v20, v20, v16
    v_mul_f32 v21, v21, v16
    s_waitcnt lgkmcnt(10)
    v_mfma_f32_16x16x32_f16 v[24:27], v[100:103], v[64:67], v[24:27]
    v_mul_f32 v22, v22, v16
    v_mul_f32 v23, v23, v16
    v_mfma_f32_16x16x32_f16 v[24:27], v[76:79], v[32:35], v[24:27]
    v_cvt_pk_bf16_f32 v28, v20, v21
    v_cvt_pk_bf16_f32 v29, v22, v23
    v_mfma_f32_16x16x32_f16 v[24:27], v[80:83], v[48:51], v[24:27]
    v_lshlrev_b32 v20, 16, v28
    v_and_b32 v21, 0xffff0000, v28
    s_waitcnt lgkmcnt(8)
    v_mfma_f32_16x16x32_f16 v[24:27], v[60:63], v[112:115], v[24:27]
    v_lshlrev_b32 v22, 16, v29
    v_and_b32 v23, 0xffff0000, v29
    s_waitcnt lgkmcnt(6)
    v_mfma_f32_16x16x32_f16 v[24:27], v[84:87], v[40:43], v[24:27]
    v_add_f32 v20, v20, v116
    v_add_f32 v21, v21, v117
    s_waitcnt lgkmcnt(4)
    v_mfma_f32_16x16x32_f16 v[24:27], v[88:91], v[72:75], v[24:27]
    v_add_f32 v22, v22, v118
    v_add_f32 v23, v23, v119
    s_waitcnt lgkmcnt(2)
    v_mfma_f32_16x16x32_f16 v[24:27], v[92:95], v[52:55], v[24:27]
    v_cvt_pk_bf16_f32 v28, v20, v21
    v_cvt_pk_bf16_f32 v29, v22, v23
    s_waitcnt lgkmcnt(0)
    v_mfma_f32_16x16x32_f16 v[24:27], v[96:99], v[120:123], v[24:27]
    v_min_u32 v28, -2, v28
    v_min_u32 v29, -2, v29
    ds_read_b32 v19, v4 offset:188
    ds_read_u8 v18, v4 offset:163
    ds_read_b128 v[20:23], v12 offset:49664
    s_nop 2
    v_mul_f32 v24, v24, v16
    v_mul_f32 v25, v25, v16
    v_mul_f32 v26, v26, v16
    v_mul_f32 v27, v27, v16
    v_cvt_pk_bf16_f32 v30, v24, v25
    v_cvt_pk_bf16_f32 v31, v26, v27
    v_lshlrev_b32 v24, 16, v30
    v_and_b32 v25, 0xffff0000, v30
    v_lshlrev_b32 v26, 16, v31
    v_and_b32 v27, 0xffff0000, v31
    v_add_f32 v24, v24, v108
    v_add_f32 v25, v25, v109
    v_add_f32 v26, v26, v110
    v_add_f32 v27, v27, v111
    v_cvt_pk_bf16_f32 v30, v24, v25
    v_cvt_pk_bf16_f32 v31, v26, v27
    v_min_u32 v30, -2, v30
    v_min_u32 v31, -2, v31
CVE_19:
    s_waitcnt lgkmcnt(0)
    s_cmp_lg_u32 s87, 1
    s_cbranch_scc1 ZA_30
    v_lshl_add_u32 v18, v18, 1, v19
    v_cmp_ne_u32 vcc, s97, v18
    s_cbranch_vccnz ZS_32
ZB_33:
    s_mov_b64 exec, s[98:99]
    v_swap_b32 v28, v20
    v_swap_b32 v29, v21
    v_swap_b32 v30, v22
    v_swap_b32 v31, v23
    s_mov_b64 exec, -1
    buffer_store_dwordx4 v[28:31], v6, s[64:67], s93 offen sc1
    buffer_store_dwordx4 v[20:23], v6, s[64:67], s92 offen sc1
    s_branch ZD_35
WS_22:
W_36:
    ds_read_b32 v18, v14 offset:76
    s_sub_u32 s39, s39, 1
    s_cbranch_scc1 KS_ABORT
    s_waitcnt lgkmcnt(0)
    v_cmp_ne_u32 vcc, s84, v18
    s_cbranch_vccnz W_36
    s_branch WB_23
WS_25:
W_37:
    ds_read_b32 v18, v14 offset:76
    s_sub_u32 s39, s39, 1
    s_cbranch_scc1 KS_ABORT
    s_waitcnt lgkmcnt(0)
    v_cmp_ne_u32 vcc, s84, v18
    s_cbranch_vccnz W_37
    s_branch WB_26
WS_28:
W_38:
    ds_read_b32 v18, v14 offset:76
    s_sub_u32 s39, s39, 1
    s_cbranch_scc1 KS_ABORT
    s_waitcnt lgkmcnt(0)
    v_cmp_ne_u32 vcc, s84, v18
    s_cbranch_vccnz W_38
    s_branch WB_29
ZS_32:
W_39:
    ds_read_b32 v19, v4 offset:188
    s_sub_u32 s39, s39, 1
    s_cbranch_scc1 KS_ABORT
    s_waitcnt lgkmcnt(0)
    v_cmp_ne_u32 vcc, s84, v19
    s_cbranch_vccnz W_39
    v_mov_b32 v19, s86
ZW_40:
    ds_read_u8 v18, v19 offset:160
    s_sub_u32 s39, s39, 1
    s_cbranch_scc1 KS_ABORT
    s_waitcnt lgkmcnt(0)
    v_cmp_ne_u32 vcc, 1, v18
    s_cbranch_vccnz ZW_40
    v_lshl_add_u32 v19, v19, 10, v12
    ds_read_b128 v[20:23], v19 offset:46592
    s_waitcnt lgkmcnt(0)
    s_branch ZB_33
ZA_30:
    s_cmp_lg_u32 s87, 0
    s_cbranch_scc1 ZC_31
    v_mov_b32 v19, s86
    v_lshl_add_u32 v18, v19, 10, v12
    ds_write_b128 v18, v[28:31] offset:46592
    ds_write_b8 v19, v5 offset:160
    s_branch ZD_35
ZC_31:
    v_cmp_eq_u32 vcc, s84, v19
    s_cbranch_vccnz ZCB_34
W_41:
    ds_read_b32 v19, v4 offset:188
    s_sub_u32 s39, s39, 1
    s_cbranch_scc1 KS_ABORT
    s_waitcnt lgkmcnt(0)
    v_cmp_ne_u32 vcc, s84, v19
    s_cbranch_vccnz W_41
ZCB_34:
    buffer_store_dwordx4 v[28:31], v6, s[64:67], s92 offen sc1
ZD_35:
    s_lshl_b32 s92, s87, 2
    s_add_u32 s92, s92, s86
    v_mov_b32 v8, s92
    s_waitcnt vmcnt(0)
    ds_write_b8 v8, v5 offset:48
    s_cmp_lt_u32 s41, 18
    s_cbranch_scc1 KS_T
    s_waitcnt lgkmcnt(0)
    s_endpgm
KS_X:
    s_cmp_lt_u32 s41, 24
    s_cbranch_scc1 KS_X2
    s_setprio 1
    s_mov_b32 s87, 2
    s_add_u32 s86, s38, 3
    s_and_b32 s86, s86, 3
    s_lshl_b32 s88, s40, 3
    s_add_u32 s88, s88, s41
    s_add_u32 s88, s88, 488
    s_branch KS_GRP
KS_X2:
    s_cmp_lt_u32 s41, 8
    s_cbranch_scc1 KS_X3
    s_sub_u32 s97, s38, 8
    s_branch KS_LN1
KS_X3:
    s_lshl_b32 s92, s2, 4
    s_add_u32 s92, s92, s38
    s_cmp_lg_u32 s92, 12
    s_cbranch_scc1 KS_X3B
    s_setprio 3
    s_memrealtime s[92:93]
    v_and_b32 v6, 3, v1
    v_lshlrev_b32 v7, 2, v6
    v_min_u32 v6, 2, v6
    v_lshlrev_b32 v6, 2, v6
    v_cmp_eq_u32 vcc, 3, v1
    s_waitcnt lgkmcnt(0)
    v_mov_b32 v8, s92
    v_mov_b32 v9, s93
    v_alignbit_b32 v8, v8, v8, v6
    v_cndmask_b32 v9, v4, v9, vcc
    v_xor_b32 v8, v8, v9
    v_and_b32 v9, 0xf0000fff, v8
    v_and_b32 v10, 0xfff000, v8
    v_lshl_or_b32 v9, v10, 4, v9
    v_lshrrev_b32 v10, 12, v8
    v_and_b32 v10, 0xf000, v10
    v_or3_b32 v9, v9, v10, v9
    v_or_b32 v9, 0x80000000, v9
    s_mov_b64 exec, 15
    global_store_dword v7, v9, s[34:35] sc1
    s_mov_b64 exec, -1
    s_setprio 0
KS_X3B:
    s_waitcnt lgkmcnt(0)
    s_barrier
    s_branch KS_G
KS_X4:
    s_cmp_lt_u32 s41, 18
    s_cbranch_scc1 KS_G
    s_waitcnt vmcnt(0) lgkmcnt(0)
    s_endpgm
KS_L:
    v_lshlrev_b32 v6, 2, v0
    ds_write_b32 v6, v4
    v_mov_b32 v8, 0
    v_mov_b32 v9, 0
    s_min_u32 s92, s38, 2
    s_mul_i32 s92, s92, 4672
    v_min_u32 v6, 59, v1
    v_lshl_add_u32 v6, v6, 3, s92
    ds_write_b64 v6, v[8:9] offset:3072
    s_mov_b32 s97, s38
    s_sub_u32 s92, s41, 8
    s_cmp_lt_u32 s92, 16
    s_cbranch_scc0 KS_L0
KS_LN1:
    s_setprio 3
    s_sub_u32 s92, s41, 8
    s_and_b32 s88, s92, 7
    s_lshr_b32 s92, s92, 3
    s_lshl_b32 s92, s92, 4
    s_add_u32 s88, s88, s92
    s_and_b32 s92, s40, 1
    s_lshl_b32 s92, s92, 3
    s_add_u32 s88, s88, s92
    s_lshr_b32 s92, s40, 1
    s_lshl_b32 s92, s92, 5
    s_add_u32 s88, s88, s92
    v_lshrrev_b32 v36, 5, v1
    v_and_b32 v37, 31, v1
    v_mul_u32_u24 v38, 1152, v36
    v_lshl_add_u32 v39, v37, 2, v38
    v_lshl_add_u32 v38, v37, 4, v38
    s_mul_i32 s93, s88, 18432
    s_mul_i32 s94, s97, 2304
    s_add_u32 s93, s93, s94
    s_waitcnt lgkmcnt(0)
    s_mov_b32 s64, s4
    s_mov_b32 s65, s5
    s_mov_b32 s66, 0x240000
    s_mov_b32 s67, 0x20000
    buffer_load_dwordx4 v[26:29], v38, s[64:67], s93 offen
    buffer_load_dwordx4 v[30:33], v38, s[64:67], s93 offen offset:512
    buffer_load_dword v34, v39, s[64:67], s93 offen offset:1024
    s_barrier
    s_lshr_b32 s93, s97, 2
    s_lshl_b32 s93, s93, 6
    s_add_u32 s94, s94, s93
    s_add_u32 s94, s94, 17088
    v_lshl_add_u32 v35, v37, 1, v36
    s_mov_b32 s98, 0x05040100
    s_mov_b32 s99, 0x07060302
    s_waitcnt vmcnt(2)
    v_lshlrev_b32 v8, 16, v26
    v_and_b32 v9, 0xffff0000, v26
    v_lshlrev_b32 v10, 16, v27
    v_and_b32 v11, 0xffff0000, v27
    v_lshlrev_b32 v12, 16, v28
    v_and_b32 v13, 0xffff0000, v28
    v_lshlrev_b32 v14, 16, v29
    v_and_b32 v15, 0xffff0000, v29
    s_waitcnt vmcnt(1)
    v_lshlrev_b32 v16, 16, v30
    v_and_b32 v17, 0xffff0000, v30
    v_lshlrev_b32 v18, 16, v31
    v_and_b32 v19, 0xffff0000, v31
    v_lshlrev_b32 v20, 16, v32
    v_and_b32 v21, 0xffff0000, v32
    v_lshlrev_b32 v22, 16, v33
    v_and_b32 v23, 0xffff0000, v33
    s_waitcnt vmcnt(0)
    v_lshlrev_b32 v24, 16, v34
    v_and_b32 v25, 0xffff0000, v34
    v_lshl_add_u32 v6, v35, 4, s94
    v_lshl_add_u32 v7, v35, 2, s94
    v_mul_u32_u24 v35, 0x20202, v36
    v_lshl_add_u32 v35, v36, 25, v35
    v_add_u32 v35, 0x05040100, v35
    v_pk_add_f32 v[40:41], v[8:9], v[10:11]
    v_pk_add_f32 v[42:43], v[12:13], v[14:15]
    v_pk_add_f32 v[40:41], v[40:41], v[16:17]
    v_pk_add_f32 v[42:43], v[42:43], v[18:19]
    v_pk_add_f32 v[40:41], v[40:41], v[20:21]
    v_pk_add_f32 v[42:43], v[42:43], v[22:23]
    v_pk_add_f32 v[40:41], v[40:41], v[24:25]
    v_pk_add_f32 v[40:41], v[40:41], v[42:43]
    v_add_f32 v40, v40, v41
    s_nop 1
    v_add_f32_dpp v40, v40, v40 row_ror:8 row_mask:0xf bank_mask:0xf
    s_nop 1
    v_add_f32_dpp v40, v40, v40 row_ror:4 row_mask:0xf bank_mask:0xf
    s_nop 1
    v_add_f32_dpp v40, v40, v40 row_ror:2 row_mask:0xf bank_mask:0xf
    s_nop 1
    v_add_f32_dpp v40, v40, v40 row_ror:1 row_mask:0xf bank_mask:0xf
    v_mov_b32 v42, v40
    s_nop 1
    v_permlane16_swap_b32 v40, v42
    v_add_f32 v40, v40, v42
    v_mul_f32 v44, 0x3ae38e39, v40
    v_mov_b32 v45, v44
    v_cvt_pk_bf16_f32 v36, v44, v44
    v_and_b32 v36, 0xffff0000, v36
    v_mov_b32 v37, v36
    v_pk_add_f32 v[38:39], v[8:9], v[44:45] neg_lo:[0,1] neg_hi:[0,1]
    v_pk_mul_f32 v[40:41], v[38:39], v[38:39]
    v_pk_add_f32 v[38:39], v[10:11], v[44:45] neg_lo:[0,1] neg_hi:[0,1]
    v_pk_mul_f32 v[42:43], v[38:39], v[38:39]
    v_pk_add_f32 v[38:39], v[12:13], v[44:45] neg_lo:[0,1] neg_hi:[0,1]
    v_pk_fma_f32 v[40:41], v[38:39], v[38:39], v[40:41]
    v_pk_add_f32 v[38:39], v[14:15], v[44:45] neg_lo:[0,1] neg_hi:[0,1]
    v_pk_fma_f32 v[42:43], v[38:39], v[38:39], v[42:43]
    v_pk_add_f32 v[38:39], v[16:17], v[44:45] neg_lo:[0,1] neg_hi:[0,1]
    v_pk_fma_f32 v[40:41], v[38:39], v[38:39], v[40:41]
    v_pk_add_f32 v[38:39], v[18:19], v[44:45] neg_lo:[0,1] neg_hi:[0,1]
    v_pk_fma_f32 v[42:43], v[38:39], v[38:39], v[42:43]
    v_pk_add_f32 v[38:39], v[20:21], v[44:45] neg_lo:[0,1] neg_hi:[0,1]
    v_pk_fma_f32 v[40:41], v[38:39], v[38:39], v[40:41]
    v_pk_add_f32 v[38:39], v[22:23], v[44:45] neg_lo:[0,1] neg_hi:[0,1]
    v_pk_fma_f32 v[42:43], v[38:39], v[38:39], v[42:43]
    v_pk_add_f32 v[38:39], v[24:25], v[44:45] neg_lo:[0,1] neg_hi:[0,1]
    v_pk_fma_f32 v[40:41], v[38:39], v[38:39], v[40:41]
    v_pk_add_f32 v[40:41], v[40:41], v[42:43]
    v_add_f32 v40, v40, v41
    s_nop 1
    v_add_f32_dpp v40, v40, v40 row_ror:8 row_mask:0xf bank_mask:0xf
    s_nop 1
    v_add_f32_dpp v40, v40, v40 row_ror:4 row_mask:0xf bank_mask:0xf
    s_nop 1
    v_add_f32_dpp v40, v40, v40 row_ror:2 row_mask:0xf bank_mask:0xf
    s_nop 1
    v_add_f32_dpp v40, v40, v40 row_ror:1 row_mask:0xf bank_mask:0xf
    v_mov_b32 v42, v40
    s_nop 1
    v_permlane16_swap_b32 v40, v42
    v_add_f32 v40, v40, v42
    v_mul_f32 v40, 0x3ae38e39, v40
    v_cvt_pk_bf16_f32 v40, v40, v40
    v_and_b32 v40, 0xffff0000, v40
    v_add_f32 v40, 0x3727c5ac, v40
    v_cvt_pk_bf16_f32 v40, v40, v40
    v_and_b32 v40, 0xffff0000, v40
    v_sqrt_f32 v40, v40
    s_nop 0
    v_cvt_pk_bf16_f32 v40, v40, v40
    v_and_b32 v40, 0xffff0000, v40
    v_rcp_f32 v38, v40
    s_nop 0
    v_mov_b32 v39, v38
    v_pk_add_f32 v[40:41], v[8:9], v[36:37] neg_lo:[0,1] neg_hi:[0,1]
    v_cvt_pk_bf16_f32 v42, v40, v41
    v_lshlrev_b32 v40, 16, v42
    v_and_b32 v41, 0xffff0000, v42
    v_pk_mul_f32 v[40:41], v[40:41], v[38:39]
    v_cvt_pk_bf16_f32 v42, v40, v41
    v_lshlrev_b32 v40, 16, v42
    v_and_b32 v41, 0xffff0000, v42
    v_cvt_pk_f16_f32 v26, v40, v41
    v_pk_add_f32 v[40:41], v[10:11], v[36:37] neg_lo:[0,1] neg_hi:[0,1]
    v_cvt_pk_bf16_f32 v42, v40, v41
    v_lshlrev_b32 v40, 16, v42
    v_and_b32 v41, 0xffff0000, v42
    v_pk_mul_f32 v[40:41], v[40:41], v[38:39]
    v_cvt_pk_bf16_f32 v42, v40, v41
    v_lshlrev_b32 v40, 16, v42
    v_and_b32 v41, 0xffff0000, v42
    v_cvt_pk_f16_f32 v27, v40, v41
    v_pk_add_f32 v[40:41], v[12:13], v[36:37] neg_lo:[0,1] neg_hi:[0,1]
    v_cvt_pk_bf16_f32 v42, v40, v41
    v_lshlrev_b32 v40, 16, v42
    v_and_b32 v41, 0xffff0000, v42
    v_pk_mul_f32 v[40:41], v[40:41], v[38:39]
    v_cvt_pk_bf16_f32 v42, v40, v41
    v_lshlrev_b32 v40, 16, v42
    v_and_b32 v41, 0xffff0000, v42
    v_cvt_pk_f16_f32 v28, v40, v41
    v_and_b32 v59, 3, v1
    v_lshlrev_b32 v59, 2, v59
    global_load_dword v58, v59, s[34:35] sc1
    v_pk_add_f32 v[40:41], v[14:15], v[36:37] neg_lo:[0,1] neg_hi:[0,1]
    v_cvt_pk_bf16_f32 v42, v40, v41
    v_lshlrev_b32 v40, 16, v42
    v_and_b32 v41, 0xffff0000, v42
    v_pk_mul_f32 v[40:41], v[40:41], v[38:39]
    v_cvt_pk_bf16_f32 v42, v40, v41
    v_lshlrev_b32 v40, 16, v42
    v_and_b32 v41, 0xffff0000, v42
    v_cvt_pk_f16_f32 v29, v40, v41
    v_permlane32_swap_b32 v26, v28
    s_nop 0
    v_permlane32_swap_b32 v27, v29
    v_perm_b32 v8, v28, v26, s98
    v_perm_b32 v9, v28, v26, s99
    v_perm_b32 v10, v29, v27, s98
    v_perm_b32 v11, v29, v27, s99
    ds_write_b128 v6, v[8:11] offset:0
    v_pk_add_f32 v[40:41], v[16:17], v[36:37] neg_lo:[0,1] neg_hi:[0,1]
    v_cvt_pk_bf16_f32 v42, v40, v41
    v_lshlrev_b32 v40, 16, v42
    v_and_b32 v41, 0xffff0000, v42
    v_pk_mul_f32 v[40:41], v[40:41], v[38:39]
    v_cvt_pk_bf16_f32 v42, v40, v41
    v_lshlrev_b32 v40, 16, v42
    v_and_b32 v41, 0xffff0000, v42
    v_cvt_pk_f16_f32 v30, v40, v41
    v_pk_add_f32 v[40:41], v[18:19], v[36:37] neg_lo:[0,1] neg_hi:[0,1]
    v_cvt_pk_bf16_f32 v42, v40, v41
    v_lshlrev_b32 v40, 16, v42
    v_and_b32 v41, 0xffff0000, v42
    v_pk_mul_f32 v[40:41], v[40:41], v[38:39]
    v_cvt_pk_bf16_f32 v42, v40, v41
    v_lshlrev_b32 v40, 16, v42
    v_and_b32 v41, 0xffff0000, v42
    v_cvt_pk_f16_f32 v31, v40, v41
    v_pk_add_f32 v[40:41], v[20:21], v[36:37] neg_lo:[0,1] neg_hi:[0,1]
    v_cvt_pk_bf16_f32 v42, v40, v41
    v_lshlrev_b32 v40, 16, v42
    v_and_b32 v41, 0xffff0000, v42
    v_pk_mul_f32 v[40:41], v[40:41], v[38:39]
    v_cvt_pk_bf16_f32 v42, v40, v41
    v_lshlrev_b32 v40, 16, v42
    v_and_b32 v41, 0xffff0000, v42
    v_cvt_pk_f16_f32 v32, v40, v41
    v_pk_add_f32 v[40:41], v[22:23], v[36:37] neg_lo:[0,1] neg_hi:[0,1]
    v_cvt_pk_bf16_f32 v42, v40, v41
    v_lshlrev_b32 v40, 16, v42
    v_and_b32 v41, 0xffff0000, v42
    v_pk_mul_f32 v[40:41], v[40:41], v[38:39]
    v_cvt_pk_bf16_f32 v42, v40, v41
    v_lshlrev_b32 v40, 16, v42
    v_and_b32 v41, 0xffff0000, v42
    v_cvt_pk_f16_f32 v33, v40, v41
    v_permlane32_swap_b32 v30, v32
    s_nop 0
    v_permlane32_swap_b32 v31, v33
    v_perm_b32 v16, v32, v30, s98
    v_perm_b32 v17, v32, v30, s99
    v_perm_b32 v18, v33, v31, s98
    v_perm_b32 v19, v33, v31, s99
    ds_write_b128 v6, v[16:19] offset:1024
    v_pk_add_f32 v[40:41], v[24:25], v[36:37] neg_lo:[0,1] neg_hi:[0,1]
    v_cvt_pk_bf16_f32 v42, v40, v41
    v_lshlrev_b32 v40, 16, v42
    v_and_b32 v41, 0xffff0000, v42
    v_pk_mul_f32 v[40:41], v[40:41], v[38:39]
    v_cvt_pk_bf16_f32 v42, v40, v41
    v_lshlrev_b32 v40, 16, v42
    v_and_b32 v41, 0xffff0000, v42
    v_cvt_pk_f16_f32 v34, v40, v41
    v_mov_b32 v40, v34
    s_nop 1
    v_permlane32_swap_b32 v34, v40
    v_perm_b32 v40, v40, v34, v35
    ds_write_b32 v7, v40 offset:2048
    v_mov_b32 v6, s97
    ds_write_b8 v6, v5 offset:0
    s_setprio 0
    s_cmp_ge_u32 s97, 4
    s_cbranch_scc1 KS_X4
    s_setprio 3
    s_mov_b32 s72, s36
    s_mov_b32 s73, s37
    s_mov_b32 s74, 0x240000
    s_mov_b32 s75, 0x20000
    v_and_b32 v6, 1, v0
    v_mul_u32_u24 v6, 9280, v6
    v_lshrrev_b32 v7, 1, v0
    v_lshl_add_u32 v6, v7, 2, v6
    v_add_u32 v6, 17088, v6
    v_lshrrev_b32 v7, 2, v0
    v_lshlrev_b32 v7, 13, v7
    v_and_b32 v8, 3, v0
    v_lshl_add_u32 v7, v8, 4, v7
    s_lshl_b32 s92, s88, 6
    s_add_u32 s93, s92, 524288
    s_add_u32 s94, s92, 1048576
    s_add_u32 s95, s92, 1572864
    s_add_u32 s96, s92, 2097152
    s_waitcnt vmcnt(0)
DBP_44:
    v_cmp_eq_u32 vcc, 0, v58
    s_cbranch_vccz DBG_45
    s_sleep 1
    global_load_dword v58, v59, s[34:35] sc1
    s_sub_u32 s39, s39, 1
    s_cbranch_scc1 KS_ABORT
    s_waitcnt vmcnt(0)
    s_branch DBP_44
DBG_45:
    s_mov_b32 s98, 0x70007
    v_lshrrev_b32 v57, 3, v58
    v_lshrrev_b32 v56, 6, v58
    v_lshrrev_b32 v55, 9, v58
W_46:
    ds_read_b64 v[20:21], v4 offset:0
    s_sub_u32 s39, s39, 1
    s_cbranch_scc1 KS_ABORT
    s_waitcnt lgkmcnt(0)
    v_and_b32 v20, v20, v21
    v_cmp_ne_u32 vcc, s84, v20
    s_cbranch_vccnz W_46
    ds_read2st64_b32 v[20:21], v6 offset0:0 offset1:9
    ds_read2st64_b32 v[22:23], v6 offset0:18 offset1:27
    ds_read2st64_b32 v[24:25], v6 offset0:2 offset1:11
    ds_read2st64_b32 v[26:27], v6 offset0:20 offset1:29
    ds_read2st64_b32 v[28:29], v6 offset0:4 offset1:13
    ds_read2st64_b32 v[30:31], v6 offset0:22 offset1:31
    ds_read2st64_b32 v[32:33], v6 offset0:6 offset1:15
    ds_read2st64_b32 v[34:35], v6 offset0:24 offset1:33
    ds_read2st64_b32 v[36:37], v6 offset0:8 offset1:17
    ds_read2st64_b32 v[38:39], v6 offset0:26 offset1:35
    s_waitcnt lgkmcnt(8)
    v_bfi_b32 v20, s98, v58, v20
    v_bfi_b32 v21, s98, v57, v21
    v_bfi_b32 v22, s98, v56, v22
    v_bfi_b32 v23, s98, v55, v23
    buffer_store_dwordx4 v[20:23], v7, s[72:75], s92 offen sc1
    s_waitcnt lgkmcnt(6)
    v_bfi_b32 v24, s98, v58, v24
    v_bfi_b32 v25, s98, v57, v25
    v_bfi_b32 v26, s98, v56, v26
    v_bfi_b32 v27, s98, v55, v27
    buffer_store_dwordx4 v[24:27], v7, s[72:75], s93 offen sc1
    s_waitcnt lgkmcnt(4)
    v_bfi_b32 v28, s98, v58, v28
    v_bfi_b32 v29, s98, v57, v29
    v_bfi_b32 v30, s98, v56, v30
    v_bfi_b32 v31, s98, v55, v31
    buffer_store_dwordx4 v[28:31], v7, s[72:75], s94 offen sc1
    s_waitcnt lgkmcnt(2)
    v_bfi_b32 v32, s98, v58, v32
    v_bfi_b32 v33, s98, v57, v33
    v_bfi_b32 v34, s98, v56, v34
    v_bfi_b32 v35, s98, v55, v35
    buffer_store_dwordx4 v[32:35], v7, s[72:75], s95 offen sc1
    s_waitcnt lgkmcnt(0)
    v_bfi_b32 v36, s98, v58, v36
    v_bfi_b32 v37, s98, v57, v37
    v_bfi_b32 v38, s98, v56, v38
    v_bfi_b32 v39, s98, v55, v39
    buffer_store_dwordx4 v[36:39], v7, s[72:75], s96 offen sc1
    s_branch KS_L2
KS_L0:
    s_and_b32 s92, s41, 15
    s_lshl_b32 s93, s40, 4
    s_add_u32 s92, s92, s93
    v_and_b32 v59, 3, v1
    v_lshlrev_b32 v59, 2, v59
    s_lshl_b32 s96, s92, 6
    s_add_u32 s93, s96, 0xb00000
    v_add_u32 v7, s93, v59
    s_mul_i32 s93, s92, 18560
    s_add_u32 s93, s93, 0x600000
    v_lshlrev_b32 v6, 4, v0
    v_mov_b32 v12, -1
    v_mov_b32 v13, -1
    v_mov_b32 v14, -1
    v_mov_b32 v15, -1
    s_setprio 3
    v_mul_u32_u24 v16, 57, v1
    v_lshrrev_b32 v16, 9, v16
    v_mul_u32_u24 v17, 9, v16
    v_sub_u32 v17, v1, v17
    v_mul_u32_u24 v16, 9216, v16
    v_lshl_add_u32 v16, v17, 7, v16
    s_and_b32 s94, s41, 15
    s_lshl_b32 s94, s94, 2
    s_add_u32 s94, s94, s38
    s_mul_i32 s94, s94, 82944
    s_mul_i32 s95, s40, 1152
    s_add_u32 s94, s94, s95
    s_add_u32 s95, s94, 64512
    s_waitcnt lgkmcnt(0)
    s_add_u32 s68, s36, s93
    s_addc_u32 s69, s37, 0
    s_mov_b32 s70, 18560
    s_mov_b32 s71, 0x20000
    s_mov_b32 s72, s26
    s_mov_b32 s73, s27
    s_mov_b32 s74, 0x510000
    s_mov_b32 s75, 0x20000
    s_mov_b32 s76, s28
    s_mov_b32 s77, s29
    s_mov_b32 s78, 0x510000
    s_mov_b32 s79, 0x20000
    s_barrier
    s_movk_i32 s92, 0
    buffer_store_dwordx4 v[12:15], v6, s[68:71], s92 offen sc1
    s_movk_i32 s92, 4096
    buffer_store_dwordx4 v[12:15], v6, s[68:71], s92 offen sc1
    s_movk_i32 s92, 8192
    buffer_store_dwordx4 v[12:15], v6, s[68:71], s92 offen sc1
    s_movk_i32 s92, 12288
    buffer_store_dwordx4 v[12:15], v6, s[68:71], s92 offen sc1
    s_movk_i32 s92, 16384
    buffer_store_dwordx4 v[12:15], v6, s[68:71], s92 offen sc1
    s_mov_b32 exec_hi, 0x7fffffff
    buffer_load_dword v18, v16, s[72:75], s94 offen
    buffer_load_dword v19, v16, s[76:79], s94 offen
    s_mov_b64 exec, 0x3ffff
    buffer_load_dword v20, v16, s[72:75], s95 offen
    buffer_load_dword v21, v16, s[76:79], s95 offen
    s_mov_b64 exec, -1
    global_load_dword v58, v59, s[34:35] sc1
    s_waitcnt vmcnt(0)
DBP_47:
    v_cmp_eq_u32 vcc, 0, v58
    s_cbranch_vccz DBG_48
    s_sleep 1
    global_load_dword v58, v59, s[34:35] sc1
    s_sub_u32 s39, s39, 1
    s_cbranch_scc1 KS_ABORT
    s_waitcnt vmcnt(0)
    s_branch DBP_47
DBG_48:
    s_mov_b64 exec, 1
    ds_add_rtn_u32 v8, v4, v5 offset:8
    s_mov_b64 exec, -1
    v_lshrrev_b32 v57, 3, v58
    v_lshrrev_b32 v56, 6, v58
    v_lshrrev_b32 v55, 9, v58
    s_waitcnt lgkmcnt(0)
    v_readfirstlane_b32 s92, v8
    s_cmp_lg_u32 s92, 3
    s_cbranch_scc1 KS_L2
    s_mov_b64 exec, 15
    global_store_dword v7, v58, s[36:37] sc1
    s_mov_b64 exec, -1
KS_L2:
    s_mov_b32 s64, s36
    s_mov_b32 s65, s37
    s_mov_b32 s66, 0x240000
    s_mov_b32 s67, 0x20000
    v_lshrrev_b32 v7, 1, v1
    v_lshlrev_b32 v7, 6, v7
    v_and_b32 v10, 1, v1
    v_lshl_add_u32 v7, v10, 4, v7
    v_lshlrev_b32 v9, 4, v1
    s_lshl_b32 s92, s38, 11
    s_lshl_b32 s93, s90, 13
    s_add_u32 s93, s93, s92
    s_lshl_b32 s95, s40, 3
    s_add_u32 s95, s95, s41
    s_add_u32 s95, s95, 488
    s_lshr_b32 s96, s95, 1
    s_lshl_b32 s96, s96, 13
    s_and_b32 s95, s95, 1
    s_lshl_b32 s95, s95, 5
    s_add_u32 s95, s95, s96
    s_add_u32 s95, s95, s92
    s_cmp_lt_u32 s41, 24
    s_cselect_b32 s95, 2359296, s95
    s_cselect_b32 s94, 0, 0x70007
    v_mov_b32_dpp v64, v58 quad_perm:[0,1,0,1] row_mask:0xf bank_mask:0xf
    v_mov_b32_dpp v65, v58 quad_perm:[2,3,2,3] row_mask:0xf bank_mask:0xf
    s_bitcmp1_b32 s41, 0
    s_cselect_b64 vcc, -1, 0
    v_cndmask_b32 v64, v64, v65, vcc
    v_and_b32 v60, 0x70007, v58
    v_and_b32 v61, 0x70007, v57
    v_and_b32 v62, 0x70007, v56
    v_and_b32 v63, 0x70007, v55
    v_lshrrev_b32 v67, 9, v64
    v_lshrrev_b32 v66, 6, v64
    v_lshrrev_b32 v65, 3, v64
    v_and_b32 v64, s94, v64
    v_and_b32 v65, s94, v65
    v_and_b32 v66, s94, v66
    v_and_b32 v67, s94, v67
    s_lshl_b32 s96, s38, 10
    s_add_u32 s96, s96, 3552
    v_bfe_u32 v11, v1, 1, 1
    v_mul_u32_u24 v11, 4672, v11
    v_lshl_add_u32 v11, v10, 4, v11
    v_lshrrev_b32 v10, 2, v1
    v_lshl_add_u32 v11, v10, 5, v11
    v_add_u32 v11, s96, v11
    v_add_u32 v10, s96, v9
    v_mov_b32 v116, s38
    s_waitcnt vmcnt(0)
    s_branch UPE_50
UP_49:
    s_sleep 2
UPE_50:
    buffer_load_dwordx4 v[20:23], v9, s[64:67], s93 offen sc1
    buffer_load_dwordx4 v[24:27], v9, s[64:67], s93 offen offset:1024 sc1
    buffer_load_dwordx4 v[28:31], v7, s[64:67], s95 offen sc1
    s_sub_u32 s39, s39, 1
    s_cbranch_scc1 KS_ABORT
    s_waitcnt vmcnt(2)
    v_xor_b32 v20, v60, v20
    v_xor_b32 v21, v61, v21
    v_xor_b32 v22, v62, v22
    v_xor_b32 v23, v63, v23
    v_or3_b32 v44, v20, v21, v21
    v_or3_b32 v44, v22, v23, v44
    s_waitcnt vmcnt(1)
    v_xor_b32 v24, v60, v24
    v_xor_b32 v25, v61, v25
    v_xor_b32 v26, v62, v26
    v_xor_b32 v27, v63, v27
    v_or3_b32 v44, v24, v25, v44
    v_or3_b32 v44, v26, v27, v44
    s_waitcnt vmcnt(0)
    v_xor_b32 v28, v64, v28
    v_xor_b32 v29, v65, v29
    v_xor_b32 v30, v66, v30
    v_xor_b32 v31, v67, v31
    v_or3_b32 v44, v28, v29, v44
    v_or3_b32 v44, v30, v31, v44
    v_and_b32 v44, 0x70007, v44
    v_cmp_ne_u32 vcc, 0, v44
    s_cbranch_vccnz UP_49
    ds_write_b128 v11, v[20:23]
    ds_write_b128 v11, v[24:27] offset:512
    ds_write_b128 v10, v[28:31] offset:9344
    ds_write_b8 v116, v5 offset:16
    s_cmp_eq_u32 s38, 2
    s_cbranch_scc1 WJ2_53
    s_add_u32 s92, s38, 1
    s_lshr_b32 s92, s92, 2
    s_cmp_eq_u32 s38, 1
    s_cselect_b32 s92, 2, s92
    s_lshl_b32 s92, s92, 10
    v_lshl_add_u32 v10, v1, 4, s92
    v_add_u32 v11, 35840, v10
W_54:
    ds_read_b32 v12, v4 offset:16
    s_sub_u32 s39, s39, 1
    s_cbranch_scc1 KS_ABORT
    s_waitcnt lgkmcnt(0)
    v_cmp_ne_u32 vcc, s84, v12
    s_cbranch_vccnz W_54
    s_setprio 3
    ds_read_b128 v[20:23], v10 offset:3520
    ds_read_b128 v[24:27], v10 offset:3536
    ds_read_b64 v[28:29], v10 offset:3552
    ds_read_b128 v[32:35], v10 offset:8192
    ds_read_b128 v[36:39], v10 offset:8208
    ds_read_b64 v[40:41], v10 offset:8224
    ds_read_b128 v[44:47], v10 offset:12864
    ds_read_b128 v[48:51], v10 offset:12880
    ds_read_b64 v[52:53], v10 offset:12896
    s_cmp_eq_u32 s38, 1
    s_cbranch_scc1 WJ1_52
    ds_read_b32 v12, v4 offset:68
    s_waitcnt lgkmcnt(7)
    v_alignbit_b32 v57, v22, v21, 16
    v_alignbit_b32 v58, v23, v22, 16
    v_alignbit_b32 v59, v24, v23, 16
    v_alignbit_b32 v60, v25, v24, 16
    v_alignbit_b32 v61, v26, v25, 16
    v_alignbit_b32 v62, v27, v26, 16
    v_alignbit_b32 v63, v28, v27, 16
    v_alignbit_b32 v64, v29, v28, 16
    v_pk_add_f16 v66, v57, v22
    v_pk_add_f16 v67, v58, v23
    v_pk_add_f16 v68, v59, v24
    v_pk_add_f16 v69, v60, v25
    v_pk_add_f16 v70, v61, v26
    v_pk_add_f16 v71, v62, v27
    v_pk_add_f16 v72, v63, v28
    v_pk_add_f16 v73, v64, v29
    v_pk_add_f16 v80, v66, v58
    v_pk_add_f16 v81, v67, v59
    v_pk_add_f16 v82, v68, v60
    v_pk_add_f16 v83, v69, v61
    v_pk_add_f16 v74, v67, v68
    v_pk_add_f16 v75, v68, v69
    v_pk_add_f16 v76, v69, v70
    v_pk_add_f16 v77, v70, v71
    v_pk_add_f16 v78, v71, v72
    v_pk_add_f16 v79, v72, v73
    s_waitcnt lgkmcnt(0)
    v_cmp_eq_u32 vcc, s84, v12
    s_cbranch_vccnz WJK_55
W_56:
    s_sleep 1
    ds_read_b32 v12, v4 offset:68
    s_sub_u32 s39, s39, 1
    s_cbranch_scc1 KS_ABORT
    s_waitcnt lgkmcnt(0)
    v_cmp_ne_u32 vcc, s84, v12
    s_cbranch_vccnz W_56
WJK_55:
    ds_write_b128 v11, v[80:83] offset:0
    v_pk_add_f16 v87, v22, v74
    v_pk_add_f16 v88, v23, v75
    v_pk_add_f16 v89, v24, v76
    v_pk_add_f16 v90, v25, v77
    v_pk_add_f16 v91, v26, v78
    ds_write_b128 v11, v[88:91] offset:3104
    v_pk_add_f16 v84, v70, v62
    v_pk_add_f16 v85, v71, v63
    v_pk_add_f16 v86, v72, v64
    v_pk_add_f16 v92, v74, v83
    v_pk_add_f16 v93, v75, v84
    v_pk_add_f16 v94, v76, v85
    v_pk_add_f16 v95, v77, v86
    ds_write_b128 v11, v[92:95] offset:6176
    v_pk_add_f16 v96, v87, v76
    v_pk_add_f16 v97, v88, v77
    v_pk_add_f16 v98, v89, v78
    v_pk_add_f16 v99, v90, v79
    ds_write_b128 v11, v[96:99] offset:8240
    ds_write_b8 v116, v5 offset:76
    ds_read_b32 v12, v4 offset:84
    v_alignbit_b32 v57, v34, v33, 16
    v_alignbit_b32 v58, v35, v34, 16
    v_alignbit_b32 v59, v36, v35, 16
    v_alignbit_b32 v60, v37, v36, 16
    v_alignbit_b32 v61, v38, v37, 16
    v_alignbit_b32 v62, v39, v38, 16
    v_alignbit_b32 v63, v40, v39, 16
    v_alignbit_b32 v64, v41, v40, 16
    v_pk_add_f16 v66, v57, v34
    v_pk_add_f16 v67, v58, v35
    v_pk_add_f16 v68, v59, v36
    v_pk_add_f16 v69, v60, v37
    v_pk_add_f16 v70, v61, v38
    v_pk_add_f16 v71, v62, v39
    v_pk_add_f16 v72, v63, v40
    v_pk_add_f16 v73, v64, v41
    v_pk_add_f16 v80, v66, v58
    v_pk_add_f16 v81, v67, v59
    v_pk_add_f16 v82, v68, v60
    v_pk_add_f16 v83, v69, v61
    v_pk_add_f16 v74, v67, v68
    v_pk_add_f16 v75, v68, v69
    v_pk_add_f16 v76, v69, v70
    v_pk_add_f16 v77, v70, v71
    v_pk_add_f16 v78, v71, v72
    v_pk_add_f16 v79, v72, v73
    s_waitcnt lgkmcnt(0)
    v_cmp_eq_u32 vcc, s84, v12
    s_cbranch_vccnz WJK_57
W_58:
    s_sleep 1
    ds_read_b32 v12, v4 offset:84
    s_sub_u32 s39, s39, 1
    s_cbranch_scc1 KS_ABORT
    s_waitcnt lgkmcnt(0)
    v_cmp_ne_u32 vcc, s84, v12
    s_cbranch_vccnz W_58
WJK_57:
    ds_write_b128 v11, v[80:83] offset:36672
    v_pk_add_f16 v87, v34, v74
    v_pk_add_f16 v88, v35, v75
    v_pk_add_f16 v89, v36, v76
    v_pk_add_f16 v90, v37, v77
    v_pk_add_f16 v91, v38, v78
    ds_write_b128 v11, v[88:91] offset:39776
    v_pk_add_f16 v84, v70, v62
    v_pk_add_f16 v85, v71, v63
    v_pk_add_f16 v86, v72, v64
    v_pk_add_f16 v92, v74, v83
    v_pk_add_f16 v93, v75, v84
    v_pk_add_f16 v94, v76, v85
    v_pk_add_f16 v95, v77, v86
    ds_write_b128 v11, v[92:95] offset:42848
    v_pk_add_f16 v96, v87, v76
    v_pk_add_f16 v97, v88, v77
    v_pk_add_f16 v98, v89, v78
    v_pk_add_f16 v99, v90, v79
    ds_write_b128 v11, v[96:99] offset:44912
    ds_write_b8 v116, v5 offset:92
    s_cmp_lt_u32 s41, 24
    s_cbranch_scc1 WJE_51
    ds_read_b32 v12, v4 offset:100
    v_alignbit_b32 v57, v46, v45, 16
    v_alignbit_b32 v58, v47, v46, 16
    v_alignbit_b32 v59, v48, v47, 16
    v_alignbit_b32 v60, v49, v48, 16
    v_alignbit_b32 v61, v50, v49, 16
    v_alignbit_b32 v62, v51, v50, 16
    v_alignbit_b32 v63, v52, v51, 16
    v_alignbit_b32 v64, v53, v52, 16
    v_pk_add_f16 v66, v57, v46
    v_pk_add_f16 v67, v58, v47
    v_pk_add_f16 v68, v59, v48
    v_pk_add_f16 v69, v60, v49
    v_pk_add_f16 v70, v61, v50
    v_pk_add_f16 v71, v62, v51
    v_pk_add_f16 v72, v63, v52
    v_pk_add_f16 v73, v64, v53
    v_pk_add_f16 v80, v66, v58
    v_pk_add_f16 v81, v67, v59
    v_pk_add_f16 v82, v68, v60
    v_pk_add_f16 v83, v69, v61
    v_pk_add_f16 v74, v67, v68
    v_pk_add_f16 v75, v68, v69
    v_pk_add_f16 v76, v69, v70
    v_pk_add_f16 v77, v70, v71
    v_pk_add_f16 v78, v71, v72
    v_pk_add_f16 v79, v72, v73
    s_waitcnt lgkmcnt(0)
    v_cmp_eq_u32 vcc, s84, v12
    s_cbranch_vccnz WJK_59
W_60:
    s_sleep 1
    ds_read_b32 v12, v4 offset:100
    s_sub_u32 s39, s39, 1
    s_cbranch_scc1 KS_ABORT
    s_waitcnt lgkmcnt(0)
    v_cmp_ne_u32 vcc, s84, v12
    s_cbranch_vccnz W_60
WJK_59:
    v_add_u32 v11, 73344, v11
    ds_write_b128 v11, v[80:83] offset:0
    v_pk_add_f16 v87, v46, v74
    v_pk_add_f16 v88, v47, v75
    v_pk_add_f16 v89, v48, v76
    v_pk_add_f16 v90, v49, v77
    v_pk_add_f16 v91, v50, v78
    ds_write_b128 v11, v[88:91] offset:3104
    v_pk_add_f16 v84, v70, v62
    v_pk_add_f16 v85, v71, v63
    v_pk_add_f16 v86, v72, v64
    v_pk_add_f16 v92, v74, v83
    v_pk_add_f16 v93, v75, v84
    v_pk_add_f16 v94, v76, v85
    v_pk_add_f16 v95, v77, v86
    ds_write_b128 v11, v[92:95] offset:6176
    v_pk_add_f16 v96, v87, v76
    v_pk_add_f16 v97, v88, v77
    v_pk_add_f16 v98, v89, v78
    v_pk_add_f16 v99, v90, v79
    ds_write_b128 v11, v[96:99] offset:8240
    ds_write_b8 v116, v5 offset:108
    s_branch WJE_51
WJ1_52:
    ds_read_b32 v12, v4 offset:68
    s_waitcnt lgkmcnt(7)
    v_alignbit_b32 v57, v22, v21, 16
    v_alignbit_b32 v58, v23, v22, 16
    v_alignbit_b32 v59, v24, v23, 16
    v_alignbit_b32 v60, v25, v24, 16
    v_alignbit_b32 v61, v26, v25, 16
    v_alignbit_b32 v62, v27, v26, 16
    v_alignbit_b32 v63, v28, v27, 16
    v_pk_add_f16 v66, v57, v22
    v_pk_add_f16 v67, v58, v23
    v_pk_add_f16 v68, v59, v24
    v_pk_add_f16 v69, v60, v25
    v_pk_add_f16 v70, v61, v26
    v_pk_add_f16 v71, v62, v27
    v_pk_add_f16 v72, v63, v28
    v_pk_add_f16 v80, v66, v58
    v_pk_add_f16 v81, v67, v59
    v_pk_add_f16 v82, v68, v60
    v_pk_add_f16 v83, v69, v61
    v_pk_add_f16 v75, v68, v69
    v_pk_add_f16 v76, v69, v70
    v_pk_add_f16 v77, v70, v71
    v_pk_add_f16 v78, v71, v72
    s_waitcnt lgkmcnt(0)
    v_cmp_eq_u32 vcc, s84, v12
    s_cbranch_vccnz WJK_61
W_62:
    s_sleep 1
    ds_read_b32 v12, v4 offset:68
    s_sub_u32 s39, s39, 1
    s_cbranch_scc1 KS_ABORT
    s_waitcnt lgkmcnt(0)
    v_cmp_ne_u32 vcc, s84, v12
    s_cbranch_vccnz W_62
WJK_61:
    ds_write_b128 v11, v[80:83] offset:0
    v_pk_add_f16 v88, v23, v75
    v_pk_add_f16 v89, v24, v76
    v_pk_add_f16 v90, v25, v77
    v_pk_add_f16 v91, v26, v78
    ds_write_b128 v11, v[88:91] offset:3104
    ds_write_b8 v116, v5 offset:76
    ds_read_b32 v12, v4 offset:84
    v_alignbit_b32 v57, v34, v33, 16
    v_alignbit_b32 v58, v35, v34, 16
    v_alignbit_b32 v59, v36, v35, 16
    v_alignbit_b32 v60, v37, v36, 16
    v_alignbit_b32 v61, v38, v37, 16
    v_alignbit_b32 v62, v39, v38, 16
    v_alignbit_b32 v63, v40, v39, 16
    v_pk_add_f16 v66, v57, v34
    v_pk_add_f16 v67, v58, v35
    v_pk_add_f16 v68, v59, v36
    v_pk_add_f16 v69, v60, v37
    v_pk_add_f16 v70, v61, v38
    v_pk_add_f16 v71, v62, v39
    v_pk_add_f16 v72, v63, v40
    v_pk_add_f16 v80, v66, v58
    v_pk_add_f16 v81, v67, v59
    v_pk_add_f16 v82, v68, v60
    v_pk_add_f16 v83, v69, v61
    v_pk_add_f16 v75, v68, v69
    v_pk_add_f16 v76, v69, v70
    v_pk_add_f16 v77, v70, v71
    v_pk_add_f16 v78, v71, v72
    s_waitcnt lgkmcnt(0)
    v_cmp_eq_u32 vcc, s84, v12
    s_cbranch_vccnz WJK_63
W_64:
    s_sleep 1
    ds_read_b32 v12, v4 offset:84
    s_sub_u32 s39, s39, 1
    s_cbranch_scc1 KS_ABORT
    s_waitcnt lgkmcnt(0)
    v_cmp_ne_u32 vcc, s84, v12
    s_cbranch_vccnz W_64
WJK_63:
    ds_write_b128 v11, v[80:83] offset:36672
    v_pk_add_f16 v88, v35, v75
    v_pk_add_f16 v89, v36, v76
    v_pk_add_f16 v90, v37, v77
    v_pk_add_f16 v91, v38, v78
    ds_write_b128 v11, v[88:91] offset:39776
    ds_write_b8 v116, v5 offset:92
    s_cmp_lt_u32 s41, 24
    s_cbranch_scc1 WJE_51
    ds_read_b32 v12, v4 offset:100
    v_alignbit_b32 v57, v46, v45, 16
    v_alignbit_b32 v58, v47, v46, 16
    v_alignbit_b32 v59, v48, v47, 16
    v_alignbit_b32 v60, v49, v48, 16
    v_alignbit_b32 v61, v50, v49, 16
    v_alignbit_b32 v62, v51, v50, 16
    v_alignbit_b32 v63, v52, v51, 16
    v_pk_add_f16 v66, v57, v46
    v_pk_add_f16 v67, v58, v47
    v_pk_add_f16 v68, v59, v48
    v_pk_add_f16 v69, v60, v49
    v_pk_add_f16 v70, v61, v50
    v_pk_add_f16 v71, v62, v51
    v_pk_add_f16 v72, v63, v52
    v_pk_add_f16 v80, v66, v58
    v_pk_add_f16 v81, v67, v59
    v_pk_add_f16 v82, v68, v60
    v_pk_add_f16 v83, v69, v61
    v_pk_add_f16 v75, v68, v69
    v_pk_add_f16 v76, v69, v70
    v_pk_add_f16 v77, v70, v71
    v_pk_add_f16 v78, v71, v72
    s_waitcnt lgkmcnt(0)
    v_cmp_eq_u32 vcc, s84, v12
    s_cbranch_vccnz WJK_65
W_66:
    s_sleep 1
    ds_read_b32 v12, v4 offset:100
    s_sub_u32 s39, s39, 1
    s_cbranch_scc1 KS_ABORT
    s_waitcnt lgkmcnt(0)
    v_cmp_ne_u32 vcc, s84, v12
    s_cbranch_vccnz W_66
WJK_65:
    v_add_u32 v11, 73344, v11
    ds_write_b128 v11, v[80:83] offset:0
    v_pk_add_f16 v88, v47, v75
    v_pk_add_f16 v89, v48, v76
    v_pk_add_f16 v90, v49, v77
    v_pk_add_f16 v91, v50, v78
    ds_write_b128 v11, v[88:91] offset:3104
    ds_write_b8 v116, v5 offset:108
    s_branch WJE_51
WJ2_53:
    ds_write_b8 v116, v5 offset:76
    ds_write_b8 v116, v5 offset:92
    ds_write_b8 v116, v5 offset:108
    v_lshrrev_b32 v10, 2, v1
    v_lshl_add_u32 v10, v10, 6, v59
    v_add_u32 v10, 0xb01000, v10
W_67:
    s_sleep 1
    ds_read_b32 v12, v4 offset:16
    s_sub_u32 s39, s39, 1
    s_cbranch_scc1 KS_ABORT
    s_waitcnt lgkmcnt(0)
    v_cmp_ne_u32 vcc, s84, v12
    s_cbranch_vccnz W_67
    s_branch F1E_69
F1_68:
    s_sleep 2
F1E_69:
    global_load_dword v20, v10, s[36:37] offset:-4096 sc1
    global_load_dword v21, v10, s[36:37] offset:-3072 sc1
    global_load_dword v22, v10, s[36:37] offset:-2048 sc1
    global_load_dword v23, v10, s[36:37] offset:-1024 sc1
    global_load_dword v24, v10, s[36:37] offset:0 sc1
    global_load_dword v25, v10, s[36:37] offset:1024 sc1
    global_load_dword v26, v10, s[36:37] offset:2048 sc1
    global_load_dword v27, v10, s[36:37] offset:3072 sc1
    s_sub_u32 s39, s39, 1
    s_cbranch_scc1 KS_ABORT
    s_waitcnt vmcnt(0)
    v_xor_b32 v20, v58, v20
    v_xor_b32 v21, v58, v21
    v_xor_b32 v22, v58, v22
    v_xor_b32 v23, v58, v23
    v_xor_b32 v24, v58, v24
    v_xor_b32 v25, v58, v25
    v_xor_b32 v26, v58, v26
    v_xor_b32 v27, v58, v27
    v_or3_b32 v20, v20, v21, v22
    v_or3_b32 v23, v23, v24, v25
    v_or3_b32 v20, v20, v26, v27
    v_or_b32 v20, v20, v23
    v_cmp_ne_u32 vcc, 0, v20
    s_cbranch_vccnz F1_68
    v_mov_b32 v20, s84
    ds_write_b32 v4, v20 offset:188
WJE_51:
    s_setprio 0
    s_lshr_b32 s92, s90, 6
    s_lshl_b32 s92, s92, 9
    s_bfe_u32 s93, s90, 0x20004
    s_lshl_b32 s93, s93, 6
    s_add_u32 s92, s92, s93
    s_and_b32 s93, s90, 3
    s_lshl_b32 s93, s93, 4
    s_add_u32 s92, s92, s93
    s_and_b32 s93, s90, 12
    s_add_u32 s92, s92, s93
    s_lshr_b32 s93, s38, 1
    s_lshl_b32 s93, s93, 8
    s_add_u32 s92, s92, s93
    s_and_b32 s93, s38, 1
    s_lshl_b32 s93, s93, 1
    s_add_u32 s92, s92, s93
    v_lshrrev_b32 v113, 5, v1
    v_and_b32 v114, 31, v1
    v_add_u32 v112, s92, v113
    v_mul_u32_u24 v115, 1152, v112
    v_lshl_add_u32 v8, v114, 2, v115
    v_lshl_add_u32 v115, v114, 4, v115
    v_lshlrev_b32 v7, 2, v114
    v_lshlrev_b32 v6, 4, v114
    v_bfe_u32 v111, v1, 3, 1
    v_add_u32 v111, s92, v111
    v_mul_u32_u24 v111, 1152, v111
    v_and_b32 v9, 7, v1
    v_lshl_add_u32 v111, v9, 4, v111
    s_mov_b32 s64, s4
    s_mov_b32 s65, s5
    s_mov_b32 s66, 0x240000
    s_mov_b32 s67, 0x20000
    s_mov_b32 s68, s24
    s_mov_b32 s69, s25
    s_mov_b32 s70, 0x480
    s_mov_b32 s71, 0x20000
    buffer_load_dwordx4 v[10:13], v115, s[64:67], 0 offen
    buffer_load_dwordx4 v[14:17], v115, s[64:67], 0 offen offset:512
    buffer_load_dword v18, v8, s[64:67], 0 offen offset:1024
    buffer_load_dwordx4 v[50:53], v6, s[68:71], 0 offen
    buffer_load_dwordx4 v[54:57], v6, s[68:71], 0 offen offset:512
    buffer_load_dword v58, v7, s[68:71], 0 offen offset:1024
    s_cmp_lt_u32 s41, 18
    s_cbranch_scc1 KS_L3B
    s_mul_i32 s92, s40, 14
    s_add_u32 s92, s92, s41
    s_mul_i32 s92, s92, 23744
    s_add_u32 s92, s92, 0x7e7a80
    s_add_u32 s68, s36, s92
    s_addc_u32 s69, s37, 0
    s_mov_b32 s70, 23744
    s_mov_b32 s71, 0x20000
    s_mov_b32 s72, s30
    s_mov_b32 s73, s31
    s_mov_b32 s74, 0x510000
    s_mov_b32 s75, 0x20000
    s_sub_u32 s92, s41, 18
    s_lshl_b32 s92, s92, 2
    s_add_u32 s92, s92, s38
    s_mul_i32 s92, s92, 11904
    s_mul_i32 s93, s40, 663552
    s_add_u32 s92, s92, s93
    v_lshlrev_b32 v6, 7, v1
    buffer_load_dword v64, v6, s[72:75], s92 offen
    buffer_load_dword v65, v6, s[72:75], s92 offen offset:3712
    v_lshlrev_b32 v6, 4, v0
    v_mov_b32 v60, -1
    v_mov_b32 v61, -1
    v_mov_b32 v62, -1
    v_mov_b32 v63, -1
    s_movk_i32 s92, 0
    buffer_store_dwordx4 v[60:63], v6, s[68:71], s92 offen sc1
    s_movk_i32 s92, 4096
    buffer_store_dwordx4 v[60:63], v6, s[68:71], s92 offen sc1
    s_movk_i32 s92, 8192
    buffer_store_dwordx4 v[60:63], v6, s[68:71], s92 offen sc1
    s_movk_i32 s92, 12288
    buffer_store_dwordx4 v[60:63], v6, s[68:71], s92 offen sc1
    s_movk_i32 s92, 16384
    buffer_store_dwordx4 v[60:63], v6, s[68:71], s92 offen sc1
    s_movk_i32 s92, 20480
    buffer_store_dwordx4 v[60:63], v6, s[68:71], s92 offen sc1
    s_branch KS_L4
KS_L3B:
W_70:
    s_sleep 2
    ds_read_b32 v6, v4 offset:192
    s_sub_u32 s39, s39, 1
    s_cbranch_scc1 KS_ABORT
    s_waitcnt lgkmcnt(0)
    v_cmp_ne_u32 vcc, s84, v6
    s_cbranch_vccnz W_70
    s_mov_b32 s68, s30
    s_mov_b32 s69, s31
    s_mov_b32 s70, 0x510000
    s_mov_b32 s71, 0x20000
    v_lshlrev_b32 v6, 4, v1
    s_mul_i32 s92, s89, 36864
    s_mul_i32 s93, s38, 9216
    s_add_u32 s92, s92, s93
    s_add_u32 s93, s93, 109184
    s_add_u32 m0, s93, 0
    s_nop 0
    buffer_load_dwordx4 v6, s[68:71], s92 offen offset:0 lds
    buffer_load_dwordx4 v6, s[68:71], s92 offen offset:1024 lds
    buffer_load_dwordx4 v6, s[68:71], s92 offen offset:2048 lds
    buffer_load_dwordx4 v6, s[68:71], s92 offen offset:3072 lds
    s_add_u32 m0, s93, 4096
    s_add_u32 s92, s92, 4096
    buffer_load_dwordx4 v6, s[68:71], s92 offen offset:0 lds
    buffer_load_dwordx4 v6, s[68:71], s92 offen offset:1024 lds
    buffer_load_dwordx4 v6, s[68:71], s92 offen offset:2048 lds
    buffer_load_dwordx4 v6, s[68:71], s92 offen offset:3072 lds
    s_add_u32 m0, s93, 8192
    s_add_u32 s92, s92, 4096
    buffer_load_dwordx4 v6, s[68:71], s92 offen offset:0 lds
KS_L4:
    s_add_u32 s64, s36, 0x600000
    s_addc_u32 s65, s37, 0
    s_mov_b32 s66, 0x240000
    s_mov_b32 s67, 0x20000
    s_mov_b32 s68, s32
    s_mov_b32 s69, s33
    s_mov_b32 s70, 0x240000
    s_mov_b32 s71, 0x20000
    s_add_u32 s72, s36, 0x300000
    s_addc_u32 s73, s37, 0
    s_mov_b32 s74, 0x240000
    s_mov_b32 s75, 0x20000
    s_add_u32 s76, s36, 0x840000
    s_addc_u32 s77, s37, 0
    s_mov_b32 s78, 0x3000
    s_mov_b32 s79, 0x20000
    s_not_b32 s93, s90
    v_xor_b32 v8, s93, v0
    v_lshrrev_b32 v6, 1, v0
    v_lshlrev_b32 v6, 6, v6
    v_and_b32 v8, 1, v8
    v_lshl_add_u32 v6, v8, 4, v6
    s_lshr_b32 s92, s90, 2
    s_lshl_b32 s92, s92, 15
    s_and_b32 s93, s90, 1
    s_lshl_b32 s93, s93, 14
    s_add_u32 s92, s92, s93
    s_and_b32 s93, s90, 2
    s_lshl_b32 s93, s93, 4
    s_add_u32 s92, s92, s93
    s_lshr_b32 s94, s90, 2
    s_lshl_b32 s94, s94, 12
    s_and_b32 s93, s90, 3
    s_lshl_b32 s93, s93, 4
    s_add_u32 s94, s94, s93
    s_lshl_b32 s93, s38, 10
    s_add_u32 s94, s94, s93
    s_add_u32 s94, s94, 0x200000
    s_add_u32 s93, s92, 8192
    v_lshlrev_b32 v9, 6, v2
    s_mul_i32 s95, s38, 2304
    s_add_u32 s95, s95, 17088
    v_lshl_add_u32 v117, v114, 5, s95
    v_lshl_add_u32 v110, v114, 3, s95
    s_lshl_b32 s95, s38, 9
    s_add_u32 s95, s95, 26368
    v_lshl_add_u32 v108, v1, 2, s95
    v_lshl_add_u32 v109, v1, 4, s95
    s_mov_b32 s95, 0x02020202
    v_mul_lo_u32 v118, v113, s95
    v_add_u32 v118, 0x05040100, v118
    v_lshlrev_b32 v8, 2, v0
    v_add_u32 v8, 17088, v8
    s_lshl_b32 s95, s38, 6
    s_add_u32 s95, s95, 19136
    v_lshl_add_u32 v119, v2, 2, s95
    s_waitcnt vmcnt(0)
    ds_write_b8 v116, v5 offset:40
    v_lshlrev_b32 v20, 16, v10
    v_and_b32 v21, 0xffff0000, v10
    v_lshlrev_b32 v22, 16, v11
    v_and_b32 v23, 0xffff0000, v11
    v_lshlrev_b32 v24, 16, v12
    v_and_b32 v25, 0xffff0000, v12
    v_lshlrev_b32 v26, 16, v13
    v_and_b32 v27, 0xffff0000, v13
    v_lshlrev_b32 v28, 16, v14
    v_and_b32 v29, 0xffff0000, v14
    v_lshlrev_b32 v30, 16, v15
    v_and_b32 v31, 0xffff0000, v15
    v_lshlrev_b32 v32, 16, v16
    v_and_b32 v33, 0xffff0000, v16
    v_lshlrev_b32 v34, 16, v17
    v_and_b32 v35, 0xffff0000, v17
    v_lshlrev_b32 v36, 16, v18
    v_and_b32 v37, 0xffff0000, v18
W_71:
    s_sleep 1
    ds_read_b32 v60, v4 offset:52
    s_sub_u32 s39, s39, 1
    s_cbranch_scc1 KS_ABORT
    s_waitcnt lgkmcnt(0)
    v_cmp_ne_u32 vcc, s84, v60
    s_cbranch_vccnz W_71
    s_setprio 3
    s_branch ZPE_73
ZP_72:
    s_sleep 1
ZPE_73:
    buffer_load_dwordx4 v[68:71], v4, s[64:67], s94 offen sc1
    s_sub_u32 s39, s39, 1
    s_cbranch_scc1 KS_ABORT
    s_waitcnt vmcnt(0)
    v_max3_u32 v44, v68, v69, v70
    v_max_u32 v44, v44, v71
    v_cmp_eq_u32 vcc, -1, v44
    s_cbranch_vccnz ZP_72
    s_branch ZPE_75
ZP_74:
    s_sleep 1
ZPE_75:
    buffer_load_dwordx4 v[60:63], v6, s[64:67], s92 offen sc1
    buffer_load_dwordx4 v[64:67], v6, s[64:67], s93 offen sc1
    buffer_load_dwordx4 v[68:71], v9, s[64:67], s94 offen sc1
    s_sub_u32 s39, s39, 1
    s_cbranch_scc1 KS_ABORT
    s_waitcnt vmcnt(0)
    v_max3_u32 v44, v60, v61, v62
    v_max3_u32 v44, v44, v63, v64
    v_max3_u32 v44, v44, v65, v66
    v_max3_u32 v44, v44, v67, v68
    v_max3_u32 v44, v44, v69, v70
    v_max_u32 v44, v44, v71
    v_cmp_eq_u32 vcc, -1, v44
    s_cbranch_vccnz ZP_74
    ds_write2st64_b32 v8, v60, v61 offset0:0 offset1:9
    ds_write2st64_b32 v8, v62, v63 offset0:18 offset1:27
    ds_write2st64_b32 v8, v64, v65 offset0:4 offset1:13
    ds_write2st64_b32 v8, v66, v67 offset0:22 offset1:31
    ds_write2st64_b32 v119, v68, v69 offset0:0 offset1:9
    ds_write2st64_b32 v119, v70, v71 offset0:18 offset1:27
    ds_write_b8 v116, v5 offset:20
W_76:
    ds_read_b32 v60, v4 offset:20
    s_sub_u32 s39, s39, 1
    s_cbranch_scc1 KS_ABORT
    s_waitcnt lgkmcnt(0)
    v_cmp_ne_u32 vcc, s84, v60
    s_cbranch_vccnz W_76
    ds_read_b128 v[60:63], v117 offset:0
    ds_read_b128 v[64:67], v117 offset:16
    ds_read_b128 v[68:71], v117 offset:1024
    ds_read_b128 v[72:75], v117 offset:1040
    ds_read_b64 v[76:77], v110 offset:2048
    s_waitcnt lgkmcnt(4)
    v_perm_b32 v44, v61, v60, v118
    v_lshlrev_b32 v46, 16, v44
    v_and_b32 v47, 0xffff0000, v44
    v_pk_add_f32 v[46:47], v[46:47], v[20:21]
    v_cvt_pk_bf16_f32 v44, v46, v47
    v_lshlrev_b32 v20, 16, v44
    v_and_b32 v21, 0xffff0000, v44
    v_perm_b32 v44, v63, v62, v118
    v_lshlrev_b32 v46, 16, v44
    v_and_b32 v47, 0xffff0000, v44
    v_pk_add_f32 v[46:47], v[46:47], v[22:23]
    v_cvt_pk_bf16_f32 v44, v46, v47
    v_lshlrev_b32 v22, 16, v44
    v_and_b32 v23, 0xffff0000, v44
    s_waitcnt lgkmcnt(3)
    v_perm_b32 v44, v65, v64, v118
    v_lshlrev_b32 v46, 16, v44
    v_and_b32 v47, 0xffff0000, v44
    v_pk_add_f32 v[46:47], v[46:47], v[24:25]
    v_cvt_pk_bf16_f32 v44, v46, v47
    v_lshlrev_b32 v24, 16, v44
    v_and_b32 v25, 0xffff0000, v44
    v_perm_b32 v44, v67, v66, v118
    v_lshlrev_b32 v46, 16, v44
    v_and_b32 v47, 0xffff0000, v44
    v_pk_add_f32 v[46:47], v[46:47], v[26:27]
    v_cvt_pk_bf16_f32 v44, v46, v47
    v_lshlrev_b32 v26, 16, v44
    v_and_b32 v27, 0xffff0000, v44
    s_waitcnt lgkmcnt(2)
    v_perm_b32 v44, v69, v68, v118
    v_lshlrev_b32 v46, 16, v44
    v_and_b32 v47, 0xffff0000, v44
    v_pk_add_f32 v[46:47], v[46:47], v[28:29]
    v_cvt_pk_bf16_f32 v44, v46, v47
    v_lshlrev_b32 v28, 16, v44
    v_and_b32 v29, 0xffff0000, v44
    v_perm_b32 v44, v71, v70, v118
    v_lshlrev_b32 v46, 16, v44
    v_and_b32 v47, 0xffff0000, v44
    v_pk_add_f32 v[46:47], v[46:47], v[30:31]
    v_cvt_pk_bf16_f32 v44, v46, v47
    v_lshlrev_b32 v30, 16, v44
    v_and_b32 v31, 0xffff0000, v44
    s_waitcnt lgkmcnt(1)
    v_perm_b32 v44, v73, v72, v118
    v_lshlrev_b32 v46, 16, v44
    v_and_b32 v47, 0xffff0000, v44
    v_pk_add_f32 v[46:47], v[46:47], v[32:33]
    v_cvt_pk_bf16_f32 v44, v46, v47
    v_lshlrev_b32 v32, 16, v44
    v_and_b32 v33, 0xffff0000, v44
    v_perm_b32 v44, v75, v74, v118
    v_lshlrev_b32 v46, 16, v44
    v_and_b32 v47, 0xffff0000, v44
    v_pk_add_f32 v[46:47], v[46:47], v[34:35]
    v_cvt_pk_bf16_f32 v44, v46, v47
    v_lshlrev_b32 v34, 16, v44
    v_and_b32 v35, 0xffff0000, v44
    s_waitcnt lgkmcnt(0)
    v_perm_b32 v44, v77, v76, v118
    v_lshlrev_b32 v46, 16, v44
    v_and_b32 v47, 0xffff0000, v44
    v_pk_add_f32 v[46:47], v[46:47], v[36:37]
    v_cvt_pk_bf16_f32 v44, v46, v47
    v_lshlrev_b32 v36, 16, v44
    v_and_b32 v37, 0xffff0000, v44
    v_pk_add_f32 v[44:45], v[20:21], v[22:23]
    v_pk_add_f32 v[46:47], v[24:25], v[26:27]
    v_pk_add_f32 v[44:45], v[44:45], v[28:29]
    v_pk_add_f32 v[46:47], v[46:47], v[30:31]
    v_pk_add_f32 v[44:45], v[44:45], v[32:33]
    v_pk_add_f32 v[46:47], v[46:47], v[34:35]
    v_pk_add_f32 v[44:45], v[44:45], v[36:37]
    v_pk_add_f32 v[44:45], v[44:45], v[46:47]
    v_add_f32 v44, v44, v45
    s_nop 1
    v_add_f32_dpp v44, v44, v44 row_ror:8 row_mask:0xf bank_mask:0xf
    s_nop 1
    v_add_f32_dpp v44, v44, v44 row_ror:4 row_mask:0xf bank_mask:0xf
    s_nop 1
    v_add_f32_dpp v44, v44, v44 row_ror:2 row_mask:0xf bank_mask:0xf
    s_nop 1
    v_add_f32_dpp v44, v44, v44 row_ror:1 row_mask:0xf bank_mask:0xf
    v_mov_b32 v46, v44
    s_nop 1
    v_permlane16_swap_b32 v44, v46
    v_add_f32 v44, v44, v46
    v_mul_f32 v48, 0x3ae38e39, v44
    v_mov_b32 v49, v48
    v_cvt_pk_bf16_f32 v40, v48, v48
    v_and_b32 v40, 0xffff0000, v40
    v_mov_b32 v41, v40
    v_pk_add_f32 v[42:43], v[20:21], v[48:49] neg_lo:[0,1] neg_hi:[0,1]
    v_pk_mul_f32 v[44:45], v[42:43], v[42:43]
    v_pk_add_f32 v[42:43], v[22:23], v[48:49] neg_lo:[0,1] neg_hi:[0,1]
    v_pk_mul_f32 v[46:47], v[42:43], v[42:43]
    v_pk_add_f32 v[42:43], v[24:25], v[48:49] neg_lo:[0,1] neg_hi:[0,1]
    v_pk_fma_f32 v[44:45], v[42:43], v[42:43], v[44:45]
    v_pk_add_f32 v[42:43], v[26:27], v[48:49] neg_lo:[0,1] neg_hi:[0,1]
    v_pk_fma_f32 v[46:47], v[42:43], v[42:43], v[46:47]
    v_pk_add_f32 v[42:43], v[28:29], v[48:49] neg_lo:[0,1] neg_hi:[0,1]
    v_pk_fma_f32 v[44:45], v[42:43], v[42:43], v[44:45]
    v_pk_add_f32 v[42:43], v[30:31], v[48:49] neg_lo:[0,1] neg_hi:[0,1]
    v_pk_fma_f32 v[46:47], v[42:43], v[42:43], v[46:47]
    v_pk_add_f32 v[42:43], v[32:33], v[48:49] neg_lo:[0,1] neg_hi:[0,1]
    v_pk_fma_f32 v[44:45], v[42:43], v[42:43], v[44:45]
    v_pk_add_f32 v[42:43], v[34:35], v[48:49] neg_lo:[0,1] neg_hi:[0,1]
    v_pk_fma_f32 v[46:47], v[42:43], v[42:43], v[46:47]
    v_pk_add_f32 v[42:43], v[36:37], v[48:49] neg_lo:[0,1] neg_hi:[0,1]
    v_pk_fma_f32 v[44:45], v[42:43], v[42:43], v[44:45]
    v_pk_add_f32 v[44:45], v[44:45], v[46:47]
    v_add_f32 v44, v44, v45
    s_nop 1
    v_add_f32_dpp v44, v44, v44 row_ror:8 row_mask:0xf bank_mask:0xf
    s_nop 1
    v_add_f32_dpp v44, v44, v44 row_ror:4 row_mask:0xf bank_mask:0xf
    s_nop 1
    v_add_f32_dpp v44, v44, v44 row_ror:2 row_mask:0xf bank_mask:0xf
    s_nop 1
    v_add_f32_dpp v44, v44, v44 row_ror:1 row_mask:0xf bank_mask:0xf
    v_mov_b32 v46, v44
    s_nop 1
    v_permlane16_swap_b32 v44, v46
    v_add_f32 v44, v44, v46
    v_mul_f32 v44, 0x3ae38e39, v44
    v_cvt_pk_bf16_f32 v44, v44, v44
    v_and_b32 v44, 0xffff0000, v44
    v_add_f32 v44, 0x3727c5ac, v44
    v_cvt_pk_bf16_f32 v44, v44, v44
    v_and_b32 v44, 0xffff0000, v44
    v_sqrt_f32 v44, v44
    s_nop 0
    v_cvt_pk_bf16_f32 v44, v44, v44
    v_and_b32 v44, 0xffff0000, v44
    v_rcp_f32 v42, v44
    s_nop 0
    v_mov_b32 v43, v42
    v_mov_b32 v60, 0
    v_mov_b32 v61, 0
    v_pk_add_f32 v[44:45], v[20:21], v[40:41] neg_lo:[0,1] neg_hi:[0,1]
    v_cvt_pk_bf16_f32 v10, v44, v45
    v_lshlrev_b32 v44, 16, v10
    v_and_b32 v45, 0xffff0000, v10
    v_pk_mul_f32 v[44:45], v[44:45], v[42:43]
    v_cvt_pk_bf16_f32 v10, v44, v45
    v_lshlrev_b32 v44, 16, v10
    v_and_b32 v45, 0xffff0000, v10
    v_lshlrev_b32 v46, 16, v50
    v_and_b32 v47, 0xffff0000, v50
    v_pk_fma_f32 v[60:61], v[44:45], v[46:47], v[60:61]
    v_pk_add_f32 v[20:21], v[44:45], v[20:21]
    v_pk_add_f32 v[44:45], v[22:23], v[40:41] neg_lo:[0,1] neg_hi:[0,1]
    v_cvt_pk_bf16_f32 v11, v44, v45
    v_lshlrev_b32 v44, 16, v11
    v_and_b32 v45, 0xffff0000, v11
    v_pk_mul_f32 v[44:45], v[44:45], v[42:43]
    v_cvt_pk_bf16_f32 v11, v44, v45
    v_lshlrev_b32 v44, 16, v11
    v_and_b32 v45, 0xffff0000, v11
    v_lshlrev_b32 v46, 16, v51
    v_and_b32 v47, 0xffff0000, v51
    v_pk_fma_f32 v[60:61], v[44:45], v[46:47], v[60:61]
    v_pk_add_f32 v[22:23], v[44:45], v[22:23]
    v_pk_add_f32 v[44:45], v[24:25], v[40:41] neg_lo:[0,1] neg_hi:[0,1]
    v_cvt_pk_bf16_f32 v12, v44, v45
    v_lshlrev_b32 v44, 16, v12
    v_and_b32 v45, 0xffff0000, v12
    v_pk_mul_f32 v[44:45], v[44:45], v[42:43]
    v_cvt_pk_bf16_f32 v12, v44, v45
    v_lshlrev_b32 v44, 16, v12
    v_and_b32 v45, 0xffff0000, v12
    v_lshlrev_b32 v46, 16, v52
    v_and_b32 v47, 0xffff0000, v52
    v_pk_fma_f32 v[60:61], v[44:45], v[46:47], v[60:61]
    v_pk_add_f32 v[24:25], v[44:45], v[24:25]
    v_pk_add_f32 v[44:45], v[26:27], v[40:41] neg_lo:[0,1] neg_hi:[0,1]
    v_cvt_pk_bf16_f32 v13, v44, v45
    v_lshlrev_b32 v44, 16, v13
    v_and_b32 v45, 0xffff0000, v13
    v_pk_mul_f32 v[44:45], v[44:45], v[42:43]
    v_cvt_pk_bf16_f32 v13, v44, v45
    v_lshlrev_b32 v44, 16, v13
    v_and_b32 v45, 0xffff0000, v13
    v_lshlrev_b32 v46, 16, v53
    v_and_b32 v47, 0xffff0000, v53
    v_pk_fma_f32 v[60:61], v[44:45], v[46:47], v[60:61]
    v_pk_add_f32 v[26:27], v[44:45], v[26:27]
    v_pk_add_f32 v[44:45], v[28:29], v[40:41] neg_lo:[0,1] neg_hi:[0,1]
    v_cvt_pk_bf16_f32 v14, v44, v45
    v_lshlrev_b32 v44, 16, v14
    v_and_b32 v45, 0xffff0000, v14
    v_pk_mul_f32 v[44:45], v[44:45], v[42:43]
    v_cvt_pk_bf16_f32 v14, v44, v45
    v_lshlrev_b32 v44, 16, v14
    v_and_b32 v45, 0xffff0000, v14
    v_lshlrev_b32 v46, 16, v54
    v_and_b32 v47, 0xffff0000, v54
    v_pk_fma_f32 v[60:61], v[44:45], v[46:47], v[60:61]
    v_pk_add_f32 v[28:29], v[44:45], v[28:29]
    v_pk_add_f32 v[44:45], v[30:31], v[40:41] neg_lo:[0,1] neg_hi:[0,1]
    v_cvt_pk_bf16_f32 v15, v44, v45
    v_lshlrev_b32 v44, 16, v15
    v_and_b32 v45, 0xffff0000, v15
    v_pk_mul_f32 v[44:45], v[44:45], v[42:43]
    v_cvt_pk_bf16_f32 v15, v44, v45
    v_lshlrev_b32 v44, 16, v15
    v_and_b32 v45, 0xffff0000, v15
    v_lshlrev_b32 v46, 16, v55
    v_and_b32 v47, 0xffff0000, v55
    v_pk_fma_f32 v[60:61], v[44:45], v[46:47], v[60:61]
    v_pk_add_f32 v[30:31], v[44:45], v[30:31]
    v_pk_add_f32 v[44:45], v[32:33], v[40:41] neg_lo:[0,1] neg_hi:[0,1]
    v_cvt_pk_bf16_f32 v16, v44, v45
    v_lshlrev_b32 v44, 16, v16
    v_and_b32 v45, 0xffff0000, v16
    v_pk_mul_f32 v[44:45], v[44:45], v[42:43]
    v_cvt_pk_bf16_f32 v16, v44, v45
    v_lshlrev_b32 v44, 16, v16
    v_and_b32 v45, 0xffff0000, v16
    v_lshlrev_b32 v46, 16, v56
    v_and_b32 v47, 0xffff0000, v56
    v_pk_fma_f32 v[60:61], v[44:45], v[46:47], v[60:61]
    v_pk_add_f32 v[32:33], v[44:45], v[32:33]
    v_pk_add_f32 v[44:45], v[34:35], v[40:41] neg_lo:[0,1] neg_hi:[0,1]
    v_cvt_pk_bf16_f32 v17, v44, v45
    v_lshlrev_b32 v44, 16, v17
    v_and_b32 v45, 0xffff0000, v17
    v_pk_mul_f32 v[44:45], v[44:45], v[42:43]
    v_cvt_pk_bf16_f32 v17, v44, v45
    v_lshlrev_b32 v44, 16, v17
    v_and_b32 v45, 0xffff0000, v17
    v_lshlrev_b32 v46, 16, v57
    v_and_b32 v47, 0xffff0000, v57
    v_pk_fma_f32 v[60:61], v[44:45], v[46:47], v[60:61]
    v_pk_add_f32 v[34:35], v[44:45], v[34:35]
    v_pk_add_f32 v[44:45], v[36:37], v[40:41] neg_lo:[0,1] neg_hi:[0,1]
    v_cvt_pk_bf16_f32 v18, v44, v45
    v_lshlrev_b32 v44, 16, v18
    v_and_b32 v45, 0xffff0000, v18
    v_pk_mul_f32 v[44:45], v[44:45], v[42:43]
    v_cvt_pk_bf16_f32 v18, v44, v45
    v_lshlrev_b32 v44, 16, v18
    v_and_b32 v45, 0xffff0000, v18
    v_lshlrev_b32 v46, 16, v58
    v_and_b32 v47, 0xffff0000, v58
    v_pk_fma_f32 v[60:61], v[44:45], v[46:47], v[60:61]
    v_pk_add_f32 v[36:37], v[44:45], v[36:37]
    v_add_f32 v60, v60, v61
    s_nop 1
    v_add_f32_dpp v60, v60, v60 row_ror:8 row_mask:0xf bank_mask:0xf
    s_nop 1
    v_add_f32_dpp v60, v60, v60 row_ror:4 row_mask:0xf bank_mask:0xf
    s_nop 1
    v_add_f32_dpp v60, v60, v60 row_ror:2 row_mask:0xf bank_mask:0xf
    s_nop 1
    v_add_f32_dpp v60, v60, v60 row_ror:1 row_mask:0xf bank_mask:0xf
    v_mov_b32 v61, v60
    s_nop 1
    v_permlane16_swap_b32 v60, v61
    v_add_f32 v60, v60, v61
    v_cvt_pk_bf16_f32 v60, v60, v60
    v_ashrrev_i32 v61, 31, v60
    v_or_b32 v61, 0x80000000, v61
    v_xor_b32 v60, v60, v61
    v_and_b32 v60, 0xffff0000, v60
    v_sub_u32 v62, 0x87ff, v112
    v_or_b32 v60, v60, v62
    v_lshl_add_u32 v61, v116, 1, v113
    v_lshlrev_b32 v61, 2, v61
    s_mov_b32 exec_lo, 1
    s_mov_b32 exec_hi, 1
    ds_write_b32 v61, v60 offset:800
    s_mov_b64 exec, 1
    ds_add_rtn_u32 v62, v4, v5 offset:12
    s_mov_b64 exec, 3
    v_lshlrev_b32 v61, 4, v114
    s_lshl_b32 s92, s90, 5
    ds_read_b128 v[64:67], v61 offset:800
    s_waitcnt lgkmcnt(1)
    v_readfirstlane_b32 s93, v62
    s_cmp_lg_u32 s93, 3
    s_cbranch_scc1 KS_NOKEY
    s_waitcnt lgkmcnt(0)
    buffer_store_dwordx4 v[64:67], v61, s[76:79], s92 offen sc1
KS_NOKEY:
    s_mov_b64 exec, -1
    v_cvt_pk_bf16_f32 v58, v36, v37
    ds_write_b32 v108, v18
    ds_write_b32 v108, v58 offset:256
    ds_read_b128 v[64:67], v109
    buffer_store_dwordx4 v[10:13], v115, s[72:75], 0 offen sc1
    buffer_store_dwordx4 v[14:17], v115, s[72:75], 0 offen offset:512 sc1
    v_cvt_pk_bf16_f32 v50, v20, v21
    v_cvt_pk_bf16_f32 v51, v22, v23
    v_cvt_pk_bf16_f32 v52, v24, v25
    v_cvt_pk_bf16_f32 v53, v26, v27
    v_cvt_pk_bf16_f32 v54, v28, v29
    v_cvt_pk_bf16_f32 v55, v30, v31
    v_cvt_pk_bf16_f32 v56, v32, v33
    v_cvt_pk_bf16_f32 v57, v34, v35
    s_mov_b64 exec, 0xffff
    s_waitcnt lgkmcnt(0)
    buffer_store_dwordx4 v[64:67], v111, s[72:75], 0 offen offset:1024 sc1
    s_mov_b64 exec, 0xffff0000
    buffer_store_dwordx4 v[64:67], v111, s[68:71], 0 offen offset:1024 sc1
    s_mov_b64 exec, -1
    buffer_store_dwordx4 v[50:53], v115, s[68:71], 0 offen sc1
    buffer_store_dwordx4 v[54:57], v115, s[68:71], 0 offen offset:512 sc1
    s_cmp_lg_u32 s93, 3
    s_cbranch_scc1 KS_NOKEY2
    s_waitcnt vmcnt(6)
    ds_write_b32 v4, v5 offset:24
KS_NOKEY2:
    s_waitcnt vmcnt(0)
    s_mov_b64 exec, 1
    ds_add_rtn_u32 v62, v4, v5 offset:176
    s_waitcnt lgkmcnt(0)
    v_cmp_eq_u32 vcc, 3, v62
    s_and_b64 exec, exec, vcc
    s_cbranch_execz KS_NOF2
    s_lshl_b32 s92, s2, 4
    s_add_u32 s92, s92, 8192
    buffer_store_dword v5, v4, s[76:79], s92 offen sc1
KS_NOF2:
    s_mov_b64 exec, -1
    s_setprio 0
    s_cmp_lt_u32 s41, 18
    s_cbranch_scc1 KS_B
    s_waitcnt lgkmcnt(0)
    s_endpgm
KS_T:
    s_setprio 0
    s_cmp_ge_u32 s38, 10
    s_cbranch_scc1 KS_P
    v_and_b32 v6, 1, v1
    v_subrev_u32 v6, 1, v6
    v_and_b32 v7, 7, v1
    v_lshlrev_b32 v7, 2, v7
    s_add_u32 s76, s36, 0x840000
    s_addc_u32 s77, s37, 0
    s_mov_b32 s78, 0x3000
    s_mov_b32 s79, 0x20000
    s_cmp_eq_u32 s38, 9
    s_cbranch_scc1 KS_W9
    s_cmp_eq_u32 s38, 8
    s_cbranch_scc1 KS_L2W
    s_sub_u32 s93, s38, 4
    s_lshl_b32 s92, s93, 10
    v_lshl_add_u32 v33, v1, 4, s92
    s_movk_i32 s92, 4096
    s_lshl_b32 s93, s93, 7
    v_lshlrev_b32 v32, 4, v2
    v_lshl_add_u32 v32, v3, 5, v32
    v_add_u32 v32, s93, v32
W_77:
    s_sleep 1
    ds_read_b32 v8, v4 offset:24
    s_sub_u32 s39, s39, 1
    s_cbranch_scc1 KS_ABORT
    s_waitcnt lgkmcnt(0)
    v_cmp_eq_u32 vcc, 0, v8
    s_cbranch_vccnz W_77
    s_setprio 2
    s_sleep 20
    s_branch ZPE_79
ZP_78:
    s_sleep 4
ZPE_79:
    buffer_load_dwordx4 v[8:11], v33, s[76:79], 0 offen sc1
    buffer_load_dwordx4 v[12:15], v33, s[76:79], s92 offen sc1
    s_sub_u32 s39, s39, 1
    s_cbranch_scc1 KS_ABORT
    s_waitcnt vmcnt(0)
    v_max3_u32 v44, v8, v9, v10
    v_max3_u32 v44, v44, v11, v12
    v_max3_u32 v44, v44, v13, v14
    v_max_u32 v44, v44, v15
    v_cmp_eq_u32 vcc, -1, v44
    s_cbranch_vccnz ZP_78
    ds_write_b32 v4, v5 offset:196
    v_max_u32 v16, v8, v9
    v_min_u32 v9, v8, v9
    v_max_u32 v17, v12, v13
    v_min_u32 v13, v12, v13
    v_max_u32 v18, v10, v11
    v_min_u32 v11, v10, v11
    v_max_u32 v19, v14, v15
    v_min_u32 v15, v14, v15
    v_max_u32 v20, v16, v18
    v_min_u32 v18, v16, v18
    v_max_u32 v21, v17, v19
    v_min_u32 v19, v17, v19
    v_max_u32 v22, v9, v11
    v_min_u32 v11, v9, v11
    v_max_u32 v23, v13, v15
    v_min_u32 v15, v13, v15
    v_max_u32 v24, v22, v18
    v_min_u32 v18, v22, v18
    v_max_u32 v25, v23, v19
    v_min_u32 v19, v23, v19
    v_mov_b32_dpp v26, v11 quad_perm:[1,0,3,2] row_mask:0xf bank_mask:0xf
    v_mov_b32_dpp v27, v18 quad_perm:[1,0,3,2] row_mask:0xf bank_mask:0xf
    v_mov_b32_dpp v8, v24 quad_perm:[1,0,3,2] row_mask:0xf bank_mask:0xf
    v_mov_b32_dpp v12, v20 quad_perm:[1,0,3,2] row_mask:0xf bank_mask:0xf
    v_med3_u32 v26, v20, v26, v6
    v_med3_u32 v27, v24, v27, v6
    v_med3_u32 v8, v18, v8, v6
    v_med3_u32 v12, v11, v12, v6
    v_max_u32 v10, v26, v8
    v_min_u32 v8, v26, v8
    v_max_u32 v14, v27, v12
    v_min_u32 v12, v27, v12
    v_max_u32 v16, v10, v14
    v_min_u32 v14, v10, v14
    v_max_u32 v17, v8, v12
    v_min_u32 v12, v8, v12
    v_mov_b32_dpp v9, v15 quad_perm:[1,0,3,2] row_mask:0xf bank_mask:0xf
    v_mov_b32_dpp v13, v19 quad_perm:[1,0,3,2] row_mask:0xf bank_mask:0xf
    v_mov_b32_dpp v22, v25 quad_perm:[1,0,3,2] row_mask:0xf bank_mask:0xf
    v_mov_b32_dpp v23, v21 quad_perm:[1,0,3,2] row_mask:0xf bank_mask:0xf
    v_med3_u32 v9, v21, v9, v6
    v_med3_u32 v13, v25, v13, v6
    v_med3_u32 v22, v19, v22, v6
    v_med3_u32 v23, v15, v23, v6
    v_max_u32 v20, v9, v22
    v_min_u32 v22, v9, v22
    v_max_u32 v24, v13, v23
    v_min_u32 v23, v13, v23
    v_max_u32 v18, v20, v24
    v_min_u32 v24, v20, v24
    v_max_u32 v11, v22, v23
    v_min_u32 v23, v22, v23
    s_nop 1
    v_max_u32_dpp v16, v23, v16 quad_perm:[1,0,3,2] row_mask:0xf bank_mask:0xf
    v_max_u32_dpp v14, v11, v14 quad_perm:[1,0,3,2] row_mask:0xf bank_mask:0xf
    v_max_u32_dpp v17, v24, v17 quad_perm:[1,0,3,2] row_mask:0xf bank_mask:0xf
    v_max_u32_dpp v12, v18, v12 quad_perm:[1,0,3,2] row_mask:0xf bank_mask:0xf
    v_mov_b32_dpp v26, v16 quad_perm:[1,0,3,2] row_mask:0xf bank_mask:0xf
    v_mov_b32_dpp v27, v14 quad_perm:[1,0,3,2] row_mask:0xf bank_mask:0xf
    v_mov_b32_dpp v10, v17 quad_perm:[1,0,3,2] row_mask:0xf bank_mask:0xf
    v_mov_b32_dpp v8, v12 quad_perm:[1,0,3,2] row_mask:0xf bank_mask:0xf
    v_med3_u32 v26, v16, v26, v6
    v_med3_u32 v27, v14, v27, v6
    v_med3_u32 v10, v17, v10, v6
    v_med3_u32 v8, v12, v8, v6
    v_max_u32 v21, v26, v10
    v_min_u32 v10, v26, v10
    v_max_u32 v25, v27, v8
    v_min_u32 v8, v27, v8
    v_max_u32 v19, v21, v25
    v_min_u32 v25, v21, v25
    v_max_u32 v15, v10, v8
    v_min_u32 v8, v10, v8
    s_nop 1
    v_max_u32_dpp v9, v8, v19 quad_perm:[3,2,1,0] row_mask:0xf bank_mask:0xf
    v_max_u32_dpp v13, v15, v25 quad_perm:[3,2,1,0] row_mask:0xf bank_mask:0xf
    v_max_u32_dpp v20, v25, v15 quad_perm:[3,2,1,0] row_mask:0xf bank_mask:0xf
    v_max_u32_dpp v22, v19, v8 quad_perm:[3,2,1,0] row_mask:0xf bank_mask:0xf
    v_mov_b32_dpp v18, v9 quad_perm:[1,0,3,2] row_mask:0xf bank_mask:0xf
    v_mov_b32_dpp v24, v13 quad_perm:[1,0,3,2] row_mask:0xf bank_mask:0xf
    v_mov_b32_dpp v11, v20 quad_perm:[1,0,3,2] row_mask:0xf bank_mask:0xf
    v_mov_b32_dpp v23, v22 quad_perm:[1,0,3,2] row_mask:0xf bank_mask:0xf
    v_med3_u32 v18, v9, v18, v6
    v_med3_u32 v24, v13, v24, v6
    v_med3_u32 v11, v20, v11, v6
    v_med3_u32 v23, v22, v23, v6
    v_max_u32 v16, v18, v11
    v_min_u32 v11, v18, v11
    v_max_u32 v14, v24, v23
    v_min_u32 v23, v24, v23
    v_max_u32 v17, v16, v14
    v_min_u32 v14, v16, v14
    v_max_u32 v12, v11, v23
    v_min_u32 v23, v11, v23
    s_nop 1
    v_max_u32_dpp v26, v23, v17 row_half_mirror row_mask:0xf bank_mask:0xf
    v_max_u32_dpp v27, v12, v14 row_half_mirror row_mask:0xf bank_mask:0xf
    v_max_u32_dpp v21, v14, v12 row_half_mirror row_mask:0xf bank_mask:0xf
    v_max_u32_dpp v10, v17, v23 row_half_mirror row_mask:0xf bank_mask:0xf
    v_mov_b32_dpp v19, v26 quad_perm:[1,0,3,2] row_mask:0xf bank_mask:0xf
    v_mov_b32_dpp v25, v27 quad_perm:[1,0,3,2] row_mask:0xf bank_mask:0xf
    v_mov_b32_dpp v15, v21 quad_perm:[1,0,3,2] row_mask:0xf bank_mask:0xf
    v_mov_b32_dpp v8, v10 quad_perm:[1,0,3,2] row_mask:0xf bank_mask:0xf
    v_med3_u32 v19, v26, v19, v6
    v_med3_u32 v25, v27, v25, v6
    v_med3_u32 v15, v21, v15, v6
    v_med3_u32 v8, v10, v8, v6
    v_max_u32 v9, v19, v15
    v_min_u32 v15, v19, v15
    v_max_u32 v13, v25, v8
    v_min_u32 v8, v25, v8
    v_max_u32 v20, v9, v13
    v_min_u32 v13, v9, v13
    v_max_u32 v22, v15, v8
    v_min_u32 v8, v15, v8
    s_nop 1
    v_max_u32_dpp v18, v8, v20 row_mirror row_mask:0xf bank_mask:0xf
    v_max_u32_dpp v24, v22, v13 row_mirror row_mask:0xf bank_mask:0xf
    v_max_u32_dpp v16, v13, v22 row_mirror row_mask:0xf bank_mask:0xf
    v_max_u32_dpp v11, v20, v8 row_mirror row_mask:0xf bank_mask:0xf
    v_mov_b32_dpp v17, v18 quad_perm:[1,0,3,2] row_mask:0xf bank_mask:0xf
    v_mov_b32_dpp v14, v24 quad_perm:[1,0,3,2] row_mask:0xf bank_mask:0xf
    v_mov_b32_dpp v12, v16 quad_perm:[1,0,3,2] row_mask:0xf bank_mask:0xf
    v_mov_b32_dpp v23, v11 quad_perm:[1,0,3,2] row_mask:0xf bank_mask:0xf
    v_med3_u32 v17, v18, v17, v6
    v_med3_u32 v14, v24, v14, v6
    v_med3_u32 v12, v16, v12, v6
    v_med3_u32 v23, v11, v23, v6
    v_max_u32 v26, v17, v12
    v_min_u32 v12, v17, v12
    v_max_u32 v27, v14, v23
    v_min_u32 v23, v14, v23
    v_max_u32 v21, v26, v27
    v_min_u32 v27, v26, v27
    v_max_u32 v10, v12, v23
    v_min_u32 v23, v12, v23
    v_mov_b32 v28, v21
    v_mov_b32 v29, v27
    v_mov_b32 v30, v10
    v_mov_b32 v31, v23
    s_mov_b32 exec_lo, 0x00030003
    s_mov_b32 exec_hi, 0x00030003
    ds_write_b128 v32, v[28:31] offset:256
    s_mov_b64 exec, -1
    s_setprio 0
    s_branch KS_B
KS_L2W:
    s_add_u32 s72, s36, 0x300000
    s_addc_u32 s73, s37, 0
    s_mov_b32 s74, 0x240000
    s_mov_b32 s75, 0x20000
    s_mov_b32 s92, 0xcccccccc
    s_mov_b32 s93, 0xcccccccc
    s_mov_b32 s94, 0xf0f0f0f0
    s_mov_b32 s95, 0xf0f0f0f0
    s_movk_i32 s96, 1152
    v_lshrrev_b32 v34, 3, v1
    v_lshlrev_b32 v34, 4, v34
    v_lshlrev_b32 v33, 4, v2
W_80:
    s_sleep 1
    ds_read_b32 v8, v4 offset:24
    s_sub_u32 s39, s39, 1
    s_cbranch_scc1 KS_ABORT
    s_waitcnt lgkmcnt(0)
    v_cmp_eq_u32 vcc, 0, v8
    s_cbranch_vccnz W_80
    s_setprio 2
KS_L2POLL:
    ds_read_b128 v[8:11], v33 offset:256
    ds_read_b128 v[12:15], v33 offset:512
    s_sub_u32 s39, s39, 1
    s_cbranch_scc1 KS_ABORT
    s_waitcnt lgkmcnt(0)
    v_min3_u32 v16, v8, v9, v10
    v_min3_u32 v17, v11, v12, v13
    v_min3_u32 v16, v16, v14, v15
    v_min_u32 v16, v16, v17
    v_cmp_eq_u32 vcc, 0, v16
    s_cbranch_vccnz KS_L2POLL
    v_max_u32_dpp v8, v15, v8 quad_perm:[1,0,3,2] row_mask:0xf bank_mask:0xf
    v_max_u32_dpp v9, v14, v9 quad_perm:[1,0,3,2] row_mask:0xf bank_mask:0xf
    v_max_u32_dpp v10, v13, v10 quad_perm:[1,0,3,2] row_mask:0xf bank_mask:0xf
    v_max_u32_dpp v11, v12, v11 quad_perm:[1,0,3,2] row_mask:0xf bank_mask:0xf
    v_mov_b32_dpp v16, v8 quad_perm:[1,0,3,2] row_mask:0xf bank_mask:0xf
    v_mov_b32_dpp v17, v9 quad_perm:[1,0,3,2] row_mask:0xf bank_mask:0xf
    v_mov_b32_dpp v18, v10 quad_perm:[1,0,3,2] row_mask:0xf bank_mask:0xf
    v_mov_b32_dpp v19, v11 quad_perm:[1,0,3,2] row_mask:0xf bank_mask:0xf
    v_med3_u32 v16, v8, v16, v6
    v_med3_u32 v17, v9, v17, v6
    v_med3_u32 v18, v10, v18, v6
    v_med3_u32 v19, v11, v19, v6
    v_max_u32 v20, v16, v18
    v_min_u32 v18, v16, v18
    v_max_u32 v21, v17, v19
    v_min_u32 v19, v17, v19
    v_max_u32 v22, v20, v21
    v_min_u32 v21, v20, v21
    v_max_u32 v23, v18, v19
    v_min_u32 v19, v18, v19
    s_nop 1
    v_max_u32_dpp v24, v19, v22 quad_perm:[3,2,1,0] row_mask:0xf bank_mask:0xf
    v_max_u32_dpp v25, v23, v21 quad_perm:[3,2,1,0] row_mask:0xf bank_mask:0xf
    v_max_u32_dpp v26, v21, v23 quad_perm:[3,2,1,0] row_mask:0xf bank_mask:0xf
    v_max_u32_dpp v27, v22, v19 quad_perm:[3,2,1,0] row_mask:0xf bank_mask:0xf
    v_mov_b32_dpp v12, v24 quad_perm:[1,0,3,2] row_mask:0xf bank_mask:0xf
    v_mov_b32_dpp v13, v25 quad_perm:[1,0,3,2] row_mask:0xf bank_mask:0xf
    v_mov_b32_dpp v14, v26 quad_perm:[1,0,3,2] row_mask:0xf bank_mask:0xf
    v_mov_b32_dpp v15, v27 quad_perm:[1,0,3,2] row_mask:0xf bank_mask:0xf
    v_med3_u32 v12, v24, v12, v6
    v_med3_u32 v13, v25, v13, v6
    v_med3_u32 v14, v26, v14, v6
    v_med3_u32 v15, v27, v15, v6
    v_max_u32 v8, v12, v14
    v_min_u32 v14, v12, v14
    v_max_u32 v9, v13, v15
    v_min_u32 v15, v13, v15
    v_max_u32 v10, v8, v9
    v_min_u32 v9, v8, v9
    v_max_u32 v11, v14, v15
    v_min_u32 v15, v14, v15
    s_nop 1
    v_max_u32_dpp v16, v15, v10 row_half_mirror row_mask:0xf bank_mask:0xf
    v_max_u32_dpp v17, v11, v9 row_half_mirror row_mask:0xf bank_mask:0xf
    v_max_u32_dpp v20, v9, v11 row_half_mirror row_mask:0xf bank_mask:0xf
    v_max_u32_dpp v18, v10, v15 row_half_mirror row_mask:0xf bank_mask:0xf
    v_mov_b32_dpp v22, v16 quad_perm:[1,0,3,2] row_mask:0xf bank_mask:0xf
    v_mov_b32_dpp v21, v17 quad_perm:[1,0,3,2] row_mask:0xf bank_mask:0xf
    v_mov_b32_dpp v23, v20 quad_perm:[1,0,3,2] row_mask:0xf bank_mask:0xf
    v_mov_b32_dpp v19, v18 quad_perm:[1,0,3,2] row_mask:0xf bank_mask:0xf
    v_med3_u32 v22, v16, v22, v6
    v_med3_u32 v21, v17, v21, v6
    v_med3_u32 v23, v20, v23, v6
    v_med3_u32 v19, v18, v19, v6
    v_max_u32 v24, v22, v23
    v_min_u32 v23, v22, v23
    v_max_u32 v25, v21, v19
    v_min_u32 v19, v21, v19
    v_max_u32 v26, v24, v25
    v_min_u32 v25, v24, v25
    v_max_u32 v27, v23, v19
    v_min_u32 v19, v23, v19
    s_nop 1
    v_max_u32_dpp v12, v19, v26 row_mirror row_mask:0xf bank_mask:0xf
    v_max_u32_dpp v13, v27, v25 row_mirror row_mask:0xf bank_mask:0xf
    v_max_u32_dpp v8, v25, v27 row_mirror row_mask:0xf bank_mask:0xf
    v_max_u32_dpp v14, v26, v19 row_mirror row_mask:0xf bank_mask:0xf
    ds_read_b32 v35, v4 offset:28
    v_cndmask_b32 v30, v12, v13, s[92:93]
    v_cndmask_b32 v31, v8, v14, s[92:93]
    v_cndmask_b32 v30, v30, v31, s[94:95]
    s_nop 1
    v_mov_b32_dpp v30, v30 row_shr:8 row_mask:0xf bank_mask:0xc
    v_and_b32 v31, 0x7ff, v30
    v_sub_u32 v31, 2047, v31
    v_mad_u32_u24 v31, v31, s96, v34
    s_waitcnt lgkmcnt(0)
    v_cmp_ne_u32 vcc, 0, v35
    s_cbranch_vccnz KS_RW1
W_81:
    ds_read_b32 v35, v4 offset:28
    s_sub_u32 s39, s39, 1
    s_cbranch_scc1 KS_ABORT
    s_waitcnt lgkmcnt(0)
    v_cmp_eq_u32 vcc, 0, v35
    s_cbranch_vccnz W_81
KS_RW1:
    s_mov_b32 m0, 17088
    s_nop 0
    buffer_load_dwordx4 v31, s[72:75], 0 offen offset:0 sc1 lds
    s_mov_b32 m0, 17984
    s_nop 0
    buffer_load_dwordx4 v31, s[72:75], 0 offen offset:128 sc1 lds
    s_mov_b32 m0, 18880
    s_nop 0
    buffer_load_dwordx4 v31, s[72:75], 0 offen offset:256 sc1 lds
    s_mov_b32 m0, 19776
    s_nop 0
    buffer_load_dwordx4 v31, s[72:75], 0 offen offset:384 sc1 lds
    s_mov_b32 m0, 20672
    s_nop 0
    buffer_load_dwordx4 v31, s[72:75], 0 offen offset:512 sc1 lds
    s_mov_b32 m0, 21568
    s_nop 0
    buffer_load_dwordx4 v31, s[72:75], 0 offen offset:640 sc1 lds
    s_mov_b32 m0, 22464
    s_nop 0
    buffer_load_dwordx4 v31, s[72:75], 0 offen offset:768 sc1 lds
    s_mov_b32 m0, 23360
    s_nop 0
    buffer_load_dwordx4 v31, s[72:75], 0 offen offset:896 sc1 lds
    s_mov_b32 m0, 24256
    s_nop 0
    buffer_load_dwordx4 v31, s[72:75], 0 offen offset:1024 sc1 lds
    ds_write_b32 v7, v30 offset:768
    s_waitcnt vmcnt(0)
    ds_write_b32 v4, v5 offset:32
    s_setprio 0
    s_branch KS_B
KS_W9:
    v_lshlrev_b32 v33, 4, v1
    s_movk_i32 s92, 0x2000
    s_add_u32 s72, s36, 0x300000
    s_addc_u32 s73, s37, 0
    s_mov_b32 s74, 0x240000
    s_mov_b32 s75, 0x20000
    s_add_u32 s64, s36, 0x600000
    s_addc_u32 s65, s37, 0
    s_mov_b32 s66, 0x240000
    s_mov_b32 s67, 0x20000
    s_mov_b32 s68, s4
    s_mov_b32 s69, s5
    s_mov_b32 s70, 0x240000
    s_mov_b32 s71, 0x20000
    v_bfe_u32 v43, v1, 2, 3
    s_lshl_b32 s93, s89, 3
    v_add_u32 v43, s93, v43
    v_bfe_u32 v40, v43, 4, 1
    v_and_b32 v41, 3, v1
    v_lshl_add_u32 v40, v40, 2, v41
    v_lshlrev_b32 v40, 2, v40
    v_lshrrev_b32 v41, 5, v43
    v_lshlrev_b32 v41, 4, v41
    v_and_b32 v42, 15, v43
    v_add_u32 v41, v41, v42
W_82:
    s_sleep 1
    ds_read_b32 v8, v4 offset:196
    s_sub_u32 s39, s39, 1
    s_cbranch_scc1 KS_ABORT
    s_waitcnt lgkmcnt(0)
    v_cmp_eq_u32 vcc, 0, v8
    s_cbranch_vccnz W_82
    s_sleep 8
    s_setprio 2
    s_branch ZPE_84
ZP_83:
    s_sleep 4
ZPE_84:
    buffer_load_dword v8, v33, s[76:79], s92 offen offset:0 sc1
    buffer_load_dword v9, v33, s[76:79], s92 offen offset:1024 sc1
    buffer_load_dword v10, v33, s[76:79], s92 offen offset:2048 sc1
    buffer_load_dword v11, v33, s[76:79], s92 offen offset:3072 sc1
    s_sub_u32 s39, s39, 1
    s_cbranch_scc1 KS_ABORT
    s_waitcnt vmcnt(0)
    v_max3_u32 v44, v8, v9, v10
    v_max_u32 v44, v44, v11
    v_cmp_eq_u32 vcc, -1, v44
    s_cbranch_vccnz ZP_83
    ds_write_b32 v4, v5 offset:28
    s_setprio 0
W_85:
    s_sleep 1
    ds_read_b32 v12, v7 offset:768
    s_sub_u32 s39, s39, 1
    s_cbranch_scc1 KS_ABORT
    s_waitcnt lgkmcnt(0)
    v_cmp_eq_u32 vcc, 0, v12
    s_cbranch_vccnz W_85
    ds_read_b32 v19, v40 offset:768
    s_waitcnt lgkmcnt(0)
    v_and_b32 v14, 0x7ff, v19
    v_sub_u32 v14, 2047, v14
    v_mul_u32_u24 v23, 1152, v14
    v_lshl_add_u32 v23, v41, 1, v23
    buffer_load_ushort v20, v23, s[72:75], 0 offen sc1
    buffer_load_ushort v17, v23, s[68:71], 0 offen
    v_lshrrev_b32 v15, 9, v14
    v_bfe_u32 v16, v14, 6, 2
    v_lshl_add_u32 v15, v15, 2, v16
    v_bfe_u32 v16, v14, 2, 2
    v_lshl_add_u32 v15, v15, 2, v16
    v_bfe_u32 v16, v14, 4, 1
    v_bfe_u32 v24, v14, 8, 1
    v_and_b32 v25, 3, v14
    v_lshl_add_u32 v24, v24, 2, v25
    v_lshlrev_b32 v24, 1, v24
    v_bfe_u32 v25, v14, 5, 1
    v_lshl_add_u32 v24, v25, 5, v24
    v_lshl_add_u32 v25, v15, 1, v16
    v_lshl_add_u32 v25, v25, 14, v24
    v_lshrrev_b32 v26, 1, v41
    v_lshl_add_u32 v25, v26, 6, v25
    v_xor_b32 v26, v41, v16
    v_not_b32 v26, v26
    v_and_b32 v26, 1, v26
    v_lshl_add_u32 v25, v26, 4, v25
    v_lshl_add_u32 v26, v15, 12, v24
    v_lshl_add_u32 v26, v16, 4, v26
    v_lshl_add_u32 v26, v41, 6, v26
    v_add_u32 v26, 2064384, v26
    v_cmp_gt_u32 vcc, 0x200, v41
    s_nop 1
    v_cndmask_b32 v25, v26, v25, vcc
    buffer_load_ushort v18, v25, s[64:67], 0 offen sc1
    s_add_u32 s72, s36, 0xb10000
    s_addc_u32 s73, s37, 0
    s_mov_b32 s74, 0x40
    s_mov_b32 s75, 0x20000
    v_ashrrev_i32 v22, 31, v19
    v_not_b32 v22, v22
    v_or_b32 v22, 0x80000000, v22
    v_xor_b32 v22, v19, v22
    v_and_b32 v22, 0xffff0000, v22
    v_mul_f32 v22, 0xbfb8aa3b, v22
    v_exp_f32 v22, v22
    s_nop 0
    v_add_f32 v22, 1.0, v22
    v_rcp_f32 v22, v22
    s_nop 0
    v_cvt_pk_bf16_f32 v22, v22, v22
    v_lshlrev_b32 v22, 16, v22
    v_and_b32 v14, 31, v1
    v_lshlrev_b32 v14, 4, v14
    s_waitcnt vmcnt(0)
    v_lshlrev_b32 v17, 16, v17
    v_lshlrev_b32 v18, 16, v18
    v_add_f32 v17, v17, v18
    v_cvt_pk_bf16_f32 v17, v17, v17
    v_and_b32 v21, 0xffff0000, v17
    v_lshlrev_b32 v20, 16, v20
    ds_write_b128 v14, v[20:23] offset:1536
    s_cmp_lg_u32 s2, 0
    s_cbranch_scc1 KS_W9E
    buffer_store_dword v12, v7, s[72:75], 0 offen
KS_W9E:
    s_waitcnt lgkmcnt(0)
    s_endpgm
KS_B:
    s_add_u32 s64, s36, 0x850000
    s_addc_u32 s65, s37, 0
    s_mov_b32 s66, 0x288000
    s_mov_b32 s67, 0x20000
    v_bfe_u32 v16, v1, 2, 2
    v_lshl_add_u32 v16, v3, 3, v16
    v_mul_u32_u24 v16, 1152, v16
    v_and_b32 v17, 3, v1
    v_lshl_add_u32 v16, v17, 3, v16
    s_lshl_b32 s92, s38, 7
    s_add_u32 s92, s92, 109184
    v_add_u32 v16, s92, v16
W_86:
    ds_read_b32 v17, v4 offset:40
    s_sub_u32 s39, s39, 1
    s_cbranch_scc1 KS_ABORT
    s_waitcnt lgkmcnt(0)
    v_cmp_ne_u32 vcc, s84, v17
    s_cbranch_vccnz W_86
    ds_read_b64_tr_b16 v[48:49], v16 offset:0
    ds_read_b64_tr_b16 v[50:51], v16 offset:4608
    ds_read_b64_tr_b16 v[52:53], v16 offset:32
    ds_read_b64_tr_b16 v[54:55], v16 offset:4640
    ds_read_b64_tr_b16 v[56:57], v16 offset:64
    ds_read_b64_tr_b16 v[58:59], v16 offset:4672
    ds_read_b64_tr_b16 v[60:61], v16 offset:96
    ds_read_b64_tr_b16 v[62:63], v16 offset:4704
    v_and_b32 v16, 7, v2
    v_lshlrev_b32 v16, 6, v16
    v_lshl_add_u32 v16, v3, 4, v16
    s_mul_i32 s92, s89, 18432
    s_lshl_b32 s93, s38, 11
    s_add_u32 s92, s92, s93
    v_lshlrev_b32 v17, 4, v1
    s_waitcnt lgkmcnt(0)
    s_barrier
    s_barrier
    ds_read_b128 v[20:23], v16 offset:1024
    s_waitcnt lgkmcnt(0)
    v_mfma_f32_16x16x32_bf16 v[32:35], v[20:23], v[48:51], 0
    v_mfma_f32_16x16x32_bf16 v[36:39], v[20:23], v[52:55], 0
    v_mfma_f32_16x16x32_bf16 v[40:43], v[20:23], v[56:59], 0
    v_mfma_f32_16x16x32_bf16 v[44:47], v[20:23], v[60:63], 0
    s_nop 5
    v_permlane32_swap_b32 v32, v36
    v_permlane32_swap_b32 v33, v37
    v_permlane32_swap_b32 v34, v38
    v_permlane32_swap_b32 v35, v39
    v_min_u32 v32, -2, v32
    v_min_u32 v33, -2, v33
    v_min_u32 v34, -2, v34
    v_min_u32 v35, -2, v35
    buffer_store_dwordx4 v[32:35], v17, s[64:67], s92 offen offset:0 sc1
    v_permlane32_swap_b32 v40, v44
    v_permlane32_swap_b32 v41, v45
    v_permlane32_swap_b32 v42, v46
    v_permlane32_swap_b32 v43, v47
    v_min_u32 v40, -2, v40
    v_min_u32 v41, -2, v41
    v_min_u32 v42, -2, v42
    v_min_u32 v43, -2, v43
    buffer_store_dwordx4 v[40:43], v17, s[64:67], s92 offen offset:1024 sc1
    s_waitcnt vmcnt(0)
    s_barrier
    s_endpgm
KS_G:
    s_mov_b32 s98, 0x05040100
    s_mov_b32 s99, 0x07060302
    s_waitcnt vmcnt(0)
    s_sub_u32 s87, s38, 12
    s_mul_i32 s92, s87, 9
    s_add_u32 s92, s92, 1
    s_lshr_b32 s86, s92, 1
    s_lshl_b32 s92, s86, 5
    v_lshl_add_u32 v7, v3, 3, s92
    v_mul_u32_u24 v7, 9216, v7
    v_and_b32 v6, 7, v2
    v_lshl_add_u32 v7, v6, 3, v7
    s_lshl_b32 s92, s89, 6
    v_add_u32 v7, s92, v7
    v_cmp_gt_u32 vcc, 8, v2
    s_mov_b32 s76, 9216
    s_mov_b32 s77, 0
    s_mov_b32 s78, 230400
    s_mov_b32 s79, 0
    v_mov_b32 v46, s26
    v_mov_b32 v47, s27
    v_mov_b32 v6, s28
    v_cndmask_b32 v46, v6, v46, vcc
    v_mov_b32 v6, s29
    v_cndmask_b32 v47, v6, v47, vcc
    v_add_co_u32 v46, vcc, v46, v7
    s_nop 1
    v_addc_co_u32 v47, vcc, 0, v47, vcc
W_87:
    s_sleep 2
    ds_read_b32 v10, v4 offset:16
    s_sub_u32 s39, s39, 1
    s_cbranch_scc1 KS_ABORT
    s_waitcnt lgkmcnt(0)
    v_cmp_ne_u32 vcc, s84, v10
    s_cbranch_vccnz W_87
    global_load_dwordx2 v[48:49], v[46:47], off
    v_lshl_add_u64 v[46:47], v[46:47], 0, s[76:77]
    global_load_dwordx2 v[50:51], v[46:47], off
    v_lshl_add_u64 v[46:47], v[46:47], 0, s[76:77]
    global_load_dwordx2 v[52:53], v[46:47], off
    v_lshl_add_u64 v[46:47], v[46:47], 0, s[76:77]
    global_load_dwordx2 v[54:55], v[46:47], off
    v_lshl_add_u64 v[46:47], v[46:47], 0, s[76:77]
    global_load_dwordx2 v[56:57], v[46:47], off
    v_lshl_add_u64 v[46:47], v[46:47], 0, s[76:77]
    global_load_dwordx2 v[58:59], v[46:47], off
    v_lshl_add_u64 v[46:47], v[46:47], 0, s[76:77]
    global_load_dwordx2 v[60:61], v[46:47], off
    v_lshl_add_u64 v[46:47], v[46:47], 0, s[76:77]
    global_load_dwordx2 v[62:63], v[46:47], off
    v_lshl_add_u64 v[46:47], v[46:47], 0, s[78:79]
    global_load_dwordx2 v[64:65], v[46:47], off
    v_lshl_add_u64 v[46:47], v[46:47], 0, s[76:77]
    global_load_dwordx2 v[66:67], v[46:47], off
    v_lshl_add_u64 v[46:47], v[46:47], 0, s[76:77]
    global_load_dwordx2 v[68:69], v[46:47], off
    v_lshl_add_u64 v[46:47], v[46:47], 0, s[76:77]
    global_load_dwordx2 v[70:71], v[46:47], off
    v_lshl_add_u64 v[46:47], v[46:47], 0, s[76:77]
    global_load_dwordx2 v[72:73], v[46:47], off
    v_lshl_add_u64 v[46:47], v[46:47], 0, s[76:77]
    global_load_dwordx2 v[74:75], v[46:47], off
    v_lshl_add_u64 v[46:47], v[46:47], 0, s[76:77]
    global_load_dwordx2 v[76:77], v[46:47], off
    v_lshl_add_u64 v[46:47], v[46:47], 0, s[76:77]
    global_load_dwordx2 v[78:79], v[46:47], off
    v_lshl_add_u64 v[46:47], v[46:47], 0, s[78:79]
    global_load_dwordx2 v[80:81], v[46:47], off
    v_lshl_add_u64 v[46:47], v[46:47], 0, s[76:77]
    global_load_dwordx2 v[82:83], v[46:47], off
    v_lshl_add_u64 v[46:47], v[46:47], 0, s[76:77]
    global_load_dwordx2 v[84:85], v[46:47], off
    v_lshl_add_u64 v[46:47], v[46:47], 0, s[76:77]
    global_load_dwordx2 v[86:87], v[46:47], off
    v_lshl_add_u64 v[46:47], v[46:47], 0, s[76:77]
    global_load_dwordx2 v[88:89], v[46:47], off
    v_lshl_add_u64 v[46:47], v[46:47], 0, s[76:77]
    global_load_dwordx2 v[90:91], v[46:47], off
    v_lshl_add_u64 v[46:47], v[46:47], 0, s[76:77]
    global_load_dwordx2 v[92:93], v[46:47], off
    v_lshl_add_u64 v[46:47], v[46:47], 0, s[76:77]
    global_load_dwordx2 v[94:95], v[46:47], off
    v_lshl_add_u64 v[46:47], v[46:47], 0, s[78:79]
    global_load_dwordx2 v[96:97], v[46:47], off
    v_lshl_add_u64 v[46:47], v[46:47], 0, s[76:77]
    global_load_dwordx2 v[98:99], v[46:47], off
    v_lshl_add_u64 v[46:47], v[46:47], 0, s[76:77]
    global_load_dwordx2 v[100:101], v[46:47], off
    v_lshl_add_u64 v[46:47], v[46:47], 0, s[76:77]
    global_load_dwordx2 v[102:103], v[46:47], off
    v_lshl_add_u64 v[46:47], v[46:47], 0, s[76:77]
    global_load_dwordx2 v[104:105], v[46:47], off
    v_lshl_add_u64 v[46:47], v[46:47], 0, s[76:77]
    global_load_dwordx2 v[106:107], v[46:47], off
    v_lshl_add_u64 v[46:47], v[46:47], 0, s[76:77]
    global_load_dwordx2 v[108:109], v[46:47], off
    v_lshl_add_u64 v[46:47], v[46:47], 0, s[76:77]
    global_load_dwordx2 v[110:111], v[46:47], off
    v_lshl_add_u64 v[46:47], v[46:47], 0, s[78:79]
    s_bitcmp1_b32 s87, 0
    s_cbranch_scc1 KS_G4
    global_load_dwordx2 v[112:113], v[46:47], off
    v_lshl_add_u64 v[46:47], v[46:47], 0, s[76:77]
    global_load_dwordx2 v[114:115], v[46:47], off
    v_lshl_add_u64 v[46:47], v[46:47], 0, s[76:77]
    global_load_dwordx2 v[116:117], v[46:47], off
    v_lshl_add_u64 v[46:47], v[46:47], 0, s[76:77]
    global_load_dwordx2 v[118:119], v[46:47], off
    v_lshl_add_u64 v[46:47], v[46:47], 0, s[76:77]
    global_load_dwordx2 v[120:121], v[46:47], off
    v_lshl_add_u64 v[46:47], v[46:47], 0, s[76:77]
    global_load_dwordx2 v[122:123], v[46:47], off
    v_lshl_add_u64 v[46:47], v[46:47], 0, s[76:77]
    global_load_dwordx2 v[124:125], v[46:47], off
    v_lshl_add_u64 v[46:47], v[46:47], 0, s[76:77]
    global_load_dwordx2 v[126:127], v[46:47], off
KS_G4:
    v_mov_b32 v6, s87
    ds_write_b8 v6, v5 offset:192
    s_waitcnt vmcnt(0)
    v_perm_b32 v32, v50, v48, s98
    v_perm_b32 v33, v54, v52, s98
    v_perm_b32 v34, v58, v56, s98
    v_perm_b32 v35, v62, v60, s98
    v_perm_b32 v36, v50, v48, s99
    v_perm_b32 v37, v54, v52, s99
    v_perm_b32 v38, v58, v56, s99
    v_perm_b32 v39, v62, v60, s99
    v_perm_b32 v40, v51, v49, s98
    v_perm_b32 v41, v55, v53, s98
    v_perm_b32 v42, v59, v57, s98
    v_perm_b32 v43, v63, v61, s98
    v_perm_b32 v44, v51, v49, s99
    v_perm_b32 v45, v55, v53, s99
    v_perm_b32 v46, v59, v57, s99
    v_perm_b32 v47, v63, v61, s99
    v_perm_b32 v48, v66, v64, s98
    v_perm_b32 v49, v70, v68, s98
    v_perm_b32 v50, v74, v72, s98
    v_perm_b32 v51, v78, v76, s98
    v_perm_b32 v52, v66, v64, s99
    v_perm_b32 v53, v70, v68, s99
    v_perm_b32 v54, v74, v72, s99
    v_perm_b32 v55, v78, v76, s99
    v_perm_b32 v56, v67, v65, s98
    v_perm_b32 v57, v71, v69, s98
    v_perm_b32 v58, v75, v73, s98
    v_perm_b32 v59, v79, v77, s98
    v_perm_b32 v60, v67, v65, s99
    v_perm_b32 v61, v71, v69, s99
    v_perm_b32 v62, v75, v73, s99
    v_perm_b32 v63, v79, v77, s99
    v_perm_b32 v64, v82, v80, s98
    v_perm_b32 v65, v86, v84, s98
    v_perm_b32 v66, v90, v88, s98
    v_perm_b32 v67, v94, v92, s98
    v_perm_b32 v68, v82, v80, s99
    v_perm_b32 v69, v86, v84, s99
    v_perm_b32 v70, v90, v88, s99
    v_perm_b32 v71, v94, v92, s99
    v_perm_b32 v72, v83, v81, s98
    v_perm_b32 v73, v87, v85, s98
    v_perm_b32 v74, v91, v89, s98
    v_perm_b32 v75, v95, v93, s98
    v_perm_b32 v76, v83, v81, s99
    v_perm_b32 v77, v87, v85, s99
    v_perm_b32 v78, v91, v89, s99
    v_perm_b32 v79, v95, v93, s99
    v_perm_b32 v80, v98, v96, s98
    v_perm_b32 v81, v102, v100, s98
    v_perm_b32 v82, v106, v104, s98
    v_perm_b32 v83, v110, v108, s98
    v_perm_b32 v84, v98, v96, s99
    v_perm_b32 v85, v102, v100, s99
    v_perm_b32 v86, v106, v104, s99
    v_perm_b32 v87, v110, v108, s99
    v_perm_b32 v88, v99, v97, s98
    v_perm_b32 v89, v103, v101, s98
    v_perm_b32 v90, v107, v105, s98
    v_perm_b32 v91, v111, v109, s98
    v_perm_b32 v92, v99, v97, s99
    v_perm_b32 v93, v103, v101, s99
    v_perm_b32 v94, v107, v105, s99
    v_perm_b32 v95, v111, v109, s99
    v_perm_b32 v96, v114, v112, s98
    v_perm_b32 v97, v118, v116, s98
    v_perm_b32 v98, v122, v120, s98
    v_perm_b32 v99, v126, v124, s98
    v_perm_b32 v100, v114, v112, s99
    v_perm_b32 v101, v118, v116, s99
    v_perm_b32 v102, v122, v120, s99
    v_perm_b32 v103, v126, v124, s99
    v_perm_b32 v104, v115, v113, s98
    v_perm_b32 v105, v119, v117, s98
    v_perm_b32 v106, v123, v121, s98
    v_perm_b32 v107, v127, v125, s98
    v_perm_b32 v108, v115, v113, s99
    v_perm_b32 v109, v119, v117, s99
    v_perm_b32 v110, v123, v121, s99
    v_perm_b32 v111, v127, v125, s99
    s_lshl_b32 s92, s86, 9
    s_add_u32 s92, s92, 17088
    v_and_b32 v6, 7, v2
    v_lshl_add_u32 v7, v6, 4, s92
    v_lshl_add_u32 v7, v3, 7, v7
    s_lshl_b32 s92, s87, 6
    v_add_u32 v11, s92, v1
    v_lshrrev_b32 v8, 5, v11
    v_and_b32 v9, 31, v11
    v_and_b32 v10, 3, v9
    v_lshlrev_b32 v10, 9, v10
    v_lshrrev_b32 v9, 2, v9
    v_lshl_add_u32 v10, v9, 4, v10
    v_lshrrev_b32 v9, 2, v8
    v_lshl_add_u32 v10, v9, 8, v10
    v_and_b32 v9, 3, v8
    v_lshl_add_u32 v10, v9, 2, v10
    v_lshlrev_b32 v11, 1, v11
    s_lshl_b32 s92, s87, 11
    v_lshl_add_u32 v9, v1, 4, s92
W_88:
    s_sleep 2
    ds_read_b32 v12, v4 offset:768
    s_sub_u32 s39, s39, 1
    s_cbranch_scc1 KS_ABORT
    s_waitcnt lgkmcnt(0)
    v_cmp_eq_u32 vcc, 0, v12
    s_cbranch_vccnz W_88
    s_setprio 2
W_89:
    ds_read_b32 v12, v4 offset:32
    s_sub_u32 s39, s39, 1
    s_cbranch_scc1 KS_ABORT
    s_waitcnt lgkmcnt(0)
    v_cmp_eq_u32 vcc, 0, v12
    s_cbranch_vccnz W_89
    ds_read_b128 v[12:15], v7 offset:0
    ds_read_b128 v[16:19], v7 offset:512
    ds_read_b128 v[20:23], v7 offset:1024
    ds_read_b128 v[24:27], v7 offset:1536
    ds_read_b128 v[28:31], v7 offset:2048
    s_waitcnt lgkmcnt(4)
    v_mfma_f32_16x16x32_bf16 v[112:115], v[12:15], v[32:35], 0
    v_mfma_f32_16x16x32_bf16 v[116:119], v[12:15], v[36:39], 0
    v_mfma_f32_16x16x32_bf16 v[120:123], v[12:15], v[40:43], 0
    v_mfma_f32_16x16x32_bf16 v[124:127], v[12:15], v[44:47], 0
    s_waitcnt lgkmcnt(3)
    v_mfma_f32_16x16x32_bf16 v[112:115], v[16:19], v[48:51], v[112:115]
    v_mfma_f32_16x16x32_bf16 v[116:119], v[16:19], v[52:55], v[116:119]
    v_mfma_f32_16x16x32_bf16 v[120:123], v[16:19], v[56:59], v[120:123]
    v_mfma_f32_16x16x32_bf16 v[124:127], v[16:19], v[60:63], v[124:127]
    s_waitcnt lgkmcnt(2)
    v_mfma_f32_16x16x32_bf16 v[112:115], v[20:23], v[64:67], v[112:115]
    v_mfma_f32_16x16x32_bf16 v[116:119], v[20:23], v[68:71], v[116:119]
    v_mfma_f32_16x16x32_bf16 v[120:123], v[20:23], v[72:75], v[120:123]
    v_mfma_f32_16x16x32_bf16 v[124:127], v[20:23], v[76:79], v[124:127]
    s_waitcnt lgkmcnt(1)
    v_mfma_f32_16x16x32_bf16 v[112:115], v[24:27], v[80:83], v[112:115]
    v_mfma_f32_16x16x32_bf16 v[116:119], v[24:27], v[84:87], v[116:119]
    v_mfma_f32_16x16x32_bf16 v[120:123], v[24:27], v[88:91], v[120:123]
    v_mfma_f32_16x16x32_bf16 v[124:127], v[24:27], v[92:95], v[124:127]
    s_bitcmp1_b32 s87, 0
    s_cbranch_scc1 KS_G5
    s_waitcnt lgkmcnt(0)
    v_mfma_f32_16x16x32_bf16 v[112:115], v[28:31], v[96:99], v[112:115]
    v_mfma_f32_16x16x32_bf16 v[116:119], v[28:31], v[100:103], v[116:119]
    v_mfma_f32_16x16x32_bf16 v[120:123], v[28:31], v[104:107], v[120:123]
    v_mfma_f32_16x16x32_bf16 v[124:127], v[28:31], v[108:111], v[124:127]
KS_G5:
    s_mov_b32 exec_lo, -1
    s_mov_b32 exec_hi, 0
    s_nop 5
    ds_write_b128 v9, v[112:115] offset:26368
    ds_write_b128 v9, v[116:119] offset:26880
    ds_write_b128 v9, v[120:123] offset:27392
    ds_write_b128 v9, v[124:127] offset:27904
    s_mov_b64 exec, -1
    s_waitcnt lgkmcnt(0)
    s_barrier
    ds_read_b32 v32, v10 offset:26368
    ds_read_b32 v33, v10 offset:26496
    ds_read_b32 v34, v10 offset:28416
    ds_read_b32 v35, v10 offset:28544
    ds_read_b32 v36, v10 offset:30464
    ds_read_b32 v37, v10 offset:30592
    ds_read_b32 v38, v10 offset:32512
    ds_read_b32 v39, v10 offset:32640
    s_waitcnt lgkmcnt(4)
    v_pk_add_f32 v[32:33], v[32:33], v[34:35]
    s_waitcnt lgkmcnt(0)
    v_pk_add_f32 v[36:37], v[36:37], v[38:39]
    v_pk_add_f32 v[32:33], v[32:33], v[36:37]
    v_cvt_pk_bf16_f32 v34, v32, v33
    v_lshlrev_b32 v32, 16, v34
    v_and_b32 v33, 0xffff0000, v34
    v_mul_f32 v34, 0xbfb8aa3b, v32
    v_exp_f32 v34, v34
    s_nop 0
    v_add_f32 v34, 1.0, v34
    v_rcp_f32 v34, v34
    s_nop 0
    v_mul_f32 v34, v32, v34
    v_cvt_pk_bf16_f32 v34, v34, v34
    v_lshlrev_b32 v34, 16, v34
    v_mul_f32 v34, v34, v33
    v_cvt_pk_bf16_f32 v34, v34, v34
    ds_write_b16 v11, v34 offset:1024
    s_waitcnt lgkmcnt(0)
    s_barrier
    s_branch KS_P2
KS_P:
    s_waitcnt lgkmcnt(0)
    s_barrier
    s_barrier
    s_setprio 2
KS_P2:
    s_sub_u32 s87, s38, 10
    s_add_u32 s64, s36, 0x850000
    s_addc_u32 s65, s37, 0
    s_mov_b32 s66, 0x288000
    s_mov_b32 s67, 0x20000
    s_mov_b32 s68, s32
    s_mov_b32 s69, s33
    s_mov_b32 s70, 0x240000
    s_mov_b32 s71, 0x20000
    v_lshrrev_b32 v8, 3, v1
    v_mul_u32_u24 v8, 18432, v8
    v_and_b32 v9, 7, v1
    v_lshl_add_u32 v8, v9, 4, v8
    s_mul_i32 s92, s87, 442368
    s_lshl_b32 s93, s89, 7
    s_add_u32 s92, s92, s93
    s_add_u32 s93, s92, 147456
    s_add_u32 s94, s92, 294912
    s_lshl_b32 s95, s87, 7
    v_lshl_add_u32 v6, v9, 4, s95
    v_lshl_add_u32 v6, v3, 2, v6
    v_lshlrev_b32 v12, 2, v1
    v_add_u32 v12, 2048, v12
    v_lshlrev_b32 v13, 4, v1
    s_barrier
    s_branch ZPE_91
ZP_90:
    s_sleep 1
ZPE_91:
    buffer_load_dwordx4 v[32:35], v8, s[64:67], s92 offen sc1
    buffer_load_dwordx4 v[36:39], v8, s[64:67], s93 offen sc1
    buffer_load_dwordx4 v[40:43], v8, s[64:67], s94 offen sc1
    s_sub_u32 s39, s39, 1
    s_cbranch_scc1 KS_ABORT
    s_waitcnt vmcnt(0)
    v_max3_u32 v44, v32, v33, v34
    v_max3_u32 v44, v44, v35, v36
    v_max3_u32 v44, v44, v37, v38
    v_max3_u32 v44, v44, v39, v40
    v_max3_u32 v44, v44, v41, v42
    v_max_u32 v44, v44, v43
    v_cmp_eq_u32 vcc, -1, v44
    s_cbranch_vccnz ZP_90
    v_pk_add_f32 v[32:33], v[32:33], v[36:37]
    v_pk_add_f32 v[34:35], v[34:35], v[38:39]
    v_pk_add_f32 v[32:33], v[32:33], v[40:41]
    v_pk_add_f32 v[34:35], v[34:35], v[42:43]
    s_nop 0
    v_add_f32_dpp v32, v32, v32 row_ror:8 row_mask:0xf bank_mask:0xf
    v_add_f32_dpp v33, v33, v33 row_ror:8 row_mask:0xf bank_mask:0xf
    v_add_f32_dpp v34, v34, v34 row_ror:8 row_mask:0xf bank_mask:0xf
    v_add_f32_dpp v35, v35, v35 row_ror:8 row_mask:0xf bank_mask:0xf
    v_permlane16_swap_b32 v32, v33
    s_nop 0
    v_permlane16_swap_b32 v34, v35
    v_add_f32 v32, v32, v33
    v_add_f32 v34, v34, v35
    s_nop 1
    v_permlane32_swap_b32 v32, v34
    v_add_f32 v32, v32, v34
    ds_write_b32 v6, v32 offset:2048
    s_waitcnt lgkmcnt(0)
    s_barrier
    s_cmp_lg_u32 s87, 0
    s_cbranch_scc1 KS_PEND
    s_mov_b32 exec_lo, -1
    s_mov_b32 exec_hi, 0
    ds_read2_b32 v[32:33], v12 offset0:0 offset1:32
    ds_read2_b32 v[34:35], v12 offset0:64 offset1:96
    ds_read2_b32 v[36:37], v12 offset0:128 offset1:160
    ds_read_b128 v[40:43], v13 offset:1536
    s_waitcnt lgkmcnt(0)
    v_pk_add_f32 v[32:33], v[32:33], v[34:35]
    v_pk_add_f32 v[32:33], v[32:33], v[36:37]
    v_add_f32 v8, v32, v33
    v_cvt_pk_bf16_f32 v8, v8, v8
    v_lshlrev_b32 v8, 16, v8
    v_mul_f32 v8, v8, v42
    v_cvt_pk_bf16_f32 v8, v8, v8
    v_lshlrev_b32 v8, 16, v8
    v_add_f32 v8, v8, v40
    v_cvt_pk_bf16_f32 v8, v8, v8
    v_lshlrev_b32 v8, 16, v8
    v_add_f32 v8, v8, v41
    v_cvt_pk_bf16_f32 v8, v8, v8
    buffer_store_short v8, v43, s[68:71], 0 offen
KS_PEND:
KS_ABORT:
KS_END:
    s_endpgm
.section .rodata,"a"
.p2align 6
.amdhsa_kernel sequential_preLN__ssm_conv_s4__moe_arch_mod__prompt_kernel
  .amdhsa_next_free_vgpr 128
  .amdhsa_next_free_sgpr 100
  .amdhsa_accum_offset 128
  .amdhsa_group_segment_fixed_size 0
  .amdhsa_kernarg_size 136
  .amdhsa_user_sgpr_count 2
  .amdhsa_user_sgpr_kernarg_segment_ptr 1
  .amdhsa_system_sgpr_workgroup_id_x 1
  .amdhsa_float_denorm_mode_32 3
.end_amdhsa_kernel
```

```asm
; @launch grid=(256,1,1) block=(1024,1,1) lds=154240
.amdgcn_target "amdgcn-amd-amdhsa--gfx950"
.text
.globl sequential_preLN__ssm_conv_s4__moe_arch_mod__prompt_kernel
.p2align 8
.type sequential_preLN__ssm_conv_s4__moe_arch_mod__prompt_kernel,@function
sequential_preLN__ssm_conv_s4__moe_arch_mod__prompt_kernel:
    s_cmp_ge_u32 s2, 256
    s_cbranch_scc1 KS_END
    s_load_dwordx16 s[4:19], s[0:1], 0
    s_load_dwordx16 s[20:35], s[0:1], 64
    s_load_dwordx2 s[36:37], s[0:1], 128
    v_readfirstlane_b32 s38, v0
    s_lshr_b32 s38, s38, 6
    s_and_b32 s40, s2, 7
    s_lshr_b32 s41, s2, 3
    s_add_u32 s92, s38, 8
    s_sub_u32 s93, s38, 4
    s_cmp_lt_u32 s38, 8
    s_cselect_b32 s92, s92, s93
    s_cmp_lt_u32 s38, 4
    s_cselect_b32 s38, s38, s92
    v_and_b32 v1, 63, v0
    v_and_b32 v2, 15, v1
    v_lshrrev_b32 v3, 4, v1
    v_mov_b32 v4, 0
    v_mov_b32 v5, 1
    s_mov_b32 s39, 524288
    s_mov_b32 s84, 0x01010101
    s_lshl_b32 s90, s40, 5
    s_add_u32 s90, s90, s41
    s_mul_i32 s89, s40, 18
    s_add_u32 s89, s89, s41
    s_cmp_lt_u32 s38, 4
    s_cbranch_scc1 KS_L
    s_cmp_ge_u32 s38, 12
    s_cbranch_scc1 KS_X
    s_setprio 2
    s_lshr_b32 s87, s38, 2
    s_sub_u32 s87, s87, 1
    s_mul_i32 s86, s87, 3
    s_xor_b32 s86, s86, s38
    s_and_b32 s86, s86, 3
    s_lshl_b32 s88, s90, 1
    s_add_u32 s88, s88, s87
    s_lshl_b32 s92, s86, 11
    s_add_u32 s92, s92, 146048
    v_lshl_add_u32 v28, v1, 3, s92
    s_cmp_eq_u32 s86, 3
    s_cbranch_scc1 PX_1
    v_lshlrev_b32 v26, 3, v2
    v_mov_b32 v21, 0x80
    s_cmp_eq_u32 s86, 1
    s_cbranch_scc1 PX_2
    s_cmp_eq_u32 s86, 2
    s_cbranch_scc1 PX_3
    v_lshl_add_u32 v26, v3, 1, v26
    v_mov_b32 v22, 1
    s_branch PX_4
PX_2:
    v_cmp_gt_u32 vcc, 2, v3
    v_lshl_add_u32 v20, v3, 2, v26
    v_add_u32 v20, 256, v20
    v_lshl_add_u32 v26, v3, 8, v26
    v_cndmask_b32 v26, v26, v20, vcc
    v_cndmask_b32 v22, v21, 2, vcc
    v_cndmask_b32 v21, 4, v21, vcc
    s_branch PX_4
PX_3:
    v_lshl_add_u32 v26, v3, 9, v26
    v_add_u32 v26, 0x400, v26
    v_mov_b32 v22, 0x100
PX_4:
    v_mad_u32_u24 v26, v22, s87, v26
    v_add_u32 v27, v26, v21
    s_movk_i32 s96, 31232
    s_movk_i32 s97, -19072
    s_lshl_b32 s95, s87, 9
    v_cvt_f32_u32 v20, v26
    v_max_u32 v22, 0x800, v26
    v_cvt_f32_u32 v21, v27
    v_max_u32 v23, 0x800, v27
    v_cmp_gt_u32 vcc, 0x80, v26
    v_lshrrev_b32 v24, 16, v20
    v_add3_u32 v24, v24, v22, s97
    v_cndmask_b32 v24, v24, v26, vcc
    v_cmp_gt_u32 vcc, 0x80, v27
    v_lshrrev_b32 v25, 16, v21
    v_add3_u32 v25, v25, v23, s97
    v_cndmask_b32 v25, v25, v27, vcc
    v_min_u32 v24, 642, v24
    v_lshl_add_u32 v24, v24, 1, s96
    v_min_u32 v25, 642, v25
    v_lshl_add_u32 v25, v25, 1, s96
    v_add_u32 v29, s95, v28
    v_lshl_or_b32 v24, v25, 16, v24
    v_lshl_or_b32 v25, v27, 16, v26
    ds_write_b64 v29, v[24:25]
PX_1:
KS_GRP:
    s_lshl_b32 s92, s88, 8
    v_lshl_add_u32 v20, v1, 2, s92
    s_lshl_b32 s92, s88, 1
    v_mov_b32 v21, s92
    s_mul_i32 s85, s87, 36672
    s_add_u32 s85, s85, 35840
    s_waitcnt lgkmcnt(0)
    global_load_ushort v46, v21, s[18:19]
    global_load_dword v40, v20, s[6:7]
    global_load_dword v41, v20, s[8:9]
    global_load_dword v42, v20, s[10:11]
    global_load_dword v43, v20, s[12:13]
    global_load_dword v44, v20, s[14:15]
    global_load_dword v45, v20, s[16:17]
    global_load_ushort v107, v21, s[20:21]
    s_barrier
    s_movk_i32 s96, 31232
    s_cmp_eq_u32 s87, 2
    s_cbranch_scc1 PREE_7
    v_mov_b32 v32, 641
    s_cmp_eq_u32 s87, 1
    s_cbranch_scc1 PREB_5
    v_mov_b32 v33, 32514
    s_cmp_eq_u32 s86, 1
    s_cbranch_scc1 PRE_9
    s_cmp_eq_u32 s86, 2
    s_cbranch_scc1 PRE_10
    s_cmp_eq_u32 s86, 3
    s_cbranch_scc1 PRE_11
    v_lshlrev_b32 v23, 1, v1
    v_sub_u32 v30, 93, v23
    v_cmp_lt_u32 vcc, 61, v30
    v_lshlrev_b32 v31, 2, v30
    v_add_u32 v31, 32010, v31
    v_cndmask_b32 v24, v31, v33, vcc
    v_sub_u32 v30, 92, v23
    v_cmp_lt_u32 vcc, 61, v30
    v_lshlrev_b32 v31, 2, v30
    v_add_u32 v31, 32010, v31
    v_cndmask_b32 v25, v31, v33, vcc
    v_sub_u32 v30, 94, v23
    v_cmp_lt_u32 vcc, 62, v30
    v_lshlrev_b32 v31, 2, v30
    v_add_u32 v31, 32008, v31
    v_cndmask_b32 v26, v31, v33, vcc
    v_sub_u32 v30, 93, v23
    v_cmp_lt_u32 vcc, 62, v30
    v_lshlrev_b32 v31, 2, v30
    v_add_u32 v31, 32008, v31
    v_cndmask_b32 v27, v31, v33, vcc
    s_branch PREW_6
PRE_9:
    v_min_u32 v23, 47, v1
    v_lshlrev_b32 v23, 1, v23
    v_sub_u32 v30, 64, v23
    v_cmp_lt_u32 vcc, 63, v30
    v_lshlrev_b32 v31, 2, v30
    v_add_u32 v31, 32258, v31
    v_cndmask_b32 v24, v31, v33, vcc
    v_sub_u32 v30, 63, v23
    v_cmp_lt_u32 vcc, 63, v30
    v_lshlrev_b32 v31, 2, v30
    v_add_u32 v31, 32258, v31
    v_cndmask_b32 v25, v31, v33, vcc
    v_sub_u32 v30, 62, v23
    v_cmp_lt_u32 vcc, 63, v30
    v_lshlrev_b32 v31, 2, v30
    v_add_u32 v31, 32258, v31
    v_cndmask_b32 v27, v31, v33, vcc
    v_mov_b32 v26, v25
    s_branch PREW_6
PRE_10:
    v_min_u32 v23, 47, v1
    v_lshlrev_b32 v23, 1, v23
    v_sub_u32 v30, 64, v23
    v_cmp_lt_u32 vcc, 63, v30
    v_lshlrev_b32 v31, 2, v30
    v_add_u32 v31, 32260, v31
    v_cndmask_b32 v24, v31, v33, vcc
    v_sub_u32 v30, 63, v23
    v_cmp_lt_u32 vcc, 63, v30
    v_lshlrev_b32 v31, 2, v30
    v_add_u32 v31, 32260, v31
    v_cndmask_b32 v25, v31, v33, vcc
    v_sub_u32 v30, 62, v23
    v_cmp_lt_u32 vcc, 63, v30
    v_lshlrev_b32 v31, 2, v30
    v_add_u32 v31, 32260, v31
    v_cndmask_b32 v27, v31, v33, vcc
    v_mov_b32 v26, v25
    s_branch PREW_6
PRE_11:
    v_cmp_gt_u32 vcc, 9, v1
    v_add_u32 v23, 0x100, v1
    v_mov_b32 v33, 0x200
    v_cndmask_b32 v23, v23, v1, vcc
    v_lshlrev_b32 v23, 1, v23
    v_sub_u32 v30, 544, v23
    v_cvt_f32_i32 v31, v30
    v_cmp_gt_u32 vcc, 0x100, v30
    v_cvt_pk_bf16_f32 v31, v31, v31
    v_and_b32 v31, 0xffff, v31
    v_subrev_u32 v31, 0x4280, v31
    v_cndmask_b32 v31, v31, v30, vcc
    v_cmp_lt_u32 vcc, 0x20d, v30
    v_or_b32 v30, 1, v23
    s_nop 0
    v_cndmask_b32 v31, v31, v32, vcc
    v_cmp_eq_u32 vcc, 0x25d, v30
    s_nop 1
    v_cndmask_b32 v31, v31, v33, vcc
    v_lshl_add_u32 v24, v31, 1, s96
    v_add_u32 v23, 1, v23
    v_sub_u32 v30, 544, v23
    v_cvt_f32_i32 v31, v30
    v_cmp_gt_u32 vcc, 0x100, v30
    v_cvt_pk_bf16_f32 v31, v31, v31
    v_and_b32 v31, 0xffff, v31
    v_subrev_u32 v31, 0x4280, v31
    v_cndmask_b32 v31, v31, v30, vcc
    v_cmp_lt_u32 vcc, 0x20d, v30
    v_or_b32 v30, 1, v23
    s_nop 0
    v_cndmask_b32 v31, v31, v32, vcc
    v_cmp_eq_u32 vcc, 0x25d, v30
    s_nop 1
    v_cndmask_b32 v31, v31, v33, vcc
    v_lshl_add_u32 v25, v31, 1, s96
    v_add_u32 v23, 1, v23
    v_sub_u32 v30, 544, v23
    v_cvt_f32_i32 v31, v30
    v_cmp_gt_u32 vcc, 0x100, v30
    v_cvt_pk_bf16_f32 v31, v31, v31
    v_and_b32 v31, 0xffff, v31
    v_subrev_u32 v31, 0x4280, v31
    v_cndmask_b32 v31, v31, v30, vcc
    v_cmp_lt_u32 vcc, 0x20d, v30
    v_or_b32 v30, 1, v23
    s_nop 0
    v_cndmask_b32 v31, v31, v32, vcc
    v_cmp_eq_u32 vcc, 0x25d, v30
    s_nop 1
    v_cndmask_b32 v31, v31, v33, vcc
    v_lshl_add_u32 v27, v31, 1, s96
    v_mov_b32 v26, v25
    s_branch PREW_6
PREB_5:
    s_lshl_b32 s93, s86, 7
    s_add_u32 s93, s93, 18
    v_lshl_add_u32 v23, v1, 1, s93
    v_sub_u32 v30, 544, v23
    v_cvt_f32_i32 v31, v30
    v_cmp_gt_u32 vcc, 0x100, v30
    v_cvt_pk_bf16_f32 v31, v31, v31
    v_and_b32 v31, 0xffff, v31
    v_subrev_u32 v31, 0x4280, v31
    v_cndmask_b32 v31, v31, v30, vcc
    v_cmp_lt_u32 vcc, 0x20d, v30
    s_nop 1
    v_cndmask_b32 v31, v31, v32, vcc
    v_lshl_add_u32 v24, v31, 1, s96
    v_add_u32 v23, 1, v23
    v_sub_u32 v30, 544, v23
    v_cvt_f32_i32 v31, v30
    v_cmp_gt_u32 vcc, 0x100, v30
    v_cvt_pk_bf16_f32 v31, v31, v31
    v_and_b32 v31, 0xffff, v31
    v_subrev_u32 v31, 0x4280, v31
    v_cndmask_b32 v31, v31, v30, vcc
    v_cmp_lt_u32 vcc, 0x20d, v30
    s_nop 1
    v_cndmask_b32 v31, v31, v32, vcc
    v_lshl_add_u32 v25, v31, 1, s96
    v_add_u32 v23, 1, v23
    v_sub_u32 v30, 544, v23
    v_cvt_f32_i32 v31, v30
    v_cmp_gt_u32 vcc, 0x100, v30
    v_cvt_pk_bf16_f32 v31, v31, v31
    v_and_b32 v31, 0xffff, v31
    v_subrev_u32 v31, 0x4280, v31
    v_cndmask_b32 v31, v31, v30, vcc
    v_cmp_lt_u32 vcc, 0x20d, v30
    s_nop 1
    v_cndmask_b32 v31, v31, v32, vcc
    v_lshl_add_u32 v26, v31, 1, s96
    s_sub_u32 s93, s86, 1
    s_cmp_lt_u32 s93, 2
    s_cselect_b32 s94, 47, 63
    s_mul_i32 s93, s93, 384
    s_add_u32 s93, s93, 35664
    s_cmp_eq_u32 s86, 0
    s_cselect_b32 s93, 35152, s93
    s_cmp_eq_u32 s86, 3
    s_cselect_b32 s93, 32528, s93
    s_cselect_b32 s95, 0x100, 0
    v_cmp_gt_u32 vcc, 9, v1
    v_min_u32 v23, s94, v1
    v_add_u32 v30, s95, v23
    v_cndmask_b32 v23, v30, v23, vcc
    v_lshl_add_u32 v27, v23, 2, s93
    v_lshl_or_b32 v24, v25, 16, v24
    v_lshl_or_b32 v25, v27, 16, v26
    ds_write_b64 v28, v[24:25] offset:1024
    v_mov_b32 v24, s86
    ds_write_b8 v24, v5 offset:212
    s_branch PREE_7
PREW_6:
    v_lshl_or_b32 v24, v25, 16, v24
    v_lshl_or_b32 v25, v27, 16, v26
    ds_write_b64 v28, v[24:25] offset:1536
    v_mov_b32 v24, s86
    ds_write_b8 v24, v5 offset:208
PREE_7:
    s_mul_i32 s93, s86, 8704
    s_min_u32 s94, s93, 22304
    s_add_u32 s94, s94, s85
    s_lshl_b32 s92, s87, 4
    v_mov_b32 v14, s92
    v_add_u32 v15, s86, v14
    v_lshl_add_u32 v72, v1, 3, s94
    v_add_u32 v73, 2176, v72
    v_add_u32 v74, 4352, v72
    v_add_u32 v75, 6528, v72
    v_mul_u32_u24 v126, 544, v2
    v_lshl_add_u32 v126, v3, 4, v126
    v_add_u32 v126, s85, v126
    v_add_u32 v127, s93, v126
    v_lshlrev_b32 v20, 3, v3
    v_sub_u32 v20, v20, v2
    v_add_u32 v21, 16, v20
    v_lshrrev_b32 v21, 1, v21
    v_and_b32 v22, 1, v2
    s_add_u32 s92, s85, 32528
    v_lshl_add_u32 v21, v21, 2, s92
    s_movk_i32 s92, 1344
    s_movk_i32 s94, 192
    v_mad_u32_u24 v6, v22, s92, v21
    v_add_u32 v7, 640, v6
    v_mad_u32_u24 v23, v22, s94, v21
    v_add_u32 v13, 3136, v23
    v_lshlrev_b32 v23, 2, v3
    v_sub_u32 v23, v23, v2
    s_add_u32 s92, s85, 35212
    v_lshl_add_u32 v11, v23, 2, s92
    s_mul_i32 s94, s87, 4672
    s_add_u32 s94, s94, 3072
    v_lshl_add_u32 v23, v2, 5, s94
    v_lshl_add_u32 v8, v3, 4, v23
    v_bfe_u32 v20, v1, 2, 2
    v_and_b32 v21, 3, v1
    v_lshl_add_u32 v20, v3, 3, v20
    v_lshlrev_b32 v105, 2, v21
    v_lshl_add_u32 v21, v21, 3, s85
    v_lshl_add_u32 v9, v20, 4, v21
    v_lshl_add_u32 v10, v20, 5, v21
    v_lshlrev_b32 v12, 4, v1
    s_add_u32 s64, s36, 0x600000
    s_addc_u32 s65, s37, 0
    s_mov_b32 s66, 0x240000
    s_mov_b32 s67, 0x20000
    s_lshl_b32 s92, s86, 19
    s_lshl_b32 s93, s90, 6
    s_add_u32 s92, s92, s93
    s_lshl_b32 s93, s86, 16
    s_lshl_b32 s95, s88, 6
    s_add_u32 s93, s93, s95
    s_add_u32 s93, s93, 2064384
    s_cmp_eq_u32 s87, 2
    s_cselect_b32 s6, s93, s92
    s_cselect_b32 s8, 12, 15
    s_add_u32 s7, s6, 16384
    s_and_b32 s9, s87, 1
    s_lshl_b32 s9, s9, 4
    s_mov_b32 s12, 0x55555555
    s_mov_b32 s13, 0x55555555
    s_lshl_b32 s92, s86, 8
    s_add_u32 s92, s92, s85
    s_add_u32 s92, s92, 36
    v_lshl_add_u32 v124, v1, 2, s92
    s_movk_i32 s92, 192
    s_cmp_eq_u32 s86, 0
    s_cselect_b32 s92, 256, s92
    s_cmp_eq_u32 s86, 3
    s_cselect_b32 s92, 1344, s92
    v_mov_b32 v20, s85
    ds_write_b16 v20, v4 offset:32514
    s_mov_b32 s18, s92
    v_mov_b32 v125, v28
W_12:
    ds_read_b64 v[18:19], v4 offset:208
    s_sub_u32 s39, s39, 1
    s_cbranch_scc1 KS_ABORT
    s_waitcnt lgkmcnt(0)
    v_and_b32 v18, v18, v19
    v_cmp_ne_u32 vcc, s84, v18
    s_cbranch_vccnz W_12
    ds_read2st64_b64 v[28:31], v125 offset0:0 offset1:1
    ds_read2st64_b64 v[32:35], v125 offset0:2 offset1:3
    s_waitcnt lgkmcnt(0)
    v_add_u32_sdwa v108, s85, v28 dst_sel:DWORD dst_unused:UNUSED_PAD src0_sel:DWORD src1_sel:WORD_0
    v_add_u32_sdwa v109, s85, v28 dst_sel:DWORD dst_unused:UNUSED_PAD src0_sel:DWORD src1_sel:WORD_1
    v_cvt_f32_u32_sdwa v110, v29 dst_sel:DWORD dst_unused:UNUSED_PAD src0_sel:WORD_0
    v_cvt_f32_u32_sdwa v111, v29 dst_sel:DWORD dst_unused:UNUSED_PAD src0_sel:WORD_1
    v_add_u32_sdwa v112, s85, v30 dst_sel:DWORD dst_unused:UNUSED_PAD src0_sel:DWORD src1_sel:WORD_0
    v_add_u32_sdwa v113, s85, v30 dst_sel:DWORD dst_unused:UNUSED_PAD src0_sel:DWORD src1_sel:WORD_1
    v_cvt_f32_u32_sdwa v114, v31 dst_sel:DWORD dst_unused:UNUSED_PAD src0_sel:WORD_0
    v_cvt_f32_u32_sdwa v115, v31 dst_sel:DWORD dst_unused:UNUSED_PAD src0_sel:WORD_1
    v_add_u32_sdwa v116, s85, v32 dst_sel:DWORD dst_unused:UNUSED_PAD src0_sel:DWORD src1_sel:WORD_0
    v_add_u32_sdwa v117, s85, v32 dst_sel:DWORD dst_unused:UNUSED_PAD src0_sel:DWORD src1_sel:WORD_1
    v_add_u32_sdwa v118, s85, v33 dst_sel:DWORD dst_unused:UNUSED_PAD src0_sel:DWORD src1_sel:WORD_0
    v_add_u32_sdwa v119, s85, v33 dst_sel:DWORD dst_unused:UNUSED_PAD src0_sel:DWORD src1_sel:WORD_1
    v_add_u32_sdwa v120, s85, v34 dst_sel:DWORD dst_unused:UNUSED_PAD src0_sel:DWORD src1_sel:WORD_0
    v_add_u32_sdwa v121, s85, v34 dst_sel:DWORD dst_unused:UNUSED_PAD src0_sel:DWORD src1_sel:WORD_1
    v_add_u32_sdwa v122, s85, v35 dst_sel:DWORD dst_unused:UNUSED_PAD src0_sel:DWORD src1_sel:WORD_0
    v_add_u32_sdwa v123, s85, v35 dst_sel:DWORD dst_unused:UNUSED_PAD src0_sel:DWORD src1_sel:WORD_1
    v_add_u32 v125, s18, v119
    s_lshl_b32 s92, s87, 5
    s_add_u32 s92, s92, s41
    s_cmp_ge_u32 s92, 88
    s_cbranch_scc1 KC_RECV
    s_mov_b32 s92, 0x3fb8aa3b
    s_mov_b32 s93, 0x32a57060
    s_mov_b32 s94, 0x3e22f983
    s_mov_b32 s95, 0x31dc9c88
    s_waitcnt vmcnt(7)
    v_lshlrev_b32 v16, 16, v46
    v_mul_f32 v17, s92, v16
    v_fma_f32 v19, v16, s92, -v17
    v_fmac_f32 v19, s93, v16
    v_exp_f32 v17, v17
    v_mul_f32 v19, 0x3f317218, v19
    v_fmac_f32 v17, v17, v19
    v_cvt_pk_bf16_f32 v17, v17, v17
    v_and_b32 v16, 0xffff0000, v17
    s_waitcnt vmcnt(5)
    ds_write_b32 v4, v5 offset:36
    v_lshlrev_b32 v20, 16, v40
    v_and_b32 v21, 0xffff0000, v40
    v_lshlrev_b32 v22, 16, v41
    v_and_b32 v23, 0xffff0000, v41
    v_pk_mul_f32 v[20:21], v[20:21], v[16:17] op_sel_hi:[1,0]
    v_pk_mul_f32 v[22:23], v[22:23], v[16:17] op_sel_hi:[1,0]
    v_max_f32 v36, v20, v21
    v_pk_mul_f32 v[68:69], v[22:23], s[94:95] op_sel_hi:[1,0]
    v_pk_fma_f32 v[70:71], v[22:23], s[94:95], v[68:69] op_sel_hi:[1,0,1] neg_lo:[0,0,1] neg_hi:[0,0,1]
    v_pk_fma_f32 v[70:71], v[22:23], s[94:95], v[70:71] op_sel:[0,1,0]
    s_cmp_eq_u32 s86, 3
    s_cbranch_scc1 SK_14
    s_waitcnt vmcnt(1)
    v_lshlrev_b32 v24, 16, v42
    v_and_b32 v25, 0xffff0000, v42
    v_lshlrev_b32 v26, 16, v43
    v_and_b32 v27, 0xffff0000, v43
    v_lshlrev_b32 v28, 16, v44
    v_and_b32 v29, 0xffff0000, v44
    v_lshlrev_b32 v30, 16, v45
    v_and_b32 v31, 0xffff0000, v45
    v_pk_mul_f32 v[24:25], v[24:25], v[16:17] op_sel_hi:[1,0]
    v_pk_mul_f32 v[26:27], v[26:27], v[16:17] op_sel_hi:[1,0]
    v_pk_mul_f32 v[90:91], v[30:31], v[26:27]
    v_pk_mul_f32 v[92:93], v[30:31], v[24:25]
    v_pk_fma_f32 v[34:35], v[28:29], v[26:27], v[92:93]
    v_pk_fma_f32 v[32:33], v[28:29], v[24:25], v[90:91] neg_lo:[0,0,1] neg_hi:[0,0,1]
    v_max3_f32 v37, abs(v34), abs(v35), abs(v32)
    v_max_f32 v37, v37, abs(v33)
SK_14:
    s_waitcnt vmcnt(0)
    s_nop 0
    v_permlane32_swap_b32 v36, v37
    v_max_f32 v36, v36, v37
    s_nop 1
    v_max_f32_dpp v36, v36, v36 row_ror:8 row_mask:0xf bank_mask:0xf
    s_nop 1
    v_max_f32_dpp v36, v36, v36 row_ror:4 row_mask:0xf bank_mask:0xf
    s_nop 1
    v_max_f32_dpp v36, v36, v36 row_ror:2 row_mask:0xf bank_mask:0xf
    s_nop 1
    v_max_f32_dpp v36, v36, v36 row_ror:1 row_mask:0xf bank_mask:0xf
    v_mov_b32 v38, v36
    s_nop 1
    v_permlane16_swap_b32 v36, v38
    v_max_f32 v36, v36, v38
    s_nop 0
    v_readlane_b32 s14, v36, 0
    v_readlane_b32 s15, v36, 32
    s_add_u32 s15, s15, 0x7fffff
    s_lshr_b32 s15, s15, 23
    s_max_u32 s15, s15, 24
    s_sub_u32 s16, 269, s15
    s_lshl_b32 s16, s16, 23
    v_subrev_f32 v20, s14, v20
    v_subrev_f32 v21, s14, v21
    v_mul_f32 v20, 0x3fb8aa3b, v20
    v_mul_f32 v21, 0x3fb8aa3b, v21
    s_cmp_eq_u32 s86, 3
    s_cbranch_scc1 JOB_18
    s_cmp_eq_u32 s86, 1
    s_cbranch_scc1 JOB_16
    s_cmp_eq_u32 s86, 2
    s_cbranch_scc1 JOB_17
    v_mul_f32 v91, 0x43000000, v68
    v_mul_f32 v90, 0x43000000, v20
    v_mul_f32 v95, 0x43000000, v69
    v_mul_f32 v94, 0x43000000, v21
    v_fract_f32 v91, v91
    v_fract_f32 v95, v95
    v_fmac_f32 v91, 0x43000000, v70
    v_fmac_f32 v95, 0x43000000, v71
    v_exp_f32 v90, v90
    v_cos_f32 v92, v91
    v_sin_f32 v91, v91
    v_exp_f32 v94, v94
    v_cos_f32 v96, v95
    v_sin_f32 v95, v95
    v_mul_f32 v44, v90, v92
    v_mul_f32 v46, v90, v91
    v_mul_f32 v45, v94, v96
    v_mul_f32 v47, v94, v95
    v_pk_mul_f32 v[32:33], v[32:33], s[16:17] op_sel_hi:[1,0]
    v_pk_mul_f32 v[34:35], v[34:35], s[16:17] op_sel_hi:[1,0]
    v_fract_f32 v91, v68
    v_fract_f32 v95, v69
    v_fmac_f32 v91, 1.0, v70
    v_fmac_f32 v95, 1.0, v71
    v_exp_f32 v90, v20
    v_cos_f32 v92, v91
    v_sin_f32 v91, v91
    v_exp_f32 v94, v21
    v_cos_f32 v96, v95
    v_sin_f32 v95, v95
    v_mul_f32 v40, v90, v92
    v_mul_f32 v42, v90, v91
    v_mul_f32 v41, v94, v96
    v_mul_f32 v43, v94, v95
    v_pk_mul_f32 v[90:91], v[34:35], v[46:47]
    v_pk_mul_f32 v[94:95], v[34:35], v[42:43]
    v_pk_mul_f32 v[92:93], v[34:35], v[44:45]
    v_pk_mul_f32 v[96:97], v[34:35], v[40:41]
    v_pk_fma_f32 v[62:63], v[32:33], v[46:47], v[92:93]
    v_pk_fma_f32 v[54:55], v[32:33], v[42:43], v[96:97]
    v_pk_fma_f32 v[60:61], v[32:33], v[44:45], v[90:91] neg_lo:[0,0,1] neg_hi:[0,0,1]
    v_pk_fma_f32 v[52:53], v[32:33], v[40:41], v[94:95] neg_lo:[0,0,1] neg_hi:[0,0,1]
    v_cvt_pk_f16_f32 v98, v32, v34
    v_cvt_pk_f16_f32 v99, v33, v35
    v_cvt_pk_f16_f32 v100, v60, v62
    v_cvt_pk_f16_f32 v101, v61, v63
    ds_write2_b64 v72, v[98:99], v[100:101] offset0:0 offset1:68
    v_pk_mul_f32 v[90:91], v[54:55], v[46:47]
    v_pk_mul_f32 v[94:95], v[54:55], v[42:43]
    v_pk_mul_f32 v[92:93], v[54:55], v[44:45]
    v_pk_mul_f32 v[96:97], v[54:55], v[40:41]
    v_pk_fma_f32 v[62:63], v[52:53], v[46:47], v[92:93]
    v_pk_fma_f32 v[58:59], v[52:53], v[42:43], v[96:97]
    v_pk_fma_f32 v[60:61], v[52:53], v[44:45], v[90:91] neg_lo:[0,0,1] neg_hi:[0,0,1]
    v_pk_fma_f32 v[56:57], v[52:53], v[40:41], v[94:95] neg_lo:[0,0,1] neg_hi:[0,0,1]
    v_cvt_pk_f16_f32 v76, v52, v54
    v_cvt_pk_f16_f32 v77, v53, v55
    v_cvt_pk_f16_f32 v78, v60, v62
    v_cvt_pk_f16_f32 v79, v61, v63
    ds_write2_b64 v72, v[76:77], v[78:79] offset0:136 offset1:204
    v_pk_mul_f32 v[90:91], v[58:59], v[46:47]
    v_pk_mul_f32 v[94:95], v[58:59], v[42:43]
    v_pk_mul_f32 v[92:93], v[58:59], v[44:45]
    v_pk_mul_f32 v[96:97], v[58:59], v[40:41]
    v_pk_fma_f32 v[62:63], v[56:57], v[46:47], v[92:93]
    v_pk_fma_f32 v[54:55], v[56:57], v[42:43], v[96:97]
    v_pk_fma_f32 v[60:61], v[56:57], v[44:45], v[90:91] neg_lo:[0,0,1] neg_hi:[0,0,1]
    v_pk_fma_f32 v[52:53], v[56:57], v[40:41], v[94:95] neg_lo:[0,0,1] neg_hi:[0,0,1]
    v_cvt_pk_f16_f32 v98, v56, v58
    v_cvt_pk_f16_f32 v99, v57, v59
    v_cvt_pk_f16_f32 v100, v60, v62
    v_cvt_pk_f16_f32 v101, v61, v63
    ds_write2_b64 v73, v[98:99], v[100:101] offset0:0 offset1:68
    v_pk_mul_f32 v[90:91], v[54:55], v[46:47]
    v_pk_mul_f32 v[94:95], v[54:55], v[42:43]
    v_pk_mul_f32 v[92:93], v[54:55], v[44:45]
    v_pk_mul_f32 v[96:97], v[54:55], v[40:41]
    v_pk_fma_f32 v[62:63], v[52:53], v[46:47], v[92:93]
    v_pk_fma_f32 v[58:59], v[52:53], v[42:43], v[96:97]
    v_pk_fma_f32 v[60:61], v[52:53], v[44:45], v[90:91] neg_lo:[0,0,1] neg_hi:[0,0,1]
    v_pk_fma_f32 v[56:57], v[52:53], v[40:41], v[94:95] neg_lo:[0,0,1] neg_hi:[0,0,1]
    v_cvt_pk_f16_f32 v76, v52, v54
    v_cvt_pk_f16_f32 v77, v53, v55
    v_cvt_pk_f16_f32 v78, v60, v62
    v_cvt_pk_f16_f32 v79, v61, v63
    ds_write2_b64 v73, v[76:77], v[78:79] offset0:136 offset1:204
    v_pk_mul_f32 v[90:91], v[58:59], v[46:47]
    v_pk_mul_f32 v[94:95], v[58:59], v[42:43]
    v_pk_mul_f32 v[92:93], v[58:59], v[44:45]
    v_pk_mul_f32 v[96:97], v[58:59], v[40:41]
    v_pk_fma_f32 v[62:63], v[56:57], v[46:47], v[92:93]
    v_pk_fma_f32 v[54:55], v[56:57], v[42:43], v[96:97]
    v_pk_fma_f32 v[60:61], v[56:57], v[44:45], v[90:91] neg_lo:[0,0,1] neg_hi:[0,0,1]
    v_pk_fma_f32 v[52:53], v[56:57], v[40:41], v[94:95] neg_lo:[0,0,1] neg_hi:[0,0,1]
    v_cvt_pk_f16_f32 v98, v56, v58
    v_cvt_pk_f16_f32 v99, v57, v59
    v_cvt_pk_f16_f32 v100, v60, v62
    v_cvt_pk_f16_f32 v101, v61, v63
    ds_write2_b64 v74, v[98:99], v[100:101] offset0:0 offset1:68
    v_pk_mul_f32 v[90:91], v[54:55], v[46:47]
    v_pk_mul_f32 v[94:95], v[54:55], v[42:43]
    v_pk_mul_f32 v[92:93], v[54:55], v[44:45]
    v_pk_mul_f32 v[96:97], v[54:55], v[40:41]
    v_pk_fma_f32 v[62:63], v[52:53], v[46:47], v[92:93]
    v_pk_fma_f32 v[58:59], v[52:53], v[42:43], v[96:97]
    v_pk_fma_f32 v[60:61], v[52:53], v[44:45], v[90:91] neg_lo:[0,0,1] neg_hi:[0,0,1]
    v_pk_fma_f32 v[56:57], v[52:53], v[40:41], v[94:95] neg_lo:[0,0,1] neg_hi:[0,0,1]
    v_cvt_pk_f16_f32 v76, v52, v54
    v_cvt_pk_f16_f32 v77, v53, v55
    v_cvt_pk_f16_f32 v78, v60, v62
    v_cvt_pk_f16_f32 v79, v61, v63
    ds_write2_b64 v74, v[76:77], v[78:79] offset0:136 offset1:204
    v_pk_mul_f32 v[90:91], v[58:59], v[46:47]
    v_pk_mul_f32 v[94:95], v[58:59], v[42:43]
    v_pk_mul_f32 v[92:93], v[58:59], v[44:45]
    v_pk_mul_f32 v[96:97], v[58:59], v[40:41]
    v_pk_fma_f32 v[62:63], v[56:57], v[46:47], v[92:93]
    v_pk_fma_f32 v[54:55], v[56:57], v[42:43], v[96:97]
    v_pk_fma_f32 v[60:61], v[56:57], v[44:45], v[90:91] neg_lo:[0,0,1] neg_hi:[0,0,1]
    v_pk_fma_f32 v[52:53], v[56:57], v[40:41], v[94:95] neg_lo:[0,0,1] neg_hi:[0,0,1]
    v_cvt_pk_f16_f32 v98, v56, v58
    v_cvt_pk_f16_f32 v99, v57, v59
    v_cvt_pk_f16_f32 v100, v60, v62
    v_cvt_pk_f16_f32 v101, v61, v63
    ds_write2_b64 v75, v[98:99], v[100:101] offset0:0 offset1:68
    v_pk_mul_f32 v[90:91], v[54:55], v[46:47]
    v_pk_mul_f32 v[92:93], v[54:55], v[44:45]
    v_pk_fma_f32 v[62:63], v[52:53], v[46:47], v[92:93]
    v_pk_fma_f32 v[60:61], v[52:53], v[44:45], v[90:91] neg_lo:[0,0,1] neg_hi:[0,0,1]
    v_cvt_pk_f16_f32 v76, v52, v54
    v_cvt_pk_f16_f32 v77, v53, v55
    v_cvt_pk_f16_f32 v78, v60, v62
    v_cvt_pk_f16_f32 v79, v61, v63
    ds_write2_b64 v75, v[76:77], v[78:79] offset0:136 offset1:204
    s_branch JOBJ_19
JOB_16:
    v_mul_f32 v91, 0x43000000, v68
    v_mul_f32 v90, 0x43000000, v20
    v_mul_f32 v95, 0x43000000, v69
    v_mul_f32 v94, 0x43000000, v21
    v_fract_f32 v91, v91
    v_fract_f32 v95, v95
    v_fmac_f32 v91, 0x43000000, v70
    v_fmac_f32 v95, 0x43000000, v71
    v_exp_f32 v90, v90
    v_cos_f32 v92, v91
    v_sin_f32 v91, v91
    v_exp_f32 v94, v94
    v_cos_f32 v96, v95
    v_sin_f32 v95, v95
    v_mul_f32 v44, v90, v92
    v_mul_f32 v46, v90, v91
    v_mul_f32 v45, v94, v96
    v_mul_f32 v47, v94, v95
    v_pk_mul_f32 v[32:33], v[32:33], s[16:17] op_sel_hi:[1,0]
    v_pk_mul_f32 v[34:35], v[34:35], s[16:17] op_sel_hi:[1,0]
    v_pk_mul_f32 v[90:91], v[46:47], v[46:47]
    v_pk_mul_f32 v[92:93], v[44:45], v[46:47]
    v_pk_fma_f32 v[48:49], v[44:45], v[44:45], v[90:91] neg_lo:[0,0,1] neg_hi:[0,0,1]
    v_pk_add_f32 v[50:51], v[92:93], v[92:93]
    v_mul_f32 v91, 2.0, v68
    v_mul_f32 v90, 2.0, v20
    v_mul_f32 v95, 2.0, v69
    v_mul_f32 v94, 2.0, v21
    v_fract_f32 v91, v91
    v_fract_f32 v95, v95
    v_fmac_f32 v91, 2.0, v70
    v_fmac_f32 v95, 2.0, v71
    v_exp_f32 v90, v90
    v_cos_f32 v92, v91
    v_sin_f32 v91, v91
    v_exp_f32 v94, v94
    v_cos_f32 v96, v95
    v_sin_f32 v95, v95
    v_mul_f32 v40, v90, v92
    v_mul_f32 v42, v90, v91
    v_mul_f32 v41, v94, v96
    v_mul_f32 v43, v94, v95
    v_pk_mul_f32 v[90:91], v[34:35], v[50:51]
    v_pk_mul_f32 v[92:93], v[34:35], v[48:49]
    v_pk_fma_f32 v[54:55], v[32:33], v[50:51], v[92:93]
    v_pk_fma_f32 v[52:53], v[32:33], v[48:49], v[90:91] neg_lo:[0,0,1] neg_hi:[0,0,1]
    v_pk_mul_f32 v[90:91], v[54:55], v[50:51]
    v_pk_mul_f32 v[92:93], v[54:55], v[48:49]
    v_pk_fma_f32 v[66:67], v[52:53], v[50:51], v[92:93]
    v_pk_fma_f32 v[64:65], v[52:53], v[48:49], v[90:91] neg_lo:[0,0,1] neg_hi:[0,0,1]
    v_pk_mul_f32 v[90:91], v[54:55], v[46:47]
    v_pk_mul_f32 v[94:95], v[54:55], v[42:43]
    v_pk_mul_f32 v[92:93], v[54:55], v[44:45]
    v_pk_mul_f32 v[96:97], v[54:55], v[40:41]
    v_pk_fma_f32 v[62:63], v[52:53], v[46:47], v[92:93]
    v_pk_fma_f32 v[58:59], v[52:53], v[42:43], v[96:97]
    v_pk_fma_f32 v[60:61], v[52:53], v[44:45], v[90:91] neg_lo:[0,0,1] neg_hi:[0,0,1]
    v_pk_fma_f32 v[56:57], v[52:53], v[40:41], v[94:95] neg_lo:[0,0,1] neg_hi:[0,0,1]
    v_cvt_pk_f16_f32 v98, v52, v54
    v_cvt_pk_f16_f32 v99, v53, v55
    v_cvt_pk_f16_f32 v100, v60, v62
    v_cvt_pk_f16_f32 v101, v61, v63
    ds_write2_b64 v72, v[98:99], v[100:101] offset0:0 offset1:68
    v_pk_mul_f32 v[90:91], v[58:59], v[46:47]
    v_pk_mul_f32 v[94:95], v[58:59], v[42:43]
    v_pk_mul_f32 v[92:93], v[58:59], v[44:45]
    v_pk_mul_f32 v[96:97], v[58:59], v[40:41]
    v_pk_fma_f32 v[62:63], v[56:57], v[46:47], v[92:93]
    v_pk_fma_f32 v[54:55], v[56:57], v[42:43], v[96:97]
    v_pk_fma_f32 v[60:61], v[56:57], v[44:45], v[90:91] neg_lo:[0,0,1] neg_hi:[0,0,1]
    v_pk_fma_f32 v[52:53], v[56:57], v[40:41], v[94:95] neg_lo:[0,0,1] neg_hi:[0,0,1]
    v_cvt_pk_f16_f32 v76, v56, v58
    v_cvt_pk_f16_f32 v77, v57, v59
    v_cvt_pk_f16_f32 v78, v60, v62
    v_cvt_pk_f16_f32 v79, v61, v63
    ds_write2_b64 v72, v[76:77], v[78:79] offset0:136 offset1:204
    v_pk_mul_f32 v[90:91], v[54:55], v[46:47]
    v_pk_mul_f32 v[94:95], v[54:55], v[42:43]
    v_pk_mul_f32 v[92:93], v[54:55], v[44:45]
    v_pk_mul_f32 v[96:97], v[54:55], v[40:41]
    v_pk_fma_f32 v[62:63], v[52:53], v[46:47], v[92:93]
    v_pk_fma_f32 v[58:59], v[52:53], v[42:43], v[96:97]
    v_pk_fma_f32 v[60:61], v[52:53], v[44:45], v[90:91] neg_lo:[0,0,1] neg_hi:[0,0,1]
    v_pk_fma_f32 v[56:57], v[52:53], v[40:41], v[94:95] neg_lo:[0,0,1] neg_hi:[0,0,1]
    v_cvt_pk_f16_f32 v98, v52, v54
    v_cvt_pk_f16_f32 v99, v53, v55
    v_cvt_pk_f16_f32 v100, v60, v62
    v_cvt_pk_f16_f32 v101, v61, v63
    ds_write2_b64 v73, v[98:99], v[100:101] offset0:0 offset1:68
    v_pk_mul_f32 v[90:91], v[58:59], v[46:47]
    v_pk_mul_f32 v[94:95], v[42:43], v[42:43]
    v_pk_mul_f32 v[92:93], v[58:59], v[44:45]
    v_pk_mul_f32 v[96:97], v[40:41], v[42:43]
    v_pk_fma_f32 v[62:63], v[56:57], v[46:47], v[92:93]
    v_pk_fma_f32 v[48:49], v[40:41], v[40:41], v[94:95] neg_lo:[0,0,1] neg_hi:[0,0,1]
    v_pk_fma_f32 v[60:61], v[56:57], v[44:45], v[90:91] neg_lo:[0,0,1] neg_hi:[0,0,1]
    v_pk_add_f32 v[50:51], v[96:97], v[96:97]
    v_cvt_pk_f16_f32 v76, v56, v58
    v_cvt_pk_f16_f32 v77, v57, v59
    v_cvt_pk_f16_f32 v78, v60, v62
    v_cvt_pk_f16_f32 v79, v61, v63
    ds_write2_b64 v73, v[76:77], v[78:79] offset0:136 offset1:204
    v_pk_mul_f32 v[90:91], v[66:67], v[50:51]
    v_pk_mul_f32 v[94:95], v[66:67], v[46:47]
    v_pk_mul_f32 v[92:93], v[66:67], v[48:49]
    v_pk_mul_f32 v[96:97], v[66:67], v[44:45]
    v_pk_fma_f32 v[62:63], v[64:65], v[50:51], v[92:93]
    v_pk_fma_f32 v[54:55], v[64:65], v[46:47], v[96:97]
    v_pk_fma_f32 v[60:61], v[64:65], v[48:49], v[90:91] neg_lo:[0,0,1] neg_hi:[0,0,1]
    v_pk_fma_f32 v[52:53], v[64:65], v[44:45], v[94:95] neg_lo:[0,0,1] neg_hi:[0,0,1]
    v_cvt_pk_f16_f32 v98, v64, v66
    v_cvt_pk_f16_f32 v99, v65, v67
    v_cvt_pk_f16_f32 v100, v60, v62
    v_cvt_pk_f16_f32 v101, v61, v63
    ds_write2_b64 v74, v[98:99], v[100:101] offset0:0 offset1:68
    v_pk_mul_f32 v[90:91], v[54:55], v[50:51]
    v_pk_mul_f32 v[94:95], v[54:55], v[46:47]
    v_pk_mul_f32 v[92:93], v[54:55], v[48:49]
    v_pk_mul_f32 v[96:97], v[54:55], v[44:45]
    v_pk_fma_f32 v[62:63], v[52:53], v[50:51], v[92:93]
    v_pk_fma_f32 v[58:59], v[52:53], v[46:47], v[96:97]
    v_pk_fma_f32 v[60:61], v[52:53], v[48:49], v[90:91] neg_lo:[0,0,1] neg_hi:[0,0,1]
    v_pk_fma_f32 v[56:57], v[52:53], v[44:45], v[94:95] neg_lo:[0,0,1] neg_hi:[0,0,1]
    v_cvt_pk_f16_f32 v76, v52, v54
    v_cvt_pk_f16_f32 v77, v53, v55
    v_cvt_pk_f16_f32 v78, v60, v62
    v_cvt_pk_f16_f32 v79, v61, v63
    ds_write2_b64 v74, v[76:77], v[78:79] offset0:136 offset1:204
    v_pk_mul_f32 v[90:91], v[58:59], v[50:51]
    v_pk_mul_f32 v[94:95], v[58:59], v[46:47]
    v_pk_mul_f32 v[92:93], v[58:59], v[48:49]
    v_pk_mul_f32 v[96:97], v[58:59], v[44:45]
    v_pk_fma_f32 v[62:63], v[56:57], v[50:51], v[92:93]
    v_pk_fma_f32 v[54:55], v[56:57], v[46:47], v[96:97]
    v_pk_fma_f32 v[60:61], v[56:57], v[48:49], v[90:91] neg_lo:[0,0,1] neg_hi:[0,0,1]
    v_pk_fma_f32 v[52:53], v[56:57], v[44:45], v[94:95] neg_lo:[0,0,1] neg_hi:[0,0,1]
    v_cvt_pk_f16_f32 v98, v56, v58
    v_cvt_pk_f16_f32 v99, v57, v59
    v_cvt_pk_f16_f32 v100, v60, v62
    v_cvt_pk_f16_f32 v101, v61, v63
    ds_write2_b64 v75, v[98:99], v[100:101] offset0:0 offset1:68
    v_pk_mul_f32 v[90:91], v[54:55], v[50:51]
    v_pk_mul_f32 v[92:93], v[54:55], v[48:49]
    v_pk_fma_f32 v[62:63], v[52:53], v[50:51], v[92:93]
    v_pk_fma_f32 v[60:61], v[52:53], v[48:49], v[90:91] neg_lo:[0,0,1] neg_hi:[0,0,1]
    v_cvt_pk_f16_f32 v76, v52, v54
    v_cvt_pk_f16_f32 v77, v53, v55
    v_cvt_pk_f16_f32 v78, v60, v62
    v_cvt_pk_f16_f32 v79, v61, v63
    ds_write2_b64 v75, v[76:77], v[78:79] offset0:136 offset1:204
    s_branch JOBJ_19
JOB_18:
    v_mul_f32 v91, 0x41000000, v68
    v_mul_f32 v90, 0x41000000, v20
    v_mul_f32 v95, 0x41000000, v69
    v_mul_f32 v94, 0x41000000, v21
    v_fract_f32 v91, v91
    v_fract_f32 v95, v95
    v_fmac_f32 v91, 0x41000000, v70
    v_fmac_f32 v95, 0x41000000, v71
    v_exp_f32 v90, v90
    v_cos_f32 v92, v91
    v_sin_f32 v91, v91
    v_exp_f32 v94, v94
    v_cos_f32 v96, v95
    v_sin_f32 v95, v95
    v_mul_f32 v40, v90, v92
    v_mul_f32 v42, v90, -v91
    v_mul_f32 v41, v94, v96
    v_mul_f32 v43, v94, -v95
    v_mov_b32 v52, 0x47000000
    v_mov_b32 v53, 0x47000000
    v_mov_b32 v54, 0
    v_mov_b32 v55, 0
    v_pk_mul_f32 v[90:91], v[42:43], v[42:43]
    v_pk_mul_f32 v[60:61], v[40:41], v[52:53]
    v_pk_mul_f32 v[92:93], v[40:41], v[42:43]
    v_pk_mul_f32 v[62:63], v[42:43], v[52:53]
    v_pk_fma_f32 v[44:45], v[40:41], v[40:41], v[90:91] neg_lo:[0,0,1] neg_hi:[0,0,1]
    v_pk_add_f32 v[46:47], v[92:93], v[92:93]
    v_pk_mul_f32 v[56:57], v[44:45], v[52:53]
    v_pk_mul_f32 v[94:95], v[62:63], v[46:47]
    v_pk_mul_f32 v[58:59], v[46:47], v[52:53]
    v_pk_mul_f32 v[96:97], v[62:63], v[44:45]
    v_pk_fma_f32 v[66:67], v[60:61], v[46:47], v[96:97]
    v_pk_fma_f32 v[64:65], v[60:61], v[44:45], v[94:95] neg_lo:[0,0,1] neg_hi:[0,0,1]
    v_cvt_pk_f16_f32 v98, v52, v54
    v_cvt_pk_f16_f32 v99, v53, v55
    v_cvt_pk_f16_f32 v100, v60, v62
    v_cvt_pk_f16_f32 v101, v61, v63
    ds_write2_b64 v72, v[98:99], v[100:101] offset0:0 offset1:68
    v_pk_mul_f32 v[90:91], v[58:59], v[46:47]
    v_pk_mul_f32 v[94:95], v[66:67], v[46:47]
    v_pk_mul_f32 v[92:93], v[58:59], v[44:45]
    v_pk_mul_f32 v[96:97], v[66:67], v[44:45]
    v_pk_fma_f32 v[54:55], v[56:57], v[46:47], v[92:93]
    v_pk_fma_f32 v[62:63], v[64:65], v[46:47], v[96:97]
    v_pk_fma_f32 v[52:53], v[56:57], v[44:45], v[90:91] neg_lo:[0,0,1] neg_hi:[0,0,1]
    v_pk_fma_f32 v[60:61], v[64:65], v[44:45], v[94:95] neg_lo:[0,0,1] neg_hi:[0,0,1]
    v_cvt_pk_f16_f32 v76, v56, v58
    v_cvt_pk_f16_f32 v77, v57, v59
    v_cvt_pk_f16_f32 v78, v64, v66
    v_cvt_pk_f16_f32 v79, v65, v67
    ds_write2_b64 v72, v[76:77], v[78:79] offset0:136 offset1:204
    v_pk_mul_f32 v[90:91], v[54:55], v[46:47]
    v_pk_mul_f32 v[94:95], v[62:63], v[46:47]
    v_pk_mul_f32 v[92:93], v[54:55], v[44:45]
    v_pk_mul_f32 v[96:97], v[62:63], v[44:45]
    v_pk_fma_f32 v[58:59], v[52:53], v[46:47], v[92:93]
    v_pk_fma_f32 v[66:67], v[60:61], v[46:47], v[96:97]
    v_pk_fma_f32 v[56:57], v[52:53], v[44:45], v[90:91] neg_lo:[0,0,1] neg_hi:[0,0,1]
    v_pk_fma_f32 v[64:65], v[60:61], v[44:45], v[94:95] neg_lo:[0,0,1] neg_hi:[0,0,1]
    v_cvt_pk_f16_f32 v98, v52, v54
    v_cvt_pk_f16_f32 v99, v53, v55
    v_cvt_pk_f16_f32 v100, v60, v62
    v_cvt_pk_f16_f32 v101, v61, v63
    ds_write2_b64 v73, v[98:99], v[100:101] offset0:0 offset1:68
    v_pk_mul_f32 v[90:91], v[58:59], v[46:47]
    v_pk_mul_f32 v[94:95], v[66:67], v[46:47]
    v_pk_mul_f32 v[92:93], v[58:59], v[44:45]
    v_pk_mul_f32 v[96:97], v[66:67], v[44:45]
    v_pk_fma_f32 v[54:55], v[56:57], v[46:47], v[92:93]
    v_pk_fma_f32 v[62:63], v[64:65], v[46:47], v[96:97]
    v_pk_fma_f32 v[52:53], v[56:57], v[44:45], v[90:91] neg_lo:[0,0,1] neg_hi:[0,0,1]
    v_pk_fma_f32 v[60:61], v[64:65], v[44:45], v[94:95] neg_lo:[0,0,1] neg_hi:[0,0,1]
    v_cvt_pk_f16_f32 v76, v56, v58
    v_cvt_pk_f16_f32 v77, v57, v59
    v_cvt_pk_f16_f32 v78, v64, v66
    v_cvt_pk_f16_f32 v79, v65, v67
    ds_write2_b64 v73, v[76:77], v[78:79] offset0:136 offset1:204
    v_pk_mul_f32 v[90:91], v[54:55], v[46:47]
    v_pk_mul_f32 v[94:95], v[62:63], v[46:47]
    v_pk_mul_f32 v[92:93], v[54:55], v[44:45]
    v_pk_mul_f32 v[96:97], v[62:63], v[44:45]
    v_pk_fma_f32 v[58:59], v[52:53], v[46:47], v[92:93]
    v_pk_fma_f32 v[66:67], v[60:61], v[46:47], v[96:97]
    v_pk_fma_f32 v[56:57], v[52:53], v[44:45], v[90:91] neg_lo:[0,0,1] neg_hi:[0,0,1]
    v_pk_fma_f32 v[64:65], v[60:61], v[44:45], v[94:95] neg_lo:[0,0,1] neg_hi:[0,0,1]
    v_cvt_pk_f16_f32 v98, v52, v54
    v_cvt_pk_f16_f32 v99, v53, v55
    v_cvt_pk_f16_f32 v100, v60, v62
    v_cvt_pk_f16_f32 v101, v61, v63
    ds_write2_b64 v74, v[98:99], v[100:101] offset0:0 offset1:68
    v_pk_mul_f32 v[90:91], v[58:59], v[46:47]
    v_pk_mul_f32 v[94:95], v[66:67], v[46:47]
    v_pk_mul_f32 v[92:93], v[58:59], v[44:45]
    v_pk_mul_f32 v[96:97], v[66:67], v[44:45]
    v_pk_fma_f32 v[54:55], v[56:57], v[46:47], v[92:93]
    v_pk_fma_f32 v[62:63], v[64:65], v[46:47], v[96:97]
    v_pk_fma_f32 v[52:53], v[56:57], v[44:45], v[90:91] neg_lo:[0,0,1] neg_hi:[0,0,1]
    v_pk_fma_f32 v[60:61], v[64:65], v[44:45], v[94:95] neg_lo:[0,0,1] neg_hi:[0,0,1]
    v_cvt_pk_f16_f32 v76, v56, v58
    v_cvt_pk_f16_f32 v77, v57, v59
    v_cvt_pk_f16_f32 v78, v64, v66
    v_cvt_pk_f16_f32 v79, v65, v67
    ds_write2_b64 v74, v[76:77], v[78:79] offset0:136 offset1:204
    v_pk_mul_f32 v[90:91], v[54:55], v[46:47]
    v_pk_mul_f32 v[94:95], v[62:63], v[46:47]
    v_pk_mul_f32 v[92:93], v[54:55], v[44:45]
    v_pk_mul_f32 v[96:97], v[62:63], v[44:45]
    v_pk_fma_f32 v[58:59], v[52:53], v[46:47], v[92:93]
    v_pk_fma_f32 v[66:67], v[60:61], v[46:47], v[96:97]
    v_pk_fma_f32 v[56:57], v[52:53], v[44:45], v[90:91] neg_lo:[0,0,1] neg_hi:[0,0,1]
    v_pk_fma_f32 v[64:65], v[60:61], v[44:45], v[94:95] neg_lo:[0,0,1] neg_hi:[0,0,1]
    v_cvt_pk_f16_f32 v98, v52, v54
    v_cvt_pk_f16_f32 v99, v53, v55
    v_cvt_pk_f16_f32 v100, v60, v62
    v_cvt_pk_f16_f32 v101, v61, v63
    ds_write2_b64 v75, v[98:99], v[100:101] offset0:0 offset1:68
    v_cvt_pk_f16_f32 v76, v56, v58
    v_cvt_pk_f16_f32 v77, v57, v59
    v_cvt_pk_f16_f32 v78, v64, v66
    v_cvt_pk_f16_f32 v79, v65, v67
    ds_write2_b64 v75, v[76:77], v[78:79] offset0:136 offset1:204
    ds_write_b8 v15, v5 offset:64
    s_cmp_eq_u32 s87, 2
    s_cbranch_scc1 KS_G0
    s_branch EXP_13
KC_SEND:
W_20:
    ds_read_b32 v104, v105 offset:224
    s_sub_u32 s39, s39, 1
    s_cbranch_scc1 KS_ABORT
    s_waitcnt lgkmcnt(0)
    v_cmp_eq_u32 vcc, 0, v104
    s_cbranch_vccnz W_20
    s_lshl_b32 s92, s88, 12
    s_lshl_b32 s93, s86, 10
    s_add_u32 s92, s92, s93
    s_add_u32 s92, s92, 0x920000
    v_add_u32 v24, s92, v12
    s_mov_b32 s93, 0xffff
    v_lshlrev_b32 v25, 16, v104
    v_cvt_f16_f32 v20, v20
    v_cvt_f16_f32 v21, v21
    v_cvt_f16_f32 v22, v22
    v_cvt_f16_f32 v23, v23
    s_cmp_lg_u32 s86, 2
    s_cbranch_scc1 KC_S2
    s_mov_b32 exec_lo, 0
    s_mov_b32 exec_hi, 0xffff0000
    v_mov_b32 v20, v106
    v_lshrrev_b32 v21, 16, v106
    s_mov_b64 exec, -1
KC_S2:
    v_bfi_b32 v20, s93, v20, v104
    v_bfi_b32 v21, s93, v21, v25
    v_bfi_b32 v22, s93, v22, v104
    v_bfi_b32 v23, s93, v23, v25
    global_store_dwordx4 v24, v[20:23], s[36:37] sc1
    s_branch KS_G0
KC_RECV:
    s_cmp_eq_u32 s86, 3
    s_cbranch_scc1 EXP_13
    s_lshl_b32 s92, s88, 12
    s_lshl_b32 s93, s86, 10
    s_add_u32 s92, s92, s93
    s_add_u32 s92, s92, 0x920000
    v_add_u32 v24, s92, v12
W_21:
    s_sleep 2
    ds_read_b32 v104, v105 offset:224
    s_sub_u32 s39, s39, 1
    s_cbranch_scc1 KS_ABORT
    s_waitcnt lgkmcnt(0)
    v_cmp_eq_u32 vcc, 0, v104
    s_cbranch_vccnz W_21
    v_lshlrev_b32 v25, 16, v104
W_22:
    s_sleep 2
    ds_read_b32 v17, v4 offset:68
    s_sub_u32 s39, s39, 1
    s_cbranch_scc1 KS_ABORT
    s_waitcnt lgkmcnt(0)
    v_cmp_ne_u32 vcc, s84, v17
    s_cbranch_vccnz W_22
    s_branch KPE_24
KP_23:
    s_sleep 2
KPE_24:
    global_load_dwordx4 v[20:23], v24, s[36:37] sc1
    s_sub_u32 s39, s39, 1
    s_cbranch_scc1 KS_ABORT
    s_waitcnt vmcnt(0)
    v_xor_b32 v20, v104, v20
    v_xor_b32 v21, v25, v21
    v_xor_b32 v22, v104, v22
    v_xor_b32 v23, v25, v23
    v_or3_b32 v26, v20, v21, v22
    v_or_b32 v26, v26, v23
    v_cmp_lt_u32 vcc, 0xffff, v26
    s_cbranch_vccnz KP_23
    v_xor_b32 v20, v104, v20
    v_xor_b32 v22, v104, v22
    ds_write_b16 v108, v20
    ds_write_b16 v109, v21
    ds_write_b16 v112, v22
    ds_write_b16 v113, v23
    s_cmp_lg_u32 s86, 2
    s_cbranch_scc1 EXP_13
    v_and_b32 v20, 0xffff, v20
    v_lshl_or_b32 v20, v21, 16, v20
    v_lshlrev_b32 v21, 16, v107
    s_mov_b32 exec_lo, 0
    s_mov_b32 exec_hi, 0x10000
    ds_write_b64 v14, v[20:21] offset:832
    s_mov_b64 exec, -1
    s_branch EXP_13
JOB_17:
    v_mul_f32 v91, 0x43000000, v68
    v_mul_f32 v90, 0x43000000, v20
    v_mul_f32 v95, 0x43000000, v69
    v_mul_f32 v94, 0x43000000, v21
    v_fract_f32 v91, v91
    v_fract_f32 v95, v95
    v_fmac_f32 v91, 0x43000000, v70
    v_fmac_f32 v95, 0x43000000, v71
    v_exp_f32 v90, v90
    v_cos_f32 v92, v91
    v_sin_f32 v91, v91
    v_exp_f32 v94, v94
    v_cos_f32 v96, v95
    v_sin_f32 v95, v95
    v_mul_f32 v44, v90, v92
    v_mul_f32 v46, v90, v91
    v_mul_f32 v45, v94, v96
    v_mul_f32 v47, v94, v95
    v_pk_mul_f32 v[32:33], v[32:33], s[16:17] op_sel_hi:[1,0]
    v_pk_mul_f32 v[34:35], v[34:35], s[16:17] op_sel_hi:[1,0]
    v_pk_mul_f32 v[90:91], v[46:47], v[46:47]
    v_pk_mul_f32 v[94:95], v[34:35], v[46:47]
    v_pk_mul_f32 v[92:93], v[44:45], v[46:47]
    v_pk_mul_f32 v[96:97], v[34:35], v[44:45]
    v_pk_fma_f32 v[40:41], v[44:45], v[44:45], v[90:91] neg_lo:[0,0,1] neg_hi:[0,0,1]
    v_pk_fma_f32 v[66:67], v[32:33], v[46:47], v[96:97]
    v_pk_add_f32 v[42:43], v[92:93], v[92:93]
    v_pk_fma_f32 v[64:65], v[32:33], v[44:45], v[94:95] neg_lo:[0,0,1] neg_hi:[0,0,1]
    v_pk_mul_f32 v[90:91], v[42:43], v[42:43]
    v_pk_mul_f32 v[92:93], v[40:41], v[42:43]
    v_pk_fma_f32 v[48:49], v[40:41], v[40:41], v[90:91] neg_lo:[0,0,1] neg_hi:[0,0,1]
    v_pk_add_f32 v[50:51], v[92:93], v[92:93]
    v_pk_mul_f32 v[90:91], v[50:51], v[50:51]
    v_pk_mul_f32 v[92:93], v[48:49], v[50:51]
    v_pk_fma_f32 v[48:49], v[48:49], v[48:49], v[90:91] neg_lo:[0,0,1] neg_hi:[0,0,1]
    v_pk_add_f32 v[50:51], v[92:93], v[92:93]
    v_pk_mul_f32 v[90:91], v[34:35], v[50:51]
    v_pk_mul_f32 v[94:95], v[66:67], v[50:51]
    v_pk_mul_f32 v[92:93], v[34:35], v[48:49]
    v_pk_mul_f32 v[96:97], v[66:67], v[48:49]
    v_pk_fma_f32 v[54:55], v[32:33], v[50:51], v[92:93]
    v_pk_fma_f32 v[62:63], v[64:65], v[50:51], v[96:97]
    v_pk_fma_f32 v[52:53], v[32:33], v[48:49], v[90:91] neg_lo:[0,0,1] neg_hi:[0,0,1]
    v_pk_fma_f32 v[60:61], v[64:65], v[48:49], v[94:95] neg_lo:[0,0,1] neg_hi:[0,0,1]
    v_pk_mul_f32 v[90:91], v[54:55], v[42:43]
    v_pk_mul_f32 v[94:95], v[62:63], v[42:43]
    v_pk_mul_f32 v[92:93], v[54:55], v[40:41]
    v_pk_mul_f32 v[96:97], v[62:63], v[40:41]
    v_pk_fma_f32 v[58:59], v[52:53], v[42:43], v[92:93]
    v_pk_fma_f32 v[66:67], v[60:61], v[42:43], v[96:97]
    v_pk_fma_f32 v[56:57], v[52:53], v[40:41], v[90:91] neg_lo:[0,0,1] neg_hi:[0,0,1]
    v_pk_fma_f32 v[64:65], v[60:61], v[40:41], v[94:95] neg_lo:[0,0,1] neg_hi:[0,0,1]
    v_cvt_pk_f16_f32 v98, v52, v54
    v_cvt_pk_f16_f32 v99, v53, v55
    v_cvt_pk_f16_f32 v100, v60, v62
    v_cvt_pk_f16_f32 v101, v61, v63
    ds_write2_b64 v72, v[98:99], v[100:101] offset0:0 offset1:68
    v_pk_mul_f32 v[90:91], v[58:59], v[42:43]
    v_pk_mul_f32 v[94:95], v[66:67], v[42:43]
    v_pk_mul_f32 v[92:93], v[58:59], v[40:41]
    v_pk_mul_f32 v[96:97], v[66:67], v[40:41]
    v_pk_fma_f32 v[54:55], v[56:57], v[42:43], v[92:93]
    v_pk_fma_f32 v[62:63], v[64:65], v[42:43], v[96:97]
    v_pk_fma_f32 v[52:53], v[56:57], v[40:41], v[90:91] neg_lo:[0,0,1] neg_hi:[0,0,1]
    v_pk_fma_f32 v[60:61], v[64:65], v[40:41], v[94:95] neg_lo:[0,0,1] neg_hi:[0,0,1]
    v_cvt_pk_f16_f32 v76, v56, v58
    v_cvt_pk_f16_f32 v77, v57, v59
    v_cvt_pk_f16_f32 v78, v64, v66
    v_cvt_pk_f16_f32 v79, v65, v67
    ds_write2_b64 v72, v[76:77], v[78:79] offset0:136 offset1:204
    v_pk_mul_f32 v[90:91], v[54:55], v[42:43]
    v_pk_mul_f32 v[94:95], v[62:63], v[42:43]
    v_pk_mul_f32 v[92:93], v[54:55], v[40:41]
    v_pk_mul_f32 v[96:97], v[62:63], v[40:41]
    v_pk_fma_f32 v[58:59], v[52:53], v[42:43], v[92:93]
    v_pk_fma_f32 v[66:67], v[60:61], v[42:43], v[96:97]
    v_pk_fma_f32 v[56:57], v[52:53], v[40:41], v[90:91] neg_lo:[0,0,1] neg_hi:[0,0,1]
    v_pk_fma_f32 v[64:65], v[60:61], v[40:41], v[94:95] neg_lo:[0,0,1] neg_hi:[0,0,1]
    v_cvt_pk_f16_f32 v98, v52, v54
    v_cvt_pk_f16_f32 v99, v53, v55
    v_cvt_pk_f16_f32 v100, v60, v62
    v_cvt_pk_f16_f32 v101, v61, v63
    ds_write2_b64 v73, v[98:99], v[100:101] offset0:0 offset1:68
    v_pk_mul_f32 v[90:91], v[58:59], v[42:43]
    v_pk_mul_f32 v[92:93], v[58:59], v[40:41]
    v_pk_fma_f32 v[54:55], v[56:57], v[42:43], v[92:93]
    v_pk_fma_f32 v[52:53], v[56:57], v[40:41], v[90:91] neg_lo:[0,0,1] neg_hi:[0,0,1]
    v_cvt_pk_f16_f32 v76, v56, v58
    v_cvt_pk_f16_f32 v77, v57, v59
    v_cvt_pk_f16_f32 v78, v64, v66
    v_cvt_pk_f16_f32 v79, v65, v67
    ds_write2_b64 v73, v[76:77], v[78:79] offset0:136 offset1:204
    v_cvt_pk_f16_f32 v98, v52, v54
    v_cvt_pk_f16_f32 v99, v53, v55
    v_mov_b32 v36, 0x4538aa3b
    v_mul_f32 v24, s14, v36
    v_max_f32 v24, 0, v24
    v_exp_f32 v24, v24
    ds_write_b64 v74, v[98:99] offset:0
    s_sub_u32 s11, s15, 7
    s_lshl_b32 s11, s11, 23
    v_lshlrev_b32 v25, 16, v107
    v_mul_f32 v24, s11, v24
    v_mov_b32 v106, v24
    ds_write_b64 v14, v[24:25] offset:832
JOBJ_19:
    ds_write_b8 v15, v5 offset:64
    ds_read_b128 v[40:43], v127 offset:0
    ds_read_b128 v[44:47], v127 offset:64
    ds_read_b128 v[48:51], v127 offset:128
    ds_read_b128 v[52:55], v127 offset:192
    ds_read_b128 v[56:59], v127 offset:256
    ds_read_b128 v[60:63], v127 offset:320
    ds_read_b128 v[64:67], v127 offset:384
    ds_read_b128 v[68:71], v127 offset:448
    v_mov_b32 v36, 0x3fb8aa3b
    v_mul_f32 v36, s14, v36
    v_mul_f32 v37, 0x45000000, v36
    v_max_f32 v37, 0, v37
    v_add_f32 v37, 0x41b80000, v37
    v_fma_f32 v110, v110, v36, -v37
    v_fma_f32 v111, v111, v36, -v37
    v_fma_f32 v114, v114, v36, -v37
    v_fma_f32 v115, v115, v36, -v37
    v_exp_f32 v110, v110
    v_exp_f32 v111, v111
    v_exp_f32 v114, v114
    v_exp_f32 v115, v115
W_25:
    ds_read_u8 v17, v14 offset:67
    s_sub_u32 s39, s39, 1
    s_cbranch_scc1 KS_ABORT
    s_waitcnt lgkmcnt(0)
    v_cmp_eq_u32 vcc, 0, v17
    s_cbranch_vccnz W_25
    ds_read_b128 v[72:75], v126 offset:22304
    ds_read_b128 v[76:79], v126 offset:22368
    ds_read_b128 v[80:83], v126 offset:22432
    ds_read_b128 v[84:87], v126 offset:22496
    ds_read_b128 v[88:91], v126 offset:22560
    ds_read_b128 v[92:95], v126 offset:22624
    ds_read_b128 v[96:99], v126 offset:22688
    ds_read_b128 v[100:103], v126 offset:22752
    s_waitcnt lgkmcnt(7)
    v_mfma_f32_16x16x32_f16 v[20:23], v[40:43], v[72:75], 0
    s_waitcnt lgkmcnt(6)
    v_mfma_f32_16x16x32_f16 v[24:27], v[44:47], v[76:79], 0
    s_waitcnt lgkmcnt(5)
    v_mfma_f32_16x16x32_f16 v[20:23], v[48:51], v[80:83], v[20:23]
    s_waitcnt lgkmcnt(4)
    v_mfma_f32_16x16x32_f16 v[24:27], v[52:55], v[84:87], v[24:27]
    s_waitcnt lgkmcnt(3)
    v_mfma_f32_16x16x32_f16 v[20:23], v[56:59], v[88:91], v[20:23]
    s_waitcnt lgkmcnt(2)
    v_mfma_f32_16x16x32_f16 v[24:27], v[60:63], v[92:95], v[24:27]
    s_waitcnt lgkmcnt(1)
    v_mfma_f32_16x16x32_f16 v[20:23], v[64:67], v[96:99], v[20:23]
    s_waitcnt lgkmcnt(0)
    v_mfma_f32_16x16x32_f16 v[24:27], v[68:71], v[100:103], v[24:27]
    s_nop 7
    v_add_f32 v20, v20, v24
    v_add_f32 v21, v21, v25
    v_add_f32 v22, v22, v26
    v_add_f32 v23, v23, v27
    v_mul_f32 v20, v20, v110
    v_mul_f32 v21, v21, v111
    v_mul_f32 v22, v22, v114
    v_mul_f32 v23, v23, v115
    s_cmp_eq_u32 s87, 2
    s_cbranch_scc1 KC_SEND
    v_cvt_f16_f32 v20, v20
    ds_write_b16 v108, v20
    v_cvt_f16_f32 v21, v21
    ds_write_b16 v109, v21
    v_cvt_f16_f32 v22, v22
    ds_write_b16 v112, v22
    v_cvt_f16_f32 v23, v23
    ds_write_b16 v113, v23
EXP_13:
    ds_write_b8 v15, v5 offset:68
    v_mov_b32 v28, 0
    v_mov_b32 v29, 0
    v_mov_b32 v30, 0
    v_mov_b32 v31, 0
    v_mov_b32 v32, s85
    s_waitcnt vmcnt(0)
W_26:
    ds_read_b32 v20, v14 offset:68
    s_sub_u32 s39, s39, 1
    s_cbranch_scc1 KS_ABORT
    s_waitcnt lgkmcnt(0)
    v_cmp_ne_u32 vcc, s84, v20
    s_cbranch_vccnz W_26
    ds_read_u16 v20, v116
    ds_read_u16 v21, v117
    ds_read_u16 v22, v118
    ds_read_u16 v23, v120
    ds_read_u16 v24, v121
    ds_read_u16 v25, v122
    ds_read_u16 v26, v123
    s_mov_b64 exec, 1
    ds_write_b128 v32, v[28:31] offset:3088
    ds_write_b128 v32, v[28:31] offset:8224
    ds_write_b128 v32, v[28:31] offset:3072
    s_mov_b64 exec, -1
    s_waitcnt lgkmcnt(7)
    v_lshl_or_b32 v28, v21, 16, v20
    v_lshl_or_b32 v29, v22, 16, v21
    ds_write_b32 v124, v28 offset:32528
    ds_write_b32 v124, v29 offset:33872
    s_waitcnt lgkmcnt(5)
    v_lshl_or_b32 v30, v24, 16, v23
    v_lshl_or_b32 v31, v26, 16, v25
    ds_write_b32 v119, v30
    ds_write_b32 v125, v31
    ds_write_b8 v15, v5 offset:72
W_27:
    ds_read_b32 v20, v14 offset:72
    s_sub_u32 s39, s39, 1
    s_cbranch_scc1 KS_ABORT
    s_waitcnt lgkmcnt(0)
    v_cmp_ne_u32 vcc, s84, v20
    s_cbranch_vccnz W_27
    ds_read_b64 v[16:17], v14 offset:832
    s_cmp_eq_u32 s86, 1
    s_cbranch_scc1 CV_29
    s_cmp_eq_u32 s86, 2
    s_cbranch_scc1 CV_30
    s_cmp_eq_u32 s86, 3
    s_cbranch_scc1 CV_31
    ds_read2_b32 v[32:33], v6 offset0:144 offset1:145
    ds_read2_b32 v[34:35], v6 offset0:146 offset1:147
    ds_read2_b32 v[36:37], v6 offset0:16 offset1:17
    ds_read2_b32 v[38:39], v6 offset0:18 offset1:19
    ds_read2_b32 v[40:41], v6 offset0:160 offset1:161
    ds_read2_b32 v[42:43], v6 offset0:162 offset1:163
    ds_read2_b32 v[44:45], v6 offset0:32 offset1:33
    ds_read2_b32 v[46:47], v6 offset0:34 offset1:35
    ds_read2_b32 v[48:49], v6 offset0:176 offset1:177
    ds_read2_b32 v[50:51], v6 offset0:178 offset1:179
    ds_read2_b32 v[52:53], v6 offset0:48 offset1:49
    ds_read2_b32 v[54:55], v6 offset0:50 offset1:51
    ds_read2_b32 v[56:57], v6 offset0:192 offset1:193
    ds_read2_b32 v[58:59], v6 offset0:194 offset1:195
    ds_read2_b32 v[60:61], v6 offset0:64 offset1:65
    ds_read2_b32 v[62:63], v6 offset0:66 offset1:67
    ds_read2_b32 v[64:65], v6 offset0:208 offset1:209
    ds_read2_b32 v[66:67], v6 offset0:210 offset1:211
    ds_read2_b32 v[68:69], v6 offset0:80 offset1:81
    ds_read2_b32 v[70:71], v6 offset0:82 offset1:83
    ds_read2_b32 v[72:73], v6 offset0:224 offset1:225
    ds_read2_b32 v[74:75], v6 offset0:226 offset1:227
    ds_read2_b32 v[76:77], v6 offset0:96 offset1:97
    ds_read2_b32 v[78:79], v6 offset0:98 offset1:99
    ds_read2_b32 v[80:81], v6 offset0:240 offset1:241
    ds_read2_b32 v[82:83], v6 offset0:242 offset1:243
    ds_read2_b32 v[84:85], v6 offset0:112 offset1:113
    ds_read2_b32 v[86:87], v6 offset0:114 offset1:115
    ds_read2_b32 v[88:89], v7 offset0:96 offset1:97
    ds_read2_b32 v[90:91], v7 offset0:98 offset1:99
    ds_read2_b32 v[92:93], v6 offset0:128 offset1:129
    ds_read2_b32 v[94:95], v6 offset0:130 offset1:131
    v_lshlrev_b32 v18, 3, v3
    v_sub_u32 v18, v8, v18
    v_lshrrev_b32 v19, 2, v2
    v_lshl_add_u32 v19, v19, 2, v3
    v_and_b32 v28, 3, v2
    v_lshlrev_b32 v28, 4, v28
    v_lshlrev_b32 v19, s8, v19
    s_waitcnt lgkmcnt(0)
    v_mov_b32 v7, v18
    v_add_u32 v6, v19, v28
    v_xor_b32 v12, s9, v12
W_33:
    ds_read_b32 v18, v4 offset:16
    s_sub_u32 s39, s39, 1
    s_cbranch_scc1 KS_ABORT
    s_waitcnt lgkmcnt(0)
    v_cmp_ne_u32 vcc, s84, v18
    s_cbranch_vccnz W_33
    s_setprio 1
    ds_read_b128 v[96:99], v8 offset:0
    ds_read_b128 v[100:103], v8 offset:64
    ds_read_b128 v[104:107], v8 offset:128
    ds_read_b128 v[108:111], v8 offset:192
    s_waitcnt lgkmcnt(3)
    v_mfma_f32_16x16x32_f16 v[20:23], v[32:35], v[96:99], 0
    v_mfma_f32_16x16x32_f16 v[24:27], v[36:39], v[96:99], 0
    ds_read_b128 v[112:115], v8 offset:256
    s_waitcnt lgkmcnt(3)
    v_mfma_f32_16x16x32_f16 v[20:23], v[40:43], v[100:103], v[20:23]
    ds_read_b64 v[28:29], v7 offset:480
    ds_read_b64 v[30:31], v7 offset:992
    v_mfma_f32_16x16x32_f16 v[24:27], v[44:47], v[100:103], v[24:27]
    ds_read_b128 v[116:119], v8 offset:320
    s_waitcnt lgkmcnt(5)
    v_mfma_f32_16x16x32_f16 v[20:23], v[48:51], v[104:107], v[20:23]
    v_mfma_f32_16x16x32_f16 v[24:27], v[52:55], v[104:107], v[24:27]
    ds_read_b128 v[120:123], v8 offset:384
    s_waitcnt lgkmcnt(2)
    v_fma_mix_f32 v104, v28, v17, 0 op_sel_hi:[1,0,0]
    v_fma_mix_f32 v105, v28, v17, 0 op_sel:[1,0,0] op_sel_hi:[1,0,0]
    v_mfma_f32_16x16x32_f16 v[20:23], v[56:59], v[108:111], v[20:23]
    v_fma_mix_f32 v106, v29, v17, 0 op_sel_hi:[1,0,0]
    v_fma_mix_f32 v107, v29, v17, 0 op_sel:[1,0,0] op_sel_hi:[1,0,0]
    v_mfma_f32_16x16x32_f16 v[24:27], v[60:63], v[108:111], v[24:27]
    ds_read_b128 v[124:127], v8 offset:448
    v_cvt_pk_bf16_f32 v28, v104, v105
    v_cvt_pk_bf16_f32 v29, v106, v107
    v_mfma_f32_16x16x32_f16 v[20:23], v[64:67], v[112:115], v[20:23]
    v_lshlrev_b32 v104, 16, v28
    v_and_b32 v105, 0xffff0000, v28
    v_mfma_f32_16x16x32_f16 v[24:27], v[68:71], v[112:115], v[24:27]
    ds_read_b128 v[36:39], v8 offset:512
    v_lshlrev_b32 v106, 16, v29
    v_and_b32 v107, 0xffff0000, v29
    s_waitcnt lgkmcnt(3)
    v_mfma_f32_16x16x32_f16 v[20:23], v[72:75], v[116:119], v[20:23]
    ds_read_b128 v[96:99], v8 offset:576
    v_fma_mix_f32 v112, v30, v17, 0 op_sel_hi:[1,0,0]
    v_fma_mix_f32 v113, v30, v17, 0 op_sel:[1,0,0] op_sel_hi:[1,0,0]
    v_mfma_f32_16x16x32_f16 v[24:27], v[76:79], v[116:119], v[24:27]
    ds_read_b128 v[44:47], v8 offset:640
    v_fma_mix_f32 v114, v31, v17, 0 op_sel_hi:[1,0,0]
    v_fma_mix_f32 v115, v31, v17, 0 op_sel:[1,0,0] op_sel_hi:[1,0,0]
    s_waitcnt lgkmcnt(4)
    v_mfma_f32_16x16x32_f16 v[20:23], v[80:83], v[120:123], v[20:23]
    ds_read_b128 v[100:103], v8 offset:704
    v_cvt_pk_bf16_f32 v30, v112, v113
    v_cvt_pk_bf16_f32 v31, v114, v115
    v_mfma_f32_16x16x32_f16 v[24:27], v[84:87], v[120:123], v[24:27]
    ds_read_b128 v[52:55], v8 offset:768
    v_lshlrev_b32 v112, 16, v30
    v_and_b32 v113, 0xffff0000, v30
    s_waitcnt lgkmcnt(5)
    v_mfma_f32_16x16x32_f16 v[20:23], v[88:91], v[124:127], v[20:23]
    ds_read_b128 v[60:63], v8 offset:832
    v_lshlrev_b32 v114, 16, v31
    v_and_b32 v115, 0xffff0000, v31
    v_mfma_f32_16x16x32_f16 v[24:27], v[92:95], v[124:127], v[24:27]
    ds_read_b128 v[108:111], v8 offset:896
    s_waitcnt lgkmcnt(6)
    v_mfma_f32_16x16x32_f16 v[24:27], v[32:35], v[36:39], v[24:27]
    ds_read_b128 v[68:71], v8 offset:960
    v_mul_f32 v20, v20, v16
    v_mul_f32 v21, v21, v16
    s_waitcnt lgkmcnt(6)
    v_mfma_f32_16x16x32_f16 v[24:27], v[40:43], v[96:99], v[24:27]
    v_mul_f32 v22, v22, v16
    v_mul_f32 v23, v23, v16
    s_waitcnt lgkmcnt(5)
    v_mfma_f32_16x16x32_f16 v[24:27], v[48:51], v[44:47], v[24:27]
    v_cvt_pk_bf16_f32 v28, v20, v21
    v_cvt_pk_bf16_f32 v29, v22, v23
    s_waitcnt lgkmcnt(4)
    v_mfma_f32_16x16x32_f16 v[24:27], v[56:59], v[100:103], v[24:27]
    v_lshlrev_b32 v20, 16, v28
    v_and_b32 v21, 0xffff0000, v28
    s_waitcnt lgkmcnt(3)
    v_mfma_f32_16x16x32_f16 v[24:27], v[64:67], v[52:55], v[24:27]
    v_lshlrev_b32 v22, 16, v29
    v_and_b32 v23, 0xffff0000, v29
    s_waitcnt lgkmcnt(2)
    v_mfma_f32_16x16x32_f16 v[24:27], v[72:75], v[60:63], v[24:27]
    v_add_f32 v20, v20, v104
    v_add_f32 v21, v21, v105
    s_waitcnt lgkmcnt(1)
    v_mfma_f32_16x16x32_f16 v[24:27], v[80:83], v[108:111], v[24:27]
    v_add_f32 v22, v22, v106
    v_add_f32 v23, v23, v107
    s_waitcnt lgkmcnt(0)
    v_mfma_f32_16x16x32_f16 v[24:27], v[88:91], v[68:71], v[24:27]
    v_cvt_pk_bf16_f32 v28, v20, v21
    v_cvt_pk_bf16_f32 v29, v22, v23
    v_min_u32 v28, -2, v28
    v_min_u32 v29, -2, v29
    ds_read_u8 v18, v4 offset:160
    ds_read_b128 v[20:23], v12 offset:46592
    s_nop 1
    v_mul_f32 v24, v24, v16
    v_mul_f32 v25, v25, v16
    v_mul_f32 v26, v26, v16
    v_mul_f32 v27, v27, v16
    v_cvt_pk_bf16_f32 v30, v24, v25
    v_cvt_pk_bf16_f32 v31, v26, v27
    v_lshlrev_b32 v24, 16, v30
    v_and_b32 v25, 0xffff0000, v30
    v_lshlrev_b32 v26, 16, v31
    v_and_b32 v27, 0xffff0000, v31
    v_add_f32 v24, v24, v112
    v_add_f32 v25, v25, v113
    v_add_f32 v26, v26, v114
    v_add_f32 v27, v27, v115
    v_cvt_pk_bf16_f32 v30, v24, v25
    v_cvt_pk_bf16_f32 v31, v26, v27
    v_min_u32 v30, -2, v30
    v_min_u32 v31, -2, v31
    s_branch CVE_32
CV_29:
    ds_read2_b32 v[32:33], v6 offset0:0 offset1:1
    ds_read2_b32 v[34:35], v6 offset0:2 offset1:3
    ds_read2_b32 v[36:37], v6 offset0:16 offset1:17
    ds_read2_b32 v[38:39], v6 offset0:18 offset1:19
    ds_read2_b32 v[40:41], v6 offset0:32 offset1:33
    ds_read2_b32 v[42:43], v6 offset0:34 offset1:35
    ds_read2_b32 v[44:45], v6 offset0:48 offset1:49
    ds_read2_b32 v[46:47], v6 offset0:50 offset1:51
    ds_read2_b32 v[48:49], v6 offset0:64 offset1:65
    ds_read2_b32 v[50:51], v6 offset0:66 offset1:67
    ds_read2_b32 v[52:53], v6 offset0:80 offset1:81
    ds_read2_b32 v[54:55], v6 offset0:82 offset1:83
    ds_read2_b32 v[56:57], v6 offset0:96 offset1:97
    ds_read2_b32 v[58:59], v6 offset0:98 offset1:99
    ds_read2_b32 v[60:61], v6 offset0:112 offset1:113
    ds_read2_b32 v[62:63], v6 offset0:114 offset1:115
    ds_read2_b32 v[64:65], v6 offset0:128 offset1:129
    ds_read2_b32 v[66:67], v6 offset0:130 offset1:131
    ds_read2_b32 v[68:69], v6 offset0:144 offset1:145
    ds_read2_b32 v[70:71], v6 offset0:146 offset1:147
    ds_read2_b32 v[72:73], v6 offset0:160 offset1:161
    ds_read2_b32 v[74:75], v6 offset0:162 offset1:163
    ds_read2_b32 v[76:77], v6 offset0:176 offset1:177
    ds_read2_b32 v[78:79], v6 offset0:178 offset1:179
    ds_read2_b32 v[80:81], v6 offset0:192 offset1:193
    ds_read2_b32 v[82:83], v6 offset0:194 offset1:195
    ds_read2_b32 v[84:85], v6 offset0:208 offset1:209
    ds_read2_b32 v[86:87], v6 offset0:210 offset1:211
    ds_read2_b32 v[88:89], v6 offset0:224 offset1:225
    ds_read2_b32 v[90:91], v6 offset0:226 offset1:227
    ds_read2_b32 v[92:93], v6 offset0:240 offset1:241
    ds_read2_b32 v[94:95], v6 offset0:242 offset1:243
    ds_read2_b32 v[96:97], v7 offset0:96 offset1:97
    ds_read2_b32 v[98:99], v7 offset0:98 offset1:99
    ds_read2_b32 v[100:101], v11 offset0:32 offset1:33
    ds_read2_b32 v[102:103], v11 offset0:34 offset1:35
    ds_read2_b32 v[104:105], v11 offset0:96 offset1:97
    ds_read2_b32 v[106:107], v11 offset0:98 offset1:99
    v_lshlrev_b32 v18, 3, v3
    v_sub_u32 v18, v8, v18
    v_lshrrev_b32 v19, 2, v2
    v_lshl_add_u32 v19, v19, 2, v3
    v_and_b32 v28, 3, v2
    v_lshlrev_b32 v28, 4, v28
    v_lshlrev_b32 v19, s8, v19
    s_waitcnt lgkmcnt(0)
    v_mov_b32 v7, v18
    v_add_u32 v6, v19, v28
    v_xor_b32 v12, s9, v12
W_34:
    ds_read_b32 v18, v4 offset:16
    s_sub_u32 s39, s39, 1
    s_cbranch_scc1 KS_ABORT
    s_waitcnt lgkmcnt(0)
    v_cmp_ne_u32 vcc, s84, v18
    s_cbranch_vccnz W_34
    s_setprio 1
    ds_read_b128 v[108:111], v8 offset:448
    ds_read_b128 v[112:115], v8 offset:512
    ds_read_b128 v[116:119], v8 offset:576
    ds_read_b128 v[120:123], v8 offset:640
    ds_read_b128 v[124:127], v8 offset:704
    s_waitcnt lgkmcnt(4)
    v_mfma_f32_16x16x32_f16 v[20:23], v[32:35], v[108:111], 0
    ds_read_b128 v[108:111], v8 offset:768
    s_waitcnt lgkmcnt(4)
    v_mfma_f32_16x16x32_f16 v[20:23], v[36:39], v[112:115], v[20:23]
    ds_read_b128 v[112:115], v8 offset:832
    s_waitcnt lgkmcnt(4)
    v_mfma_f32_16x16x32_f16 v[20:23], v[40:43], v[116:119], v[20:23]
    ds_read_b128 v[116:119], v8 offset:896
    ds_read_b64 v[28:29], v7 offset:1504
    ds_read_b64 v[30:31], v7 offset:2016
    s_waitcnt lgkmcnt(6)
    v_mfma_f32_16x16x32_f16 v[20:23], v[44:47], v[120:123], v[20:23]
    ds_read_b128 v[120:123], v8 offset:960
    s_waitcnt lgkmcnt(6)
    v_mfma_f32_16x16x32_f16 v[20:23], v[48:51], v[124:127], v[20:23]
    ds_read_b128 v[124:127], v8 offset:1024
    s_waitcnt lgkmcnt(6)
    v_mfma_f32_16x16x32_f16 v[20:23], v[52:55], v[108:111], v[20:23]
    ds_read_b128 v[108:111], v8 offset:1088
    s_waitcnt lgkmcnt(6)
    v_mfma_f32_16x16x32_f16 v[20:23], v[56:59], v[112:115], v[20:23]
    s_waitcnt lgkmcnt(5)
    v_mfma_f32_16x16x32_f16 v[20:23], v[60:63], v[116:119], v[20:23]
    ds_read_b128 v[112:115], v8 offset:1152
    s_waitcnt lgkmcnt(3)
    v_mfma_f32_16x16x32_f16 v[20:23], v[64:67], v[120:123], v[20:23]
    v_mfma_f32_16x16x32_f16 v[24:27], v[32:35], v[120:123], 0
    ds_read_b128 v[116:119], v8 offset:1216
    v_fma_mix_f32 v120, v28, v17, 0 op_sel_hi:[1,0,0]
    v_fma_mix_f32 v121, v28, v17, 0 op_sel:[1,0,0] op_sel_hi:[1,0,0]
    s_waitcnt lgkmcnt(3)
    v_mfma_f32_16x16x32_f16 v[20:23], v[68:71], v[124:127], v[20:23]
    v_fma_mix_f32 v122, v29, v17, 0 op_sel_hi:[1,0,0]
    v_fma_mix_f32 v123, v29, v17, 0 op_sel:[1,0,0] op_sel_hi:[1,0,0]
    v_mfma_f32_16x16x32_f16 v[24:27], v[36:39], v[124:127], v[24:27]
    ds_read_b128 v[32:35], v8 offset:1280
    v_cvt_pk_bf16_f32 v28, v120, v121
    v_cvt_pk_bf16_f32 v29, v122, v123
    s_waitcnt lgkmcnt(3)
    v_mfma_f32_16x16x32_f16 v[20:23], v[72:75], v[108:111], v[20:23]
    v_lshlrev_b32 v120, 16, v28
    v_and_b32 v121, 0xffff0000, v28
    v_mfma_f32_16x16x32_f16 v[24:27], v[40:43], v[108:111], v[24:27]
    ds_read_b128 v[36:39], v8 offset:1344
    v_lshlrev_b32 v122, 16, v29
    v_and_b32 v123, 0xffff0000, v29
    s_waitcnt lgkmcnt(3)
    v_mfma_f32_16x16x32_f16 v[20:23], v[76:79], v[112:115], v[20:23]
    v_fma_mix_f32 v108, v30, v17, 0 op_sel_hi:[1,0,0]
    v_fma_mix_f32 v109, v30, v17, 0 op_sel:[1,0,0] op_sel_hi:[1,0,0]
    v_mfma_f32_16x16x32_f16 v[24:27], v[44:47], v[112:115], v[24:27]
    ds_read_b128 v[124:127], v8 offset:1408
    v_fma_mix_f32 v110, v31, v17, 0 op_sel_hi:[1,0,0]
    v_fma_mix_f32 v111, v31, v17, 0 op_sel:[1,0,0] op_sel_hi:[1,0,0]
    s_waitcnt lgkmcnt(3)
    v_mfma_f32_16x16x32_f16 v[20:23], v[80:83], v[116:119], v[20:23]
    v_cvt_pk_bf16_f32 v30, v108, v109
    v_cvt_pk_bf16_f32 v31, v110, v111
    v_mfma_f32_16x16x32_f16 v[24:27], v[48:51], v[116:119], v[24:27]
    ds_read_b128 v[40:43], v8 offset:1472
    v_lshlrev_b32 v108, 16, v30
    v_and_b32 v109, 0xffff0000, v30
    s_waitcnt lgkmcnt(3)
    v_mfma_f32_16x16x32_f16 v[20:23], v[84:87], v[32:35], v[20:23]
    v_lshlrev_b32 v110, 16, v31
    v_and_b32 v111, 0xffff0000, v31
    v_mfma_f32_16x16x32_f16 v[24:27], v[52:55], v[32:35], v[24:27]
    ds_read_b128 v[44:47], v8 offset:1536
    s_waitcnt lgkmcnt(3)
    v_mfma_f32_16x16x32_f16 v[20:23], v[88:91], v[36:39], v[20:23]
    ds_read_b128 v[112:115], v8 offset:1600
    v_mfma_f32_16x16x32_f16 v[24:27], v[56:59], v[36:39], v[24:27]
    ds_read_b128 v[48:51], v8 offset:1664
    s_waitcnt lgkmcnt(4)
    v_mfma_f32_16x16x32_f16 v[20:23], v[92:95], v[124:127], v[20:23]
    ds_read_b128 v[116:119], v8 offset:1728
    v_mfma_f32_16x16x32_f16 v[24:27], v[60:63], v[124:127], v[24:27]
    ds_read_b128 v[52:55], v8 offset:1792
    s_waitcnt lgkmcnt(5)
    v_mfma_f32_16x16x32_f16 v[20:23], v[96:99], v[40:43], v[20:23]
    ds_read_b128 v[32:35], v8 offset:1856
    v_mfma_f32_16x16x32_f16 v[24:27], v[64:67], v[40:43], v[24:27]
    ds_read_b32 v18, v14 offset:76
    ds_read_b128 v[56:59], v8 offset:1920
    s_waitcnt lgkmcnt(7)
    v_mfma_f32_16x16x32_f16 v[24:27], v[68:71], v[44:47], v[24:27]
    ds_read_b128 v[36:39], v8 offset:1984
    s_waitcnt lgkmcnt(7)
    v_mfma_f32_16x16x32_f16 v[24:27], v[72:75], v[112:115], v[24:27]
    ds_read2_b32 v[60:61], v11 offset0:16 offset1:17
    ds_read2_b32 v[62:63], v11 offset0:18 offset1:19
    s_waitcnt lgkmcnt(8)
    v_mfma_f32_16x16x32_f16 v[24:27], v[76:79], v[48:51], v[24:27]
    s_waitcnt lgkmcnt(4)
    v_cmp_ne_u32 vcc, s84, v18
    s_cbranch_vccnz WS_35
WB_36:
    ds_read_b64_tr_b16 v[124:125], v9 offset:0
    ds_read_b64_tr_b16 v[126:127], v9 offset:64
    ds_read_b64_tr_b16 v[64:65], v9 offset:3088
    ds_read_b64_tr_b16 v[66:67], v9 offset:3152
    v_mfma_f32_16x16x32_f16 v[24:27], v[80:83], v[116:119], v[24:27]
    v_mfma_f32_16x16x32_f16 v[24:27], v[84:87], v[52:55], v[24:27]
    ds_read_b64_tr_b16 v[40:41], v9 offset:512
    ds_read_b64_tr_b16 v[42:43], v9 offset:576
    ds_read2_b32 v[68:69], v11 offset0:80 offset1:81
    ds_read2_b32 v[70:71], v11 offset0:82 offset1:83
    v_mfma_f32_16x16x32_f16 v[24:27], v[88:91], v[32:35], v[24:27]
    s_waitcnt lgkmcnt(11)
    v_mfma_f32_16x16x32_f16 v[24:27], v[92:95], v[56:59], v[24:27]
    ds_read_b64_tr_b16 v[44:45], v9 offset:3600
    ds_read_b64_tr_b16 v[46:47], v9 offset:3664
    s_waitcnt lgkmcnt(12)
    v_mfma_f32_16x16x32_f16 v[24:27], v[96:99], v[36:39], v[24:27]
    s_waitcnt lgkmcnt(8)
    v_mfma_f32_16x16x32_f16 v[20:23], v[124:127], v[100:103], v[20:23]
    s_waitcnt lgkmcnt(6)
    v_mfma_f32_16x16x32_f16 v[20:23], v[64:67], v[104:107], v[20:23]
    v_mfma_f32_16x16x32_f16 v[24:27], v[124:127], v[60:63], v[24:27]
    s_waitcnt lgkmcnt(4)
    v_mfma_f32_16x16x32_f16 v[24:27], v[40:43], v[100:103], v[24:27]
    s_nop 4
    v_mul_f32 v20, v20, v16
    v_mul_f32 v21, v21, v16
    s_waitcnt lgkmcnt(2)
    v_mfma_f32_16x16x32_f16 v[24:27], v[64:67], v[68:71], v[24:27]
    v_mul_f32 v22, v22, v16
    v_mul_f32 v23, v23, v16
    s_waitcnt lgkmcnt(0)
    v_mfma_f32_16x16x32_f16 v[24:27], v[44:47], v[104:107], v[24:27]
    v_cvt_pk_bf16_f32 v28, v20, v21
    v_cvt_pk_bf16_f32 v29, v22, v23
    v_lshlrev_b32 v20, 16, v28
    v_and_b32 v21, 0xffff0000, v28
    v_lshlrev_b32 v22, 16, v29
    v_and_b32 v23, 0xffff0000, v29
    v_add_f32 v20, v20, v120
    v_add_f32 v21, v21, v121
    v_add_f32 v22, v22, v122
    v_add_f32 v23, v23, v123
    v_cvt_pk_bf16_f32 v28, v20, v21
    v_cvt_pk_bf16_f32 v29, v22, v23
    v_min_u32 v28, -2, v28
    v_min_u32 v29, -2, v29
    ds_read_u8 v18, v4 offset:161
    ds_read_b128 v[20:23], v12 offset:47616
    v_mul_f32 v24, v24, v16
    v_mul_f32 v25, v25, v16
    v_mul_f32 v26, v26, v16
    v_mul_f32 v27, v27, v16
    v_cvt_pk_bf16_f32 v30, v24, v25
    v_cvt_pk_bf16_f32 v31, v26, v27
    v_lshlrev_b32 v24, 16, v30
    v_and_b32 v25, 0xffff0000, v30
    v_lshlrev_b32 v26, 16, v31
    v_and_b32 v27, 0xffff0000, v31
    v_add_f32 v24, v24, v108
    v_add_f32 v25, v25, v109
    v_add_f32 v26, v26, v110
    v_add_f32 v27, v27, v111
    v_cvt_pk_bf16_f32 v30, v24, v25
    v_cvt_pk_bf16_f32 v31, v26, v27
    v_min_u32 v30, -2, v30
    v_min_u32 v31, -2, v31
    s_branch CVE_32
CV_30:
    ds_read2_b32 v[32:33], v7 offset0:128 offset1:129
    ds_read2_b32 v[34:35], v7 offset0:130 offset1:131
    ds_read2_b32 v[36:37], v6 offset0:0 offset1:1
    ds_read2_b32 v[38:39], v6 offset0:2 offset1:3
    ds_read2_b32 v[40:41], v6 offset0:16 offset1:17
    ds_read2_b32 v[42:43], v6 offset0:18 offset1:19
    ds_read2_b32 v[44:45], v6 offset0:32 offset1:33
    ds_read2_b32 v[46:47], v6 offset0:34 offset1:35
    ds_read2_b32 v[48:49], v6 offset0:48 offset1:49
    ds_read2_b32 v[50:51], v6 offset0:50 offset1:51
    ds_read2_b32 v[52:53], v6 offset0:64 offset1:65
    ds_read2_b32 v[54:55], v6 offset0:66 offset1:67
    ds_read2_b32 v[56:57], v6 offset0:80 offset1:81
    ds_read2_b32 v[58:59], v6 offset0:82 offset1:83
    ds_read2_b32 v[60:61], v6 offset0:96 offset1:97
    ds_read2_b32 v[62:63], v6 offset0:98 offset1:99
    ds_read2_b32 v[64:65], v6 offset0:112 offset1:113
    ds_read2_b32 v[66:67], v6 offset0:114 offset1:115
    ds_read2_b32 v[68:69], v6 offset0:128 offset1:129
    ds_read2_b32 v[70:71], v6 offset0:130 offset1:131
    ds_read2_b32 v[72:73], v6 offset0:144 offset1:145
    ds_read2_b32 v[74:75], v6 offset0:146 offset1:147
    ds_read2_b32 v[76:77], v6 offset0:160 offset1:161
    ds_read2_b32 v[78:79], v6 offset0:162 offset1:163
    ds_read2_b32 v[80:81], v6 offset0:176 offset1:177
    ds_read2_b32 v[82:83], v6 offset0:178 offset1:179
    ds_read2_b32 v[84:85], v6 offset0:192 offset1:193
    ds_read2_b32 v[86:87], v6 offset0:194 offset1:195
    ds_read2_b32 v[88:89], v6 offset0:208 offset1:209
    ds_read2_b32 v[90:91], v6 offset0:210 offset1:211
    ds_read2_b32 v[92:93], v6 offset0:224 offset1:225
    ds_read2_b32 v[94:95], v6 offset0:226 offset1:227
    ds_read2_b32 v[96:97], v6 offset0:240 offset1:241
    ds_read2_b32 v[98:99], v6 offset0:242 offset1:243
    ds_read2_b32 v[100:101], v7 offset0:96 offset1:97
    ds_read2_b32 v[102:103], v7 offset0:98 offset1:99
    ds_read2_b32 v[104:105], v11 offset0:0 offset1:1
    ds_read2_b32 v[106:107], v11 offset0:2 offset1:3
    v_lshlrev_b32 v18, 3, v3
    v_sub_u32 v18, v8, v18
    v_lshrrev_b32 v19, 2, v2
    v_lshl_add_u32 v19, v19, 2, v3
    v_and_b32 v28, 3, v2
    v_lshlrev_b32 v28, 4, v28
    v_lshlrev_b32 v19, s8, v19
    s_waitcnt lgkmcnt(0)
    v_mov_b32 v7, v18
    v_add_u32 v6, v19, v28
    v_xor_b32 v12, s9, v12
W_37:
    ds_read_b32 v18, v4 offset:16
    s_sub_u32 s39, s39, 1
    s_cbranch_scc1 KS_ABORT
    s_waitcnt lgkmcnt(0)
    v_cmp_ne_u32 vcc, s84, v18
    s_cbranch_vccnz W_37
    s_setprio 1
    ds_read_b128 v[108:111], v8 offset:448
    ds_read_b128 v[112:115], v8 offset:960
    ds_read_b128 v[116:119], v8 offset:1472
    ds_read_b128 v[120:123], v8 offset:1536
    ds_read_b128 v[124:127], v8 offset:1600
    s_waitcnt lgkmcnt(4)
    v_mfma_f32_16x16x32_f16 v[20:23], v[32:35], v[108:111], 0
    ds_read_b128 v[108:111], v8 offset:1664
    s_waitcnt lgkmcnt(4)
    v_mfma_f32_16x16x32_f16 v[24:27], v[32:35], v[112:115], 0
    ds_read_b128 v[32:35], v8 offset:1728
    ds_read_b128 v[112:115], v8 offset:1792
    s_waitcnt lgkmcnt(5)
    v_mfma_f32_16x16x32_f16 v[20:23], v[36:39], v[116:119], v[20:23]
    ds_read_b128 v[116:119], v8 offset:1856
    ds_read_b64 v[28:29], v7 offset:2528
    ds_read_b64 v[30:31], v7 offset:3040
    s_waitcnt lgkmcnt(7)
    v_mfma_f32_16x16x32_f16 v[20:23], v[40:43], v[120:123], v[20:23]
    ds_read_b128 v[120:123], v8 offset:1920
    s_waitcnt lgkmcnt(7)
    v_mfma_f32_16x16x32_f16 v[20:23], v[44:47], v[124:127], v[20:23]
    ds_read_b128 v[124:127], v8 offset:1984
    s_waitcnt lgkmcnt(7)
    v_mfma_f32_16x16x32_f16 v[20:23], v[48:51], v[108:111], v[20:23]
    ds_read_b128 v[108:111], v8 offset:2048
    s_waitcnt lgkmcnt(7)
    v_mfma_f32_16x16x32_f16 v[20:23], v[52:55], v[32:35], v[20:23]
    s_waitcnt lgkmcnt(6)
    v_mfma_f32_16x16x32_f16 v[20:23], v[56:59], v[112:115], v[20:23]
    ds_read_b128 v[32:35], v8 offset:2112
    s_waitcnt lgkmcnt(6)
    v_mfma_f32_16x16x32_f16 v[20:23], v[60:63], v[116:119], v[20:23]
    s_waitcnt lgkmcnt(4)
    v_fma_mix_f32 v116, v28, v17, 0 op_sel_hi:[1,0,0]
    v_fma_mix_f32 v117, v28, v17, 0 op_sel:[1,0,0] op_sel_hi:[1,0,0]
    s_waitcnt lgkmcnt(3)
    v_mfma_f32_16x16x32_f16 v[20:23], v[64:67], v[120:123], v[20:23]
    ds_read_b128 v[112:115], v8 offset:2176
    v_fma_mix_f32 v118, v29, v17, 0 op_sel_hi:[1,0,0]
    v_fma_mix_f32 v119, v29, v17, 0 op_sel:[1,0,0] op_sel_hi:[1,0,0]
    s_waitcnt lgkmcnt(3)
    v_mfma_f32_16x16x32_f16 v[20:23], v[68:71], v[124:127], v[20:23]
    v_cvt_pk_bf16_f32 v28, v116, v117
    v_cvt_pk_bf16_f32 v29, v118, v119
    v_mfma_f32_16x16x32_f16 v[24:27], v[36:39], v[124:127], v[24:27]
    ds_read_b128 v[120:123], v8 offset:2240
    v_lshlrev_b32 v116, 16, v28
    v_and_b32 v117, 0xffff0000, v28
    s_waitcnt lgkmcnt(3)
    v_mfma_f32_16x16x32_f16 v[20:23], v[72:75], v[108:111], v[20:23]
    v_lshlrev_b32 v118, 16, v29
    v_and_b32 v119, 0xffff0000, v29
    v_mfma_f32_16x16x32_f16 v[24:27], v[40:43], v[108:111], v[24:27]
    ds_read_b128 v[36:39], v8 offset:2304
    v_fma_mix_f32 v108, v30, v17, 0 op_sel_hi:[1,0,0]
    v_fma_mix_f32 v109, v30, v17, 0 op_sel:[1,0,0] op_sel_hi:[1,0,0]
    s_waitcnt lgkmcnt(3)
    v_mfma_f32_16x16x32_f16 v[20:23], v[76:79], v[32:35], v[20:23]
    v_fma_mix_f32 v110, v31, v17, 0 op_sel_hi:[1,0,0]
    v_fma_mix_f32 v111, v31, v17, 0 op_sel:[1,0,0] op_sel_hi:[1,0,0]
    v_mfma_f32_16x16x32_f16 v[24:27], v[44:47], v[32:35], v[24:27]
    ds_read_b128 v[124:127], v8 offset:2368
    v_cvt_pk_bf16_f32 v30, v108, v109
    v_cvt_pk_bf16_f32 v31, v110, v111
    s_waitcnt lgkmcnt(3)
    v_mfma_f32_16x16x32_f16 v[20:23], v[80:83], v[112:115], v[20:23]
    v_lshlrev_b32 v108, 16, v30
    v_and_b32 v109, 0xffff0000, v30
    v_mfma_f32_16x16x32_f16 v[24:27], v[48:51], v[112:115], v[24:27]
    ds_read_b128 v[40:43], v8 offset:2432
    v_lshlrev_b32 v110, 16, v31
    v_and_b32 v111, 0xffff0000, v31
    s_waitcnt lgkmcnt(3)
    v_mfma_f32_16x16x32_f16 v[20:23], v[84:87], v[120:123], v[20:23]
    v_mfma_f32_16x16x32_f16 v[24:27], v[52:55], v[120:123], v[24:27]
    ds_read_b128 v[44:47], v8 offset:2496
    s_waitcnt lgkmcnt(3)
    v_mfma_f32_16x16x32_f16 v[20:23], v[88:91], v[36:39], v[20:23]
    v_mfma_f32_16x16x32_f16 v[24:27], v[56:59], v[36:39], v[24:27]
    ds_read_b128 v[32:35], v8 offset:2560
    s_waitcnt lgkmcnt(3)
    v_mfma_f32_16x16x32_f16 v[20:23], v[92:95], v[124:127], v[20:23]
    ds_read_b128 v[48:51], v8 offset:2624
    v_mfma_f32_16x16x32_f16 v[24:27], v[60:63], v[124:127], v[24:27]
    ds_read_b128 v[112:115], v8 offset:2688
    s_waitcnt lgkmcnt(4)
    v_mfma_f32_16x16x32_f16 v[20:23], v[96:99], v[40:43], v[20:23]
    ds_read_b128 v[52:55], v8 offset:2752
    v_mfma_f32_16x16x32_f16 v[24:27], v[64:67], v[40:43], v[24:27]
    ds_read_b128 v[120:123], v8 offset:2816
    s_waitcnt lgkmcnt(5)
    v_mfma_f32_16x16x32_f16 v[20:23], v[100:103], v[44:47], v[20:23]
    ds_read_b128 v[56:59], v8 offset:2880
    v_mfma_f32_16x16x32_f16 v[24:27], v[68:71], v[44:47], v[24:27]
    ds_read_b32 v18, v14 offset:76
    ds_read_b128 v[36:39], v8 offset:2944
    s_waitcnt lgkmcnt(7)
    v_mfma_f32_16x16x32_f16 v[24:27], v[72:75], v[32:35], v[24:27]
    ds_read_b128 v[60:63], v8 offset:3008
    s_waitcnt lgkmcnt(7)
    v_mfma_f32_16x16x32_f16 v[24:27], v[76:79], v[48:51], v[24:27]
    ds_read2_b32 v[124:125], v11 offset0:16 offset1:17
    ds_read2_b32 v[126:127], v11 offset0:18 offset1:19
    ds_read2_b32 v[64:65], v11 offset0:32 offset1:33
    ds_read2_b32 v[66:67], v11 offset0:34 offset1:35
    s_waitcnt lgkmcnt(10)
    v_mfma_f32_16x16x32_f16 v[24:27], v[80:83], v[112:115], v[24:27]
    s_waitcnt lgkmcnt(6)
    v_cmp_ne_u32 vcc, s84, v18
    s_cbranch_vccnz WS_38
WB_39:
    ds_read_b64_tr_b16 v[40:41], v9 offset:0
    ds_read_b64_tr_b16 v[42:43], v9 offset:64
    ds_read_b64_tr_b16 v[68:69], v9 offset:512
    ds_read_b64_tr_b16 v[70:71], v9 offset:576
    v_mfma_f32_16x16x32_f16 v[24:27], v[84:87], v[52:55], v[24:27]
    ds_read_b64_tr_b16 v[44:45], v9 offset:1024
    ds_read_b64_tr_b16 v[46:47], v9 offset:1088
    v_mfma_f32_16x16x32_f16 v[24:27], v[88:91], v[120:123], v[24:27]
    ds_read_b64_tr_b16 v[72:73], v9 offset:3088
    ds_read_b64_tr_b16 v[74:75], v9 offset:3152
    ds_read2_b32 v[32:33], v11 offset0:64 offset1:65
    ds_read2_b32 v[34:35], v11 offset0:66 offset1:67
    v_mfma_f32_16x16x32_f16 v[24:27], v[92:95], v[56:59], v[24:27]
    ds_read_b64_tr_b16 v[76:77], v9 offset:3600
    ds_read_b64_tr_b16 v[78:79], v9 offset:3664
    ds_read2_b32 v[48:49], v11 offset0:80 offset1:81
    ds_read2_b32 v[50:51], v11 offset0:82 offset1:83
    v_mfma_f32_16x16x32_f16 v[24:27], v[96:99], v[36:39], v[24:27]
    ds_read_b64_tr_b16 v[80:81], v9 offset:4112
    ds_read_b64_tr_b16 v[82:83], v9 offset:4176
    ds_read2_b32 v[112:113], v11 offset0:96 offset1:97
    ds_read2_b32 v[114:115], v11 offset0:98 offset1:99
    v_mfma_f32_16x16x32_f16 v[24:27], v[100:103], v[60:63], v[24:27]
    ds_read_b64_tr_b16 v[84:85], v10 offset:6176
    ds_read_b64_tr_b16 v[86:87], v10 offset:6304
    ds_read2_b32 v[52:53], v13 offset0:24 offset1:25
    ds_read2_b32 v[54:55], v13 offset0:26 offset1:27
    v_mfma_f32_16x16x32_f16 v[20:23], v[40:43], v[104:107], v[20:23]
    ds_read_b64_tr_b16 v[88:89], v10 offset:8224
    ds_read_b64_tr_b16 v[90:91], v10 offset:8352
    ds_read2_b32 v[120:121], v13 offset0:120 offset1:121
    ds_read2_b32 v[122:123], v13 offset0:122 offset1:123
    v_mfma_f32_16x16x32_f16 v[20:23], v[68:71], v[124:127], v[20:23]
    v_mfma_f32_16x16x32_f16 v[20:23], v[44:47], v[64:67], v[20:23]
    v_mfma_f32_16x16x32_f16 v[20:23], v[72:75], v[32:35], v[20:23]
    ds_read_b64_tr_b16 v[92:93], v9 offset:1536
    ds_read_b64_tr_b16 v[94:95], v9 offset:1600
    s_waitcnt lgkmcnt(14)
    v_mfma_f32_16x16x32_f16 v[20:23], v[76:79], v[48:51], v[20:23]
    s_waitcnt lgkmcnt(10)
    v_mfma_f32_16x16x32_f16 v[20:23], v[80:83], v[112:115], v[20:23]
    s_waitcnt lgkmcnt(6)
    v_mfma_f32_16x16x32_f16 v[20:23], v[84:87], v[52:55], v[20:23]
    ds_read_b64_tr_b16 v[56:57], v9 offset:4624
    ds_read_b64_tr_b16 v[58:59], v9 offset:4688
    ds_read2_b32 v[96:97], v13 offset0:16 offset1:17
    ds_read2_b32 v[98:99], v13 offset0:18 offset1:19
    s_waitcnt lgkmcnt(6)
    v_mfma_f32_16x16x32_f16 v[20:23], v[88:91], v[120:123], v[20:23]
    ds_read2_b32 v[36:37], v13 offset0:112 offset1:113
    ds_read2_b32 v[38:39], v13 offset0:114 offset1:115
    v_mfma_f32_16x16x32_f16 v[24:27], v[68:71], v[104:107], v[24:27]
    v_mfma_f32_16x16x32_f16 v[24:27], v[44:47], v[124:127], v[24:27]
    s_nop 3
    v_mul_f32 v20, v20, v16
    v_mul_f32 v21, v21, v16
    s_waitcnt lgkmcnt(6)
    v_mfma_f32_16x16x32_f16 v[24:27], v[92:95], v[64:67], v[24:27]
    v_mul_f32 v22, v22, v16
    v_mul_f32 v23, v23, v16
    v_mfma_f32_16x16x32_f16 v[24:27], v[76:79], v[32:35], v[24:27]
    v_cvt_pk_bf16_f32 v28, v20, v21
    v_cvt_pk_bf16_f32 v29, v22, v23
    v_mfma_f32_16x16x32_f16 v[24:27], v[80:83], v[48:51], v[24:27]
    v_lshlrev_b32 v20, 16, v28
    v_and_b32 v21, 0xffff0000, v28
    s_waitcnt lgkmcnt(4)
    v_mfma_f32_16x16x32_f16 v[24:27], v[56:59], v[112:115], v[24:27]
    v_lshlrev_b32 v22, 16, v29
    v_and_b32 v23, 0xffff0000, v29
    s_waitcnt lgkmcnt(2)
    v_mfma_f32_16x16x32_f16 v[24:27], v[84:87], v[96:99], v[24:27]
    v_add_f32 v20, v20, v116
    v_add_f32 v21, v21, v117
    s_waitcnt lgkmcnt(0)
    v_mfma_f32_16x16x32_f16 v[24:27], v[88:91], v[36:39], v[24:27]
    v_add_f32 v22, v22, v118
    v_add_f32 v23, v23, v119
    v_cvt_pk_bf16_f32 v28, v20, v21
    v_cvt_pk_bf16_f32 v29, v22, v23
    v_min_u32 v28, -2, v28
    v_min_u32 v29, -2, v29
    ds_read_u8 v18, v4 offset:162
    ds_read_b128 v[20:23], v12 offset:48640
    v_mul_f32 v24, v24, v16
    v_mul_f32 v25, v25, v16
    v_mul_f32 v26, v26, v16
    v_mul_f32 v27, v27, v16
    v_cvt_pk_bf16_f32 v30, v24, v25
    v_cvt_pk_bf16_f32 v31, v26, v27
    v_lshlrev_b32 v24, 16, v30
    v_and_b32 v25, 0xffff0000, v30
    v_lshlrev_b32 v26, 16, v31
    v_and_b32 v27, 0xffff0000, v31
    v_add_f32 v24, v24, v108
    v_add_f32 v25, v25, v109
    v_add_f32 v26, v26, v110
    v_add_f32 v27, v27, v111
    v_cvt_pk_bf16_f32 v30, v24, v25
    v_cvt_pk_bf16_f32 v31, v26, v27
    v_min_u32 v30, -2, v30
    v_min_u32 v31, -2, v31
    s_branch CVE_32
CV_31:
    ds_read2_b32 v[32:33], v7 offset0:128 offset1:129
    ds_read2_b32 v[34:35], v7 offset0:130 offset1:131
    ds_read2_b32 v[36:37], v6 offset0:0 offset1:1
    ds_read2_b32 v[38:39], v6 offset0:2 offset1:3
    ds_read2_b32 v[40:41], v6 offset0:16 offset1:17
    ds_read2_b32 v[42:43], v6 offset0:18 offset1:19
    ds_read2_b32 v[44:45], v6 offset0:32 offset1:33
    ds_read2_b32 v[46:47], v6 offset0:34 offset1:35
    ds_read2_b32 v[48:49], v6 offset0:48 offset1:49
    ds_read2_b32 v[50:51], v6 offset0:50 offset1:51
    ds_read2_b32 v[52:53], v6 offset0:64 offset1:65
    ds_read2_b32 v[54:55], v6 offset0:66 offset1:67
    ds_read2_b32 v[56:57], v6 offset0:80 offset1:81
    ds_read2_b32 v[58:59], v6 offset0:82 offset1:83
    ds_read2_b32 v[60:61], v6 offset0:96 offset1:97
    ds_read2_b32 v[62:63], v6 offset0:98 offset1:99
    ds_read2_b32 v[64:65], v6 offset0:112 offset1:113
    ds_read2_b32 v[66:67], v6 offset0:114 offset1:115
    ds_read2_b32 v[68:69], v6 offset0:128 offset1:129
    ds_read2_b32 v[70:71], v6 offset0:130 offset1:131
    ds_read2_b32 v[72:73], v6 offset0:144 offset1:145
    ds_read2_b32 v[74:75], v6 offset0:146 offset1:147
    ds_read2_b32 v[76:77], v6 offset0:160 offset1:161
    ds_read2_b32 v[78:79], v6 offset0:162 offset1:163
    ds_read2_b32 v[80:81], v6 offset0:176 offset1:177
    ds_read2_b32 v[82:83], v6 offset0:178 offset1:179
    ds_read2_b32 v[84:85], v6 offset0:192 offset1:193
    ds_read2_b32 v[86:87], v6 offset0:194 offset1:195
    ds_read2_b32 v[88:89], v6 offset0:208 offset1:209
    ds_read2_b32 v[90:91], v6 offset0:210 offset1:211
    ds_read2_b32 v[92:93], v6 offset0:224 offset1:225
    ds_read2_b32 v[94:95], v6 offset0:226 offset1:227
    ds_read2_b32 v[96:97], v6 offset0:240 offset1:241
    ds_read2_b32 v[98:99], v6 offset0:242 offset1:243
    ds_read2_b32 v[100:101], v7 offset0:96 offset1:97
    ds_read2_b32 v[102:103], v7 offset0:98 offset1:99
    ds_read2_b32 v[104:105], v11 offset0:0 offset1:1
    ds_read2_b32 v[106:107], v11 offset0:2 offset1:3
    v_lshlrev_b32 v18, 3, v3
    v_sub_u32 v18, v8, v18
    v_lshrrev_b32 v19, 2, v2
    v_lshl_add_u32 v19, v19, 2, v3
    v_and_b32 v28, 3, v2
    v_lshlrev_b32 v28, 4, v28
    v_lshlrev_b32 v19, s8, v19
    s_waitcnt lgkmcnt(0)
    v_mov_b32 v7, v18
    v_add_u32 v6, v19, v28
    v_xor_b32 v12, s9, v12
W_40:
    ds_read_b32 v18, v4 offset:16
    s_sub_u32 s39, s39, 1
    s_cbranch_scc1 KS_ABORT
    s_waitcnt lgkmcnt(0)
    v_cmp_ne_u32 vcc, s84, v18
    s_cbranch_vccnz W_40
    s_setprio 1
    ds_read_b128 v[108:111], v8 offset:1472
    ds_read_b128 v[112:115], v8 offset:1984
    ds_read_b128 v[116:119], v8 offset:2496
    ds_read_b128 v[120:123], v8 offset:2560
    ds_read_b128 v[124:127], v8 offset:2624
    s_waitcnt lgkmcnt(4)
    v_mfma_f32_16x16x32_f16 v[20:23], v[32:35], v[108:111], 0
    ds_read_b128 v[108:111], v8 offset:2688
    s_waitcnt lgkmcnt(4)
    v_mfma_f32_16x16x32_f16 v[24:27], v[32:35], v[112:115], 0
    ds_read_b128 v[32:35], v8 offset:2752
    ds_read_b128 v[112:115], v8 offset:2816
    s_waitcnt lgkmcnt(5)
    v_mfma_f32_16x16x32_f16 v[20:23], v[36:39], v[116:119], v[20:23]
    ds_read_b128 v[116:119], v8 offset:2880
    ds_read_b64 v[28:29], v7 offset:3552
    ds_read_b64 v[30:31], v7 offset:4064
    s_waitcnt lgkmcnt(7)
    v_mfma_f32_16x16x32_f16 v[20:23], v[40:43], v[120:123], v[20:23]
    ds_read_b128 v[120:123], v8 offset:2944
    s_waitcnt lgkmcnt(7)
    v_mfma_f32_16x16x32_f16 v[20:23], v[44:47], v[124:127], v[20:23]
    ds_read_b128 v[124:127], v8 offset:3008
    s_waitcnt lgkmcnt(7)
    v_mfma_f32_16x16x32_f16 v[20:23], v[48:51], v[108:111], v[20:23]
    ds_read_b128 v[108:111], v8 offset:3072
    s_waitcnt lgkmcnt(7)
    v_mfma_f32_16x16x32_f16 v[20:23], v[52:55], v[32:35], v[20:23]
    s_waitcnt lgkmcnt(6)
    v_mfma_f32_16x16x32_f16 v[20:23], v[56:59], v[112:115], v[20:23]
    ds_read_b128 v[32:35], v8 offset:3136
    s_waitcnt lgkmcnt(6)
    v_mfma_f32_16x16x32_f16 v[20:23], v[60:63], v[116:119], v[20:23]
    s_waitcnt lgkmcnt(4)
    v_fma_mix_f32 v116, v28, v17, 0 op_sel_hi:[1,0,0]
    v_fma_mix_f32 v117, v28, v17, 0 op_sel:[1,0,0] op_sel_hi:[1,0,0]
    s_waitcnt lgkmcnt(3)
    v_mfma_f32_16x16x32_f16 v[20:23], v[64:67], v[120:123], v[20:23]
    ds_read_b128 v[112:115], v8 offset:3200
    v_fma_mix_f32 v118, v29, v17, 0 op_sel_hi:[1,0,0]
    v_fma_mix_f32 v119, v29, v17, 0 op_sel:[1,0,0] op_sel_hi:[1,0,0]
    s_waitcnt lgkmcnt(3)
    v_mfma_f32_16x16x32_f16 v[20:23], v[68:71], v[124:127], v[20:23]
    v_cvt_pk_bf16_f32 v28, v116, v117
    v_cvt_pk_bf16_f32 v29, v118, v119
    v_mfma_f32_16x16x32_f16 v[24:27], v[36:39], v[124:127], v[24:27]
    ds_read_b128 v[120:123], v8 offset:3264
    v_lshlrev_b32 v116, 16, v28
    v_and_b32 v117, 0xffff0000, v28
    s_waitcnt lgkmcnt(3)
    v_mfma_f32_16x16x32_f16 v[20:23], v[72:75], v[108:111], v[20:23]
    v_lshlrev_b32 v118, 16, v29
    v_and_b32 v119, 0xffff0000, v29
    v_mfma_f32_16x16x32_f16 v[24:27], v[40:43], v[108:111], v[24:27]
    ds_read_b128 v[36:39], v8 offset:3328
    v_fma_mix_f32 v108, v30, v17, 0 op_sel_hi:[1,0,0]
    v_fma_mix_f32 v109, v30, v17, 0 op_sel:[1,0,0] op_sel_hi:[1,0,0]
    s_waitcnt lgkmcnt(3)
    v_mfma_f32_16x16x32_f16 v[20:23], v[76:79], v[32:35], v[20:23]
    v_fma_mix_f32 v110, v31, v17, 0 op_sel_hi:[1,0,0]
    v_fma_mix_f32 v111, v31, v17, 0 op_sel:[1,0,0] op_sel_hi:[1,0,0]
    v_mfma_f32_16x16x32_f16 v[24:27], v[44:47], v[32:35], v[24:27]
    ds_read_b128 v[124:127], v8 offset:3392
    v_cvt_pk_bf16_f32 v30, v108, v109
    v_cvt_pk_bf16_f32 v31, v110, v111
    s_waitcnt lgkmcnt(3)
    v_mfma_f32_16x16x32_f16 v[20:23], v[80:83], v[112:115], v[20:23]
    v_lshlrev_b32 v108, 16, v30
    v_and_b32 v109, 0xffff0000, v30
    v_mfma_f32_16x16x32_f16 v[24:27], v[48:51], v[112:115], v[24:27]
    ds_read_b128 v[40:43], v8 offset:3456
    v_lshlrev_b32 v110, 16, v31
    v_and_b32 v111, 0xffff0000, v31
    s_waitcnt lgkmcnt(3)
    v_mfma_f32_16x16x32_f16 v[20:23], v[84:87], v[120:123], v[20:23]
    v_mfma_f32_16x16x32_f16 v[24:27], v[52:55], v[120:123], v[24:27]
    ds_read_b128 v[44:47], v8 offset:3520
    s_waitcnt lgkmcnt(3)
    v_mfma_f32_16x16x32_f16 v[20:23], v[88:91], v[36:39], v[20:23]
    v_mfma_f32_16x16x32_f16 v[24:27], v[56:59], v[36:39], v[24:27]
    ds_read_b128 v[32:35], v8 offset:3584
    s_waitcnt lgkmcnt(3)
    v_mfma_f32_16x16x32_f16 v[20:23], v[92:95], v[124:127], v[20:23]
    ds_read_b128 v[48:51], v8 offset:3648
    v_mfma_f32_16x16x32_f16 v[24:27], v[60:63], v[124:127], v[24:27]
    ds_read_b128 v[112:115], v8 offset:3712
    s_waitcnt lgkmcnt(4)
    v_mfma_f32_16x16x32_f16 v[20:23], v[96:99], v[40:43], v[20:23]
    ds_read_b128 v[52:55], v8 offset:3776
    v_mfma_f32_16x16x32_f16 v[24:27], v[64:67], v[40:43], v[24:27]
    ds_read_b128 v[120:123], v8 offset:3840
    s_waitcnt lgkmcnt(5)
    v_mfma_f32_16x16x32_f16 v[20:23], v[100:103], v[44:47], v[20:23]
    ds_read_b128 v[56:59], v8 offset:3904
    v_mfma_f32_16x16x32_f16 v[24:27], v[68:71], v[44:47], v[24:27]
    ds_read_b32 v18, v14 offset:76
    ds_read_b128 v[36:39], v8 offset:3968
    s_waitcnt lgkmcnt(7)
    v_mfma_f32_16x16x32_f16 v[24:27], v[72:75], v[32:35], v[24:27]
    ds_read_b128 v[60:63], v8 offset:4032
    s_waitcnt lgkmcnt(7)
    v_mfma_f32_16x16x32_f16 v[24:27], v[76:79], v[48:51], v[24:27]
    ds_read2_b32 v[124:125], v11 offset0:16 offset1:17
    ds_read2_b32 v[126:127], v11 offset0:18 offset1:19
    ds_read2_b32 v[64:65], v11 offset0:32 offset1:33
    ds_read2_b32 v[66:67], v11 offset0:34 offset1:35
    s_waitcnt lgkmcnt(10)
    v_mfma_f32_16x16x32_f16 v[24:27], v[80:83], v[112:115], v[24:27]
    s_waitcnt lgkmcnt(6)
    v_cmp_ne_u32 vcc, s84, v18
    s_cbranch_vccnz WS_41
WB_42:
    ds_read_b64_tr_b16 v[40:41], v9 offset:1024
    ds_read_b64_tr_b16 v[42:43], v9 offset:1088
    ds_read_b64_tr_b16 v[68:69], v9 offset:1536
    ds_read_b64_tr_b16 v[70:71], v9 offset:1600
    v_mfma_f32_16x16x32_f16 v[24:27], v[84:87], v[52:55], v[24:27]
    ds_read_b64_tr_b16 v[44:45], v9 offset:2048
    ds_read_b64_tr_b16 v[46:47], v9 offset:2112
    v_mfma_f32_16x16x32_f16 v[24:27], v[88:91], v[120:123], v[24:27]
    ds_read_b64_tr_b16 v[72:73], v9 offset:4112
    ds_read_b64_tr_b16 v[74:75], v9 offset:4176
    ds_read2_b32 v[32:33], v11 offset0:64 offset1:65
    ds_read2_b32 v[34:35], v11 offset0:66 offset1:67
    v_mfma_f32_16x16x32_f16 v[24:27], v[92:95], v[56:59], v[24:27]
    ds_read_b64_tr_b16 v[76:77], v9 offset:4624
    ds_read_b64_tr_b16 v[78:79], v9 offset:4688
    ds_read2_b32 v[48:49], v11 offset0:80 offset1:81
    ds_read2_b32 v[50:51], v11 offset0:82 offset1:83
    v_mfma_f32_16x16x32_f16 v[24:27], v[96:99], v[36:39], v[24:27]
    ds_read_b64_tr_b16 v[80:81], v9 offset:5136
    ds_read_b64_tr_b16 v[82:83], v9 offset:5200
    ds_read2_b32 v[112:113], v11 offset0:96 offset1:97
    ds_read2_b32 v[114:115], v11 offset0:98 offset1:99
    v_mfma_f32_16x16x32_f16 v[24:27], v[100:103], v[60:63], v[24:27]
    ds_read_b64_tr_b16 v[84:85], v10 offset:6176
    ds_read_b64_tr_b16 v[86:87], v10 offset:6304
    ds_read2_b32 v[52:53], v13 offset0:8 offset1:9
    ds_read2_b32 v[54:55], v13 offset0:10 offset1:11
    v_mfma_f32_16x16x32_f16 v[20:23], v[40:43], v[104:107], v[20:23]
    ds_read_b64_tr_b16 v[88:89], v10 offset:7200
    ds_read_b64_tr_b16 v[90:91], v10 offset:7328
    ds_read2_b32 v[120:121], v13 offset0:24 offset1:25
    ds_read2_b32 v[122:123], v13 offset0:26 offset1:27
    v_mfma_f32_16x16x32_f16 v[20:23], v[68:71], v[124:127], v[20:23]
    ds_read_b64_tr_b16 v[92:93], v10 offset:8224
    ds_read_b64_tr_b16 v[94:95], v10 offset:8352
    ds_read2_b32 v[56:57], v13 offset0:104 offset1:105
    ds_read2_b32 v[58:59], v13 offset0:106 offset1:107
    v_mfma_f32_16x16x32_f16 v[20:23], v[44:47], v[64:67], v[20:23]
    ds_read_b64_tr_b16 v[96:97], v10 offset:9248
    ds_read_b64_tr_b16 v[98:99], v10 offset:9376
    ds_read2_b32 v[36:37], v13 offset0:120 offset1:121
    ds_read2_b32 v[38:39], v13 offset0:122 offset1:123
    v_mfma_f32_16x16x32_f16 v[20:23], v[72:75], v[32:35], v[20:23]
    v_mfma_f32_16x16x32_f16 v[20:23], v[76:79], v[48:51], v[20:23]
    v_mfma_f32_16x16x32_f16 v[20:23], v[80:83], v[112:115], v[20:23]
    ds_read_b64_tr_b16 v[100:101], v9 offset:2560
    ds_read_b64_tr_b16 v[102:103], v9 offset:2624
    s_waitcnt lgkmcnt(14)
    v_mfma_f32_16x16x32_f16 v[20:23], v[84:87], v[52:55], v[20:23]
    s_waitcnt lgkmcnt(10)
    v_mfma_f32_16x16x32_f16 v[20:23], v[88:91], v[120:123], v[20:23]
    s_waitcnt lgkmcnt(6)
    v_mfma_f32_16x16x32_f16 v[20:23], v[92:95], v[56:59], v[20:23]
    ds_read_b64_tr_b16 v[60:61], v9 offset:5648
    ds_read_b64_tr_b16 v[62:63], v9 offset:5712
    ds_read2_b32 v[40:41], v13 offset0:0 offset1:1
    ds_read2_b32 v[42:43], v13 offset0:2 offset1:3
    s_waitcnt lgkmcnt(6)
    v_mfma_f32_16x16x32_f16 v[20:23], v[96:99], v[36:39], v[20:23]
    ds_read2_b32 v[72:73], v13 offset0:16 offset1:17
    ds_read2_b32 v[74:75], v13 offset0:18 offset1:19
    ds_read2_b32 v[52:53], v13 offset0:96 offset1:97
    ds_read2_b32 v[54:55], v13 offset0:98 offset1:99
    v_mfma_f32_16x16x32_f16 v[24:27], v[68:71], v[104:107], v[24:27]
    ds_read2_b32 v[120:121], v13 offset0:112 offset1:113
    ds_read2_b32 v[122:123], v13 offset0:114 offset1:115
    v_mfma_f32_16x16x32_f16 v[24:27], v[44:47], v[124:127], v[24:27]
    v_mul_f32 v20, v20, v16
    v_mul_f32 v21, v21, v16
    s_waitcnt lgkmcnt(10)
    v_mfma_f32_16x16x32_f16 v[24:27], v[100:103], v[64:67], v[24:27]
    v_mul_f32 v22, v22, v16
    v_mul_f32 v23, v23, v16
    v_mfma_f32_16x16x32_f16 v[24:27], v[76:79], v[32:35], v[24:27]
    v_cvt_pk_bf16_f32 v28, v20, v21
    v_cvt_pk_bf16_f32 v29, v22, v23
    v_mfma_f32_16x16x32_f16 v[24:27], v[80:83], v[48:51], v[24:27]
    v_lshlrev_b32 v20, 16, v28
    v_and_b32 v21, 0xffff0000, v28
    s_waitcnt lgkmcnt(8)
    v_mfma_f32_16x16x32_f16 v[24:27], v[60:63], v[112:115], v[24:27]
    v_lshlrev_b32 v22, 16, v29
    v_and_b32 v23, 0xffff0000, v29
    s_waitcnt lgkmcnt(6)
    v_mfma_f32_16x16x32_f16 v[24:27], v[84:87], v[40:43], v[24:27]
    v_add_f32 v20, v20, v116
    v_add_f32 v21, v21, v117
    s_waitcnt lgkmcnt(4)
    v_mfma_f32_16x16x32_f16 v[24:27], v[88:91], v[72:75], v[24:27]
    v_add_f32 v22, v22, v118
    v_add_f32 v23, v23, v119
    s_waitcnt lgkmcnt(2)
    v_mfma_f32_16x16x32_f16 v[24:27], v[92:95], v[52:55], v[24:27]
    v_cvt_pk_bf16_f32 v28, v20, v21
    v_cvt_pk_bf16_f32 v29, v22, v23
    s_waitcnt lgkmcnt(0)
    v_mfma_f32_16x16x32_f16 v[24:27], v[96:99], v[120:123], v[24:27]
    v_min_u32 v28, -2, v28
    v_min_u32 v29, -2, v29
    ds_read_u8 v18, v4 offset:163
    ds_read_b128 v[20:23], v12 offset:49664
    s_nop 3
    v_mul_f32 v24, v24, v16
    v_mul_f32 v25, v25, v16
    v_mul_f32 v26, v26, v16
    v_mul_f32 v27, v27, v16
    v_cvt_pk_bf16_f32 v30, v24, v25
    v_cvt_pk_bf16_f32 v31, v26, v27
    v_lshlrev_b32 v24, 16, v30
    v_and_b32 v25, 0xffff0000, v30
    v_lshlrev_b32 v26, 16, v31
    v_and_b32 v27, 0xffff0000, v31
    v_add_f32 v24, v24, v108
    v_add_f32 v25, v25, v109
    v_add_f32 v26, v26, v110
    v_add_f32 v27, v27, v111
    v_cvt_pk_bf16_f32 v30, v24, v25
    v_cvt_pk_bf16_f32 v31, v26, v27
    v_min_u32 v30, -2, v30
    v_min_u32 v31, -2, v31
CVE_32:
    s_waitcnt lgkmcnt(0)
    s_cmp_lg_u32 s87, 1
    s_cbranch_scc1 ZA_43
    v_cmp_ne_u32 vcc, 1, v18
    s_cbranch_vccnz ZS_45
ZB_46:
    s_mov_b64 exec, s[12:13]
    v_swap_b32 v28, v20
    v_swap_b32 v29, v21
    v_swap_b32 v30, v22
    v_swap_b32 v31, v23
    s_mov_b64 exec, -1
    buffer_store_dwordx4 v[28:31], v6, s[64:67], s7 offen sc1
    buffer_store_dwordx4 v[20:23], v6, s[64:67], s6 offen sc1
    s_branch ZD_48
WS_35:
W_49:
    ds_read_b32 v18, v14 offset:76
    s_sub_u32 s39, s39, 1
    s_cbranch_scc1 KS_ABORT
    s_waitcnt lgkmcnt(0)
    v_cmp_ne_u32 vcc, s84, v18
    s_cbranch_vccnz W_49
    s_branch WB_36
WS_38:
W_50:
    ds_read_b32 v18, v14 offset:76
    s_sub_u32 s39, s39, 1
    s_cbranch_scc1 KS_ABORT
    s_waitcnt lgkmcnt(0)
    v_cmp_ne_u32 vcc, s84, v18
    s_cbranch_vccnz W_50
    s_branch WB_39
WS_41:
W_51:
    ds_read_b32 v18, v14 offset:76
    s_sub_u32 s39, s39, 1
    s_cbranch_scc1 KS_ABORT
    s_waitcnt lgkmcnt(0)
    v_cmp_ne_u32 vcc, s84, v18
    s_cbranch_vccnz W_51
    s_branch WB_42
ZS_45:
    v_mov_b32 v19, s86
ZW_52:
    ds_read_u8 v18, v19 offset:160
    s_sub_u32 s39, s39, 1
    s_cbranch_scc1 KS_ABORT
    s_waitcnt lgkmcnt(0)
    v_cmp_ne_u32 vcc, 1, v18
    s_cbranch_vccnz ZW_52
    v_lshl_add_u32 v19, v19, 10, v12
    ds_read_b128 v[20:23], v19 offset:46592
    s_waitcnt lgkmcnt(0)
    s_branch ZB_46
ZA_43:
    s_cmp_lg_u32 s87, 0
    s_cbranch_scc1 ZC_44
    v_mov_b32 v19, s86
    v_lshl_add_u32 v18, v19, 10, v12
    ds_write_b128 v18, v[28:31] offset:46592
    ds_write_b8 v19, v5 offset:160
    s_branch ZD_48
ZC_44:
    buffer_store_dwordx4 v[28:31], v6, s[64:67], s6 offen sc1
ZD_48:
    s_lshl_b32 s92, s87, 2
    s_add_u32 s92, s92, s86
    v_mov_b32 v8, s92
    s_waitcnt vmcnt(0)
    ds_write_b8 v8, v5 offset:48
    s_cmp_lt_u32 s41, 18
    s_cbranch_scc1 KS_T
    s_waitcnt lgkmcnt(0)
    s_endpgm
KS_X:
    s_cmp_lt_u32 s41, 24
    s_cbranch_scc1 KS_X2
    s_setprio 2
KS_XC:
    s_mov_b32 s87, 2
    s_add_u32 s86, s38, 3
    s_and_b32 s86, s86, 3
    s_lshl_b32 s88, s40, 3
    s_and_b32 s92, s41, 7
    s_add_u32 s88, s88, s92
    s_add_u32 s88, s88, 512
    s_lshl_b32 s92, s86, 11
    s_add_u32 s92, s92, 146048
    v_lshl_add_u32 v28, v1, 3, s92
    s_branch KS_GRP
KS_X2:
    s_cmp_lt_u32 s41, 8
    s_cbranch_scc1 KS_X3
    s_sub_u32 s97, s38, 8
    s_branch KS_LN1
KS_X3:
    s_lshl_b32 s92, s2, 4
    s_add_u32 s92, s92, s38
    s_cmp_lg_u32 s92, 12
    s_cbranch_scc1 KS_X3B
    s_setprio 3
    s_memrealtime s[92:93]
    v_and_b32 v6, 3, v1
    v_lshlrev_b32 v7, 2, v6
    v_min_u32 v6, 2, v6
    v_lshlrev_b32 v6, 2, v6
    v_cmp_eq_u32 vcc, 3, v1
    s_waitcnt lgkmcnt(0)
    v_mov_b32 v8, s92
    v_mov_b32 v9, s93
    v_alignbit_b32 v8, v8, v8, v6
    v_cndmask_b32 v9, v4, v9, vcc
    v_xor_b32 v8, v8, v9
    v_and_b32 v9, 0xf0000fff, v8
    v_and_b32 v10, 0xfff000, v8
    v_lshl_or_b32 v9, v10, 4, v9
    v_lshrrev_b32 v10, 12, v8
    v_and_b32 v10, 0xf000, v10
    v_or3_b32 v9, v9, v10, v9
    v_or_b32 v9, 0x80000000, v9
    s_mov_b64 exec, 15
    global_store_dword v7, v9, s[34:35] sc1
    s_mov_b64 exec, -1
    s_setprio 0
KS_X3B:
    s_setprio 3
    s_branch KS_XC
    s_waitcnt lgkmcnt(0)
    s_barrier
    s_branch KS_G
KS_X4:
    s_cmp_lt_u32 s41, 18
    s_cbranch_scc1 KS_G
    s_waitcnt vmcnt(0) lgkmcnt(0)
    s_endpgm
KS_L:
    v_lshlrev_b32 v6, 2, v0
    ds_write_b32 v6, v4
    v_mov_b32 v8, 0
    v_mov_b32 v9, 0
    s_min_u32 s92, s38, 2
    s_mul_i32 s92, s92, 4672
    v_min_u32 v6, 59, v1
    v_lshl_add_u32 v6, v6, 3, s92
    ds_write_b64 v6, v[8:9] offset:3072
    s_mov_b32 s97, s38
    s_sub_u32 s92, s41, 8
    s_cmp_lt_u32 s92, 16
    s_cbranch_scc0 KS_L0
KS_LN1:
    s_setprio 3
    s_sub_u32 s92, s41, 8
    s_and_b32 s88, s92, 7
    s_lshr_b32 s92, s92, 3
    s_lshl_b32 s92, s92, 4
    s_add_u32 s88, s88, s92
    s_and_b32 s92, s40, 1
    s_lshl_b32 s92, s92, 3
    s_add_u32 s88, s88, s92
    s_lshr_b32 s92, s40, 1
    s_lshl_b32 s92, s92, 5
    s_add_u32 s88, s88, s92
    v_lshrrev_b32 v36, 5, v1
    v_and_b32 v37, 31, v1
    v_mul_u32_u24 v38, 1152, v36
    v_lshl_add_u32 v39, v37, 2, v38
    v_lshl_add_u32 v38, v37, 4, v38
    s_mul_i32 s93, s88, 18432
    s_mul_i32 s94, s97, 2304
    s_add_u32 s93, s93, s94
    s_waitcnt lgkmcnt(0)
    s_mov_b32 s64, s4
    s_mov_b32 s65, s5
    s_mov_b32 s66, 0x240000
    s_mov_b32 s67, 0x20000
    buffer_load_dwordx4 v[26:29], v38, s[64:67], s93 offen
    buffer_load_dwordx4 v[30:33], v38, s[64:67], s93 offen offset:512
    buffer_load_dword v34, v39, s[64:67], s93 offen offset:1024
    s_barrier
    s_lshr_b32 s93, s97, 2
    s_lshl_b32 s93, s93, 6
    s_add_u32 s94, s94, s93
    s_add_u32 s94, s94, 17088
    v_lshl_add_u32 v35, v37, 1, v36
    s_mov_b32 s98, 0x05040100
    s_mov_b32 s99, 0x07060302
    v_mul_u32_u24 v46, 57, v1
    v_lshrrev_b32 v46, 9, v46
    v_mul_u32_u24 v47, 9, v46
    v_sub_u32 v47, v1, v47
    v_mul_u32_u24 v46, 9216, v46
    v_lshl_add_u32 v46, v47, 7, v46
    s_sub_u32 s93, s97, 4
    s_and_b32 s93, s93, 7
    s_lshl_b32 s95, s93, 4
    s_add_u32 s95, s95, s41
    s_sub_u32 s95, s95, 8
    s_bitcmp1_b32 s95, 0
    s_cselect_b32 s76, s28, s26
    s_cselect_b32 s77, s29, s27
    s_mov_b32 s78, 0x510000
    s_mov_b32 s79, 0x20000
    s_lshr_b32 s96, s95, 1
    s_mul_i32 s96, s96, 64512
    s_mul_i32 s92, s40, 1152
    s_add_u32 s96, s96, s92
    s_waitcnt vmcnt(2)
    v_lshlrev_b32 v8, 16, v26
    v_and_b32 v9, 0xffff0000, v26
    v_lshlrev_b32 v10, 16, v27
    v_and_b32 v11, 0xffff0000, v27
    v_lshlrev_b32 v12, 16, v28
    v_and_b32 v13, 0xffff0000, v28
    v_lshlrev_b32 v14, 16, v29
    v_and_b32 v15, 0xffff0000, v29
    s_waitcnt vmcnt(1)
    v_lshlrev_b32 v16, 16, v30
    v_and_b32 v17, 0xffff0000, v30
    v_lshlrev_b32 v18, 16, v31
    v_and_b32 v19, 0xffff0000, v31
    v_lshlrev_b32 v20, 16, v32
    v_and_b32 v21, 0xffff0000, v32
    v_lshlrev_b32 v22, 16, v33
    v_and_b32 v23, 0xffff0000, v33
    s_waitcnt vmcnt(0)
    v_lshlrev_b32 v24, 16, v34
    v_and_b32 v25, 0xffff0000, v34
    s_cmp_ge_u32 s93, 3
    s_cbranch_scc1 LN1A_53
    buffer_load_dword v47, v46, s[76:79], s96 offen
LN1A_53:
    v_lshl_add_u32 v6, v35, 4, s94
    v_lshl_add_u32 v7, v35, 2, s94
    v_mul_u32_u24 v35, 0x20202, v36
    v_lshl_add_u32 v35, v36, 25, v35
    v_add_u32 v35, 0x05040100, v35
    v_pk_add_f32 v[40:41], v[8:9], v[10:11]
    v_pk_add_f32 v[42:43], v[12:13], v[14:15]
    v_pk_add_f32 v[40:41], v[40:41], v[16:17]
    v_pk_add_f32 v[42:43], v[42:43], v[18:19]
    v_pk_add_f32 v[40:41], v[40:41], v[20:21]
    v_pk_add_f32 v[42:43], v[42:43], v[22:23]
    v_pk_add_f32 v[40:41], v[40:41], v[24:25]
    v_pk_add_f32 v[40:41], v[40:41], v[42:43]
    v_add_f32 v40, v40, v41
    s_nop 1
    v_add_f32_dpp v40, v40, v40 row_ror:8 row_mask:0xf bank_mask:0xf
    s_nop 1
    v_add_f32_dpp v40, v40, v40 row_ror:4 row_mask:0xf bank_mask:0xf
    s_nop 1
    v_add_f32_dpp v40, v40, v40 row_ror:2 row_mask:0xf bank_mask:0xf
    s_nop 1
    v_add_f32_dpp v40, v40, v40 row_ror:1 row_mask:0xf bank_mask:0xf
    v_mov_b32 v42, v40
    s_nop 1
    v_permlane16_swap_b32 v40, v42
    v_add_f32 v40, v40, v42
    v_mul_f32 v44, 0x3ae38e39, v40
    v_mov_b32 v45, v44
    v_cvt_pk_bf16_f32 v36, v44, v44
    v_and_b32 v36, 0xffff0000, v36
    v_mov_b32 v37, v36
    v_pk_add_f32 v[38:39], v[8:9], v[44:45] neg_lo:[0,1] neg_hi:[0,1]
    v_pk_mul_f32 v[40:41], v[38:39], v[38:39]
    v_pk_add_f32 v[38:39], v[10:11], v[44:45] neg_lo:[0,1] neg_hi:[0,1]
    v_pk_mul_f32 v[42:43], v[38:39], v[38:39]
    v_pk_add_f32 v[38:39], v[12:13], v[44:45] neg_lo:[0,1] neg_hi:[0,1]
    v_pk_fma_f32 v[40:41], v[38:39], v[38:39], v[40:41]
    v_pk_add_f32 v[38:39], v[14:15], v[44:45] neg_lo:[0,1] neg_hi:[0,1]
    v_pk_fma_f32 v[42:43], v[38:39], v[38:39], v[42:43]
    v_pk_add_f32 v[38:39], v[16:17], v[44:45] neg_lo:[0,1] neg_hi:[0,1]
    v_pk_fma_f32 v[40:41], v[38:39], v[38:39], v[40:41]
    v_pk_add_f32 v[38:39], v[18:19], v[44:45] neg_lo:[0,1] neg_hi:[0,1]
    v_pk_fma_f32 v[42:43], v[38:39], v[38:39], v[42:43]
    v_pk_add_f32 v[38:39], v[20:21], v[44:45] neg_lo:[0,1] neg_hi:[0,1]
    v_pk_fma_f32 v[40:41], v[38:39], v[38:39], v[40:41]
    v_pk_add_f32 v[38:39], v[22:23], v[44:45] neg_lo:[0,1] neg_hi:[0,1]
    v_pk_fma_f32 v[42:43], v[38:39], v[38:39], v[42:43]
    v_pk_add_f32 v[38:39], v[24:25], v[44:45] neg_lo:[0,1] neg_hi:[0,1]
    v_pk_fma_f32 v[40:41], v[38:39], v[38:39], v[40:41]
    v_pk_add_f32 v[40:41], v[40:41], v[42:43]
    v_add_f32 v40, v40, v41
    s_nop 1
    v_add_f32_dpp v40, v40, v40 row_ror:8 row_mask:0xf bank_mask:0xf
    s_nop 1
    v_add_f32_dpp v40, v40, v40 row_ror:4 row_mask:0xf bank_mask:0xf
    s_nop 1
    v_add_f32_dpp v40, v40, v40 row_ror:2 row_mask:0xf bank_mask:0xf
    s_nop 1
    v_add_f32_dpp v40, v40, v40 row_ror:1 row_mask:0xf bank_mask:0xf
    v_mov_b32 v42, v40
    s_nop 1
    v_permlane16_swap_b32 v40, v42
    v_add_f32 v40, v40, v42
    v_mul_f32 v40, 0x3ae38e39, v40
    v_cvt_pk_bf16_f32 v40, v40, v40
    v_and_b32 v40, 0xffff0000, v40
    v_add_f32 v40, 0x3727c5ac, v40
    v_cvt_pk_bf16_f32 v40, v40, v40
    v_and_b32 v40, 0xffff0000, v40
    v_sqrt_f32 v40, v40
    s_nop 0
    v_cvt_pk_bf16_f32 v40, v40, v40
    v_and_b32 v40, 0xffff0000, v40
    v_rcp_f32 v38, v40
    s_nop 0
    v_mov_b32 v39, v38
    v_pk_add_f32 v[40:41], v[8:9], v[36:37] neg_lo:[0,1] neg_hi:[0,1]
    v_cvt_pk_bf16_f32 v42, v40, v41
    v_lshlrev_b32 v40, 16, v42
    v_and_b32 v41, 0xffff0000, v42
    v_pk_mul_f32 v[40:41], v[40:41], v[38:39]
    v_cvt_pk_bf16_f32 v42, v40, v41
    v_lshlrev_b32 v40, 16, v42
    v_and_b32 v41, 0xffff0000, v42
    v_cvt_pk_f16_f32 v26, v40, v41
    v_pk_add_f32 v[40:41], v[10:11], v[36:37] neg_lo:[0,1] neg_hi:[0,1]
    v_cvt_pk_bf16_f32 v42, v40, v41
    v_lshlrev_b32 v40, 16, v42
    v_and_b32 v41, 0xffff0000, v42
    v_pk_mul_f32 v[40:41], v[40:41], v[38:39]
    v_cvt_pk_bf16_f32 v42, v40, v41
    v_lshlrev_b32 v40, 16, v42
    v_and_b32 v41, 0xffff0000, v42
    v_cvt_pk_f16_f32 v27, v40, v41
    v_pk_add_f32 v[40:41], v[12:13], v[36:37] neg_lo:[0,1] neg_hi:[0,1]
    v_cvt_pk_bf16_f32 v42, v40, v41
    v_lshlrev_b32 v40, 16, v42
    v_and_b32 v41, 0xffff0000, v42
    v_pk_mul_f32 v[40:41], v[40:41], v[38:39]
    v_cvt_pk_bf16_f32 v42, v40, v41
    v_lshlrev_b32 v40, 16, v42
    v_and_b32 v41, 0xffff0000, v42
    v_cvt_pk_f16_f32 v28, v40, v41
    v_and_b32 v59, 3, v1
    v_lshlrev_b32 v59, 2, v59
    global_load_dword v58, v59, s[34:35] sc1
    v_pk_add_f32 v[40:41], v[14:15], v[36:37] neg_lo:[0,1] neg_hi:[0,1]
    v_cvt_pk_bf16_f32 v42, v40, v41
    v_lshlrev_b32 v40, 16, v42
    v_and_b32 v41, 0xffff0000, v42
    v_pk_mul_f32 v[40:41], v[40:41], v[38:39]
    v_cvt_pk_bf16_f32 v42, v40, v41
    v_lshlrev_b32 v40, 16, v42
    v_and_b32 v41, 0xffff0000, v42
    v_cvt_pk_f16_f32 v29, v40, v41
    v_permlane32_swap_b32 v26, v28
    s_nop 0
    v_permlane32_swap_b32 v27, v29
    v_perm_b32 v8, v28, v26, s98
    v_perm_b32 v9, v28, v26, s99
    v_perm_b32 v10, v29, v27, s98
    v_perm_b32 v11, v29, v27, s99
    ds_write_b128 v6, v[8:11] offset:0
    v_pk_add_f32 v[40:41], v[16:17], v[36:37] neg_lo:[0,1] neg_hi:[0,1]
    v_cvt_pk_bf16_f32 v42, v40, v41
    v_lshlrev_b32 v40, 16, v42
    v_and_b32 v41, 0xffff0000, v42
    v_pk_mul_f32 v[40:41], v[40:41], v[38:39]
    v_cvt_pk_bf16_f32 v42, v40, v41
    v_lshlrev_b32 v40, 16, v42
    v_and_b32 v41, 0xffff0000, v42
    v_cvt_pk_f16_f32 v30, v40, v41
    v_pk_add_f32 v[40:41], v[18:19], v[36:37] neg_lo:[0,1] neg_hi:[0,1]
    v_cvt_pk_bf16_f32 v42, v40, v41
    v_lshlrev_b32 v40, 16, v42
    v_and_b32 v41, 0xffff0000, v42
    v_pk_mul_f32 v[40:41], v[40:41], v[38:39]
    v_cvt_pk_bf16_f32 v42, v40, v41
    v_lshlrev_b32 v40, 16, v42
    v_and_b32 v41, 0xffff0000, v42
    v_cvt_pk_f16_f32 v31, v40, v41
    v_pk_add_f32 v[40:41], v[20:21], v[36:37] neg_lo:[0,1] neg_hi:[0,1]
    v_cvt_pk_bf16_f32 v42, v40, v41
    v_lshlrev_b32 v40, 16, v42
    v_and_b32 v41, 0xffff0000, v42
    v_pk_mul_f32 v[40:41], v[40:41], v[38:39]
    v_cvt_pk_bf16_f32 v42, v40, v41
    v_lshlrev_b32 v40, 16, v42
    v_and_b32 v41, 0xffff0000, v42
    v_cvt_pk_f16_f32 v32, v40, v41
    v_pk_add_f32 v[40:41], v[22:23], v[36:37] neg_lo:[0,1] neg_hi:[0,1]
    v_cvt_pk_bf16_f32 v42, v40, v41
    v_lshlrev_b32 v40, 16, v42
    v_and_b32 v41, 0xffff0000, v42
    v_pk_mul_f32 v[40:41], v[40:41], v[38:39]
    v_cvt_pk_bf16_f32 v42, v40, v41
    v_lshlrev_b32 v40, 16, v42
    v_and_b32 v41, 0xffff0000, v42
    v_cvt_pk_f16_f32 v33, v40, v41
    v_permlane32_swap_b32 v30, v32
    s_nop 0
    v_permlane32_swap_b32 v31, v33
    v_perm_b32 v16, v32, v30, s98
    v_perm_b32 v17, v32, v30, s99
    v_perm_b32 v18, v33, v31, s98
    v_perm_b32 v19, v33, v31, s99
    ds_write_b128 v6, v[16:19] offset:1024
    v_pk_add_f32 v[40:41], v[24:25], v[36:37] neg_lo:[0,1] neg_hi:[0,1]
    v_cvt_pk_bf16_f32 v42, v40, v41
    v_lshlrev_b32 v40, 16, v42
    v_and_b32 v41, 0xffff0000, v42
    v_pk_mul_f32 v[40:41], v[40:41], v[38:39]
    v_cvt_pk_bf16_f32 v42, v40, v41
    v_lshlrev_b32 v40, 16, v42
    v_and_b32 v41, 0xffff0000, v42
    v_cvt_pk_f16_f32 v34, v40, v41
    v_mov_b32 v40, v34
    s_nop 1
    v_permlane32_swap_b32 v34, v40
    v_perm_b32 v40, v40, v34, v35
    ds_write_b32 v7, v40 offset:2048
    v_mov_b32 v6, s97
    ds_write_b8 v6, v5 offset:0
    s_setprio 0
    s_cmp_ge_u32 s97, 4
    s_cbranch_scc1 KS_X4
    s_setprio 3
    s_mov_b32 s72, s36
    s_mov_b32 s73, s37
    s_mov_b32 s74, 0x240000
    s_mov_b32 s75, 0x20000
    v_and_b32 v6, 1, v0
    v_mul_u32_u24 v6, 9280, v6
    v_lshrrev_b32 v7, 1, v0
    v_lshl_add_u32 v6, v7, 2, v6
    v_add_u32 v6, 17088, v6
    v_lshrrev_b32 v7, 2, v0
    v_lshlrev_b32 v7, 13, v7
    v_and_b32 v8, 3, v0
    v_lshl_add_u32 v7, v8, 4, v7
    s_lshl_b32 s92, s88, 6
    s_add_u32 s93, s92, 524288
    s_add_u32 s94, s92, 1048576
    s_add_u32 s95, s92, 1572864
    s_add_u32 s96, s92, 2097152
    s_waitcnt vmcnt(0)
DBP_55:
    v_cmp_eq_u32 vcc, 0, v58
    s_cbranch_vccz DBG_56
    s_sleep 1
    global_load_dword v58, v59, s[34:35] sc1
    s_sub_u32 s39, s39, 1
    s_cbranch_scc1 KS_ABORT
    s_waitcnt vmcnt(0)
    s_branch DBP_55
DBG_56:
    s_mov_b32 s98, 0x70007
    v_lshrrev_b32 v57, 3, v58
    v_lshrrev_b32 v56, 6, v58
    v_lshrrev_b32 v55, 9, v58
W_57:
    ds_read_b64 v[20:21], v4 offset:0
    s_sub_u32 s39, s39, 1
    s_cbranch_scc1 KS_ABORT
    s_waitcnt lgkmcnt(0)
    v_and_b32 v20, v20, v21
    v_cmp_ne_u32 vcc, s84, v20
    s_cbranch_vccnz W_57
    ds_read2st64_b32 v[20:21], v6 offset0:0 offset1:9
    ds_read2st64_b32 v[22:23], v6 offset0:18 offset1:27
    ds_read2st64_b32 v[24:25], v6 offset0:2 offset1:11
    ds_read2st64_b32 v[26:27], v6 offset0:20 offset1:29
    ds_read2st64_b32 v[28:29], v6 offset0:4 offset1:13
    ds_read2st64_b32 v[30:31], v6 offset0:22 offset1:31
    ds_read2st64_b32 v[32:33], v6 offset0:6 offset1:15
    ds_read2st64_b32 v[34:35], v6 offset0:24 offset1:33
    ds_read2st64_b32 v[36:37], v6 offset0:8 offset1:17
    ds_read2st64_b32 v[38:39], v6 offset0:26 offset1:35
    s_waitcnt lgkmcnt(8)
    v_bfi_b32 v20, s98, v58, v20
    v_bfi_b32 v21, s98, v57, v21
    v_bfi_b32 v22, s98, v56, v22
    v_bfi_b32 v23, s98, v55, v23
    buffer_store_dwordx4 v[20:23], v7, s[72:75], s92 offen sc1
    s_waitcnt lgkmcnt(6)
    v_bfi_b32 v24, s98, v58, v24
    v_bfi_b32 v25, s98, v57, v25
    v_bfi_b32 v26, s98, v56, v26
    v_bfi_b32 v27, s98, v55, v27
    buffer_store_dwordx4 v[24:27], v7, s[72:75], s93 offen sc1
    s_waitcnt lgkmcnt(4)
    v_bfi_b32 v28, s98, v58, v28
    v_bfi_b32 v29, s98, v57, v29
    v_bfi_b32 v30, s98, v56, v30
    v_bfi_b32 v31, s98, v55, v31
    buffer_store_dwordx4 v[28:31], v7, s[72:75], s94 offen sc1
    s_waitcnt lgkmcnt(2)
    v_bfi_b32 v32, s98, v58, v32
    v_bfi_b32 v33, s98, v57, v33
    v_bfi_b32 v34, s98, v56, v34
    v_bfi_b32 v35, s98, v55, v35
    buffer_store_dwordx4 v[32:35], v7, s[72:75], s95 offen sc1
    s_waitcnt lgkmcnt(0)
    v_bfi_b32 v36, s98, v58, v36
    v_bfi_b32 v37, s98, v57, v37
    v_bfi_b32 v38, s98, v56, v38
    v_bfi_b32 v39, s98, v55, v39
    buffer_store_dwordx4 v[36:39], v7, s[72:75], s96 offen sc1
    s_mov_b32 s87, 1
    s_branch KS_L2B
KS_L0:
    s_and_b32 s92, s41, 15
    s_lshl_b32 s93, s40, 4
    s_add_u32 s92, s92, s93
    v_and_b32 v59, 3, v1
    v_lshlrev_b32 v59, 2, v59
    s_lshl_b32 s96, s92, 6
    s_add_u32 s93, s96, 0xb00000
    v_add_u32 v7, s93, v59
    s_mul_i32 s93, s92, 18560
    s_add_u32 s93, s93, 0x600000
    v_lshlrev_b32 v6, 4, v0
    v_mov_b32 v12, -1
    v_mov_b32 v13, -1
    v_mov_b32 v14, -1
    v_mov_b32 v15, -1
    s_setprio 3
    v_mul_u32_u24 v16, 57, v1
    v_lshrrev_b32 v16, 9, v16
    v_mul_u32_u24 v17, 9, v16
    v_sub_u32 v17, v1, v17
    v_mul_u32_u24 v16, 9216, v16
    v_lshl_add_u32 v16, v17, 7, v16
    s_waitcnt lgkmcnt(0)
    s_add_u32 s68, s36, s93
    s_addc_u32 s69, s37, 0
    s_mov_b32 s70, 18560
    s_mov_b32 s71, 0x20000
    s_barrier
W_58:
    s_sleep 2
    ds_read_b32 v8, v4 offset:36
    s_sub_u32 s39, s39, 1
    s_cbranch_scc1 KS_ABORT
    s_waitcnt lgkmcnt(0)
    v_cmp_eq_u32 vcc, 0, v8
    s_cbranch_vccnz W_58
    s_movk_i32 s92, 0
    buffer_store_dwordx4 v[12:15], v6, s[68:71], s92 offen sc1
    s_movk_i32 s92, 4096
    buffer_store_dwordx4 v[12:15], v6, s[68:71], s92 offen sc1
    s_movk_i32 s92, 8192
    buffer_store_dwordx4 v[12:15], v6, s[68:71], s92 offen sc1
    s_movk_i32 s92, 12288
    buffer_store_dwordx4 v[12:15], v6, s[68:71], s92 offen sc1
    s_movk_i32 s92, 16384
    buffer_store_dwordx4 v[12:15], v6, s[68:71], s92 offen sc1
    global_load_dword v58, v59, s[34:35] sc1
    s_waitcnt vmcnt(0)
DBP_59:
    v_cmp_eq_u32 vcc, 0, v58
    s_cbranch_vccz DBG_60
    s_sleep 1
    global_load_dword v58, v59, s[34:35] sc1
    s_sub_u32 s39, s39, 1
    s_cbranch_scc1 KS_ABORT
    s_waitcnt vmcnt(0)
    s_branch DBP_59
DBG_60:
    ds_write_b32 v59, v58 offset:224
    s_mov_b64 exec, 1
    ds_add_rtn_u32 v8, v4, v5 offset:8
    s_mov_b64 exec, -1
    v_lshrrev_b32 v57, 3, v58
    v_lshrrev_b32 v56, 6, v58
    v_lshrrev_b32 v55, 9, v58
    s_waitcnt lgkmcnt(0)
    v_readfirstlane_b32 s92, v8
    s_cmp_lg_u32 s92, 3
    s_cbranch_scc1 KS_L2
    s_mov_b64 exec, 15
    global_store_dword v7, v58, s[36:37] sc1
    s_mov_b64 exec, -1
    s_and_b32 s94, s41, 7
    s_cmp_ge_u32 s41, 8
    s_cbranch_scc1 KS_L1C
    s_setprio 0
W_61:
    s_sleep 2
    ds_read_b32 v8, v4 offset:100
    s_sub_u32 s39, s39, 1
    s_cbranch_scc1 KS_ABORT
    s_waitcnt lgkmcnt(0)
    v_cmp_ne_u32 vcc, s84, v8
    s_cbranch_vccnz W_61
    s_setprio 3
    s_bitcmp1_b32 s94, 0
    s_cselect_b32 s72, s28, s26
    s_cselect_b32 s73, s29, s27
    s_mov_b32 s74, 0x510000
    s_mov_b32 s75, 0x20000
    s_lshr_b32 s95, s94, 1
    s_mul_i32 s95, s95, 64512
    s_mul_i32 s96, s40, 1152
    s_add_u32 s95, s95, s96
    s_add_u32 s96, s95, 1548288
    buffer_load_dword v18, v16, s[72:75], s96 offen
    s_add_u32 s96, s95, 1806336
    buffer_load_dword v18, v16, s[72:75], s96 offen
    s_add_u32 s96, s95, 2064384
    buffer_load_dword v18, v16, s[72:75], s96 offen
    s_add_u32 s96, s95, 2322432
    buffer_load_dword v18, v16, s[72:75], s96 offen
    s_add_u32 s96, s95, 2580480
    buffer_load_dword v18, v16, s[72:75], s96 offen
    s_add_u32 s96, s95, 2838528
    buffer_load_dword v18, v16, s[72:75], s96 offen
    s_branch KS_L2
KS_L1C:
    s_bitcmp1_b32 s94, 0
    s_cselect_b32 s72, s28, s26
    s_cselect_b32 s73, s29, s27
    s_mov_b32 s74, 0x510000
    s_mov_b32 s75, 0x20000
    s_lshr_b32 s95, s94, 1
    s_mul_i32 s95, s95, 64512
    s_mul_i32 s96, s40, 1152
    s_add_u32 s95, s95, s96
    s_add_u32 s96, s95, 3096576
    buffer_load_dword v18, v16, s[72:75], s96 offen
    s_add_u32 s96, s95, 3354624
    buffer_load_dword v18, v16, s[72:75], s96 offen
    s_add_u32 s96, s95, 3612672
    buffer_load_dword v18, v16, s[72:75], s96 offen
KS_L2:
    s_mov_b32 s87, 0
KS_L2B:
    s_mov_b32 s64, s36
    s_mov_b32 s65, s37
    s_mov_b32 s66, 0x240000
    s_mov_b32 s67, 0x20000
    v_lshrrev_b32 v7, 1, v1
    v_lshlrev_b32 v7, 6, v7
    v_and_b32 v10, 1, v1
    v_lshl_add_u32 v7, v10, 4, v7
    v_lshlrev_b32 v9, 4, v1
    s_lshl_b32 s92, s38, 11
    s_lshl_b32 s93, s90, 13
    s_add_u32 s93, s93, s92
    s_lshl_b32 s95, s40, 3
    s_add_u32 s95, s95, s41
    s_add_u32 s95, s95, 488
    s_lshr_b32 s96, s95, 1
    s_lshl_b32 s96, s96, 13
    s_and_b32 s95, s95, 1
    s_lshl_b32 s95, s95, 5
    s_add_u32 s95, s95, s96
    s_add_u32 s95, s95, s92
    s_cmp_lt_u32 s41, 24
    s_cselect_b32 s95, 2359296, s95
    s_cselect_b32 s94, 0, 0x70007
    v_mov_b32_dpp v64, v58 quad_perm:[0,1,0,1] row_mask:0xf bank_mask:0xf
    v_mov_b32_dpp v65, v58 quad_perm:[2,3,2,3] row_mask:0xf bank_mask:0xf
    s_bitcmp1_b32 s41, 0
    s_cselect_b64 vcc, -1, 0
    v_cndmask_b32 v64, v64, v65, vcc
    v_and_b32 v60, 0x70007, v58
    v_and_b32 v61, 0x70007, v57
    v_and_b32 v62, 0x70007, v56
    v_and_b32 v63, 0x70007, v55
    v_lshrrev_b32 v67, 9, v64
    v_lshrrev_b32 v66, 6, v64
    v_lshrrev_b32 v65, 3, v64
    v_and_b32 v64, s94, v64
    v_and_b32 v65, s94, v65
    v_and_b32 v66, s94, v66
    v_and_b32 v67, s94, v67
    s_lshl_b32 s96, s38, 10
    s_add_u32 s96, s96, 3552
    v_bfe_u32 v11, v1, 1, 1
    v_mul_u32_u24 v11, 4672, v11
    v_lshl_add_u32 v11, v10, 4, v11
    v_lshrrev_b32 v10, 2, v1
    v_lshl_add_u32 v11, v10, 5, v11
    v_add_u32 v11, s96, v11
    v_add_u32 v10, s96, v9
    v_mov_b32 v116, s38
    s_add_u32 s92, s92, 0xb00000
    v_lshrrev_b32 v12, 2, v1
    v_lshl_add_u32 v12, v12, 6, v59
    v_add_u32 v12, s92, v12
    s_cmp_eq_u32 s87, 0
    s_cbranch_scc1 KS_L2C
    s_waitcnt vmcnt(0)
    s_branch KS_L2D
KS_L2C:
    s_setprio 0
W_62:
    s_sleep 2
    ds_read_b32 v8, v4 offset:68
    s_sub_u32 s39, s39, 1
    s_cbranch_scc1 KS_ABORT
    s_waitcnt lgkmcnt(0)
    v_cmp_ne_u32 vcc, s84, v8
    s_cbranch_vccnz W_62
    s_setprio 3
KS_L2D:
    s_branch UPE_64
UP_63:
    s_sleep 2
UPE_64:
    global_load_dword v32, v12, s[36:37] sc1
    global_load_dword v33, v12, s[36:37] offset:1024 sc1
    buffer_load_dwordx4 v[20:23], v9, s[64:67], s93 offen sc1
    buffer_load_dwordx4 v[24:27], v9, s[64:67], s93 offen offset:1024 sc1
    buffer_load_dwordx4 v[28:31], v7, s[64:67], s95 offen sc1
    s_sub_u32 s39, s39, 1
    s_cbranch_scc1 KS_ABORT
    s_waitcnt vmcnt(2)
    v_xor_b32 v32, v58, v32
    v_xor_b32 v33, v58, v33
    v_xor_b32 v20, v60, v20
    v_xor_b32 v21, v61, v21
    v_xor_b32 v22, v62, v22
    v_xor_b32 v23, v63, v23
    v_or3_b32 v44, v20, v21, v21
    v_or3_b32 v44, v22, v23, v44
    s_waitcnt vmcnt(1)
    v_xor_b32 v24, v60, v24
    v_xor_b32 v25, v61, v25
    v_xor_b32 v26, v62, v26
    v_xor_b32 v27, v63, v27
    v_or3_b32 v44, v24, v25, v44
    v_or3_b32 v44, v26, v27, v44
    s_waitcnt vmcnt(0)
    v_xor_b32 v28, v64, v28
    v_xor_b32 v29, v65, v29
    v_xor_b32 v30, v66, v30
    v_xor_b32 v31, v67, v31
    v_or3_b32 v44, v28, v29, v44
    v_or3_b32 v44, v30, v31, v44
    v_and_b32 v44, 0x70007, v44
    v_or3_b32 v44, v44, v32, v33
    v_cmp_ne_u32 vcc, 0, v44
    s_cbranch_vccnz UP_63
    ds_write_b128 v11, v[20:23]
    ds_write_b128 v11, v[24:27] offset:512
    ds_write_b128 v10, v[28:31] offset:9344
    ds_write_b8 v116, v5 offset:16
    s_cmp_eq_u32 s38, 2
    s_cbranch_scc1 WJ2_67
    s_add_u32 s92, s38, 1
    s_lshr_b32 s92, s92, 2
    s_cmp_eq_u32 s38, 1
    s_cselect_b32 s92, 2, s92
    s_lshl_b32 s92, s92, 10
    v_lshl_add_u32 v10, v1, 4, s92
    v_add_u32 v11, 35840, v10
W_68:
    ds_read_b32 v12, v4 offset:16
    s_sub_u32 s39, s39, 1
    s_cbranch_scc1 KS_ABORT
    s_waitcnt lgkmcnt(0)
    v_cmp_ne_u32 vcc, s84, v12
    s_cbranch_vccnz W_68
    s_setprio 3
    ds_read_b128 v[20:23], v10 offset:3520
    ds_read_b128 v[24:27], v10 offset:3536
    ds_read_b64 v[28:29], v10 offset:3552
    ds_read_b128 v[32:35], v10 offset:8192
    ds_read_b128 v[36:39], v10 offset:8208
    ds_read_b64 v[40:41], v10 offset:8224
    ds_read_b128 v[44:47], v10 offset:12864
    ds_read_b128 v[48:51], v10 offset:12880
    ds_read_b64 v[52:53], v10 offset:12896
    s_cmp_eq_u32 s38, 1
    s_cbranch_scc1 WJ1_66
    ds_read_b32 v12, v4 offset:68
    s_waitcnt lgkmcnt(7)
    v_alignbit_b32 v57, v22, v21, 16
    v_alignbit_b32 v58, v23, v22, 16
    v_alignbit_b32 v59, v24, v23, 16
    v_alignbit_b32 v60, v25, v24, 16
    v_alignbit_b32 v61, v26, v25, 16
    v_alignbit_b32 v62, v27, v26, 16
    v_alignbit_b32 v63, v28, v27, 16
    v_alignbit_b32 v64, v29, v28, 16
    v_pk_add_f16 v66, v57, v22
    v_pk_add_f16 v67, v58, v23
    v_pk_add_f16 v68, v59, v24
    v_pk_add_f16 v69, v60, v25
    v_pk_add_f16 v70, v61, v26
    v_pk_add_f16 v71, v62, v27
    v_pk_add_f16 v72, v63, v28
    v_pk_add_f16 v73, v64, v29
    v_pk_add_f16 v80, v66, v58
    v_pk_add_f16 v81, v67, v59
    v_pk_add_f16 v82, v68, v60
    v_pk_add_f16 v83, v69, v61
    v_pk_add_f16 v74, v67, v68
    v_pk_add_f16 v75, v68, v69
    v_pk_add_f16 v76, v69, v70
    v_pk_add_f16 v77, v70, v71
    v_pk_add_f16 v78, v71, v72
    v_pk_add_f16 v79, v72, v73
    s_waitcnt lgkmcnt(0)
    v_cmp_eq_u32 vcc, s84, v12
    s_cbranch_vccnz WJK_69
W_70:
    s_sleep 1
    ds_read_b32 v12, v4 offset:68
    s_sub_u32 s39, s39, 1
    s_cbranch_scc1 KS_ABORT
    s_waitcnt lgkmcnt(0)
    v_cmp_ne_u32 vcc, s84, v12
    s_cbranch_vccnz W_70
WJK_69:
    ds_write_b128 v11, v[80:83] offset:0
    v_pk_add_f16 v87, v22, v74
    v_pk_add_f16 v88, v23, v75
    v_pk_add_f16 v89, v24, v76
    v_pk_add_f16 v90, v25, v77
    v_pk_add_f16 v91, v26, v78
    ds_write_b128 v11, v[88:91] offset:3104
    v_pk_add_f16 v84, v70, v62
    v_pk_add_f16 v85, v71, v63
    v_pk_add_f16 v86, v72, v64
    v_pk_add_f16 v92, v74, v83
    v_pk_add_f16 v93, v75, v84
    v_pk_add_f16 v94, v76, v85
    v_pk_add_f16 v95, v77, v86
    ds_write_b128 v11, v[92:95] offset:6176
    v_pk_add_f16 v96, v87, v76
    v_pk_add_f16 v97, v88, v77
    v_pk_add_f16 v98, v89, v78
    v_pk_add_f16 v99, v90, v79
    ds_write_b128 v11, v[96:99] offset:8240
    ds_write_b8 v116, v5 offset:76
    ds_read_b32 v12, v4 offset:84
    v_alignbit_b32 v57, v34, v33, 16
    v_alignbit_b32 v58, v35, v34, 16
    v_alignbit_b32 v59, v36, v35, 16
    v_alignbit_b32 v60, v37, v36, 16
    v_alignbit_b32 v61, v38, v37, 16
    v_alignbit_b32 v62, v39, v38, 16
    v_alignbit_b32 v63, v40, v39, 16
    v_alignbit_b32 v64, v41, v40, 16
    v_pk_add_f16 v66, v57, v34
    v_pk_add_f16 v67, v58, v35
    v_pk_add_f16 v68, v59, v36
    v_pk_add_f16 v69, v60, v37
    v_pk_add_f16 v70, v61, v38
    v_pk_add_f16 v71, v62, v39
    v_pk_add_f16 v72, v63, v40
    v_pk_add_f16 v73, v64, v41
    v_pk_add_f16 v80, v66, v58
    v_pk_add_f16 v81, v67, v59
    v_pk_add_f16 v82, v68, v60
    v_pk_add_f16 v83, v69, v61
    v_pk_add_f16 v74, v67, v68
    v_pk_add_f16 v75, v68, v69
    v_pk_add_f16 v76, v69, v70
    v_pk_add_f16 v77, v70, v71
    v_pk_add_f16 v78, v71, v72
    v_pk_add_f16 v79, v72, v73
    s_waitcnt lgkmcnt(0)
    v_cmp_eq_u32 vcc, s84, v12
    s_cbranch_vccnz WJK_71
W_72:
    s_sleep 1
    ds_read_b32 v12, v4 offset:84
    s_sub_u32 s39, s39, 1
    s_cbranch_scc1 KS_ABORT
    s_waitcnt lgkmcnt(0)
    v_cmp_ne_u32 vcc, s84, v12
    s_cbranch_vccnz W_72
WJK_71:
    ds_write_b128 v11, v[80:83] offset:36672
    v_pk_add_f16 v87, v34, v74
    v_pk_add_f16 v88, v35, v75
    v_pk_add_f16 v89, v36, v76
    v_pk_add_f16 v90, v37, v77
    v_pk_add_f16 v91, v38, v78
    ds_write_b128 v11, v[88:91] offset:39776
    v_pk_add_f16 v84, v70, v62
    v_pk_add_f16 v85, v71, v63
    v_pk_add_f16 v86, v72, v64
    v_pk_add_f16 v92, v74, v83
    v_pk_add_f16 v93, v75, v84
    v_pk_add_f16 v94, v76, v85
    v_pk_add_f16 v95, v77, v86
    ds_write_b128 v11, v[92:95] offset:42848
    v_pk_add_f16 v96, v87, v76
    v_pk_add_f16 v97, v88, v77
    v_pk_add_f16 v98, v89, v78
    v_pk_add_f16 v99, v90, v79
    ds_write_b128 v11, v[96:99] offset:44912
    ds_write_b8 v116, v5 offset:92
    s_cmp_lt_u32 s41, 24
    s_cbranch_scc1 WJE_65
    ds_read_b32 v12, v4 offset:100
    v_alignbit_b32 v57, v46, v45, 16
    v_alignbit_b32 v58, v47, v46, 16
    v_alignbit_b32 v59, v48, v47, 16
    v_alignbit_b32 v60, v49, v48, 16
    v_alignbit_b32 v61, v50, v49, 16
    v_alignbit_b32 v62, v51, v50, 16
    v_alignbit_b32 v63, v52, v51, 16
    v_alignbit_b32 v64, v53, v52, 16
    v_pk_add_f16 v66, v57, v46
    v_pk_add_f16 v67, v58, v47
    v_pk_add_f16 v68, v59, v48
    v_pk_add_f16 v69, v60, v49
    v_pk_add_f16 v70, v61, v50
    v_pk_add_f16 v71, v62, v51
    v_pk_add_f16 v72, v63, v52
    v_pk_add_f16 v73, v64, v53
    v_pk_add_f16 v80, v66, v58
    v_pk_add_f16 v81, v67, v59
    v_pk_add_f16 v82, v68, v60
    v_pk_add_f16 v83, v69, v61
    v_pk_add_f16 v74, v67, v68
    v_pk_add_f16 v75, v68, v69
    v_pk_add_f16 v76, v69, v70
    v_pk_add_f16 v77, v70, v71
    v_pk_add_f16 v78, v71, v72
    v_pk_add_f16 v79, v72, v73
    s_waitcnt lgkmcnt(0)
    v_cmp_eq_u32 vcc, s84, v12
    s_cbranch_vccnz WJK_73
W_74:
    s_sleep 1
    ds_read_b32 v12, v4 offset:100
    s_sub_u32 s39, s39, 1
    s_cbranch_scc1 KS_ABORT
    s_waitcnt lgkmcnt(0)
    v_cmp_ne_u32 vcc, s84, v12
    s_cbranch_vccnz W_74
WJK_73:
    v_add_u32 v11, 73344, v11
    ds_write_b128 v11, v[80:83] offset:0
    v_pk_add_f16 v87, v46, v74
    v_pk_add_f16 v88, v47, v75
    v_pk_add_f16 v89, v48, v76
    v_pk_add_f16 v90, v49, v77
    v_pk_add_f16 v91, v50, v78
    ds_write_b128 v11, v[88:91] offset:3104
    v_pk_add_f16 v84, v70, v62
    v_pk_add_f16 v85, v71, v63
    v_pk_add_f16 v86, v72, v64
    v_pk_add_f16 v92, v74, v83
    v_pk_add_f16 v93, v75, v84
    v_pk_add_f16 v94, v76, v85
    v_pk_add_f16 v95, v77, v86
    ds_write_b128 v11, v[92:95] offset:6176
    v_pk_add_f16 v96, v87, v76
    v_pk_add_f16 v97, v88, v77
    v_pk_add_f16 v98, v89, v78
    v_pk_add_f16 v99, v90, v79
    ds_write_b128 v11, v[96:99] offset:8240
    ds_write_b8 v116, v5 offset:108
    s_branch WJE_65
WJ1_66:
    ds_read_b32 v12, v4 offset:68
    s_waitcnt lgkmcnt(7)
    v_alignbit_b32 v57, v22, v21, 16
    v_alignbit_b32 v58, v23, v22, 16
    v_alignbit_b32 v59, v24, v23, 16
    v_alignbit_b32 v60, v25, v24, 16
    v_alignbit_b32 v61, v26, v25, 16
    v_alignbit_b32 v62, v27, v26, 16
    v_alignbit_b32 v63, v28, v27, 16
    v_pk_add_f16 v66, v57, v22
    v_pk_add_f16 v67, v58, v23
    v_pk_add_f16 v68, v59, v24
    v_pk_add_f16 v69, v60, v25
    v_pk_add_f16 v70, v61, v26
    v_pk_add_f16 v71, v62, v27
    v_pk_add_f16 v72, v63, v28
    v_pk_add_f16 v80, v66, v58
    v_pk_add_f16 v81, v67, v59
    v_pk_add_f16 v82, v68, v60
    v_pk_add_f16 v83, v69, v61
    v_pk_add_f16 v75, v68, v69
    v_pk_add_f16 v76, v69, v70
    v_pk_add_f16 v77, v70, v71
    v_pk_add_f16 v78, v71, v72
    s_waitcnt lgkmcnt(0)
    v_cmp_eq_u32 vcc, s84, v12
    s_cbranch_vccnz WJK_75
W_76:
    s_sleep 1
    ds_read_b32 v12, v4 offset:68
    s_sub_u32 s39, s39, 1
    s_cbranch_scc1 KS_ABORT
    s_waitcnt lgkmcnt(0)
    v_cmp_ne_u32 vcc, s84, v12
    s_cbranch_vccnz W_76
WJK_75:
    ds_write_b128 v11, v[80:83] offset:0
    v_pk_add_f16 v88, v23, v75
    v_pk_add_f16 v89, v24, v76
    v_pk_add_f16 v90, v25, v77
    v_pk_add_f16 v91, v26, v78
    ds_write_b128 v11, v[88:91] offset:3104
    ds_write_b8 v116, v5 offset:76
    ds_read_b32 v12, v4 offset:84
    v_alignbit_b32 v57, v34, v33, 16
    v_alignbit_b32 v58, v35, v34, 16
    v_alignbit_b32 v59, v36, v35, 16
    v_alignbit_b32 v60, v37, v36, 16
    v_alignbit_b32 v61, v38, v37, 16
    v_alignbit_b32 v62, v39, v38, 16
    v_alignbit_b32 v63, v40, v39, 16
    v_pk_add_f16 v66, v57, v34
    v_pk_add_f16 v67, v58, v35
    v_pk_add_f16 v68, v59, v36
    v_pk_add_f16 v69, v60, v37
    v_pk_add_f16 v70, v61, v38
    v_pk_add_f16 v71, v62, v39
    v_pk_add_f16 v72, v63, v40
    v_pk_add_f16 v80, v66, v58
    v_pk_add_f16 v81, v67, v59
    v_pk_add_f16 v82, v68, v60
    v_pk_add_f16 v83, v69, v61
    v_pk_add_f16 v75, v68, v69
    v_pk_add_f16 v76, v69, v70
    v_pk_add_f16 v77, v70, v71
    v_pk_add_f16 v78, v71, v72
    s_waitcnt lgkmcnt(0)
    v_cmp_eq_u32 vcc, s84, v12
    s_cbranch_vccnz WJK_77
W_78:
    s_sleep 1
    ds_read_b32 v12, v4 offset:84
    s_sub_u32 s39, s39, 1
    s_cbranch_scc1 KS_ABORT
    s_waitcnt lgkmcnt(0)
    v_cmp_ne_u32 vcc, s84, v12
    s_cbranch_vccnz W_78
WJK_77:
    ds_write_b128 v11, v[80:83] offset:36672
    v_pk_add_f16 v88, v35, v75
    v_pk_add_f16 v89, v36, v76
    v_pk_add_f16 v90, v37, v77
    v_pk_add_f16 v91, v38, v78
    ds_write_b128 v11, v[88:91] offset:39776
    ds_write_b8 v116, v5 offset:92
    s_cmp_lt_u32 s41, 24
    s_cbranch_scc1 WJE_65
    ds_read_b32 v12, v4 offset:100
    v_alignbit_b32 v57, v46, v45, 16
    v_alignbit_b32 v58, v47, v46, 16
    v_alignbit_b32 v59, v48, v47, 16
    v_alignbit_b32 v60, v49, v48, 16
    v_alignbit_b32 v61, v50, v49, 16
    v_alignbit_b32 v62, v51, v50, 16
    v_alignbit_b32 v63, v52, v51, 16
    v_pk_add_f16 v66, v57, v46
    v_pk_add_f16 v67, v58, v47
    v_pk_add_f16 v68, v59, v48
    v_pk_add_f16 v69, v60, v49
    v_pk_add_f16 v70, v61, v50
    v_pk_add_f16 v71, v62, v51
    v_pk_add_f16 v72, v63, v52
    v_pk_add_f16 v80, v66, v58
    v_pk_add_f16 v81, v67, v59
    v_pk_add_f16 v82, v68, v60
    v_pk_add_f16 v83, v69, v61
    v_pk_add_f16 v75, v68, v69
    v_pk_add_f16 v76, v69, v70
    v_pk_add_f16 v77, v70, v71
    v_pk_add_f16 v78, v71, v72
    s_waitcnt lgkmcnt(0)
    v_cmp_eq_u32 vcc, s84, v12
    s_cbranch_vccnz WJK_79
W_80:
    s_sleep 1
    ds_read_b32 v12, v4 offset:100
    s_sub_u32 s39, s39, 1
    s_cbranch_scc1 KS_ABORT
    s_waitcnt lgkmcnt(0)
    v_cmp_ne_u32 vcc, s84, v12
    s_cbranch_vccnz W_80
WJK_79:
    v_add_u32 v11, 73344, v11
    ds_write_b128 v11, v[80:83] offset:0
    v_pk_add_f16 v88, v47, v75
    v_pk_add_f16 v89, v48, v76
    v_pk_add_f16 v90, v49, v77
    v_pk_add_f16 v91, v50, v78
    ds_write_b128 v11, v[88:91] offset:3104
    ds_write_b8 v116, v5 offset:108
    s_branch WJE_65
WJ2_67:
    ds_write_b8 v116, v5 offset:76
    ds_write_b8 v116, v5 offset:92
    ds_write_b8 v116, v5 offset:108
    s_sub_u32 s94, s41, 18
    s_cmp_ge_u32 s94, 14
    s_cbranch_scc1 WJE_65
    v_mul_u32_u24 v100, 57, v1
    v_lshrrev_b32 v100, 9, v100
    v_mul_u32_u24 v101, 9, v100
    v_sub_u32 v101, v1, v101
    v_mul_u32_u24 v100, 9216, v100
    v_lshl_add_u32 v100, v101, 7, v100
W_81:
    s_sleep 1
    ds_read_b32 v12, v4 offset:16
    s_sub_u32 s39, s39, 1
    s_cbranch_scc1 KS_ABORT
    s_waitcnt lgkmcnt(0)
    v_cmp_ne_u32 vcc, s84, v12
    s_cbranch_vccnz W_81
    s_bitcmp1_b32 s94, 0
    s_cselect_b32 s72, s28, s26
    s_cselect_b32 s73, s29, s27
    s_mov_b32 s74, 0x510000
    s_mov_b32 s75, 0x20000
    s_lshr_b32 s95, s94, 1
    s_mul_i32 s95, s95, 64512
    s_mul_i32 s96, s40, 1152
    s_add_u32 s95, s95, s96
    s_add_u32 s96, s95, 3870720
    buffer_load_dword v102, v100, s[72:75], s96 offen
    s_add_u32 s96, s95, 4322304
    buffer_load_dword v102, v100, s[72:75], s96 offen
    s_add_u32 s96, s95, 4773888
    buffer_load_dword v102, v100, s[72:75], s96 offen
    s_cmp_ge_u32 s94, 4
    s_cbranch_scc1 KS_PF2D
    s_add_u32 s96, s95, 5225472
    buffer_load_dword v102, v100, s[72:75], s96 offen
KS_PF2D:
    s_sub_u32 s94, 13, s94
    s_mov_b32 s72, s30
    s_mov_b32 s73, s31
    s_mov_b32 s74, 0x510000
    s_mov_b32 s75, 0x20000
    s_lshl_b32 s95, s94, 13
    s_mul_i32 s96, s40, 663552
    s_add_u32 s95, s95, s96
    v_lshlrev_b32 v100, 7, v1
    s_add_u32 s96, s95, 0
    buffer_load_dword v120, v100, s[72:75], s96 offen
    s_add_u32 s96, s95, 114688
    buffer_load_dword v120, v100, s[72:75], s96 offen
    s_add_u32 s96, s95, 229376
    buffer_load_dword v120, v100, s[72:75], s96 offen
WJE_65:
    s_setprio 0
    s_lshr_b32 s92, s90, 6
    s_lshl_b32 s92, s92, 9
    s_bfe_u32 s93, s90, 0x20004
    s_lshl_b32 s93, s93, 6
    s_add_u32 s92, s92, s93
    s_and_b32 s93, s90, 3
    s_lshl_b32 s93, s93, 4
    s_add_u32 s92, s92, s93
    s_and_b32 s93, s90, 12
    s_add_u32 s92, s92, s93
    s_lshr_b32 s93, s38, 1
    s_lshl_b32 s93, s93, 8
    s_add_u32 s92, s92, s93
    s_and_b32 s93, s38, 1
    s_lshl_b32 s93, s93, 1
    s_add_u32 s92, s92, s93
    v_lshrrev_b32 v113, 5, v1
    v_and_b32 v114, 31, v1
    v_add_u32 v112, s92, v113
    v_mul_u32_u24 v115, 1152, v112
    v_lshl_add_u32 v8, v114, 2, v115
    v_lshl_add_u32 v115, v114, 4, v115
    v_lshlrev_b32 v7, 2, v114
    v_lshlrev_b32 v6, 4, v114
    v_bfe_u32 v111, v1, 3, 1
    v_add_u32 v111, s92, v111
    v_mul_u32_u24 v111, 1152, v111
    v_and_b32 v9, 7, v1
    v_lshl_add_u32 v111, v9, 4, v111
    s_mov_b32 s64, s4
    s_mov_b32 s65, s5
    s_mov_b32 s66, 0x240000
    s_mov_b32 s67, 0x20000
    s_mov_b32 s68, s24
    s_mov_b32 s69, s25
    s_mov_b32 s70, 0x480
    s_mov_b32 s71, 0x20000
    buffer_load_dwordx4 v[10:13], v115, s[64:67], 0 offen
    buffer_load_dwordx4 v[14:17], v115, s[64:67], 0 offen offset:512
    buffer_load_dword v18, v8, s[64:67], 0 offen offset:1024
    buffer_load_dwordx4 v[50:53], v6, s[68:71], 0 offen
    buffer_load_dwordx4 v[54:57], v6, s[68:71], 0 offen offset:512
    buffer_load_dword v58, v7, s[68:71], 0 offen offset:1024
    s_cmp_lt_u32 s41, 18
    s_cbranch_scc1 KS_L4
    s_mul_i32 s92, s40, 14
    s_add_u32 s92, s92, s41
    s_mul_i32 s92, s92, 23744
    s_add_u32 s92, s92, 0x7e7a80
    s_add_u32 s68, s36, s92
    s_addc_u32 s69, s37, 0
    s_mov_b32 s70, 23744
    s_mov_b32 s71, 0x20000
    v_lshlrev_b32 v6, 4, v0
    v_mov_b32 v60, -1
    v_mov_b32 v61, -1
    v_mov_b32 v62, -1
    v_mov_b32 v63, -1
    s_movk_i32 s92, 0
    buffer_store_dwordx4 v[60:63], v6, s[68:71], s92 offen sc1
    s_movk_i32 s92, 4096
    buffer_store_dwordx4 v[60:63], v6, s[68:71], s92 offen sc1
    s_movk_i32 s92, 8192
    buffer_store_dwordx4 v[60:63], v6, s[68:71], s92 offen sc1
    s_movk_i32 s92, 12288
    buffer_store_dwordx4 v[60:63], v6, s[68:71], s92 offen sc1
    s_movk_i32 s92, 16384
    buffer_store_dwordx4 v[60:63], v6, s[68:71], s92 offen sc1
    s_movk_i32 s92, 20480
    buffer_store_dwordx4 v[60:63], v6, s[68:71], s92 offen sc1
KS_L4:
    s_add_u32 s64, s36, 0x600000
    s_addc_u32 s65, s37, 0
    s_mov_b32 s66, 0x240000
    s_mov_b32 s67, 0x20000
    s_mov_b32 s68, s32
    s_mov_b32 s69, s33
    s_mov_b32 s70, 0x240000
    s_mov_b32 s71, 0x20000
    s_add_u32 s72, s36, 0x300000
    s_addc_u32 s73, s37, 0
    s_mov_b32 s74, 0x240000
    s_mov_b32 s75, 0x20000
    s_add_u32 s76, s36, 0x840000
    s_addc_u32 s77, s37, 0
    s_mov_b32 s78, 0x3000
    s_mov_b32 s79, 0x20000
    s_not_b32 s93, s90
    v_xor_b32 v8, s93, v0
    v_lshrrev_b32 v6, 1, v0
    v_lshlrev_b32 v6, 6, v6
    v_and_b32 v8, 1, v8
    v_lshl_add_u32 v6, v8, 4, v6
    s_lshr_b32 s92, s90, 2
    s_lshl_b32 s92, s92, 15
    s_and_b32 s93, s90, 1
    s_lshl_b32 s93, s93, 14
    s_add_u32 s92, s92, s93
    s_and_b32 s93, s90, 2
    s_lshl_b32 s93, s93, 4
    s_add_u32 s92, s92, s93
    s_lshr_b32 s94, s90, 2
    s_lshl_b32 s94, s94, 12
    s_and_b32 s93, s90, 3
    s_lshl_b32 s93, s93, 4
    s_add_u32 s94, s94, s93
    s_lshl_b32 s93, s38, 10
    s_add_u32 s94, s94, s93
    s_add_u32 s94, s94, 0x200000
    s_add_u32 s93, s92, 8192
    v_lshlrev_b32 v9, 6, v2
    s_mul_i32 s95, s38, 2304
    s_add_u32 s95, s95, 17088
    v_lshl_add_u32 v117, v114, 5, s95
    v_lshl_add_u32 v110, v114, 3, s95
    s_lshl_b32 s95, s38, 9
    s_add_u32 s95, s95, 26368
    v_lshl_add_u32 v108, v1, 2, s95
    v_lshl_add_u32 v109, v1, 4, s95
    s_mov_b32 s95, 0x02020202
    v_mul_lo_u32 v118, v113, s95
    v_add_u32 v118, 0x05040100, v118
    v_lshlrev_b32 v8, 2, v0
    v_add_u32 v8, 17088, v8
    s_lshl_b32 s95, s38, 6
    s_add_u32 s95, s95, 19136
    v_lshl_add_u32 v119, v2, 2, s95
    s_waitcnt vmcnt(0)
    v_lshlrev_b32 v20, 16, v10
    v_and_b32 v21, 0xffff0000, v10
    v_lshlrev_b32 v22, 16, v11
    v_and_b32 v23, 0xffff0000, v11
    v_lshlrev_b32 v24, 16, v12
    v_and_b32 v25, 0xffff0000, v12
    v_lshlrev_b32 v26, 16, v13
    v_and_b32 v27, 0xffff0000, v13
    v_lshlrev_b32 v28, 16, v14
    v_and_b32 v29, 0xffff0000, v14
    v_lshlrev_b32 v30, 16, v15
    v_and_b32 v31, 0xffff0000, v15
    v_lshlrev_b32 v32, 16, v16
    v_and_b32 v33, 0xffff0000, v16
    v_lshlrev_b32 v34, 16, v17
    v_and_b32 v35, 0xffff0000, v17
    v_lshlrev_b32 v36, 16, v18
    v_and_b32 v37, 0xffff0000, v18
W_82:
    s_sleep 1
    ds_read_b32 v60, v4 offset:52
    s_sub_u32 s39, s39, 1
    s_cbranch_scc1 KS_ABORT
    s_waitcnt lgkmcnt(0)
    v_cmp_ne_u32 vcc, s84, v60
    s_cbranch_vccnz W_82
    s_setprio 3
    s_sub_u32 s97, s41, 18
    s_cmp_ge_u32 s97, 6
    s_cbranch_scc1 KS_PF3E
    s_cmp_lg_u32 s38, 2
    s_cbranch_scc1 KS_PF3E
    s_mov_b32 s80, s30
    s_mov_b32 s81, s31
    s_mov_b32 s82, 0x510000
    s_mov_b32 s83, 0x20000
    s_lshl_b32 s95, s97, 13
    s_mul_i32 s96, s40, 663552
    s_add_u32 s95, s95, s96
    v_lshlrev_b32 v100, 7, v1
    s_add_u32 s96, s95, 344064
    buffer_load_dword v120, v100, s[80:83], s96 offen
    s_add_u32 s96, s95, 393216
    buffer_load_dword v120, v100, s[80:83], s96 offen
    s_add_u32 s96, s95, 442368
    buffer_load_dword v120, v100, s[80:83], s96 offen
    s_add_u32 s96, s95, 491520
    buffer_load_dword v120, v100, s[80:83], s96 offen
    s_add_u32 s96, s95, 540672
    buffer_load_dword v120, v100, s[80:83], s96 offen
    s_add_u32 s96, s95, 589824
    buffer_load_dword v120, v100, s[80:83], s96 offen
    s_cmp_ge_u32 s97, 3
    s_cbranch_scc1 KS_PF3E
    s_add_u32 s96, s95, 638976
    buffer_load_dword v120, v100, s[80:83], s96 offen
KS_PF3E:
    s_branch ZPE_84
ZP_83:
    s_sleep 1
ZPE_84:
    buffer_load_dwordx4 v[68:71], v4, s[64:67], s94 offen sc1
    s_sub_u32 s39, s39, 1
    s_cbranch_scc1 KS_ABORT
    s_waitcnt vmcnt(0)
    v_max3_u32 v44, v68, v69, v70
    v_max_u32 v44, v44, v71
    v_cmp_eq_u32 vcc, -1, v44
    s_cbranch_vccnz ZP_83
    s_branch ZPE_86
ZP_85:
    s_sleep 1
ZPE_86:
    buffer_load_dwordx4 v[60:63], v6, s[64:67], s92 offen sc1
    buffer_load_dwordx4 v[64:67], v6, s[64:67], s93 offen sc1
    buffer_load_dwordx4 v[68:71], v9, s[64:67], s94 offen sc1
    s_sub_u32 s39, s39, 1
    s_cbranch_scc1 KS_ABORT
    s_waitcnt vmcnt(0)
    v_max3_u32 v44, v60, v61, v62
    v_max3_u32 v44, v44, v63, v64
    v_max3_u32 v44, v44, v65, v66
    v_max3_u32 v44, v44, v67, v68
    v_max3_u32 v44, v44, v69, v70
    v_max_u32 v44, v44, v71
    v_cmp_eq_u32 vcc, -1, v44
    s_cbranch_vccnz ZP_85
    ds_write2st64_b32 v8, v60, v61 offset0:0 offset1:9
    ds_write2st64_b32 v8, v62, v63 offset0:18 offset1:27
    ds_write2st64_b32 v8, v64, v65 offset0:4 offset1:13
    ds_write2st64_b32 v8, v66, v67 offset0:22 offset1:31
    ds_write2st64_b32 v119, v68, v69 offset0:0 offset1:9
    ds_write2st64_b32 v119, v70, v71 offset0:18 offset1:27
    ds_write_b8 v116, v5 offset:20
W_87:
    ds_read_b32 v60, v4 offset:20
    s_sub_u32 s39, s39, 1
    s_cbranch_scc1 KS_ABORT
    s_waitcnt lgkmcnt(0)
    v_cmp_ne_u32 vcc, s84, v60
    s_cbranch_vccnz W_87
    ds_read_b128 v[60:63], v117 offset:0
    ds_read_b128 v[64:67], v117 offset:16
    ds_read_b128 v[68:71], v117 offset:1024
    ds_read_b128 v[72:75], v117 offset:1040
    ds_read_b64 v[76:77], v110 offset:2048
    s_waitcnt lgkmcnt(4)
    v_perm_b32 v44, v61, v60, v118
    v_lshlrev_b32 v46, 16, v44
    v_and_b32 v47, 0xffff0000, v44
    v_pk_add_f32 v[46:47], v[46:47], v[20:21]
    v_cvt_pk_bf16_f32 v44, v46, v47
    v_lshlrev_b32 v20, 16, v44
    v_and_b32 v21, 0xffff0000, v44
    v_perm_b32 v44, v63, v62, v118
    v_lshlrev_b32 v46, 16, v44
    v_and_b32 v47, 0xffff0000, v44
    v_pk_add_f32 v[46:47], v[46:47], v[22:23]
    v_cvt_pk_bf16_f32 v44, v46, v47
    v_lshlrev_b32 v22, 16, v44
    v_and_b32 v23, 0xffff0000, v44
    s_waitcnt lgkmcnt(3)
    v_perm_b32 v44, v65, v64, v118
    v_lshlrev_b32 v46, 16, v44
    v_and_b32 v47, 0xffff0000, v44
    v_pk_add_f32 v[46:47], v[46:47], v[24:25]
    v_cvt_pk_bf16_f32 v44, v46, v47
    v_lshlrev_b32 v24, 16, v44
    v_and_b32 v25, 0xffff0000, v44
    v_perm_b32 v44, v67, v66, v118
    v_lshlrev_b32 v46, 16, v44
    v_and_b32 v47, 0xffff0000, v44
    v_pk_add_f32 v[46:47], v[46:47], v[26:27]
    v_cvt_pk_bf16_f32 v44, v46, v47
    v_lshlrev_b32 v26, 16, v44
    v_and_b32 v27, 0xffff0000, v44
    s_waitcnt lgkmcnt(2)
    v_perm_b32 v44, v69, v68, v118
    v_lshlrev_b32 v46, 16, v44
    v_and_b32 v47, 0xffff0000, v44
    v_pk_add_f32 v[46:47], v[46:47], v[28:29]
    v_cvt_pk_bf16_f32 v44, v46, v47
    v_lshlrev_b32 v28, 16, v44
    v_and_b32 v29, 0xffff0000, v44
    v_perm_b32 v44, v71, v70, v118
    v_lshlrev_b32 v46, 16, v44
    v_and_b32 v47, 0xffff0000, v44
    v_pk_add_f32 v[46:47], v[46:47], v[30:31]
    v_cvt_pk_bf16_f32 v44, v46, v47
    v_lshlrev_b32 v30, 16, v44
    v_and_b32 v31, 0xffff0000, v44
    s_waitcnt lgkmcnt(1)
    v_perm_b32 v44, v73, v72, v118
    v_lshlrev_b32 v46, 16, v44
    v_and_b32 v47, 0xffff0000, v44
    v_pk_add_f32 v[46:47], v[46:47], v[32:33]
    v_cvt_pk_bf16_f32 v44, v46, v47
    v_lshlrev_b32 v32, 16, v44
    v_and_b32 v33, 0xffff0000, v44
    v_perm_b32 v44, v75, v74, v118
    v_lshlrev_b32 v46, 16, v44
    v_and_b32 v47, 0xffff0000, v44
    v_pk_add_f32 v[46:47], v[46:47], v[34:35]
    v_cvt_pk_bf16_f32 v44, v46, v47
    v_lshlrev_b32 v34, 16, v44
    v_and_b32 v35, 0xffff0000, v44
    s_waitcnt lgkmcnt(0)
    v_perm_b32 v44, v77, v76, v118
    v_lshlrev_b32 v46, 16, v44
    v_and_b32 v47, 0xffff0000, v44
    v_pk_add_f32 v[46:47], v[46:47], v[36:37]
    v_cvt_pk_bf16_f32 v44, v46, v47
    v_lshlrev_b32 v36, 16, v44
    v_and_b32 v37, 0xffff0000, v44
    v_pk_add_f32 v[44:45], v[20:21], v[22:23]
    v_pk_add_f32 v[46:47], v[24:25], v[26:27]
    v_pk_add_f32 v[44:45], v[44:45], v[28:29]
    v_pk_add_f32 v[46:47], v[46:47], v[30:31]
    v_pk_add_f32 v[44:45], v[44:45], v[32:33]
    v_pk_add_f32 v[46:47], v[46:47], v[34:35]
    v_pk_add_f32 v[44:45], v[44:45], v[36:37]
    v_pk_add_f32 v[44:45], v[44:45], v[46:47]
    v_add_f32 v44, v44, v45
    s_nop 1
    v_add_f32_dpp v44, v44, v44 row_ror:8 row_mask:0xf bank_mask:0xf
    s_nop 1
    v_add_f32_dpp v44, v44, v44 row_ror:4 row_mask:0xf bank_mask:0xf
    s_nop 1
    v_add_f32_dpp v44, v44, v44 row_ror:2 row_mask:0xf bank_mask:0xf
    s_nop 1
    v_add_f32_dpp v44, v44, v44 row_ror:1 row_mask:0xf bank_mask:0xf
    v_mov_b32 v46, v44
    s_nop 1
    v_permlane16_swap_b32 v44, v46
    v_add_f32 v44, v44, v46
    v_mul_f32 v48, 0x3ae38e39, v44
    v_mov_b32 v49, v48
    v_cvt_pk_bf16_f32 v40, v48, v48
    v_and_b32 v40, 0xffff0000, v40
    v_mov_b32 v41, v40
    v_pk_add_f32 v[42:43], v[20:21], v[48:49] neg_lo:[0,1] neg_hi:[0,1]
    v_pk_mul_f32 v[44:45], v[42:43], v[42:43]
    v_pk_add_f32 v[42:43], v[22:23], v[48:49] neg_lo:[0,1] neg_hi:[0,1]
    v_pk_mul_f32 v[46:47], v[42:43], v[42:43]
    v_pk_add_f32 v[42:43], v[24:25], v[48:49] neg_lo:[0,1] neg_hi:[0,1]
    v_pk_fma_f32 v[44:45], v[42:43], v[42:43], v[44:45]
    v_pk_add_f32 v[42:43], v[26:27], v[48:49] neg_lo:[0,1] neg_hi:[0,1]
    v_pk_fma_f32 v[46:47], v[42:43], v[42:43], v[46:47]
    v_pk_add_f32 v[42:43], v[28:29], v[48:49] neg_lo:[0,1] neg_hi:[0,1]
    v_pk_fma_f32 v[44:45], v[42:43], v[42:43], v[44:45]
    v_pk_add_f32 v[42:43], v[30:31], v[48:49] neg_lo:[0,1] neg_hi:[0,1]
    v_pk_fma_f32 v[46:47], v[42:43], v[42:43], v[46:47]
    v_pk_add_f32 v[42:43], v[32:33], v[48:49] neg_lo:[0,1] neg_hi:[0,1]
    v_pk_fma_f32 v[44:45], v[42:43], v[42:43], v[44:45]
    v_pk_add_f32 v[42:43], v[34:35], v[48:49] neg_lo:[0,1] neg_hi:[0,1]
    v_pk_fma_f32 v[46:47], v[42:43], v[42:43], v[46:47]
    v_pk_add_f32 v[42:43], v[36:37], v[48:49] neg_lo:[0,1] neg_hi:[0,1]
    v_pk_fma_f32 v[44:45], v[42:43], v[42:43], v[44:45]
    v_pk_add_f32 v[44:45], v[44:45], v[46:47]
    v_add_f32 v44, v44, v45
    s_nop 1
    v_add_f32_dpp v44, v44, v44 row_ror:8 row_mask:0xf bank_mask:0xf
    s_nop 1
    v_add_f32_dpp v44, v44, v44 row_ror:4 row_mask:0xf bank_mask:0xf
    s_nop 1
    v_add_f32_dpp v44, v44, v44 row_ror:2 row_mask:0xf bank_mask:0xf
    s_nop 1
    v_add_f32_dpp v44, v44, v44 row_ror:1 row_mask:0xf bank_mask:0xf
    v_mov_b32 v46, v44
    s_nop 1
    v_permlane16_swap_b32 v44, v46
    v_add_f32 v44, v44, v46
    v_mul_f32 v44, 0x3ae38e39, v44
    v_cvt_pk_bf16_f32 v44, v44, v44
    v_and_b32 v44, 0xffff0000, v44
    v_add_f32 v44, 0x3727c5ac, v44
    v_cvt_pk_bf16_f32 v44, v44, v44
    v_and_b32 v44, 0xffff0000, v44
    v_sqrt_f32 v44, v44
    s_nop 0
    v_cvt_pk_bf16_f32 v44, v44, v44
    v_and_b32 v44, 0xffff0000, v44
    v_rcp_f32 v42, v44
    s_nop 0
    v_mov_b32 v43, v42
    v_mov_b32 v60, 0
    v_mov_b32 v61, 0
    v_pk_add_f32 v[44:45], v[20:21], v[40:41] neg_lo:[0,1] neg_hi:[0,1]
    v_cvt_pk_bf16_f32 v10, v44, v45
    v_lshlrev_b32 v44, 16, v10
    v_and_b32 v45, 0xffff0000, v10
    v_pk_mul_f32 v[44:45], v[44:45], v[42:43]
    v_cvt_pk_bf16_f32 v10, v44, v45
    v_lshlrev_b32 v44, 16, v10
    v_and_b32 v45, 0xffff0000, v10
    v_lshlrev_b32 v46, 16, v50
    v_and_b32 v47, 0xffff0000, v50
    v_pk_fma_f32 v[60:61], v[44:45], v[46:47], v[60:61]
    v_pk_add_f32 v[20:21], v[44:45], v[20:21]
    v_pk_add_f32 v[44:45], v[22:23], v[40:41] neg_lo:[0,1] neg_hi:[0,1]
    v_cvt_pk_bf16_f32 v11, v44, v45
    v_lshlrev_b32 v44, 16, v11
    v_and_b32 v45, 0xffff0000, v11
    v_pk_mul_f32 v[44:45], v[44:45], v[42:43]
    v_cvt_pk_bf16_f32 v11, v44, v45
    v_lshlrev_b32 v44, 16, v11
    v_and_b32 v45, 0xffff0000, v11
    v_lshlrev_b32 v46, 16, v51
    v_and_b32 v47, 0xffff0000, v51
    v_pk_fma_f32 v[60:61], v[44:45], v[46:47], v[60:61]
    v_pk_add_f32 v[22:23], v[44:45], v[22:23]
    v_pk_add_f32 v[44:45], v[24:25], v[40:41] neg_lo:[0,1] neg_hi:[0,1]
    v_cvt_pk_bf16_f32 v12, v44, v45
    v_lshlrev_b32 v44, 16, v12
    v_and_b32 v45, 0xffff0000, v12
    v_pk_mul_f32 v[44:45], v[44:45], v[42:43]
    v_cvt_pk_bf16_f32 v12, v44, v45
    v_lshlrev_b32 v44, 16, v12
    v_and_b32 v45, 0xffff0000, v12
    v_lshlrev_b32 v46, 16, v52
    v_and_b32 v47, 0xffff0000, v52
    v_pk_fma_f32 v[60:61], v[44:45], v[46:47], v[60:61]
    v_pk_add_f32 v[24:25], v[44:45], v[24:25]
    v_pk_add_f32 v[44:45], v[26:27], v[40:41] neg_lo:[0,1] neg_hi:[0,1]
    v_cvt_pk_bf16_f32 v13, v44, v45
    v_lshlrev_b32 v44, 16, v13
    v_and_b32 v45, 0xffff0000, v13
    v_pk_mul_f32 v[44:45], v[44:45], v[42:43]
    v_cvt_pk_bf16_f32 v13, v44, v45
    v_lshlrev_b32 v44, 16, v13
    v_and_b32 v45, 0xffff0000, v13
    v_lshlrev_b32 v46, 16, v53
    v_and_b32 v47, 0xffff0000, v53
    v_pk_fma_f32 v[60:61], v[44:45], v[46:47], v[60:61]
    v_pk_add_f32 v[26:27], v[44:45], v[26:27]
    v_pk_add_f32 v[44:45], v[28:29], v[40:41] neg_lo:[0,1] neg_hi:[0,1]
    v_cvt_pk_bf16_f32 v14, v44, v45
    v_lshlrev_b32 v44, 16, v14
    v_and_b32 v45, 0xffff0000, v14
    v_pk_mul_f32 v[44:45], v[44:45], v[42:43]
    v_cvt_pk_bf16_f32 v14, v44, v45
    v_lshlrev_b32 v44, 16, v14
    v_and_b32 v45, 0xffff0000, v14
    v_lshlrev_b32 v46, 16, v54
    v_and_b32 v47, 0xffff0000, v54
    v_pk_fma_f32 v[60:61], v[44:45], v[46:47], v[60:61]
    v_pk_add_f32 v[28:29], v[44:45], v[28:29]
    v_pk_add_f32 v[44:45], v[30:31], v[40:41] neg_lo:[0,1] neg_hi:[0,1]
    v_cvt_pk_bf16_f32 v15, v44, v45
    v_lshlrev_b32 v44, 16, v15
    v_and_b32 v45, 0xffff0000, v15
    v_pk_mul_f32 v[44:45], v[44:45], v[42:43]
    v_cvt_pk_bf16_f32 v15, v44, v45
    v_lshlrev_b32 v44, 16, v15
    v_and_b32 v45, 0xffff0000, v15
    v_lshlrev_b32 v46, 16, v55
    v_and_b32 v47, 0xffff0000, v55
    v_pk_fma_f32 v[60:61], v[44:45], v[46:47], v[60:61]
    v_pk_add_f32 v[30:31], v[44:45], v[30:31]
    v_pk_add_f32 v[44:45], v[32:33], v[40:41] neg_lo:[0,1] neg_hi:[0,1]
    v_cvt_pk_bf16_f32 v16, v44, v45
    v_lshlrev_b32 v44, 16, v16
    v_and_b32 v45, 0xffff0000, v16
    v_pk_mul_f32 v[44:45], v[44:45], v[42:43]
    v_cvt_pk_bf16_f32 v16, v44, v45
    v_lshlrev_b32 v44, 16, v16
    v_and_b32 v45, 0xffff0000, v16
    v_lshlrev_b32 v46, 16, v56
    v_and_b32 v47, 0xffff0000, v56
    v_pk_fma_f32 v[60:61], v[44:45], v[46:47], v[60:61]
    v_pk_add_f32 v[32:33], v[44:45], v[32:33]
    v_pk_add_f32 v[44:45], v[34:35], v[40:41] neg_lo:[0,1] neg_hi:[0,1]
    v_cvt_pk_bf16_f32 v17, v44, v45
    v_lshlrev_b32 v44, 16, v17
    v_and_b32 v45, 0xffff0000, v17
    v_pk_mul_f32 v[44:45], v[44:45], v[42:43]
    v_cvt_pk_bf16_f32 v17, v44, v45
    v_lshlrev_b32 v44, 16, v17
    v_and_b32 v45, 0xffff0000, v17
    v_lshlrev_b32 v46, 16, v57
    v_and_b32 v47, 0xffff0000, v57
    v_pk_fma_f32 v[60:61], v[44:45], v[46:47], v[60:61]
    v_pk_add_f32 v[34:35], v[44:45], v[34:35]
    v_pk_add_f32 v[44:45], v[36:37], v[40:41] neg_lo:[0,1] neg_hi:[0,1]
    v_cvt_pk_bf16_f32 v18, v44, v45
    v_lshlrev_b32 v44, 16, v18
    v_and_b32 v45, 0xffff0000, v18
    v_pk_mul_f32 v[44:45], v[44:45], v[42:43]
    v_cvt_pk_bf16_f32 v18, v44, v45
    v_lshlrev_b32 v44, 16, v18
    v_and_b32 v45, 0xffff0000, v18
    v_lshlrev_b32 v46, 16, v58
    v_and_b32 v47, 0xffff0000, v58
    v_pk_fma_f32 v[60:61], v[44:45], v[46:47], v[60:61]
    v_pk_add_f32 v[36:37], v[44:45], v[36:37]
    v_add_f32 v60, v60, v61
    s_nop 1
    v_add_f32_dpp v60, v60, v60 row_ror:8 row_mask:0xf bank_mask:0xf
    s_nop 1
    v_add_f32_dpp v60, v60, v60 row_ror:4 row_mask:0xf bank_mask:0xf
    s_nop 1
    v_add_f32_dpp v60, v60, v60 row_ror:2 row_mask:0xf bank_mask:0xf
    s_nop 1
    v_add_f32_dpp v60, v60, v60 row_ror:1 row_mask:0xf bank_mask:0xf
    v_mov_b32 v61, v60
    s_nop 1
    v_permlane16_swap_b32 v60, v61
    v_add_f32 v60, v60, v61
    v_cvt_pk_bf16_f32 v60, v60, v60
    v_ashrrev_i32 v61, 31, v60
    v_or_b32 v61, 0x80000000, v61
    v_xor_b32 v60, v60, v61
    v_and_b32 v60, 0xffff0000, v60
    v_sub_u32 v62, 0x87ff, v112
    v_or_b32 v60, v60, v62
    v_lshl_add_u32 v61, v116, 1, v113
    v_lshlrev_b32 v61, 2, v61
    s_mov_b32 exec_lo, 1
    s_mov_b32 exec_hi, 1
    ds_write_b32 v61, v60 offset:800
    s_mov_b64 exec, 1
    ds_add_rtn_u32 v62, v4, v5 offset:12
    s_mov_b64 exec, 3
    v_lshlrev_b32 v61, 4, v114
    s_lshl_b32 s92, s90, 5
    ds_read_b128 v[64:67], v61 offset:800
    s_waitcnt lgkmcnt(1)
    v_readfirstlane_b32 s93, v62
    s_cmp_lg_u32 s93, 3
    s_cbranch_scc1 KS_NOKEY
    s_waitcnt lgkmcnt(0)
    buffer_store_dwordx4 v[64:67], v61, s[76:79], s92 offen sc1
KS_NOKEY:
    s_mov_b64 exec, -1
    v_cvt_pk_bf16_f32 v58, v36, v37
    ds_write_b32 v108, v18
    ds_write_b32 v108, v58 offset:256
    ds_read_b128 v[64:67], v109
    buffer_store_dwordx4 v[10:13], v115, s[72:75], 0 offen sc1
    buffer_store_dwordx4 v[14:17], v115, s[72:75], 0 offen offset:512 sc1
    v_cvt_pk_bf16_f32 v50, v20, v21
    v_cvt_pk_bf16_f32 v51, v22, v23
    v_cvt_pk_bf16_f32 v52, v24, v25
    v_cvt_pk_bf16_f32 v53, v26, v27
    v_cvt_pk_bf16_f32 v54, v28, v29
    v_cvt_pk_bf16_f32 v55, v30, v31
    v_cvt_pk_bf16_f32 v56, v32, v33
    v_cvt_pk_bf16_f32 v57, v34, v35
    s_mov_b64 exec, 0xffff
    s_waitcnt lgkmcnt(0)
    buffer_store_dwordx4 v[64:67], v111, s[72:75], 0 offen offset:1024 sc1
    s_mov_b64 exec, 0xffff0000
    buffer_store_dwordx4 v[64:67], v111, s[68:71], 0 offen offset:1024 sc1
    s_mov_b64 exec, -1
    buffer_store_dwordx4 v[50:53], v115, s[68:71], 0 offen sc1
    buffer_store_dwordx4 v[54:57], v115, s[68:71], 0 offen offset:512 sc1
    s_cmp_lg_u32 s93, 3
    s_cbranch_scc1 KS_NOKEY2
    s_waitcnt vmcnt(6)
    ds_write_b32 v4, v5 offset:24
KS_NOKEY2:
    s_waitcnt vmcnt(0)
    s_mov_b64 exec, 1
    ds_add_rtn_u32 v62, v4, v5 offset:176
    s_waitcnt lgkmcnt(0)
    v_cmp_eq_u32 vcc, 3, v62
    s_and_b64 exec, exec, vcc
    s_cbranch_execz KS_NOF2
    s_lshl_b32 s92, s2, 4
    s_add_u32 s92, s92, 8192
    buffer_store_dword v5, v4, s[76:79], s92 offen sc1
KS_NOF2:
    s_mov_b64 exec, -1
    s_setprio 0
    s_cmp_lt_u32 s41, 18
    s_cbranch_scc1 KS_B
    s_waitcnt lgkmcnt(0)
    s_endpgm
KS_T:
    s_setprio 0
    s_cmp_ge_u32 s38, 10
    s_cbranch_scc1 KS_P
    v_and_b32 v6, 1, v1
    v_subrev_u32 v6, 1, v6
    v_and_b32 v7, 7, v1
    v_lshlrev_b32 v7, 2, v7
    s_add_u32 s76, s36, 0x840000
    s_addc_u32 s77, s37, 0
    s_mov_b32 s78, 0x3000
    s_mov_b32 s79, 0x20000
    s_cmp_eq_u32 s38, 9
    s_cbranch_scc1 KS_W9
    s_cmp_eq_u32 s38, 8
    s_cbranch_scc1 KS_L2W
    s_sub_u32 s93, s38, 4
    s_lshl_b32 s92, s93, 10
    v_lshl_add_u32 v33, v1, 4, s92
    s_movk_i32 s92, 4096
    s_lshl_b32 s93, s93, 7
    v_lshlrev_b32 v32, 4, v2
    v_lshl_add_u32 v32, v3, 5, v32
    v_add_u32 v32, s93, v32
W_88:
    s_sleep 1
    ds_read_b32 v8, v4 offset:24
    s_sub_u32 s39, s39, 1
    s_cbranch_scc1 KS_ABORT
    s_waitcnt lgkmcnt(0)
    v_cmp_eq_u32 vcc, 0, v8
    s_cbranch_vccnz W_88
    s_setprio 2
    s_sleep 20
    s_branch ZPE_90
ZP_89:
    s_sleep 4
ZPE_90:
    buffer_load_dwordx4 v[8:11], v33, s[76:79], 0 offen sc1
    buffer_load_dwordx4 v[12:15], v33, s[76:79], s92 offen sc1
    s_sub_u32 s39, s39, 1
    s_cbranch_scc1 KS_ABORT
    s_waitcnt vmcnt(0)
    v_max3_u32 v44, v8, v9, v10
    v_max3_u32 v44, v44, v11, v12
    v_max3_u32 v44, v44, v13, v14
    v_max_u32 v44, v44, v15
    v_cmp_eq_u32 vcc, -1, v44
    s_cbranch_vccnz ZP_89
    ds_write_b32 v4, v5 offset:196
    v_max_u32 v16, v8, v9
    v_min_u32 v9, v8, v9
    v_max_u32 v17, v12, v13
    v_min_u32 v13, v12, v13
    v_max_u32 v18, v10, v11
    v_min_u32 v11, v10, v11
    v_max_u32 v19, v14, v15
    v_min_u32 v15, v14, v15
    v_max_u32 v20, v16, v18
    v_min_u32 v18, v16, v18
    v_max_u32 v21, v17, v19
    v_min_u32 v19, v17, v19
    v_max_u32 v22, v9, v11
    v_min_u32 v11, v9, v11
    v_max_u32 v23, v13, v15
    v_min_u32 v15, v13, v15
    v_max_u32 v24, v22, v18
    v_min_u32 v18, v22, v18
    v_max_u32 v25, v23, v19
    v_min_u32 v19, v23, v19
    v_mov_b32_dpp v26, v11 quad_perm:[1,0,3,2] row_mask:0xf bank_mask:0xf
    v_mov_b32_dpp v27, v18 quad_perm:[1,0,3,2] row_mask:0xf bank_mask:0xf
    v_mov_b32_dpp v8, v24 quad_perm:[1,0,3,2] row_mask:0xf bank_mask:0xf
    v_mov_b32_dpp v12, v20 quad_perm:[1,0,3,2] row_mask:0xf bank_mask:0xf
    v_med3_u32 v26, v20, v26, v6
    v_med3_u32 v27, v24, v27, v6
    v_med3_u32 v8, v18, v8, v6
    v_med3_u32 v12, v11, v12, v6
    v_max_u32 v10, v26, v8
    v_min_u32 v8, v26, v8
    v_max_u32 v14, v27, v12
    v_min_u32 v12, v27, v12
    v_max_u32 v16, v10, v14
    v_min_u32 v14, v10, v14
    v_max_u32 v17, v8, v12
    v_min_u32 v12, v8, v12
    v_mov_b32_dpp v9, v15 quad_perm:[1,0,3,2] row_mask:0xf bank_mask:0xf
    v_mov_b32_dpp v13, v19 quad_perm:[1,0,3,2] row_mask:0xf bank_mask:0xf
    v_mov_b32_dpp v22, v25 quad_perm:[1,0,3,2] row_mask:0xf bank_mask:0xf
    v_mov_b32_dpp v23, v21 quad_perm:[1,0,3,2] row_mask:0xf bank_mask:0xf
    v_med3_u32 v9, v21, v9, v6
    v_med3_u32 v13, v25, v13, v6
    v_med3_u32 v22, v19, v22, v6
    v_med3_u32 v23, v15, v23, v6
    v_max_u32 v20, v9, v22
    v_min_u32 v22, v9, v22
    v_max_u32 v24, v13, v23
    v_min_u32 v23, v13, v23
    v_max_u32 v18, v20, v24
    v_min_u32 v24, v20, v24
    v_max_u32 v11, v22, v23
    v_min_u32 v23, v22, v23
    s_nop 1
    v_max_u32_dpp v16, v23, v16 quad_perm:[1,0,3,2] row_mask:0xf bank_mask:0xf
    v_max_u32_dpp v14, v11, v14 quad_perm:[1,0,3,2] row_mask:0xf bank_mask:0xf
    v_max_u32_dpp v17, v24, v17 quad_perm:[1,0,3,2] row_mask:0xf bank_mask:0xf
    v_max_u32_dpp v12, v18, v12 quad_perm:[1,0,3,2] row_mask:0xf bank_mask:0xf
    v_mov_b32_dpp v26, v16 quad_perm:[1,0,3,2] row_mask:0xf bank_mask:0xf
    v_mov_b32_dpp v27, v14 quad_perm:[1,0,3,2] row_mask:0xf bank_mask:0xf
    v_mov_b32_dpp v10, v17 quad_perm:[1,0,3,2] row_mask:0xf bank_mask:0xf
    v_mov_b32_dpp v8, v12 quad_perm:[1,0,3,2] row_mask:0xf bank_mask:0xf
    v_med3_u32 v26, v16, v26, v6
    v_med3_u32 v27, v14, v27, v6
    v_med3_u32 v10, v17, v10, v6
    v_med3_u32 v8, v12, v8, v6
    v_max_u32 v21, v26, v10
    v_min_u32 v10, v26, v10
    v_max_u32 v25, v27, v8
    v_min_u32 v8, v27, v8
    v_max_u32 v19, v21, v25
    v_min_u32 v25, v21, v25
    v_max_u32 v15, v10, v8
    v_min_u32 v8, v10, v8
    s_nop 1
    v_max_u32_dpp v9, v8, v19 quad_perm:[3,2,1,0] row_mask:0xf bank_mask:0xf
    v_max_u32_dpp v13, v15, v25 quad_perm:[3,2,1,0] row_mask:0xf bank_mask:0xf
    v_max_u32_dpp v20, v25, v15 quad_perm:[3,2,1,0] row_mask:0xf bank_mask:0xf
    v_max_u32_dpp v22, v19, v8 quad_perm:[3,2,1,0] row_mask:0xf bank_mask:0xf
    v_mov_b32_dpp v18, v9 quad_perm:[1,0,3,2] row_mask:0xf bank_mask:0xf
    v_mov_b32_dpp v24, v13 quad_perm:[1,0,3,2] row_mask:0xf bank_mask:0xf
    v_mov_b32_dpp v11, v20 quad_perm:[1,0,3,2] row_mask:0xf bank_mask:0xf
    v_mov_b32_dpp v23, v22 quad_perm:[1,0,3,2] row_mask:0xf bank_mask:0xf
    v_med3_u32 v18, v9, v18, v6
    v_med3_u32 v24, v13, v24, v6
    v_med3_u32 v11, v20, v11, v6
    v_med3_u32 v23, v22, v23, v6
    v_max_u32 v16, v18, v11
    v_min_u32 v11, v18, v11
    v_max_u32 v14, v24, v23
    v_min_u32 v23, v24, v23
    v_max_u32 v17, v16, v14
    v_min_u32 v14, v16, v14
    v_max_u32 v12, v11, v23
    v_min_u32 v23, v11, v23
    s_nop 1
    v_max_u32_dpp v26, v23, v17 row_half_mirror row_mask:0xf bank_mask:0xf
    v_max_u32_dpp v27, v12, v14 row_half_mirror row_mask:0xf bank_mask:0xf
    v_max_u32_dpp v21, v14, v12 row_half_mirror row_mask:0xf bank_mask:0xf
    v_max_u32_dpp v10, v17, v23 row_half_mirror row_mask:0xf bank_mask:0xf
    v_mov_b32_dpp v19, v26 quad_perm:[1,0,3,2] row_mask:0xf bank_mask:0xf
    v_mov_b32_dpp v25, v27 quad_perm:[1,0,3,2] row_mask:0xf bank_mask:0xf
    v_mov_b32_dpp v15, v21 quad_perm:[1,0,3,2] row_mask:0xf bank_mask:0xf
    v_mov_b32_dpp v8, v10 quad_perm:[1,0,3,2] row_mask:0xf bank_mask:0xf
    v_med3_u32 v19, v26, v19, v6
    v_med3_u32 v25, v27, v25, v6
    v_med3_u32 v15, v21, v15, v6
    v_med3_u32 v8, v10, v8, v6
    v_max_u32 v9, v19, v15
    v_min_u32 v15, v19, v15
    v_max_u32 v13, v25, v8
    v_min_u32 v8, v25, v8
    v_max_u32 v20, v9, v13
    v_min_u32 v13, v9, v13
    v_max_u32 v22, v15, v8
    v_min_u32 v8, v15, v8
    s_nop 1
    v_max_u32_dpp v18, v8, v20 row_mirror row_mask:0xf bank_mask:0xf
    v_max_u32_dpp v24, v22, v13 row_mirror row_mask:0xf bank_mask:0xf
    v_max_u32_dpp v16, v13, v22 row_mirror row_mask:0xf bank_mask:0xf
    v_max_u32_dpp v11, v20, v8 row_mirror row_mask:0xf bank_mask:0xf
    v_mov_b32_dpp v17, v18 quad_perm:[1,0,3,2] row_mask:0xf bank_mask:0xf
    v_mov_b32_dpp v14, v24 quad_perm:[1,0,3,2] row_mask:0xf bank_mask:0xf
    v_mov_b32_dpp v12, v16 quad_perm:[1,0,3,2] row_mask:0xf bank_mask:0xf
    v_mov_b32_dpp v23, v11 quad_perm:[1,0,3,2] row_mask:0xf bank_mask:0xf
    v_med3_u32 v17, v18, v17, v6
    v_med3_u32 v14, v24, v14, v6
    v_med3_u32 v12, v16, v12, v6
    v_med3_u32 v23, v11, v23, v6
    v_max_u32 v26, v17, v12
    v_min_u32 v12, v17, v12
    v_max_u32 v27, v14, v23
    v_min_u32 v23, v14, v23
    v_max_u32 v21, v26, v27
    v_min_u32 v27, v26, v27
    v_max_u32 v10, v12, v23
    v_min_u32 v23, v12, v23
    v_mov_b32 v28, v21
    v_mov_b32 v29, v27
    v_mov_b32 v30, v10
    v_mov_b32 v31, v23
    s_mov_b32 exec_lo, 0x00030003
    s_mov_b32 exec_hi, 0x00030003
    ds_write_b128 v32, v[28:31] offset:256
    s_mov_b64 exec, -1
    s_setprio 0
    s_branch KS_B
KS_L2W:
    s_add_u32 s72, s36, 0x300000
    s_addc_u32 s73, s37, 0
    s_mov_b32 s74, 0x240000
    s_mov_b32 s75, 0x20000
    s_mov_b32 s92, 0xcccccccc
    s_mov_b32 s93, 0xcccccccc
    s_mov_b32 s94, 0xf0f0f0f0
    s_mov_b32 s95, 0xf0f0f0f0
    s_movk_i32 s96, 1152
    v_lshrrev_b32 v34, 3, v1
    v_lshlrev_b32 v34, 4, v34
    v_lshlrev_b32 v33, 4, v2
W_91:
    s_sleep 1
    ds_read_b32 v8, v4 offset:24
    s_sub_u32 s39, s39, 1
    s_cbranch_scc1 KS_ABORT
    s_waitcnt lgkmcnt(0)
    v_cmp_eq_u32 vcc, 0, v8
    s_cbranch_vccnz W_91
    s_setprio 2
KS_L2POLL:
    ds_read_b128 v[8:11], v33 offset:256
    ds_read_b128 v[12:15], v33 offset:512
    s_sub_u32 s39, s39, 1
    s_cbranch_scc1 KS_ABORT
    s_waitcnt lgkmcnt(0)
    v_min3_u32 v16, v8, v9, v10
    v_min3_u32 v17, v11, v12, v13
    v_min3_u32 v16, v16, v14, v15
    v_min_u32 v16, v16, v17
    v_cmp_eq_u32 vcc, 0, v16
    s_cbranch_vccnz KS_L2POLL
    v_max_u32_dpp v8, v15, v8 quad_perm:[1,0,3,2] row_mask:0xf bank_mask:0xf
    v_max_u32_dpp v9, v14, v9 quad_perm:[1,0,3,2] row_mask:0xf bank_mask:0xf
    v_max_u32_dpp v10, v13, v10 quad_perm:[1,0,3,2] row_mask:0xf bank_mask:0xf
    v_max_u32_dpp v11, v12, v11 quad_perm:[1,0,3,2] row_mask:0xf bank_mask:0xf
    v_mov_b32_dpp v16, v8 quad_perm:[1,0,3,2] row_mask:0xf bank_mask:0xf
    v_mov_b32_dpp v17, v9 quad_perm:[1,0,3,2] row_mask:0xf bank_mask:0xf
    v_mov_b32_dpp v18, v10 quad_perm:[1,0,3,2] row_mask:0xf bank_mask:0xf
    v_mov_b32_dpp v19, v11 quad_perm:[1,0,3,2] row_mask:0xf bank_mask:0xf
    v_med3_u32 v16, v8, v16, v6
    v_med3_u32 v17, v9, v17, v6
    v_med3_u32 v18, v10, v18, v6
    v_med3_u32 v19, v11, v19, v6
    v_max_u32 v20, v16, v18
    v_min_u32 v18, v16, v18
    v_max_u32 v21, v17, v19
    v_min_u32 v19, v17, v19
    v_max_u32 v22, v20, v21
    v_min_u32 v21, v20, v21
    v_max_u32 v23, v18, v19
    v_min_u32 v19, v18, v19
    s_nop 1
    v_max_u32_dpp v24, v19, v22 quad_perm:[3,2,1,0] row_mask:0xf bank_mask:0xf
    v_max_u32_dpp v25, v23, v21 quad_perm:[3,2,1,0] row_mask:0xf bank_mask:0xf
    v_max_u32_dpp v26, v21, v23 quad_perm:[3,2,1,0] row_mask:0xf bank_mask:0xf
    v_max_u32_dpp v27, v22, v19 quad_perm:[3,2,1,0] row_mask:0xf bank_mask:0xf
    v_mov_b32_dpp v12, v24 quad_perm:[1,0,3,2] row_mask:0xf bank_mask:0xf
    v_mov_b32_dpp v13, v25 quad_perm:[1,0,3,2] row_mask:0xf bank_mask:0xf
    v_mov_b32_dpp v14, v26 quad_perm:[1,0,3,2] row_mask:0xf bank_mask:0xf
    v_mov_b32_dpp v15, v27 quad_perm:[1,0,3,2] row_mask:0xf bank_mask:0xf
    v_med3_u32 v12, v24, v12, v6
    v_med3_u32 v13, v25, v13, v6
    v_med3_u32 v14, v26, v14, v6
    v_med3_u32 v15, v27, v15, v6
    v_max_u32 v8, v12, v14
    v_min_u32 v14, v12, v14
    v_max_u32 v9, v13, v15
    v_min_u32 v15, v13, v15
    v_max_u32 v10, v8, v9
    v_min_u32 v9, v8, v9
    v_max_u32 v11, v14, v15
    v_min_u32 v15, v14, v15
    s_nop 1
    v_max_u32_dpp v16, v15, v10 row_half_mirror row_mask:0xf bank_mask:0xf
    v_max_u32_dpp v17, v11, v9 row_half_mirror row_mask:0xf bank_mask:0xf
    v_max_u32_dpp v20, v9, v11 row_half_mirror row_mask:0xf bank_mask:0xf
    v_max_u32_dpp v18, v10, v15 row_half_mirror row_mask:0xf bank_mask:0xf
    v_mov_b32_dpp v22, v16 quad_perm:[1,0,3,2] row_mask:0xf bank_mask:0xf
    v_mov_b32_dpp v21, v17 quad_perm:[1,0,3,2] row_mask:0xf bank_mask:0xf
    v_mov_b32_dpp v23, v20 quad_perm:[1,0,3,2] row_mask:0xf bank_mask:0xf
    v_mov_b32_dpp v19, v18 quad_perm:[1,0,3,2] row_mask:0xf bank_mask:0xf
    v_med3_u32 v22, v16, v22, v6
    v_med3_u32 v21, v17, v21, v6
    v_med3_u32 v23, v20, v23, v6
    v_med3_u32 v19, v18, v19, v6
    v_max_u32 v24, v22, v23
    v_min_u32 v23, v22, v23
    v_max_u32 v25, v21, v19
    v_min_u32 v19, v21, v19
    v_max_u32 v26, v24, v25
    v_min_u32 v25, v24, v25
    v_max_u32 v27, v23, v19
    v_min_u32 v19, v23, v19
    s_nop 1
    v_max_u32_dpp v12, v19, v26 row_mirror row_mask:0xf bank_mask:0xf
    v_max_u32_dpp v13, v27, v25 row_mirror row_mask:0xf bank_mask:0xf
    v_max_u32_dpp v8, v25, v27 row_mirror row_mask:0xf bank_mask:0xf
    v_max_u32_dpp v14, v26, v19 row_mirror row_mask:0xf bank_mask:0xf
    ds_read_b32 v35, v4 offset:28
    v_cndmask_b32 v30, v12, v13, s[92:93]
    v_cndmask_b32 v31, v8, v14, s[92:93]
    v_cndmask_b32 v30, v30, v31, s[94:95]
    s_nop 1
    v_mov_b32_dpp v30, v30 row_shr:8 row_mask:0xf bank_mask:0xc
    v_and_b32 v31, 0x7ff, v30
    v_sub_u32 v31, 2047, v31
    v_mad_u32_u24 v31, v31, s96, v34
    s_waitcnt lgkmcnt(0)
    v_cmp_ne_u32 vcc, 0, v35
    s_cbranch_vccnz KS_RW1
W_92:
    ds_read_b32 v35, v4 offset:28
    s_sub_u32 s39, s39, 1
    s_cbranch_scc1 KS_ABORT
    s_waitcnt lgkmcnt(0)
    v_cmp_eq_u32 vcc, 0, v35
    s_cbranch_vccnz W_92
KS_RW1:
    s_mov_b32 m0, 17088
    s_nop 0
    buffer_load_dwordx4 v31, s[72:75], 0 offen offset:0 sc1 lds
    s_mov_b32 m0, 17984
    s_nop 0
    buffer_load_dwordx4 v31, s[72:75], 0 offen offset:128 sc1 lds
    s_mov_b32 m0, 18880
    s_nop 0
    buffer_load_dwordx4 v31, s[72:75], 0 offen offset:256 sc1 lds
    s_mov_b32 m0, 19776
    s_nop 0
    buffer_load_dwordx4 v31, s[72:75], 0 offen offset:384 sc1 lds
    s_mov_b32 m0, 20672
    s_nop 0
    buffer_load_dwordx4 v31, s[72:75], 0 offen offset:512 sc1 lds
    s_mov_b32 m0, 21568
    s_nop 0
    buffer_load_dwordx4 v31, s[72:75], 0 offen offset:640 sc1 lds
    s_mov_b32 m0, 22464
    s_nop 0
    buffer_load_dwordx4 v31, s[72:75], 0 offen offset:768 sc1 lds
    s_mov_b32 m0, 23360
    s_nop 0
    buffer_load_dwordx4 v31, s[72:75], 0 offen offset:896 sc1 lds
    s_mov_b32 m0, 24256
    s_nop 0
    buffer_load_dwordx4 v31, s[72:75], 0 offen offset:1024 sc1 lds
    ds_write_b32 v7, v30 offset:768
    s_waitcnt vmcnt(0)
    ds_write_b32 v4, v5 offset:32
    s_setprio 0
    s_branch KS_B
KS_W9:
    v_lshlrev_b32 v33, 4, v1
    s_movk_i32 s92, 0x2000
    s_add_u32 s72, s36, 0x300000
    s_addc_u32 s73, s37, 0
    s_mov_b32 s74, 0x240000
    s_mov_b32 s75, 0x20000
    s_add_u32 s64, s36, 0x600000
    s_addc_u32 s65, s37, 0
    s_mov_b32 s66, 0x240000
    s_mov_b32 s67, 0x20000
    s_mov_b32 s68, s4
    s_mov_b32 s69, s5
    s_mov_b32 s70, 0x240000
    s_mov_b32 s71, 0x20000
    v_bfe_u32 v43, v1, 2, 3
    s_lshl_b32 s93, s89, 3
    v_add_u32 v43, s93, v43
    v_bfe_u32 v40, v43, 4, 1
    v_and_b32 v41, 3, v1
    v_lshl_add_u32 v40, v40, 2, v41
    v_lshlrev_b32 v40, 2, v40
    v_lshrrev_b32 v41, 5, v43
    v_lshlrev_b32 v41, 4, v41
    v_and_b32 v42, 15, v43
    v_add_u32 v41, v41, v42
W_93:
    s_sleep 1
    ds_read_b32 v8, v4 offset:196
    s_sub_u32 s39, s39, 1
    s_cbranch_scc1 KS_ABORT
    s_waitcnt lgkmcnt(0)
    v_cmp_eq_u32 vcc, 0, v8
    s_cbranch_vccnz W_93
    s_sleep 8
    s_setprio 2
    s_branch ZPE_95
ZP_94:
    s_sleep 4
ZPE_95:
    buffer_load_dword v8, v33, s[76:79], s92 offen offset:0 sc1
    buffer_load_dword v9, v33, s[76:79], s92 offen offset:1024 sc1
    buffer_load_dword v10, v33, s[76:79], s92 offen offset:2048 sc1
    buffer_load_dword v11, v33, s[76:79], s92 offen offset:3072 sc1
    s_sub_u32 s39, s39, 1
    s_cbranch_scc1 KS_ABORT
    s_waitcnt vmcnt(0)
    v_max3_u32 v44, v8, v9, v10
    v_max_u32 v44, v44, v11
    v_cmp_eq_u32 vcc, -1, v44
    s_cbranch_vccnz ZP_94
    ds_write_b32 v4, v5 offset:28
    s_setprio 0
W_96:
    s_sleep 1
    ds_read_b32 v12, v7 offset:768
    s_sub_u32 s39, s39, 1
    s_cbranch_scc1 KS_ABORT
    s_waitcnt lgkmcnt(0)
    v_cmp_eq_u32 vcc, 0, v12
    s_cbranch_vccnz W_96
    ds_read_b32 v19, v40 offset:768
    s_waitcnt lgkmcnt(0)
    v_and_b32 v14, 0x7ff, v19
    v_sub_u32 v14, 2047, v14
    v_mul_u32_u24 v23, 1152, v14
    v_lshl_add_u32 v23, v41, 1, v23
    buffer_load_ushort v20, v23, s[72:75], 0 offen sc1
    buffer_load_ushort v17, v23, s[68:71], 0 offen
    v_lshrrev_b32 v15, 9, v14
    v_bfe_u32 v16, v14, 6, 2
    v_lshl_add_u32 v15, v15, 2, v16
    v_bfe_u32 v16, v14, 2, 2
    v_lshl_add_u32 v15, v15, 2, v16
    v_bfe_u32 v16, v14, 4, 1
    v_bfe_u32 v24, v14, 8, 1
    v_and_b32 v25, 3, v14
    v_lshl_add_u32 v24, v24, 2, v25
    v_lshlrev_b32 v24, 1, v24
    v_bfe_u32 v25, v14, 5, 1
    v_lshl_add_u32 v24, v25, 5, v24
    v_lshl_add_u32 v25, v15, 1, v16
    v_lshl_add_u32 v25, v25, 14, v24
    v_lshrrev_b32 v26, 1, v41
    v_lshl_add_u32 v25, v26, 6, v25
    v_xor_b32 v26, v41, v16
    v_not_b32 v26, v26
    v_and_b32 v26, 1, v26
    v_lshl_add_u32 v25, v26, 4, v25
    v_lshl_add_u32 v26, v15, 12, v24
    v_lshl_add_u32 v26, v16, 4, v26
    v_lshl_add_u32 v26, v41, 6, v26
    v_add_u32 v26, 2064384, v26
    v_cmp_gt_u32 vcc, 0x200, v41
    s_nop 1
    v_cndmask_b32 v25, v26, v25, vcc
    buffer_load_ushort v18, v25, s[64:67], 0 offen sc1
    s_add_u32 s72, s36, 0xb10000
    s_addc_u32 s73, s37, 0
    s_mov_b32 s74, 0x40
    s_mov_b32 s75, 0x20000
    v_ashrrev_i32 v22, 31, v19
    v_not_b32 v22, v22
    v_or_b32 v22, 0x80000000, v22
    v_xor_b32 v22, v19, v22
    v_and_b32 v22, 0xffff0000, v22
    v_mul_f32 v22, 0xbfb8aa3b, v22
    v_exp_f32 v22, v22
    s_nop 0
    v_add_f32 v22, 1.0, v22
    v_rcp_f32 v22, v22
    s_nop 0
    v_cvt_pk_bf16_f32 v22, v22, v22
    v_lshlrev_b32 v22, 16, v22
    v_and_b32 v14, 31, v1
    v_lshlrev_b32 v14, 4, v14
    s_waitcnt vmcnt(0)
    v_lshlrev_b32 v17, 16, v17
    v_lshlrev_b32 v18, 16, v18
    v_add_f32 v17, v17, v18
    v_cvt_pk_bf16_f32 v17, v17, v17
    v_and_b32 v21, 0xffff0000, v17
    v_lshlrev_b32 v20, 16, v20
    ds_write_b128 v14, v[20:23] offset:1536
    s_cmp_lg_u32 s2, 0
    s_cbranch_scc1 KS_W9E
    buffer_store_dword v12, v7, s[72:75], 0 offen
KS_W9E:
    s_waitcnt lgkmcnt(0)
    s_endpgm
KS_B:
    s_add_u32 s64, s36, 0x850000
    s_addc_u32 s65, s37, 0
    s_mov_b32 s66, 0x288000
    s_mov_b32 s67, 0x20000
    v_bfe_u32 v16, v1, 2, 2
    v_lshl_add_u32 v16, v3, 3, v16
    v_mul_u32_u24 v16, 1152, v16
    v_and_b32 v17, 3, v1
    v_lshl_add_u32 v16, v17, 3, v16
    s_lshl_b32 s92, s38, 7
    s_add_u32 s92, s92, 109184
    v_add_u32 v16, s92, v16
W_97:
    ds_read_b32 v17, v4 offset:40
    s_sub_u32 s39, s39, 1
    s_cbranch_scc1 KS_ABORT
    s_waitcnt lgkmcnt(0)
    v_cmp_ne_u32 vcc, s84, v17
    s_cbranch_vccnz W_97
    ds_read_b64_tr_b16 v[48:49], v16 offset:0
    ds_read_b64_tr_b16 v[50:51], v16 offset:4608
    ds_read_b64_tr_b16 v[52:53], v16 offset:32
    ds_read_b64_tr_b16 v[54:55], v16 offset:4640
    ds_read_b64_tr_b16 v[56:57], v16 offset:64
    ds_read_b64_tr_b16 v[58:59], v16 offset:4672
    ds_read_b64_tr_b16 v[60:61], v16 offset:96
    ds_read_b64_tr_b16 v[62:63], v16 offset:4704
    v_and_b32 v16, 7, v2
    v_lshlrev_b32 v16, 6, v16
    v_lshl_add_u32 v16, v3, 4, v16
    s_mul_i32 s92, s89, 18432
    s_lshl_b32 s93, s38, 11
    s_add_u32 s92, s92, s93
    v_lshlrev_b32 v17, 4, v1
    s_waitcnt lgkmcnt(0)
    s_barrier
    s_barrier
    ds_read_b128 v[20:23], v16 offset:1024
    s_waitcnt lgkmcnt(0)
    v_mfma_f32_16x16x32_bf16 v[32:35], v[20:23], v[48:51], 0
    v_mfma_f32_16x16x32_bf16 v[36:39], v[20:23], v[52:55], 0
    v_mfma_f32_16x16x32_bf16 v[40:43], v[20:23], v[56:59], 0
    v_mfma_f32_16x16x32_bf16 v[44:47], v[20:23], v[60:63], 0
    s_nop 5
    v_permlane32_swap_b32 v32, v36
    v_permlane32_swap_b32 v33, v37
    v_permlane32_swap_b32 v34, v38
    v_permlane32_swap_b32 v35, v39
    v_min_u32 v32, -2, v32
    v_min_u32 v33, -2, v33
    v_min_u32 v34, -2, v34
    v_min_u32 v35, -2, v35
    buffer_store_dwordx4 v[32:35], v17, s[64:67], s92 offen offset:0 sc1
    v_permlane32_swap_b32 v40, v44
    v_permlane32_swap_b32 v41, v45
    v_permlane32_swap_b32 v42, v46
    v_permlane32_swap_b32 v43, v47
    v_min_u32 v40, -2, v40
    v_min_u32 v41, -2, v41
    v_min_u32 v42, -2, v42
    v_min_u32 v43, -2, v43
    buffer_store_dwordx4 v[40:43], v17, s[64:67], s92 offen offset:1024 sc1
    s_waitcnt vmcnt(0)
    s_barrier
    s_endpgm
KS_G0:
    ds_write_b8 v15, v5 offset:68
    s_setprio 0
KS_G:
    s_mov_b32 s98, 0x05040100
    s_mov_b32 s99, 0x07060302
    s_waitcnt vmcnt(0)
    s_sub_u32 s87, s38, 12
    s_mul_i32 s92, s87, 9
    s_add_u32 s92, s92, 1
    s_lshr_b32 s86, s92, 1
    s_lshl_b32 s92, s86, 5
    v_lshl_add_u32 v7, v3, 3, s92
    v_mul_u32_u24 v7, 9216, v7
    v_and_b32 v6, 7, v2
    v_lshl_add_u32 v7, v6, 3, v7
    s_lshl_b32 s92, s89, 6
    v_add_u32 v7, s92, v7
    v_cmp_gt_u32 vcc, 8, v2
    s_mov_b32 s76, 9216
    s_mov_b32 s77, 0
    s_mov_b32 s78, 230400
    s_mov_b32 s79, 0
    v_mov_b32 v46, s26
    v_mov_b32 v47, s27
    v_mov_b32 v6, s28
    v_cndmask_b32 v46, v6, v46, vcc
    v_mov_b32 v6, s29
    v_cndmask_b32 v47, v6, v47, vcc
    v_add_co_u32 v46, vcc, v46, v7
    s_nop 1
    v_addc_co_u32 v47, vcc, 0, v47, vcc
    s_lshr_b32 s92, 3, s87
    s_bitcmp1_b32 s92, 0
    s_cbranch_scc0 GT_98
W_99:
    s_sleep 2
    ds_read_b32 v10, v4 offset:16
    s_sub_u32 s39, s39, 1
    s_cbranch_scc1 KS_ABORT
    s_waitcnt lgkmcnt(0)
    v_cmp_ne_u32 vcc, s84, v10
    s_cbranch_vccnz W_99
GT_98:
    s_lshr_b32 s92, 12, s87
    s_bitcmp1_b32 s92, 0
    s_cbranch_scc0 GT_100
W_101:
    s_sleep 2
    ds_read_b32 v10, v4 offset:52
    s_sub_u32 s39, s39, 1
    s_cbranch_scc1 KS_ABORT
    s_waitcnt lgkmcnt(0)
    v_cmp_ne_u32 vcc, s84, v10
    s_cbranch_vccnz W_101
    s_setprio 1
GT_100:
    global_load_dwordx2 v[48:49], v[46:47], off
    v_lshl_add_u64 v[46:47], v[46:47], 0, s[76:77]
    global_load_dwordx2 v[50:51], v[46:47], off
    v_lshl_add_u64 v[46:47], v[46:47], 0, s[76:77]
    global_load_dwordx2 v[52:53], v[46:47], off
    v_lshl_add_u64 v[46:47], v[46:47], 0, s[76:77]
    global_load_dwordx2 v[54:55], v[46:47], off
    v_lshl_add_u64 v[46:47], v[46:47], 0, s[76:77]
    global_load_dwordx2 v[56:57], v[46:47], off
    v_lshl_add_u64 v[46:47], v[46:47], 0, s[76:77]
    global_load_dwordx2 v[58:59], v[46:47], off
    v_lshl_add_u64 v[46:47], v[46:47], 0, s[76:77]
    global_load_dwordx2 v[60:61], v[46:47], off
    v_lshl_add_u64 v[46:47], v[46:47], 0, s[76:77]
    global_load_dwordx2 v[62:63], v[46:47], off
    v_lshl_add_u64 v[46:47], v[46:47], 0, s[78:79]
    global_load_dwordx2 v[64:65], v[46:47], off
    v_lshl_add_u64 v[46:47], v[46:47], 0, s[76:77]
    global_load_dwordx2 v[66:67], v[46:47], off
    v_lshl_add_u64 v[46:47], v[46:47], 0, s[76:77]
    global_load_dwordx2 v[68:69], v[46:47], off
    v_lshl_add_u64 v[46:47], v[46:47], 0, s[76:77]
    global_load_dwordx2 v[70:71], v[46:47], off
    v_lshl_add_u64 v[46:47], v[46:47], 0, s[76:77]
    global_load_dwordx2 v[72:73], v[46:47], off
    v_lshl_add_u64 v[46:47], v[46:47], 0, s[76:77]
    global_load_dwordx2 v[74:75], v[46:47], off
    v_lshl_add_u64 v[46:47], v[46:47], 0, s[76:77]
    global_load_dwordx2 v[76:77], v[46:47], off
    v_lshl_add_u64 v[46:47], v[46:47], 0, s[76:77]
    global_load_dwordx2 v[78:79], v[46:47], off
    v_lshl_add_u64 v[46:47], v[46:47], 0, s[78:79]
    global_load_dwordx2 v[80:81], v[46:47], off
    v_lshl_add_u64 v[46:47], v[46:47], 0, s[76:77]
    global_load_dwordx2 v[82:83], v[46:47], off
    v_lshl_add_u64 v[46:47], v[46:47], 0, s[76:77]
    global_load_dwordx2 v[84:85], v[46:47], off
    v_lshl_add_u64 v[46:47], v[46:47], 0, s[76:77]
    global_load_dwordx2 v[86:87], v[46:47], off
    v_lshl_add_u64 v[46:47], v[46:47], 0, s[76:77]
    global_load_dwordx2 v[88:89], v[46:47], off
    v_lshl_add_u64 v[46:47], v[46:47], 0, s[76:77]
    global_load_dwordx2 v[90:91], v[46:47], off
    v_lshl_add_u64 v[46:47], v[46:47], 0, s[76:77]
    global_load_dwordx2 v[92:93], v[46:47], off
    v_lshl_add_u64 v[46:47], v[46:47], 0, s[76:77]
    global_load_dwordx2 v[94:95], v[46:47], off
    v_lshl_add_u64 v[46:47], v[46:47], 0, s[78:79]
    global_load_dwordx2 v[96:97], v[46:47], off
    v_lshl_add_u64 v[46:47], v[46:47], 0, s[76:77]
    global_load_dwordx2 v[98:99], v[46:47], off
    v_lshl_add_u64 v[46:47], v[46:47], 0, s[76:77]
    global_load_dwordx2 v[100:101], v[46:47], off
    v_lshl_add_u64 v[46:47], v[46:47], 0, s[76:77]
    global_load_dwordx2 v[102:103], v[46:47], off
    v_lshl_add_u64 v[46:47], v[46:47], 0, s[76:77]
    global_load_dwordx2 v[104:105], v[46:47], off
    v_lshl_add_u64 v[46:47], v[46:47], 0, s[76:77]
    global_load_dwordx2 v[106:107], v[46:47], off
    v_lshl_add_u64 v[46:47], v[46:47], 0, s[76:77]
    global_load_dwordx2 v[108:109], v[46:47], off
    v_lshl_add_u64 v[46:47], v[46:47], 0, s[76:77]
    global_load_dwordx2 v[110:111], v[46:47], off
    v_lshl_add_u64 v[46:47], v[46:47], 0, s[78:79]
    s_bitcmp1_b32 s87, 0
    s_cbranch_scc1 KS_G4
    global_load_dwordx2 v[112:113], v[46:47], off
    v_lshl_add_u64 v[46:47], v[46:47], 0, s[76:77]
    global_load_dwordx2 v[114:115], v[46:47], off
    v_lshl_add_u64 v[46:47], v[46:47], 0, s[76:77]
    global_load_dwordx2 v[116:117], v[46:47], off
    v_lshl_add_u64 v[46:47], v[46:47], 0, s[76:77]
    global_load_dwordx2 v[118:119], v[46:47], off
    v_lshl_add_u64 v[46:47], v[46:47], 0, s[76:77]
    global_load_dwordx2 v[120:121], v[46:47], off
    v_lshl_add_u64 v[46:47], v[46:47], 0, s[76:77]
    global_load_dwordx2 v[122:123], v[46:47], off
    v_lshl_add_u64 v[46:47], v[46:47], 0, s[76:77]
    global_load_dwordx2 v[124:125], v[46:47], off
    v_lshl_add_u64 v[46:47], v[46:47], 0, s[76:77]
    global_load_dwordx2 v[126:127], v[46:47], off
KS_G4:
    v_mov_b32 v6, s87
    ds_write_b8 v6, v5 offset:192
    s_waitcnt vmcnt(0)
    v_perm_b32 v32, v50, v48, s98
    v_perm_b32 v33, v54, v52, s98
    v_perm_b32 v34, v58, v56, s98
    v_perm_b32 v35, v62, v60, s98
    v_perm_b32 v36, v50, v48, s99
    v_perm_b32 v37, v54, v52, s99
    v_perm_b32 v38, v58, v56, s99
    v_perm_b32 v39, v62, v60, s99
    v_perm_b32 v40, v51, v49, s98
    v_perm_b32 v41, v55, v53, s98
    v_perm_b32 v42, v59, v57, s98
    v_perm_b32 v43, v63, v61, s98
    v_perm_b32 v44, v51, v49, s99
    v_perm_b32 v45, v55, v53, s99
    v_perm_b32 v46, v59, v57, s99
    v_perm_b32 v47, v63, v61, s99
    v_perm_b32 v48, v66, v64, s98
    v_perm_b32 v49, v70, v68, s98
    v_perm_b32 v50, v74, v72, s98
    v_perm_b32 v51, v78, v76, s98
    v_perm_b32 v52, v66, v64, s99
    v_perm_b32 v53, v70, v68, s99
    v_perm_b32 v54, v74, v72, s99
    v_perm_b32 v55, v78, v76, s99
    v_perm_b32 v56, v67, v65, s98
    v_perm_b32 v57, v71, v69, s98
    v_perm_b32 v58, v75, v73, s98
    v_perm_b32 v59, v79, v77, s98
    v_perm_b32 v60, v67, v65, s99
    v_perm_b32 v61, v71, v69, s99
    v_perm_b32 v62, v75, v73, s99
    v_perm_b32 v63, v79, v77, s99
    v_perm_b32 v64, v82, v80, s98
    v_perm_b32 v65, v86, v84, s98
    v_perm_b32 v66, v90, v88, s98
    v_perm_b32 v67, v94, v92, s98
    v_perm_b32 v68, v82, v80, s99
    v_perm_b32 v69, v86, v84, s99
    v_perm_b32 v70, v90, v88, s99
    v_perm_b32 v71, v94, v92, s99
    v_perm_b32 v72, v83, v81, s98
    v_perm_b32 v73, v87, v85, s98
    v_perm_b32 v74, v91, v89, s98
    v_perm_b32 v75, v95, v93, s98
    v_perm_b32 v76, v83, v81, s99
    v_perm_b32 v77, v87, v85, s99
    v_perm_b32 v78, v91, v89, s99
    v_perm_b32 v79, v95, v93, s99
    v_perm_b32 v80, v98, v96, s98
    v_perm_b32 v81, v102, v100, s98
    v_perm_b32 v82, v106, v104, s98
    v_perm_b32 v83, v110, v108, s98
    v_perm_b32 v84, v98, v96, s99
    v_perm_b32 v85, v102, v100, s99
    v_perm_b32 v86, v106, v104, s99
    v_perm_b32 v87, v110, v108, s99
    v_perm_b32 v88, v99, v97, s98
    v_perm_b32 v89, v103, v101, s98
    v_perm_b32 v90, v107, v105, s98
    v_perm_b32 v91, v111, v109, s98
    v_perm_b32 v92, v99, v97, s99
    v_perm_b32 v93, v103, v101, s99
    v_perm_b32 v94, v107, v105, s99
    v_perm_b32 v95, v111, v109, s99
    v_perm_b32 v96, v114, v112, s98
    v_perm_b32 v97, v118, v116, s98
    v_perm_b32 v98, v122, v120, s98
    v_perm_b32 v99, v126, v124, s98
    v_perm_b32 v100, v114, v112, s99
    v_perm_b32 v101, v118, v116, s99
    v_perm_b32 v102, v122, v120, s99
    v_perm_b32 v103, v126, v124, s99
    v_perm_b32 v104, v115, v113, s98
    v_perm_b32 v105, v119, v117, s98
    v_perm_b32 v106, v123, v121, s98
    v_perm_b32 v107, v127, v125, s98
    v_perm_b32 v108, v115, v113, s99
    v_perm_b32 v109, v119, v117, s99
    v_perm_b32 v110, v123, v121, s99
    v_perm_b32 v111, v127, v125, s99
    s_lshl_b32 s92, s86, 9
    s_add_u32 s92, s92, 17088
    v_and_b32 v6, 7, v2
    v_lshl_add_u32 v7, v6, 4, s92
    v_lshl_add_u32 v7, v3, 7, v7
    s_lshl_b32 s92, s87, 6
    v_add_u32 v11, s92, v1
    v_lshrrev_b32 v8, 5, v11
    v_and_b32 v9, 31, v11
    v_and_b32 v10, 3, v9
    v_lshlrev_b32 v10, 9, v10
    v_lshrrev_b32 v9, 2, v9
    v_lshl_add_u32 v10, v9, 4, v10
    v_lshrrev_b32 v9, 2, v8
    v_lshl_add_u32 v10, v9, 8, v10
    v_and_b32 v9, 3, v8
    v_lshl_add_u32 v10, v9, 2, v10
    v_lshlrev_b32 v11, 1, v11
    s_lshl_b32 s92, s87, 11
    v_lshl_add_u32 v9, v1, 4, s92
W_102:
    s_sleep 2
    ds_read_b32 v12, v4 offset:768
    s_sub_u32 s39, s39, 1
    s_cbranch_scc1 KS_ABORT
    s_waitcnt lgkmcnt(0)
    v_cmp_eq_u32 vcc, 0, v12
    s_cbranch_vccnz W_102
    s_setprio 2
W_103:
    ds_read_b32 v12, v4 offset:32
    s_sub_u32 s39, s39, 1
    s_cbranch_scc1 KS_ABORT
    s_waitcnt lgkmcnt(0)
    v_cmp_eq_u32 vcc, 0, v12
    s_cbranch_vccnz W_103
    ds_read_b128 v[12:15], v7 offset:0
    ds_read_b128 v[16:19], v7 offset:512
    ds_read_b128 v[20:23], v7 offset:1024
    ds_read_b128 v[24:27], v7 offset:1536
    ds_read_b128 v[28:31], v7 offset:2048
    s_waitcnt lgkmcnt(4)
    v_mfma_f32_16x16x32_bf16 v[112:115], v[12:15], v[32:35], 0
    v_mfma_f32_16x16x32_bf16 v[116:119], v[12:15], v[36:39], 0
    v_mfma_f32_16x16x32_bf16 v[120:123], v[12:15], v[40:43], 0
    v_mfma_f32_16x16x32_bf16 v[124:127], v[12:15], v[44:47], 0
    s_waitcnt lgkmcnt(3)
    v_mfma_f32_16x16x32_bf16 v[112:115], v[16:19], v[48:51], v[112:115]
    v_mfma_f32_16x16x32_bf16 v[116:119], v[16:19], v[52:55], v[116:119]
    v_mfma_f32_16x16x32_bf16 v[120:123], v[16:19], v[56:59], v[120:123]
    v_mfma_f32_16x16x32_bf16 v[124:127], v[16:19], v[60:63], v[124:127]
    s_waitcnt lgkmcnt(2)
    v_mfma_f32_16x16x32_bf16 v[112:115], v[20:23], v[64:67], v[112:115]
    v_mfma_f32_16x16x32_bf16 v[116:119], v[20:23], v[68:71], v[116:119]
    v_mfma_f32_16x16x32_bf16 v[120:123], v[20:23], v[72:75], v[120:123]
    v_mfma_f32_16x16x32_bf16 v[124:127], v[20:23], v[76:79], v[124:127]
    s_waitcnt lgkmcnt(1)
    v_mfma_f32_16x16x32_bf16 v[112:115], v[24:27], v[80:83], v[112:115]
    v_mfma_f32_16x16x32_bf16 v[116:119], v[24:27], v[84:87], v[116:119]
    v_mfma_f32_16x16x32_bf16 v[120:123], v[24:27], v[88:91], v[120:123]
    v_mfma_f32_16x16x32_bf16 v[124:127], v[24:27], v[92:95], v[124:127]
    s_bitcmp1_b32 s87, 0
    s_cbranch_scc1 KS_G5
    s_waitcnt lgkmcnt(0)
    v_mfma_f32_16x16x32_bf16 v[112:115], v[28:31], v[96:99], v[112:115]
    v_mfma_f32_16x16x32_bf16 v[116:119], v[28:31], v[100:103], v[116:119]
    v_mfma_f32_16x16x32_bf16 v[120:123], v[28:31], v[104:107], v[120:123]
    v_mfma_f32_16x16x32_bf16 v[124:127], v[28:31], v[108:111], v[124:127]
KS_G5:
    s_mov_b32 exec_lo, -1
    s_mov_b32 exec_hi, 0
    s_nop 5
    ds_write_b128 v9, v[112:115] offset:26368
    ds_write_b128 v9, v[116:119] offset:26880
    ds_write_b128 v9, v[120:123] offset:27392
    ds_write_b128 v9, v[124:127] offset:27904
    s_mov_b64 exec, -1
    s_waitcnt lgkmcnt(0)
    s_barrier
    ds_read_b32 v32, v10 offset:26368
    ds_read_b32 v33, v10 offset:26496
    ds_read_b32 v34, v10 offset:28416
    ds_read_b32 v35, v10 offset:28544
    ds_read_b32 v36, v10 offset:30464
    ds_read_b32 v37, v10 offset:30592
    ds_read_b32 v38, v10 offset:32512
    ds_read_b32 v39, v10 offset:32640
    s_waitcnt lgkmcnt(4)
    v_pk_add_f32 v[32:33], v[32:33], v[34:35]
    s_waitcnt lgkmcnt(0)
    v_pk_add_f32 v[36:37], v[36:37], v[38:39]
    v_pk_add_f32 v[32:33], v[32:33], v[36:37]
    v_cvt_pk_bf16_f32 v34, v32, v33
    v_lshlrev_b32 v32, 16, v34
    v_and_b32 v33, 0xffff0000, v34
    v_mul_f32 v34, 0xbfb8aa3b, v32
    v_exp_f32 v34, v34
    s_nop 0
    v_add_f32 v34, 1.0, v34
    v_rcp_f32 v34, v34
    s_nop 0
    v_mul_f32 v34, v32, v34
    v_cvt_pk_bf16_f32 v34, v34, v34
    v_lshlrev_b32 v34, 16, v34
    v_mul_f32 v34, v34, v33
    v_cvt_pk_bf16_f32 v34, v34, v34
    ds_write_b16 v11, v34 offset:1024
    s_waitcnt lgkmcnt(0)
    s_barrier
    s_branch KS_P2
KS_P:
    s_mov_b32 s68, s30
    s_mov_b32 s69, s31
    s_mov_b32 s70, 0x510000
    s_mov_b32 s71, 0x20000
    s_sub_u32 s94, s38, 10
    v_lshlrev_b32 v6, 4, v1
    s_mul_i32 s92, s89, 36864
    s_mul_i32 s93, s94, 18432
    s_add_u32 s92, s92, s93
    s_add_u32 s93, s93, 109184
    s_lshl_b32 s94, s94, 1
    v_mov_b32 v7, s94
    v_mov_b32 v8, s84
W_104:
    s_sleep 2
    ds_read_b32 v10, v4 offset:20
    s_sub_u32 s39, s39, 1
    s_cbranch_scc1 KS_ABORT
    s_waitcnt lgkmcnt(0)
    v_cmp_ne_u32 vcc, s84, v10
    s_cbranch_vccnz W_104
    s_setprio 1
    s_add_u32 m0, s93, 0
    s_nop 0
    buffer_load_dwordx4 v6, s[68:71], s92 offen offset:0 lds
    buffer_load_dwordx4 v6, s[68:71], s92 offen offset:1024 lds
    buffer_load_dwordx4 v6, s[68:71], s92 offen offset:2048 lds
    buffer_load_dwordx4 v6, s[68:71], s92 offen offset:3072 lds
    s_add_u32 m0, s93, 4096
    s_add_u32 s92, s92, 4096
    buffer_load_dwordx4 v6, s[68:71], s92 offen offset:0 lds
    buffer_load_dwordx4 v6, s[68:71], s92 offen offset:1024 lds
    buffer_load_dwordx4 v6, s[68:71], s92 offen offset:2048 lds
    buffer_load_dwordx4 v6, s[68:71], s92 offen offset:3072 lds
    s_add_u32 m0, s93, 8192
    s_add_u32 s92, s92, 4096
    buffer_load_dwordx4 v6, s[68:71], s92 offen offset:0 lds
    buffer_load_dwordx4 v6, s[68:71], s92 offen offset:1024 lds
    buffer_load_dwordx4 v6, s[68:71], s92 offen offset:2048 lds
    buffer_load_dwordx4 v6, s[68:71], s92 offen offset:3072 lds
    s_add_u32 m0, s93, 12288
    s_add_u32 s92, s92, 4096
    buffer_load_dwordx4 v6, s[68:71], s92 offen offset:0 lds
    buffer_load_dwordx4 v6, s[68:71], s92 offen offset:1024 lds
    buffer_load_dwordx4 v6, s[68:71], s92 offen offset:2048 lds
    buffer_load_dwordx4 v6, s[68:71], s92 offen offset:3072 lds
    s_add_u32 m0, s93, 16384
    s_add_u32 s92, s92, 4096
    buffer_load_dwordx4 v6, s[68:71], s92 offen offset:0 lds
    buffer_load_dwordx4 v6, s[68:71], s92 offen offset:1024 lds
    s_waitcnt vmcnt(0)
    ds_write_b16 v7, v8 offset:40
    s_setprio 0
    s_waitcnt lgkmcnt(0)
    s_barrier
    s_barrier
    s_setprio 2
KS_P2:
    s_sub_u32 s87, s38, 10
    s_add_u32 s64, s36, 0x850000
    s_addc_u32 s65, s37, 0
    s_mov_b32 s66, 0x288000
    s_mov_b32 s67, 0x20000
    s_mov_b32 s68, s32
    s_mov_b32 s69, s33
    s_mov_b32 s70, 0x240000
    s_mov_b32 s71, 0x20000
    v_lshrrev_b32 v8, 3, v1
    v_mul_u32_u24 v8, 18432, v8
    v_and_b32 v9, 7, v1
    v_lshl_add_u32 v8, v9, 4, v8
    s_mul_i32 s92, s87, 442368
    s_lshl_b32 s93, s89, 7
    s_add_u32 s92, s92, s93
    s_add_u32 s93, s92, 147456
    s_add_u32 s94, s92, 294912
    s_lshl_b32 s95, s87, 7
    v_lshl_add_u32 v6, v9, 4, s95
    v_lshl_add_u32 v6, v3, 2, v6
    v_lshlrev_b32 v12, 2, v1
    v_add_u32 v12, 2048, v12
    v_lshlrev_b32 v13, 4, v1
    s_barrier
    s_branch ZPE_106
ZP_105:
    s_sleep 1
ZPE_106:
    buffer_load_dwordx4 v[32:35], v8, s[64:67], s92 offen sc1
    buffer_load_dwordx4 v[36:39], v8, s[64:67], s93 offen sc1
    buffer_load_dwordx4 v[40:43], v8, s[64:67], s94 offen sc1
    s_sub_u32 s39, s39, 1
    s_cbranch_scc1 KS_ABORT
    s_waitcnt vmcnt(0)
    v_max3_u32 v44, v32, v33, v34
    v_max3_u32 v44, v44, v35, v36
    v_max3_u32 v44, v44, v37, v38
    v_max3_u32 v44, v44, v39, v40
    v_max3_u32 v44, v44, v41, v42
    v_max_u32 v44, v44, v43
    v_cmp_eq_u32 vcc, -1, v44
    s_cbranch_vccnz ZP_105
    v_pk_add_f32 v[32:33], v[32:33], v[36:37]
    v_pk_add_f32 v[34:35], v[34:35], v[38:39]
    v_pk_add_f32 v[32:33], v[32:33], v[40:41]
    v_pk_add_f32 v[34:35], v[34:35], v[42:43]
    s_nop 0
    v_add_f32_dpp v32, v32, v32 row_ror:8 row_mask:0xf bank_mask:0xf
    v_add_f32_dpp v33, v33, v33 row_ror:8 row_mask:0xf bank_mask:0xf
    v_add_f32_dpp v34, v34, v34 row_ror:8 row_mask:0xf bank_mask:0xf
    v_add_f32_dpp v35, v35, v35 row_ror:8 row_mask:0xf bank_mask:0xf
    v_permlane16_swap_b32 v32, v33
    s_nop 0
    v_permlane16_swap_b32 v34, v35
    v_add_f32 v32, v32, v33
    v_add_f32 v34, v34, v35
    s_nop 1
    v_permlane32_swap_b32 v32, v34
    v_add_f32 v32, v32, v34
    ds_write_b32 v6, v32 offset:2048
    s_waitcnt lgkmcnt(0)
    s_barrier
    s_cmp_lg_u32 s87, 0
    s_cbranch_scc1 KS_PEND
    s_mov_b32 exec_lo, -1
    s_mov_b32 exec_hi, 0
    ds_read2_b32 v[32:33], v12 offset0:0 offset1:32
    ds_read2_b32 v[34:35], v12 offset0:64 offset1:96
    ds_read2_b32 v[36:37], v12 offset0:128 offset1:160
    ds_read_b128 v[40:43], v13 offset:1536
    s_waitcnt lgkmcnt(0)
    v_pk_add_f32 v[32:33], v[32:33], v[34:35]
    v_pk_add_f32 v[32:33], v[32:33], v[36:37]
    v_add_f32 v8, v32, v33
    v_cvt_pk_bf16_f32 v8, v8, v8
    v_lshlrev_b32 v8, 16, v8
    v_mul_f32 v8, v8, v42
    v_cvt_pk_bf16_f32 v8, v8, v8
    v_lshlrev_b32 v8, 16, v8
    v_add_f32 v8, v8, v40
    v_cvt_pk_bf16_f32 v8, v8, v8
    v_lshlrev_b32 v8, 16, v8
    v_add_f32 v8, v8, v41
    v_cvt_pk_bf16_f32 v8, v8, v8
    buffer_store_short v8, v43, s[68:71], 0 offen
KS_PEND:
KS_ABORT:
KS_END:
    s_endpgm
.section .rodata,"a"
.p2align 6
.amdhsa_kernel sequential_preLN__ssm_conv_s4__moe_arch_mod__prompt_kernel
  .amdhsa_next_free_vgpr 128
  .amdhsa_next_free_sgpr 100
  .amdhsa_accum_offset 128
  .amdhsa_group_segment_fixed_size 0
  .amdhsa_kernarg_size 136
  .amdhsa_user_sgpr_count 2
  .amdhsa_user_sgpr_kernarg_segment_ptr 1
  .amdhsa_system_sgpr_workgroup_id_x 1
  .amdhsa_float_denorm_mode_32 3
.end_amdhsa_kernel
```

```asm
; @launch grid=(256,1,1) block=(1024,1,1) lds=154240
.amdgcn_target "amdgcn-amd-amdhsa--gfx950"
.text
.globl sequential_preLN__ssm_conv_s4__moe_arch_mod__prompt_kernel
.p2align 8
.type sequential_preLN__ssm_conv_s4__moe_arch_mod__prompt_kernel,@function
sequential_preLN__ssm_conv_s4__moe_arch_mod__prompt_kernel:
    s_cmp_ge_u32 s2, 256
    s_cbranch_scc1 KS_END
    s_load_dwordx16 s[4:19], s[0:1], 0
    s_load_dwordx16 s[20:35], s[0:1], 64
    s_load_dwordx2 s[36:37], s[0:1], 128
    v_readfirstlane_b32 s38, v0
    s_lshr_b32 s38, s38, 6
    s_and_b32 s40, s2, 7
    s_lshr_b32 s41, s2, 3
    s_cmp_lg_u32 s38, 0
    s_cbranch_scc1 KS_CPE
    s_getpc_b64 s[42:43]
KS_PC:
    s_and_b32 s92, s41, 3
    s_lshl_b32 s92, s92, 13
    v_lshl_add_u32 v126, v0, 7, s92
    v_min_u32 v126, KS_END-KS_PC, v126
    global_load_dword v127, v126, s[42:43]
KS_CPE:
    s_add_u32 s92, s38, 8
    s_sub_u32 s93, s38, 4
    s_cmp_lt_u32 s38, 8
    s_cselect_b32 s92, s92, s93
    s_cmp_lt_u32 s38, 4
    s_cselect_b32 s38, s38, s92
    v_and_b32 v1, 63, v0
    v_and_b32 v2, 15, v1
    v_lshrrev_b32 v3, 4, v1
    v_mov_b32 v4, 0
    v_mov_b32 v5, 1
    s_mov_b32 s39, 524288
    s_mov_b32 s84, 0x01010101
    s_lshl_b32 s90, s40, 5
    s_add_u32 s90, s90, s41
    s_mul_i32 s89, s40, 18
    s_add_u32 s89, s89, s41
    s_cmp_lt_u32 s38, 4
    s_cbranch_scc1 KS_L
    s_cmp_ge_u32 s38, 12
    s_cbranch_scc1 KS_X
    s_setprio 2
    s_lshr_b32 s87, s38, 2
    s_sub_u32 s87, s87, 1
    s_mul_i32 s86, s87, 3
    s_xor_b32 s86, s86, s38
    s_and_b32 s86, s86, 3
    s_lshl_b32 s88, s90, 1
    s_add_u32 s88, s88, s87
    s_lshl_b32 s92, s86, 11
    s_add_u32 s92, s92, 146048
    v_lshl_add_u32 v28, v1, 3, s92
    s_cmp_eq_u32 s86, 3
    s_cbranch_scc1 PX_1
    v_lshlrev_b32 v26, 3, v2
    v_mov_b32 v21, 0x80
    s_cmp_eq_u32 s86, 1
    s_cbranch_scc1 PX_2
    s_cmp_eq_u32 s86, 2
    s_cbranch_scc1 PX_3
    v_lshl_add_u32 v26, v3, 1, v26
    v_mov_b32 v22, 1
    s_branch PX_4
PX_2:
    v_cmp_gt_u32 vcc, 2, v3
    v_lshl_add_u32 v20, v3, 2, v26
    v_add_u32 v20, 256, v20
    v_lshl_add_u32 v26, v3, 8, v26
    v_cndmask_b32 v26, v26, v20, vcc
    v_cndmask_b32 v22, v21, 2, vcc
    v_cndmask_b32 v21, 4, v21, vcc
    s_branch PX_4
PX_3:
    v_lshl_add_u32 v26, v3, 9, v26
    v_add_u32 v26, 0x400, v26
    v_mov_b32 v22, 0x100
PX_4:
    v_mad_u32_u24 v26, v22, s87, v26
    v_add_u32 v27, v26, v21
    s_movk_i32 s96, 31232
    s_movk_i32 s97, -19072
    s_lshl_b32 s95, s87, 9
    v_cvt_f32_u32 v20, v26
    v_max_u32 v22, 0x800, v26
    v_cvt_f32_u32 v21, v27
    v_max_u32 v23, 0x800, v27
    v_cmp_gt_u32 vcc, 0x80, v26
    v_lshrrev_b32 v24, 16, v20
    v_add3_u32 v24, v24, v22, s97
    v_cndmask_b32 v24, v24, v26, vcc
    v_cmp_gt_u32 vcc, 0x80, v27
    v_lshrrev_b32 v25, 16, v21
    v_add3_u32 v25, v25, v23, s97
    v_cndmask_b32 v25, v25, v27, vcc
    v_min_u32 v24, 642, v24
    v_lshl_add_u32 v24, v24, 1, s96
    v_min_u32 v25, 642, v25
    v_lshl_add_u32 v25, v25, 1, s96
    v_add_u32 v29, s95, v28
    v_lshl_or_b32 v24, v25, 16, v24
    v_lshl_or_b32 v25, v27, 16, v26
    ds_write_b64 v29, v[24:25]
PX_1:
KS_GRP:
    s_lshl_b32 s92, s88, 8
    v_lshl_add_u32 v20, v1, 2, s92
    s_lshl_b32 s92, s88, 1
    v_mov_b32 v21, s92
    s_mul_i32 s85, s87, 36672
    s_add_u32 s85, s85, 35840
    s_waitcnt lgkmcnt(0)
    global_load_ushort v46, v21, s[18:19]
    global_load_dword v40, v20, s[6:7]
    global_load_dword v41, v20, s[8:9]
    global_load_dword v42, v20, s[10:11]
    global_load_dword v43, v20, s[12:13]
    global_load_dword v44, v20, s[14:15]
    global_load_dword v45, v20, s[16:17]
    global_load_ushort v107, v21, s[20:21]
    s_barrier
    s_movk_i32 s96, 31232
    s_cmp_eq_u32 s87, 2
    s_cbranch_scc1 PREE_7
    v_mov_b32 v32, 641
    s_cmp_eq_u32 s87, 1
    s_cbranch_scc1 PREB_5
    v_mov_b32 v33, 32514
    s_cmp_eq_u32 s86, 1
    s_cbranch_scc1 PRE_9
    s_cmp_eq_u32 s86, 2
    s_cbranch_scc1 PRE_10
    s_cmp_eq_u32 s86, 3
    s_cbranch_scc1 PRE_11
    v_lshlrev_b32 v23, 1, v1
    v_sub_u32 v30, 93, v23
    v_cmp_lt_u32 vcc, 61, v30
    v_lshlrev_b32 v31, 2, v30
    v_add_u32 v31, 32010, v31
    v_cndmask_b32 v24, v31, v33, vcc
    v_sub_u32 v30, 92, v23
    v_cmp_lt_u32 vcc, 61, v30
    v_lshlrev_b32 v31, 2, v30
    v_add_u32 v31, 32010, v31
    v_cndmask_b32 v25, v31, v33, vcc
    v_sub_u32 v30, 94, v23
    v_cmp_lt_u32 vcc, 62, v30
    v_lshlrev_b32 v31, 2, v30
    v_add_u32 v31, 32008, v31
    v_cndmask_b32 v26, v31, v33, vcc
    v_sub_u32 v30, 93, v23
    v_cmp_lt_u32 vcc, 62, v30
    v_lshlrev_b32 v31, 2, v30
    v_add_u32 v31, 32008, v31
    v_cndmask_b32 v27, v31, v33, vcc
    s_branch PREW_6
PRE_9:
    v_min_u32 v23, 47, v1
    v_lshlrev_b32 v23, 1, v23
    v_sub_u32 v30, 64, v23
    v_cmp_lt_u32 vcc, 63, v30
    v_lshlrev_b32 v31, 2, v30
    v_add_u32 v31, 32258, v31
    v_cndmask_b32 v24, v31, v33, vcc
    v_sub_u32 v30, 63, v23
    v_cmp_lt_u32 vcc, 63, v30
    v_lshlrev_b32 v31, 2, v30
    v_add_u32 v31, 32258, v31
    v_cndmask_b32 v25, v31, v33, vcc
    v_sub_u32 v30, 62, v23
    v_cmp_lt_u32 vcc, 63, v30
    v_lshlrev_b32 v31, 2, v30
    v_add_u32 v31, 32258, v31
    v_cndmask_b32 v27, v31, v33, vcc
    v_mov_b32 v26, v25
    s_branch PREW_6
PRE_10:
    v_min_u32 v23, 47, v1
    v_lshlrev_b32 v23, 1, v23
    v_sub_u32 v30, 64, v23
    v_cmp_lt_u32 vcc, 63, v30
    v_lshlrev_b32 v31, 2, v30
    v_add_u32 v31, 32260, v31
    v_cndmask_b32 v24, v31, v33, vcc
    v_sub_u32 v30, 63, v23
    v_cmp_lt_u32 vcc, 63, v30
    v_lshlrev_b32 v31, 2, v30
    v_add_u32 v31, 32260, v31
    v_cndmask_b32 v25, v31, v33, vcc
    v_sub_u32 v30, 62, v23
    v_cmp_lt_u32 vcc, 63, v30
    v_lshlrev_b32 v31, 2, v30
    v_add_u32 v31, 32260, v31
    v_cndmask_b32 v27, v31, v33, vcc
    v_mov_b32 v26, v25
    s_branch PREW_6
PRE_11:
    v_cmp_gt_u32 vcc, 9, v1
    v_add_u32 v23, 0x100, v1
    v_mov_b32 v33, 0x200
    v_cndmask_b32 v23, v23, v1, vcc
    v_lshlrev_b32 v23, 1, v23
    v_sub_u32 v30, 544, v23
    v_cvt_f32_i32 v31, v30
    v_cmp_gt_u32 vcc, 0x100, v30
    v_cvt_pk_bf16_f32 v31, v31, v31
    v_and_b32 v31, 0xffff, v31
    v_subrev_u32 v31, 0x4280, v31
    v_cndmask_b32 v31, v31, v30, vcc
    v_cmp_lt_u32 vcc, 0x20d, v30
    v_or_b32 v30, 1, v23
    s_nop 0
    v_cndmask_b32 v31, v31, v32, vcc
    v_cmp_eq_u32 vcc, 0x25d, v30
    s_nop 1
    v_cndmask_b32 v31, v31, v33, vcc
    v_lshl_add_u32 v24, v31, 1, s96
    v_add_u32 v23, 1, v23
    v_sub_u32 v30, 544, v23
    v_cvt_f32_i32 v31, v30
    v_cmp_gt_u32 vcc, 0x100, v30
    v_cvt_pk_bf16_f32 v31, v31, v31
    v_and_b32 v31, 0xffff, v31
    v_subrev_u32 v31, 0x4280, v31
    v_cndmask_b32 v31, v31, v30, vcc
    v_cmp_lt_u32 vcc, 0x20d, v30
    v_or_b32 v30, 1, v23
    s_nop 0
    v_cndmask_b32 v31, v31, v32, vcc
    v_cmp_eq_u32 vcc, 0x25d, v30
    s_nop 1
    v_cndmask_b32 v31, v31, v33, vcc
    v_lshl_add_u32 v25, v31, 1, s96
    v_add_u32 v23, 1, v23
    v_sub_u32 v30, 544, v23
    v_cvt_f32_i32 v31, v30
    v_cmp_gt_u32 vcc, 0x100, v30
    v_cvt_pk_bf16_f32 v31, v31, v31
    v_and_b32 v31, 0xffff, v31
    v_subrev_u32 v31, 0x4280, v31
    v_cndmask_b32 v31, v31, v30, vcc
    v_cmp_lt_u32 vcc, 0x20d, v30
    v_or_b32 v30, 1, v23
    s_nop 0
    v_cndmask_b32 v31, v31, v32, vcc
    v_cmp_eq_u32 vcc, 0x25d, v30
    s_nop 1
    v_cndmask_b32 v31, v31, v33, vcc
    v_lshl_add_u32 v27, v31, 1, s96
    v_mov_b32 v26, v25
    s_branch PREW_6
PREB_5:
    s_lshl_b32 s93, s86, 7
    s_add_u32 s93, s93, 18
    v_lshl_add_u32 v23, v1, 1, s93
    v_sub_u32 v30, 544, v23
    v_cvt_f32_i32 v31, v30
    v_cmp_gt_u32 vcc, 0x100, v30
    v_cvt_pk_bf16_f32 v31, v31, v31
    v_and_b32 v31, 0xffff, v31
    v_subrev_u32 v31, 0x4280, v31
    v_cndmask_b32 v31, v31, v30, vcc
    v_cmp_lt_u32 vcc, 0x20d, v30
    s_nop 1
    v_cndmask_b32 v31, v31, v32, vcc
    v_lshl_add_u32 v24, v31, 1, s96
    v_add_u32 v23, 1, v23
    v_sub_u32 v30, 544, v23
    v_cvt_f32_i32 v31, v30
    v_cmp_gt_u32 vcc, 0x100, v30
    v_cvt_pk_bf16_f32 v31, v31, v31
    v_and_b32 v31, 0xffff, v31
    v_subrev_u32 v31, 0x4280, v31
    v_cndmask_b32 v31, v31, v30, vcc
    v_cmp_lt_u32 vcc, 0x20d, v30
    s_nop 1
    v_cndmask_b32 v31, v31, v32, vcc
    v_lshl_add_u32 v25, v31, 1, s96
    v_add_u32 v23, 1, v23
    v_sub_u32 v30, 544, v23
    v_cvt_f32_i32 v31, v30
    v_cmp_gt_u32 vcc, 0x100, v30
    v_cvt_pk_bf16_f32 v31, v31, v31
    v_and_b32 v31, 0xffff, v31
    v_subrev_u32 v31, 0x4280, v31
    v_cndmask_b32 v31, v31, v30, vcc
    v_cmp_lt_u32 vcc, 0x20d, v30
    s_nop 1
    v_cndmask_b32 v31, v31, v32, vcc
    v_lshl_add_u32 v26, v31, 1, s96
    s_sub_u32 s93, s86, 1
    s_cmp_lt_u32 s93, 2
    s_cselect_b32 s94, 47, 63
    s_mul_i32 s93, s93, 384
    s_add_u32 s93, s93, 35664
    s_cmp_eq_u32 s86, 0
    s_cselect_b32 s93, 35152, s93
    s_cmp_eq_u32 s86, 3
    s_cselect_b32 s93, 32528, s93
    s_cselect_b32 s95, 0x100, 0
    v_cmp_gt_u32 vcc, 9, v1
    v_min_u32 v23, s94, v1
    v_add_u32 v30, s95, v23
    v_cndmask_b32 v23, v30, v23, vcc
    v_lshl_add_u32 v27, v23, 2, s93
    v_lshl_or_b32 v24, v25, 16, v24
    v_lshl_or_b32 v25, v27, 16, v26
    ds_write_b64 v28, v[24:25] offset:1024
    v_mov_b32 v24, s86
    ds_write_b8 v24, v5 offset:212
    s_branch PREE_7
PREW_6:
    v_lshl_or_b32 v24, v25, 16, v24
    v_lshl_or_b32 v25, v27, 16, v26
    ds_write_b64 v28, v[24:25] offset:1536
    v_mov_b32 v24, s86
    ds_write_b8 v24, v5 offset:208
PREE_7:
    s_mul_i32 s93, s86, 8704
    s_min_u32 s94, s93, 22304
    s_add_u32 s94, s94, s85
    s_lshl_b32 s92, s87, 4
    v_mov_b32 v14, s92
    v_add_u32 v15, s86, v14
    v_lshl_add_u32 v72, v1, 3, s94
    v_add_u32 v73, 2176, v72
    v_add_u32 v74, 4352, v72
    v_add_u32 v75, 6528, v72
    v_mul_u32_u24 v126, 544, v2
    v_lshl_add_u32 v126, v3, 4, v126
    v_add_u32 v126, s85, v126
    v_add_u32 v127, s93, v126
    v_lshlrev_b32 v20, 3, v3
    v_sub_u32 v20, v20, v2
    v_add_u32 v21, 16, v20
    v_lshrrev_b32 v21, 1, v21
    v_and_b32 v22, 1, v2
    s_add_u32 s92, s85, 32528
    v_lshl_add_u32 v21, v21, 2, s92
    s_movk_i32 s92, 1344
    s_movk_i32 s94, 192
    v_mad_u32_u24 v6, v22, s92, v21
    v_add_u32 v7, 640, v6
    v_mad_u32_u24 v23, v22, s94, v21
    v_add_u32 v13, 3136, v23
    v_lshlrev_b32 v23, 2, v3
    v_sub_u32 v23, v23, v2
    s_add_u32 s92, s85, 35212
    v_lshl_add_u32 v11, v23, 2, s92
    s_mul_i32 s94, s87, 4672
    s_add_u32 s94, s94, 3072
    v_lshl_add_u32 v23, v2, 5, s94
    v_lshl_add_u32 v8, v3, 4, v23
    v_bfe_u32 v20, v1, 2, 2
    v_and_b32 v21, 3, v1
    v_lshl_add_u32 v20, v3, 3, v20
    v_lshlrev_b32 v105, 2, v21
    v_lshl_add_u32 v21, v21, 3, s85
    v_lshl_add_u32 v9, v20, 4, v21
    v_lshl_add_u32 v10, v20, 5, v21
    v_lshlrev_b32 v12, 4, v1
    s_add_u32 s64, s36, 0x600000
    s_addc_u32 s65, s37, 0
    s_mov_b32 s66, 0x240000
    s_mov_b32 s67, 0x20000
    s_mov_b32 s10, 0x8080
    s_lshl_b32 s92, s86, 19
    s_lshl_b32 s93, s90, 6
    s_add_u32 s92, s92, s93
    s_lshl_b32 s93, s86, 16
    s_lshl_b32 s95, s88, 6
    s_add_u32 s93, s93, s95
    s_add_u32 s93, s93, 2064384
    s_cmp_eq_u32 s87, 2
    s_cselect_b32 s6, s93, s92
    s_cselect_b32 s8, 0x1080, s10
    s_cselect_b32 s92, 1, 3
    s_and_b32 s92, s92, s86
    s_lshl_b32 s92, s92, 11
    s_xor_b32 s6, s6, s92
    s_and_b32 s10, s6, 0x7c0
    s_xor_b32 s6, s6, s10
    s_xor_b32 s7, s6, 0x6000
    s_and_b32 s9, s87, 1
    s_lshl_b32 s9, s9, 4
    s_mov_b32 s12, 0x55555555
    s_mov_b32 s13, 0x55555555
    s_lshl_b32 s92, s86, 8
    s_add_u32 s92, s92, s85
    s_add_u32 s92, s92, 36
    v_lshl_add_u32 v124, v1, 2, s92
    s_movk_i32 s92, 192
    s_cmp_eq_u32 s86, 0
    s_cselect_b32 s92, 256, s92
    s_cmp_eq_u32 s86, 3
    s_cselect_b32 s92, 1344, s92
    v_mov_b32 v20, s85
    ds_write_b16 v20, v4 offset:32514
    s_mov_b32 s18, s92
    v_mov_b32 v125, v28
W_12:
    ds_read_b64 v[18:19], v4 offset:208
    s_sub_u32 s39, s39, 1
    s_cbranch_scc1 KS_ABORT
    s_waitcnt lgkmcnt(0)
    v_and_b32 v18, v18, v19
    v_cmp_ne_u32 vcc, s84, v18
    s_cbranch_vccnz W_12
    ds_read2st64_b64 v[28:31], v125 offset0:0 offset1:1
    ds_read2st64_b64 v[32:35], v125 offset0:2 offset1:3
    s_waitcnt lgkmcnt(0)
    v_add_u32_sdwa v108, s85, v28 dst_sel:DWORD dst_unused:UNUSED_PAD src0_sel:DWORD src1_sel:WORD_0
    v_add_u32_sdwa v109, s85, v28 dst_sel:DWORD dst_unused:UNUSED_PAD src0_sel:DWORD src1_sel:WORD_1
    v_cvt_f32_u32_sdwa v110, v29 dst_sel:DWORD dst_unused:UNUSED_PAD src0_sel:WORD_0
    v_cvt_f32_u32_sdwa v111, v29 dst_sel:DWORD dst_unused:UNUSED_PAD src0_sel:WORD_1
    v_add_u32_sdwa v112, s85, v30 dst_sel:DWORD dst_unused:UNUSED_PAD src0_sel:DWORD src1_sel:WORD_0
    v_add_u32_sdwa v113, s85, v30 dst_sel:DWORD dst_unused:UNUSED_PAD src0_sel:DWORD src1_sel:WORD_1
    v_cvt_f32_u32_sdwa v114, v31 dst_sel:DWORD dst_unused:UNUSED_PAD src0_sel:WORD_0
    v_cvt_f32_u32_sdwa v115, v31 dst_sel:DWORD dst_unused:UNUSED_PAD src0_sel:WORD_1
    v_add_u32_sdwa v116, s85, v32 dst_sel:DWORD dst_unused:UNUSED_PAD src0_sel:DWORD src1_sel:WORD_0
    v_add_u32_sdwa v117, s85, v32 dst_sel:DWORD dst_unused:UNUSED_PAD src0_sel:DWORD src1_sel:WORD_1
    v_add_u32_sdwa v118, s85, v33 dst_sel:DWORD dst_unused:UNUSED_PAD src0_sel:DWORD src1_sel:WORD_0
    v_add_u32_sdwa v119, s85, v33 dst_sel:DWORD dst_unused:UNUSED_PAD src0_sel:DWORD src1_sel:WORD_1
    v_add_u32_sdwa v120, s85, v34 dst_sel:DWORD dst_unused:UNUSED_PAD src0_sel:DWORD src1_sel:WORD_0
    v_add_u32_sdwa v121, s85, v34 dst_sel:DWORD dst_unused:UNUSED_PAD src0_sel:DWORD src1_sel:WORD_1
    v_add_u32_sdwa v122, s85, v35 dst_sel:DWORD dst_unused:UNUSED_PAD src0_sel:DWORD src1_sel:WORD_0
    v_add_u32_sdwa v123, s85, v35 dst_sel:DWORD dst_unused:UNUSED_PAD src0_sel:DWORD src1_sel:WORD_1
    v_add_u32 v125, s18, v119
    s_lshl_b32 s92, s87, 5
    s_add_u32 s92, s92, s41
    s_cmp_ge_u32 s92, 88
    s_cbranch_scc1 KC_RECV
    s_mov_b32 s92, 0x3fb8aa3b
    s_mov_b32 s93, 0x32a57060
    s_mov_b32 s94, 0x3e22f983
    s_mov_b32 s95, 0x31dc9c88
    s_waitcnt vmcnt(7)
    v_lshlrev_b32 v16, 16, v46
    v_mul_f32 v17, s92, v16
    v_fma_f32 v19, v16, s92, -v17
    v_fmac_f32 v19, s93, v16
    v_exp_f32 v17, v17
    v_mul_f32 v19, 0x3f317218, v19
    v_fmac_f32 v17, v17, v19
    v_cvt_pk_bf16_f32 v17, v17, v17
    v_and_b32 v16, 0xffff0000, v17
    s_waitcnt vmcnt(5)
    ds_write_b32 v4, v5 offset:36
    v_lshlrev_b32 v20, 16, v40
    v_and_b32 v21, 0xffff0000, v40
    v_lshlrev_b32 v22, 16, v41
    v_and_b32 v23, 0xffff0000, v41
    v_pk_mul_f32 v[20:21], v[20:21], v[16:17] op_sel_hi:[1,0]
    v_pk_mul_f32 v[22:23], v[22:23], v[16:17] op_sel_hi:[1,0]
    v_max_f32 v36, v20, v21
    v_pk_mul_f32 v[68:69], v[22:23], s[94:95] op_sel_hi:[1,0]
    v_pk_fma_f32 v[70:71], v[22:23], s[94:95], v[68:69] op_sel_hi:[1,0,1] neg_lo:[0,0,1] neg_hi:[0,0,1]
    v_pk_fma_f32 v[70:71], v[22:23], s[94:95], v[70:71] op_sel:[0,1,0]
    s_cmp_eq_u32 s86, 3
    s_cbranch_scc1 SK_14
    s_waitcnt vmcnt(1)
    v_lshlrev_b32 v24, 16, v42
    v_and_b32 v25, 0xffff0000, v42
    v_lshlrev_b32 v26, 16, v43
    v_and_b32 v27, 0xffff0000, v43
    v_lshlrev_b32 v28, 16, v44
    v_and_b32 v29, 0xffff0000, v44
    v_lshlrev_b32 v30, 16, v45
    v_and_b32 v31, 0xffff0000, v45
    v_pk_mul_f32 v[24:25], v[24:25], v[16:17] op_sel_hi:[1,0]
    v_pk_mul_f32 v[26:27], v[26:27], v[16:17] op_sel_hi:[1,0]
    v_pk_mul_f32 v[90:91], v[30:31], v[26:27]
    v_pk_mul_f32 v[92:93], v[30:31], v[24:25]
    v_pk_fma_f32 v[34:35], v[28:29], v[26:27], v[92:93]
    v_pk_fma_f32 v[32:33], v[28:29], v[24:25], v[90:91] neg_lo:[0,0,1] neg_hi:[0,0,1]
    v_max3_f32 v37, abs(v34), abs(v35), abs(v32)
    v_max_f32 v37, v37, abs(v33)
SK_14:
    s_waitcnt vmcnt(0)
    s_nop 0
    v_permlane32_swap_b32 v36, v37
    v_max_f32 v36, v36, v37
    s_nop 1
    v_max_f32_dpp v36, v36, v36 row_ror:8 row_mask:0xf bank_mask:0xf
    s_nop 1
    v_max_f32_dpp v36, v36, v36 row_ror:4 row_mask:0xf bank_mask:0xf
    s_nop 1
    v_max_f32_dpp v36, v36, v36 row_ror:2 row_mask:0xf bank_mask:0xf
    s_nop 1
    v_max_f32_dpp v36, v36, v36 row_ror:1 row_mask:0xf bank_mask:0xf
    v_mov_b32 v38, v36
    s_nop 1
    v_permlane16_swap_b32 v36, v38
    v_max_f32 v36, v36, v38
    s_nop 0
    v_readlane_b32 s14, v36, 0
    v_readlane_b32 s15, v36, 32
    s_add_u32 s15, s15, 0x7fffff
    s_lshr_b32 s15, s15, 23
    s_max_u32 s15, s15, 24
    s_sub_u32 s16, 269, s15
    s_lshl_b32 s16, s16, 23
    v_subrev_f32 v20, s14, v20
    v_subrev_f32 v21, s14, v21
    v_mul_f32 v20, 0x3fb8aa3b, v20
    v_mul_f32 v21, 0x3fb8aa3b, v21
    s_cmp_eq_u32 s86, 3
    s_cbranch_scc1 JOB_18
    s_cmp_eq_u32 s86, 1
    s_cbranch_scc1 JOB_16
    s_cmp_eq_u32 s86, 2
    s_cbranch_scc1 JOB_17
    v_mul_f32 v91, 0x43000000, v68
    v_mul_f32 v90, 0x43000000, v20
    v_mul_f32 v95, 0x43000000, v69
    v_mul_f32 v94, 0x43000000, v21
    v_fract_f32 v91, v91
    v_fract_f32 v95, v95
    v_fmac_f32 v91, 0x43000000, v70
    v_fmac_f32 v95, 0x43000000, v71
    v_exp_f32 v90, v90
    v_cos_f32 v92, v91
    v_sin_f32 v91, v91
    v_exp_f32 v94, v94
    v_cos_f32 v96, v95
    v_sin_f32 v95, v95
    v_mul_f32 v44, v90, v92
    v_mul_f32 v46, v90, v91
    v_mul_f32 v45, v94, v96
    v_mul_f32 v47, v94, v95
    v_pk_mul_f32 v[32:33], v[32:33], s[16:17] op_sel_hi:[1,0]
    v_pk_mul_f32 v[34:35], v[34:35], s[16:17] op_sel_hi:[1,0]
    v_fract_f32 v91, v68
    v_fract_f32 v95, v69
    v_fmac_f32 v91, 1.0, v70
    v_fmac_f32 v95, 1.0, v71
    v_exp_f32 v90, v20
    v_cos_f32 v92, v91
    v_sin_f32 v91, v91
    v_exp_f32 v94, v21
    v_cos_f32 v96, v95
    v_sin_f32 v95, v95
    v_mul_f32 v40, v90, v92
    v_mul_f32 v42, v90, v91
    v_mul_f32 v41, v94, v96
    v_mul_f32 v43, v94, v95
    v_pk_mul_f32 v[90:91], v[34:35], v[46:47]
    v_pk_mul_f32 v[94:95], v[34:35], v[42:43]
    v_pk_mul_f32 v[92:93], v[34:35], v[44:45]
    v_pk_mul_f32 v[96:97], v[34:35], v[40:41]
    v_pk_fma_f32 v[62:63], v[32:33], v[46:47], v[92:93]
    v_pk_fma_f32 v[54:55], v[32:33], v[42:43], v[96:97]
    v_pk_fma_f32 v[60:61], v[32:33], v[44:45], v[90:91] neg_lo:[0,0,1] neg_hi:[0,0,1]
    v_pk_fma_f32 v[52:53], v[32:33], v[40:41], v[94:95] neg_lo:[0,0,1] neg_hi:[0,0,1]
    v_cvt_pk_f16_f32 v98, v32, v34
    v_cvt_pk_f16_f32 v99, v33, v35
    v_cvt_pk_f16_f32 v100, v60, v62
    v_cvt_pk_f16_f32 v101, v61, v63
    ds_write2_b64 v72, v[98:99], v[100:101] offset0:0 offset1:68
    v_pk_mul_f32 v[90:91], v[54:55], v[46:47]
    v_pk_mul_f32 v[94:95], v[54:55], v[42:43]
    v_pk_mul_f32 v[92:93], v[54:55], v[44:45]
    v_pk_mul_f32 v[96:97], v[54:55], v[40:41]
    v_pk_fma_f32 v[62:63], v[52:53], v[46:47], v[92:93]
    v_pk_fma_f32 v[58:59], v[52:53], v[42:43], v[96:97]
    v_pk_fma_f32 v[60:61], v[52:53], v[44:45], v[90:91] neg_lo:[0,0,1] neg_hi:[0,0,1]
    v_pk_fma_f32 v[56:57], v[52:53], v[40:41], v[94:95] neg_lo:[0,0,1] neg_hi:[0,0,1]
    v_cvt_pk_f16_f32 v76, v52, v54
    v_cvt_pk_f16_f32 v77, v53, v55
    v_cvt_pk_f16_f32 v78, v60, v62
    v_cvt_pk_f16_f32 v79, v61, v63
    ds_write2_b64 v72, v[76:77], v[78:79] offset0:136 offset1:204
    v_pk_mul_f32 v[90:91], v[58:59], v[46:47]
    v_pk_mul_f32 v[94:95], v[58:59], v[42:43]
    v_pk_mul_f32 v[92:93], v[58:59], v[44:45]
    v_pk_mul_f32 v[96:97], v[58:59], v[40:41]
    v_pk_fma_f32 v[62:63], v[56:57], v[46:47], v[92:93]
    v_pk_fma_f32 v[54:55], v[56:57], v[42:43], v[96:97]
    v_pk_fma_f32 v[60:61], v[56:57], v[44:45], v[90:91] neg_lo:[0,0,1] neg_hi:[0,0,1]
    v_pk_fma_f32 v[52:53], v[56:57], v[40:41], v[94:95] neg_lo:[0,0,1] neg_hi:[0,0,1]
    v_cvt_pk_f16_f32 v98, v56, v58
    v_cvt_pk_f16_f32 v99, v57, v59
    v_cvt_pk_f16_f32 v100, v60, v62
    v_cvt_pk_f16_f32 v101, v61, v63
    ds_write2_b64 v73, v[98:99], v[100:101] offset0:0 offset1:68
    v_pk_mul_f32 v[90:91], v[54:55], v[46:47]
    v_pk_mul_f32 v[94:95], v[54:55], v[42:43]
    v_pk_mul_f32 v[92:93], v[54:55], v[44:45]
    v_pk_mul_f32 v[96:97], v[54:55], v[40:41]
    v_pk_fma_f32 v[62:63], v[52:53], v[46:47], v[92:93]
    v_pk_fma_f32 v[58:59], v[52:53], v[42:43], v[96:97]
    v_pk_fma_f32 v[60:61], v[52:53], v[44:45], v[90:91] neg_lo:[0,0,1] neg_hi:[0,0,1]
    v_pk_fma_f32 v[56:57], v[52:53], v[40:41], v[94:95] neg_lo:[0,0,1] neg_hi:[0,0,1]
    v_cvt_pk_f16_f32 v76, v52, v54
    v_cvt_pk_f16_f32 v77, v53, v55
    v_cvt_pk_f16_f32 v78, v60, v62
    v_cvt_pk_f16_f32 v79, v61, v63
    ds_write2_b64 v73, v[76:77], v[78:79] offset0:136 offset1:204
    v_pk_mul_f32 v[90:91], v[58:59], v[46:47]
    v_pk_mul_f32 v[94:95], v[58:59], v[42:43]
    v_pk_mul_f32 v[92:93], v[58:59], v[44:45]
    v_pk_mul_f32 v[96:97], v[58:59], v[40:41]
    v_pk_fma_f32 v[62:63], v[56:57], v[46:47], v[92:93]
    v_pk_fma_f32 v[54:55], v[56:57], v[42:43], v[96:97]
    v_pk_fma_f32 v[60:61], v[56:57], v[44:45], v[90:91] neg_lo:[0,0,1] neg_hi:[0,0,1]
    v_pk_fma_f32 v[52:53], v[56:57], v[40:41], v[94:95] neg_lo:[0,0,1] neg_hi:[0,0,1]
    v_cvt_pk_f16_f32 v98, v56, v58
    v_cvt_pk_f16_f32 v99, v57, v59
    v_cvt_pk_f16_f32 v100, v60, v62
    v_cvt_pk_f16_f32 v101, v61, v63
    ds_write2_b64 v74, v[98:99], v[100:101] offset0:0 offset1:68
    v_pk_mul_f32 v[90:91], v[54:55], v[46:47]
    v_pk_mul_f32 v[94:95], v[54:55], v[42:43]
    v_pk_mul_f32 v[92:93], v[54:55], v[44:45]
    v_pk_mul_f32 v[96:97], v[54:55], v[40:41]
    v_pk_fma_f32 v[62:63], v[52:53], v[46:47], v[92:93]
    v_pk_fma_f32 v[58:59], v[52:53], v[42:43], v[96:97]
    v_pk_fma_f32 v[60:61], v[52:53], v[44:45], v[90:91] neg_lo:[0,0,1] neg_hi:[0,0,1]
    v_pk_fma_f32 v[56:57], v[52:53], v[40:41], v[94:95] neg_lo:[0,0,1] neg_hi:[0,0,1]
    v_cvt_pk_f16_f32 v76, v52, v54
    v_cvt_pk_f16_f32 v77, v53, v55
    v_cvt_pk_f16_f32 v78, v60, v62
    v_cvt_pk_f16_f32 v79, v61, v63
    ds_write2_b64 v74, v[76:77], v[78:79] offset0:136 offset1:204
    v_pk_mul_f32 v[90:91], v[58:59], v[46:47]
    v_pk_mul_f32 v[94:95], v[58:59], v[42:43]
    v_pk_mul_f32 v[92:93], v[58:59], v[44:45]
    v_pk_mul_f32 v[96:97], v[58:59], v[40:41]
    v_pk_fma_f32 v[62:63], v[56:57], v[46:47], v[92:93]
    v_pk_fma_f32 v[54:55], v[56:57], v[42:43], v[96:97]
    v_pk_fma_f32 v[60:61], v[56:57], v[44:45], v[90:91] neg_lo:[0,0,1] neg_hi:[0,0,1]
    v_pk_fma_f32 v[52:53], v[56:57], v[40:41], v[94:95] neg_lo:[0,0,1] neg_hi:[0,0,1]
    v_cvt_pk_f16_f32 v98, v56, v58
    v_cvt_pk_f16_f32 v99, v57, v59
    v_cvt_pk_f16_f32 v100, v60, v62
    v_cvt_pk_f16_f32 v101, v61, v63
    ds_write2_b64 v75, v[98:99], v[100:101] offset0:0 offset1:68
    v_pk_mul_f32 v[90:91], v[54:55], v[46:47]
    v_pk_mul_f32 v[92:93], v[54:55], v[44:45]
    v_pk_fma_f32 v[62:63], v[52:53], v[46:47], v[92:93]
    v_pk_fma_f32 v[60:61], v[52:53], v[44:45], v[90:91] neg_lo:[0,0,1] neg_hi:[0,0,1]
    v_cvt_pk_f16_f32 v76, v52, v54
    v_cvt_pk_f16_f32 v77, v53, v55
    v_cvt_pk_f16_f32 v78, v60, v62
    v_cvt_pk_f16_f32 v79, v61, v63
    ds_write2_b64 v75, v[76:77], v[78:79] offset0:136 offset1:204
    s_branch JOBJ_19
JOB_16:
    v_mul_f32 v91, 0x43000000, v68
    v_mul_f32 v90, 0x43000000, v20
    v_mul_f32 v95, 0x43000000, v69
    v_mul_f32 v94, 0x43000000, v21
    v_fract_f32 v91, v91
    v_fract_f32 v95, v95
    v_fmac_f32 v91, 0x43000000, v70
    v_fmac_f32 v95, 0x43000000, v71
    v_exp_f32 v90, v90
    v_cos_f32 v92, v91
    v_sin_f32 v91, v91
    v_exp_f32 v94, v94
    v_cos_f32 v96, v95
    v_sin_f32 v95, v95
    v_mul_f32 v44, v90, v92
    v_mul_f32 v46, v90, v91
    v_mul_f32 v45, v94, v96
    v_mul_f32 v47, v94, v95
    v_pk_mul_f32 v[32:33], v[32:33], s[16:17] op_sel_hi:[1,0]
    v_pk_mul_f32 v[34:35], v[34:35], s[16:17] op_sel_hi:[1,0]
    v_pk_mul_f32 v[90:91], v[46:47], v[46:47]
    v_pk_mul_f32 v[92:93], v[44:45], v[46:47]
    v_pk_fma_f32 v[48:49], v[44:45], v[44:45], v[90:91] neg_lo:[0,0,1] neg_hi:[0,0,1]
    v_pk_add_f32 v[50:51], v[92:93], v[92:93]
    v_mul_f32 v91, 2.0, v68
    v_mul_f32 v90, 2.0, v20
    v_mul_f32 v95, 2.0, v69
    v_mul_f32 v94, 2.0, v21
    v_fract_f32 v91, v91
    v_fract_f32 v95, v95
    v_fmac_f32 v91, 2.0, v70
    v_fmac_f32 v95, 2.0, v71
    v_exp_f32 v90, v90
    v_cos_f32 v92, v91
    v_sin_f32 v91, v91
    v_exp_f32 v94, v94
    v_cos_f32 v96, v95
    v_sin_f32 v95, v95
    v_mul_f32 v40, v90, v92
    v_mul_f32 v42, v90, v91
    v_mul_f32 v41, v94, v96
    v_mul_f32 v43, v94, v95
    v_pk_mul_f32 v[90:91], v[34:35], v[50:51]
    v_pk_mul_f32 v[92:93], v[34:35], v[48:49]
    v_pk_fma_f32 v[54:55], v[32:33], v[50:51], v[92:93]
    v_pk_fma_f32 v[52:53], v[32:33], v[48:49], v[90:91] neg_lo:[0,0,1] neg_hi:[0,0,1]
    v_pk_mul_f32 v[90:91], v[54:55], v[50:51]
    v_pk_mul_f32 v[92:93], v[54:55], v[48:49]
    v_pk_fma_f32 v[66:67], v[52:53], v[50:51], v[92:93]
    v_pk_fma_f32 v[64:65], v[52:53], v[48:49], v[90:91] neg_lo:[0,0,1] neg_hi:[0,0,1]
    v_pk_mul_f32 v[90:91], v[54:55], v[46:47]
    v_pk_mul_f32 v[94:95], v[54:55], v[42:43]
    v_pk_mul_f32 v[92:93], v[54:55], v[44:45]
    v_pk_mul_f32 v[96:97], v[54:55], v[40:41]
    v_pk_fma_f32 v[62:63], v[52:53], v[46:47], v[92:93]
    v_pk_fma_f32 v[58:59], v[52:53], v[42:43], v[96:97]
    v_pk_fma_f32 v[60:61], v[52:53], v[44:45], v[90:91] neg_lo:[0,0,1] neg_hi:[0,0,1]
    v_pk_fma_f32 v[56:57], v[52:53], v[40:41], v[94:95] neg_lo:[0,0,1] neg_hi:[0,0,1]
    v_cvt_pk_f16_f32 v98, v52, v54
    v_cvt_pk_f16_f32 v99, v53, v55
    v_cvt_pk_f16_f32 v100, v60, v62
    v_cvt_pk_f16_f32 v101, v61, v63
    ds_write2_b64 v72, v[98:99], v[100:101] offset0:0 offset1:68
    v_pk_mul_f32 v[90:91], v[58:59], v[46:47]
    v_pk_mul_f32 v[94:95], v[58:59], v[42:43]
    v_pk_mul_f32 v[92:93], v[58:59], v[44:45]
    v_pk_mul_f32 v[96:97], v[58:59], v[40:41]
    v_pk_fma_f32 v[62:63], v[56:57], v[46:47], v[92:93]
    v_pk_fma_f32 v[54:55], v[56:57], v[42:43], v[96:97]
    v_pk_fma_f32 v[60:61], v[56:57], v[44:45], v[90:91] neg_lo:[0,0,1] neg_hi:[0,0,1]
    v_pk_fma_f32 v[52:53], v[56:57], v[40:41], v[94:95] neg_lo:[0,0,1] neg_hi:[0,0,1]
    v_cvt_pk_f16_f32 v76, v56, v58
    v_cvt_pk_f16_f32 v77, v57, v59
    v_cvt_pk_f16_f32 v78, v60, v62
    v_cvt_pk_f16_f32 v79, v61, v63
    ds_write2_b64 v72, v[76:77], v[78:79] offset0:136 offset1:204
    v_pk_mul_f32 v[90:91], v[54:55], v[46:47]
    v_pk_mul_f32 v[94:95], v[54:55], v[42:43]
    v_pk_mul_f32 v[92:93], v[54:55], v[44:45]
    v_pk_mul_f32 v[96:97], v[54:55], v[40:41]
    v_pk_fma_f32 v[62:63], v[52:53], v[46:47], v[92:93]
    v_pk_fma_f32 v[58:59], v[52:53], v[42:43], v[96:97]
    v_pk_fma_f32 v[60:61], v[52:53], v[44:45], v[90:91] neg_lo:[0,0,1] neg_hi:[0,0,1]
    v_pk_fma_f32 v[56:57], v[52:53], v[40:41], v[94:95] neg_lo:[0,0,1] neg_hi:[0,0,1]
    v_cvt_pk_f16_f32 v98, v52, v54
    v_cvt_pk_f16_f32 v99, v53, v55
    v_cvt_pk_f16_f32 v100, v60, v62
    v_cvt_pk_f16_f32 v101, v61, v63
    ds_write2_b64 v73, v[98:99], v[100:101] offset0:0 offset1:68
    v_pk_mul_f32 v[90:91], v[58:59], v[46:47]
    v_pk_mul_f32 v[94:95], v[42:43], v[42:43]
    v_pk_mul_f32 v[92:93], v[58:59], v[44:45]
    v_pk_mul_f32 v[96:97], v[40:41], v[42:43]
    v_pk_fma_f32 v[62:63], v[56:57], v[46:47], v[92:93]
    v_pk_fma_f32 v[48:49], v[40:41], v[40:41], v[94:95] neg_lo:[0,0,1] neg_hi:[0,0,1]
    v_pk_fma_f32 v[60:61], v[56:57], v[44:45], v[90:91] neg_lo:[0,0,1] neg_hi:[0,0,1]
    v_pk_add_f32 v[50:51], v[96:97], v[96:97]
    v_cvt_pk_f16_f32 v76, v56, v58
    v_cvt_pk_f16_f32 v77, v57, v59
    v_cvt_pk_f16_f32 v78, v60, v62
    v_cvt_pk_f16_f32 v79, v61, v63
    ds_write2_b64 v73, v[76:77], v[78:79] offset0:136 offset1:204
    v_pk_mul_f32 v[90:91], v[66:67], v[50:51]
    v_pk_mul_f32 v[94:95], v[66:67], v[46:47]
    v_pk_mul_f32 v[92:93], v[66:67], v[48:49]
    v_pk_mul_f32 v[96:97], v[66:67], v[44:45]
    v_pk_fma_f32 v[62:63], v[64:65], v[50:51], v[92:93]
    v_pk_fma_f32 v[54:55], v[64:65], v[46:47], v[96:97]
    v_pk_fma_f32 v[60:61], v[64:65], v[48:49], v[90:91] neg_lo:[0,0,1] neg_hi:[0,0,1]
    v_pk_fma_f32 v[52:53], v[64:65], v[44:45], v[94:95] neg_lo:[0,0,1] neg_hi:[0,0,1]
    v_cvt_pk_f16_f32 v98, v64, v66
    v_cvt_pk_f16_f32 v99, v65, v67
    v_cvt_pk_f16_f32 v100, v60, v62
    v_cvt_pk_f16_f32 v101, v61, v63
    ds_write2_b64 v74, v[98:99], v[100:101] offset0:0 offset1:68
    v_pk_mul_f32 v[90:91], v[54:55], v[50:51]
    v_pk_mul_f32 v[94:95], v[54:55], v[46:47]
    v_pk_mul_f32 v[92:93], v[54:55], v[48:49]
    v_pk_mul_f32 v[96:97], v[54:55], v[44:45]
    v_pk_fma_f32 v[62:63], v[52:53], v[50:51], v[92:93]
    v_pk_fma_f32 v[58:59], v[52:53], v[46:47], v[96:97]
    v_pk_fma_f32 v[60:61], v[52:53], v[48:49], v[90:91] neg_lo:[0,0,1] neg_hi:[0,0,1]
    v_pk_fma_f32 v[56:57], v[52:53], v[44:45], v[94:95] neg_lo:[0,0,1] neg_hi:[0,0,1]
    v_cvt_pk_f16_f32 v76, v52, v54
    v_cvt_pk_f16_f32 v77, v53, v55
    v_cvt_pk_f16_f32 v78, v60, v62
    v_cvt_pk_f16_f32 v79, v61, v63
    ds_write2_b64 v74, v[76:77], v[78:79] offset0:136 offset1:204
    v_pk_mul_f32 v[90:91], v[58:59], v[50:51]
    v_pk_mul_f32 v[94:95], v[58:59], v[46:47]
    v_pk_mul_f32 v[92:93], v[58:59], v[48:49]
    v_pk_mul_f32 v[96:97], v[58:59], v[44:45]
    v_pk_fma_f32 v[62:63], v[56:57], v[50:51], v[92:93]
    v_pk_fma_f32 v[54:55], v[56:57], v[46:47], v[96:97]
    v_pk_fma_f32 v[60:61], v[56:57], v[48:49], v[90:91] neg_lo:[0,0,1] neg_hi:[0,0,1]
    v_pk_fma_f32 v[52:53], v[56:57], v[44:45], v[94:95] neg_lo:[0,0,1] neg_hi:[0,0,1]
    v_cvt_pk_f16_f32 v98, v56, v58
    v_cvt_pk_f16_f32 v99, v57, v59
    v_cvt_pk_f16_f32 v100, v60, v62
    v_cvt_pk_f16_f32 v101, v61, v63
    ds_write2_b64 v75, v[98:99], v[100:101] offset0:0 offset1:68
    v_pk_mul_f32 v[90:91], v[54:55], v[50:51]
    v_pk_mul_f32 v[92:93], v[54:55], v[48:49]
    v_pk_fma_f32 v[62:63], v[52:53], v[50:51], v[92:93]
    v_pk_fma_f32 v[60:61], v[52:53], v[48:49], v[90:91] neg_lo:[0,0,1] neg_hi:[0,0,1]
    v_cvt_pk_f16_f32 v76, v52, v54
    v_cvt_pk_f16_f32 v77, v53, v55
    v_cvt_pk_f16_f32 v78, v60, v62
    v_cvt_pk_f16_f32 v79, v61, v63
    ds_write2_b64 v75, v[76:77], v[78:79] offset0:136 offset1:204
    s_branch JOBJ_19
JOB_18:
    v_mul_f32 v91, 0x41000000, v68
    v_mul_f32 v90, 0x41000000, v20
    v_mul_f32 v95, 0x41000000, v69
    v_mul_f32 v94, 0x41000000, v21
    v_fract_f32 v91, v91
    v_fract_f32 v95, v95
    v_fmac_f32 v91, 0x41000000, v70
    v_fmac_f32 v95, 0x41000000, v71
    v_exp_f32 v90, v90
    v_cos_f32 v92, v91
    v_sin_f32 v91, v91
    v_exp_f32 v94, v94
    v_cos_f32 v96, v95
    v_sin_f32 v95, v95
    v_mul_f32 v40, v90, v92
    v_mul_f32 v42, v90, -v91
    v_mul_f32 v41, v94, v96
    v_mul_f32 v43, v94, -v95
    v_mov_b32 v52, 0x47000000
    v_mov_b32 v53, 0x47000000
    v_mov_b32 v54, 0
    v_mov_b32 v55, 0
    v_pk_mul_f32 v[90:91], v[42:43], v[42:43]
    v_pk_mul_f32 v[60:61], v[40:41], v[52:53]
    v_pk_mul_f32 v[92:93], v[40:41], v[42:43]
    v_pk_mul_f32 v[62:63], v[42:43], v[52:53]
    v_pk_fma_f32 v[44:45], v[40:41], v[40:41], v[90:91] neg_lo:[0,0,1] neg_hi:[0,0,1]
    v_pk_add_f32 v[46:47], v[92:93], v[92:93]
    v_pk_mul_f32 v[56:57], v[44:45], v[52:53]
    v_pk_mul_f32 v[94:95], v[62:63], v[46:47]
    v_pk_mul_f32 v[58:59], v[46:47], v[52:53]
    v_pk_mul_f32 v[96:97], v[62:63], v[44:45]
    v_pk_fma_f32 v[66:67], v[60:61], v[46:47], v[96:97]
    v_pk_fma_f32 v[64:65], v[60:61], v[44:45], v[94:95] neg_lo:[0,0,1] neg_hi:[0,0,1]
    v_cvt_pk_f16_f32 v98, v52, v54
    v_cvt_pk_f16_f32 v99, v53, v55
    v_cvt_pk_f16_f32 v100, v60, v62
    v_cvt_pk_f16_f32 v101, v61, v63
    ds_write2_b64 v72, v[98:99], v[100:101] offset0:0 offset1:68
    v_pk_mul_f32 v[90:91], v[58:59], v[46:47]
    v_pk_mul_f32 v[94:95], v[66:67], v[46:47]
    v_pk_mul_f32 v[92:93], v[58:59], v[44:45]
    v_pk_mul_f32 v[96:97], v[66:67], v[44:45]
    v_pk_fma_f32 v[54:55], v[56:57], v[46:47], v[92:93]
    v_pk_fma_f32 v[62:63], v[64:65], v[46:47], v[96:97]
    v_pk_fma_f32 v[52:53], v[56:57], v[44:45], v[90:91] neg_lo:[0,0,1] neg_hi:[0,0,1]
    v_pk_fma_f32 v[60:61], v[64:65], v[44:45], v[94:95] neg_lo:[0,0,1] neg_hi:[0,0,1]
    v_cvt_pk_f16_f32 v76, v56, v58
    v_cvt_pk_f16_f32 v77, v57, v59
    v_cvt_pk_f16_f32 v78, v64, v66
    v_cvt_pk_f16_f32 v79, v65, v67
    ds_write2_b64 v72, v[76:77], v[78:79] offset0:136 offset1:204
    v_pk_mul_f32 v[90:91], v[54:55], v[46:47]
    v_pk_mul_f32 v[94:95], v[62:63], v[46:47]
    v_pk_mul_f32 v[92:93], v[54:55], v[44:45]
    v_pk_mul_f32 v[96:97], v[62:63], v[44:45]
    v_pk_fma_f32 v[58:59], v[52:53], v[46:47], v[92:93]
    v_pk_fma_f32 v[66:67], v[60:61], v[46:47], v[96:97]
    v_pk_fma_f32 v[56:57], v[52:53], v[44:45], v[90:91] neg_lo:[0,0,1] neg_hi:[0,0,1]
    v_pk_fma_f32 v[64:65], v[60:61], v[44:45], v[94:95] neg_lo:[0,0,1] neg_hi:[0,0,1]
    v_cvt_pk_f16_f32 v98, v52, v54
    v_cvt_pk_f16_f32 v99, v53, v55
    v_cvt_pk_f16_f32 v100, v60, v62
    v_cvt_pk_f16_f32 v101, v61, v63
    ds_write2_b64 v73, v[98:99], v[100:101] offset0:0 offset1:68
    v_pk_mul_f32 v[90:91], v[58:59], v[46:47]
    v_pk_mul_f32 v[94:95], v[66:67], v[46:47]
    v_pk_mul_f32 v[92:93], v[58:59], v[44:45]
    v_pk_mul_f32 v[96:97], v[66:67], v[44:45]
    v_pk_fma_f32 v[54:55], v[56:57], v[46:47], v[92:93]
    v_pk_fma_f32 v[62:63], v[64:65], v[46:47], v[96:97]
    v_pk_fma_f32 v[52:53], v[56:57], v[44:45], v[90:91] neg_lo:[0,0,1] neg_hi:[0,0,1]
    v_pk_fma_f32 v[60:61], v[64:65], v[44:45], v[94:95] neg_lo:[0,0,1] neg_hi:[0,0,1]
    v_cvt_pk_f16_f32 v76, v56, v58
    v_cvt_pk_f16_f32 v77, v57, v59
    v_cvt_pk_f16_f32 v78, v64, v66
    v_cvt_pk_f16_f32 v79, v65, v67
    ds_write2_b64 v73, v[76:77], v[78:79] offset0:136 offset1:204
    v_pk_mul_f32 v[90:91], v[54:55], v[46:47]
    v_pk_mul_f32 v[94:95], v[62:63], v[46:47]
    v_pk_mul_f32 v[92:93], v[54:55], v[44:45]
    v_pk_mul_f32 v[96:97], v[62:63], v[44:45]
    v_pk_fma_f32 v[58:59], v[52:53], v[46:47], v[92:93]
    v_pk_fma_f32 v[66:67], v[60:61], v[46:47], v[96:97]
    v_pk_fma_f32 v[56:57], v[52:53], v[44:45], v[90:91] neg_lo:[0,0,1] neg_hi:[0,0,1]
    v_pk_fma_f32 v[64:65], v[60:61], v[44:45], v[94:95] neg_lo:[0,0,1] neg_hi:[0,0,1]
    v_cvt_pk_f16_f32 v98, v52, v54
    v_cvt_pk_f16_f32 v99, v53, v55
    v_cvt_pk_f16_f32 v100, v60, v62
    v_cvt_pk_f16_f32 v101, v61, v63
    ds_write2_b64 v74, v[98:99], v[100:101] offset0:0 offset1:68
    v_pk_mul_f32 v[90:91], v[58:59], v[46:47]
    v_pk_mul_f32 v[94:95], v[66:67], v[46:47]
    v_pk_mul_f32 v[92:93], v[58:59], v[44:45]
    v_pk_mul_f32 v[96:97], v[66:67], v[44:45]
    v_pk_fma_f32 v[54:55], v[56:57], v[46:47], v[92:93]
    v_pk_fma_f32 v[62:63], v[64:65], v[46:47], v[96:97]
    v_pk_fma_f32 v[52:53], v[56:57], v[44:45], v[90:91] neg_lo:[0,0,1] neg_hi:[0,0,1]
    v_pk_fma_f32 v[60:61], v[64:65], v[44:45], v[94:95] neg_lo:[0,0,1] neg_hi:[0,0,1]
    v_cvt_pk_f16_f32 v76, v56, v58
    v_cvt_pk_f16_f32 v77, v57, v59
    v_cvt_pk_f16_f32 v78, v64, v66
    v_cvt_pk_f16_f32 v79, v65, v67
    ds_write2_b64 v74, v[76:77], v[78:79] offset0:136 offset1:204
    v_pk_mul_f32 v[90:91], v[54:55], v[46:47]
    v_pk_mul_f32 v[94:95], v[62:63], v[46:47]
    v_pk_mul_f32 v[92:93], v[54:55], v[44:45]
    v_pk_mul_f32 v[96:97], v[62:63], v[44:45]
    v_pk_fma_f32 v[58:59], v[52:53], v[46:47], v[92:93]
    v_pk_fma_f32 v[66:67], v[60:61], v[46:47], v[96:97]
    v_pk_fma_f32 v[56:57], v[52:53], v[44:45], v[90:91] neg_lo:[0,0,1] neg_hi:[0,0,1]
    v_pk_fma_f32 v[64:65], v[60:61], v[44:45], v[94:95] neg_lo:[0,0,1] neg_hi:[0,0,1]
    v_cvt_pk_f16_f32 v98, v52, v54
    v_cvt_pk_f16_f32 v99, v53, v55
    v_cvt_pk_f16_f32 v100, v60, v62
    v_cvt_pk_f16_f32 v101, v61, v63
    ds_write2_b64 v75, v[98:99], v[100:101] offset0:0 offset1:68
    v_cvt_pk_f16_f32 v76, v56, v58
    v_cvt_pk_f16_f32 v77, v57, v59
    v_cvt_pk_f16_f32 v78, v64, v66
    v_cvt_pk_f16_f32 v79, v65, v67
    ds_write2_b64 v75, v[76:77], v[78:79] offset0:136 offset1:204
    ds_write_b8 v15, v5 offset:64
    s_cmp_eq_u32 s87, 2
    s_cbranch_scc1 KS_G0
    s_branch EXP_13
KC_SEND:
W_20:
    ds_read_b32 v104, v105 offset:224
    s_sub_u32 s39, s39, 1
    s_cbranch_scc1 KS_ABORT
    s_waitcnt lgkmcnt(0)
    v_cmp_eq_u32 vcc, 0, v104
    s_cbranch_vccnz W_20
    s_lshl_b32 s92, s88, 12
    s_lshl_b32 s93, s86, 10
    s_add_u32 s92, s92, s93
    s_add_u32 s92, s92, 0x920000
    v_add_u32 v24, s92, v12
    s_mov_b32 s93, 0xffff
    v_lshlrev_b32 v25, 16, v104
    v_cvt_f16_f32 v20, v20
    v_cvt_f16_f32 v21, v21
    v_cvt_f16_f32 v22, v22
    v_cvt_f16_f32 v23, v23
    s_cmp_lg_u32 s86, 2
    s_cbranch_scc1 KC_S2
    s_mov_b32 exec_lo, 0
    s_mov_b32 exec_hi, 0xffff0000
    v_mov_b32 v20, v106
    v_lshrrev_b32 v21, 16, v106
    s_mov_b64 exec, -1
KC_S2:
    v_bfi_b32 v20, s93, v20, v104
    v_bfi_b32 v21, s93, v21, v25
    v_bfi_b32 v22, s93, v22, v104
    v_bfi_b32 v23, s93, v23, v25
    global_store_dwordx4 v24, v[20:23], s[36:37] sc1
    s_branch KS_G0
KC_RECV:
    s_cmp_eq_u32 s86, 3
    s_cbranch_scc1 EXP_13
    s_lshl_b32 s92, s88, 12
    s_lshl_b32 s93, s86, 10
    s_add_u32 s92, s92, s93
    s_add_u32 s92, s92, 0x920000
    v_add_u32 v24, s92, v12
W_21:
    s_sleep 2
    ds_read_b32 v104, v105 offset:224
    s_sub_u32 s39, s39, 1
    s_cbranch_scc1 KS_ABORT
    s_waitcnt lgkmcnt(0)
    v_cmp_eq_u32 vcc, 0, v104
    s_cbranch_vccnz W_21
    v_lshlrev_b32 v25, 16, v104
W_22:
    s_sleep 2
    ds_read_b32 v17, v4 offset:68
    s_sub_u32 s39, s39, 1
    s_cbranch_scc1 KS_ABORT
    s_waitcnt lgkmcnt(0)
    v_cmp_ne_u32 vcc, s84, v17
    s_cbranch_vccnz W_22
    s_branch KPE_24
KP_23:
    s_sleep 2
KPE_24:
    global_load_dwordx4 v[20:23], v24, s[36:37] sc1
    s_sub_u32 s39, s39, 1
    s_cbranch_scc1 KS_ABORT
    s_waitcnt vmcnt(0)
    v_xor_b32 v20, v104, v20
    v_xor_b32 v21, v25, v21
    v_xor_b32 v22, v104, v22
    v_xor_b32 v23, v25, v23
    v_or3_b32 v26, v20, v21, v22
    v_or_b32 v26, v26, v23
    v_cmp_lt_u32 vcc, 0xffff, v26
    s_cbranch_vccnz KP_23
    v_xor_b32 v20, v104, v20
    v_xor_b32 v22, v104, v22
    ds_write_b16 v108, v20
    ds_write_b16 v109, v21
    ds_write_b16 v112, v22
    ds_write_b16 v113, v23
    s_cmp_lg_u32 s86, 2
    s_cbranch_scc1 EXP_13
    v_and_b32 v20, 0xffff, v20
    v_lshl_or_b32 v20, v21, 16, v20
    v_lshlrev_b32 v21, 16, v107
    s_mov_b32 exec_lo, 0
    s_mov_b32 exec_hi, 0x10000
    ds_write_b64 v14, v[20:21] offset:832
    s_mov_b64 exec, -1
    s_branch EXP_13
JOB_17:
    v_mul_f32 v91, 0x43000000, v68
    v_mul_f32 v90, 0x43000000, v20
    v_mul_f32 v95, 0x43000000, v69
    v_mul_f32 v94, 0x43000000, v21
    v_fract_f32 v91, v91
    v_fract_f32 v95, v95
    v_fmac_f32 v91, 0x43000000, v70
    v_fmac_f32 v95, 0x43000000, v71
    v_exp_f32 v90, v90
    v_cos_f32 v92, v91
    v_sin_f32 v91, v91
    v_exp_f32 v94, v94
    v_cos_f32 v96, v95
    v_sin_f32 v95, v95
    v_mul_f32 v44, v90, v92
    v_mul_f32 v46, v90, v91
    v_mul_f32 v45, v94, v96
    v_mul_f32 v47, v94, v95
    v_pk_mul_f32 v[32:33], v[32:33], s[16:17] op_sel_hi:[1,0]
    v_pk_mul_f32 v[34:35], v[34:35], s[16:17] op_sel_hi:[1,0]
    v_pk_mul_f32 v[90:91], v[46:47], v[46:47]
    v_pk_mul_f32 v[94:95], v[34:35], v[46:47]
    v_pk_mul_f32 v[92:93], v[44:45], v[46:47]
    v_pk_mul_f32 v[96:97], v[34:35], v[44:45]
    v_pk_fma_f32 v[40:41], v[44:45], v[44:45], v[90:91] neg_lo:[0,0,1] neg_hi:[0,0,1]
    v_pk_fma_f32 v[66:67], v[32:33], v[46:47], v[96:97]
    v_pk_add_f32 v[42:43], v[92:93], v[92:93]
    v_pk_fma_f32 v[64:65], v[32:33], v[44:45], v[94:95] neg_lo:[0,0,1] neg_hi:[0,0,1]
    v_pk_mul_f32 v[90:91], v[42:43], v[42:43]
    v_pk_mul_f32 v[92:93], v[40:41], v[42:43]
    v_pk_fma_f32 v[48:49], v[40:41], v[40:41], v[90:91] neg_lo:[0,0,1] neg_hi:[0,0,1]
    v_pk_add_f32 v[50:51], v[92:93], v[92:93]
    v_pk_mul_f32 v[90:91], v[50:51], v[50:51]
    v_pk_mul_f32 v[92:93], v[48:49], v[50:51]
    v_pk_fma_f32 v[48:49], v[48:49], v[48:49], v[90:91] neg_lo:[0,0,1] neg_hi:[0,0,1]
    v_pk_add_f32 v[50:51], v[92:93], v[92:93]
    v_pk_mul_f32 v[90:91], v[34:35], v[50:51]
    v_pk_mul_f32 v[94:95], v[66:67], v[50:51]
    v_pk_mul_f32 v[92:93], v[34:35], v[48:49]
    v_pk_mul_f32 v[96:97], v[66:67], v[48:49]
    v_pk_fma_f32 v[54:55], v[32:33], v[50:51], v[92:93]
    v_pk_fma_f32 v[62:63], v[64:65], v[50:51], v[96:97]
    v_pk_fma_f32 v[52:53], v[32:33], v[48:49], v[90:91] neg_lo:[0,0,1] neg_hi:[0,0,1]
    v_pk_fma_f32 v[60:61], v[64:65], v[48:49], v[94:95] neg_lo:[0,0,1] neg_hi:[0,0,1]
    v_pk_mul_f32 v[90:91], v[54:55], v[42:43]
    v_pk_mul_f32 v[94:95], v[62:63], v[42:43]
    v_pk_mul_f32 v[92:93], v[54:55], v[40:41]
    v_pk_mul_f32 v[96:97], v[62:63], v[40:41]
    v_pk_fma_f32 v[58:59], v[52:53], v[42:43], v[92:93]
    v_pk_fma_f32 v[66:67], v[60:61], v[42:43], v[96:97]
    v_pk_fma_f32 v[56:57], v[52:53], v[40:41], v[90:91] neg_lo:[0,0,1] neg_hi:[0,0,1]
    v_pk_fma_f32 v[64:65], v[60:61], v[40:41], v[94:95] neg_lo:[0,0,1] neg_hi:[0,0,1]
    v_cvt_pk_f16_f32 v98, v52, v54
    v_cvt_pk_f16_f32 v99, v53, v55
    v_cvt_pk_f16_f32 v100, v60, v62
    v_cvt_pk_f16_f32 v101, v61, v63
    ds_write2_b64 v72, v[98:99], v[100:101] offset0:0 offset1:68
    v_pk_mul_f32 v[90:91], v[58:59], v[42:43]
    v_pk_mul_f32 v[94:95], v[66:67], v[42:43]
    v_pk_mul_f32 v[92:93], v[58:59], v[40:41]
    v_pk_mul_f32 v[96:97], v[66:67], v[40:41]
    v_pk_fma_f32 v[54:55], v[56:57], v[42:43], v[92:93]
    v_pk_fma_f32 v[62:63], v[64:65], v[42:43], v[96:97]
    v_pk_fma_f32 v[52:53], v[56:57], v[40:41], v[90:91] neg_lo:[0,0,1] neg_hi:[0,0,1]
    v_pk_fma_f32 v[60:61], v[64:65], v[40:41], v[94:95] neg_lo:[0,0,1] neg_hi:[0,0,1]
    v_cvt_pk_f16_f32 v76, v56, v58
    v_cvt_pk_f16_f32 v77, v57, v59
    v_cvt_pk_f16_f32 v78, v64, v66
    v_cvt_pk_f16_f32 v79, v65, v67
    ds_write2_b64 v72, v[76:77], v[78:79] offset0:136 offset1:204
    v_pk_mul_f32 v[90:91], v[54:55], v[42:43]
    v_pk_mul_f32 v[94:95], v[62:63], v[42:43]
    v_pk_mul_f32 v[92:93], v[54:55], v[40:41]
    v_pk_mul_f32 v[96:97], v[62:63], v[40:41]
    v_pk_fma_f32 v[58:59], v[52:53], v[42:43], v[92:93]
    v_pk_fma_f32 v[66:67], v[60:61], v[42:43], v[96:97]
    v_pk_fma_f32 v[56:57], v[52:53], v[40:41], v[90:91] neg_lo:[0,0,1] neg_hi:[0,0,1]
    v_pk_fma_f32 v[64:65], v[60:61], v[40:41], v[94:95] neg_lo:[0,0,1] neg_hi:[0,0,1]
    v_cvt_pk_f16_f32 v98, v52, v54
    v_cvt_pk_f16_f32 v99, v53, v55
    v_cvt_pk_f16_f32 v100, v60, v62
    v_cvt_pk_f16_f32 v101, v61, v63
    ds_write2_b64 v73, v[98:99], v[100:101] offset0:0 offset1:68
    v_pk_mul_f32 v[90:91], v[58:59], v[42:43]
    v_pk_mul_f32 v[92:93], v[58:59], v[40:41]
    v_pk_fma_f32 v[54:55], v[56:57], v[42:43], v[92:93]
    v_pk_fma_f32 v[52:53], v[56:57], v[40:41], v[90:91] neg_lo:[0,0,1] neg_hi:[0,0,1]
    v_cvt_pk_f16_f32 v76, v56, v58
    v_cvt_pk_f16_f32 v77, v57, v59
    v_cvt_pk_f16_f32 v78, v64, v66
    v_cvt_pk_f16_f32 v79, v65, v67
    ds_write2_b64 v73, v[76:77], v[78:79] offset0:136 offset1:204
    v_cvt_pk_f16_f32 v98, v52, v54
    v_cvt_pk_f16_f32 v99, v53, v55
    v_mov_b32 v36, 0x4538aa3b
    v_mul_f32 v24, s14, v36
    v_max_f32 v24, 0, v24
    v_exp_f32 v24, v24
    ds_write_b64 v74, v[98:99] offset:0
    s_sub_u32 s11, s15, 7
    s_lshl_b32 s11, s11, 23
    v_lshlrev_b32 v25, 16, v107
    v_mul_f32 v24, s11, v24
    v_mov_b32 v106, v24
    ds_write_b64 v14, v[24:25] offset:832
JOBJ_19:
    ds_write_b8 v15, v5 offset:64
    ds_read_b128 v[40:43], v127 offset:0
    ds_read_b128 v[44:47], v127 offset:64
    ds_read_b128 v[48:51], v127 offset:128
    ds_read_b128 v[52:55], v127 offset:192
    ds_read_b128 v[56:59], v127 offset:256
    ds_read_b128 v[60:63], v127 offset:320
    ds_read_b128 v[64:67], v127 offset:384
    ds_read_b128 v[68:71], v127 offset:448
    v_mov_b32 v36, 0x3fb8aa3b
    v_mul_f32 v36, s14, v36
    v_mul_f32 v37, 0x45000000, v36
    v_max_f32 v37, 0, v37
    v_add_f32 v37, 0x41b80000, v37
    v_fma_f32 v110, v110, v36, -v37
    v_fma_f32 v111, v111, v36, -v37
    v_fma_f32 v114, v114, v36, -v37
    v_fma_f32 v115, v115, v36, -v37
    v_exp_f32 v110, v110
    v_exp_f32 v111, v111
    v_exp_f32 v114, v114
    v_exp_f32 v115, v115
W_25:
    ds_read_u8 v17, v14 offset:67
    s_sub_u32 s39, s39, 1
    s_cbranch_scc1 KS_ABORT
    s_waitcnt lgkmcnt(0)
    v_cmp_eq_u32 vcc, 0, v17
    s_cbranch_vccnz W_25
    ds_read_b128 v[72:75], v126 offset:22304
    ds_read_b128 v[76:79], v126 offset:22368
    ds_read_b128 v[80:83], v126 offset:22432
    ds_read_b128 v[84:87], v126 offset:22496
    ds_read_b128 v[88:91], v126 offset:22560
    ds_read_b128 v[92:95], v126 offset:22624
    ds_read_b128 v[96:99], v126 offset:22688
    ds_read_b128 v[100:103], v126 offset:22752
    s_waitcnt lgkmcnt(7)
    v_mfma_f32_16x16x32_f16 v[20:23], v[40:43], v[72:75], 0
    s_waitcnt lgkmcnt(6)
    v_mfma_f32_16x16x32_f16 v[24:27], v[44:47], v[76:79], 0
    s_waitcnt lgkmcnt(5)
    v_mfma_f32_16x16x32_f16 v[20:23], v[48:51], v[80:83], v[20:23]
    s_waitcnt lgkmcnt(4)
    v_mfma_f32_16x16x32_f16 v[24:27], v[52:55], v[84:87], v[24:27]
    s_waitcnt lgkmcnt(3)
    v_mfma_f32_16x16x32_f16 v[20:23], v[56:59], v[88:91], v[20:23]
    s_waitcnt lgkmcnt(2)
    v_mfma_f32_16x16x32_f16 v[24:27], v[60:63], v[92:95], v[24:27]
    s_waitcnt lgkmcnt(1)
    v_mfma_f32_16x16x32_f16 v[20:23], v[64:67], v[96:99], v[20:23]
    s_waitcnt lgkmcnt(0)
    v_mfma_f32_16x16x32_f16 v[24:27], v[68:71], v[100:103], v[24:27]
    s_nop 7
    v_add_f32 v20, v20, v24
    v_add_f32 v21, v21, v25
    v_add_f32 v22, v22, v26
    v_add_f32 v23, v23, v27
    v_mul_f32 v20, v20, v110
    v_mul_f32 v21, v21, v111
    v_mul_f32 v22, v22, v114
    v_mul_f32 v23, v23, v115
    s_cmp_eq_u32 s87, 2
    s_cbranch_scc1 KC_SEND
    v_cvt_f16_f32 v20, v20
    ds_write_b16 v108, v20
    v_cvt_f16_f32 v21, v21
    ds_write_b16 v109, v21
    v_cvt_f16_f32 v22, v22
    ds_write_b16 v112, v22
    v_cvt_f16_f32 v23, v23
    ds_write_b16 v113, v23
EXP_13:
    ds_write_b8 v15, v5 offset:68
    v_mov_b32 v28, 0
    v_mov_b32 v29, 0
    v_mov_b32 v30, 0
    v_mov_b32 v31, 0
    v_mov_b32 v32, s85
    s_waitcnt vmcnt(0)
W_26:
    ds_read_b32 v20, v14 offset:68
    s_sub_u32 s39, s39, 1
    s_cbranch_scc1 KS_ABORT
    s_waitcnt lgkmcnt(0)
    v_cmp_ne_u32 vcc, s84, v20
    s_cbranch_vccnz W_26
    ds_read_u16 v20, v116
    ds_read_u16 v21, v117
    ds_read_u16 v22, v118
    ds_read_u16 v23, v120
    ds_read_u16 v24, v121
    ds_read_u16 v25, v122
    ds_read_u16 v26, v123
    s_mov_b64 exec, 1
    ds_write_b128 v32, v[28:31] offset:3088
    ds_write_b128 v32, v[28:31] offset:8224
    ds_write_b128 v32, v[28:31] offset:3072
    s_mov_b64 exec, -1
    s_waitcnt lgkmcnt(7)
    v_lshl_or_b32 v28, v21, 16, v20
    v_lshl_or_b32 v29, v22, 16, v21
    ds_write_b32 v124, v28 offset:32528
    ds_write_b32 v124, v29 offset:33872
    s_waitcnt lgkmcnt(5)
    v_lshl_or_b32 v30, v24, 16, v23
    v_lshl_or_b32 v31, v26, 16, v25
    ds_write_b32 v119, v30
    ds_write_b32 v125, v31
    ds_write_b8 v15, v5 offset:72
W_27:
    ds_read_b32 v20, v14 offset:72
    s_sub_u32 s39, s39, 1
    s_cbranch_scc1 KS_ABORT
    s_waitcnt lgkmcnt(0)
    v_cmp_ne_u32 vcc, s84, v20
    s_cbranch_vccnz W_27
    ds_read_b64 v[16:17], v14 offset:832
    s_cmp_eq_u32 s86, 1
    s_cbranch_scc1 CV_29
    s_cmp_eq_u32 s86, 2
    s_cbranch_scc1 CV_30
    s_cmp_eq_u32 s86, 3
    s_cbranch_scc1 CV_31
    ds_read2_b32 v[32:33], v6 offset0:144 offset1:145
    ds_read2_b32 v[34:35], v6 offset0:146 offset1:147
    ds_read2_b32 v[36:37], v6 offset0:16 offset1:17
    ds_read2_b32 v[38:39], v6 offset0:18 offset1:19
    ds_read2_b32 v[40:41], v6 offset0:160 offset1:161
    ds_read2_b32 v[42:43], v6 offset0:162 offset1:163
    ds_read2_b32 v[44:45], v6 offset0:32 offset1:33
    ds_read2_b32 v[46:47], v6 offset0:34 offset1:35
    ds_read2_b32 v[48:49], v6 offset0:176 offset1:177
    ds_read2_b32 v[50:51], v6 offset0:178 offset1:179
    ds_read2_b32 v[52:53], v6 offset0:48 offset1:49
    ds_read2_b32 v[54:55], v6 offset0:50 offset1:51
    ds_read2_b32 v[56:57], v6 offset0:192 offset1:193
    ds_read2_b32 v[58:59], v6 offset0:194 offset1:195
    ds_read2_b32 v[60:61], v6 offset0:64 offset1:65
    ds_read2_b32 v[62:63], v6 offset0:66 offset1:67
    ds_read2_b32 v[64:65], v6 offset0:208 offset1:209
    ds_read2_b32 v[66:67], v6 offset0:210 offset1:211
    ds_read2_b32 v[68:69], v6 offset0:80 offset1:81
    ds_read2_b32 v[70:71], v6 offset0:82 offset1:83
    ds_read2_b32 v[72:73], v6 offset0:224 offset1:225
    ds_read2_b32 v[74:75], v6 offset0:226 offset1:227
    ds_read2_b32 v[76:77], v6 offset0:96 offset1:97
    ds_read2_b32 v[78:79], v6 offset0:98 offset1:99
    ds_read2_b32 v[80:81], v6 offset0:240 offset1:241
    ds_read2_b32 v[82:83], v6 offset0:242 offset1:243
    ds_read2_b32 v[84:85], v6 offset0:112 offset1:113
    ds_read2_b32 v[86:87], v6 offset0:114 offset1:115
    ds_read2_b32 v[88:89], v7 offset0:96 offset1:97
    ds_read2_b32 v[90:91], v7 offset0:98 offset1:99
    ds_read2_b32 v[92:93], v6 offset0:128 offset1:129
    ds_read2_b32 v[94:95], v6 offset0:130 offset1:131
    v_lshlrev_b32 v18, 3, v3
    v_sub_u32 v18, v8, v18
    v_lshrrev_b32 v19, 2, v2
    v_lshl_add_u32 v19, v19, 2, v3
    v_and_b32 v28, 3, v2
    v_lshlrev_b32 v28, 4, v28
    v_mul_u32_u24 v19, s8, v19
    v_xor_b32 v19, s10, v19
    s_waitcnt lgkmcnt(0)
    v_mov_b32 v7, v18
    v_add_u32 v6, v19, v28
    v_xor_b32 v12, s9, v12
W_33:
    ds_read_b32 v18, v4 offset:16
    s_sub_u32 s39, s39, 1
    s_cbranch_scc1 KS_ABORT
    s_waitcnt lgkmcnt(0)
    v_cmp_ne_u32 vcc, s84, v18
    s_cbranch_vccnz W_33
    s_setprio 1
    ds_read_b128 v[96:99], v8 offset:0
    ds_read_b128 v[100:103], v8 offset:64
    ds_read_b128 v[104:107], v8 offset:128
    ds_read_b128 v[108:111], v8 offset:192
    s_waitcnt lgkmcnt(3)
    v_mfma_f32_16x16x32_f16 v[20:23], v[32:35], v[96:99], 0
    v_mfma_f32_16x16x32_f16 v[24:27], v[36:39], v[96:99], 0
    ds_read_b128 v[112:115], v8 offset:256
    s_waitcnt lgkmcnt(3)
    v_mfma_f32_16x16x32_f16 v[20:23], v[40:43], v[100:103], v[20:23]
    ds_read_b64 v[28:29], v7 offset:480
    ds_read_b64 v[30:31], v7 offset:992
    v_mfma_f32_16x16x32_f16 v[24:27], v[44:47], v[100:103], v[24:27]
    ds_read_b128 v[116:119], v8 offset:320
    s_waitcnt lgkmcnt(5)
    v_mfma_f32_16x16x32_f16 v[20:23], v[48:51], v[104:107], v[20:23]
    v_mfma_f32_16x16x32_f16 v[24:27], v[52:55], v[104:107], v[24:27]
    ds_read_b128 v[120:123], v8 offset:384
    s_waitcnt lgkmcnt(2)
    v_fma_mix_f32 v104, v28, v17, 0 op_sel_hi:[1,0,0]
    v_fma_mix_f32 v105, v28, v17, 0 op_sel:[1,0,0] op_sel_hi:[1,0,0]
    v_mfma_f32_16x16x32_f16 v[20:23], v[56:59], v[108:111], v[20:23]
    v_fma_mix_f32 v106, v29, v17, 0 op_sel_hi:[1,0,0]
    v_fma_mix_f32 v107, v29, v17, 0 op_sel:[1,0,0] op_sel_hi:[1,0,0]
    v_mfma_f32_16x16x32_f16 v[24:27], v[60:63], v[108:111], v[24:27]
    ds_read_b128 v[124:127], v8 offset:448
    v_cvt_pk_bf16_f32 v28, v104, v105
    v_cvt_pk_bf16_f32 v29, v106, v107
    v_mfma_f32_16x16x32_f16 v[20:23], v[64:67], v[112:115], v[20:23]
    v_lshlrev_b32 v104, 16, v28
    v_and_b32 v105, 0xffff0000, v28
    v_mfma_f32_16x16x32_f16 v[24:27], v[68:71], v[112:115], v[24:27]
    ds_read_b128 v[36:39], v8 offset:512
    v_lshlrev_b32 v106, 16, v29
    v_and_b32 v107, 0xffff0000, v29
    s_waitcnt lgkmcnt(3)
    v_mfma_f32_16x16x32_f16 v[20:23], v[72:75], v[116:119], v[20:23]
    ds_read_b128 v[96:99], v8 offset:576
    v_fma_mix_f32 v112, v30, v17, 0 op_sel_hi:[1,0,0]
    v_fma_mix_f32 v113, v30, v17, 0 op_sel:[1,0,0] op_sel_hi:[1,0,0]
    v_mfma_f32_16x16x32_f16 v[24:27], v[76:79], v[116:119], v[24:27]
    ds_read_b128 v[44:47], v8 offset:640
    v_fma_mix_f32 v114, v31, v17, 0 op_sel_hi:[1,0,0]
    v_fma_mix_f32 v115, v31, v17, 0 op_sel:[1,0,0] op_sel_hi:[1,0,0]
    s_waitcnt lgkmcnt(4)
    v_mfma_f32_16x16x32_f16 v[20:23], v[80:83], v[120:123], v[20:23]
    ds_read_b128 v[100:103], v8 offset:704
    v_cvt_pk_bf16_f32 v30, v112, v113
    v_cvt_pk_bf16_f32 v31, v114, v115
    v_mfma_f32_16x16x32_f16 v[24:27], v[84:87], v[120:123], v[24:27]
    ds_read_b128 v[52:55], v8 offset:768
    v_lshlrev_b32 v112, 16, v30
    v_and_b32 v113, 0xffff0000, v30
    s_waitcnt lgkmcnt(5)
    v_mfma_f32_16x16x32_f16 v[20:23], v[88:91], v[124:127], v[20:23]
    ds_read_b128 v[60:63], v8 offset:832
    v_lshlrev_b32 v114, 16, v31
    v_and_b32 v115, 0xffff0000, v31
    v_mfma_f32_16x16x32_f16 v[24:27], v[92:95], v[124:127], v[24:27]
    ds_read_b128 v[108:111], v8 offset:896
    s_waitcnt lgkmcnt(6)
    v_mfma_f32_16x16x32_f16 v[24:27], v[32:35], v[36:39], v[24:27]
    ds_read_b128 v[68:71], v8 offset:960
    v_mul_f32 v20, v20, v16
    v_mul_f32 v21, v21, v16
    s_waitcnt lgkmcnt(6)
    v_mfma_f32_16x16x32_f16 v[24:27], v[40:43], v[96:99], v[24:27]
    v_mul_f32 v22, v22, v16
    v_mul_f32 v23, v23, v16
    s_waitcnt lgkmcnt(5)
    v_mfma_f32_16x16x32_f16 v[24:27], v[48:51], v[44:47], v[24:27]
    v_cvt_pk_bf16_f32 v28, v20, v21
    v_cvt_pk_bf16_f32 v29, v22, v23
    s_waitcnt lgkmcnt(4)
    v_mfma_f32_16x16x32_f16 v[24:27], v[56:59], v[100:103], v[24:27]
    v_lshlrev_b32 v20, 16, v28
    v_and_b32 v21, 0xffff0000, v28
    s_waitcnt lgkmcnt(3)
    v_mfma_f32_16x16x32_f16 v[24:27], v[64:67], v[52:55], v[24:27]
    v_lshlrev_b32 v22, 16, v29
    v_and_b32 v23, 0xffff0000, v29
    s_waitcnt lgkmcnt(2)
    v_mfma_f32_16x16x32_f16 v[24:27], v[72:75], v[60:63], v[24:27]
    v_add_f32 v20, v20, v104
    v_add_f32 v21, v21, v105
    s_waitcnt lgkmcnt(1)
    v_mfma_f32_16x16x32_f16 v[24:27], v[80:83], v[108:111], v[24:27]
    v_add_f32 v22, v22, v106
    v_add_f32 v23, v23, v107
    s_waitcnt lgkmcnt(0)
    v_mfma_f32_16x16x32_f16 v[24:27], v[88:91], v[68:71], v[24:27]
    v_cvt_pk_bf16_f32 v28, v20, v21
    v_cvt_pk_bf16_f32 v29, v22, v23
    v_min_u32 v28, -2, v28
    v_min_u32 v29, -2, v29
    ds_read_u8 v18, v4 offset:160
    ds_read_b128 v[20:23], v12 offset:46592
    s_nop 1
    v_mul_f32 v24, v24, v16
    v_mul_f32 v25, v25, v16
    v_mul_f32 v26, v26, v16
    v_mul_f32 v27, v27, v16
    v_cvt_pk_bf16_f32 v30, v24, v25
    v_cvt_pk_bf16_f32 v31, v26, v27
    v_lshlrev_b32 v24, 16, v30
    v_and_b32 v25, 0xffff0000, v30
    v_lshlrev_b32 v26, 16, v31
    v_and_b32 v27, 0xffff0000, v31
    v_add_f32 v24, v24, v112
    v_add_f32 v25, v25, v113
    v_add_f32 v26, v26, v114
    v_add_f32 v27, v27, v115
    v_cvt_pk_bf16_f32 v30, v24, v25
    v_cvt_pk_bf16_f32 v31, v26, v27
    v_min_u32 v30, -2, v30
    v_min_u32 v31, -2, v31
    s_branch CVE_32
CV_29:
    ds_read2_b32 v[32:33], v6 offset0:0 offset1:1
    ds_read2_b32 v[34:35], v6 offset0:2 offset1:3
    ds_read2_b32 v[36:37], v6 offset0:16 offset1:17
    ds_read2_b32 v[38:39], v6 offset0:18 offset1:19
    ds_read2_b32 v[40:41], v6 offset0:32 offset1:33
    ds_read2_b32 v[42:43], v6 offset0:34 offset1:35
    ds_read2_b32 v[44:45], v6 offset0:48 offset1:49
    ds_read2_b32 v[46:47], v6 offset0:50 offset1:51
    ds_read2_b32 v[48:49], v6 offset0:64 offset1:65
    ds_read2_b32 v[50:51], v6 offset0:66 offset1:67
    ds_read2_b32 v[52:53], v6 offset0:80 offset1:81
    ds_read2_b32 v[54:55], v6 offset0:82 offset1:83
    ds_read2_b32 v[56:57], v6 offset0:96 offset1:97
    ds_read2_b32 v[58:59], v6 offset0:98 offset1:99
    ds_read2_b32 v[60:61], v6 offset0:112 offset1:113
    ds_read2_b32 v[62:63], v6 offset0:114 offset1:115
    ds_read2_b32 v[64:65], v6 offset0:128 offset1:129
    ds_read2_b32 v[66:67], v6 offset0:130 offset1:131
    ds_read2_b32 v[68:69], v6 offset0:144 offset1:145
    ds_read2_b32 v[70:71], v6 offset0:146 offset1:147
    ds_read2_b32 v[72:73], v6 offset0:160 offset1:161
    ds_read2_b32 v[74:75], v6 offset0:162 offset1:163
    ds_read2_b32 v[76:77], v6 offset0:176 offset1:177
    ds_read2_b32 v[78:79], v6 offset0:178 offset1:179
    ds_read2_b32 v[80:81], v6 offset0:192 offset1:193
    ds_read2_b32 v[82:83], v6 offset0:194 offset1:195
    ds_read2_b32 v[84:85], v6 offset0:208 offset1:209
    ds_read2_b32 v[86:87], v6 offset0:210 offset1:211
    ds_read2_b32 v[88:89], v6 offset0:224 offset1:225
    ds_read2_b32 v[90:91], v6 offset0:226 offset1:227
    ds_read2_b32 v[92:93], v6 offset0:240 offset1:241
    ds_read2_b32 v[94:95], v6 offset0:242 offset1:243
    ds_read2_b32 v[96:97], v7 offset0:96 offset1:97
    ds_read2_b32 v[98:99], v7 offset0:98 offset1:99
    ds_read2_b32 v[100:101], v11 offset0:32 offset1:33
    ds_read2_b32 v[102:103], v11 offset0:34 offset1:35
    ds_read2_b32 v[104:105], v11 offset0:96 offset1:97
    ds_read2_b32 v[106:107], v11 offset0:98 offset1:99
    v_lshlrev_b32 v18, 3, v3
    v_sub_u32 v18, v8, v18
    v_lshrrev_b32 v19, 2, v2
    v_lshl_add_u32 v19, v19, 2, v3
    v_and_b32 v28, 3, v2
    v_lshlrev_b32 v28, 4, v28
    v_mul_u32_u24 v19, s8, v19
    v_xor_b32 v19, s10, v19
    s_waitcnt lgkmcnt(0)
    v_mov_b32 v7, v18
    v_add_u32 v6, v19, v28
    v_xor_b32 v12, s9, v12
W_34:
    ds_read_b32 v18, v4 offset:16
    s_sub_u32 s39, s39, 1
    s_cbranch_scc1 KS_ABORT
    s_waitcnt lgkmcnt(0)
    v_cmp_ne_u32 vcc, s84, v18
    s_cbranch_vccnz W_34
    s_setprio 1
    ds_read_b128 v[108:111], v8 offset:448
    ds_read_b128 v[112:115], v8 offset:512
    ds_read_b128 v[116:119], v8 offset:576
    ds_read_b128 v[120:123], v8 offset:640
    ds_read_b128 v[124:127], v8 offset:704
    s_waitcnt lgkmcnt(4)
    v_mfma_f32_16x16x32_f16 v[20:23], v[32:35], v[108:111], 0
    ds_read_b128 v[108:111], v8 offset:768
    s_waitcnt lgkmcnt(4)
    v_mfma_f32_16x16x32_f16 v[20:23], v[36:39], v[112:115], v[20:23]
    ds_read_b128 v[112:115], v8 offset:832
    s_waitcnt lgkmcnt(4)
    v_mfma_f32_16x16x32_f16 v[20:23], v[40:43], v[116:119], v[20:23]
    ds_read_b128 v[116:119], v8 offset:896
    ds_read_b64 v[28:29], v7 offset:1504
    ds_read_b64 v[30:31], v7 offset:2016
    s_waitcnt lgkmcnt(6)
    v_mfma_f32_16x16x32_f16 v[20:23], v[44:47], v[120:123], v[20:23]
    ds_read_b128 v[120:123], v8 offset:960
    s_waitcnt lgkmcnt(6)
    v_mfma_f32_16x16x32_f16 v[20:23], v[48:51], v[124:127], v[20:23]
    ds_read_b128 v[124:127], v8 offset:1024
    s_waitcnt lgkmcnt(6)
    v_mfma_f32_16x16x32_f16 v[20:23], v[52:55], v[108:111], v[20:23]
    ds_read_b128 v[108:111], v8 offset:1088
    s_waitcnt lgkmcnt(6)
    v_mfma_f32_16x16x32_f16 v[20:23], v[56:59], v[112:115], v[20:23]
    s_waitcnt lgkmcnt(5)
    v_mfma_f32_16x16x32_f16 v[20:23], v[60:63], v[116:119], v[20:23]
    ds_read_b128 v[112:115], v8 offset:1152
    s_waitcnt lgkmcnt(3)
    v_mfma_f32_16x16x32_f16 v[20:23], v[64:67], v[120:123], v[20:23]
    v_mfma_f32_16x16x32_f16 v[24:27], v[32:35], v[120:123], 0
    ds_read_b128 v[116:119], v8 offset:1216
    v_fma_mix_f32 v120, v28, v17, 0 op_sel_hi:[1,0,0]
    v_fma_mix_f32 v121, v28, v17, 0 op_sel:[1,0,0] op_sel_hi:[1,0,0]
    s_waitcnt lgkmcnt(3)
    v_mfma_f32_16x16x32_f16 v[20:23], v[68:71], v[124:127], v[20:23]
    v_fma_mix_f32 v122, v29, v17, 0 op_sel_hi:[1,0,0]
    v_fma_mix_f32 v123, v29, v17, 0 op_sel:[1,0,0] op_sel_hi:[1,0,0]
    v_mfma_f32_16x16x32_f16 v[24:27], v[36:39], v[124:127], v[24:27]
    ds_read_b128 v[32:35], v8 offset:1280
    v_cvt_pk_bf16_f32 v28, v120, v121
    v_cvt_pk_bf16_f32 v29, v122, v123
    s_waitcnt lgkmcnt(3)
    v_mfma_f32_16x16x32_f16 v[20:23], v[72:75], v[108:111], v[20:23]
    v_lshlrev_b32 v120, 16, v28
    v_and_b32 v121, 0xffff0000, v28
    v_mfma_f32_16x16x32_f16 v[24:27], v[40:43], v[108:111], v[24:27]
    ds_read_b128 v[36:39], v8 offset:1344
    v_lshlrev_b32 v122, 16, v29
    v_and_b32 v123, 0xffff0000, v29
    s_waitcnt lgkmcnt(3)
    v_mfma_f32_16x16x32_f16 v[20:23], v[76:79], v[112:115], v[20:23]
    v_fma_mix_f32 v108, v30, v17, 0 op_sel_hi:[1,0,0]
    v_fma_mix_f32 v109, v30, v17, 0 op_sel:[1,0,0] op_sel_hi:[1,0,0]
    v_mfma_f32_16x16x32_f16 v[24:27], v[44:47], v[112:115], v[24:27]
    ds_read_b128 v[124:127], v8 offset:1408
    v_fma_mix_f32 v110, v31, v17, 0 op_sel_hi:[1,0,0]
    v_fma_mix_f32 v111, v31, v17, 0 op_sel:[1,0,0] op_sel_hi:[1,0,0]
    s_waitcnt lgkmcnt(3)
    v_mfma_f32_16x16x32_f16 v[20:23], v[80:83], v[116:119], v[20:23]
    v_cvt_pk_bf16_f32 v30, v108, v109
    v_cvt_pk_bf16_f32 v31, v110, v111
    v_mfma_f32_16x16x32_f16 v[24:27], v[48:51], v[116:119], v[24:27]
    ds_read_b128 v[40:43], v8 offset:1472
    v_lshlrev_b32 v108, 16, v30
    v_and_b32 v109, 0xffff0000, v30
    s_waitcnt lgkmcnt(3)
    v_mfma_f32_16x16x32_f16 v[20:23], v[84:87], v[32:35], v[20:23]
    v_lshlrev_b32 v110, 16, v31
    v_and_b32 v111, 0xffff0000, v31
    v_mfma_f32_16x16x32_f16 v[24:27], v[52:55], v[32:35], v[24:27]
    ds_read_b128 v[44:47], v8 offset:1536
    s_waitcnt lgkmcnt(3)
    v_mfma_f32_16x16x32_f16 v[20:23], v[88:91], v[36:39], v[20:23]
    ds_read_b128 v[112:115], v8 offset:1600
    v_mfma_f32_16x16x32_f16 v[24:27], v[56:59], v[36:39], v[24:27]
    ds_read_b128 v[48:51], v8 offset:1664
    s_waitcnt lgkmcnt(4)
    v_mfma_f32_16x16x32_f16 v[20:23], v[92:95], v[124:127], v[20:23]
    ds_read_b128 v[116:119], v8 offset:1728
    v_mfma_f32_16x16x32_f16 v[24:27], v[60:63], v[124:127], v[24:27]
    ds_read_b128 v[52:55], v8 offset:1792
    s_waitcnt lgkmcnt(5)
    v_mfma_f32_16x16x32_f16 v[20:23], v[96:99], v[40:43], v[20:23]
    ds_read_b128 v[32:35], v8 offset:1856
    v_mfma_f32_16x16x32_f16 v[24:27], v[64:67], v[40:43], v[24:27]
    ds_read_b32 v18, v14 offset:76
    ds_read_b128 v[56:59], v8 offset:1920
    s_waitcnt lgkmcnt(7)
    v_mfma_f32_16x16x32_f16 v[24:27], v[68:71], v[44:47], v[24:27]
    ds_read_b128 v[36:39], v8 offset:1984
    s_waitcnt lgkmcnt(7)
    v_mfma_f32_16x16x32_f16 v[24:27], v[72:75], v[112:115], v[24:27]
    ds_read2_b32 v[60:61], v11 offset0:16 offset1:17
    ds_read2_b32 v[62:63], v11 offset0:18 offset1:19
    s_waitcnt lgkmcnt(8)
    v_mfma_f32_16x16x32_f16 v[24:27], v[76:79], v[48:51], v[24:27]
    s_waitcnt lgkmcnt(4)
    v_cmp_ne_u32 vcc, s84, v18
    s_cbranch_vccnz WS_35
WB_36:
    ds_read_b64_tr_b16 v[124:125], v9 offset:0
    ds_read_b64_tr_b16 v[126:127], v9 offset:64
    ds_read_b64_tr_b16 v[64:65], v9 offset:3088
    ds_read_b64_tr_b16 v[66:67], v9 offset:3152
    v_mfma_f32_16x16x32_f16 v[24:27], v[80:83], v[116:119], v[24:27]
    v_mfma_f32_16x16x32_f16 v[24:27], v[84:87], v[52:55], v[24:27]
    ds_read_b64_tr_b16 v[40:41], v9 offset:512
    ds_read_b64_tr_b16 v[42:43], v9 offset:576
    ds_read2_b32 v[68:69], v11 offset0:80 offset1:81
    ds_read2_b32 v[70:71], v11 offset0:82 offset1:83
    v_mfma_f32_16x16x32_f16 v[24:27], v[88:91], v[32:35], v[24:27]
    s_waitcnt lgkmcnt(11)
    v_mfma_f32_16x16x32_f16 v[24:27], v[92:95], v[56:59], v[24:27]
    ds_read_b64_tr_b16 v[44:45], v9 offset:3600
    ds_read_b64_tr_b16 v[46:47], v9 offset:3664
    s_waitcnt lgkmcnt(12)
    v_mfma_f32_16x16x32_f16 v[24:27], v[96:99], v[36:39], v[24:27]
    s_waitcnt lgkmcnt(8)
    v_mfma_f32_16x16x32_f16 v[20:23], v[124:127], v[100:103], v[20:23]
    s_waitcnt lgkmcnt(6)
    v_mfma_f32_16x16x32_f16 v[20:23], v[64:67], v[104:107], v[20:23]
    v_mfma_f32_16x16x32_f16 v[24:27], v[124:127], v[60:63], v[24:27]
    s_waitcnt lgkmcnt(4)
    v_mfma_f32_16x16x32_f16 v[24:27], v[40:43], v[100:103], v[24:27]
    s_nop 4
    v_mul_f32 v20, v20, v16
    v_mul_f32 v21, v21, v16
    s_waitcnt lgkmcnt(2)
    v_mfma_f32_16x16x32_f16 v[24:27], v[64:67], v[68:71], v[24:27]
    v_mul_f32 v22, v22, v16
    v_mul_f32 v23, v23, v16
    s_waitcnt lgkmcnt(0)
    v_mfma_f32_16x16x32_f16 v[24:27], v[44:47], v[104:107], v[24:27]
    v_cvt_pk_bf16_f32 v28, v20, v21
    v_cvt_pk_bf16_f32 v29, v22, v23
    v_lshlrev_b32 v20, 16, v28
    v_and_b32 v21, 0xffff0000, v28
    v_lshlrev_b32 v22, 16, v29
    v_and_b32 v23, 0xffff0000, v29
    v_add_f32 v20, v20, v120
    v_add_f32 v21, v21, v121
    v_add_f32 v22, v22, v122
    v_add_f32 v23, v23, v123
    v_cvt_pk_bf16_f32 v28, v20, v21
    v_cvt_pk_bf16_f32 v29, v22, v23
    v_min_u32 v28, -2, v28
    v_min_u32 v29, -2, v29
    ds_read_u8 v18, v4 offset:161
    ds_read_b128 v[20:23], v12 offset:47616
    v_mul_f32 v24, v24, v16
    v_mul_f32 v25, v25, v16
    v_mul_f32 v26, v26, v16
    v_mul_f32 v27, v27, v16
    v_cvt_pk_bf16_f32 v30, v24, v25
    v_cvt_pk_bf16_f32 v31, v26, v27
    v_lshlrev_b32 v24, 16, v30
    v_and_b32 v25, 0xffff0000, v30
    v_lshlrev_b32 v26, 16, v31
    v_and_b32 v27, 0xffff0000, v31
    v_add_f32 v24, v24, v108
    v_add_f32 v25, v25, v109
    v_add_f32 v26, v26, v110
    v_add_f32 v27, v27, v111
    v_cvt_pk_bf16_f32 v30, v24, v25
    v_cvt_pk_bf16_f32 v31, v26, v27
    v_min_u32 v30, -2, v30
    v_min_u32 v31, -2, v31
    s_branch CVE_32
CV_30:
    ds_read2_b32 v[32:33], v7 offset0:128 offset1:129
    ds_read2_b32 v[34:35], v7 offset0:130 offset1:131
    ds_read2_b32 v[36:37], v6 offset0:0 offset1:1
    ds_read2_b32 v[38:39], v6 offset0:2 offset1:3
    ds_read2_b32 v[40:41], v6 offset0:16 offset1:17
    ds_read2_b32 v[42:43], v6 offset0:18 offset1:19
    ds_read2_b32 v[44:45], v6 offset0:32 offset1:33
    ds_read2_b32 v[46:47], v6 offset0:34 offset1:35
    ds_read2_b32 v[48:49], v6 offset0:48 offset1:49
    ds_read2_b32 v[50:51], v6 offset0:50 offset1:51
    ds_read2_b32 v[52:53], v6 offset0:64 offset1:65
    ds_read2_b32 v[54:55], v6 offset0:66 offset1:67
    ds_read2_b32 v[56:57], v6 offset0:80 offset1:81
    ds_read2_b32 v[58:59], v6 offset0:82 offset1:83
    ds_read2_b32 v[60:61], v6 offset0:96 offset1:97
    ds_read2_b32 v[62:63], v6 offset0:98 offset1:99
    ds_read2_b32 v[64:65], v6 offset0:112 offset1:113
    ds_read2_b32 v[66:67], v6 offset0:114 offset1:115
    ds_read2_b32 v[68:69], v6 offset0:128 offset1:129
    ds_read2_b32 v[70:71], v6 offset0:130 offset1:131
    ds_read2_b32 v[72:73], v6 offset0:144 offset1:145
    ds_read2_b32 v[74:75], v6 offset0:146 offset1:147
    ds_read2_b32 v[76:77], v6 offset0:160 offset1:161
    ds_read2_b32 v[78:79], v6 offset0:162 offset1:163
    ds_read2_b32 v[80:81], v6 offset0:176 offset1:177
    ds_read2_b32 v[82:83], v6 offset0:178 offset1:179
    ds_read2_b32 v[84:85], v6 offset0:192 offset1:193
    ds_read2_b32 v[86:87], v6 offset0:194 offset1:195
    ds_read2_b32 v[88:89], v6 offset0:208 offset1:209
    ds_read2_b32 v[90:91], v6 offset0:210 offset1:211
    ds_read2_b32 v[92:93], v6 offset0:224 offset1:225
    ds_read2_b32 v[94:95], v6 offset0:226 offset1:227
    ds_read2_b32 v[96:97], v6 offset0:240 offset1:241
    ds_read2_b32 v[98:99], v6 offset0:242 offset1:243
    ds_read2_b32 v[100:101], v7 offset0:96 offset1:97
    ds_read2_b32 v[102:103], v7 offset0:98 offset1:99
    ds_read2_b32 v[104:105], v11 offset0:0 offset1:1
    ds_read2_b32 v[106:107], v11 offset0:2 offset1:3
    v_lshlrev_b32 v18, 3, v3
    v_sub_u32 v18, v8, v18
    v_lshrrev_b32 v19, 2, v2
    v_lshl_add_u32 v19, v19, 2, v3
    v_and_b32 v28, 3, v2
    v_lshlrev_b32 v28, 4, v28
    v_mul_u32_u24 v19, s8, v19
    v_xor_b32 v19, s10, v19
    s_waitcnt lgkmcnt(0)
    v_mov_b32 v7, v18
    v_add_u32 v6, v19, v28
    v_xor_b32 v12, s9, v12
W_37:
    ds_read_b32 v18, v4 offset:16
    s_sub_u32 s39, s39, 1
    s_cbranch_scc1 KS_ABORT
    s_waitcnt lgkmcnt(0)
    v_cmp_ne_u32 vcc, s84, v18
    s_cbranch_vccnz W_37
    s_setprio 1
    ds_read_b128 v[108:111], v8 offset:448
    ds_read_b128 v[112:115], v8 offset:960
    ds_read_b128 v[116:119], v8 offset:1472
    ds_read_b128 v[120:123], v8 offset:1536
    ds_read_b128 v[124:127], v8 offset:1600
    s_waitcnt lgkmcnt(4)
    v_mfma_f32_16x16x32_f16 v[20:23], v[32:35], v[108:111], 0
    ds_read_b128 v[108:111], v8 offset:1664
    s_waitcnt lgkmcnt(4)
    v_mfma_f32_16x16x32_f16 v[24:27], v[32:35], v[112:115], 0
    ds_read_b128 v[32:35], v8 offset:1728
    ds_read_b128 v[112:115], v8 offset:1792
    s_waitcnt lgkmcnt(5)
    v_mfma_f32_16x16x32_f16 v[20:23], v[36:39], v[116:119], v[20:23]
    ds_read_b128 v[116:119], v8 offset:1856
    ds_read_b64 v[28:29], v7 offset:2528
    ds_read_b64 v[30:31], v7 offset:3040
    s_waitcnt lgkmcnt(7)
    v_mfma_f32_16x16x32_f16 v[20:23], v[40:43], v[120:123], v[20:23]
    ds_read_b128 v[120:123], v8 offset:1920
    s_waitcnt lgkmcnt(7)
    v_mfma_f32_16x16x32_f16 v[20:23], v[44:47], v[124:127], v[20:23]
    ds_read_b128 v[124:127], v8 offset:1984
    s_waitcnt lgkmcnt(7)
    v_mfma_f32_16x16x32_f16 v[20:23], v[48:51], v[108:111], v[20:23]
    ds_read_b128 v[108:111], v8 offset:2048
    s_waitcnt lgkmcnt(7)
    v_mfma_f32_16x16x32_f16 v[20:23], v[52:55], v[32:35], v[20:23]
    s_waitcnt lgkmcnt(6)
    v_mfma_f32_16x16x32_f16 v[20:23], v[56:59], v[112:115], v[20:23]
    ds_read_b128 v[32:35], v8 offset:2112
    s_waitcnt lgkmcnt(6)
    v_mfma_f32_16x16x32_f16 v[20:23], v[60:63], v[116:119], v[20:23]
    s_waitcnt lgkmcnt(4)
    v_fma_mix_f32 v116, v28, v17, 0 op_sel_hi:[1,0,0]
    v_fma_mix_f32 v117, v28, v17, 0 op_sel:[1,0,0] op_sel_hi:[1,0,0]
    s_waitcnt lgkmcnt(3)
    v_mfma_f32_16x16x32_f16 v[20:23], v[64:67], v[120:123], v[20:23]
    ds_read_b128 v[112:115], v8 offset:2176
    v_fma_mix_f32 v118, v29, v17, 0 op_sel_hi:[1,0,0]
    v_fma_mix_f32 v119, v29, v17, 0 op_sel:[1,0,0] op_sel_hi:[1,0,0]
    s_waitcnt lgkmcnt(3)
    v_mfma_f32_16x16x32_f16 v[20:23], v[68:71], v[124:127], v[20:23]
    v_cvt_pk_bf16_f32 v28, v116, v117
    v_cvt_pk_bf16_f32 v29, v118, v119
    v_mfma_f32_16x16x32_f16 v[24:27], v[36:39], v[124:127], v[24:27]
    ds_read_b128 v[120:123], v8 offset:2240
    v_lshlrev_b32 v116, 16, v28
    v_and_b32 v117, 0xffff0000, v28
    s_waitcnt lgkmcnt(3)
    v_mfma_f32_16x16x32_f16 v[20:23], v[72:75], v[108:111], v[20:23]
    v_lshlrev_b32 v118, 16, v29
    v_and_b32 v119, 0xffff0000, v29
    v_mfma_f32_16x16x32_f16 v[24:27], v[40:43], v[108:111], v[24:27]
    ds_read_b128 v[36:39], v8 offset:2304
    v_fma_mix_f32 v108, v30, v17, 0 op_sel_hi:[1,0,0]
    v_fma_mix_f32 v109, v30, v17, 0 op_sel:[1,0,0] op_sel_hi:[1,0,0]
    s_waitcnt lgkmcnt(3)
    v_mfma_f32_16x16x32_f16 v[20:23], v[76:79], v[32:35], v[20:23]
    v_fma_mix_f32 v110, v31, v17, 0 op_sel_hi:[1,0,0]
    v_fma_mix_f32 v111, v31, v17, 0 op_sel:[1,0,0] op_sel_hi:[1,0,0]
    v_mfma_f32_16x16x32_f16 v[24:27], v[44:47], v[32:35], v[24:27]
    ds_read_b128 v[124:127], v8 offset:2368
    v_cvt_pk_bf16_f32 v30, v108, v109
    v_cvt_pk_bf16_f32 v31, v110, v111
    s_waitcnt lgkmcnt(3)
    v_mfma_f32_16x16x32_f16 v[20:23], v[80:83], v[112:115], v[20:23]
    v_lshlrev_b32 v108, 16, v30
    v_and_b32 v109, 0xffff0000, v30
    v_mfma_f32_16x16x32_f16 v[24:27], v[48:51], v[112:115], v[24:27]
    ds_read_b128 v[40:43], v8 offset:2432
    v_lshlrev_b32 v110, 16, v31
    v_and_b32 v111, 0xffff0000, v31
    s_waitcnt lgkmcnt(3)
    v_mfma_f32_16x16x32_f16 v[20:23], v[84:87], v[120:123], v[20:23]
    v_mfma_f32_16x16x32_f16 v[24:27], v[52:55], v[120:123], v[24:27]
    ds_read_b128 v[44:47], v8 offset:2496
    s_waitcnt lgkmcnt(3)
    v_mfma_f32_16x16x32_f16 v[20:23], v[88:91], v[36:39], v[20:23]
    v_mfma_f32_16x16x32_f16 v[24:27], v[56:59], v[36:39], v[24:27]
    ds_read_b128 v[32:35], v8 offset:2560
    s_waitcnt lgkmcnt(3)
    v_mfma_f32_16x16x32_f16 v[20:23], v[92:95], v[124:127], v[20:23]
    ds_read_b128 v[48:51], v8 offset:2624
    v_mfma_f32_16x16x32_f16 v[24:27], v[60:63], v[124:127], v[24:27]
    ds_read_b128 v[112:115], v8 offset:2688
    s_waitcnt lgkmcnt(4)
    v_mfma_f32_16x16x32_f16 v[20:23], v[96:99], v[40:43], v[20:23]
    ds_read_b128 v[52:55], v8 offset:2752
    v_mfma_f32_16x16x32_f16 v[24:27], v[64:67], v[40:43], v[24:27]
    ds_read_b128 v[120:123], v8 offset:2816
    s_waitcnt lgkmcnt(5)
    v_mfma_f32_16x16x32_f16 v[20:23], v[100:103], v[44:47], v[20:23]
    ds_read_b128 v[56:59], v8 offset:2880
    v_mfma_f32_16x16x32_f16 v[24:27], v[68:71], v[44:47], v[24:27]
    ds_read_b32 v18, v14 offset:76
    ds_read_b128 v[36:39], v8 offset:2944
    s_waitcnt lgkmcnt(7)
    v_mfma_f32_16x16x32_f16 v[24:27], v[72:75], v[32:35], v[24:27]
    ds_read_b128 v[60:63], v8 offset:3008
    s_waitcnt lgkmcnt(7)
    v_mfma_f32_16x16x32_f16 v[24:27], v[76:79], v[48:51], v[24:27]
    ds_read2_b32 v[124:125], v11 offset0:16 offset1:17
    ds_read2_b32 v[126:127], v11 offset0:18 offset1:19
    ds_read2_b32 v[64:65], v11 offset0:32 offset1:33
    ds_read2_b32 v[66:67], v11 offset0:34 offset1:35
    s_waitcnt lgkmcnt(10)
    v_mfma_f32_16x16x32_f16 v[24:27], v[80:83], v[112:115], v[24:27]
    s_waitcnt lgkmcnt(6)
    v_cmp_ne_u32 vcc, s84, v18
    s_cbranch_vccnz WS_38
WB_39:
    ds_read_b64_tr_b16 v[40:41], v9 offset:0
    ds_read_b64_tr_b16 v[42:43], v9 offset:64
    ds_read_b64_tr_b16 v[68:69], v9 offset:512
    ds_read_b64_tr_b16 v[70:71], v9 offset:576
    v_mfma_f32_16x16x32_f16 v[24:27], v[84:87], v[52:55], v[24:27]
    ds_read_b64_tr_b16 v[44:45], v9 offset:1024
    ds_read_b64_tr_b16 v[46:47], v9 offset:1088
    v_mfma_f32_16x16x32_f16 v[24:27], v[88:91], v[120:123], v[24:27]
    ds_read_b64_tr_b16 v[72:73], v9 offset:3088
    ds_read_b64_tr_b16 v[74:75], v9 offset:3152
    ds_read2_b32 v[32:33], v11 offset0:64 offset1:65
    ds_read2_b32 v[34:35], v11 offset0:66 offset1:67
    v_mfma_f32_16x16x32_f16 v[24:27], v[92:95], v[56:59], v[24:27]
    ds_read_b64_tr_b16 v[76:77], v9 offset:3600
    ds_read_b64_tr_b16 v[78:79], v9 offset:3664
    ds_read2_b32 v[48:49], v11 offset0:80 offset1:81
    ds_read2_b32 v[50:51], v11 offset0:82 offset1:83
    v_mfma_f32_16x16x32_f16 v[24:27], v[96:99], v[36:39], v[24:27]
    ds_read_b64_tr_b16 v[80:81], v9 offset:4112
    ds_read_b64_tr_b16 v[82:83], v9 offset:4176
    ds_read2_b32 v[112:113], v11 offset0:96 offset1:97
    ds_read2_b32 v[114:115], v11 offset0:98 offset1:99
    v_mfma_f32_16x16x32_f16 v[24:27], v[100:103], v[60:63], v[24:27]
    ds_read_b64_tr_b16 v[84:85], v10 offset:6176
    ds_read_b64_tr_b16 v[86:87], v10 offset:6304
    ds_read2_b32 v[52:53], v13 offset0:24 offset1:25
    ds_read2_b32 v[54:55], v13 offset0:26 offset1:27
    v_mfma_f32_16x16x32_f16 v[20:23], v[40:43], v[104:107], v[20:23]
    ds_read_b64_tr_b16 v[88:89], v10 offset:8224
    ds_read_b64_tr_b16 v[90:91], v10 offset:8352
    ds_read2_b32 v[120:121], v13 offset0:120 offset1:121
    ds_read2_b32 v[122:123], v13 offset0:122 offset1:123
    v_mfma_f32_16x16x32_f16 v[20:23], v[68:71], v[124:127], v[20:23]
    v_mfma_f32_16x16x32_f16 v[20:23], v[44:47], v[64:67], v[20:23]
    v_mfma_f32_16x16x32_f16 v[20:23], v[72:75], v[32:35], v[20:23]
    ds_read_b64_tr_b16 v[92:93], v9 offset:1536
    ds_read_b64_tr_b16 v[94:95], v9 offset:1600
    s_waitcnt lgkmcnt(14)
    v_mfma_f32_16x16x32_f16 v[20:23], v[76:79], v[48:51], v[20:23]
    s_waitcnt lgkmcnt(10)
    v_mfma_f32_16x16x32_f16 v[20:23], v[80:83], v[112:115], v[20:23]
    s_waitcnt lgkmcnt(6)
    v_mfma_f32_16x16x32_f16 v[20:23], v[84:87], v[52:55], v[20:23]
    ds_read_b64_tr_b16 v[56:57], v9 offset:4624
    ds_read_b64_tr_b16 v[58:59], v9 offset:4688
    ds_read2_b32 v[96:97], v13 offset0:16 offset1:17
    ds_read2_b32 v[98:99], v13 offset0:18 offset1:19
    s_waitcnt lgkmcnt(6)
    v_mfma_f32_16x16x32_f16 v[20:23], v[88:91], v[120:123], v[20:23]
    ds_read2_b32 v[36:37], v13 offset0:112 offset1:113
    ds_read2_b32 v[38:39], v13 offset0:114 offset1:115
    v_mfma_f32_16x16x32_f16 v[24:27], v[68:71], v[104:107], v[24:27]
    v_mfma_f32_16x16x32_f16 v[24:27], v[44:47], v[124:127], v[24:27]
    s_nop 3
    v_mul_f32 v20, v20, v16
    v_mul_f32 v21, v21, v16
    s_waitcnt lgkmcnt(6)
    v_mfma_f32_16x16x32_f16 v[24:27], v[92:95], v[64:67], v[24:27]
    v_mul_f32 v22, v22, v16
    v_mul_f32 v23, v23, v16
    v_mfma_f32_16x16x32_f16 v[24:27], v[76:79], v[32:35], v[24:27]
    v_cvt_pk_bf16_f32 v28, v20, v21
    v_cvt_pk_bf16_f32 v29, v22, v23
    v_mfma_f32_16x16x32_f16 v[24:27], v[80:83], v[48:51], v[24:27]
    v_lshlrev_b32 v20, 16, v28
    v_and_b32 v21, 0xffff0000, v28
    s_waitcnt lgkmcnt(4)
    v_mfma_f32_16x16x32_f16 v[24:27], v[56:59], v[112:115], v[24:27]
    v_lshlrev_b32 v22, 16, v29
    v_and_b32 v23, 0xffff0000, v29
    s_waitcnt lgkmcnt(2)
    v_mfma_f32_16x16x32_f16 v[24:27], v[84:87], v[96:99], v[24:27]
    v_add_f32 v20, v20, v116
    v_add_f32 v21, v21, v117
    s_waitcnt lgkmcnt(0)
    v_mfma_f32_16x16x32_f16 v[24:27], v[88:91], v[36:39], v[24:27]
    v_add_f32 v22, v22, v118
    v_add_f32 v23, v23, v119
    v_cvt_pk_bf16_f32 v28, v20, v21
    v_cvt_pk_bf16_f32 v29, v22, v23
    v_min_u32 v28, -2, v28
    v_min_u32 v29, -2, v29
    ds_read_u8 v18, v4 offset:162
    ds_read_b128 v[20:23], v12 offset:48640
    v_mul_f32 v24, v24, v16
    v_mul_f32 v25, v25, v16
    v_mul_f32 v26, v26, v16
    v_mul_f32 v27, v27, v16
    v_cvt_pk_bf16_f32 v30, v24, v25
    v_cvt_pk_bf16_f32 v31, v26, v27
    v_lshlrev_b32 v24, 16, v30
    v_and_b32 v25, 0xffff0000, v30
    v_lshlrev_b32 v26, 16, v31
    v_and_b32 v27, 0xffff0000, v31
    v_add_f32 v24, v24, v108
    v_add_f32 v25, v25, v109
    v_add_f32 v26, v26, v110
    v_add_f32 v27, v27, v111
    v_cvt_pk_bf16_f32 v30, v24, v25
    v_cvt_pk_bf16_f32 v31, v26, v27
    v_min_u32 v30, -2, v30
    v_min_u32 v31, -2, v31
    s_branch CVE_32
CV_31:
    ds_read2_b32 v[32:33], v7 offset0:128 offset1:129
    ds_read2_b32 v[34:35], v7 offset0:130 offset1:131
    ds_read2_b32 v[36:37], v6 offset0:0 offset1:1
    ds_read2_b32 v[38:39], v6 offset0:2 offset1:3
    ds_read2_b32 v[40:41], v6 offset0:16 offset1:17
    ds_read2_b32 v[42:43], v6 offset0:18 offset1:19
    ds_read2_b32 v[44:45], v6 offset0:32 offset1:33
    ds_read2_b32 v[46:47], v6 offset0:34 offset1:35
    ds_read2_b32 v[48:49], v6 offset0:48 offset1:49
    ds_read2_b32 v[50:51], v6 offset0:50 offset1:51
    ds_read2_b32 v[52:53], v6 offset0:64 offset1:65
    ds_read2_b32 v[54:55], v6 offset0:66 offset1:67
    ds_read2_b32 v[56:57], v6 offset0:80 offset1:81
    ds_read2_b32 v[58:59], v6 offset0:82 offset1:83
    ds_read2_b32 v[60:61], v6 offset0:96 offset1:97
    ds_read2_b32 v[62:63], v6 offset0:98 offset1:99
    ds_read2_b32 v[64:65], v6 offset0:112 offset1:113
    ds_read2_b32 v[66:67], v6 offset0:114 offset1:115
    ds_read2_b32 v[68:69], v6 offset0:128 offset1:129
    ds_read2_b32 v[70:71], v6 offset0:130 offset1:131
    ds_read2_b32 v[72:73], v6 offset0:144 offset1:145
    ds_read2_b32 v[74:75], v6 offset0:146 offset1:147
    ds_read2_b32 v[76:77], v6 offset0:160 offset1:161
    ds_read2_b32 v[78:79], v6 offset0:162 offset1:163
    ds_read2_b32 v[80:81], v6 offset0:176 offset1:177
    ds_read2_b32 v[82:83], v6 offset0:178 offset1:179
    ds_read2_b32 v[84:85], v6 offset0:192 offset1:193
    ds_read2_b32 v[86:87], v6 offset0:194 offset1:195
    ds_read2_b32 v[88:89], v6 offset0:208 offset1:209
    ds_read2_b32 v[90:91], v6 offset0:210 offset1:211
    ds_read2_b32 v[92:93], v6 offset0:224 offset1:225
    ds_read2_b32 v[94:95], v6 offset0:226 offset1:227
    ds_read2_b32 v[96:97], v6 offset0:240 offset1:241
    ds_read2_b32 v[98:99], v6 offset0:242 offset1:243
    ds_read2_b32 v[100:101], v7 offset0:96 offset1:97
    ds_read2_b32 v[102:103], v7 offset0:98 offset1:99
    ds_read2_b32 v[104:105], v11 offset0:0 offset1:1
    ds_read2_b32 v[106:107], v11 offset0:2 offset1:3
    v_lshlrev_b32 v18, 3, v3
    v_sub_u32 v18, v8, v18
    v_lshrrev_b32 v19, 2, v2
    v_lshl_add_u32 v19, v19, 2, v3
    v_and_b32 v28, 3, v2
    v_lshlrev_b32 v28, 4, v28
    v_mul_u32_u24 v19, s8, v19
    v_xor_b32 v19, s10, v19
    s_waitcnt lgkmcnt(0)
    v_mov_b32 v7, v18
    v_add_u32 v6, v19, v28
    v_xor_b32 v12, s9, v12
W_40:
    ds_read_b32 v18, v4 offset:16
    s_sub_u32 s39, s39, 1
    s_cbranch_scc1 KS_ABORT
    s_waitcnt lgkmcnt(0)
    v_cmp_ne_u32 vcc, s84, v18
    s_cbranch_vccnz W_40
    s_setprio 1
    ds_read_b128 v[108:111], v8 offset:1472
    ds_read_b128 v[112:115], v8 offset:1984
    ds_read_b128 v[116:119], v8 offset:2496
    ds_read_b128 v[120:123], v8 offset:2560
    ds_read_b128 v[124:127], v8 offset:2624
    s_waitcnt lgkmcnt(4)
    v_mfma_f32_16x16x32_f16 v[20:23], v[32:35], v[108:111], 0
    ds_read_b128 v[108:111], v8 offset:2688
    s_waitcnt lgkmcnt(4)
    v_mfma_f32_16x16x32_f16 v[24:27], v[32:35], v[112:115], 0
    ds_read_b128 v[32:35], v8 offset:2752
    ds_read_b128 v[112:115], v8 offset:2816
    s_waitcnt lgkmcnt(5)
    v_mfma_f32_16x16x32_f16 v[20:23], v[36:39], v[116:119], v[20:23]
    ds_read_b128 v[116:119], v8 offset:2880
    ds_read_b64 v[28:29], v7 offset:3552
    ds_read_b64 v[30:31], v7 offset:4064
    s_waitcnt lgkmcnt(7)
    v_mfma_f32_16x16x32_f16 v[20:23], v[40:43], v[120:123], v[20:23]
    ds_read_b128 v[120:123], v8 offset:2944
    s_waitcnt lgkmcnt(7)
    v_mfma_f32_16x16x32_f16 v[20:23], v[44:47], v[124:127], v[20:23]
    ds_read_b128 v[124:127], v8 offset:3008
    s_waitcnt lgkmcnt(7)
    v_mfma_f32_16x16x32_f16 v[20:23], v[48:51], v[108:111], v[20:23]
    ds_read_b128 v[108:111], v8 offset:3072
    s_waitcnt lgkmcnt(7)
    v_mfma_f32_16x16x32_f16 v[20:23], v[52:55], v[32:35], v[20:23]
    s_waitcnt lgkmcnt(6)
    v_mfma_f32_16x16x32_f16 v[20:23], v[56:59], v[112:115], v[20:23]
    ds_read_b128 v[32:35], v8 offset:3136
    s_waitcnt lgkmcnt(6)
    v_mfma_f32_16x16x32_f16 v[20:23], v[60:63], v[116:119], v[20:23]
    s_waitcnt lgkmcnt(4)
    v_fma_mix_f32 v116, v28, v17, 0 op_sel_hi:[1,0,0]
    v_fma_mix_f32 v117, v28, v17, 0 op_sel:[1,0,0] op_sel_hi:[1,0,0]
    s_waitcnt lgkmcnt(3)
    v_mfma_f32_16x16x32_f16 v[20:23], v[64:67], v[120:123], v[20:23]
    ds_read_b128 v[112:115], v8 offset:3200
    v_fma_mix_f32 v118, v29, v17, 0 op_sel_hi:[1,0,0]
    v_fma_mix_f32 v119, v29, v17, 0 op_sel:[1,0,0] op_sel_hi:[1,0,0]
    s_waitcnt lgkmcnt(3)
    v_mfma_f32_16x16x32_f16 v[20:23], v[68:71], v[124:127], v[20:23]
    v_cvt_pk_bf16_f32 v28, v116, v117
    v_cvt_pk_bf16_f32 v29, v118, v119
    v_mfma_f32_16x16x32_f16 v[24:27], v[36:39], v[124:127], v[24:27]
    ds_read_b128 v[120:123], v8 offset:3264
    v_lshlrev_b32 v116, 16, v28
    v_and_b32 v117, 0xffff0000, v28
    s_waitcnt lgkmcnt(3)
    v_mfma_f32_16x16x32_f16 v[20:23], v[72:75], v[108:111], v[20:23]
    v_lshlrev_b32 v118, 16, v29
    v_and_b32 v119, 0xffff0000, v29
    v_mfma_f32_16x16x32_f16 v[24:27], v[40:43], v[108:111], v[24:27]
    ds_read_b128 v[36:39], v8 offset:3328
    v_fma_mix_f32 v108, v30, v17, 0 op_sel_hi:[1,0,0]
    v_fma_mix_f32 v109, v30, v17, 0 op_sel:[1,0,0] op_sel_hi:[1,0,0]
    s_waitcnt lgkmcnt(3)
    v_mfma_f32_16x16x32_f16 v[20:23], v[76:79], v[32:35], v[20:23]
    v_fma_mix_f32 v110, v31, v17, 0 op_sel_hi:[1,0,0]
    v_fma_mix_f32 v111, v31, v17, 0 op_sel:[1,0,0] op_sel_hi:[1,0,0]
    v_mfma_f32_16x16x32_f16 v[24:27], v[44:47], v[32:35], v[24:27]
    ds_read_b128 v[124:127], v8 offset:3392
    v_cvt_pk_bf16_f32 v30, v108, v109
    v_cvt_pk_bf16_f32 v31, v110, v111
    s_waitcnt lgkmcnt(3)
    v_mfma_f32_16x16x32_f16 v[20:23], v[80:83], v[112:115], v[20:23]
    v_lshlrev_b32 v108, 16, v30
    v_and_b32 v109, 0xffff0000, v30
    v_mfma_f32_16x16x32_f16 v[24:27], v[48:51], v[112:115], v[24:27]
    ds_read_b128 v[40:43], v8 offset:3456
    v_lshlrev_b32 v110, 16, v31
    v_and_b32 v111, 0xffff0000, v31
    s_waitcnt lgkmcnt(3)
    v_mfma_f32_16x16x32_f16 v[20:23], v[84:87], v[120:123], v[20:23]
    v_mfma_f32_16x16x32_f16 v[24:27], v[52:55], v[120:123], v[24:27]
    ds_read_b128 v[44:47], v8 offset:3520
    s_waitcnt lgkmcnt(3)
    v_mfma_f32_16x16x32_f16 v[20:23], v[88:91], v[36:39], v[20:23]
    v_mfma_f32_16x16x32_f16 v[24:27], v[56:59], v[36:39], v[24:27]
    ds_read_b128 v[32:35], v8 offset:3584
    s_waitcnt lgkmcnt(3)
    v_mfma_f32_16x16x32_f16 v[20:23], v[92:95], v[124:127], v[20:23]
    ds_read_b128 v[48:51], v8 offset:3648
    v_mfma_f32_16x16x32_f16 v[24:27], v[60:63], v[124:127], v[24:27]
    ds_read_b128 v[112:115], v8 offset:3712
    s_waitcnt lgkmcnt(4)
    v_mfma_f32_16x16x32_f16 v[20:23], v[96:99], v[40:43], v[20:23]
    ds_read_b128 v[52:55], v8 offset:3776
    v_mfma_f32_16x16x32_f16 v[24:27], v[64:67], v[40:43], v[24:27]
    ds_read_b128 v[120:123], v8 offset:3840
    s_waitcnt lgkmcnt(5)
    v_mfma_f32_16x16x32_f16 v[20:23], v[100:103], v[44:47], v[20:23]
    ds_read_b128 v[56:59], v8 offset:3904
    v_mfma_f32_16x16x32_f16 v[24:27], v[68:71], v[44:47], v[24:27]
    ds_read_b32 v18, v14 offset:76
    ds_read_b128 v[36:39], v8 offset:3968
    s_waitcnt lgkmcnt(7)
    v_mfma_f32_16x16x32_f16 v[24:27], v[72:75], v[32:35], v[24:27]
    ds_read_b128 v[60:63], v8 offset:4032
    s_waitcnt lgkmcnt(7)
    v_mfma_f32_16x16x32_f16 v[24:27], v[76:79], v[48:51], v[24:27]
    ds_read2_b32 v[124:125], v11 offset0:16 offset1:17
    ds_read2_b32 v[126:127], v11 offset0:18 offset1:19
    ds_read2_b32 v[64:65], v11 offset0:32 offset1:33
    ds_read2_b32 v[66:67], v11 offset0:34 offset1:35
    s_waitcnt lgkmcnt(10)
    v_mfma_f32_16x16x32_f16 v[24:27], v[80:83], v[112:115], v[24:27]
    s_waitcnt lgkmcnt(6)
    v_cmp_ne_u32 vcc, s84, v18
    s_cbranch_vccnz WS_41
WB_42:
    ds_read_b64_tr_b16 v[40:41], v9 offset:1024
    ds_read_b64_tr_b16 v[42:43], v9 offset:1088
    ds_read_b64_tr_b16 v[68:69], v9 offset:1536
    ds_read_b64_tr_b16 v[70:71], v9 offset:1600
    v_mfma_f32_16x16x32_f16 v[24:27], v[84:87], v[52:55], v[24:27]
    ds_read_b64_tr_b16 v[44:45], v9 offset:2048
    ds_read_b64_tr_b16 v[46:47], v9 offset:2112
    v_mfma_f32_16x16x32_f16 v[24:27], v[88:91], v[120:123], v[24:27]
    ds_read_b64_tr_b16 v[72:73], v9 offset:4112
    ds_read_b64_tr_b16 v[74:75], v9 offset:4176
    ds_read2_b32 v[32:33], v11 offset0:64 offset1:65
    ds_read2_b32 v[34:35], v11 offset0:66 offset1:67
    v_mfma_f32_16x16x32_f16 v[24:27], v[92:95], v[56:59], v[24:27]
    ds_read_b64_tr_b16 v[76:77], v9 offset:4624
    ds_read_b64_tr_b16 v[78:79], v9 offset:4688
    ds_read2_b32 v[48:49], v11 offset0:80 offset1:81
    ds_read2_b32 v[50:51], v11 offset0:82 offset1:83
    v_mfma_f32_16x16x32_f16 v[24:27], v[96:99], v[36:39], v[24:27]
    ds_read_b64_tr_b16 v[80:81], v9 offset:5136
    ds_read_b64_tr_b16 v[82:83], v9 offset:5200
    ds_read2_b32 v[112:113], v11 offset0:96 offset1:97
    ds_read2_b32 v[114:115], v11 offset0:98 offset1:99
    v_mfma_f32_16x16x32_f16 v[24:27], v[100:103], v[60:63], v[24:27]
    ds_read_b64_tr_b16 v[84:85], v10 offset:6176
    ds_read_b64_tr_b16 v[86:87], v10 offset:6304
    ds_read2_b32 v[52:53], v13 offset0:8 offset1:9
    ds_read2_b32 v[54:55], v13 offset0:10 offset1:11
    v_mfma_f32_16x16x32_f16 v[20:23], v[40:43], v[104:107], v[20:23]
    ds_read_b64_tr_b16 v[88:89], v10 offset:7200
    ds_read_b64_tr_b16 v[90:91], v10 offset:7328
    ds_read2_b32 v[120:121], v13 offset0:24 offset1:25
    ds_read2_b32 v[122:123], v13 offset0:26 offset1:27
    v_mfma_f32_16x16x32_f16 v[20:23], v[68:71], v[124:127], v[20:23]
    ds_read_b64_tr_b16 v[92:93], v10 offset:8224
    ds_read_b64_tr_b16 v[94:95], v10 offset:8352
    ds_read2_b32 v[56:57], v13 offset0:104 offset1:105
    ds_read2_b32 v[58:59], v13 offset0:106 offset1:107
    v_mfma_f32_16x16x32_f16 v[20:23], v[44:47], v[64:67], v[20:23]
    ds_read_b64_tr_b16 v[96:97], v10 offset:9248
    ds_read_b64_tr_b16 v[98:99], v10 offset:9376
    ds_read2_b32 v[36:37], v13 offset0:120 offset1:121
    ds_read2_b32 v[38:39], v13 offset0:122 offset1:123
    v_mfma_f32_16x16x32_f16 v[20:23], v[72:75], v[32:35], v[20:23]
    v_mfma_f32_16x16x32_f16 v[20:23], v[76:79], v[48:51], v[20:23]
    v_mfma_f32_16x16x32_f16 v[20:23], v[80:83], v[112:115], v[20:23]
    ds_read_b64_tr_b16 v[100:101], v9 offset:2560
    ds_read_b64_tr_b16 v[102:103], v9 offset:2624
    s_waitcnt lgkmcnt(14)
    v_mfma_f32_16x16x32_f16 v[20:23], v[84:87], v[52:55], v[20:23]
    s_waitcnt lgkmcnt(10)
    v_mfma_f32_16x16x32_f16 v[20:23], v[88:91], v[120:123], v[20:23]
    s_waitcnt lgkmcnt(6)
    v_mfma_f32_16x16x32_f16 v[20:23], v[92:95], v[56:59], v[20:23]
    ds_read_b64_tr_b16 v[60:61], v9 offset:5648
    ds_read_b64_tr_b16 v[62:63], v9 offset:5712
    ds_read2_b32 v[40:41], v13 offset0:0 offset1:1
    ds_read2_b32 v[42:43], v13 offset0:2 offset1:3
    s_waitcnt lgkmcnt(6)
    v_mfma_f32_16x16x32_f16 v[20:23], v[96:99], v[36:39], v[20:23]
    ds_read2_b32 v[72:73], v13 offset0:16 offset1:17
    ds_read2_b32 v[74:75], v13 offset0:18 offset1:19
    ds_read2_b32 v[52:53], v13 offset0:96 offset1:97
    ds_read2_b32 v[54:55], v13 offset0:98 offset1:99
    v_mfma_f32_16x16x32_f16 v[24:27], v[68:71], v[104:107], v[24:27]
    ds_read2_b32 v[120:121], v13 offset0:112 offset1:113
    ds_read2_b32 v[122:123], v13 offset0:114 offset1:115
    v_mfma_f32_16x16x32_f16 v[24:27], v[44:47], v[124:127], v[24:27]
    v_mul_f32 v20, v20, v16
    v_mul_f32 v21, v21, v16
    s_waitcnt lgkmcnt(10)
    v_mfma_f32_16x16x32_f16 v[24:27], v[100:103], v[64:67], v[24:27]
    v_mul_f32 v22, v22, v16
    v_mul_f32 v23, v23, v16
    v_mfma_f32_16x16x32_f16 v[24:27], v[76:79], v[32:35], v[24:27]
    v_cvt_pk_bf16_f32 v28, v20, v21
    v_cvt_pk_bf16_f32 v29, v22, v23
    v_mfma_f32_16x16x32_f16 v[24:27], v[80:83], v[48:51], v[24:27]
    v_lshlrev_b32 v20, 16, v28
    v_and_b32 v21, 0xffff0000, v28
    s_waitcnt lgkmcnt(8)
    v_mfma_f32_16x16x32_f16 v[24:27], v[60:63], v[112:115], v[24:27]
    v_lshlrev_b32 v22, 16, v29
    v_and_b32 v23, 0xffff0000, v29
    s_waitcnt lgkmcnt(6)
    v_mfma_f32_16x16x32_f16 v[24:27], v[84:87], v[40:43], v[24:27]
    v_add_f32 v20, v20, v116
    v_add_f32 v21, v21, v117
    s_waitcnt lgkmcnt(4)
    v_mfma_f32_16x16x32_f16 v[24:27], v[88:91], v[72:75], v[24:27]
    v_add_f32 v22, v22, v118
    v_add_f32 v23, v23, v119
    s_waitcnt lgkmcnt(2)
    v_mfma_f32_16x16x32_f16 v[24:27], v[92:95], v[52:55], v[24:27]
    v_cvt_pk_bf16_f32 v28, v20, v21
    v_cvt_pk_bf16_f32 v29, v22, v23
    s_waitcnt lgkmcnt(0)
    v_mfma_f32_16x16x32_f16 v[24:27], v[96:99], v[120:123], v[24:27]
    v_min_u32 v28, -2, v28
    v_min_u32 v29, -2, v29
    ds_read_u8 v18, v4 offset:163
    ds_read_b128 v[20:23], v12 offset:49664
    s_nop 3
    v_mul_f32 v24, v24, v16
    v_mul_f32 v25, v25, v16
    v_mul_f32 v26, v26, v16
    v_mul_f32 v27, v27, v16
    v_cvt_pk_bf16_f32 v30, v24, v25
    v_cvt_pk_bf16_f32 v31, v26, v27
    v_lshlrev_b32 v24, 16, v30
    v_and_b32 v25, 0xffff0000, v30
    v_lshlrev_b32 v26, 16, v31
    v_and_b32 v27, 0xffff0000, v31
    v_add_f32 v24, v24, v108
    v_add_f32 v25, v25, v109
    v_add_f32 v26, v26, v110
    v_add_f32 v27, v27, v111
    v_cvt_pk_bf16_f32 v30, v24, v25
    v_cvt_pk_bf16_f32 v31, v26, v27
    v_min_u32 v30, -2, v30
    v_min_u32 v31, -2, v31
CVE_32:
    s_waitcnt lgkmcnt(0)
    s_cmp_lg_u32 s87, 1
    s_cbranch_scc1 ZA_43
    v_cmp_ne_u32 vcc, 1, v18
    s_cbranch_vccnz ZS_45
ZB_46:
    s_mov_b64 exec, s[12:13]
    v_swap_b32 v28, v20
    v_swap_b32 v29, v21
    v_swap_b32 v30, v22
    v_swap_b32 v31, v23
    s_mov_b64 exec, -1
    buffer_store_dwordx4 v[28:31], v6, s[64:67], s7 offen sc1
    buffer_store_dwordx4 v[20:23], v6, s[64:67], s6 offen sc1
    s_branch ZD_48
WS_35:
W_49:
    ds_read_b32 v18, v14 offset:76
    s_sub_u32 s39, s39, 1
    s_cbranch_scc1 KS_ABORT
    s_waitcnt lgkmcnt(0)
    v_cmp_ne_u32 vcc, s84, v18
    s_cbranch_vccnz W_49
    s_branch WB_36
WS_38:
W_50:
    ds_read_b32 v18, v14 offset:76
    s_sub_u32 s39, s39, 1
    s_cbranch_scc1 KS_ABORT
    s_waitcnt lgkmcnt(0)
    v_cmp_ne_u32 vcc, s84, v18
    s_cbranch_vccnz W_50
    s_branch WB_39
WS_41:
W_51:
    ds_read_b32 v18, v14 offset:76
    s_sub_u32 s39, s39, 1
    s_cbranch_scc1 KS_ABORT
    s_waitcnt lgkmcnt(0)
    v_cmp_ne_u32 vcc, s84, v18
    s_cbranch_vccnz W_51
    s_branch WB_42
ZS_45:
    v_mov_b32 v19, s86
ZW_52:
    ds_read_u8 v18, v19 offset:160
    s_sub_u32 s39, s39, 1
    s_cbranch_scc1 KS_ABORT
    s_waitcnt lgkmcnt(0)
    v_cmp_ne_u32 vcc, 1, v18
    s_cbranch_vccnz ZW_52
    v_lshl_add_u32 v19, v19, 10, v12
    ds_read_b128 v[20:23], v19 offset:46592
    s_waitcnt lgkmcnt(0)
    s_branch ZB_46
ZA_43:
    s_cmp_lg_u32 s87, 0
    s_cbranch_scc1 ZC_44
    v_mov_b32 v19, s86
    v_lshl_add_u32 v18, v19, 10, v12
    ds_write_b128 v18, v[28:31] offset:46592
    ds_write_b8 v19, v5 offset:160
    s_branch ZD_48
ZC_44:
    buffer_store_dwordx4 v[28:31], v6, s[64:67], s6 offen sc1
ZD_48:
    s_lshl_b32 s92, s87, 2
    s_add_u32 s92, s92, s86
    v_mov_b32 v8, s92
    s_waitcnt vmcnt(0)
    ds_write_b8 v8, v5 offset:48
    s_cmp_lt_u32 s41, 18
    s_cbranch_scc1 KS_T
    s_waitcnt lgkmcnt(0)
    s_endpgm
KS_X:
    s_cmp_lt_u32 s41, 24
    s_cbranch_scc1 KS_X2
    s_setprio 2
KS_XC:
    s_mov_b32 s87, 2
    s_add_u32 s86, s38, 3
    s_and_b32 s86, s86, 3
    s_lshl_b32 s88, s40, 3
    s_and_b32 s92, s41, 7
    s_add_u32 s88, s88, s92
    s_add_u32 s88, s88, 512
    s_lshl_b32 s92, s86, 11
    s_add_u32 s92, s92, 146048
    v_lshl_add_u32 v28, v1, 3, s92
    s_branch KS_GRP
KS_X2:
    s_cmp_lt_u32 s41, 8
    s_cbranch_scc1 KS_X3
    s_sub_u32 s97, s38, 8
    s_branch KS_LN1
KS_X3:
    s_lshl_b32 s92, s2, 4
    s_add_u32 s92, s92, s38
    s_cmp_lg_u32 s92, 44
    s_cbranch_scc1 KS_X3B
    s_setprio 3
    s_memrealtime s[92:93]
    v_and_b32 v6, 3, v1
    v_lshlrev_b32 v7, 2, v6
    v_min_u32 v6, 2, v6
    v_lshlrev_b32 v6, 2, v6
    v_cmp_eq_u32 vcc, 3, v1
    s_waitcnt lgkmcnt(0)
    v_mov_b32 v8, s92
    v_mov_b32 v9, s93
    v_alignbit_b32 v8, v8, v8, v6
    v_cndmask_b32 v9, v4, v9, vcc
    v_xor_b32 v8, v8, v9
    v_and_b32 v9, 0xf0000fff, v8
    v_and_b32 v10, 0xfff000, v8
    v_lshl_or_b32 v9, v10, 4, v9
    v_lshrrev_b32 v10, 12, v8
    v_and_b32 v10, 0xf000, v10
    v_or3_b32 v9, v9, v10, v9
    v_or_b32 v9, 0x80000000, v9
    s_mov_b64 exec, 15
    global_store_dword v7, v9, s[34:35] sc1
    s_mov_b64 exec, -1
    s_setprio 0
KS_X3B:
    s_setprio 3
    s_branch KS_XC
    s_waitcnt lgkmcnt(0)
    s_barrier
    s_branch KS_G
KS_X4:
    s_cmp_lt_u32 s41, 18
    s_cbranch_scc1 KS_G
    s_waitcnt vmcnt(0) lgkmcnt(0)
    s_endpgm
KS_L:
    v_lshlrev_b32 v6, 2, v0
    ds_write_b32 v6, v4
    v_mov_b32 v8, 0
    v_mov_b32 v9, 0
    s_min_u32 s92, s38, 2
    s_mul_i32 s92, s92, 4672
    v_min_u32 v6, 59, v1
    v_lshl_add_u32 v6, v6, 3, s92
    ds_write_b64 v6, v[8:9] offset:3072
    s_mov_b32 s97, s38
    s_sub_u32 s92, s41, 8
    s_cmp_lt_u32 s92, 16
    s_cbranch_scc0 KS_L0
KS_LN1:
    s_setprio 3
    s_sub_u32 s92, s41, 8
    s_and_b32 s88, s92, 7
    s_lshr_b32 s92, s92, 3
    s_lshl_b32 s92, s92, 4
    s_add_u32 s88, s88, s92
    s_and_b32 s92, s40, 1
    s_lshl_b32 s92, s92, 3
    s_add_u32 s88, s88, s92
    s_lshr_b32 s92, s40, 1
    s_lshl_b32 s92, s92, 5
    s_add_u32 s88, s88, s92
    v_lshrrev_b32 v36, 5, v1
    v_and_b32 v37, 31, v1
    v_mul_u32_u24 v38, 1152, v36
    v_lshl_add_u32 v39, v37, 2, v38
    v_lshl_add_u32 v38, v37, 4, v38
    s_mul_i32 s93, s88, 18432
    s_mul_i32 s94, s97, 2304
    s_add_u32 s93, s93, s94
    s_waitcnt lgkmcnt(0)
    s_mov_b32 s64, s4
    s_mov_b32 s65, s5
    s_mov_b32 s66, 0x240000
    s_mov_b32 s67, 0x20000
    buffer_load_dwordx4 v[26:29], v38, s[64:67], s93 offen
    buffer_load_dwordx4 v[30:33], v38, s[64:67], s93 offen offset:512
    buffer_load_dword v34, v39, s[64:67], s93 offen offset:1024
    s_barrier
    s_lshr_b32 s93, s97, 2
    s_lshl_b32 s93, s93, 6
    s_add_u32 s94, s94, s93
    s_add_u32 s94, s94, 17088
    v_lshl_add_u32 v35, v37, 1, v36
    s_mov_b32 s98, 0x05040100
    s_mov_b32 s99, 0x07060302
    s_waitcnt vmcnt(2)
    v_lshlrev_b32 v8, 16, v26
    v_and_b32 v9, 0xffff0000, v26
    v_lshlrev_b32 v10, 16, v27
    v_and_b32 v11, 0xffff0000, v27
    v_lshlrev_b32 v12, 16, v28
    v_and_b32 v13, 0xffff0000, v28
    v_lshlrev_b32 v14, 16, v29
    v_and_b32 v15, 0xffff0000, v29
    s_waitcnt vmcnt(1)
    v_lshlrev_b32 v16, 16, v30
    v_and_b32 v17, 0xffff0000, v30
    v_lshlrev_b32 v18, 16, v31
    v_and_b32 v19, 0xffff0000, v31
    v_lshlrev_b32 v20, 16, v32
    v_and_b32 v21, 0xffff0000, v32
    v_lshlrev_b32 v22, 16, v33
    v_and_b32 v23, 0xffff0000, v33
    s_waitcnt vmcnt(0)
    v_lshlrev_b32 v24, 16, v34
    v_and_b32 v25, 0xffff0000, v34
    v_lshl_add_u32 v6, v35, 4, s94
    v_lshl_add_u32 v7, v35, 2, s94
    v_mul_u32_u24 v35, 0x20202, v36
    v_lshl_add_u32 v35, v36, 25, v35
    v_add_u32 v35, 0x05040100, v35
    v_pk_add_f32 v[40:41], v[8:9], v[10:11]
    v_pk_add_f32 v[42:43], v[12:13], v[14:15]
    v_pk_add_f32 v[40:41], v[40:41], v[16:17]
    v_pk_add_f32 v[42:43], v[42:43], v[18:19]
    v_pk_add_f32 v[40:41], v[40:41], v[20:21]
    v_pk_add_f32 v[42:43], v[42:43], v[22:23]
    v_pk_add_f32 v[40:41], v[40:41], v[24:25]
    v_pk_add_f32 v[40:41], v[40:41], v[42:43]
    v_add_f32 v40, v40, v41
    s_nop 1
    v_add_f32_dpp v40, v40, v40 row_ror:8 row_mask:0xf bank_mask:0xf
    s_nop 1
    v_add_f32_dpp v40, v40, v40 row_ror:4 row_mask:0xf bank_mask:0xf
    s_nop 1
    v_add_f32_dpp v40, v40, v40 row_ror:2 row_mask:0xf bank_mask:0xf
    s_nop 1
    v_add_f32_dpp v40, v40, v40 row_ror:1 row_mask:0xf bank_mask:0xf
    v_mov_b32 v42, v40
    s_nop 1
    v_permlane16_swap_b32 v40, v42
    v_add_f32 v40, v40, v42
    v_mul_f32 v44, 0x3ae38e39, v40
    v_mov_b32 v45, v44
    v_cvt_pk_bf16_f32 v36, v44, v44
    v_and_b32 v36, 0xffff0000, v36
    v_mov_b32 v37, v36
    v_pk_add_f32 v[38:39], v[8:9], v[44:45] neg_lo:[0,1] neg_hi:[0,1]
    v_pk_mul_f32 v[40:41], v[38:39], v[38:39]
    v_pk_add_f32 v[38:39], v[10:11], v[44:45] neg_lo:[0,1] neg_hi:[0,1]
    v_pk_mul_f32 v[42:43], v[38:39], v[38:39]
    v_pk_add_f32 v[38:39], v[12:13], v[44:45] neg_lo:[0,1] neg_hi:[0,1]
    v_pk_fma_f32 v[40:41], v[38:39], v[38:39], v[40:41]
    v_pk_add_f32 v[38:39], v[14:15], v[44:45] neg_lo:[0,1] neg_hi:[0,1]
    v_pk_fma_f32 v[42:43], v[38:39], v[38:39], v[42:43]
    v_pk_add_f32 v[38:39], v[16:17], v[44:45] neg_lo:[0,1] neg_hi:[0,1]
    v_pk_fma_f32 v[40:41], v[38:39], v[38:39], v[40:41]
    v_pk_add_f32 v[38:39], v[18:19], v[44:45] neg_lo:[0,1] neg_hi:[0,1]
    v_pk_fma_f32 v[42:43], v[38:39], v[38:39], v[42:43]
    v_pk_add_f32 v[38:39], v[20:21], v[44:45] neg_lo:[0,1] neg_hi:[0,1]
    v_pk_fma_f32 v[40:41], v[38:39], v[38:39], v[40:41]
    v_pk_add_f32 v[38:39], v[22:23], v[44:45] neg_lo:[0,1] neg_hi:[0,1]
    v_pk_fma_f32 v[42:43], v[38:39], v[38:39], v[42:43]
    v_pk_add_f32 v[38:39], v[24:25], v[44:45] neg_lo:[0,1] neg_hi:[0,1]
    v_pk_fma_f32 v[40:41], v[38:39], v[38:39], v[40:41]
    v_pk_add_f32 v[40:41], v[40:41], v[42:43]
    v_add_f32 v40, v40, v41
    s_nop 1
    v_add_f32_dpp v40, v40, v40 row_ror:8 row_mask:0xf bank_mask:0xf
    s_nop 1
    v_add_f32_dpp v40, v40, v40 row_ror:4 row_mask:0xf bank_mask:0xf
    s_nop 1
    v_add_f32_dpp v40, v40, v40 row_ror:2 row_mask:0xf bank_mask:0xf
    s_nop 1
    v_add_f32_dpp v40, v40, v40 row_ror:1 row_mask:0xf bank_mask:0xf
    v_mov_b32 v42, v40
    s_nop 1
    v_permlane16_swap_b32 v40, v42
    v_add_f32 v40, v40, v42
    v_mul_f32 v40, 0x3ae38e39, v40
    v_cvt_pk_bf16_f32 v40, v40, v40
    v_and_b32 v40, 0xffff0000, v40
    v_add_f32 v40, 0x3727c5ac, v40
    v_cvt_pk_bf16_f32 v40, v40, v40
    v_and_b32 v40, 0xffff0000, v40
    v_sqrt_f32 v40, v40
    s_nop 0
    v_cvt_pk_bf16_f32 v40, v40, v40
    v_and_b32 v40, 0xffff0000, v40
    v_rcp_f32 v38, v40
    s_nop 0
    v_mov_b32 v39, v38
    v_pk_add_f32 v[40:41], v[8:9], v[36:37] neg_lo:[0,1] neg_hi:[0,1]
    v_cvt_pk_bf16_f32 v42, v40, v41
    v_lshlrev_b32 v40, 16, v42
    v_and_b32 v41, 0xffff0000, v42
    v_pk_mul_f32 v[40:41], v[40:41], v[38:39]
    v_cvt_pk_bf16_f32 v42, v40, v41
    v_lshlrev_b32 v40, 16, v42
    v_and_b32 v41, 0xffff0000, v42
    v_cvt_pk_f16_f32 v26, v40, v41
    v_pk_add_f32 v[40:41], v[10:11], v[36:37] neg_lo:[0,1] neg_hi:[0,1]
    v_cvt_pk_bf16_f32 v42, v40, v41
    v_lshlrev_b32 v40, 16, v42
    v_and_b32 v41, 0xffff0000, v42
    v_pk_mul_f32 v[40:41], v[40:41], v[38:39]
    v_cvt_pk_bf16_f32 v42, v40, v41
    v_lshlrev_b32 v40, 16, v42
    v_and_b32 v41, 0xffff0000, v42
    v_cvt_pk_f16_f32 v27, v40, v41
    v_pk_add_f32 v[40:41], v[12:13], v[36:37] neg_lo:[0,1] neg_hi:[0,1]
    v_cvt_pk_bf16_f32 v42, v40, v41
    v_lshlrev_b32 v40, 16, v42
    v_and_b32 v41, 0xffff0000, v42
    v_pk_mul_f32 v[40:41], v[40:41], v[38:39]
    v_cvt_pk_bf16_f32 v42, v40, v41
    v_lshlrev_b32 v40, 16, v42
    v_and_b32 v41, 0xffff0000, v42
    v_cvt_pk_f16_f32 v28, v40, v41
    v_and_b32 v59, 3, v1
    v_lshlrev_b32 v59, 2, v59
    global_load_dword v58, v59, s[34:35] sc1
    v_pk_add_f32 v[40:41], v[14:15], v[36:37] neg_lo:[0,1] neg_hi:[0,1]
    v_cvt_pk_bf16_f32 v42, v40, v41
    v_lshlrev_b32 v40, 16, v42
    v_and_b32 v41, 0xffff0000, v42
    v_pk_mul_f32 v[40:41], v[40:41], v[38:39]
    v_cvt_pk_bf16_f32 v42, v40, v41
    v_lshlrev_b32 v40, 16, v42
    v_and_b32 v41, 0xffff0000, v42
    v_cvt_pk_f16_f32 v29, v40, v41
    v_permlane32_swap_b32 v26, v28
    s_nop 0
    v_permlane32_swap_b32 v27, v29
    v_perm_b32 v8, v28, v26, s98
    v_perm_b32 v9, v28, v26, s99
    v_perm_b32 v10, v29, v27, s98
    v_perm_b32 v11, v29, v27, s99
    ds_write_b128 v6, v[8:11] offset:0
    v_pk_add_f32 v[40:41], v[16:17], v[36:37] neg_lo:[0,1] neg_hi:[0,1]
    v_cvt_pk_bf16_f32 v42, v40, v41
    v_lshlrev_b32 v40, 16, v42
    v_and_b32 v41, 0xffff0000, v42
    v_pk_mul_f32 v[40:41], v[40:41], v[38:39]
    v_cvt_pk_bf16_f32 v42, v40, v41
    v_lshlrev_b32 v40, 16, v42
    v_and_b32 v41, 0xffff0000, v42
    v_cvt_pk_f16_f32 v30, v40, v41
    v_pk_add_f32 v[40:41], v[18:19], v[36:37] neg_lo:[0,1] neg_hi:[0,1]
    v_cvt_pk_bf16_f32 v42, v40, v41
    v_lshlrev_b32 v40, 16, v42
    v_and_b32 v41, 0xffff0000, v42
    v_pk_mul_f32 v[40:41], v[40:41], v[38:39]
    v_cvt_pk_bf16_f32 v42, v40, v41
    v_lshlrev_b32 v40, 16, v42
    v_and_b32 v41, 0xffff0000, v42
    v_cvt_pk_f16_f32 v31, v40, v41
    v_pk_add_f32 v[40:41], v[20:21], v[36:37] neg_lo:[0,1] neg_hi:[0,1]
    v_cvt_pk_bf16_f32 v42, v40, v41
    v_lshlrev_b32 v40, 16, v42
    v_and_b32 v41, 0xffff0000, v42
    v_pk_mul_f32 v[40:41], v[40:41], v[38:39]
    v_cvt_pk_bf16_f32 v42, v40, v41
    v_lshlrev_b32 v40, 16, v42
    v_and_b32 v41, 0xffff0000, v42
    v_cvt_pk_f16_f32 v32, v40, v41
    v_pk_add_f32 v[40:41], v[22:23], v[36:37] neg_lo:[0,1] neg_hi:[0,1]
    v_cvt_pk_bf16_f32 v42, v40, v41
    v_lshlrev_b32 v40, 16, v42
    v_and_b32 v41, 0xffff0000, v42
    v_pk_mul_f32 v[40:41], v[40:41], v[38:39]
    v_cvt_pk_bf16_f32 v42, v40, v41
    v_lshlrev_b32 v40, 16, v42
    v_and_b32 v41, 0xffff0000, v42
    v_cvt_pk_f16_f32 v33, v40, v41
    v_permlane32_swap_b32 v30, v32
    s_nop 0
    v_permlane32_swap_b32 v31, v33
    v_perm_b32 v16, v32, v30, s98
    v_perm_b32 v17, v32, v30, s99
    v_perm_b32 v18, v33, v31, s98
    v_perm_b32 v19, v33, v31, s99
    ds_write_b128 v6, v[16:19] offset:1024
    v_pk_add_f32 v[40:41], v[24:25], v[36:37] neg_lo:[0,1] neg_hi:[0,1]
    v_cvt_pk_bf16_f32 v42, v40, v41
    v_lshlrev_b32 v40, 16, v42
    v_and_b32 v41, 0xffff0000, v42
    v_pk_mul_f32 v[40:41], v[40:41], v[38:39]
    v_cvt_pk_bf16_f32 v42, v40, v41
    v_lshlrev_b32 v40, 16, v42
    v_and_b32 v41, 0xffff0000, v42
    v_cvt_pk_f16_f32 v34, v40, v41
    v_mov_b32 v40, v34
    s_nop 1
    v_permlane32_swap_b32 v34, v40
    v_perm_b32 v40, v40, v34, v35
    ds_write_b32 v7, v40 offset:2048
    v_mov_b32 v6, s97
    ds_write_b8 v6, v5 offset:0
    s_setprio 0
    s_cmp_ge_u32 s97, 4
    s_cbranch_scc1 KS_X4
    s_setprio 3
    s_mov_b32 s72, s36
    s_mov_b32 s73, s37
    s_mov_b32 s74, 0x240000
    s_mov_b32 s75, 0x20000
    v_and_b32 v6, 1, v0
    v_mul_u32_u24 v6, 9280, v6
    v_lshrrev_b32 v7, 1, v0
    v_lshl_add_u32 v6, v7, 2, v6
    v_add_u32 v6, 17088, v6
    v_lshrrev_b32 v7, 2, v0
    v_mul_u32_u24 v7, 0x2080, v7
    v_and_b32 v8, 3, v0
    v_lshl_add_u32 v7, v8, 4, v7
    s_lshl_b32 s92, s88, 6
    v_xor_b32 v7, s92, v7
    s_mov_b32 s92, 0
    s_add_u32 s93, s92, 524288
    s_add_u32 s94, s92, 1048576
    s_add_u32 s95, s92, 1572864
    s_add_u32 s96, s92, 2097152
    s_waitcnt vmcnt(0)
DBP_55:
    v_cmp_eq_u32 vcc, 0, v58
    s_cbranch_vccz DBG_56
    s_sleep 1
    global_load_dword v58, v59, s[34:35] sc1
    s_sub_u32 s39, s39, 1
    s_cbranch_scc1 KS_ABORT
    s_waitcnt vmcnt(0)
    s_branch DBP_55
DBG_56:
    ds_write_b32 v59, v58 offset:224
    s_mov_b32 s98, 0x70007
    v_lshrrev_b32 v57, 3, v58
    v_lshrrev_b32 v56, 6, v58
    v_lshrrev_b32 v55, 9, v58
W_57:
    ds_read_b64 v[20:21], v4 offset:0
    s_sub_u32 s39, s39, 1
    s_cbranch_scc1 KS_ABORT
    s_waitcnt lgkmcnt(0)
    v_and_b32 v20, v20, v21
    v_cmp_ne_u32 vcc, s84, v20
    s_cbranch_vccnz W_57
    ds_read2st64_b32 v[20:21], v6 offset0:0 offset1:9
    ds_read2st64_b32 v[22:23], v6 offset0:18 offset1:27
    ds_read2st64_b32 v[24:25], v6 offset0:2 offset1:11
    ds_read2st64_b32 v[26:27], v6 offset0:20 offset1:29
    ds_read2st64_b32 v[28:29], v6 offset0:4 offset1:13
    ds_read2st64_b32 v[30:31], v6 offset0:22 offset1:31
    ds_read2st64_b32 v[32:33], v6 offset0:6 offset1:15
    ds_read2st64_b32 v[34:35], v6 offset0:24 offset1:33
    ds_read2st64_b32 v[36:37], v6 offset0:8 offset1:17
    ds_read2st64_b32 v[38:39], v6 offset0:26 offset1:35
    s_waitcnt lgkmcnt(8)
    v_bfi_b32 v20, s98, v58, v20
    v_bfi_b32 v21, s98, v57, v21
    v_bfi_b32 v22, s98, v56, v22
    v_bfi_b32 v23, s98, v55, v23
    buffer_store_dwordx4 v[20:23], v7, s[72:75], s92 offen sc1
    s_waitcnt lgkmcnt(6)
    v_bfi_b32 v24, s98, v58, v24
    v_bfi_b32 v25, s98, v57, v25
    v_bfi_b32 v26, s98, v56, v26
    v_bfi_b32 v27, s98, v55, v27
    buffer_store_dwordx4 v[24:27], v7, s[72:75], s93 offen sc1
    s_waitcnt lgkmcnt(4)
    v_bfi_b32 v28, s98, v58, v28
    v_bfi_b32 v29, s98, v57, v29
    v_bfi_b32 v30, s98, v56, v30
    v_bfi_b32 v31, s98, v55, v31
    buffer_store_dwordx4 v[28:31], v7, s[72:75], s94 offen sc1
    s_waitcnt lgkmcnt(2)
    v_bfi_b32 v32, s98, v58, v32
    v_bfi_b32 v33, s98, v57, v33
    v_bfi_b32 v34, s98, v56, v34
    v_bfi_b32 v35, s98, v55, v35
    buffer_store_dwordx4 v[32:35], v7, s[72:75], s95 offen sc1
    s_waitcnt lgkmcnt(0)
    v_bfi_b32 v36, s98, v58, v36
    v_bfi_b32 v37, s98, v57, v37
    v_bfi_b32 v38, s98, v56, v38
    v_bfi_b32 v39, s98, v55, v39
    buffer_store_dwordx4 v[36:39], v7, s[72:75], s96 offen sc1
    v_mul_u32_u24 v46, 57, v1
    v_lshrrev_b32 v46, 9, v46
    v_mul_u32_u24 v47, 9, v46
    v_sub_u32 v47, v1, v47
    v_mul_u32_u24 v46, 9216, v46
    v_lshl_add_u32 v46, v47, 7, v46
    s_lshl_b32 s94, s38, 4
    s_add_u32 s94, s94, s41
    s_sub_u32 s94, s94, 8
    s_bitcmp1_b32 s94, 0
    s_cselect_b32 s72, s28, s26
    s_cselect_b32 s73, s29, s27
    s_mov_b32 s74, 0x510000
    s_mov_b32 s75, 0x20000
    s_lshr_b32 s95, s94, 1
    s_mul_i32 s95, s95, 64512
    s_mul_i32 s96, s40, 1152
    s_add_u32 s95, s95, s96
    s_cmp_ge_u32 s94, 48
    s_cbranch_scc1 KS_LLE
    s_add_u32 s96, s95, 0
    buffer_load_dword v47, v46, s[72:75], s96 offen nt
    buffer_load_dword v47, v46, s[72:75], s96 offen sc1
KS_LLE:
    s_mov_b32 s87, 1
    s_branch KS_L2B
KS_L0:
    s_and_b32 s92, s41, 15
    s_lshl_b32 s93, s40, 4
    s_add_u32 s92, s92, s93
    v_and_b32 v59, 3, v1
    v_lshlrev_b32 v59, 2, v59
    s_lshl_b32 s96, s92, 6
    s_add_u32 s93, s96, 0xb00000
    v_add_u32 v7, s93, v59
    s_mul_i32 s93, s92, 18560
    s_add_u32 s93, s93, 0x600000
    v_lshlrev_b32 v6, 4, v0
    v_mov_b32 v12, -1
    v_mov_b32 v13, -1
    v_mov_b32 v14, -1
    v_mov_b32 v15, -1
    s_setprio 3
    v_mul_u32_u24 v16, 57, v1
    v_lshrrev_b32 v16, 9, v16
    v_mul_u32_u24 v17, 9, v16
    v_sub_u32 v17, v1, v17
    v_mul_u32_u24 v16, 9216, v16
    v_lshl_add_u32 v16, v17, 7, v16
    s_waitcnt lgkmcnt(0)
    s_add_u32 s68, s36, s93
    s_addc_u32 s69, s37, 0
    s_mov_b32 s70, 18560
    s_mov_b32 s71, 0x20000
    s_barrier
W_58:
    s_sleep 2
    ds_read_b32 v8, v4 offset:36
    s_sub_u32 s39, s39, 1
    s_cbranch_scc1 KS_ABORT
    s_waitcnt lgkmcnt(0)
    v_cmp_eq_u32 vcc, 0, v8
    s_cbranch_vccnz W_58
    s_movk_i32 s92, 0
    buffer_store_dwordx4 v[12:15], v6, s[68:71], s92 offen sc1
    s_movk_i32 s92, 4096
    buffer_store_dwordx4 v[12:15], v6, s[68:71], s92 offen sc1
    s_movk_i32 s92, 8192
    buffer_store_dwordx4 v[12:15], v6, s[68:71], s92 offen sc1
    s_movk_i32 s92, 12288
    buffer_store_dwordx4 v[12:15], v6, s[68:71], s92 offen sc1
    s_movk_i32 s92, 16384
    buffer_store_dwordx4 v[12:15], v6, s[68:71], s92 offen sc1
    global_load_dword v58, v59, s[34:35] sc1
    s_waitcnt vmcnt(0)
DBP_59:
    v_cmp_eq_u32 vcc, 0, v58
    s_cbranch_vccz DBG_60
    s_sleep 1
    global_load_dword v58, v59, s[34:35] sc1
    s_sub_u32 s39, s39, 1
    s_cbranch_scc1 KS_ABORT
    s_waitcnt vmcnt(0)
    s_branch DBP_59
DBG_60:
    ds_write_b32 v59, v58 offset:224
    s_mov_b64 exec, 1
    ds_add_rtn_u32 v8, v4, v5 offset:8
    s_mov_b64 exec, -1
    v_lshrrev_b32 v57, 3, v58
    v_lshrrev_b32 v56, 6, v58
    v_lshrrev_b32 v55, 9, v58
    s_waitcnt lgkmcnt(0)
    v_readfirstlane_b32 s92, v8
    s_cmp_lg_u32 s92, 3
    s_cbranch_scc1 KS_L2
    s_mov_b64 exec, 15
    global_store_dword v7, v58, s[36:37] sc1
    s_mov_b64 exec, -1
    s_and_b32 s94, s41, 7
    s_cmp_ge_u32 s41, 8
    s_cbranch_scc1 KS_L1C
    s_setprio 0
W_61:
    s_sleep 2
    ds_read_b32 v8, v4 offset:100
    s_sub_u32 s39, s39, 1
    s_cbranch_scc1 KS_ABORT
    s_waitcnt lgkmcnt(0)
    v_cmp_ne_u32 vcc, s84, v8
    s_cbranch_vccnz W_61
    s_setprio 3
    s_bitcmp1_b32 s94, 0
    s_cselect_b32 s72, s28, s26
    s_cselect_b32 s73, s29, s27
    s_mov_b32 s74, 0x510000
    s_mov_b32 s75, 0x20000
    s_lshr_b32 s95, s94, 1
    s_mul_i32 s95, s95, 64512
    s_mul_i32 s96, s40, 1152
    s_add_u32 s95, s95, s96
    s_add_u32 s96, s95, 1548288
    buffer_load_dword v18, v16, s[72:75], s96 offen nt
    buffer_load_dword v18, v16, s[72:75], s96 offen sc1
    s_add_u32 s96, s95, 1806336
    buffer_load_dword v18, v16, s[72:75], s96 offen nt
    buffer_load_dword v18, v16, s[72:75], s96 offen sc1
    s_add_u32 s96, s95, 2064384
    buffer_load_dword v18, v16, s[72:75], s96 offen nt
    buffer_load_dword v18, v16, s[72:75], s96 offen sc1
    s_add_u32 s96, s95, 2322432
    buffer_load_dword v18, v16, s[72:75], s96 offen nt
    buffer_load_dword v18, v16, s[72:75], s96 offen sc1
    s_add_u32 s96, s95, 2580480
    buffer_load_dword v18, v16, s[72:75], s96 offen nt
    buffer_load_dword v18, v16, s[72:75], s96 offen sc1
    s_add_u32 s96, s95, 2838528
    buffer_load_dword v18, v16, s[72:75], s96 offen nt
    buffer_load_dword v18, v16, s[72:75], s96 offen sc1
    s_branch KS_L2
KS_L1C:
    s_bitcmp1_b32 s94, 0
    s_cselect_b32 s72, s28, s26
    s_cselect_b32 s73, s29, s27
    s_mov_b32 s74, 0x510000
    s_mov_b32 s75, 0x20000
    s_lshr_b32 s95, s94, 1
    s_mul_i32 s95, s95, 64512
    s_mul_i32 s96, s40, 1152
    s_add_u32 s95, s95, s96
    s_add_u32 s96, s95, 3096576
    buffer_load_dword v18, v16, s[72:75], s96 offen nt
    buffer_load_dword v18, v16, s[72:75], s96 offen sc1
    s_add_u32 s96, s95, 3354624
    buffer_load_dword v18, v16, s[72:75], s96 offen nt
    buffer_load_dword v18, v16, s[72:75], s96 offen sc1
    s_add_u32 s96, s95, 3612672
    buffer_load_dword v18, v16, s[72:75], s96 offen nt
    buffer_load_dword v18, v16, s[72:75], s96 offen sc1
KS_L2:
    s_mov_b32 s87, 0
KS_L2B:
    s_mov_b32 s64, s36
    s_mov_b32 s65, s37
    s_mov_b32 s66, 0x240000
    s_mov_b32 s67, 0x20000
    v_lshrrev_b32 v7, 1, v1
    v_lshlrev_b32 v7, 6, v7
    v_and_b32 v10, 1, v1
    v_lshl_add_u32 v7, v10, 4, v7
    v_lshlrev_b32 v9, 4, v1
    s_lshl_b32 s92, s38, 11
    s_lshl_b32 s93, s90, 13
    s_add_u32 s93, s93, s92
    s_lshl_b32 s94, s90, 7
    s_and_b32 s95, s94, 0x380
    v_xor_b32 v13, s95, v9
    s_and_b32 s94, s94, 0x1c00
    s_xor_b32 s93, s93, s94
    s_xor_b32 s97, s93, 0x400
    s_lshl_b32 s95, s40, 3
    s_add_u32 s95, s95, s41
    s_add_u32 s95, s95, 488
    s_lshr_b32 s96, s95, 1
    s_lshl_b32 s96, s96, 13
    s_and_b32 s95, s95, 1
    s_lshl_b32 s95, s95, 5
    s_add_u32 s95, s95, s96
    s_add_u32 s95, s95, s92
    s_lshr_b32 s96, s96, 6
    s_and_b32 s94, s96, 0x780
    v_xor_b32 v7, s94, v7
    s_and_b32 s96, s96, 0x1800
    s_xor_b32 s95, s95, s96
    s_cmp_lt_u32 s41, 24
    s_cselect_b32 s95, 2359296, s95
    s_cselect_b32 s94, 0, 0x70007
    v_mov_b32_dpp v64, v58 quad_perm:[0,1,0,1] row_mask:0xf bank_mask:0xf
    v_mov_b32_dpp v65, v58 quad_perm:[2,3,2,3] row_mask:0xf bank_mask:0xf
    s_bitcmp1_b32 s41, 0
    s_cselect_b64 vcc, -1, 0
    v_cndmask_b32 v64, v64, v65, vcc
    v_and_b32 v60, 0x70007, v58
    v_and_b32 v61, 0x70007, v57
    v_and_b32 v62, 0x70007, v56
    v_and_b32 v63, 0x70007, v55
    v_lshrrev_b32 v67, 9, v64
    v_lshrrev_b32 v66, 6, v64
    v_lshrrev_b32 v65, 3, v64
    v_and_b32 v64, s94, v64
    v_and_b32 v65, s94, v65
    v_and_b32 v66, s94, v66
    v_and_b32 v67, s94, v67
    s_lshl_b32 s96, s38, 10
    s_add_u32 s96, s96, 3552
    v_bfe_u32 v11, v1, 1, 1
    v_mul_u32_u24 v11, 4672, v11
    v_lshl_add_u32 v11, v10, 4, v11
    v_lshrrev_b32 v10, 2, v1
    v_lshl_add_u32 v11, v10, 5, v11
    v_add_u32 v11, s96, v11
    v_add_u32 v10, s96, v9
    v_mov_b32 v116, s38
    s_add_u32 s92, s92, 0xb00000
    v_lshrrev_b32 v12, 2, v1
    v_lshl_add_u32 v12, v12, 6, v59
    v_add_u32 v12, s92, v12
    s_cmp_lt_u32 s41, 8
    s_cselect_b32 s94, 4, 0
    s_cmp_ge_u32 s41, 24
    s_cselect_b32 s94, 4, s94
    v_mov_b32 v14, s94
    s_setprio 0
    s_waitcnt vmcnt(0)
W_62:
    s_sleep 2
    ds_read_b32 v8, v14 offset:64
    s_sub_u32 s39, s39, 1
    s_cbranch_scc1 KS_ABORT
    s_waitcnt lgkmcnt(0)
    v_cmp_ne_u32 vcc, s84, v8
    s_cbranch_vccnz W_62
    s_setprio 3
    s_branch UPE_64
UP_63:
    s_sleep 2
UPE_64:
    global_load_dword v32, v12, s[36:37] sc1
    global_load_dword v33, v12, s[36:37] offset:1024 sc1
    buffer_load_dwordx4 v[20:23], v13, s[64:67], s93 offen sc1
    buffer_load_dwordx4 v[24:27], v13, s[64:67], s97 offen sc1
    buffer_load_dwordx4 v[28:31], v7, s[64:67], s95 offen sc1
    s_sub_u32 s39, s39, 1
    s_cbranch_scc1 KS_ABORT
    s_waitcnt vmcnt(2)
    v_xor_b32 v32, v58, v32
    v_xor_b32 v33, v58, v33
    v_xor_b32 v20, v60, v20
    v_xor_b32 v21, v61, v21
    v_xor_b32 v22, v62, v22
    v_xor_b32 v23, v63, v23
    v_or3_b32 v44, v20, v21, v21
    v_or3_b32 v44, v22, v23, v44
    s_waitcnt vmcnt(1)
    v_xor_b32 v24, v60, v24
    v_xor_b32 v25, v61, v25
    v_xor_b32 v26, v62, v26
    v_xor_b32 v27, v63, v27
    v_or3_b32 v44, v24, v25, v44
    v_or3_b32 v44, v26, v27, v44
    s_waitcnt vmcnt(0)
    v_xor_b32 v28, v64, v28
    v_xor_b32 v29, v65, v29
    v_xor_b32 v30, v66, v30
    v_xor_b32 v31, v67, v31
    v_or3_b32 v44, v28, v29, v44
    v_or3_b32 v44, v30, v31, v44
    v_and_b32 v44, 0x70007, v44
    v_or3_b32 v44, v44, v32, v33
    v_cmp_ne_u32 vcc, 0, v44
    s_cbranch_vccnz UP_63
    ds_write_b128 v11, v[20:23]
    ds_write_b128 v11, v[24:27] offset:512
    ds_write_b128 v10, v[28:31] offset:9344
    ds_write_b8 v116, v5 offset:16
    s_cmp_eq_u32 s38, 2
    s_cbranch_scc1 WJ2_67
    s_add_u32 s92, s38, 1
    s_lshr_b32 s92, s92, 2
    s_cmp_eq_u32 s38, 1
    s_cselect_b32 s92, 2, s92
    s_lshl_b32 s92, s92, 10
    v_lshl_add_u32 v10, v1, 4, s92
    v_add_u32 v11, 35840, v10
W_68:
    ds_read_b32 v12, v4 offset:16
    s_sub_u32 s39, s39, 1
    s_cbranch_scc1 KS_ABORT
    s_waitcnt lgkmcnt(0)
    v_cmp_ne_u32 vcc, s84, v12
    s_cbranch_vccnz W_68
    s_setprio 3
    ds_read_b128 v[20:23], v10 offset:3520
    ds_read_b128 v[24:27], v10 offset:3536
    ds_read_b64 v[28:29], v10 offset:3552
    ds_read_b128 v[32:35], v10 offset:8192
    ds_read_b128 v[36:39], v10 offset:8208
    ds_read_b64 v[40:41], v10 offset:8224
    ds_read_b128 v[44:47], v10 offset:12864
    ds_read_b128 v[48:51], v10 offset:12880
    ds_read_b64 v[52:53], v10 offset:12896
    s_cmp_eq_u32 s38, 1
    s_cbranch_scc1 WJ1_66
    ds_read_b32 v12, v4 offset:68
    s_waitcnt lgkmcnt(7)
    v_alignbit_b32 v57, v22, v21, 16
    v_alignbit_b32 v58, v23, v22, 16
    v_alignbit_b32 v59, v24, v23, 16
    v_alignbit_b32 v60, v25, v24, 16
    v_alignbit_b32 v61, v26, v25, 16
    v_alignbit_b32 v62, v27, v26, 16
    v_alignbit_b32 v63, v28, v27, 16
    v_alignbit_b32 v64, v29, v28, 16
    v_pk_add_f16 v66, v57, v22
    v_pk_add_f16 v67, v58, v23
    v_pk_add_f16 v68, v59, v24
    v_pk_add_f16 v69, v60, v25
    v_pk_add_f16 v70, v61, v26
    v_pk_add_f16 v71, v62, v27
    v_pk_add_f16 v72, v63, v28
    v_pk_add_f16 v73, v64, v29
    v_pk_add_f16 v80, v66, v58
    v_pk_add_f16 v81, v67, v59
    v_pk_add_f16 v82, v68, v60
    v_pk_add_f16 v83, v69, v61
    v_pk_add_f16 v74, v67, v68
    v_pk_add_f16 v75, v68, v69
    v_pk_add_f16 v76, v69, v70
    v_pk_add_f16 v77, v70, v71
    v_pk_add_f16 v78, v71, v72
    v_pk_add_f16 v79, v72, v73
    s_waitcnt lgkmcnt(0)
    v_cmp_eq_u32 vcc, s84, v12
    s_cbranch_vccnz WJK_69
W_70:
    s_sleep 1
    ds_read_b32 v12, v4 offset:68
    s_sub_u32 s39, s39, 1
    s_cbranch_scc1 KS_ABORT
    s_waitcnt lgkmcnt(0)
    v_cmp_ne_u32 vcc, s84, v12
    s_cbranch_vccnz W_70
WJK_69:
    ds_write_b128 v11, v[80:83] offset:0
    v_pk_add_f16 v87, v22, v74
    v_pk_add_f16 v88, v23, v75
    v_pk_add_f16 v89, v24, v76
    v_pk_add_f16 v90, v25, v77
    v_pk_add_f16 v91, v26, v78
    ds_write_b128 v11, v[88:91] offset:3104
    v_pk_add_f16 v84, v70, v62
    v_pk_add_f16 v85, v71, v63
    v_pk_add_f16 v86, v72, v64
    v_pk_add_f16 v92, v74, v83
    v_pk_add_f16 v93, v75, v84
    v_pk_add_f16 v94, v76, v85
    v_pk_add_f16 v95, v77, v86
    ds_write_b128 v11, v[92:95] offset:6176
    v_pk_add_f16 v96, v87, v76
    v_pk_add_f16 v97, v88, v77
    v_pk_add_f16 v98, v89, v78
    v_pk_add_f16 v99, v90, v79
    ds_write_b128 v11, v[96:99] offset:8240
    ds_write_b8 v116, v5 offset:76
    ds_read_b32 v12, v4 offset:84
    v_alignbit_b32 v57, v34, v33, 16
    v_alignbit_b32 v58, v35, v34, 16
    v_alignbit_b32 v59, v36, v35, 16
    v_alignbit_b32 v60, v37, v36, 16
    v_alignbit_b32 v61, v38, v37, 16
    v_alignbit_b32 v62, v39, v38, 16
    v_alignbit_b32 v63, v40, v39, 16
    v_alignbit_b32 v64, v41, v40, 16
    v_pk_add_f16 v66, v57, v34
    v_pk_add_f16 v67, v58, v35
    v_pk_add_f16 v68, v59, v36
    v_pk_add_f16 v69, v60, v37
    v_pk_add_f16 v70, v61, v38
    v_pk_add_f16 v71, v62, v39
    v_pk_add_f16 v72, v63, v40
    v_pk_add_f16 v73, v64, v41
    v_pk_add_f16 v80, v66, v58
    v_pk_add_f16 v81, v67, v59
    v_pk_add_f16 v82, v68, v60
    v_pk_add_f16 v83, v69, v61
    v_pk_add_f16 v74, v67, v68
    v_pk_add_f16 v75, v68, v69
    v_pk_add_f16 v76, v69, v70
    v_pk_add_f16 v77, v70, v71
    v_pk_add_f16 v78, v71, v72
    v_pk_add_f16 v79, v72, v73
    s_waitcnt lgkmcnt(0)
    v_cmp_eq_u32 vcc, s84, v12
    s_cbranch_vccnz WJK_71
W_72:
    s_sleep 1
    ds_read_b32 v12, v4 offset:84
    s_sub_u32 s39, s39, 1
    s_cbranch_scc1 KS_ABORT
    s_waitcnt lgkmcnt(0)
    v_cmp_ne_u32 vcc, s84, v12
    s_cbranch_vccnz W_72
WJK_71:
    ds_write_b128 v11, v[80:83] offset:36672
    v_pk_add_f16 v87, v34, v74
    v_pk_add_f16 v88, v35, v75
    v_pk_add_f16 v89, v36, v76
    v_pk_add_f16 v90, v37, v77
    v_pk_add_f16 v91, v38, v78
    ds_write_b128 v11, v[88:91] offset:39776
    v_pk_add_f16 v84, v70, v62
    v_pk_add_f16 v85, v71, v63
    v_pk_add_f16 v86, v72, v64
    v_pk_add_f16 v92, v74, v83
    v_pk_add_f16 v93, v75, v84
    v_pk_add_f16 v94, v76, v85
    v_pk_add_f16 v95, v77, v86
    ds_write_b128 v11, v[92:95] offset:42848
    v_pk_add_f16 v96, v87, v76
    v_pk_add_f16 v97, v88, v77
    v_pk_add_f16 v98, v89, v78
    v_pk_add_f16 v99, v90, v79
    ds_write_b128 v11, v[96:99] offset:44912
    ds_write_b8 v116, v5 offset:92
    s_cmp_lt_u32 s41, 24
    s_cbranch_scc1 WJE_65
    ds_read_b32 v12, v4 offset:100
    v_alignbit_b32 v57, v46, v45, 16
    v_alignbit_b32 v58, v47, v46, 16
    v_alignbit_b32 v59, v48, v47, 16
    v_alignbit_b32 v60, v49, v48, 16
    v_alignbit_b32 v61, v50, v49, 16
    v_alignbit_b32 v62, v51, v50, 16
    v_alignbit_b32 v63, v52, v51, 16
    v_alignbit_b32 v64, v53, v52, 16
    v_pk_add_f16 v66, v57, v46
    v_pk_add_f16 v67, v58, v47
    v_pk_add_f16 v68, v59, v48
    v_pk_add_f16 v69, v60, v49
    v_pk_add_f16 v70, v61, v50
    v_pk_add_f16 v71, v62, v51
    v_pk_add_f16 v72, v63, v52
    v_pk_add_f16 v73, v64, v53
    v_pk_add_f16 v80, v66, v58
    v_pk_add_f16 v81, v67, v59
    v_pk_add_f16 v82, v68, v60
    v_pk_add_f16 v83, v69, v61
    v_pk_add_f16 v74, v67, v68
    v_pk_add_f16 v75, v68, v69
    v_pk_add_f16 v76, v69, v70
    v_pk_add_f16 v77, v70, v71
    v_pk_add_f16 v78, v71, v72
    v_pk_add_f16 v79, v72, v73
    s_waitcnt lgkmcnt(0)
    v_cmp_eq_u32 vcc, s84, v12
    s_cbranch_vccnz WJK_73
W_74:
    s_sleep 1
    ds_read_b32 v12, v4 offset:100
    s_sub_u32 s39, s39, 1
    s_cbranch_scc1 KS_ABORT
    s_waitcnt lgkmcnt(0)
    v_cmp_ne_u32 vcc, s84, v12
    s_cbranch_vccnz W_74
WJK_73:
    v_add_u32 v11, 73344, v11
    ds_write_b128 v11, v[80:83] offset:0
    v_pk_add_f16 v87, v46, v74
    v_pk_add_f16 v88, v47, v75
    v_pk_add_f16 v89, v48, v76
    v_pk_add_f16 v90, v49, v77
    v_pk_add_f16 v91, v50, v78
    ds_write_b128 v11, v[88:91] offset:3104
    v_pk_add_f16 v84, v70, v62
    v_pk_add_f16 v85, v71, v63
    v_pk_add_f16 v86, v72, v64
    v_pk_add_f16 v92, v74, v83
    v_pk_add_f16 v93, v75, v84
    v_pk_add_f16 v94, v76, v85
    v_pk_add_f16 v95, v77, v86
    ds_write_b128 v11, v[92:95] offset:6176
    v_pk_add_f16 v96, v87, v76
    v_pk_add_f16 v97, v88, v77
    v_pk_add_f16 v98, v89, v78
    v_pk_add_f16 v99, v90, v79
    ds_write_b128 v11, v[96:99] offset:8240
    ds_write_b8 v116, v5 offset:108
    s_branch WJE_65
WJ1_66:
    ds_read_b32 v12, v4 offset:68
    s_waitcnt lgkmcnt(7)
    v_alignbit_b32 v57, v22, v21, 16
    v_alignbit_b32 v58, v23, v22, 16
    v_alignbit_b32 v59, v24, v23, 16
    v_alignbit_b32 v60, v25, v24, 16
    v_alignbit_b32 v61, v26, v25, 16
    v_alignbit_b32 v62, v27, v26, 16
    v_alignbit_b32 v63, v28, v27, 16
    v_pk_add_f16 v66, v57, v22
    v_pk_add_f16 v67, v58, v23
    v_pk_add_f16 v68, v59, v24
    v_pk_add_f16 v69, v60, v25
    v_pk_add_f16 v70, v61, v26
    v_pk_add_f16 v71, v62, v27
    v_pk_add_f16 v72, v63, v28
    v_pk_add_f16 v80, v66, v58
    v_pk_add_f16 v81, v67, v59
    v_pk_add_f16 v82, v68, v60
    v_pk_add_f16 v83, v69, v61
    v_pk_add_f16 v75, v68, v69
    v_pk_add_f16 v76, v69, v70
    v_pk_add_f16 v77, v70, v71
    v_pk_add_f16 v78, v71, v72
    s_waitcnt lgkmcnt(0)
    v_cmp_eq_u32 vcc, s84, v12
    s_cbranch_vccnz WJK_75
W_76:
    s_sleep 1
    ds_read_b32 v12, v4 offset:68
    s_sub_u32 s39, s39, 1
    s_cbranch_scc1 KS_ABORT
    s_waitcnt lgkmcnt(0)
    v_cmp_ne_u32 vcc, s84, v12
    s_cbranch_vccnz W_76
WJK_75:
    ds_write_b128 v11, v[80:83] offset:0
    v_pk_add_f16 v88, v23, v75
    v_pk_add_f16 v89, v24, v76
    v_pk_add_f16 v90, v25, v77
    v_pk_add_f16 v91, v26, v78
    ds_write_b128 v11, v[88:91] offset:3104
    ds_write_b8 v116, v5 offset:76
    ds_read_b32 v12, v4 offset:84
    v_alignbit_b32 v57, v34, v33, 16
    v_alignbit_b32 v58, v35, v34, 16
    v_alignbit_b32 v59, v36, v35, 16
    v_alignbit_b32 v60, v37, v36, 16
    v_alignbit_b32 v61, v38, v37, 16
    v_alignbit_b32 v62, v39, v38, 16
    v_alignbit_b32 v63, v40, v39, 16
    v_pk_add_f16 v66, v57, v34
    v_pk_add_f16 v67, v58, v35
    v_pk_add_f16 v68, v59, v36
    v_pk_add_f16 v69, v60, v37
    v_pk_add_f16 v70, v61, v38
    v_pk_add_f16 v71, v62, v39
    v_pk_add_f16 v72, v63, v40
    v_pk_add_f16 v80, v66, v58
    v_pk_add_f16 v81, v67, v59
    v_pk_add_f16 v82, v68, v60
    v_pk_add_f16 v83, v69, v61
    v_pk_add_f16 v75, v68, v69
    v_pk_add_f16 v76, v69, v70
    v_pk_add_f16 v77, v70, v71
    v_pk_add_f16 v78, v71, v72
    s_waitcnt lgkmcnt(0)
    v_cmp_eq_u32 vcc, s84, v12
    s_cbranch_vccnz WJK_77
W_78:
    s_sleep 1
    ds_read_b32 v12, v4 offset:84
    s_sub_u32 s39, s39, 1
    s_cbranch_scc1 KS_ABORT
    s_waitcnt lgkmcnt(0)
    v_cmp_ne_u32 vcc, s84, v12
    s_cbranch_vccnz W_78
WJK_77:
    ds_write_b128 v11, v[80:83] offset:36672
    v_pk_add_f16 v88, v35, v75
    v_pk_add_f16 v89, v36, v76
    v_pk_add_f16 v90, v37, v77
    v_pk_add_f16 v91, v38, v78
    ds_write_b128 v11, v[88:91] offset:39776
    ds_write_b8 v116, v5 offset:92
    s_cmp_lt_u32 s41, 24
    s_cbranch_scc1 WJE_65
    ds_read_b32 v12, v4 offset:100
    v_alignbit_b32 v57, v46, v45, 16
    v_alignbit_b32 v58, v47, v46, 16
    v_alignbit_b32 v59, v48, v47, 16
    v_alignbit_b32 v60, v49, v48, 16
    v_alignbit_b32 v61, v50, v49, 16
    v_alignbit_b32 v62, v51, v50, 16
    v_alignbit_b32 v63, v52, v51, 16
    v_pk_add_f16 v66, v57, v46
    v_pk_add_f16 v67, v58, v47
    v_pk_add_f16 v68, v59, v48
    v_pk_add_f16 v69, v60, v49
    v_pk_add_f16 v70, v61, v50
    v_pk_add_f16 v71, v62, v51
    v_pk_add_f16 v72, v63, v52
    v_pk_add_f16 v80, v66, v58
    v_pk_add_f16 v81, v67, v59
    v_pk_add_f16 v82, v68, v60
    v_pk_add_f16 v83, v69, v61
    v_pk_add_f16 v75, v68, v69
    v_pk_add_f16 v76, v69, v70
    v_pk_add_f16 v77, v70, v71
    v_pk_add_f16 v78, v71, v72
    s_waitcnt lgkmcnt(0)
    v_cmp_eq_u32 vcc, s84, v12
    s_cbranch_vccnz WJK_79
W_80:
    s_sleep 1
    ds_read_b32 v12, v4 offset:100
    s_sub_u32 s39, s39, 1
    s_cbranch_scc1 KS_ABORT
    s_waitcnt lgkmcnt(0)
    v_cmp_ne_u32 vcc, s84, v12
    s_cbranch_vccnz W_80
WJK_79:
    v_add_u32 v11, 73344, v11
    ds_write_b128 v11, v[80:83] offset:0
    v_pk_add_f16 v88, v47, v75
    v_pk_add_f16 v89, v48, v76
    v_pk_add_f16 v90, v49, v77
    v_pk_add_f16 v91, v50, v78
    ds_write_b128 v11, v[88:91] offset:3104
    ds_write_b8 v116, v5 offset:108
    s_branch WJE_65
WJ2_67:
    ds_write_b8 v116, v5 offset:76
    ds_write_b8 v116, v5 offset:92
    ds_write_b8 v116, v5 offset:108
    s_sub_u32 s94, s41, 18
    s_cmp_ge_u32 s94, 14
    s_cbranch_scc1 WJE_65
    v_mul_u32_u24 v100, 57, v1
    v_lshrrev_b32 v100, 9, v100
    v_mul_u32_u24 v101, 9, v100
    v_sub_u32 v101, v1, v101
    v_mul_u32_u24 v100, 9216, v100
    v_lshl_add_u32 v100, v101, 7, v100
W_81:
    s_sleep 1
    ds_read_b32 v12, v4 offset:16
    s_sub_u32 s39, s39, 1
    s_cbranch_scc1 KS_ABORT
    s_waitcnt lgkmcnt(0)
    v_cmp_ne_u32 vcc, s84, v12
    s_cbranch_vccnz W_81
    s_bitcmp1_b32 s94, 0
    s_cselect_b32 s72, s28, s26
    s_cselect_b32 s73, s29, s27
    s_mov_b32 s74, 0x510000
    s_mov_b32 s75, 0x20000
    s_lshr_b32 s95, s94, 1
    s_mul_i32 s95, s95, 64512
    s_mul_i32 s96, s40, 1152
    s_add_u32 s95, s95, s96
    s_add_u32 s96, s95, 3870720
    buffer_load_dword v102, v100, s[72:75], s96 offen nt
    buffer_load_dword v102, v100, s[72:75], s96 offen sc1
    s_add_u32 s96, s95, 4322304
    buffer_load_dword v102, v100, s[72:75], s96 offen nt
    buffer_load_dword v102, v100, s[72:75], s96 offen sc1
    s_add_u32 s96, s95, 4773888
    buffer_load_dword v102, v100, s[72:75], s96 offen nt
    buffer_load_dword v102, v100, s[72:75], s96 offen sc1
    s_cmp_ge_u32 s94, 4
    s_cbranch_scc1 KS_PF2D
    s_add_u32 s96, s95, 5225472
    buffer_load_dword v102, v100, s[72:75], s96 offen nt
    buffer_load_dword v102, v100, s[72:75], s96 offen sc1
KS_PF2D:
    s_sub_u32 s94, 13, s94
    s_mov_b32 s72, s30
    s_mov_b32 s73, s31
    s_mov_b32 s74, 0x510000
    s_mov_b32 s75, 0x20000
    s_lshl_b32 s95, s94, 13
    s_mul_i32 s96, s40, 663552
    s_add_u32 s95, s95, s96
    v_lshlrev_b32 v100, 7, v1
    s_add_u32 s96, s95, 0
    buffer_load_dword v120, v100, s[72:75], s96 offen nt
    buffer_load_dword v120, v100, s[72:75], s96 offen sc1
    s_add_u32 s96, s95, 114688
    buffer_load_dword v120, v100, s[72:75], s96 offen nt
    buffer_load_dword v120, v100, s[72:75], s96 offen sc1
    s_add_u32 s96, s95, 229376
    buffer_load_dword v120, v100, s[72:75], s96 offen nt
    buffer_load_dword v120, v100, s[72:75], s96 offen sc1
    s_add_u32 s96, s95, 344064
    buffer_load_dword v120, v100, s[72:75], s96 offen nt
    buffer_load_dword v120, v100, s[72:75], s96 offen sc1
    s_add_u32 s96, s95, 458752
    buffer_load_dword v120, v100, s[72:75], s96 offen nt
    buffer_load_dword v120, v100, s[72:75], s96 offen sc1
    s_cmp_ge_u32 s94, 11
    s_cbranch_scc1 WJE_65
    s_add_u32 s96, s95, 573440
    buffer_load_dword v120, v100, s[72:75], s96 offen nt
    buffer_load_dword v120, v100, s[72:75], s96 offen sc1
WJE_65:
    s_setprio 0
    s_lshr_b32 s92, s90, 6
    s_lshl_b32 s92, s92, 9
    s_bfe_u32 s93, s90, 0x20004
    s_lshl_b32 s93, s93, 6
    s_add_u32 s92, s92, s93
    s_and_b32 s93, s90, 3
    s_lshl_b32 s93, s93, 4
    s_add_u32 s92, s92, s93
    s_and_b32 s93, s90, 12
    s_add_u32 s92, s92, s93
    s_lshr_b32 s93, s38, 1
    s_lshl_b32 s93, s93, 8
    s_add_u32 s92, s92, s93
    s_and_b32 s93, s38, 1
    s_lshl_b32 s93, s93, 1
    s_add_u32 s92, s92, s93
    v_lshrrev_b32 v113, 5, v1
    v_and_b32 v114, 31, v1
    v_add_u32 v112, s92, v113
    v_mul_u32_u24 v115, 1152, v112
    v_lshl_add_u32 v8, v114, 2, v115
    v_lshl_add_u32 v115, v114, 4, v115
    v_lshlrev_b32 v7, 2, v114
    v_lshlrev_b32 v6, 4, v114
    v_bfe_u32 v111, v1, 3, 1
    v_add_u32 v111, s92, v111
    v_mul_u32_u24 v111, 1152, v111
    v_and_b32 v9, 7, v1
    v_lshl_add_u32 v111, v9, 4, v111
    s_mov_b32 s64, s4
    s_mov_b32 s65, s5
    s_mov_b32 s66, 0x240000
    s_mov_b32 s67, 0x20000
    s_mov_b32 s68, s24
    s_mov_b32 s69, s25
    s_mov_b32 s70, 0x480
    s_mov_b32 s71, 0x20000
    buffer_load_dwordx4 v[10:13], v115, s[64:67], 0 offen
    buffer_load_dwordx4 v[14:17], v115, s[64:67], 0 offen offset:512
    buffer_load_dword v18, v8, s[64:67], 0 offen offset:1024
    buffer_load_dwordx4 v[50:53], v6, s[68:71], 0 offen
    buffer_load_dwordx4 v[54:57], v6, s[68:71], 0 offen offset:512
    buffer_load_dword v58, v7, s[68:71], 0 offen offset:1024
KS_L4:
    s_add_u32 s64, s36, 0x600000
    s_addc_u32 s65, s37, 0
    s_mov_b32 s66, 0x240000
    s_mov_b32 s67, 0x20000
    s_mov_b32 s68, s32
    s_mov_b32 s69, s33
    s_mov_b32 s70, 0x240000
    s_mov_b32 s71, 0x20000
    s_add_u32 s72, s36, 0x300000
    s_addc_u32 s73, s37, 0
    s_mov_b32 s74, 0x240000
    s_mov_b32 s75, 0x20000
    s_add_u32 s76, s36, 0x840000
    s_addc_u32 s77, s37, 0
    s_mov_b32 s78, 0x3000
    s_mov_b32 s79, 0x20000
    s_not_b32 s93, s90
    v_xor_b32 v8, s93, v0
    v_lshrrev_b32 v6, 1, v0
    v_lshlrev_b32 v6, 6, v6
    v_and_b32 v8, 1, v8
    v_lshl_add_u32 v6, v8, 4, v6
    s_lshr_b32 s92, s90, 2
    s_lshl_b32 s92, s92, 15
    s_and_b32 s93, s90, 1
    s_lshl_b32 s93, s93, 14
    s_add_u32 s92, s92, s93
    s_and_b32 s93, s90, 2
    s_lshl_b32 s93, s93, 4
    s_add_u32 s92, s92, s93
    s_lshr_b32 s94, s90, 2
    s_lshl_b32 s94, s94, 12
    s_and_b32 s93, s90, 3
    s_lshl_b32 s93, s93, 4
    s_add_u32 s94, s94, s93
    s_lshl_b32 s93, s38, 10
    s_add_u32 s94, s94, s93
    s_add_u32 s94, s94, 0x200000
    v_lshlrev_b32 v9, 6, v2
    s_lshl_b32 s93, s90, 5
    s_and_b32 s95, s93, 0x1f80
    v_xor_b32 v6, s95, v6
    s_and_b32 s95, s93, 0x380
    v_xor_b32 v9, s95, v9
    s_and_b32 s95, s93, 0xc00
    s_xor_b32 s94, s94, s95
    s_and_b32 s93, s90, 1
    s_lshl_b32 s93, s93, 13
    s_xor_b32 s92, s92, s93
    s_xor_b32 s93, s92, 0x2000
    s_mul_i32 s95, s38, 2304
    s_add_u32 s95, s95, 17088
    v_lshl_add_u32 v117, v114, 5, s95
    v_lshl_add_u32 v110, v114, 3, s95
    s_lshl_b32 s95, s38, 9
    s_add_u32 s95, s95, 26368
    v_lshl_add_u32 v108, v1, 2, s95
    v_lshl_add_u32 v109, v1, 4, s95
    s_mov_b32 s95, 0x02020202
    v_mul_lo_u32 v118, v113, s95
    v_add_u32 v118, 0x05040100, v118
    v_lshlrev_b32 v8, 2, v0
    v_add_u32 v8, 17088, v8
    s_lshl_b32 s95, s38, 6
    s_add_u32 s95, s95, 19136
    v_lshl_add_u32 v119, v2, 2, s95
    s_waitcnt vmcnt(0)
    v_lshlrev_b32 v20, 16, v10
    v_and_b32 v21, 0xffff0000, v10
    v_lshlrev_b32 v22, 16, v11
    v_and_b32 v23, 0xffff0000, v11
    v_lshlrev_b32 v24, 16, v12
    v_and_b32 v25, 0xffff0000, v12
    v_lshlrev_b32 v26, 16, v13
    v_and_b32 v27, 0xffff0000, v13
    v_lshlrev_b32 v28, 16, v14
    v_and_b32 v29, 0xffff0000, v14
    v_lshlrev_b32 v30, 16, v15
    v_and_b32 v31, 0xffff0000, v15
    v_lshlrev_b32 v32, 16, v16
    v_and_b32 v33, 0xffff0000, v16
    v_lshlrev_b32 v34, 16, v17
    v_and_b32 v35, 0xffff0000, v17
    v_lshlrev_b32 v36, 16, v18
    v_and_b32 v37, 0xffff0000, v18
W_82:
    s_sleep 1
    ds_read_b32 v60, v4 offset:52
    s_sub_u32 s39, s39, 1
    s_cbranch_scc1 KS_ABORT
    s_waitcnt lgkmcnt(0)
    v_cmp_ne_u32 vcc, s84, v60
    s_cbranch_vccnz W_82
    s_setprio 3
    s_branch ZPE_84
ZP_83:
    s_sleep 1
ZPE_84:
    buffer_load_dwordx4 v[68:71], v4, s[64:67], s94 offen sc1
    s_sub_u32 s39, s39, 1
    s_cbranch_scc1 KS_ABORT
    s_waitcnt vmcnt(0)
    v_max3_u32 v44, v68, v69, v70
    v_max_u32 v44, v44, v71
    v_cmp_eq_u32 vcc, -1, v44
    s_cbranch_vccnz ZP_83
    s_branch ZPE_86
ZP_85:
    s_sleep 1
ZPE_86:
    buffer_load_dwordx4 v[60:63], v6, s[64:67], s92 offen sc1
    buffer_load_dwordx4 v[64:67], v6, s[64:67], s93 offen sc1
    buffer_load_dwordx4 v[68:71], v9, s[64:67], s94 offen sc1
    s_sub_u32 s39, s39, 1
    s_cbranch_scc1 KS_ABORT
    s_waitcnt vmcnt(0)
    v_max3_u32 v44, v60, v61, v62
    v_max3_u32 v44, v44, v63, v64
    v_max3_u32 v44, v44, v65, v66
    v_max3_u32 v44, v44, v67, v68
    v_max3_u32 v44, v44, v69, v70
    v_max_u32 v44, v44, v71
    v_cmp_eq_u32 vcc, -1, v44
    s_cbranch_vccnz ZP_85
    ds_write2st64_b32 v8, v60, v61 offset0:0 offset1:9
    ds_write2st64_b32 v8, v62, v63 offset0:18 offset1:27
    ds_write2st64_b32 v8, v64, v65 offset0:4 offset1:13
    ds_write2st64_b32 v8, v66, v67 offset0:22 offset1:31
    ds_write2st64_b32 v119, v68, v69 offset0:0 offset1:9
    ds_write2st64_b32 v119, v70, v71 offset0:18 offset1:27
    ds_write_b8 v116, v5 offset:20
W_87:
    ds_read_b32 v60, v4 offset:20
    s_sub_u32 s39, s39, 1
    s_cbranch_scc1 KS_ABORT
    s_waitcnt lgkmcnt(0)
    v_cmp_ne_u32 vcc, s84, v60
    s_cbranch_vccnz W_87
    ds_read_b128 v[60:63], v117 offset:0
    ds_read_b128 v[64:67], v117 offset:16
    ds_read_b128 v[68:71], v117 offset:1024
    ds_read_b128 v[72:75], v117 offset:1040
    ds_read_b64 v[76:77], v110 offset:2048
    s_waitcnt lgkmcnt(4)
    v_perm_b32 v44, v61, v60, v118
    v_lshlrev_b32 v46, 16, v44
    v_and_b32 v47, 0xffff0000, v44
    v_pk_add_f32 v[46:47], v[46:47], v[20:21]
    v_cvt_pk_bf16_f32 v44, v46, v47
    v_lshlrev_b32 v20, 16, v44
    v_and_b32 v21, 0xffff0000, v44
    v_perm_b32 v44, v63, v62, v118
    v_lshlrev_b32 v46, 16, v44
    v_and_b32 v47, 0xffff0000, v44
    v_pk_add_f32 v[46:47], v[46:47], v[22:23]
    v_cvt_pk_bf16_f32 v44, v46, v47
    v_lshlrev_b32 v22, 16, v44
    v_and_b32 v23, 0xffff0000, v44
    s_waitcnt lgkmcnt(3)
    v_perm_b32 v44, v65, v64, v118
    v_lshlrev_b32 v46, 16, v44
    v_and_b32 v47, 0xffff0000, v44
    v_pk_add_f32 v[46:47], v[46:47], v[24:25]
    v_cvt_pk_bf16_f32 v44, v46, v47
    v_lshlrev_b32 v24, 16, v44
    v_and_b32 v25, 0xffff0000, v44
    v_perm_b32 v44, v67, v66, v118
    v_lshlrev_b32 v46, 16, v44
    v_and_b32 v47, 0xffff0000, v44
    v_pk_add_f32 v[46:47], v[46:47], v[26:27]
    v_cvt_pk_bf16_f32 v44, v46, v47
    v_lshlrev_b32 v26, 16, v44
    v_and_b32 v27, 0xffff0000, v44
    s_waitcnt lgkmcnt(2)
    v_perm_b32 v44, v69, v68, v118
    v_lshlrev_b32 v46, 16, v44
    v_and_b32 v47, 0xffff0000, v44
    v_pk_add_f32 v[46:47], v[46:47], v[28:29]
    v_cvt_pk_bf16_f32 v44, v46, v47
    v_lshlrev_b32 v28, 16, v44
    v_and_b32 v29, 0xffff0000, v44
    v_perm_b32 v44, v71, v70, v118
    v_lshlrev_b32 v46, 16, v44
    v_and_b32 v47, 0xffff0000, v44
    v_pk_add_f32 v[46:47], v[46:47], v[30:31]
    v_cvt_pk_bf16_f32 v44, v46, v47
    v_lshlrev_b32 v30, 16, v44
    v_and_b32 v31, 0xffff0000, v44
    s_waitcnt lgkmcnt(1)
    v_perm_b32 v44, v73, v72, v118
    v_lshlrev_b32 v46, 16, v44
    v_and_b32 v47, 0xffff0000, v44
    v_pk_add_f32 v[46:47], v[46:47], v[32:33]
    v_cvt_pk_bf16_f32 v44, v46, v47
    v_lshlrev_b32 v32, 16, v44
    v_and_b32 v33, 0xffff0000, v44
    v_perm_b32 v44, v75, v74, v118
    v_lshlrev_b32 v46, 16, v44
    v_and_b32 v47, 0xffff0000, v44
    v_pk_add_f32 v[46:47], v[46:47], v[34:35]
    v_cvt_pk_bf16_f32 v44, v46, v47
    v_lshlrev_b32 v34, 16, v44
    v_and_b32 v35, 0xffff0000, v44
    s_waitcnt lgkmcnt(0)
    v_perm_b32 v44, v77, v76, v118
    v_lshlrev_b32 v46, 16, v44
    v_and_b32 v47, 0xffff0000, v44
    v_pk_add_f32 v[46:47], v[46:47], v[36:37]
    v_cvt_pk_bf16_f32 v44, v46, v47
    v_lshlrev_b32 v36, 16, v44
    v_and_b32 v37, 0xffff0000, v44
    v_pk_add_f32 v[44:45], v[20:21], v[22:23]
    v_pk_add_f32 v[46:47], v[24:25], v[26:27]
    v_pk_add_f32 v[44:45], v[44:45], v[28:29]
    v_pk_add_f32 v[46:47], v[46:47], v[30:31]
    v_pk_add_f32 v[44:45], v[44:45], v[32:33]
    v_pk_add_f32 v[46:47], v[46:47], v[34:35]
    v_pk_add_f32 v[44:45], v[44:45], v[36:37]
    v_pk_add_f32 v[44:45], v[44:45], v[46:47]
    v_add_f32 v44, v44, v45
    s_nop 1
    v_add_f32_dpp v44, v44, v44 row_ror:8 row_mask:0xf bank_mask:0xf
    s_nop 1
    v_add_f32_dpp v44, v44, v44 row_ror:4 row_mask:0xf bank_mask:0xf
    s_nop 1
    v_add_f32_dpp v44, v44, v44 row_ror:2 row_mask:0xf bank_mask:0xf
    s_nop 1
    v_add_f32_dpp v44, v44, v44 row_ror:1 row_mask:0xf bank_mask:0xf
    v_mov_b32 v46, v44
    s_nop 1
    v_permlane16_swap_b32 v44, v46
    v_add_f32 v44, v44, v46
    v_mul_f32 v48, 0x3ae38e39, v44
    v_mov_b32 v49, v48
    v_cvt_pk_bf16_f32 v40, v48, v48
    v_and_b32 v40, 0xffff0000, v40
    v_mov_b32 v41, v40
    v_pk_add_f32 v[42:43], v[20:21], v[48:49] neg_lo:[0,1] neg_hi:[0,1]
    v_pk_mul_f32 v[44:45], v[42:43], v[42:43]
    v_pk_add_f32 v[42:43], v[22:23], v[48:49] neg_lo:[0,1] neg_hi:[0,1]
    v_pk_mul_f32 v[46:47], v[42:43], v[42:43]
    v_pk_add_f32 v[42:43], v[24:25], v[48:49] neg_lo:[0,1] neg_hi:[0,1]
    v_pk_fma_f32 v[44:45], v[42:43], v[42:43], v[44:45]
    v_pk_add_f32 v[42:43], v[26:27], v[48:49] neg_lo:[0,1] neg_hi:[0,1]
    v_pk_fma_f32 v[46:47], v[42:43], v[42:43], v[46:47]
    v_pk_add_f32 v[42:43], v[28:29], v[48:49] neg_lo:[0,1] neg_hi:[0,1]
    v_pk_fma_f32 v[44:45], v[42:43], v[42:43], v[44:45]
    v_pk_add_f32 v[42:43], v[30:31], v[48:49] neg_lo:[0,1] neg_hi:[0,1]
    v_pk_fma_f32 v[46:47], v[42:43], v[42:43], v[46:47]
    v_pk_add_f32 v[42:43], v[32:33], v[48:49] neg_lo:[0,1] neg_hi:[0,1]
    v_pk_fma_f32 v[44:45], v[42:43], v[42:43], v[44:45]
    v_pk_add_f32 v[42:43], v[34:35], v[48:49] neg_lo:[0,1] neg_hi:[0,1]
    v_pk_fma_f32 v[46:47], v[42:43], v[42:43], v[46:47]
    v_pk_add_f32 v[42:43], v[36:37], v[48:49] neg_lo:[0,1] neg_hi:[0,1]
    v_pk_fma_f32 v[44:45], v[42:43], v[42:43], v[44:45]
    v_pk_add_f32 v[44:45], v[44:45], v[46:47]
    v_add_f32 v44, v44, v45
    s_nop 1
    v_add_f32_dpp v44, v44, v44 row_ror:8 row_mask:0xf bank_mask:0xf
    s_nop 1
    v_add_f32_dpp v44, v44, v44 row_ror:4 row_mask:0xf bank_mask:0xf
    s_nop 1
    v_add_f32_dpp v44, v44, v44 row_ror:2 row_mask:0xf bank_mask:0xf
    s_nop 1
    v_add_f32_dpp v44, v44, v44 row_ror:1 row_mask:0xf bank_mask:0xf
    v_mov_b32 v46, v44
    s_nop 1
    v_permlane16_swap_b32 v44, v46
    v_add_f32 v44, v44, v46
    v_mul_f32 v44, 0x3ae38e39, v44
    v_cvt_pk_bf16_f32 v44, v44, v44
    v_and_b32 v44, 0xffff0000, v44
    v_add_f32 v44, 0x3727c5ac, v44
    v_cvt_pk_bf16_f32 v44, v44, v44
    v_and_b32 v44, 0xffff0000, v44
    v_sqrt_f32 v44, v44
    s_nop 0
    v_cvt_pk_bf16_f32 v44, v44, v44
    v_and_b32 v44, 0xffff0000, v44
    v_rcp_f32 v42, v44
    s_nop 0
    v_mov_b32 v43, v42
    v_mov_b32 v60, 0
    v_mov_b32 v61, 0
    v_pk_add_f32 v[44:45], v[20:21], v[40:41] neg_lo:[0,1] neg_hi:[0,1]
    v_cvt_pk_bf16_f32 v10, v44, v45
    v_lshlrev_b32 v44, 16, v10
    v_and_b32 v45, 0xffff0000, v10
    v_pk_mul_f32 v[44:45], v[44:45], v[42:43]
    v_cvt_pk_bf16_f32 v10, v44, v45
    v_lshlrev_b32 v44, 16, v10
    v_and_b32 v45, 0xffff0000, v10
    v_lshlrev_b32 v46, 16, v50
    v_and_b32 v47, 0xffff0000, v50
    v_pk_fma_f32 v[60:61], v[44:45], v[46:47], v[60:61]
    v_pk_add_f32 v[20:21], v[44:45], v[20:21]
    v_pk_add_f32 v[44:45], v[22:23], v[40:41] neg_lo:[0,1] neg_hi:[0,1]
    v_cvt_pk_bf16_f32 v11, v44, v45
    v_lshlrev_b32 v44, 16, v11
    v_and_b32 v45, 0xffff0000, v11
    v_pk_mul_f32 v[44:45], v[44:45], v[42:43]
    v_cvt_pk_bf16_f32 v11, v44, v45
    v_lshlrev_b32 v44, 16, v11
    v_and_b32 v45, 0xffff0000, v11
    v_lshlrev_b32 v46, 16, v51
    v_and_b32 v47, 0xffff0000, v51
    v_pk_fma_f32 v[60:61], v[44:45], v[46:47], v[60:61]
    v_pk_add_f32 v[22:23], v[44:45], v[22:23]
    v_pk_add_f32 v[44:45], v[24:25], v[40:41] neg_lo:[0,1] neg_hi:[0,1]
    v_cvt_pk_bf16_f32 v12, v44, v45
    v_lshlrev_b32 v44, 16, v12
    v_and_b32 v45, 0xffff0000, v12
    v_pk_mul_f32 v[44:45], v[44:45], v[42:43]
    v_cvt_pk_bf16_f32 v12, v44, v45
    v_lshlrev_b32 v44, 16, v12
    v_and_b32 v45, 0xffff0000, v12
    v_lshlrev_b32 v46, 16, v52
    v_and_b32 v47, 0xffff0000, v52
    v_pk_fma_f32 v[60:61], v[44:45], v[46:47], v[60:61]
    v_pk_add_f32 v[24:25], v[44:45], v[24:25]
    v_pk_add_f32 v[44:45], v[26:27], v[40:41] neg_lo:[0,1] neg_hi:[0,1]
    v_cvt_pk_bf16_f32 v13, v44, v45
    v_lshlrev_b32 v44, 16, v13
    v_and_b32 v45, 0xffff0000, v13
    v_pk_mul_f32 v[44:45], v[44:45], v[42:43]
    v_cvt_pk_bf16_f32 v13, v44, v45
    v_lshlrev_b32 v44, 16, v13
    v_and_b32 v45, 0xffff0000, v13
    v_lshlrev_b32 v46, 16, v53
    v_and_b32 v47, 0xffff0000, v53
    v_pk_fma_f32 v[60:61], v[44:45], v[46:47], v[60:61]
    v_pk_add_f32 v[26:27], v[44:45], v[26:27]
    v_pk_add_f32 v[44:45], v[28:29], v[40:41] neg_lo:[0,1] neg_hi:[0,1]
    v_cvt_pk_bf16_f32 v14, v44, v45
    v_lshlrev_b32 v44, 16, v14
    v_and_b32 v45, 0xffff0000, v14
    v_pk_mul_f32 v[44:45], v[44:45], v[42:43]
    v_cvt_pk_bf16_f32 v14, v44, v45
    v_lshlrev_b32 v44, 16, v14
    v_and_b32 v45, 0xffff0000, v14
    v_lshlrev_b32 v46, 16, v54
    v_and_b32 v47, 0xffff0000, v54
    v_pk_fma_f32 v[60:61], v[44:45], v[46:47], v[60:61]
    v_pk_add_f32 v[28:29], v[44:45], v[28:29]
    v_pk_add_f32 v[44:45], v[30:31], v[40:41] neg_lo:[0,1] neg_hi:[0,1]
    v_cvt_pk_bf16_f32 v15, v44, v45
    v_lshlrev_b32 v44, 16, v15
    v_and_b32 v45, 0xffff0000, v15
    v_pk_mul_f32 v[44:45], v[44:45], v[42:43]
    v_cvt_pk_bf16_f32 v15, v44, v45
    v_lshlrev_b32 v44, 16, v15
    v_and_b32 v45, 0xffff0000, v15
    v_lshlrev_b32 v46, 16, v55
    v_and_b32 v47, 0xffff0000, v55
    v_pk_fma_f32 v[60:61], v[44:45], v[46:47], v[60:61]
    v_pk_add_f32 v[30:31], v[44:45], v[30:31]
    v_pk_add_f32 v[44:45], v[32:33], v[40:41] neg_lo:[0,1] neg_hi:[0,1]
    v_cvt_pk_bf16_f32 v16, v44, v45
    v_lshlrev_b32 v44, 16, v16
    v_and_b32 v45, 0xffff0000, v16
    v_pk_mul_f32 v[44:45], v[44:45], v[42:43]
    v_cvt_pk_bf16_f32 v16, v44, v45
    v_lshlrev_b32 v44, 16, v16
    v_and_b32 v45, 0xffff0000, v16
    v_lshlrev_b32 v46, 16, v56
    v_and_b32 v47, 0xffff0000, v56
    v_pk_fma_f32 v[60:61], v[44:45], v[46:47], v[60:61]
    v_pk_add_f32 v[32:33], v[44:45], v[32:33]
    v_pk_add_f32 v[44:45], v[34:35], v[40:41] neg_lo:[0,1] neg_hi:[0,1]
    v_cvt_pk_bf16_f32 v17, v44, v45
    v_lshlrev_b32 v44, 16, v17
    v_and_b32 v45, 0xffff0000, v17
    v_pk_mul_f32 v[44:45], v[44:45], v[42:43]
    v_cvt_pk_bf16_f32 v17, v44, v45
    v_lshlrev_b32 v44, 16, v17
    v_and_b32 v45, 0xffff0000, v17
    v_lshlrev_b32 v46, 16, v57
    v_and_b32 v47, 0xffff0000, v57
    v_pk_fma_f32 v[60:61], v[44:45], v[46:47], v[60:61]
    v_pk_add_f32 v[34:35], v[44:45], v[34:35]
    v_pk_add_f32 v[44:45], v[36:37], v[40:41] neg_lo:[0,1] neg_hi:[0,1]
    v_cvt_pk_bf16_f32 v18, v44, v45
    v_lshlrev_b32 v44, 16, v18
    v_and_b32 v45, 0xffff0000, v18
    v_pk_mul_f32 v[44:45], v[44:45], v[42:43]
    v_cvt_pk_bf16_f32 v18, v44, v45
    v_lshlrev_b32 v44, 16, v18
    v_and_b32 v45, 0xffff0000, v18
    v_lshlrev_b32 v46, 16, v58
    v_and_b32 v47, 0xffff0000, v58
    v_pk_fma_f32 v[60:61], v[44:45], v[46:47], v[60:61]
    v_pk_add_f32 v[36:37], v[44:45], v[36:37]
    v_add_f32 v60, v60, v61
    s_nop 1
    v_add_f32_dpp v60, v60, v60 row_ror:8 row_mask:0xf bank_mask:0xf
    s_nop 1
    v_add_f32_dpp v60, v60, v60 row_ror:4 row_mask:0xf bank_mask:0xf
    s_nop 1
    v_add_f32_dpp v60, v60, v60 row_ror:2 row_mask:0xf bank_mask:0xf
    s_nop 1
    v_add_f32_dpp v60, v60, v60 row_ror:1 row_mask:0xf bank_mask:0xf
    v_mov_b32 v61, v60
    s_nop 1
    v_permlane16_swap_b32 v60, v61
    v_add_f32 v60, v60, v61
    v_cvt_pk_bf16_f32 v60, v60, v60
    v_ashrrev_i32 v61, 31, v60
    v_or_b32 v61, 0x80000000, v61
    v_xor_b32 v60, v60, v61
    v_and_b32 v60, 0xffff0000, v60
    v_sub_u32 v62, 0x87ff, v112
    v_or_b32 v60, v60, v62
    v_lshl_add_u32 v61, v116, 1, v113
    v_lshlrev_b32 v61, 2, v61
    s_mov_b32 exec_lo, 1
    s_mov_b32 exec_hi, 1
    ds_write_b32 v61, v60 offset:800
    s_mov_b64 exec, 1
    ds_add_rtn_u32 v62, v4, v5 offset:12
    s_mov_b64 exec, 3
    v_lshlrev_b32 v61, 4, v114
    s_lshl_b32 s92, s90, 5
    ds_read_b128 v[64:67], v61 offset:800
    s_waitcnt lgkmcnt(1)
    v_readfirstlane_b32 s93, v62
    s_cmp_lg_u32 s93, 3
    s_cbranch_scc1 KS_NOKEY
    s_waitcnt lgkmcnt(0)
    buffer_store_dwordx4 v[64:67], v61, s[76:79], s92 offen sc1
KS_NOKEY:
    s_mov_b64 exec, -1
    v_cvt_pk_bf16_f32 v58, v36, v37
    ds_write_b32 v108, v18
    ds_write_b32 v108, v58 offset:256
    ds_read_b128 v[64:67], v109
    buffer_store_dwordx4 v[10:13], v115, s[72:75], 0 offen sc1
    buffer_store_dwordx4 v[14:17], v115, s[72:75], 0 offen offset:512 sc1
    v_cvt_pk_bf16_f32 v50, v20, v21
    v_cvt_pk_bf16_f32 v51, v22, v23
    v_cvt_pk_bf16_f32 v52, v24, v25
    v_cvt_pk_bf16_f32 v53, v26, v27
    v_cvt_pk_bf16_f32 v54, v28, v29
    v_cvt_pk_bf16_f32 v55, v30, v31
    v_cvt_pk_bf16_f32 v56, v32, v33
    v_cvt_pk_bf16_f32 v57, v34, v35
    s_mov_b64 exec, 0xffff
    s_waitcnt lgkmcnt(0)
    buffer_store_dwordx4 v[64:67], v111, s[72:75], 0 offen offset:1024 sc1
    s_mov_b64 exec, 0xffff0000
    buffer_store_dwordx4 v[64:67], v111, s[68:71], 0 offen offset:1024 sc1
    s_mov_b64 exec, -1
    buffer_store_dwordx4 v[50:53], v115, s[68:71], 0 offen sc1
    buffer_store_dwordx4 v[54:57], v115, s[68:71], 0 offen offset:512 sc1
    s_cmp_lg_u32 s93, 3
    s_cbranch_scc1 KS_NOKEY2
    s_waitcnt vmcnt(6)
    ds_write_b32 v4, v5 offset:24
KS_NOKEY2:
    s_waitcnt vmcnt(0)
    s_mov_b64 exec, 1
    ds_add_rtn_u32 v62, v4, v5 offset:176
    s_waitcnt lgkmcnt(0)
    v_cmp_eq_u32 vcc, 3, v62
    s_and_b64 exec, exec, vcc
    s_cbranch_execz KS_NOF2
    s_lshl_b32 s92, s2, 4
    s_add_u32 s92, s92, 8192
    buffer_store_dword v5, v4, s[76:79], s92 offen sc1
KS_NOF2:
    s_mov_b64 exec, -1
    s_setprio 0
    s_cmp_lt_u32 s41, 18
    s_cbranch_scc1 KS_B
    s_waitcnt lgkmcnt(0)
    s_endpgm
KS_T:
    s_setprio 0
    s_cmp_ge_u32 s38, 10
    s_cbranch_scc1 KS_P
    v_and_b32 v6, 1, v1
    v_subrev_u32 v6, 1, v6
    v_and_b32 v7, 7, v1
    v_lshlrev_b32 v7, 2, v7
    s_add_u32 s76, s36, 0x840000
    s_addc_u32 s77, s37, 0
    s_mov_b32 s78, 0x3000
    s_mov_b32 s79, 0x20000
    s_cmp_eq_u32 s38, 9
    s_cbranch_scc1 KS_W9
    s_cmp_eq_u32 s38, 8
    s_cbranch_scc1 KS_L2W
    s_sub_u32 s93, s38, 4
    s_lshl_b32 s92, s93, 10
    v_lshl_add_u32 v33, v1, 4, s92
    s_movk_i32 s92, 4096
    s_lshl_b32 s93, s93, 7
    v_lshlrev_b32 v32, 4, v2
    v_lshl_add_u32 v32, v3, 5, v32
    v_add_u32 v32, s93, v32
W_88:
    s_sleep 1
    ds_read_b32 v8, v4 offset:24
    s_sub_u32 s39, s39, 1
    s_cbranch_scc1 KS_ABORT
    s_waitcnt lgkmcnt(0)
    v_cmp_eq_u32 vcc, 0, v8
    s_cbranch_vccnz W_88
    s_setprio 2
    s_sleep 20
    s_branch ZPE_90
ZP_89:
    s_sleep 4
ZPE_90:
    buffer_load_dwordx4 v[8:11], v33, s[76:79], 0 offen sc1
    buffer_load_dwordx4 v[12:15], v33, s[76:79], s92 offen sc1
    s_sub_u32 s39, s39, 1
    s_cbranch_scc1 KS_ABORT
    s_waitcnt vmcnt(0)
    v_max3_u32 v44, v8, v9, v10
    v_max3_u32 v44, v44, v11, v12
    v_max3_u32 v44, v44, v13, v14
    v_max_u32 v44, v44, v15
    v_cmp_eq_u32 vcc, -1, v44
    s_cbranch_vccnz ZP_89
    ds_write_b32 v4, v5 offset:196
    v_max_u32 v16, v8, v9
    v_min_u32 v9, v8, v9
    v_max_u32 v17, v12, v13
    v_min_u32 v13, v12, v13
    v_max_u32 v18, v10, v11
    v_min_u32 v11, v10, v11
    v_max_u32 v19, v14, v15
    v_min_u32 v15, v14, v15
    v_max_u32 v20, v16, v18
    v_min_u32 v18, v16, v18
    v_max_u32 v21, v17, v19
    v_min_u32 v19, v17, v19
    v_max_u32 v22, v9, v11
    v_min_u32 v11, v9, v11
    v_max_u32 v23, v13, v15
    v_min_u32 v15, v13, v15
    v_max_u32 v24, v22, v18
    v_min_u32 v18, v22, v18
    v_max_u32 v25, v23, v19
    v_min_u32 v19, v23, v19
    v_mov_b32_dpp v26, v11 quad_perm:[1,0,3,2] row_mask:0xf bank_mask:0xf
    v_mov_b32_dpp v27, v18 quad_perm:[1,0,3,2] row_mask:0xf bank_mask:0xf
    v_mov_b32_dpp v8, v24 quad_perm:[1,0,3,2] row_mask:0xf bank_mask:0xf
    v_mov_b32_dpp v12, v20 quad_perm:[1,0,3,2] row_mask:0xf bank_mask:0xf
    v_med3_u32 v26, v20, v26, v6
    v_med3_u32 v27, v24, v27, v6
    v_med3_u32 v8, v18, v8, v6
    v_med3_u32 v12, v11, v12, v6
    v_max_u32 v10, v26, v8
    v_min_u32 v8, v26, v8
    v_max_u32 v14, v27, v12
    v_min_u32 v12, v27, v12
    v_max_u32 v16, v10, v14
    v_min_u32 v14, v10, v14
    v_max_u32 v17, v8, v12
    v_min_u32 v12, v8, v12
    v_mov_b32_dpp v9, v15 quad_perm:[1,0,3,2] row_mask:0xf bank_mask:0xf
    v_mov_b32_dpp v13, v19 quad_perm:[1,0,3,2] row_mask:0xf bank_mask:0xf
    v_mov_b32_dpp v22, v25 quad_perm:[1,0,3,2] row_mask:0xf bank_mask:0xf
    v_mov_b32_dpp v23, v21 quad_perm:[1,0,3,2] row_mask:0xf bank_mask:0xf
    v_med3_u32 v9, v21, v9, v6
    v_med3_u32 v13, v25, v13, v6
    v_med3_u32 v22, v19, v22, v6
    v_med3_u32 v23, v15, v23, v6
    v_max_u32 v20, v9, v22
    v_min_u32 v22, v9, v22
    v_max_u32 v24, v13, v23
    v_min_u32 v23, v13, v23
    v_max_u32 v18, v20, v24
    v_min_u32 v24, v20, v24
    v_max_u32 v11, v22, v23
    v_min_u32 v23, v22, v23
    s_nop 1
    v_max_u32_dpp v16, v23, v16 quad_perm:[1,0,3,2] row_mask:0xf bank_mask:0xf
    v_max_u32_dpp v14, v11, v14 quad_perm:[1,0,3,2] row_mask:0xf bank_mask:0xf
    v_max_u32_dpp v17, v24, v17 quad_perm:[1,0,3,2] row_mask:0xf bank_mask:0xf
    v_max_u32_dpp v12, v18, v12 quad_perm:[1,0,3,2] row_mask:0xf bank_mask:0xf
    v_mov_b32_dpp v26, v16 quad_perm:[1,0,3,2] row_mask:0xf bank_mask:0xf
    v_mov_b32_dpp v27, v14 quad_perm:[1,0,3,2] row_mask:0xf bank_mask:0xf
    v_mov_b32_dpp v10, v17 quad_perm:[1,0,3,2] row_mask:0xf bank_mask:0xf
    v_mov_b32_dpp v8, v12 quad_perm:[1,0,3,2] row_mask:0xf bank_mask:0xf
    v_med3_u32 v26, v16, v26, v6
    v_med3_u32 v27, v14, v27, v6
    v_med3_u32 v10, v17, v10, v6
    v_med3_u32 v8, v12, v8, v6
    v_max_u32 v21, v26, v10
    v_min_u32 v10, v26, v10
    v_max_u32 v25, v27, v8
    v_min_u32 v8, v27, v8
    v_max_u32 v19, v21, v25
    v_min_u32 v25, v21, v25
    v_max_u32 v15, v10, v8
    v_min_u32 v8, v10, v8
    s_nop 1
    v_max_u32_dpp v9, v8, v19 quad_perm:[3,2,1,0] row_mask:0xf bank_mask:0xf
    v_max_u32_dpp v13, v15, v25 quad_perm:[3,2,1,0] row_mask:0xf bank_mask:0xf
    v_max_u32_dpp v20, v25, v15 quad_perm:[3,2,1,0] row_mask:0xf bank_mask:0xf
    v_max_u32_dpp v22, v19, v8 quad_perm:[3,2,1,0] row_mask:0xf bank_mask:0xf
    v_mov_b32_dpp v18, v9 quad_perm:[1,0,3,2] row_mask:0xf bank_mask:0xf
    v_mov_b32_dpp v24, v13 quad_perm:[1,0,3,2] row_mask:0xf bank_mask:0xf
    v_mov_b32_dpp v11, v20 quad_perm:[1,0,3,2] row_mask:0xf bank_mask:0xf
    v_mov_b32_dpp v23, v22 quad_perm:[1,0,3,2] row_mask:0xf bank_mask:0xf
    v_med3_u32 v18, v9, v18, v6
    v_med3_u32 v24, v13, v24, v6
    v_med3_u32 v11, v20, v11, v6
    v_med3_u32 v23, v22, v23, v6
    v_max_u32 v16, v18, v11
    v_min_u32 v11, v18, v11
    v_max_u32 v14, v24, v23
    v_min_u32 v23, v24, v23
    v_max_u32 v17, v16, v14
    v_min_u32 v14, v16, v14
    v_max_u32 v12, v11, v23
    v_min_u32 v23, v11, v23
    s_nop 1
    v_max_u32_dpp v26, v23, v17 row_half_mirror row_mask:0xf bank_mask:0xf
    v_max_u32_dpp v27, v12, v14 row_half_mirror row_mask:0xf bank_mask:0xf
    v_max_u32_dpp v21, v14, v12 row_half_mirror row_mask:0xf bank_mask:0xf
    v_max_u32_dpp v10, v17, v23 row_half_mirror row_mask:0xf bank_mask:0xf
    v_mov_b32_dpp v19, v26 quad_perm:[1,0,3,2] row_mask:0xf bank_mask:0xf
    v_mov_b32_dpp v25, v27 quad_perm:[1,0,3,2] row_mask:0xf bank_mask:0xf
    v_mov_b32_dpp v15, v21 quad_perm:[1,0,3,2] row_mask:0xf bank_mask:0xf
    v_mov_b32_dpp v8, v10 quad_perm:[1,0,3,2] row_mask:0xf bank_mask:0xf
    v_med3_u32 v19, v26, v19, v6
    v_med3_u32 v25, v27, v25, v6
    v_med3_u32 v15, v21, v15, v6
    v_med3_u32 v8, v10, v8, v6
    v_max_u32 v9, v19, v15
    v_min_u32 v15, v19, v15
    v_max_u32 v13, v25, v8
    v_min_u32 v8, v25, v8
    v_max_u32 v20, v9, v13
    v_min_u32 v13, v9, v13
    v_max_u32 v22, v15, v8
    v_min_u32 v8, v15, v8
    s_nop 1
    v_max_u32_dpp v18, v8, v20 row_mirror row_mask:0xf bank_mask:0xf
    v_max_u32_dpp v24, v22, v13 row_mirror row_mask:0xf bank_mask:0xf
    v_max_u32_dpp v16, v13, v22 row_mirror row_mask:0xf bank_mask:0xf
    v_max_u32_dpp v11, v20, v8 row_mirror row_mask:0xf bank_mask:0xf
    v_mov_b32_dpp v17, v18 quad_perm:[1,0,3,2] row_mask:0xf bank_mask:0xf
    v_mov_b32_dpp v14, v24 quad_perm:[1,0,3,2] row_mask:0xf bank_mask:0xf
    v_mov_b32_dpp v12, v16 quad_perm:[1,0,3,2] row_mask:0xf bank_mask:0xf
    v_mov_b32_dpp v23, v11 quad_perm:[1,0,3,2] row_mask:0xf bank_mask:0xf
    v_med3_u32 v17, v18, v17, v6
    v_med3_u32 v14, v24, v14, v6
    v_med3_u32 v12, v16, v12, v6
    v_med3_u32 v23, v11, v23, v6
    v_max_u32 v26, v17, v12
    v_min_u32 v12, v17, v12
    v_max_u32 v27, v14, v23
    v_min_u32 v23, v14, v23
    v_max_u32 v21, v26, v27
    v_min_u32 v27, v26, v27
    v_max_u32 v10, v12, v23
    v_min_u32 v23, v12, v23
    v_mov_b32 v28, v21
    v_mov_b32 v29, v27
    v_mov_b32 v30, v10
    v_mov_b32 v31, v23
    s_mov_b32 exec_lo, 0x00030003
    s_mov_b32 exec_hi, 0x00030003
    ds_write_b128 v32, v[28:31] offset:256
    s_mov_b64 exec, -1
    s_setprio 0
    s_branch KS_B
KS_L2W:
    s_add_u32 s72, s36, 0x300000
    s_addc_u32 s73, s37, 0
    s_mov_b32 s74, 0x240000
    s_mov_b32 s75, 0x20000
    s_mov_b32 s92, 0xcccccccc
    s_mov_b32 s93, 0xcccccccc
    s_mov_b32 s94, 0xf0f0f0f0
    s_mov_b32 s95, 0xf0f0f0f0
    s_movk_i32 s96, 1152
    v_lshrrev_b32 v34, 3, v1
    v_lshlrev_b32 v34, 4, v34
    v_lshlrev_b32 v33, 4, v2
W_91:
    s_sleep 1
    ds_read_b32 v8, v4 offset:24
    s_sub_u32 s39, s39, 1
    s_cbranch_scc1 KS_ABORT
    s_waitcnt lgkmcnt(0)
    v_cmp_eq_u32 vcc, 0, v8
    s_cbranch_vccnz W_91
    s_setprio 2
KS_L2POLL:
    ds_read_b128 v[8:11], v33 offset:256
    ds_read_b128 v[12:15], v33 offset:512
    s_sub_u32 s39, s39, 1
    s_cbranch_scc1 KS_ABORT
    s_waitcnt lgkmcnt(0)
    v_min3_u32 v16, v8, v9, v10
    v_min3_u32 v17, v11, v12, v13
    v_min3_u32 v16, v16, v14, v15
    v_min_u32 v16, v16, v17
    v_cmp_eq_u32 vcc, 0, v16
    s_cbranch_vccnz KS_L2POLL
    v_max_u32_dpp v8, v15, v8 quad_perm:[1,0,3,2] row_mask:0xf bank_mask:0xf
    v_max_u32_dpp v9, v14, v9 quad_perm:[1,0,3,2] row_mask:0xf bank_mask:0xf
    v_max_u32_dpp v10, v13, v10 quad_perm:[1,0,3,2] row_mask:0xf bank_mask:0xf
    v_max_u32_dpp v11, v12, v11 quad_perm:[1,0,3,2] row_mask:0xf bank_mask:0xf
    v_mov_b32_dpp v16, v8 quad_perm:[1,0,3,2] row_mask:0xf bank_mask:0xf
    v_mov_b32_dpp v17, v9 quad_perm:[1,0,3,2] row_mask:0xf bank_mask:0xf
    v_mov_b32_dpp v18, v10 quad_perm:[1,0,3,2] row_mask:0xf bank_mask:0xf
    v_mov_b32_dpp v19, v11 quad_perm:[1,0,3,2] row_mask:0xf bank_mask:0xf
    v_med3_u32 v16, v8, v16, v6
    v_med3_u32 v17, v9, v17, v6
    v_med3_u32 v18, v10, v18, v6
    v_med3_u32 v19, v11, v19, v6
    v_max_u32 v20, v16, v18
    v_min_u32 v18, v16, v18
    v_max_u32 v21, v17, v19
    v_min_u32 v19, v17, v19
    v_max_u32 v22, v20, v21
    v_min_u32 v21, v20, v21
    v_max_u32 v23, v18, v19
    v_min_u32 v19, v18, v19
    s_nop 1
    v_max_u32_dpp v24, v19, v22 quad_perm:[3,2,1,0] row_mask:0xf bank_mask:0xf
    v_max_u32_dpp v25, v23, v21 quad_perm:[3,2,1,0] row_mask:0xf bank_mask:0xf
    v_max_u32_dpp v26, v21, v23 quad_perm:[3,2,1,0] row_mask:0xf bank_mask:0xf
    v_max_u32_dpp v27, v22, v19 quad_perm:[3,2,1,0] row_mask:0xf bank_mask:0xf
    v_mov_b32_dpp v12, v24 quad_perm:[1,0,3,2] row_mask:0xf bank_mask:0xf
    v_mov_b32_dpp v13, v25 quad_perm:[1,0,3,2] row_mask:0xf bank_mask:0xf
    v_mov_b32_dpp v14, v26 quad_perm:[1,0,3,2] row_mask:0xf bank_mask:0xf
    v_mov_b32_dpp v15, v27 quad_perm:[1,0,3,2] row_mask:0xf bank_mask:0xf
    v_med3_u32 v12, v24, v12, v6
    v_med3_u32 v13, v25, v13, v6
    v_med3_u32 v14, v26, v14, v6
    v_med3_u32 v15, v27, v15, v6
    v_max_u32 v8, v12, v14
    v_min_u32 v14, v12, v14
    v_max_u32 v9, v13, v15
    v_min_u32 v15, v13, v15
    v_max_u32 v10, v8, v9
    v_min_u32 v9, v8, v9
    v_max_u32 v11, v14, v15
    v_min_u32 v15, v14, v15
    s_nop 1
    v_max_u32_dpp v16, v15, v10 row_half_mirror row_mask:0xf bank_mask:0xf
    v_max_u32_dpp v17, v11, v9 row_half_mirror row_mask:0xf bank_mask:0xf
    v_max_u32_dpp v20, v9, v11 row_half_mirror row_mask:0xf bank_mask:0xf
    v_max_u32_dpp v18, v10, v15 row_half_mirror row_mask:0xf bank_mask:0xf
    v_mov_b32_dpp v22, v16 quad_perm:[1,0,3,2] row_mask:0xf bank_mask:0xf
    v_mov_b32_dpp v21, v17 quad_perm:[1,0,3,2] row_mask:0xf bank_mask:0xf
    v_mov_b32_dpp v23, v20 quad_perm:[1,0,3,2] row_mask:0xf bank_mask:0xf
    v_mov_b32_dpp v19, v18 quad_perm:[1,0,3,2] row_mask:0xf bank_mask:0xf
    v_med3_u32 v22, v16, v22, v6
    v_med3_u32 v21, v17, v21, v6
    v_med3_u32 v23, v20, v23, v6
    v_med3_u32 v19, v18, v19, v6
    v_max_u32 v24, v22, v23
    v_min_u32 v23, v22, v23
    v_max_u32 v25, v21, v19
    v_min_u32 v19, v21, v19
    v_max_u32 v26, v24, v25
    v_min_u32 v25, v24, v25
    v_max_u32 v27, v23, v19
    v_min_u32 v19, v23, v19
    s_nop 1
    v_max_u32_dpp v12, v19, v26 row_mirror row_mask:0xf bank_mask:0xf
    v_max_u32_dpp v13, v27, v25 row_mirror row_mask:0xf bank_mask:0xf
    v_max_u32_dpp v8, v25, v27 row_mirror row_mask:0xf bank_mask:0xf
    v_max_u32_dpp v14, v26, v19 row_mirror row_mask:0xf bank_mask:0xf
    ds_read_b32 v35, v4 offset:28
    v_cndmask_b32 v30, v12, v13, s[92:93]
    v_cndmask_b32 v31, v8, v14, s[92:93]
    v_cndmask_b32 v30, v30, v31, s[94:95]
    s_nop 1
    v_mov_b32_dpp v30, v30 row_shr:8 row_mask:0xf bank_mask:0xc
    v_and_b32 v31, 0x7ff, v30
    v_sub_u32 v31, 2047, v31
    v_mad_u32_u24 v31, v31, s96, v34
    s_waitcnt lgkmcnt(0)
    v_cmp_ne_u32 vcc, 0, v35
    s_cbranch_vccnz KS_RW1
W_92:
    ds_read_b32 v35, v4 offset:28
    s_sub_u32 s39, s39, 1
    s_cbranch_scc1 KS_ABORT
    s_waitcnt lgkmcnt(0)
    v_cmp_eq_u32 vcc, 0, v35
    s_cbranch_vccnz W_92
KS_RW1:
    s_mov_b32 m0, 17088
    s_nop 0
    buffer_load_dwordx4 v31, s[72:75], 0 offen offset:0 sc1 lds
    s_mov_b32 m0, 17984
    s_nop 0
    buffer_load_dwordx4 v31, s[72:75], 0 offen offset:128 sc1 lds
    s_mov_b32 m0, 18880
    s_nop 0
    buffer_load_dwordx4 v31, s[72:75], 0 offen offset:256 sc1 lds
    s_mov_b32 m0, 19776
    s_nop 0
    buffer_load_dwordx4 v31, s[72:75], 0 offen offset:384 sc1 lds
    s_mov_b32 m0, 20672
    s_nop 0
    buffer_load_dwordx4 v31, s[72:75], 0 offen offset:512 sc1 lds
    s_mov_b32 m0, 21568
    s_nop 0
    buffer_load_dwordx4 v31, s[72:75], 0 offen offset:640 sc1 lds
    s_mov_b32 m0, 22464
    s_nop 0
    buffer_load_dwordx4 v31, s[72:75], 0 offen offset:768 sc1 lds
    s_mov_b32 m0, 23360
    s_nop 0
    buffer_load_dwordx4 v31, s[72:75], 0 offen offset:896 sc1 lds
    s_mov_b32 m0, 24256
    s_nop 0
    buffer_load_dwordx4 v31, s[72:75], 0 offen offset:1024 sc1 lds
    ds_write_b32 v7, v30 offset:768
    s_waitcnt vmcnt(0)
    ds_write_b32 v4, v5 offset:32
    s_setprio 0
    s_branch KS_B
KS_W9:
    v_lshlrev_b32 v33, 4, v1
    s_movk_i32 s92, 0x2000
    s_add_u32 s72, s36, 0x300000
    s_addc_u32 s73, s37, 0
    s_mov_b32 s74, 0x240000
    s_mov_b32 s75, 0x20000
    s_add_u32 s64, s36, 0x600000
    s_addc_u32 s65, s37, 0
    s_mov_b32 s66, 0x240000
    s_mov_b32 s67, 0x20000
    s_mov_b32 s68, s4
    s_mov_b32 s69, s5
    s_mov_b32 s70, 0x240000
    s_mov_b32 s71, 0x20000
    v_bfe_u32 v43, v1, 2, 3
    s_lshl_b32 s93, s89, 3
    v_add_u32 v43, s93, v43
    v_bfe_u32 v40, v43, 4, 1
    v_and_b32 v41, 3, v1
    v_lshl_add_u32 v40, v40, 2, v41
    v_lshlrev_b32 v40, 2, v40
    v_lshrrev_b32 v41, 5, v43
    v_lshlrev_b32 v41, 4, v41
    v_and_b32 v42, 15, v43
    v_add_u32 v41, v41, v42
W_93:
    s_sleep 1
    ds_read_b32 v8, v4 offset:196
    s_sub_u32 s39, s39, 1
    s_cbranch_scc1 KS_ABORT
    s_waitcnt lgkmcnt(0)
    v_cmp_eq_u32 vcc, 0, v8
    s_cbranch_vccnz W_93
    s_sleep 8
    s_setprio 2
    s_branch ZPE_95
ZP_94:
    s_sleep 4
ZPE_95:
    buffer_load_dword v8, v33, s[76:79], s92 offen offset:0 sc1
    buffer_load_dword v9, v33, s[76:79], s92 offen offset:1024 sc1
    buffer_load_dword v10, v33, s[76:79], s92 offen offset:2048 sc1
    buffer_load_dword v11, v33, s[76:79], s92 offen offset:3072 sc1
    s_sub_u32 s39, s39, 1
    s_cbranch_scc1 KS_ABORT
    s_waitcnt vmcnt(0)
    v_max3_u32 v44, v8, v9, v10
    v_max_u32 v44, v44, v11
    v_cmp_eq_u32 vcc, -1, v44
    s_cbranch_vccnz ZP_94
    ds_write_b32 v4, v5 offset:28
    s_setprio 0
W_96:
    s_sleep 1
    ds_read_b32 v12, v7 offset:768
    s_sub_u32 s39, s39, 1
    s_cbranch_scc1 KS_ABORT
    s_waitcnt lgkmcnt(0)
    v_cmp_eq_u32 vcc, 0, v12
    s_cbranch_vccnz W_96
    ds_read_b32 v19, v40 offset:768
    s_waitcnt lgkmcnt(0)
    v_and_b32 v14, 0x7ff, v19
    v_sub_u32 v14, 2047, v14
    v_mul_u32_u24 v23, 1152, v14
    v_lshl_add_u32 v23, v41, 1, v23
    buffer_load_ushort v20, v23, s[72:75], 0 offen sc1
    buffer_load_ushort v17, v23, s[68:71], 0 offen
    v_lshrrev_b32 v15, 9, v14
    v_bfe_u32 v16, v14, 6, 2
    v_lshl_add_u32 v15, v15, 2, v16
    v_bfe_u32 v16, v14, 2, 2
    v_lshl_add_u32 v15, v15, 2, v16
    v_bfe_u32 v16, v14, 4, 1
    v_bfe_u32 v24, v14, 8, 1
    v_and_b32 v25, 3, v14
    v_lshl_add_u32 v24, v24, 2, v25
    v_lshlrev_b32 v24, 1, v24
    v_bfe_u32 v25, v14, 5, 1
    v_lshl_add_u32 v24, v25, 5, v24
    v_lshl_add_u32 v25, v15, 1, v16
    v_lshl_add_u32 v25, v25, 14, v24
    v_lshrrev_b32 v26, 1, v41
    v_lshl_add_u32 v25, v26, 6, v25
    v_xor_b32 v26, v41, v16
    v_not_b32 v26, v26
    v_and_b32 v26, 1, v26
    v_lshl_add_u32 v25, v26, 4, v25
    v_lshl_add_u32 v26, v15, 12, v24
    v_lshl_add_u32 v26, v16, 4, v26
    v_lshl_add_u32 v26, v41, 6, v26
    v_add_u32 v26, 2064384, v26
    v_lshl_add_u32 v27, v16, 6, v15
    v_lshlrev_b32 v27, 7, v27
    v_xor_b32 v25, v27, v25
    v_and_b32 v27, 0xf80, v27
    v_xor_b32 v26, v27, v26
    v_cmp_gt_u32 vcc, 0x200, v41
    s_nop 1
    v_cndmask_b32 v25, v26, v25, vcc
    buffer_load_ushort v18, v25, s[64:67], 0 offen sc1
    s_add_u32 s72, s36, 0xb10000
    s_addc_u32 s73, s37, 0
    s_mov_b32 s74, 0x40
    s_mov_b32 s75, 0x20000
    v_ashrrev_i32 v22, 31, v19
    v_not_b32 v22, v22
    v_or_b32 v22, 0x80000000, v22
    v_xor_b32 v22, v19, v22
    v_and_b32 v22, 0xffff0000, v22
    v_mul_f32 v22, 0xbfb8aa3b, v22
    v_exp_f32 v22, v22
    s_nop 0
    v_add_f32 v22, 1.0, v22
    v_rcp_f32 v22, v22
    s_nop 0
    v_cvt_pk_bf16_f32 v22, v22, v22
    v_lshlrev_b32 v22, 16, v22
    v_and_b32 v14, 31, v1
    v_lshlrev_b32 v14, 4, v14
    s_waitcnt vmcnt(0)
    v_lshlrev_b32 v17, 16, v17
    v_lshlrev_b32 v18, 16, v18
    v_add_f32 v17, v17, v18
    v_cvt_pk_bf16_f32 v17, v17, v17
    v_and_b32 v21, 0xffff0000, v17
    v_lshlrev_b32 v20, 16, v20
    ds_write_b128 v14, v[20:23] offset:1536
    s_cmp_lg_u32 s2, 0
    s_cbranch_scc1 KS_W9E
    buffer_store_dword v12, v7, s[72:75], 0 offen
KS_W9E:
    s_waitcnt lgkmcnt(0)
    s_endpgm
KS_B:
    s_add_u32 s64, s36, 0x850000
    s_addc_u32 s65, s37, 0
    s_mov_b32 s66, 0x28c800
    s_mov_b32 s67, 0x20000
    v_bfe_u32 v16, v1, 2, 2
    v_lshl_add_u32 v16, v3, 3, v16
    v_mul_u32_u24 v16, 1152, v16
    v_and_b32 v17, 3, v1
    v_lshl_add_u32 v16, v17, 3, v16
    s_lshl_b32 s92, s38, 7
    s_add_u32 s92, s92, 109184
    v_add_u32 v16, s92, v16
    v_lshlrev_b32 v18, 2, v17
    ds_read_b32 v24, v18 offset:224
    s_movk_i32 s94, 0xff
W_97:
    ds_read_b32 v17, v4 offset:40
    s_sub_u32 s39, s39, 1
    s_cbranch_scc1 KS_ABORT
    s_waitcnt lgkmcnt(0)
    v_cmp_ne_u32 vcc, s84, v17
    s_cbranch_vccnz W_97
    v_lshrrev_b32 v25, 8, v24
    v_lshrrev_b32 v26, 16, v24
    v_lshrrev_b32 v27, 24, v24
    ds_read_b64_tr_b16 v[48:49], v16 offset:0
    ds_read_b64_tr_b16 v[50:51], v16 offset:4608
    ds_read_b64_tr_b16 v[52:53], v16 offset:32
    ds_read_b64_tr_b16 v[54:55], v16 offset:4640
    ds_read_b64_tr_b16 v[56:57], v16 offset:64
    ds_read_b64_tr_b16 v[58:59], v16 offset:4672
    ds_read_b64_tr_b16 v[60:61], v16 offset:96
    ds_read_b64_tr_b16 v[62:63], v16 offset:4704
    v_and_b32 v16, 7, v2
    v_lshlrev_b32 v16, 6, v16
    v_lshl_add_u32 v16, v3, 4, v16
    s_mul_i32 s92, s89, 18560
    s_lshl_b32 s93, s38, 11
    s_add_u32 s92, s92, s93
    v_lshlrev_b32 v17, 4, v1
    s_waitcnt lgkmcnt(0)
    s_barrier
    s_barrier
    ds_read_b128 v[20:23], v16 offset:1024
    s_waitcnt lgkmcnt(0)
    v_mfma_f32_16x16x32_bf16 v[32:35], v[20:23], v[48:51], 0
    v_mfma_f32_16x16x32_bf16 v[36:39], v[20:23], v[52:55], 0
    v_mfma_f32_16x16x32_bf16 v[40:43], v[20:23], v[56:59], 0
    v_mfma_f32_16x16x32_bf16 v[44:47], v[20:23], v[60:63], 0
    s_nop 5
    v_permlane32_swap_b32 v32, v36
    v_permlane32_swap_b32 v33, v37
    v_permlane32_swap_b32 v34, v38
    v_permlane32_swap_b32 v35, v39
    v_bfi_b32 v32, s94, v24, v32
    v_bfi_b32 v33, s94, v25, v33
    v_bfi_b32 v34, s94, v26, v34
    v_bfi_b32 v35, s94, v27, v35
    buffer_store_dwordx4 v[32:35], v17, s[64:67], s92 offen offset:0 sc1
    v_permlane32_swap_b32 v40, v44
    v_permlane32_swap_b32 v41, v45
    v_permlane32_swap_b32 v42, v46
    v_permlane32_swap_b32 v43, v47
    v_bfi_b32 v40, s94, v24, v40
    v_bfi_b32 v41, s94, v25, v41
    v_bfi_b32 v42, s94, v26, v42
    v_bfi_b32 v43, s94, v27, v43
    buffer_store_dwordx4 v[40:43], v17, s[64:67], s92 offen offset:1024 sc1
    s_waitcnt vmcnt(0)
    s_barrier
    s_endpgm
KS_G0:
    ds_write_b8 v15, v5 offset:68
    s_setprio 0
KS_G:
    s_mov_b32 s98, 0x05040100
    s_mov_b32 s99, 0x07060302
    s_waitcnt vmcnt(0)
    s_sub_u32 s87, s38, 12
    s_mul_i32 s92, s87, 9
    s_add_u32 s92, s92, 1
    s_lshr_b32 s86, s92, 1
    s_lshl_b32 s92, s86, 5
    v_lshl_add_u32 v7, v3, 3, s92
    v_mul_u32_u24 v7, 9216, v7
    v_and_b32 v6, 7, v2
    v_lshl_add_u32 v7, v6, 3, v7
    s_lshl_b32 s92, s89, 6
    v_add_u32 v7, s92, v7
    v_cmp_gt_u32 vcc, 8, v2
    s_mov_b32 s76, 9216
    s_mov_b32 s77, 0
    s_mov_b32 s78, 230400
    s_mov_b32 s79, 0
    v_mov_b32 v46, s26
    v_mov_b32 v47, s27
    v_mov_b32 v6, s28
    v_cndmask_b32 v46, v6, v46, vcc
    v_mov_b32 v6, s29
    v_cndmask_b32 v47, v6, v47, vcc
    v_add_co_u32 v46, vcc, v46, v7
    s_nop 1
    v_addc_co_u32 v47, vcc, 0, v47, vcc
    s_lshr_b32 s92, 3, s87
    s_bitcmp1_b32 s92, 0
    s_cbranch_scc0 GT_98
W_99:
    s_sleep 2
    ds_read_b32 v10, v4 offset:16
    s_sub_u32 s39, s39, 1
    s_cbranch_scc1 KS_ABORT
    s_waitcnt lgkmcnt(0)
    v_cmp_ne_u32 vcc, s84, v10
    s_cbranch_vccnz W_99
GT_98:
    s_lshr_b32 s92, 12, s87
    s_bitcmp1_b32 s92, 0
    s_cbranch_scc0 GT_100
W_101:
    s_sleep 2
    ds_read_b32 v10, v4 offset:52
    s_sub_u32 s39, s39, 1
    s_cbranch_scc1 KS_ABORT
    s_waitcnt lgkmcnt(0)
    v_cmp_ne_u32 vcc, s84, v10
    s_cbranch_vccnz W_101
    s_setprio 1
GT_100:
    global_load_dwordx2 v[48:49], v[46:47], off
    v_lshl_add_u64 v[46:47], v[46:47], 0, s[76:77]
    global_load_dwordx2 v[50:51], v[46:47], off
    v_lshl_add_u64 v[46:47], v[46:47], 0, s[76:77]
    global_load_dwordx2 v[52:53], v[46:47], off
    v_lshl_add_u64 v[46:47], v[46:47], 0, s[76:77]
    global_load_dwordx2 v[54:55], v[46:47], off
    v_lshl_add_u64 v[46:47], v[46:47], 0, s[76:77]
    global_load_dwordx2 v[56:57], v[46:47], off
    v_lshl_add_u64 v[46:47], v[46:47], 0, s[76:77]
    global_load_dwordx2 v[58:59], v[46:47], off
    v_lshl_add_u64 v[46:47], v[46:47], 0, s[76:77]
    global_load_dwordx2 v[60:61], v[46:47], off
    v_lshl_add_u64 v[46:47], v[46:47], 0, s[76:77]
    global_load_dwordx2 v[62:63], v[46:47], off
    v_lshl_add_u64 v[46:47], v[46:47], 0, s[78:79]
    global_load_dwordx2 v[64:65], v[46:47], off
    v_lshl_add_u64 v[46:47], v[46:47], 0, s[76:77]
    global_load_dwordx2 v[66:67], v[46:47], off
    v_lshl_add_u64 v[46:47], v[46:47], 0, s[76:77]
    global_load_dwordx2 v[68:69], v[46:47], off
    v_lshl_add_u64 v[46:47], v[46:47], 0, s[76:77]
    global_load_dwordx2 v[70:71], v[46:47], off
    v_lshl_add_u64 v[46:47], v[46:47], 0, s[76:77]
    global_load_dwordx2 v[72:73], v[46:47], off
    v_lshl_add_u64 v[46:47], v[46:47], 0, s[76:77]
    global_load_dwordx2 v[74:75], v[46:47], off
    v_lshl_add_u64 v[46:47], v[46:47], 0, s[76:77]
    global_load_dwordx2 v[76:77], v[46:47], off
    v_lshl_add_u64 v[46:47], v[46:47], 0, s[76:77]
    global_load_dwordx2 v[78:79], v[46:47], off
    v_lshl_add_u64 v[46:47], v[46:47], 0, s[78:79]
    global_load_dwordx2 v[80:81], v[46:47], off
    v_lshl_add_u64 v[46:47], v[46:47], 0, s[76:77]
    global_load_dwordx2 v[82:83], v[46:47], off
    v_lshl_add_u64 v[46:47], v[46:47], 0, s[76:77]
    global_load_dwordx2 v[84:85], v[46:47], off
    v_lshl_add_u64 v[46:47], v[46:47], 0, s[76:77]
    global_load_dwordx2 v[86:87], v[46:47], off
    v_lshl_add_u64 v[46:47], v[46:47], 0, s[76:77]
    global_load_dwordx2 v[88:89], v[46:47], off
    v_lshl_add_u64 v[46:47], v[46:47], 0, s[76:77]
    global_load_dwordx2 v[90:91], v[46:47], off
    v_lshl_add_u64 v[46:47], v[46:47], 0, s[76:77]
    global_load_dwordx2 v[92:93], v[46:47], off
    v_lshl_add_u64 v[46:47], v[46:47], 0, s[76:77]
    global_load_dwordx2 v[94:95], v[46:47], off
    v_lshl_add_u64 v[46:47], v[46:47], 0, s[78:79]
    global_load_dwordx2 v[96:97], v[46:47], off
    v_lshl_add_u64 v[46:47], v[46:47], 0, s[76:77]
    global_load_dwordx2 v[98:99], v[46:47], off
    v_lshl_add_u64 v[46:47], v[46:47], 0, s[76:77]
    global_load_dwordx2 v[100:101], v[46:47], off
    v_lshl_add_u64 v[46:47], v[46:47], 0, s[76:77]
    global_load_dwordx2 v[102:103], v[46:47], off
    v_lshl_add_u64 v[46:47], v[46:47], 0, s[76:77]
    global_load_dwordx2 v[104:105], v[46:47], off
    v_lshl_add_u64 v[46:47], v[46:47], 0, s[76:77]
    global_load_dwordx2 v[106:107], v[46:47], off
    v_lshl_add_u64 v[46:47], v[46:47], 0, s[76:77]
    global_load_dwordx2 v[108:109], v[46:47], off
    v_lshl_add_u64 v[46:47], v[46:47], 0, s[76:77]
    global_load_dwordx2 v[110:111], v[46:47], off
    v_lshl_add_u64 v[46:47], v[46:47], 0, s[78:79]
    s_bitcmp1_b32 s87, 0
    s_cbranch_scc1 KS_G4
    global_load_dwordx2 v[112:113], v[46:47], off
    v_lshl_add_u64 v[46:47], v[46:47], 0, s[76:77]
    global_load_dwordx2 v[114:115], v[46:47], off
    v_lshl_add_u64 v[46:47], v[46:47], 0, s[76:77]
    global_load_dwordx2 v[116:117], v[46:47], off
    v_lshl_add_u64 v[46:47], v[46:47], 0, s[76:77]
    global_load_dwordx2 v[118:119], v[46:47], off
    v_lshl_add_u64 v[46:47], v[46:47], 0, s[76:77]
    global_load_dwordx2 v[120:121], v[46:47], off
    v_lshl_add_u64 v[46:47], v[46:47], 0, s[76:77]
    global_load_dwordx2 v[122:123], v[46:47], off
    v_lshl_add_u64 v[46:47], v[46:47], 0, s[76:77]
    global_load_dwordx2 v[124:125], v[46:47], off
    v_lshl_add_u64 v[46:47], v[46:47], 0, s[76:77]
    global_load_dwordx2 v[126:127], v[46:47], off
KS_G4:
    v_mov_b32 v6, s87
    ds_write_b8 v6, v5 offset:192
    s_waitcnt vmcnt(0)
    v_perm_b32 v32, v50, v48, s98
    v_perm_b32 v33, v54, v52, s98
    v_perm_b32 v34, v58, v56, s98
    v_perm_b32 v35, v62, v60, s98
    v_perm_b32 v36, v50, v48, s99
    v_perm_b32 v37, v54, v52, s99
    v_perm_b32 v38, v58, v56, s99
    v_perm_b32 v39, v62, v60, s99
    v_perm_b32 v40, v51, v49, s98
    v_perm_b32 v41, v55, v53, s98
    v_perm_b32 v42, v59, v57, s98
    v_perm_b32 v43, v63, v61, s98
    v_perm_b32 v44, v51, v49, s99
    v_perm_b32 v45, v55, v53, s99
    v_perm_b32 v46, v59, v57, s99
    v_perm_b32 v47, v63, v61, s99
    v_perm_b32 v48, v66, v64, s98
    v_perm_b32 v49, v70, v68, s98
    v_perm_b32 v50, v74, v72, s98
    v_perm_b32 v51, v78, v76, s98
    v_perm_b32 v52, v66, v64, s99
    v_perm_b32 v53, v70, v68, s99
    v_perm_b32 v54, v74, v72, s99
    v_perm_b32 v55, v78, v76, s99
    v_perm_b32 v56, v67, v65, s98
    v_perm_b32 v57, v71, v69, s98
    v_perm_b32 v58, v75, v73, s98
    v_perm_b32 v59, v79, v77, s98
    v_perm_b32 v60, v67, v65, s99
    v_perm_b32 v61, v71, v69, s99
    v_perm_b32 v62, v75, v73, s99
    v_perm_b32 v63, v79, v77, s99
    v_perm_b32 v64, v82, v80, s98
    v_perm_b32 v65, v86, v84, s98
    v_perm_b32 v66, v90, v88, s98
    v_perm_b32 v67, v94, v92, s98
    v_perm_b32 v68, v82, v80, s99
    v_perm_b32 v69, v86, v84, s99
    v_perm_b32 v70, v90, v88, s99
    v_perm_b32 v71, v94, v92, s99
    v_perm_b32 v72, v83, v81, s98
    v_perm_b32 v73, v87, v85, s98
    v_perm_b32 v74, v91, v89, s98
    v_perm_b32 v75, v95, v93, s98
    v_perm_b32 v76, v83, v81, s99
    v_perm_b32 v77, v87, v85, s99
    v_perm_b32 v78, v91, v89, s99
    v_perm_b32 v79, v95, v93, s99
    v_perm_b32 v80, v98, v96, s98
    v_perm_b32 v81, v102, v100, s98
    v_perm_b32 v82, v106, v104, s98
    v_perm_b32 v83, v110, v108, s98
    v_perm_b32 v84, v98, v96, s99
    v_perm_b32 v85, v102, v100, s99
    v_perm_b32 v86, v106, v104, s99
    v_perm_b32 v87, v110, v108, s99
    v_perm_b32 v88, v99, v97, s98
    v_perm_b32 v89, v103, v101, s98
    v_perm_b32 v90, v107, v105, s98
    v_perm_b32 v91, v111, v109, s98
    v_perm_b32 v92, v99, v97, s99
    v_perm_b32 v93, v103, v101, s99
    v_perm_b32 v94, v107, v105, s99
    v_perm_b32 v95, v111, v109, s99
    v_perm_b32 v96, v114, v112, s98
    v_perm_b32 v97, v118, v116, s98
    v_perm_b32 v98, v122, v120, s98
    v_perm_b32 v99, v126, v124, s98
    v_perm_b32 v100, v114, v112, s99
    v_perm_b32 v101, v118, v116, s99
    v_perm_b32 v102, v122, v120, s99
    v_perm_b32 v103, v126, v124, s99
    v_perm_b32 v104, v115, v113, s98
    v_perm_b32 v105, v119, v117, s98
    v_perm_b32 v106, v123, v121, s98
    v_perm_b32 v107, v127, v125, s98
    v_perm_b32 v108, v115, v113, s99
    v_perm_b32 v109, v119, v117, s99
    v_perm_b32 v110, v123, v121, s99
    v_perm_b32 v111, v127, v125, s99
    s_lshl_b32 s92, s86, 9
    s_add_u32 s92, s92, 17088
    v_and_b32 v6, 7, v2
    v_lshl_add_u32 v7, v6, 4, s92
    v_lshl_add_u32 v7, v3, 7, v7
    s_lshl_b32 s92, s87, 6
    v_add_u32 v11, s92, v1
    v_lshrrev_b32 v8, 5, v11
    v_and_b32 v9, 31, v11
    v_and_b32 v10, 3, v9
    v_lshlrev_b32 v10, 9, v10
    v_lshrrev_b32 v9, 2, v9
    v_lshl_add_u32 v10, v9, 4, v10
    v_lshrrev_b32 v9, 2, v8
    v_lshl_add_u32 v10, v9, 8, v10
    v_and_b32 v9, 3, v8
    v_lshl_add_u32 v10, v9, 2, v10
    v_lshlrev_b32 v11, 1, v11
    s_lshl_b32 s92, s87, 11
    v_lshl_add_u32 v9, v1, 4, s92
W_102:
    s_sleep 2
    ds_read_b32 v12, v4 offset:768
    s_sub_u32 s39, s39, 1
    s_cbranch_scc1 KS_ABORT
    s_waitcnt lgkmcnt(0)
    v_cmp_eq_u32 vcc, 0, v12
    s_cbranch_vccnz W_102
    s_setprio 2
W_103:
    ds_read_b32 v12, v4 offset:32
    s_sub_u32 s39, s39, 1
    s_cbranch_scc1 KS_ABORT
    s_waitcnt lgkmcnt(0)
    v_cmp_eq_u32 vcc, 0, v12
    s_cbranch_vccnz W_103
    ds_read_b128 v[12:15], v7 offset:0
    ds_read_b128 v[16:19], v7 offset:512
    ds_read_b128 v[20:23], v7 offset:1024
    ds_read_b128 v[24:27], v7 offset:1536
    ds_read_b128 v[28:31], v7 offset:2048
    s_waitcnt lgkmcnt(4)
    v_mfma_f32_16x16x32_bf16 v[112:115], v[12:15], v[32:35], 0
    v_mfma_f32_16x16x32_bf16 v[116:119], v[12:15], v[36:39], 0
    v_mfma_f32_16x16x32_bf16 v[120:123], v[12:15], v[40:43], 0
    v_mfma_f32_16x16x32_bf16 v[124:127], v[12:15], v[44:47], 0
    s_waitcnt lgkmcnt(3)
    v_mfma_f32_16x16x32_bf16 v[112:115], v[16:19], v[48:51], v[112:115]
    v_mfma_f32_16x16x32_bf16 v[116:119], v[16:19], v[52:55], v[116:119]
    v_mfma_f32_16x16x32_bf16 v[120:123], v[16:19], v[56:59], v[120:123]
    v_mfma_f32_16x16x32_bf16 v[124:127], v[16:19], v[60:63], v[124:127]
    s_waitcnt lgkmcnt(2)
    v_mfma_f32_16x16x32_bf16 v[112:115], v[20:23], v[64:67], v[112:115]
    v_mfma_f32_16x16x32_bf16 v[116:119], v[20:23], v[68:71], v[116:119]
    v_mfma_f32_16x16x32_bf16 v[120:123], v[20:23], v[72:75], v[120:123]
    v_mfma_f32_16x16x32_bf16 v[124:127], v[20:23], v[76:79], v[124:127]
    s_waitcnt lgkmcnt(1)
    v_mfma_f32_16x16x32_bf16 v[112:115], v[24:27], v[80:83], v[112:115]
    v_mfma_f32_16x16x32_bf16 v[116:119], v[24:27], v[84:87], v[116:119]
    v_mfma_f32_16x16x32_bf16 v[120:123], v[24:27], v[88:91], v[120:123]
    v_mfma_f32_16x16x32_bf16 v[124:127], v[24:27], v[92:95], v[124:127]
    s_bitcmp1_b32 s87, 0
    s_cbranch_scc1 KS_G5
    s_waitcnt lgkmcnt(0)
    v_mfma_f32_16x16x32_bf16 v[112:115], v[28:31], v[96:99], v[112:115]
    v_mfma_f32_16x16x32_bf16 v[116:119], v[28:31], v[100:103], v[116:119]
    v_mfma_f32_16x16x32_bf16 v[120:123], v[28:31], v[104:107], v[120:123]
    v_mfma_f32_16x16x32_bf16 v[124:127], v[28:31], v[108:111], v[124:127]
KS_G5:
    s_mov_b32 exec_lo, -1
    s_mov_b32 exec_hi, 0
    s_nop 5
    ds_write_b128 v9, v[112:115] offset:26368
    ds_write_b128 v9, v[116:119] offset:26880
    ds_write_b128 v9, v[120:123] offset:27392
    ds_write_b128 v9, v[124:127] offset:27904
    s_mov_b64 exec, -1
    s_waitcnt lgkmcnt(0)
    s_barrier
    ds_read_b32 v32, v10 offset:26368
    ds_read_b32 v33, v10 offset:26496
    ds_read_b32 v34, v10 offset:28416
    ds_read_b32 v35, v10 offset:28544
    ds_read_b32 v36, v10 offset:30464
    ds_read_b32 v37, v10 offset:30592
    ds_read_b32 v38, v10 offset:32512
    ds_read_b32 v39, v10 offset:32640
    s_waitcnt lgkmcnt(4)
    v_pk_add_f32 v[32:33], v[32:33], v[34:35]
    s_waitcnt lgkmcnt(0)
    v_pk_add_f32 v[36:37], v[36:37], v[38:39]
    v_pk_add_f32 v[32:33], v[32:33], v[36:37]
    v_cvt_pk_bf16_f32 v34, v32, v33
    v_lshlrev_b32 v32, 16, v34
    v_and_b32 v33, 0xffff0000, v34
    v_mul_f32 v34, 0xbfb8aa3b, v32
    v_exp_f32 v34, v34
    s_nop 0
    v_add_f32 v34, 1.0, v34
    v_rcp_f32 v34, v34
    s_nop 0
    v_mul_f32 v34, v32, v34
    v_cvt_pk_bf16_f32 v34, v34, v34
    v_lshlrev_b32 v34, 16, v34
    v_mul_f32 v34, v34, v33
    v_cvt_pk_bf16_f32 v34, v34, v34
    ds_write_b16 v11, v34 offset:1024
    s_waitcnt lgkmcnt(0)
    s_barrier
    s_branch KS_P2
KS_P:
    s_mov_b32 s68, s30
    s_mov_b32 s69, s31
    s_mov_b32 s70, 0x510000
    s_mov_b32 s71, 0x20000
    s_sub_u32 s94, s38, 10
    v_lshlrev_b32 v6, 4, v1
    s_mul_i32 s92, s89, 36864
    s_mul_i32 s93, s94, 18432
    s_add_u32 s92, s92, s93
    s_add_u32 s93, s93, 109184
    s_lshl_b32 s94, s94, 1
    v_mov_b32 v7, s94
    v_mov_b32 v8, s84
W_104:
    s_sleep 2
    ds_read_b32 v10, v4 offset:20
    s_sub_u32 s39, s39, 1
    s_cbranch_scc1 KS_ABORT
    s_waitcnt lgkmcnt(0)
    v_cmp_ne_u32 vcc, s84, v10
    s_cbranch_vccnz W_104
    s_setprio 1
    s_add_u32 m0, s93, 0
    s_nop 0
    buffer_load_dwordx4 v6, s[68:71], s92 offen offset:0  lds
    buffer_load_dwordx4 v6, s[68:71], s92 offen offset:1024  lds
    buffer_load_dwordx4 v6, s[68:71], s92 offen offset:2048  lds
    buffer_load_dwordx4 v6, s[68:71], s92 offen offset:3072  lds
    s_add_u32 m0, s93, 4096
    s_add_u32 s92, s92, 4096
    buffer_load_dwordx4 v6, s[68:71], s92 offen offset:0  lds
    buffer_load_dwordx4 v6, s[68:71], s92 offen offset:1024  lds
    buffer_load_dwordx4 v6, s[68:71], s92 offen offset:2048  lds
    buffer_load_dwordx4 v6, s[68:71], s92 offen offset:3072  lds
    s_add_u32 m0, s93, 8192
    s_add_u32 s92, s92, 4096
    buffer_load_dwordx4 v6, s[68:71], s92 offen offset:0  lds
    buffer_load_dwordx4 v6, s[68:71], s92 offen offset:1024  lds
    buffer_load_dwordx4 v6, s[68:71], s92 offen offset:2048  lds
    buffer_load_dwordx4 v6, s[68:71], s92 offen offset:3072  lds
    s_add_u32 m0, s93, 12288
    s_add_u32 s92, s92, 4096
    buffer_load_dwordx4 v6, s[68:71], s92 offen offset:0  lds
    buffer_load_dwordx4 v6, s[68:71], s92 offen offset:1024  lds
    buffer_load_dwordx4 v6, s[68:71], s92 offen offset:2048  lds
    buffer_load_dwordx4 v6, s[68:71], s92 offen offset:3072  lds
    s_add_u32 m0, s93, 16384
    s_add_u32 s92, s92, 4096
    buffer_load_dwordx4 v6, s[68:71], s92 offen offset:0  lds
    buffer_load_dwordx4 v6, s[68:71], s92 offen offset:1024  lds
    s_waitcnt vmcnt(0)
    ds_write_b16 v7, v8 offset:40
    s_setprio 0
    s_waitcnt lgkmcnt(0)
    s_barrier
    s_barrier
    s_setprio 2
KS_P2:
    s_sub_u32 s87, s38, 10
    s_add_u32 s64, s36, 0x850000
    s_addc_u32 s65, s37, 0
    s_mov_b32 s66, 0x28c800
    s_mov_b32 s67, 0x20000
    s_mov_b32 s68, s32
    s_mov_b32 s69, s33
    s_mov_b32 s70, 0x240000
    s_mov_b32 s71, 0x20000
    v_lshrrev_b32 v8, 3, v1
    v_mul_u32_u24 v8, 18560, v8
    v_and_b32 v9, 7, v1
    v_lshl_add_u32 v8, v9, 4, v8
    s_mul_i32 s92, s87, 445440
    s_lshl_b32 s93, s89, 7
    s_add_u32 s92, s92, s93
    s_add_u32 s93, s92, 148480
    s_add_u32 s94, s92, 296960
    s_lshl_b32 s95, s87, 7
    v_lshl_add_u32 v6, v9, 4, s95
    v_lshl_add_u32 v6, v3, 2, v6
    v_lshlrev_b32 v12, 2, v1
    v_add_u32 v12, 2048, v12
    v_lshlrev_b32 v13, 4, v1
    v_and_b32 v14, 12, v12
    ds_read_b32 v24, v14 offset:224
    s_waitcnt lgkmcnt(0)
    v_lshrrev_b32 v25, 8, v24
    v_lshrrev_b32 v26, 16, v24
    v_lshrrev_b32 v27, 24, v24
    s_barrier
    s_branch PPE_106
PP_105:
    s_sleep 1
PPE_106:
    buffer_load_dwordx4 v[32:35], v8, s[64:67], s92 offen sc1
    buffer_load_dwordx4 v[36:39], v8, s[64:67], s93 offen sc1
    buffer_load_dwordx4 v[40:43], v8, s[64:67], s94 offen sc1
    s_sub_u32 s39, s39, 1
    s_cbranch_scc1 KS_ABORT
    s_waitcnt vmcnt(2)
    v_xor_b32 v44, v24, v32
    v_xor_b32 v45, v25, v33
    v_bitop3_b32 v44, v44, v26, v34 bitop3:0xf6
    v_bitop3_b32 v45, v45, v27, v35 bitop3:0xf6
    s_waitcnt vmcnt(1)
    v_bitop3_b32 v44, v44, v24, v36 bitop3:0xf6
    v_bitop3_b32 v45, v45, v25, v37 bitop3:0xf6
    v_bitop3_b32 v44, v44, v26, v38 bitop3:0xf6
    v_bitop3_b32 v45, v45, v27, v39 bitop3:0xf6
    s_waitcnt vmcnt(0)
    v_bitop3_b32 v44, v44, v24, v40 bitop3:0xf6
    v_bitop3_b32 v45, v45, v25, v41 bitop3:0xf6
    v_bitop3_b32 v44, v44, v26, v42 bitop3:0xf6
    v_bitop3_b32 v45, v45, v27, v43 bitop3:0xf6
    v_or_b32 v44, v44, v45
    v_and_b32 v44, 0xff, v44
    v_cmp_ne_u32 vcc, 0, v44
    s_cbranch_vccnz PP_105
    v_pk_add_f32 v[32:33], v[32:33], v[36:37]
    v_pk_add_f32 v[34:35], v[34:35], v[38:39]
    v_pk_add_f32 v[32:33], v[32:33], v[40:41]
    v_pk_add_f32 v[34:35], v[34:35], v[42:43]
    s_nop 0
    v_add_f32_dpp v32, v32, v32 row_ror:8 row_mask:0xf bank_mask:0xf
    v_add_f32_dpp v33, v33, v33 row_ror:8 row_mask:0xf bank_mask:0xf
    v_add_f32_dpp v34, v34, v34 row_ror:8 row_mask:0xf bank_mask:0xf
    v_add_f32_dpp v35, v35, v35 row_ror:8 row_mask:0xf bank_mask:0xf
    v_permlane16_swap_b32 v32, v33
    s_nop 0
    v_permlane16_swap_b32 v34, v35
    v_add_f32 v32, v32, v33
    v_add_f32 v34, v34, v35
    s_nop 1
    v_permlane32_swap_b32 v32, v34
    v_add_f32 v32, v32, v34
    ds_write_b32 v6, v32 offset:2048
    s_waitcnt lgkmcnt(0)
    s_barrier
    s_cmp_lg_u32 s87, 0
    s_cbranch_scc1 KS_PEND
    s_mov_b32 exec_lo, -1
    s_mov_b32 exec_hi, 0
    ds_read2_b32 v[32:33], v12 offset0:0 offset1:32
    ds_read2_b32 v[34:35], v12 offset0:64 offset1:96
    ds_read2_b32 v[36:37], v12 offset0:128 offset1:160
    ds_read_b128 v[40:43], v13 offset:1536
    s_waitcnt lgkmcnt(0)
    v_pk_add_f32 v[32:33], v[32:33], v[34:35]
    v_pk_add_f32 v[32:33], v[32:33], v[36:37]
    v_add_f32 v8, v32, v33
    v_cvt_pk_bf16_f32 v8, v8, v8
    v_lshlrev_b32 v8, 16, v8
    v_mul_f32 v8, v8, v42
    v_cvt_pk_bf16_f32 v8, v8, v8
    v_lshlrev_b32 v8, 16, v8
    v_add_f32 v8, v8, v40
    v_cvt_pk_bf16_f32 v8, v8, v8
    v_lshlrev_b32 v8, 16, v8
    v_add_f32 v8, v8, v41
    v_cvt_pk_bf16_f32 v8, v8, v8
    buffer_store_short v8, v43, s[68:71], 0 offen
KS_PEND:
KS_ABORT:
KS_END:
    s_endpgm
.section .rodata,"a"
.p2align 6
.amdhsa_kernel sequential_preLN__ssm_conv_s4__moe_arch_mod__prompt_kernel
  .amdhsa_next_free_vgpr 128
  .amdhsa_next_free_sgpr 100
  .amdhsa_accum_offset 128
  .amdhsa_group_segment_fixed_size 0
  .amdhsa_kernarg_size 136
  .amdhsa_user_sgpr_count 2
  .amdhsa_user_sgpr_kernarg_segment_ptr 1
  .amdhsa_system_sgpr_workgroup_id_x 1
  .amdhsa_float_denorm_mode_32 3
.end_amdhsa_kernel
```

```asm
; @launch grid=(256,1,1) block=(1024,1,1) lds=154240
.amdgcn_target "amdgcn-amd-amdhsa--gfx950"
.text
.globl sequential_preLN__ssm_conv_s4__moe_arch_mod__prompt_kernel
.p2align 8
.type sequential_preLN__ssm_conv_s4__moe_arch_mod__prompt_kernel,@function
sequential_preLN__ssm_conv_s4__moe_arch_mod__prompt_kernel:
    s_cmp_ge_u32 s2, 256
    s_cbranch_scc1 KS_END
    s_load_dwordx16 s[4:19], s[0:1], 0
    s_load_dwordx16 s[20:35], s[0:1], 64
    s_load_dwordx2 s[36:37], s[0:1], 128
    v_readfirstlane_b32 s38, v0
    s_lshr_b32 s38, s38, 6
    s_and_b32 s40, s2, 7
    s_lshr_b32 s41, s2, 3
    s_cmp_lg_u32 s38, 0
    s_cbranch_scc1 KS_CPE
    s_getpc_b64 s[42:43]
KS_PC:
    s_and_b32 s92, s41, 3
    s_lshl_b32 s92, s92, 13
    v_lshl_add_u32 v126, v0, 7, s92
    v_min_u32 v126, KS_END-KS_PC, v126
    global_load_dword v127, v126, s[42:43]
KS_CPE:
    s_add_u32 s92, s38, 8
    s_sub_u32 s93, s38, 4
    s_cmp_lt_u32 s38, 8
    s_cselect_b32 s92, s92, s93
    s_cmp_lt_u32 s38, 4
    s_cselect_b32 s38, s38, s92
    v_and_b32 v1, 63, v0
    v_and_b32 v2, 15, v1
    v_lshrrev_b32 v3, 4, v1
    v_mov_b32 v4, 0
    v_mov_b32 v5, 1
    s_mov_b32 s39, 524288
    s_mov_b32 s84, 0x01010101
    s_lshl_b32 s90, s40, 5
    s_add_u32 s90, s90, s41
    s_mul_i32 s89, s40, 18
    s_add_u32 s89, s89, s41
    s_cmp_lt_u32 s38, 4
    s_cbranch_scc1 KS_L
    s_cmp_ge_u32 s38, 12
    s_cbranch_scc1 KS_X
    s_setprio 2
    s_lshr_b32 s87, s38, 2
    s_sub_u32 s87, s87, 1
    s_mul_i32 s86, s87, 3
    s_xor_b32 s86, s86, s38
    s_and_b32 s86, s86, 3
    s_lshl_b32 s88, s90, 1
    s_add_u32 s88, s88, s87
    s_lshl_b32 s92, s86, 11
    s_add_u32 s92, s92, 146048
    v_lshl_add_u32 v28, v1, 3, s92
    s_cmp_eq_u32 s86, 3
    s_cbranch_scc1 PX_1
    v_lshlrev_b32 v26, 3, v2
    v_mov_b32 v21, 0x80
    s_cmp_eq_u32 s86, 1
    s_cbranch_scc1 PX_2
    s_cmp_eq_u32 s86, 2
    s_cbranch_scc1 PX_3
    v_lshl_add_u32 v26, v3, 1, v26
    v_mov_b32 v22, 1
    s_branch PX_4
PX_2:
    v_cmp_gt_u32 vcc, 2, v3
    v_lshl_add_u32 v20, v3, 2, v26
    v_add_u32 v20, 256, v20
    v_lshl_add_u32 v26, v3, 8, v26
    v_cndmask_b32 v26, v26, v20, vcc
    v_cndmask_b32 v22, v21, 2, vcc
    v_cndmask_b32 v21, 4, v21, vcc
    s_branch PX_4
PX_3:
    v_lshl_add_u32 v26, v3, 9, v26
    v_add_u32 v26, 0x400, v26
    v_mov_b32 v22, 0x100
PX_4:
    v_mad_u32_u24 v26, v22, s87, v26
    v_add_u32 v27, v26, v21
    s_movk_i32 s96, 31232
    s_movk_i32 s97, -19072
    s_lshl_b32 s95, s87, 9
    v_cvt_f32_u32 v20, v26
    v_max_u32 v22, 0x800, v26
    v_cvt_f32_u32 v21, v27
    v_max_u32 v23, 0x800, v27
    v_cmp_gt_u32 vcc, 0x80, v26
    v_lshrrev_b32 v24, 16, v20
    v_add3_u32 v24, v24, v22, s97
    v_cndmask_b32 v24, v24, v26, vcc
    v_cmp_gt_u32 vcc, 0x80, v27
    v_lshrrev_b32 v25, 16, v21
    v_add3_u32 v25, v25, v23, s97
    v_cndmask_b32 v25, v25, v27, vcc
    v_min_u32 v24, 642, v24
    v_lshl_add_u32 v24, v24, 1, s96
    v_min_u32 v25, 642, v25
    v_lshl_add_u32 v25, v25, 1, s96
    v_add_u32 v29, s95, v28
    v_lshl_or_b32 v24, v25, 16, v24
    v_lshl_or_b32 v25, v27, 16, v26
    ds_write_b64 v29, v[24:25]
PX_1:
KS_GRP:
    s_lshl_b32 s92, s88, 8
    v_lshl_add_u32 v20, v1, 2, s92
    s_lshl_b32 s92, s88, 1
    v_mov_b32 v21, s92
    s_mul_i32 s85, s87, 36672
    s_add_u32 s85, s85, 35840
    s_waitcnt lgkmcnt(0)
    global_load_ushort v46, v21, s[18:19]
    global_load_dword v40, v20, s[6:7]
    global_load_dword v41, v20, s[8:9]
    global_load_dword v42, v20, s[10:11]
    global_load_dword v43, v20, s[12:13]
    global_load_dword v44, v20, s[14:15]
    global_load_dword v45, v20, s[16:17]
    global_load_ushort v107, v21, s[20:21]
    s_barrier
    s_movk_i32 s96, 31232
    s_cmp_eq_u32 s87, 2
    s_cbranch_scc1 PREE_7
    v_mov_b32 v32, 641
    s_cmp_eq_u32 s87, 1
    s_cbranch_scc1 PREB_5
    v_mov_b32 v33, 32514
    s_cmp_eq_u32 s86, 1
    s_cbranch_scc1 PRE_9
    s_cmp_eq_u32 s86, 2
    s_cbranch_scc1 PRE_10
    s_cmp_eq_u32 s86, 3
    s_cbranch_scc1 PRE_11
    v_lshlrev_b32 v23, 1, v1
    v_sub_u32 v30, 93, v23
    v_cmp_lt_u32 vcc, 61, v30
    v_lshlrev_b32 v31, 2, v30
    v_add_u32 v31, 32010, v31
    v_cndmask_b32 v24, v31, v33, vcc
    v_sub_u32 v30, 92, v23
    v_cmp_lt_u32 vcc, 61, v30
    v_lshlrev_b32 v31, 2, v30
    v_add_u32 v31, 32010, v31
    v_cndmask_b32 v25, v31, v33, vcc
    v_sub_u32 v30, 94, v23
    v_cmp_lt_u32 vcc, 62, v30
    v_lshlrev_b32 v31, 2, v30
    v_add_u32 v31, 32008, v31
    v_cndmask_b32 v26, v31, v33, vcc
    v_sub_u32 v30, 93, v23
    v_cmp_lt_u32 vcc, 62, v30
    v_lshlrev_b32 v31, 2, v30
    v_add_u32 v31, 32008, v31
    v_cndmask_b32 v27, v31, v33, vcc
    s_branch PREW_6
PRE_9:
    v_min_u32 v23, 47, v1
    v_lshlrev_b32 v23, 1, v23
    v_sub_u32 v30, 64, v23
    v_cmp_lt_u32 vcc, 63, v30
    v_lshlrev_b32 v31, 2, v30
    v_add_u32 v31, 32258, v31
    v_cndmask_b32 v24, v31, v33, vcc
    v_sub_u32 v30, 63, v23
    v_cmp_lt_u32 vcc, 63, v30
    v_lshlrev_b32 v31, 2, v30
    v_add_u32 v31, 32258, v31
    v_cndmask_b32 v25, v31, v33, vcc
    v_sub_u32 v30, 62, v23
    v_cmp_lt_u32 vcc, 63, v30
    v_lshlrev_b32 v31, 2, v30
    v_add_u32 v31, 32258, v31
    v_cndmask_b32 v27, v31, v33, vcc
    v_mov_b32 v26, v25
    s_branch PREW_6
PRE_10:
    v_min_u32 v23, 47, v1
    v_lshlrev_b32 v23, 1, v23
    v_sub_u32 v30, 64, v23
    v_cmp_lt_u32 vcc, 63, v30
    v_lshlrev_b32 v31, 2, v30
    v_add_u32 v31, 32260, v31
    v_cndmask_b32 v24, v31, v33, vcc
    v_sub_u32 v30, 63, v23
    v_cmp_lt_u32 vcc, 63, v30
    v_lshlrev_b32 v31, 2, v30
    v_add_u32 v31, 32260, v31
    v_cndmask_b32 v25, v31, v33, vcc
    v_sub_u32 v30, 62, v23
    v_cmp_lt_u32 vcc, 63, v30
    v_lshlrev_b32 v31, 2, v30
    v_add_u32 v31, 32260, v31
    v_cndmask_b32 v27, v31, v33, vcc
    v_mov_b32 v26, v25
    s_branch PREW_6
PRE_11:
    v_cmp_gt_u32 vcc, 9, v1
    v_add_u32 v23, 0x100, v1
    v_mov_b32 v33, 0x200
    v_cndmask_b32 v23, v23, v1, vcc
    v_lshlrev_b32 v23, 1, v23
    v_sub_u32 v30, 544, v23
    v_cvt_f32_i32 v31, v30
    v_cmp_gt_u32 vcc, 0x100, v30
    v_cvt_pk_bf16_f32 v31, v31, v31
    v_and_b32 v31, 0xffff, v31
    v_subrev_u32 v31, 0x4280, v31
    v_cndmask_b32 v31, v31, v30, vcc
    v_cmp_lt_u32 vcc, 0x20d, v30
    v_or_b32 v30, 1, v23
    s_nop 0
    v_cndmask_b32 v31, v31, v32, vcc
    v_cmp_eq_u32 vcc, 0x25d, v30
    s_nop 1
    v_cndmask_b32 v31, v31, v33, vcc
    v_lshl_add_u32 v24, v31, 1, s96
    v_add_u32 v23, 1, v23
    v_sub_u32 v30, 544, v23
    v_cvt_f32_i32 v31, v30
    v_cmp_gt_u32 vcc, 0x100, v30
    v_cvt_pk_bf16_f32 v31, v31, v31
    v_and_b32 v31, 0xffff, v31
    v_subrev_u32 v31, 0x4280, v31
    v_cndmask_b32 v31, v31, v30, vcc
    v_cmp_lt_u32 vcc, 0x20d, v30
    v_or_b32 v30, 1, v23
    s_nop 0
    v_cndmask_b32 v31, v31, v32, vcc
    v_cmp_eq_u32 vcc, 0x25d, v30
    s_nop 1
    v_cndmask_b32 v31, v31, v33, vcc
    v_lshl_add_u32 v25, v31, 1, s96
    v_add_u32 v23, 1, v23
    v_sub_u32 v30, 544, v23
    v_cvt_f32_i32 v31, v30
    v_cmp_gt_u32 vcc, 0x100, v30
    v_cvt_pk_bf16_f32 v31, v31, v31
    v_and_b32 v31, 0xffff, v31
    v_subrev_u32 v31, 0x4280, v31
    v_cndmask_b32 v31, v31, v30, vcc
    v_cmp_lt_u32 vcc, 0x20d, v30
    v_or_b32 v30, 1, v23
    s_nop 0
    v_cndmask_b32 v31, v31, v32, vcc
    v_cmp_eq_u32 vcc, 0x25d, v30
    s_nop 1
    v_cndmask_b32 v31, v31, v33, vcc
    v_lshl_add_u32 v27, v31, 1, s96
    v_mov_b32 v26, v25
    s_branch PREW_6
PREB_5:
    s_lshl_b32 s93, s86, 7
    s_add_u32 s93, s93, 18
    v_lshl_add_u32 v23, v1, 1, s93
    v_sub_u32 v30, 544, v23
    v_cvt_f32_i32 v31, v30
    v_cmp_gt_u32 vcc, 0x100, v30
    v_cvt_pk_bf16_f32 v31, v31, v31
    v_and_b32 v31, 0xffff, v31
    v_subrev_u32 v31, 0x4280, v31
    v_cndmask_b32 v31, v31, v30, vcc
    v_cmp_lt_u32 vcc, 0x20d, v30
    s_nop 1
    v_cndmask_b32 v31, v31, v32, vcc
    v_lshl_add_u32 v24, v31, 1, s96
    v_add_u32 v23, 1, v23
    v_sub_u32 v30, 544, v23
    v_cvt_f32_i32 v31, v30
    v_cmp_gt_u32 vcc, 0x100, v30
    v_cvt_pk_bf16_f32 v31, v31, v31
    v_and_b32 v31, 0xffff, v31
    v_subrev_u32 v31, 0x4280, v31
    v_cndmask_b32 v31, v31, v30, vcc
    v_cmp_lt_u32 vcc, 0x20d, v30
    s_nop 1
    v_cndmask_b32 v31, v31, v32, vcc
    v_lshl_add_u32 v25, v31, 1, s96
    v_add_u32 v23, 1, v23
    v_sub_u32 v30, 544, v23
    v_cvt_f32_i32 v31, v30
    v_cmp_gt_u32 vcc, 0x100, v30
    v_cvt_pk_bf16_f32 v31, v31, v31
    v_and_b32 v31, 0xffff, v31
    v_subrev_u32 v31, 0x4280, v31
    v_cndmask_b32 v31, v31, v30, vcc
    v_cmp_lt_u32 vcc, 0x20d, v30
    s_nop 1
    v_cndmask_b32 v31, v31, v32, vcc
    v_lshl_add_u32 v26, v31, 1, s96
    s_sub_u32 s93, s86, 1
    s_cmp_lt_u32 s93, 2
    s_cselect_b32 s94, 47, 63
    s_mul_i32 s93, s93, 384
    s_add_u32 s93, s93, 35664
    s_cmp_eq_u32 s86, 0
    s_cselect_b32 s93, 35152, s93
    s_cmp_eq_u32 s86, 3
    s_cselect_b32 s93, 32528, s93
    s_cselect_b32 s95, 0x100, 0
    v_cmp_gt_u32 vcc, 9, v1
    v_min_u32 v23, s94, v1
    v_add_u32 v30, s95, v23
    v_cndmask_b32 v23, v30, v23, vcc
    v_lshl_add_u32 v27, v23, 2, s93
    v_lshl_or_b32 v24, v25, 16, v24
    v_lshl_or_b32 v25, v27, 16, v26
    ds_write_b64 v28, v[24:25] offset:1024
    v_mov_b32 v24, s86
    ds_write_b8 v24, v5 offset:212
    s_branch PREE_7
PREW_6:
    v_lshl_or_b32 v24, v25, 16, v24
    v_lshl_or_b32 v25, v27, 16, v26
    ds_write_b64 v28, v[24:25] offset:1536
    v_mov_b32 v24, s86
    ds_write_b8 v24, v5 offset:208
PREE_7:
    s_mul_i32 s93, s86, 8704
    s_min_u32 s94, s93, 22304
    s_add_u32 s94, s94, s85
    s_lshl_b32 s92, s87, 4
    v_mov_b32 v14, s92
    v_add_u32 v15, s86, v14
    v_lshl_add_u32 v72, v1, 3, s94
    v_add_u32 v73, 2176, v72
    v_add_u32 v74, 4352, v72
    v_add_u32 v75, 6528, v72
    v_mul_u32_u24 v126, 544, v2
    v_lshl_add_u32 v126, v3, 4, v126
    v_add_u32 v126, s85, v126
    v_add_u32 v127, s93, v126
    v_lshlrev_b32 v20, 3, v3
    v_sub_u32 v20, v20, v2
    v_add_u32 v21, 16, v20
    v_lshrrev_b32 v21, 1, v21
    v_and_b32 v22, 1, v2
    s_add_u32 s92, s85, 32528
    v_lshl_add_u32 v21, v21, 2, s92
    s_movk_i32 s92, 1344
    s_movk_i32 s94, 192
    v_mad_u32_u24 v6, v22, s92, v21
    v_add_u32 v7, 640, v6
    v_mad_u32_u24 v23, v22, s94, v21
    v_add_u32 v13, 3136, v23
    v_lshlrev_b32 v23, 2, v3
    v_sub_u32 v23, v23, v2
    s_add_u32 s92, s85, 35212
    v_lshl_add_u32 v11, v23, 2, s92
    s_mul_i32 s94, s87, 4672
    s_add_u32 s94, s94, 3072
    v_lshl_add_u32 v23, v2, 5, s94
    v_lshl_add_u32 v8, v3, 4, v23
    v_bfe_u32 v20, v1, 2, 2
    v_and_b32 v21, 3, v1
    v_lshl_add_u32 v20, v3, 3, v20
    v_lshlrev_b32 v105, 2, v21
    v_lshl_add_u32 v21, v21, 3, s85
    v_lshl_add_u32 v9, v20, 4, v21
    v_lshl_add_u32 v10, v20, 5, v21
    v_lshlrev_b32 v12, 4, v1
    s_add_u32 s64, s36, 0x600000
    s_addc_u32 s65, s37, 0
    s_mov_b32 s66, 0x240000
    s_mov_b32 s67, 0x20000
    s_mov_b32 s10, 0x8080
    s_lshl_b32 s92, s86, 19
    s_lshl_b32 s93, s90, 6
    s_add_u32 s92, s92, s93
    s_lshl_b32 s93, s86, 16
    s_lshl_b32 s95, s88, 6
    s_add_u32 s93, s93, s95
    s_add_u32 s93, s93, 2064384
    s_cmp_eq_u32 s87, 2
    s_cselect_b32 s6, s93, s92
    s_cselect_b32 s8, 0x1080, s10
    s_cselect_b32 s92, 1, 3
    s_and_b32 s92, s92, s86
    s_lshl_b32 s92, s92, 11
    s_xor_b32 s6, s6, s92
    s_and_b32 s10, s6, 0x7c0
    s_xor_b32 s6, s6, s10
    s_xor_b32 s7, s6, 0x6000
    s_and_b32 s9, s87, 1
    s_lshl_b32 s9, s9, 4
    s_mov_b32 s12, 0x55555555
    s_mov_b32 s13, 0x55555555
    s_lshl_b32 s92, s86, 8
    s_add_u32 s92, s92, s85
    s_add_u32 s92, s92, 36
    v_lshl_add_u32 v124, v1, 2, s92
    s_movk_i32 s92, 192
    s_cmp_eq_u32 s86, 0
    s_cselect_b32 s92, 256, s92
    s_cmp_eq_u32 s86, 3
    s_cselect_b32 s92, 1344, s92
    v_mov_b32 v20, s85
    ds_write_b16 v20, v4 offset:32514
    s_mov_b32 s18, s92
    v_mov_b32 v125, v28
W_12:
    ds_read_b64 v[18:19], v4 offset:208
    s_sub_u32 s39, s39, 1
    s_cbranch_scc1 KS_ABORT
    s_waitcnt lgkmcnt(0)
    v_and_b32 v18, v18, v19
    v_cmp_ne_u32 vcc, s84, v18
    s_cbranch_vccnz W_12
    ds_read2st64_b64 v[28:31], v125 offset0:0 offset1:1
    ds_read2st64_b64 v[32:35], v125 offset0:2 offset1:3
    s_waitcnt lgkmcnt(0)
    v_add_u32_sdwa v108, s85, v28 dst_sel:DWORD dst_unused:UNUSED_PAD src0_sel:DWORD src1_sel:WORD_0
    v_add_u32_sdwa v109, s85, v28 dst_sel:DWORD dst_unused:UNUSED_PAD src0_sel:DWORD src1_sel:WORD_1
    v_cvt_f32_u32_sdwa v110, v29 dst_sel:DWORD dst_unused:UNUSED_PAD src0_sel:WORD_0
    v_cvt_f32_u32_sdwa v111, v29 dst_sel:DWORD dst_unused:UNUSED_PAD src0_sel:WORD_1
    v_add_u32_sdwa v112, s85, v30 dst_sel:DWORD dst_unused:UNUSED_PAD src0_sel:DWORD src1_sel:WORD_0
    v_add_u32_sdwa v113, s85, v30 dst_sel:DWORD dst_unused:UNUSED_PAD src0_sel:DWORD src1_sel:WORD_1
    v_cvt_f32_u32_sdwa v114, v31 dst_sel:DWORD dst_unused:UNUSED_PAD src0_sel:WORD_0
    v_cvt_f32_u32_sdwa v115, v31 dst_sel:DWORD dst_unused:UNUSED_PAD src0_sel:WORD_1
    v_add_u32_sdwa v116, s85, v32 dst_sel:DWORD dst_unused:UNUSED_PAD src0_sel:DWORD src1_sel:WORD_0
    v_add_u32_sdwa v117, s85, v32 dst_sel:DWORD dst_unused:UNUSED_PAD src0_sel:DWORD src1_sel:WORD_1
    v_add_u32_sdwa v118, s85, v33 dst_sel:DWORD dst_unused:UNUSED_PAD src0_sel:DWORD src1_sel:WORD_0
    v_add_u32_sdwa v119, s85, v33 dst_sel:DWORD dst_unused:UNUSED_PAD src0_sel:DWORD src1_sel:WORD_1
    v_add_u32_sdwa v120, s85, v34 dst_sel:DWORD dst_unused:UNUSED_PAD src0_sel:DWORD src1_sel:WORD_0
    v_add_u32_sdwa v121, s85, v34 dst_sel:DWORD dst_unused:UNUSED_PAD src0_sel:DWORD src1_sel:WORD_1
    v_add_u32_sdwa v122, s85, v35 dst_sel:DWORD dst_unused:UNUSED_PAD src0_sel:DWORD src1_sel:WORD_0
    v_add_u32_sdwa v123, s85, v35 dst_sel:DWORD dst_unused:UNUSED_PAD src0_sel:DWORD src1_sel:WORD_1
    v_add_u32 v125, s18, v119
    s_lshl_b32 s92, s87, 5
    s_add_u32 s92, s92, s41
    s_cmp_ge_u32 s92, 88
    s_cbranch_scc1 KC_RECV
    s_mov_b32 s92, 0x3fb8aa3b
    s_mov_b32 s93, 0x32a57060
    s_mov_b32 s94, 0x3e22f983
    s_mov_b32 s95, 0x31dc9c88
    s_waitcnt vmcnt(7)
    v_lshlrev_b32 v16, 16, v46
    v_mul_f32 v17, s92, v16
    v_fma_f32 v19, v16, s92, -v17
    v_fmac_f32 v19, s93, v16
    v_exp_f32 v17, v17
    v_mul_f32 v19, 0x3f317218, v19
    v_fmac_f32 v17, v17, v19
    v_cvt_pk_bf16_f32 v17, v17, v17
    v_and_b32 v16, 0xffff0000, v17
    s_waitcnt vmcnt(5)
    ds_write_b32 v4, v5 offset:36
    v_lshlrev_b32 v20, 16, v40
    v_and_b32 v21, 0xffff0000, v40
    v_lshlrev_b32 v22, 16, v41
    v_and_b32 v23, 0xffff0000, v41
    v_pk_mul_f32 v[20:21], v[20:21], v[16:17] op_sel_hi:[1,0]
    v_pk_mul_f32 v[22:23], v[22:23], v[16:17] op_sel_hi:[1,0]
    v_max_f32 v36, v20, v21
    v_pk_mul_f32 v[68:69], v[22:23], s[94:95] op_sel_hi:[1,0]
    v_pk_fma_f32 v[70:71], v[22:23], s[94:95], v[68:69] op_sel_hi:[1,0,1] neg_lo:[0,0,1] neg_hi:[0,0,1]
    v_pk_fma_f32 v[70:71], v[22:23], s[94:95], v[70:71] op_sel:[0,1,0]
    s_cmp_eq_u32 s86, 3
    s_cbranch_scc1 SK_14
    s_waitcnt vmcnt(1)
    v_lshlrev_b32 v24, 16, v42
    v_and_b32 v25, 0xffff0000, v42
    v_lshlrev_b32 v26, 16, v43
    v_and_b32 v27, 0xffff0000, v43
    v_lshlrev_b32 v28, 16, v44
    v_and_b32 v29, 0xffff0000, v44
    v_lshlrev_b32 v30, 16, v45
    v_and_b32 v31, 0xffff0000, v45
    v_pk_mul_f32 v[24:25], v[24:25], v[16:17] op_sel_hi:[1,0]
    v_pk_mul_f32 v[26:27], v[26:27], v[16:17] op_sel_hi:[1,0]
    v_pk_mul_f32 v[90:91], v[30:31], v[26:27]
    v_pk_mul_f32 v[92:93], v[30:31], v[24:25]
    v_pk_fma_f32 v[34:35], v[28:29], v[26:27], v[92:93]
    v_pk_fma_f32 v[32:33], v[28:29], v[24:25], v[90:91] neg_lo:[0,0,1] neg_hi:[0,0,1]
    v_max3_f32 v37, abs(v34), abs(v35), abs(v32)
    v_max_f32 v37, v37, abs(v33)
SK_14:
    s_waitcnt vmcnt(0)
    s_nop 0
    v_permlane32_swap_b32 v36, v37
    v_max_f32 v36, v36, v37
    s_nop 1
    v_max_f32_dpp v36, v36, v36 row_ror:8 row_mask:0xf bank_mask:0xf
    s_nop 1
    v_max_f32_dpp v36, v36, v36 row_ror:4 row_mask:0xf bank_mask:0xf
    s_nop 1
    v_max_f32_dpp v36, v36, v36 row_ror:2 row_mask:0xf bank_mask:0xf
    s_nop 1
    v_max_f32_dpp v36, v36, v36 row_ror:1 row_mask:0xf bank_mask:0xf
    v_mov_b32 v38, v36
    s_nop 1
    v_permlane16_swap_b32 v36, v38
    v_max_f32 v36, v36, v38
    s_nop 0
    v_readlane_b32 s14, v36, 0
    v_readlane_b32 s15, v36, 32
    s_add_u32 s15, s15, 0x7fffff
    s_lshr_b32 s15, s15, 23
    s_max_u32 s15, s15, 24
    s_sub_u32 s16, 269, s15
    s_lshl_b32 s16, s16, 23
    v_subrev_f32 v20, s14, v20
    v_subrev_f32 v21, s14, v21
    v_mul_f32 v20, 0x3fb8aa3b, v20
    v_mul_f32 v21, 0x3fb8aa3b, v21
    s_cmp_eq_u32 s86, 3
    s_cbranch_scc1 JOB_18
    s_cmp_eq_u32 s86, 1
    s_cbranch_scc1 JOB_16
    s_cmp_eq_u32 s86, 2
    s_cbranch_scc1 JOB_17
    v_mul_f32 v91, 0x43000000, v68
    v_mul_f32 v90, 0x43000000, v20
    v_mul_f32 v95, 0x43000000, v69
    v_mul_f32 v94, 0x43000000, v21
    v_fract_f32 v91, v91
    v_fract_f32 v95, v95
    v_fmac_f32 v91, 0x43000000, v70
    v_fmac_f32 v95, 0x43000000, v71
    v_exp_f32 v90, v90
    v_cos_f32 v92, v91
    v_sin_f32 v91, v91
    v_exp_f32 v94, v94
    v_cos_f32 v96, v95
    v_sin_f32 v95, v95
    v_mul_f32 v44, v90, v92
    v_mul_f32 v46, v90, v91
    v_mul_f32 v45, v94, v96
    v_mul_f32 v47, v94, v95
    v_pk_mul_f32 v[32:33], v[32:33], s[16:17] op_sel_hi:[1,0]
    v_pk_mul_f32 v[34:35], v[34:35], s[16:17] op_sel_hi:[1,0]
    v_fract_f32 v91, v68
    v_fract_f32 v95, v69
    v_fmac_f32 v91, 1.0, v70
    v_fmac_f32 v95, 1.0, v71
    v_exp_f32 v90, v20
    v_cos_f32 v92, v91
    v_sin_f32 v91, v91
    v_exp_f32 v94, v21
    v_cos_f32 v96, v95
    v_sin_f32 v95, v95
    v_mul_f32 v40, v90, v92
    v_mul_f32 v42, v90, v91
    v_mul_f32 v41, v94, v96
    v_mul_f32 v43, v94, v95
    v_pk_mul_f32 v[90:91], v[34:35], v[46:47]
    v_pk_mul_f32 v[94:95], v[34:35], v[42:43]
    v_pk_mul_f32 v[92:93], v[34:35], v[44:45]
    v_pk_mul_f32 v[96:97], v[34:35], v[40:41]
    v_pk_fma_f32 v[62:63], v[32:33], v[46:47], v[92:93]
    v_pk_fma_f32 v[54:55], v[32:33], v[42:43], v[96:97]
    v_pk_fma_f32 v[60:61], v[32:33], v[44:45], v[90:91] neg_lo:[0,0,1] neg_hi:[0,0,1]
    v_pk_fma_f32 v[52:53], v[32:33], v[40:41], v[94:95] neg_lo:[0,0,1] neg_hi:[0,0,1]
    v_cvt_pk_f16_f32 v98, v32, v34
    v_cvt_pk_f16_f32 v99, v33, v35
    v_cvt_pk_f16_f32 v100, v60, v62
    v_cvt_pk_f16_f32 v101, v61, v63
    ds_write2_b64 v72, v[98:99], v[100:101] offset0:0 offset1:68
    v_pk_mul_f32 v[90:91], v[54:55], v[46:47]
    v_pk_mul_f32 v[94:95], v[54:55], v[42:43]
    v_pk_mul_f32 v[92:93], v[54:55], v[44:45]
    v_pk_mul_f32 v[96:97], v[54:55], v[40:41]
    v_pk_fma_f32 v[62:63], v[52:53], v[46:47], v[92:93]
    v_pk_fma_f32 v[58:59], v[52:53], v[42:43], v[96:97]
    v_pk_fma_f32 v[60:61], v[52:53], v[44:45], v[90:91] neg_lo:[0,0,1] neg_hi:[0,0,1]
    v_pk_fma_f32 v[56:57], v[52:53], v[40:41], v[94:95] neg_lo:[0,0,1] neg_hi:[0,0,1]
    v_cvt_pk_f16_f32 v76, v52, v54
    v_cvt_pk_f16_f32 v77, v53, v55
    v_cvt_pk_f16_f32 v78, v60, v62
    v_cvt_pk_f16_f32 v79, v61, v63
    ds_write2_b64 v72, v[76:77], v[78:79] offset0:136 offset1:204
    v_pk_mul_f32 v[90:91], v[58:59], v[46:47]
    v_pk_mul_f32 v[94:95], v[58:59], v[42:43]
    v_pk_mul_f32 v[92:93], v[58:59], v[44:45]
    v_pk_mul_f32 v[96:97], v[58:59], v[40:41]
    v_pk_fma_f32 v[62:63], v[56:57], v[46:47], v[92:93]
    v_pk_fma_f32 v[54:55], v[56:57], v[42:43], v[96:97]
    v_pk_fma_f32 v[60:61], v[56:57], v[44:45], v[90:91] neg_lo:[0,0,1] neg_hi:[0,0,1]
    v_pk_fma_f32 v[52:53], v[56:57], v[40:41], v[94:95] neg_lo:[0,0,1] neg_hi:[0,0,1]
    v_cvt_pk_f16_f32 v98, v56, v58
    v_cvt_pk_f16_f32 v99, v57, v59
    v_cvt_pk_f16_f32 v100, v60, v62
    v_cvt_pk_f16_f32 v101, v61, v63
    ds_write2_b64 v73, v[98:99], v[100:101] offset0:0 offset1:68
    v_pk_mul_f32 v[90:91], v[54:55], v[46:47]
    v_pk_mul_f32 v[94:95], v[54:55], v[42:43]
    v_pk_mul_f32 v[92:93], v[54:55], v[44:45]
    v_pk_mul_f32 v[96:97], v[54:55], v[40:41]
    v_pk_fma_f32 v[62:63], v[52:53], v[46:47], v[92:93]
    v_pk_fma_f32 v[58:59], v[52:53], v[42:43], v[96:97]
    v_pk_fma_f32 v[60:61], v[52:53], v[44:45], v[90:91] neg_lo:[0,0,1] neg_hi:[0,0,1]
    v_pk_fma_f32 v[56:57], v[52:53], v[40:41], v[94:95] neg_lo:[0,0,1] neg_hi:[0,0,1]
    v_cvt_pk_f16_f32 v76, v52, v54
    v_cvt_pk_f16_f32 v77, v53, v55
    v_cvt_pk_f16_f32 v78, v60, v62
    v_cvt_pk_f16_f32 v79, v61, v63
    ds_write2_b64 v73, v[76:77], v[78:79] offset0:136 offset1:204
    v_pk_mul_f32 v[90:91], v[58:59], v[46:47]
    v_pk_mul_f32 v[94:95], v[58:59], v[42:43]
    v_pk_mul_f32 v[92:93], v[58:59], v[44:45]
    v_pk_mul_f32 v[96:97], v[58:59], v[40:41]
    v_pk_fma_f32 v[62:63], v[56:57], v[46:47], v[92:93]
    v_pk_fma_f32 v[54:55], v[56:57], v[42:43], v[96:97]
    v_pk_fma_f32 v[60:61], v[56:57], v[44:45], v[90:91] neg_lo:[0,0,1] neg_hi:[0,0,1]
    v_pk_fma_f32 v[52:53], v[56:57], v[40:41], v[94:95] neg_lo:[0,0,1] neg_hi:[0,0,1]
    v_cvt_pk_f16_f32 v98, v56, v58
    v_cvt_pk_f16_f32 v99, v57, v59
    v_cvt_pk_f16_f32 v100, v60, v62
    v_cvt_pk_f16_f32 v101, v61, v63
    ds_write2_b64 v74, v[98:99], v[100:101] offset0:0 offset1:68
    v_pk_mul_f32 v[90:91], v[54:55], v[46:47]
    v_pk_mul_f32 v[94:95], v[54:55], v[42:43]
    v_pk_mul_f32 v[92:93], v[54:55], v[44:45]
    v_pk_mul_f32 v[96:97], v[54:55], v[40:41]
    v_pk_fma_f32 v[62:63], v[52:53], v[46:47], v[92:93]
    v_pk_fma_f32 v[58:59], v[52:53], v[42:43], v[96:97]
    v_pk_fma_f32 v[60:61], v[52:53], v[44:45], v[90:91] neg_lo:[0,0,1] neg_hi:[0,0,1]
    v_pk_fma_f32 v[56:57], v[52:53], v[40:41], v[94:95] neg_lo:[0,0,1] neg_hi:[0,0,1]
    v_cvt_pk_f16_f32 v76, v52, v54
    v_cvt_pk_f16_f32 v77, v53, v55
    v_cvt_pk_f16_f32 v78, v60, v62
    v_cvt_pk_f16_f32 v79, v61, v63
    ds_write2_b64 v74, v[76:77], v[78:79] offset0:136 offset1:204
    v_pk_mul_f32 v[90:91], v[58:59], v[46:47]
    v_pk_mul_f32 v[94:95], v[58:59], v[42:43]
    v_pk_mul_f32 v[92:93], v[58:59], v[44:45]
    v_pk_mul_f32 v[96:97], v[58:59], v[40:41]
    v_pk_fma_f32 v[62:63], v[56:57], v[46:47], v[92:93]
    v_pk_fma_f32 v[54:55], v[56:57], v[42:43], v[96:97]
    v_pk_fma_f32 v[60:61], v[56:57], v[44:45], v[90:91] neg_lo:[0,0,1] neg_hi:[0,0,1]
    v_pk_fma_f32 v[52:53], v[56:57], v[40:41], v[94:95] neg_lo:[0,0,1] neg_hi:[0,0,1]
    v_cvt_pk_f16_f32 v98, v56, v58
    v_cvt_pk_f16_f32 v99, v57, v59
    v_cvt_pk_f16_f32 v100, v60, v62
    v_cvt_pk_f16_f32 v101, v61, v63
    ds_write2_b64 v75, v[98:99], v[100:101] offset0:0 offset1:68
    v_pk_mul_f32 v[90:91], v[54:55], v[46:47]
    v_pk_mul_f32 v[92:93], v[54:55], v[44:45]
    v_pk_fma_f32 v[62:63], v[52:53], v[46:47], v[92:93]
    v_pk_fma_f32 v[60:61], v[52:53], v[44:45], v[90:91] neg_lo:[0,0,1] neg_hi:[0,0,1]
    v_cvt_pk_f16_f32 v76, v52, v54
    v_cvt_pk_f16_f32 v77, v53, v55
    v_cvt_pk_f16_f32 v78, v60, v62
    v_cvt_pk_f16_f32 v79, v61, v63
    ds_write2_b64 v75, v[76:77], v[78:79] offset0:136 offset1:204
    s_branch JOBJ_19
JOB_16:
    v_mul_f32 v91, 0x43000000, v68
    v_mul_f32 v90, 0x43000000, v20
    v_mul_f32 v95, 0x43000000, v69
    v_mul_f32 v94, 0x43000000, v21
    v_fract_f32 v91, v91
    v_fract_f32 v95, v95
    v_fmac_f32 v91, 0x43000000, v70
    v_fmac_f32 v95, 0x43000000, v71
    v_exp_f32 v90, v90
    v_cos_f32 v92, v91
    v_sin_f32 v91, v91
    v_exp_f32 v94, v94
    v_cos_f32 v96, v95
    v_sin_f32 v95, v95
    v_mul_f32 v44, v90, v92
    v_mul_f32 v46, v90, v91
    v_mul_f32 v45, v94, v96
    v_mul_f32 v47, v94, v95
    v_pk_mul_f32 v[32:33], v[32:33], s[16:17] op_sel_hi:[1,0]
    v_pk_mul_f32 v[34:35], v[34:35], s[16:17] op_sel_hi:[1,0]
    v_pk_mul_f32 v[90:91], v[46:47], v[46:47]
    v_pk_mul_f32 v[92:93], v[44:45], v[46:47]
    v_pk_fma_f32 v[48:49], v[44:45], v[44:45], v[90:91] neg_lo:[0,0,1] neg_hi:[0,0,1]
    v_pk_add_f32 v[50:51], v[92:93], v[92:93]
    v_mul_f32 v91, 2.0, v68
    v_mul_f32 v90, 2.0, v20
    v_mul_f32 v95, 2.0, v69
    v_mul_f32 v94, 2.0, v21
    v_fract_f32 v91, v91
    v_fract_f32 v95, v95
    v_fmac_f32 v91, 2.0, v70
    v_fmac_f32 v95, 2.0, v71
    v_exp_f32 v90, v90
    v_cos_f32 v92, v91
    v_sin_f32 v91, v91
    v_exp_f32 v94, v94
    v_cos_f32 v96, v95
    v_sin_f32 v95, v95
    v_mul_f32 v40, v90, v92
    v_mul_f32 v42, v90, v91
    v_mul_f32 v41, v94, v96
    v_mul_f32 v43, v94, v95
    v_pk_mul_f32 v[90:91], v[34:35], v[50:51]
    v_pk_mul_f32 v[92:93], v[34:35], v[48:49]
    v_pk_fma_f32 v[54:55], v[32:33], v[50:51], v[92:93]
    v_pk_fma_f32 v[52:53], v[32:33], v[48:49], v[90:91] neg_lo:[0,0,1] neg_hi:[0,0,1]
    v_pk_mul_f32 v[90:91], v[54:55], v[50:51]
    v_pk_mul_f32 v[92:93], v[54:55], v[48:49]
    v_pk_fma_f32 v[66:67], v[52:53], v[50:51], v[92:93]
    v_pk_fma_f32 v[64:65], v[52:53], v[48:49], v[90:91] neg_lo:[0,0,1] neg_hi:[0,0,1]
    v_pk_mul_f32 v[90:91], v[54:55], v[46:47]
    v_pk_mul_f32 v[94:95], v[54:55], v[42:43]
    v_pk_mul_f32 v[92:93], v[54:55], v[44:45]
    v_pk_mul_f32 v[96:97], v[54:55], v[40:41]
    v_pk_fma_f32 v[62:63], v[52:53], v[46:47], v[92:93]
    v_pk_fma_f32 v[58:59], v[52:53], v[42:43], v[96:97]
    v_pk_fma_f32 v[60:61], v[52:53], v[44:45], v[90:91] neg_lo:[0,0,1] neg_hi:[0,0,1]
    v_pk_fma_f32 v[56:57], v[52:53], v[40:41], v[94:95] neg_lo:[0,0,1] neg_hi:[0,0,1]
    v_cvt_pk_f16_f32 v98, v52, v54
    v_cvt_pk_f16_f32 v99, v53, v55
    v_cvt_pk_f16_f32 v100, v60, v62
    v_cvt_pk_f16_f32 v101, v61, v63
    ds_write2_b64 v72, v[98:99], v[100:101] offset0:0 offset1:68
    v_pk_mul_f32 v[90:91], v[58:59], v[46:47]
    v_pk_mul_f32 v[94:95], v[58:59], v[42:43]
    v_pk_mul_f32 v[92:93], v[58:59], v[44:45]
    v_pk_mul_f32 v[96:97], v[58:59], v[40:41]
    v_pk_fma_f32 v[62:63], v[56:57], v[46:47], v[92:93]
    v_pk_fma_f32 v[54:55], v[56:57], v[42:43], v[96:97]
    v_pk_fma_f32 v[60:61], v[56:57], v[44:45], v[90:91] neg_lo:[0,0,1] neg_hi:[0,0,1]
    v_pk_fma_f32 v[52:53], v[56:57], v[40:41], v[94:95] neg_lo:[0,0,1] neg_hi:[0,0,1]
    v_cvt_pk_f16_f32 v76, v56, v58
    v_cvt_pk_f16_f32 v77, v57, v59
    v_cvt_pk_f16_f32 v78, v60, v62
    v_cvt_pk_f16_f32 v79, v61, v63
    ds_write2_b64 v72, v[76:77], v[78:79] offset0:136 offset1:204
    v_pk_mul_f32 v[90:91], v[54:55], v[46:47]
    v_pk_mul_f32 v[94:95], v[54:55], v[42:43]
    v_pk_mul_f32 v[92:93], v[54:55], v[44:45]
    v_pk_mul_f32 v[96:97], v[54:55], v[40:41]
    v_pk_fma_f32 v[62:63], v[52:53], v[46:47], v[92:93]
    v_pk_fma_f32 v[58:59], v[52:53], v[42:43], v[96:97]
    v_pk_fma_f32 v[60:61], v[52:53], v[44:45], v[90:91] neg_lo:[0,0,1] neg_hi:[0,0,1]
    v_pk_fma_f32 v[56:57], v[52:53], v[40:41], v[94:95] neg_lo:[0,0,1] neg_hi:[0,0,1]
    v_cvt_pk_f16_f32 v98, v52, v54
    v_cvt_pk_f16_f32 v99, v53, v55
    v_cvt_pk_f16_f32 v100, v60, v62
    v_cvt_pk_f16_f32 v101, v61, v63
    ds_write2_b64 v73, v[98:99], v[100:101] offset0:0 offset1:68
    v_pk_mul_f32 v[90:91], v[58:59], v[46:47]
    v_pk_mul_f32 v[94:95], v[42:43], v[42:43]
    v_pk_mul_f32 v[92:93], v[58:59], v[44:45]
    v_pk_mul_f32 v[96:97], v[40:41], v[42:43]
    v_pk_fma_f32 v[62:63], v[56:57], v[46:47], v[92:93]
    v_pk_fma_f32 v[48:49], v[40:41], v[40:41], v[94:95] neg_lo:[0,0,1] neg_hi:[0,0,1]
    v_pk_fma_f32 v[60:61], v[56:57], v[44:45], v[90:91] neg_lo:[0,0,1] neg_hi:[0,0,1]
    v_pk_add_f32 v[50:51], v[96:97], v[96:97]
    v_cvt_pk_f16_f32 v76, v56, v58
    v_cvt_pk_f16_f32 v77, v57, v59
    v_cvt_pk_f16_f32 v78, v60, v62
    v_cvt_pk_f16_f32 v79, v61, v63
    ds_write2_b64 v73, v[76:77], v[78:79] offset0:136 offset1:204
    v_pk_mul_f32 v[90:91], v[66:67], v[50:51]
    v_pk_mul_f32 v[94:95], v[66:67], v[46:47]
    v_pk_mul_f32 v[92:93], v[66:67], v[48:49]
    v_pk_mul_f32 v[96:97], v[66:67], v[44:45]
    v_pk_fma_f32 v[62:63], v[64:65], v[50:51], v[92:93]
    v_pk_fma_f32 v[54:55], v[64:65], v[46:47], v[96:97]
    v_pk_fma_f32 v[60:61], v[64:65], v[48:49], v[90:91] neg_lo:[0,0,1] neg_hi:[0,0,1]
    v_pk_fma_f32 v[52:53], v[64:65], v[44:45], v[94:95] neg_lo:[0,0,1] neg_hi:[0,0,1]
    v_cvt_pk_f16_f32 v98, v64, v66
    v_cvt_pk_f16_f32 v99, v65, v67
    v_cvt_pk_f16_f32 v100, v60, v62
    v_cvt_pk_f16_f32 v101, v61, v63
    ds_write2_b64 v74, v[98:99], v[100:101] offset0:0 offset1:68
    v_pk_mul_f32 v[90:91], v[54:55], v[50:51]
    v_pk_mul_f32 v[94:95], v[54:55], v[46:47]
    v_pk_mul_f32 v[92:93], v[54:55], v[48:49]
    v_pk_mul_f32 v[96:97], v[54:55], v[44:45]
    v_pk_fma_f32 v[62:63], v[52:53], v[50:51], v[92:93]
    v_pk_fma_f32 v[58:59], v[52:53], v[46:47], v[96:97]
    v_pk_fma_f32 v[60:61], v[52:53], v[48:49], v[90:91] neg_lo:[0,0,1] neg_hi:[0,0,1]
    v_pk_fma_f32 v[56:57], v[52:53], v[44:45], v[94:95] neg_lo:[0,0,1] neg_hi:[0,0,1]
    v_cvt_pk_f16_f32 v76, v52, v54
    v_cvt_pk_f16_f32 v77, v53, v55
    v_cvt_pk_f16_f32 v78, v60, v62
    v_cvt_pk_f16_f32 v79, v61, v63
    ds_write2_b64 v74, v[76:77], v[78:79] offset0:136 offset1:204
    v_pk_mul_f32 v[90:91], v[58:59], v[50:51]
    v_pk_mul_f32 v[94:95], v[58:59], v[46:47]
    v_pk_mul_f32 v[92:93], v[58:59], v[48:49]
    v_pk_mul_f32 v[96:97], v[58:59], v[44:45]
    v_pk_fma_f32 v[62:63], v[56:57], v[50:51], v[92:93]
    v_pk_fma_f32 v[54:55], v[56:57], v[46:47], v[96:97]
    v_pk_fma_f32 v[60:61], v[56:57], v[48:49], v[90:91] neg_lo:[0,0,1] neg_hi:[0,0,1]
    v_pk_fma_f32 v[52:53], v[56:57], v[44:45], v[94:95] neg_lo:[0,0,1] neg_hi:[0,0,1]
    v_cvt_pk_f16_f32 v98, v56, v58
    v_cvt_pk_f16_f32 v99, v57, v59
    v_cvt_pk_f16_f32 v100, v60, v62
    v_cvt_pk_f16_f32 v101, v61, v63
    ds_write2_b64 v75, v[98:99], v[100:101] offset0:0 offset1:68
    v_pk_mul_f32 v[90:91], v[54:55], v[50:51]
    v_pk_mul_f32 v[92:93], v[54:55], v[48:49]
    v_pk_fma_f32 v[62:63], v[52:53], v[50:51], v[92:93]
    v_pk_fma_f32 v[60:61], v[52:53], v[48:49], v[90:91] neg_lo:[0,0,1] neg_hi:[0,0,1]
    v_cvt_pk_f16_f32 v76, v52, v54
    v_cvt_pk_f16_f32 v77, v53, v55
    v_cvt_pk_f16_f32 v78, v60, v62
    v_cvt_pk_f16_f32 v79, v61, v63
    ds_write2_b64 v75, v[76:77], v[78:79] offset0:136 offset1:204
    s_branch JOBJ_19
JOB_18:
    v_mul_f32 v91, 0x41000000, v68
    v_mul_f32 v90, 0x41000000, v20
    v_mul_f32 v95, 0x41000000, v69
    v_mul_f32 v94, 0x41000000, v21
    v_fract_f32 v91, v91
    v_fract_f32 v95, v95
    v_fmac_f32 v91, 0x41000000, v70
    v_fmac_f32 v95, 0x41000000, v71
    v_exp_f32 v90, v90
    v_cos_f32 v92, v91
    v_sin_f32 v91, v91
    v_exp_f32 v94, v94
    v_cos_f32 v96, v95
    v_sin_f32 v95, v95
    v_mul_f32 v40, v90, v92
    v_mul_f32 v42, v90, -v91
    v_mul_f32 v41, v94, v96
    v_mul_f32 v43, v94, -v95
    v_mov_b32 v52, 0x47000000
    v_mov_b32 v53, 0x47000000
    v_mov_b32 v54, 0
    v_mov_b32 v55, 0
    v_pk_mul_f32 v[90:91], v[42:43], v[42:43]
    v_pk_mul_f32 v[60:61], v[40:41], v[52:53]
    v_pk_mul_f32 v[92:93], v[40:41], v[42:43]
    v_pk_mul_f32 v[62:63], v[42:43], v[52:53]
    v_pk_fma_f32 v[44:45], v[40:41], v[40:41], v[90:91] neg_lo:[0,0,1] neg_hi:[0,0,1]
    v_pk_add_f32 v[46:47], v[92:93], v[92:93]
    v_pk_mul_f32 v[56:57], v[44:45], v[52:53]
    v_pk_mul_f32 v[94:95], v[62:63], v[46:47]
    v_pk_mul_f32 v[58:59], v[46:47], v[52:53]
    v_pk_mul_f32 v[96:97], v[62:63], v[44:45]
    v_pk_fma_f32 v[66:67], v[60:61], v[46:47], v[96:97]
    v_pk_fma_f32 v[64:65], v[60:61], v[44:45], v[94:95] neg_lo:[0,0,1] neg_hi:[0,0,1]
    v_cvt_pk_f16_f32 v98, v52, v54
    v_cvt_pk_f16_f32 v99, v53, v55
    v_cvt_pk_f16_f32 v100, v60, v62
    v_cvt_pk_f16_f32 v101, v61, v63
    ds_write2_b64 v72, v[98:99], v[100:101] offset0:0 offset1:68
    v_pk_mul_f32 v[90:91], v[58:59], v[46:47]
    v_pk_mul_f32 v[94:95], v[66:67], v[46:47]
    v_pk_mul_f32 v[92:93], v[58:59], v[44:45]
    v_pk_mul_f32 v[96:97], v[66:67], v[44:45]
    v_pk_fma_f32 v[54:55], v[56:57], v[46:47], v[92:93]
    v_pk_fma_f32 v[62:63], v[64:65], v[46:47], v[96:97]
    v_pk_fma_f32 v[52:53], v[56:57], v[44:45], v[90:91] neg_lo:[0,0,1] neg_hi:[0,0,1]
    v_pk_fma_f32 v[60:61], v[64:65], v[44:45], v[94:95] neg_lo:[0,0,1] neg_hi:[0,0,1]
    v_cvt_pk_f16_f32 v76, v56, v58
    v_cvt_pk_f16_f32 v77, v57, v59
    v_cvt_pk_f16_f32 v78, v64, v66
    v_cvt_pk_f16_f32 v79, v65, v67
    ds_write2_b64 v72, v[76:77], v[78:79] offset0:136 offset1:204
    v_pk_mul_f32 v[90:91], v[54:55], v[46:47]
    v_pk_mul_f32 v[94:95], v[62:63], v[46:47]
    v_pk_mul_f32 v[92:93], v[54:55], v[44:45]
    v_pk_mul_f32 v[96:97], v[62:63], v[44:45]
    v_pk_fma_f32 v[58:59], v[52:53], v[46:47], v[92:93]
    v_pk_fma_f32 v[66:67], v[60:61], v[46:47], v[96:97]
    v_pk_fma_f32 v[56:57], v[52:53], v[44:45], v[90:91] neg_lo:[0,0,1] neg_hi:[0,0,1]
    v_pk_fma_f32 v[64:65], v[60:61], v[44:45], v[94:95] neg_lo:[0,0,1] neg_hi:[0,0,1]
    v_cvt_pk_f16_f32 v98, v52, v54
    v_cvt_pk_f16_f32 v99, v53, v55
    v_cvt_pk_f16_f32 v100, v60, v62
    v_cvt_pk_f16_f32 v101, v61, v63
    ds_write2_b64 v73, v[98:99], v[100:101] offset0:0 offset1:68
    v_pk_mul_f32 v[90:91], v[58:59], v[46:47]
    v_pk_mul_f32 v[94:95], v[66:67], v[46:47]
    v_pk_mul_f32 v[92:93], v[58:59], v[44:45]
    v_pk_mul_f32 v[96:97], v[66:67], v[44:45]
    v_pk_fma_f32 v[54:55], v[56:57], v[46:47], v[92:93]
    v_pk_fma_f32 v[62:63], v[64:65], v[46:47], v[96:97]
    v_pk_fma_f32 v[52:53], v[56:57], v[44:45], v[90:91] neg_lo:[0,0,1] neg_hi:[0,0,1]
    v_pk_fma_f32 v[60:61], v[64:65], v[44:45], v[94:95] neg_lo:[0,0,1] neg_hi:[0,0,1]
    v_cvt_pk_f16_f32 v76, v56, v58
    v_cvt_pk_f16_f32 v77, v57, v59
    v_cvt_pk_f16_f32 v78, v64, v66
    v_cvt_pk_f16_f32 v79, v65, v67
    ds_write2_b64 v73, v[76:77], v[78:79] offset0:136 offset1:204
    v_pk_mul_f32 v[90:91], v[54:55], v[46:47]
    v_pk_mul_f32 v[94:95], v[62:63], v[46:47]
    v_pk_mul_f32 v[92:93], v[54:55], v[44:45]
    v_pk_mul_f32 v[96:97], v[62:63], v[44:45]
    v_pk_fma_f32 v[58:59], v[52:53], v[46:47], v[92:93]
    v_pk_fma_f32 v[66:67], v[60:61], v[46:47], v[96:97]
    v_pk_fma_f32 v[56:57], v[52:53], v[44:45], v[90:91] neg_lo:[0,0,1] neg_hi:[0,0,1]
    v_pk_fma_f32 v[64:65], v[60:61], v[44:45], v[94:95] neg_lo:[0,0,1] neg_hi:[0,0,1]
    v_cvt_pk_f16_f32 v98, v52, v54
    v_cvt_pk_f16_f32 v99, v53, v55
    v_cvt_pk_f16_f32 v100, v60, v62
    v_cvt_pk_f16_f32 v101, v61, v63
    ds_write2_b64 v74, v[98:99], v[100:101] offset0:0 offset1:68
    v_pk_mul_f32 v[90:91], v[58:59], v[46:47]
    v_pk_mul_f32 v[94:95], v[66:67], v[46:47]
    v_pk_mul_f32 v[92:93], v[58:59], v[44:45]
    v_pk_mul_f32 v[96:97], v[66:67], v[44:45]
    v_pk_fma_f32 v[54:55], v[56:57], v[46:47], v[92:93]
    v_pk_fma_f32 v[62:63], v[64:65], v[46:47], v[96:97]
    v_pk_fma_f32 v[52:53], v[56:57], v[44:45], v[90:91] neg_lo:[0,0,1] neg_hi:[0,0,1]
    v_pk_fma_f32 v[60:61], v[64:65], v[44:45], v[94:95] neg_lo:[0,0,1] neg_hi:[0,0,1]
    v_cvt_pk_f16_f32 v76, v56, v58
    v_cvt_pk_f16_f32 v77, v57, v59
    v_cvt_pk_f16_f32 v78, v64, v66
    v_cvt_pk_f16_f32 v79, v65, v67
    ds_write2_b64 v74, v[76:77], v[78:79] offset0:136 offset1:204
    v_pk_mul_f32 v[90:91], v[54:55], v[46:47]
    v_pk_mul_f32 v[94:95], v[62:63], v[46:47]
    v_pk_mul_f32 v[92:93], v[54:55], v[44:45]
    v_pk_mul_f32 v[96:97], v[62:63], v[44:45]
    v_pk_fma_f32 v[58:59], v[52:53], v[46:47], v[92:93]
    v_pk_fma_f32 v[66:67], v[60:61], v[46:47], v[96:97]
    v_pk_fma_f32 v[56:57], v[52:53], v[44:45], v[90:91] neg_lo:[0,0,1] neg_hi:[0,0,1]
    v_pk_fma_f32 v[64:65], v[60:61], v[44:45], v[94:95] neg_lo:[0,0,1] neg_hi:[0,0,1]
    v_cvt_pk_f16_f32 v98, v52, v54
    v_cvt_pk_f16_f32 v99, v53, v55
    v_cvt_pk_f16_f32 v100, v60, v62
    v_cvt_pk_f16_f32 v101, v61, v63
    ds_write2_b64 v75, v[98:99], v[100:101] offset0:0 offset1:68
    v_cvt_pk_f16_f32 v76, v56, v58
    v_cvt_pk_f16_f32 v77, v57, v59
    v_cvt_pk_f16_f32 v78, v64, v66
    v_cvt_pk_f16_f32 v79, v65, v67
    ds_write2_b64 v75, v[76:77], v[78:79] offset0:136 offset1:204
    ds_write_b8 v15, v5 offset:64
    s_cmp_eq_u32 s87, 2
    s_cbranch_scc1 KS_G0
    s_branch EXP_13
KC_SEND:
W_20:
    ds_read_b32 v104, v105 offset:224
    s_sub_u32 s39, s39, 1
    s_cbranch_scc1 KS_ABORT
    s_waitcnt lgkmcnt(0)
    v_cmp_eq_u32 vcc, 0, v104
    s_cbranch_vccnz W_20
    s_lshl_b32 s92, s88, 12
    s_lshl_b32 s93, s86, 10
    s_add_u32 s92, s92, s93
    s_add_u32 s92, s92, 0x920000
    v_add_u32 v24, s92, v12
    s_mov_b32 s93, 0xffff
    v_lshlrev_b32 v25, 16, v104
    v_cvt_f16_f32 v20, v20
    v_cvt_f16_f32 v21, v21
    v_cvt_f16_f32 v22, v22
    v_cvt_f16_f32 v23, v23
    s_cmp_lg_u32 s86, 2
    s_cbranch_scc1 KC_S2
    s_mov_b32 exec_lo, 0
    s_mov_b32 exec_hi, 0xffff0000
    v_mov_b32 v20, v106
    v_lshrrev_b32 v21, 16, v106
    s_mov_b64 exec, -1
KC_S2:
    v_bfi_b32 v20, s93, v20, v104
    v_bfi_b32 v21, s93, v21, v25
    v_bfi_b32 v22, s93, v22, v104
    v_bfi_b32 v23, s93, v23, v25
    global_store_dwordx4 v24, v[20:23], s[36:37] sc1
    s_branch KS_G0
KC_RECV:
    s_cmp_eq_u32 s86, 3
    s_cbranch_scc1 EXP_13
    s_lshl_b32 s92, s88, 12
    s_lshl_b32 s93, s86, 10
    s_add_u32 s92, s92, s93
    s_add_u32 s92, s92, 0x920000
    v_add_u32 v24, s92, v12
W_21:
    s_sleep 2
    ds_read_b32 v104, v105 offset:224
    s_sub_u32 s39, s39, 1
    s_cbranch_scc1 KS_ABORT
    s_waitcnt lgkmcnt(0)
    v_cmp_eq_u32 vcc, 0, v104
    s_cbranch_vccnz W_21
    v_lshlrev_b32 v25, 16, v104
W_22:
    s_sleep 2
    ds_read_b32 v17, v4 offset:68
    s_sub_u32 s39, s39, 1
    s_cbranch_scc1 KS_ABORT
    s_waitcnt lgkmcnt(0)
    v_cmp_ne_u32 vcc, s84, v17
    s_cbranch_vccnz W_22
    s_branch KPE_24
KP_23:
    s_sleep 2
KPE_24:
    global_load_dwordx4 v[20:23], v24, s[36:37] sc1
    s_sub_u32 s39, s39, 1
    s_cbranch_scc1 KS_ABORT
    s_waitcnt vmcnt(0)
    v_xor_b32 v20, v104, v20
    v_xor_b32 v21, v25, v21
    v_xor_b32 v22, v104, v22
    v_xor_b32 v23, v25, v23
    v_or3_b32 v26, v20, v21, v22
    v_or_b32 v26, v26, v23
    v_cmp_lt_u32 vcc, 0xffff, v26
    s_cbranch_vccnz KP_23
    v_xor_b32 v20, v104, v20
    v_xor_b32 v22, v104, v22
    ds_write_b16 v108, v20
    ds_write_b16 v109, v21
    ds_write_b16 v112, v22
    ds_write_b16 v113, v23
    s_cmp_lg_u32 s86, 2
    s_cbranch_scc1 EXP_13
    v_and_b32 v20, 0xffff, v20
    v_lshl_or_b32 v20, v21, 16, v20
    v_lshlrev_b32 v21, 16, v107
    s_mov_b32 exec_lo, 0
    s_mov_b32 exec_hi, 0x10000
    ds_write_b64 v14, v[20:21] offset:832
    s_mov_b64 exec, -1
    s_branch EXP_13
JOB_17:
    v_mul_f32 v91, 0x43000000, v68
    v_mul_f32 v90, 0x43000000, v20
    v_mul_f32 v95, 0x43000000, v69
    v_mul_f32 v94, 0x43000000, v21
    v_fract_f32 v91, v91
    v_fract_f32 v95, v95
    v_fmac_f32 v91, 0x43000000, v70
    v_fmac_f32 v95, 0x43000000, v71
    v_exp_f32 v90, v90
    v_cos_f32 v92, v91
    v_sin_f32 v91, v91
    v_exp_f32 v94, v94
    v_cos_f32 v96, v95
    v_sin_f32 v95, v95
    v_mul_f32 v44, v90, v92
    v_mul_f32 v46, v90, v91
    v_mul_f32 v45, v94, v96
    v_mul_f32 v47, v94, v95
    v_pk_mul_f32 v[32:33], v[32:33], s[16:17] op_sel_hi:[1,0]
    v_pk_mul_f32 v[34:35], v[34:35], s[16:17] op_sel_hi:[1,0]
    v_pk_mul_f32 v[90:91], v[46:47], v[46:47]
    v_pk_mul_f32 v[94:95], v[34:35], v[46:47]
    v_pk_mul_f32 v[92:93], v[44:45], v[46:47]
    v_pk_mul_f32 v[96:97], v[34:35], v[44:45]
    v_pk_fma_f32 v[40:41], v[44:45], v[44:45], v[90:91] neg_lo:[0,0,1] neg_hi:[0,0,1]
    v_pk_fma_f32 v[66:67], v[32:33], v[46:47], v[96:97]
    v_pk_add_f32 v[42:43], v[92:93], v[92:93]
    v_pk_fma_f32 v[64:65], v[32:33], v[44:45], v[94:95] neg_lo:[0,0,1] neg_hi:[0,0,1]
    v_pk_mul_f32 v[90:91], v[42:43], v[42:43]
    v_pk_mul_f32 v[92:93], v[40:41], v[42:43]
    v_pk_fma_f32 v[48:49], v[40:41], v[40:41], v[90:91] neg_lo:[0,0,1] neg_hi:[0,0,1]
    v_pk_add_f32 v[50:51], v[92:93], v[92:93]
    v_pk_mul_f32 v[90:91], v[50:51], v[50:51]
    v_pk_mul_f32 v[92:93], v[48:49], v[50:51]
    v_pk_fma_f32 v[48:49], v[48:49], v[48:49], v[90:91] neg_lo:[0,0,1] neg_hi:[0,0,1]
    v_pk_add_f32 v[50:51], v[92:93], v[92:93]
    v_pk_mul_f32 v[90:91], v[34:35], v[50:51]
    v_pk_mul_f32 v[94:95], v[66:67], v[50:51]
    v_pk_mul_f32 v[92:93], v[34:35], v[48:49]
    v_pk_mul_f32 v[96:97], v[66:67], v[48:49]
    v_pk_fma_f32 v[54:55], v[32:33], v[50:51], v[92:93]
    v_pk_fma_f32 v[62:63], v[64:65], v[50:51], v[96:97]
    v_pk_fma_f32 v[52:53], v[32:33], v[48:49], v[90:91] neg_lo:[0,0,1] neg_hi:[0,0,1]
    v_pk_fma_f32 v[60:61], v[64:65], v[48:49], v[94:95] neg_lo:[0,0,1] neg_hi:[0,0,1]
    v_pk_mul_f32 v[90:91], v[54:55], v[42:43]
    v_pk_mul_f32 v[94:95], v[62:63], v[42:43]
    v_pk_mul_f32 v[92:93], v[54:55], v[40:41]
    v_pk_mul_f32 v[96:97], v[62:63], v[40:41]
    v_pk_fma_f32 v[58:59], v[52:53], v[42:43], v[92:93]
    v_pk_fma_f32 v[66:67], v[60:61], v[42:43], v[96:97]
    v_pk_fma_f32 v[56:57], v[52:53], v[40:41], v[90:91] neg_lo:[0,0,1] neg_hi:[0,0,1]
    v_pk_fma_f32 v[64:65], v[60:61], v[40:41], v[94:95] neg_lo:[0,0,1] neg_hi:[0,0,1]
    v_cvt_pk_f16_f32 v98, v52, v54
    v_cvt_pk_f16_f32 v99, v53, v55
    v_cvt_pk_f16_f32 v100, v60, v62
    v_cvt_pk_f16_f32 v101, v61, v63
    ds_write2_b64 v72, v[98:99], v[100:101] offset0:0 offset1:68
    v_pk_mul_f32 v[90:91], v[58:59], v[42:43]
    v_pk_mul_f32 v[94:95], v[66:67], v[42:43]
    v_pk_mul_f32 v[92:93], v[58:59], v[40:41]
    v_pk_mul_f32 v[96:97], v[66:67], v[40:41]
    v_pk_fma_f32 v[54:55], v[56:57], v[42:43], v[92:93]
    v_pk_fma_f32 v[62:63], v[64:65], v[42:43], v[96:97]
    v_pk_fma_f32 v[52:53], v[56:57], v[40:41], v[90:91] neg_lo:[0,0,1] neg_hi:[0,0,1]
    v_pk_fma_f32 v[60:61], v[64:65], v[40:41], v[94:95] neg_lo:[0,0,1] neg_hi:[0,0,1]
    v_cvt_pk_f16_f32 v76, v56, v58
    v_cvt_pk_f16_f32 v77, v57, v59
    v_cvt_pk_f16_f32 v78, v64, v66
    v_cvt_pk_f16_f32 v79, v65, v67
    ds_write2_b64 v72, v[76:77], v[78:79] offset0:136 offset1:204
    v_pk_mul_f32 v[90:91], v[54:55], v[42:43]
    v_pk_mul_f32 v[94:95], v[62:63], v[42:43]
    v_pk_mul_f32 v[92:93], v[54:55], v[40:41]
    v_pk_mul_f32 v[96:97], v[62:63], v[40:41]
    v_pk_fma_f32 v[58:59], v[52:53], v[42:43], v[92:93]
    v_pk_fma_f32 v[66:67], v[60:61], v[42:43], v[96:97]
    v_pk_fma_f32 v[56:57], v[52:53], v[40:41], v[90:91] neg_lo:[0,0,1] neg_hi:[0,0,1]
    v_pk_fma_f32 v[64:65], v[60:61], v[40:41], v[94:95] neg_lo:[0,0,1] neg_hi:[0,0,1]
    v_cvt_pk_f16_f32 v98, v52, v54
    v_cvt_pk_f16_f32 v99, v53, v55
    v_cvt_pk_f16_f32 v100, v60, v62
    v_cvt_pk_f16_f32 v101, v61, v63
    ds_write2_b64 v73, v[98:99], v[100:101] offset0:0 offset1:68
    v_pk_mul_f32 v[90:91], v[58:59], v[42:43]
    v_pk_mul_f32 v[92:93], v[58:59], v[40:41]
    v_pk_fma_f32 v[54:55], v[56:57], v[42:43], v[92:93]
    v_pk_fma_f32 v[52:53], v[56:57], v[40:41], v[90:91] neg_lo:[0,0,1] neg_hi:[0,0,1]
    v_cvt_pk_f16_f32 v76, v56, v58
    v_cvt_pk_f16_f32 v77, v57, v59
    v_cvt_pk_f16_f32 v78, v64, v66
    v_cvt_pk_f16_f32 v79, v65, v67
    ds_write2_b64 v73, v[76:77], v[78:79] offset0:136 offset1:204
    v_cvt_pk_f16_f32 v98, v52, v54
    v_cvt_pk_f16_f32 v99, v53, v55
    v_mov_b32 v36, 0x4538aa3b
    v_mul_f32 v24, s14, v36
    v_max_f32 v24, 0, v24
    v_exp_f32 v24, v24
    ds_write_b64 v74, v[98:99] offset:0
    s_sub_u32 s11, s15, 7
    s_lshl_b32 s11, s11, 23
    v_lshlrev_b32 v25, 16, v107
    v_mul_f32 v24, s11, v24
    v_mov_b32 v106, v24
    ds_write_b64 v14, v[24:25] offset:832
JOBJ_19:
    ds_write_b8 v15, v5 offset:64
    ds_read_b128 v[40:43], v127 offset:0
    ds_read_b128 v[44:47], v127 offset:64
    ds_read_b128 v[48:51], v127 offset:128
    ds_read_b128 v[52:55], v127 offset:192
    ds_read_b128 v[56:59], v127 offset:256
    ds_read_b128 v[60:63], v127 offset:320
    ds_read_b128 v[64:67], v127 offset:384
    ds_read_b128 v[68:71], v127 offset:448
    v_mov_b32 v36, 0x3fb8aa3b
    v_mul_f32 v36, s14, v36
    v_mul_f32 v37, 0x45000000, v36
    v_max_f32 v37, 0, v37
    v_add_f32 v37, 0x41b80000, v37
    v_fma_f32 v110, v110, v36, -v37
    v_fma_f32 v111, v111, v36, -v37
    v_fma_f32 v114, v114, v36, -v37
    v_fma_f32 v115, v115, v36, -v37
    v_exp_f32 v110, v110
    v_exp_f32 v111, v111
    v_exp_f32 v114, v114
    v_exp_f32 v115, v115
W_25:
    ds_read_u8 v17, v14 offset:67
    s_sub_u32 s39, s39, 1
    s_cbranch_scc1 KS_ABORT
    s_waitcnt lgkmcnt(0)
    v_cmp_eq_u32 vcc, 0, v17
    s_cbranch_vccnz W_25
    ds_read_b128 v[72:75], v126 offset:22304
    ds_read_b128 v[76:79], v126 offset:22368
    ds_read_b128 v[80:83], v126 offset:22432
    ds_read_b128 v[84:87], v126 offset:22496
    ds_read_b128 v[88:91], v126 offset:22560
    ds_read_b128 v[92:95], v126 offset:22624
    ds_read_b128 v[96:99], v126 offset:22688
    ds_read_b128 v[100:103], v126 offset:22752
    s_waitcnt lgkmcnt(7)
    v_mfma_f32_16x16x32_f16 v[20:23], v[40:43], v[72:75], 0
    s_waitcnt lgkmcnt(6)
    v_mfma_f32_16x16x32_f16 v[24:27], v[44:47], v[76:79], 0
    s_waitcnt lgkmcnt(5)
    v_mfma_f32_16x16x32_f16 v[20:23], v[48:51], v[80:83], v[20:23]
    s_waitcnt lgkmcnt(4)
    v_mfma_f32_16x16x32_f16 v[24:27], v[52:55], v[84:87], v[24:27]
    s_waitcnt lgkmcnt(3)
    v_mfma_f32_16x16x32_f16 v[20:23], v[56:59], v[88:91], v[20:23]
    s_waitcnt lgkmcnt(2)
    v_mfma_f32_16x16x32_f16 v[24:27], v[60:63], v[92:95], v[24:27]
    s_waitcnt lgkmcnt(1)
    v_mfma_f32_16x16x32_f16 v[20:23], v[64:67], v[96:99], v[20:23]
    s_waitcnt lgkmcnt(0)
    v_mfma_f32_16x16x32_f16 v[24:27], v[68:71], v[100:103], v[24:27]
    s_nop 7
    v_add_f32 v20, v20, v24
    v_add_f32 v21, v21, v25
    v_add_f32 v22, v22, v26
    v_add_f32 v23, v23, v27
    v_mul_f32 v20, v20, v110
    v_mul_f32 v21, v21, v111
    v_mul_f32 v22, v22, v114
    v_mul_f32 v23, v23, v115
    s_cmp_eq_u32 s87, 2
    s_cbranch_scc1 KC_SEND
    v_cvt_f16_f32 v20, v20
    ds_write_b16 v108, v20
    v_cvt_f16_f32 v21, v21
    ds_write_b16 v109, v21
    v_cvt_f16_f32 v22, v22
    ds_write_b16 v112, v22
    v_cvt_f16_f32 v23, v23
    ds_write_b16 v113, v23
EXP_13:
    ds_write_b8 v15, v5 offset:68
    v_mov_b32 v28, 0
    v_mov_b32 v29, 0
    v_mov_b32 v30, 0
    v_mov_b32 v31, 0
    v_mov_b32 v32, s85
    s_waitcnt vmcnt(0)
W_26:
    ds_read_b32 v20, v14 offset:68
    s_sub_u32 s39, s39, 1
    s_cbranch_scc1 KS_ABORT
    s_waitcnt lgkmcnt(0)
    v_cmp_ne_u32 vcc, s84, v20
    s_cbranch_vccnz W_26
    ds_read_u16 v20, v116
    ds_read_u16 v21, v117
    ds_read_u16 v22, v118
    ds_read_u16 v23, v120
    ds_read_u16 v24, v121
    ds_read_u16 v25, v122
    ds_read_u16 v26, v123
    s_mov_b64 exec, 1
    ds_write_b128 v32, v[28:31] offset:3088
    ds_write_b128 v32, v[28:31] offset:8224
    ds_write_b128 v32, v[28:31] offset:3072
    s_mov_b64 exec, -1
    s_waitcnt lgkmcnt(7)
    v_lshl_or_b32 v28, v21, 16, v20
    v_lshl_or_b32 v29, v22, 16, v21
    ds_write_b32 v124, v28 offset:32528
    ds_write_b32 v124, v29 offset:33872
    s_waitcnt lgkmcnt(5)
    v_lshl_or_b32 v30, v24, 16, v23
    v_lshl_or_b32 v31, v26, 16, v25
    ds_write_b32 v119, v30
    ds_write_b32 v125, v31
    ds_write_b8 v15, v5 offset:72
W_27:
    ds_read_b32 v20, v14 offset:72
    s_sub_u32 s39, s39, 1
    s_cbranch_scc1 KS_ABORT
    s_waitcnt lgkmcnt(0)
    v_cmp_ne_u32 vcc, s84, v20
    s_cbranch_vccnz W_27
    ds_read_b64 v[16:17], v14 offset:832
    s_cmp_eq_u32 s86, 1
    s_cbranch_scc1 CV_29
    s_cmp_eq_u32 s86, 2
    s_cbranch_scc1 CV_30
    s_cmp_eq_u32 s86, 3
    s_cbranch_scc1 CV_31
    ds_read2_b32 v[32:33], v6 offset0:144 offset1:145
    ds_read2_b32 v[34:35], v6 offset0:146 offset1:147
    ds_read2_b32 v[36:37], v6 offset0:16 offset1:17
    ds_read2_b32 v[38:39], v6 offset0:18 offset1:19
    ds_read2_b32 v[40:41], v6 offset0:160 offset1:161
    ds_read2_b32 v[42:43], v6 offset0:162 offset1:163
    ds_read2_b32 v[44:45], v6 offset0:32 offset1:33
    ds_read2_b32 v[46:47], v6 offset0:34 offset1:35
    ds_read2_b32 v[48:49], v6 offset0:176 offset1:177
    ds_read2_b32 v[50:51], v6 offset0:178 offset1:179
    ds_read2_b32 v[52:53], v6 offset0:48 offset1:49
    ds_read2_b32 v[54:55], v6 offset0:50 offset1:51
    ds_read2_b32 v[56:57], v6 offset0:192 offset1:193
    ds_read2_b32 v[58:59], v6 offset0:194 offset1:195
    ds_read2_b32 v[60:61], v6 offset0:64 offset1:65
    ds_read2_b32 v[62:63], v6 offset0:66 offset1:67
    ds_read2_b32 v[64:65], v6 offset0:208 offset1:209
    ds_read2_b32 v[66:67], v6 offset0:210 offset1:211
    ds_read2_b32 v[68:69], v6 offset0:80 offset1:81
    ds_read2_b32 v[70:71], v6 offset0:82 offset1:83
    ds_read2_b32 v[72:73], v6 offset0:224 offset1:225
    ds_read2_b32 v[74:75], v6 offset0:226 offset1:227
    ds_read2_b32 v[76:77], v6 offset0:96 offset1:97
    ds_read2_b32 v[78:79], v6 offset0:98 offset1:99
    ds_read2_b32 v[80:81], v6 offset0:240 offset1:241
    ds_read2_b32 v[82:83], v6 offset0:242 offset1:243
    ds_read2_b32 v[84:85], v6 offset0:112 offset1:113
    ds_read2_b32 v[86:87], v6 offset0:114 offset1:115
    ds_read2_b32 v[88:89], v7 offset0:96 offset1:97
    ds_read2_b32 v[90:91], v7 offset0:98 offset1:99
    ds_read2_b32 v[92:93], v6 offset0:128 offset1:129
    ds_read2_b32 v[94:95], v6 offset0:130 offset1:131
    v_lshlrev_b32 v18, 3, v3
    v_sub_u32 v18, v8, v18
    v_lshrrev_b32 v19, 2, v2
    v_lshl_add_u32 v19, v19, 2, v3
    v_and_b32 v28, 3, v2
    v_lshlrev_b32 v28, 4, v28
    v_mul_u32_u24 v19, s8, v19
    v_xor_b32 v19, s10, v19
    s_waitcnt lgkmcnt(0)
    v_mov_b32 v7, v18
    v_add_u32 v6, v19, v28
    v_xor_b32 v12, s9, v12
W_33:
    ds_read_b32 v18, v4 offset:16
    s_sub_u32 s39, s39, 1
    s_cbranch_scc1 KS_ABORT
    s_waitcnt lgkmcnt(0)
    v_cmp_ne_u32 vcc, s84, v18
    s_cbranch_vccnz W_33
    s_setprio 1
    ds_read_b128 v[96:99], v8 offset:0
    ds_read_b128 v[100:103], v8 offset:64
    ds_read_b128 v[104:107], v8 offset:128
    ds_read_b128 v[108:111], v8 offset:192
    s_waitcnt lgkmcnt(3)
    v_mfma_f32_16x16x32_f16 v[20:23], v[32:35], v[96:99], 0
    v_mfma_f32_16x16x32_f16 v[24:27], v[36:39], v[96:99], 0
    ds_read_b128 v[112:115], v8 offset:256
    s_waitcnt lgkmcnt(3)
    v_mfma_f32_16x16x32_f16 v[20:23], v[40:43], v[100:103], v[20:23]
    ds_read_b64 v[28:29], v7 offset:480
    ds_read_b64 v[30:31], v7 offset:992
    v_mfma_f32_16x16x32_f16 v[24:27], v[44:47], v[100:103], v[24:27]
    ds_read_b128 v[116:119], v8 offset:320
    s_waitcnt lgkmcnt(5)
    v_mfma_f32_16x16x32_f16 v[20:23], v[48:51], v[104:107], v[20:23]
    v_mfma_f32_16x16x32_f16 v[24:27], v[52:55], v[104:107], v[24:27]
    ds_read_b128 v[120:123], v8 offset:384
    s_waitcnt lgkmcnt(2)
    v_fma_mix_f32 v104, v28, v17, 0 op_sel_hi:[1,0,0]
    v_fma_mix_f32 v105, v28, v17, 0 op_sel:[1,0,0] op_sel_hi:[1,0,0]
    v_mfma_f32_16x16x32_f16 v[20:23], v[56:59], v[108:111], v[20:23]
    v_fma_mix_f32 v106, v29, v17, 0 op_sel_hi:[1,0,0]
    v_fma_mix_f32 v107, v29, v17, 0 op_sel:[1,0,0] op_sel_hi:[1,0,0]
    v_mfma_f32_16x16x32_f16 v[24:27], v[60:63], v[108:111], v[24:27]
    ds_read_b128 v[124:127], v8 offset:448
    v_cvt_pk_bf16_f32 v28, v104, v105
    v_cvt_pk_bf16_f32 v29, v106, v107
    v_mfma_f32_16x16x32_f16 v[20:23], v[64:67], v[112:115], v[20:23]
    v_lshlrev_b32 v104, 16, v28
    v_and_b32 v105, 0xffff0000, v28
    v_mfma_f32_16x16x32_f16 v[24:27], v[68:71], v[112:115], v[24:27]
    ds_read_b128 v[36:39], v8 offset:512
    v_lshlrev_b32 v106, 16, v29
    v_and_b32 v107, 0xffff0000, v29
    s_waitcnt lgkmcnt(3)
    v_mfma_f32_16x16x32_f16 v[20:23], v[72:75], v[116:119], v[20:23]
    ds_read_b128 v[96:99], v8 offset:576
    v_fma_mix_f32 v112, v30, v17, 0 op_sel_hi:[1,0,0]
    v_fma_mix_f32 v113, v30, v17, 0 op_sel:[1,0,0] op_sel_hi:[1,0,0]
    v_mfma_f32_16x16x32_f16 v[24:27], v[76:79], v[116:119], v[24:27]
    ds_read_b128 v[44:47], v8 offset:640
    v_fma_mix_f32 v114, v31, v17, 0 op_sel_hi:[1,0,0]
    v_fma_mix_f32 v115, v31, v17, 0 op_sel:[1,0,0] op_sel_hi:[1,0,0]
    s_waitcnt lgkmcnt(4)
    v_mfma_f32_16x16x32_f16 v[20:23], v[80:83], v[120:123], v[20:23]
    ds_read_b128 v[100:103], v8 offset:704
    v_cvt_pk_bf16_f32 v30, v112, v113
    v_cvt_pk_bf16_f32 v31, v114, v115
    v_mfma_f32_16x16x32_f16 v[24:27], v[84:87], v[120:123], v[24:27]
    ds_read_b128 v[52:55], v8 offset:768
    v_lshlrev_b32 v112, 16, v30
    v_and_b32 v113, 0xffff0000, v30
    s_waitcnt lgkmcnt(5)
    v_mfma_f32_16x16x32_f16 v[20:23], v[88:91], v[124:127], v[20:23]
    ds_read_b128 v[60:63], v8 offset:832
    v_lshlrev_b32 v114, 16, v31
    v_and_b32 v115, 0xffff0000, v31
    v_mfma_f32_16x16x32_f16 v[24:27], v[92:95], v[124:127], v[24:27]
    ds_read_b128 v[108:111], v8 offset:896
    s_waitcnt lgkmcnt(6)
    v_mfma_f32_16x16x32_f16 v[24:27], v[32:35], v[36:39], v[24:27]
    ds_read_b128 v[68:71], v8 offset:960
    v_mul_f32 v20, v20, v16
    v_mul_f32 v21, v21, v16
    s_waitcnt lgkmcnt(6)
    v_mfma_f32_16x16x32_f16 v[24:27], v[40:43], v[96:99], v[24:27]
    v_mul_f32 v22, v22, v16
    v_mul_f32 v23, v23, v16
    s_waitcnt lgkmcnt(5)
    v_mfma_f32_16x16x32_f16 v[24:27], v[48:51], v[44:47], v[24:27]
    v_cvt_pk_bf16_f32 v28, v20, v21
    v_cvt_pk_bf16_f32 v29, v22, v23
    s_waitcnt lgkmcnt(4)
    v_mfma_f32_16x16x32_f16 v[24:27], v[56:59], v[100:103], v[24:27]
    v_lshlrev_b32 v20, 16, v28
    v_and_b32 v21, 0xffff0000, v28
    s_waitcnt lgkmcnt(3)
    v_mfma_f32_16x16x32_f16 v[24:27], v[64:67], v[52:55], v[24:27]
    v_lshlrev_b32 v22, 16, v29
    v_and_b32 v23, 0xffff0000, v29
    s_waitcnt lgkmcnt(2)
    v_mfma_f32_16x16x32_f16 v[24:27], v[72:75], v[60:63], v[24:27]
    v_add_f32 v20, v20, v104
    v_add_f32 v21, v21, v105
    s_waitcnt lgkmcnt(1)
    v_mfma_f32_16x16x32_f16 v[24:27], v[80:83], v[108:111], v[24:27]
    v_add_f32 v22, v22, v106
    v_add_f32 v23, v23, v107
    s_waitcnt lgkmcnt(0)
    v_mfma_f32_16x16x32_f16 v[24:27], v[88:91], v[68:71], v[24:27]
    v_cvt_pk_bf16_f32 v28, v20, v21
    v_cvt_pk_bf16_f32 v29, v22, v23
    v_min_u32 v28, -2, v28
    v_min_u32 v29, -2, v29
    ds_read_u8 v18, v4 offset:160
    ds_read_b128 v[20:23], v12 offset:46592
    s_nop 1
    v_mul_f32 v24, v24, v16
    v_mul_f32 v25, v25, v16
    v_mul_f32 v26, v26, v16
    v_mul_f32 v27, v27, v16
    v_cvt_pk_bf16_f32 v30, v24, v25
    v_cvt_pk_bf16_f32 v31, v26, v27
    v_lshlrev_b32 v24, 16, v30
    v_and_b32 v25, 0xffff0000, v30
    v_lshlrev_b32 v26, 16, v31
    v_and_b32 v27, 0xffff0000, v31
    v_add_f32 v24, v24, v112
    v_add_f32 v25, v25, v113
    v_add_f32 v26, v26, v114
    v_add_f32 v27, v27, v115
    v_cvt_pk_bf16_f32 v30, v24, v25
    v_cvt_pk_bf16_f32 v31, v26, v27
    v_min_u32 v30, -2, v30
    v_min_u32 v31, -2, v31
    s_branch CVE_32
CV_29:
    ds_read2_b32 v[32:33], v6 offset0:0 offset1:1
    ds_read2_b32 v[34:35], v6 offset0:2 offset1:3
    ds_read2_b32 v[36:37], v6 offset0:16 offset1:17
    ds_read2_b32 v[38:39], v6 offset0:18 offset1:19
    ds_read2_b32 v[40:41], v6 offset0:32 offset1:33
    ds_read2_b32 v[42:43], v6 offset0:34 offset1:35
    ds_read2_b32 v[44:45], v6 offset0:48 offset1:49
    ds_read2_b32 v[46:47], v6 offset0:50 offset1:51
    ds_read2_b32 v[48:49], v6 offset0:64 offset1:65
    ds_read2_b32 v[50:51], v6 offset0:66 offset1:67
    ds_read2_b32 v[52:53], v6 offset0:80 offset1:81
    ds_read2_b32 v[54:55], v6 offset0:82 offset1:83
    ds_read2_b32 v[56:57], v6 offset0:96 offset1:97
    ds_read2_b32 v[58:59], v6 offset0:98 offset1:99
    ds_read2_b32 v[60:61], v6 offset0:112 offset1:113
    ds_read2_b32 v[62:63], v6 offset0:114 offset1:115
    ds_read2_b32 v[64:65], v6 offset0:128 offset1:129
    ds_read2_b32 v[66:67], v6 offset0:130 offset1:131
    ds_read2_b32 v[68:69], v6 offset0:144 offset1:145
    ds_read2_b32 v[70:71], v6 offset0:146 offset1:147
    ds_read2_b32 v[72:73], v6 offset0:160 offset1:161
    ds_read2_b32 v[74:75], v6 offset0:162 offset1:163
    ds_read2_b32 v[76:77], v6 offset0:176 offset1:177
    ds_read2_b32 v[78:79], v6 offset0:178 offset1:179
    ds_read2_b32 v[80:81], v6 offset0:192 offset1:193
    ds_read2_b32 v[82:83], v6 offset0:194 offset1:195
    ds_read2_b32 v[84:85], v6 offset0:208 offset1:209
    ds_read2_b32 v[86:87], v6 offset0:210 offset1:211
    ds_read2_b32 v[88:89], v6 offset0:224 offset1:225
    ds_read2_b32 v[90:91], v6 offset0:226 offset1:227
    ds_read2_b32 v[92:93], v6 offset0:240 offset1:241
    ds_read2_b32 v[94:95], v6 offset0:242 offset1:243
    ds_read2_b32 v[96:97], v7 offset0:96 offset1:97
    ds_read2_b32 v[98:99], v7 offset0:98 offset1:99
    ds_read2_b32 v[100:101], v11 offset0:32 offset1:33
    ds_read2_b32 v[102:103], v11 offset0:34 offset1:35
    ds_read2_b32 v[104:105], v11 offset0:96 offset1:97
    ds_read2_b32 v[106:107], v11 offset0:98 offset1:99
    v_lshlrev_b32 v18, 3, v3
    v_sub_u32 v18, v8, v18
    v_lshrrev_b32 v19, 2, v2
    v_lshl_add_u32 v19, v19, 2, v3
    v_and_b32 v28, 3, v2
    v_lshlrev_b32 v28, 4, v28
    v_mul_u32_u24 v19, s8, v19
    v_xor_b32 v19, s10, v19
    s_waitcnt lgkmcnt(0)
    v_mov_b32 v7, v18
    v_add_u32 v6, v19, v28
    v_xor_b32 v12, s9, v12
W_34:
    ds_read_b32 v18, v4 offset:16
    s_sub_u32 s39, s39, 1
    s_cbranch_scc1 KS_ABORT
    s_waitcnt lgkmcnt(0)
    v_cmp_ne_u32 vcc, s84, v18
    s_cbranch_vccnz W_34
    s_setprio 1
    ds_read_b128 v[108:111], v8 offset:448
    ds_read_b128 v[112:115], v8 offset:512
    ds_read_b128 v[116:119], v8 offset:576
    ds_read_b128 v[120:123], v8 offset:640
    ds_read_b128 v[124:127], v8 offset:704
    s_waitcnt lgkmcnt(4)
    v_mfma_f32_16x16x32_f16 v[20:23], v[32:35], v[108:111], 0
    ds_read_b128 v[108:111], v8 offset:768
    s_waitcnt lgkmcnt(4)
    v_mfma_f32_16x16x32_f16 v[20:23], v[36:39], v[112:115], v[20:23]
    ds_read_b128 v[112:115], v8 offset:832
    s_waitcnt lgkmcnt(4)
    v_mfma_f32_16x16x32_f16 v[20:23], v[40:43], v[116:119], v[20:23]
    ds_read_b128 v[116:119], v8 offset:896
    ds_read_b64 v[28:29], v7 offset:1504
    ds_read_b64 v[30:31], v7 offset:2016
    s_waitcnt lgkmcnt(6)
    v_mfma_f32_16x16x32_f16 v[20:23], v[44:47], v[120:123], v[20:23]
    ds_read_b128 v[120:123], v8 offset:960
    s_waitcnt lgkmcnt(6)
    v_mfma_f32_16x16x32_f16 v[20:23], v[48:51], v[124:127], v[20:23]
    ds_read_b128 v[124:127], v8 offset:1024
    s_waitcnt lgkmcnt(6)
    v_mfma_f32_16x16x32_f16 v[20:23], v[52:55], v[108:111], v[20:23]
    ds_read_b128 v[108:111], v8 offset:1088
    s_waitcnt lgkmcnt(6)
    v_mfma_f32_16x16x32_f16 v[20:23], v[56:59], v[112:115], v[20:23]
    s_waitcnt lgkmcnt(5)
    v_mfma_f32_16x16x32_f16 v[20:23], v[60:63], v[116:119], v[20:23]
    ds_read_b128 v[112:115], v8 offset:1152
    s_waitcnt lgkmcnt(3)
    v_mfma_f32_16x16x32_f16 v[20:23], v[64:67], v[120:123], v[20:23]
    v_mfma_f32_16x16x32_f16 v[24:27], v[32:35], v[120:123], 0
    ds_read_b128 v[116:119], v8 offset:1216
    v_fma_mix_f32 v120, v28, v17, 0 op_sel_hi:[1,0,0]
    v_fma_mix_f32 v121, v28, v17, 0 op_sel:[1,0,0] op_sel_hi:[1,0,0]
    s_waitcnt lgkmcnt(3)
    v_mfma_f32_16x16x32_f16 v[20:23], v[68:71], v[124:127], v[20:23]
    v_fma_mix_f32 v122, v29, v17, 0 op_sel_hi:[1,0,0]
    v_fma_mix_f32 v123, v29, v17, 0 op_sel:[1,0,0] op_sel_hi:[1,0,0]
    v_mfma_f32_16x16x32_f16 v[24:27], v[36:39], v[124:127], v[24:27]
    ds_read_b128 v[32:35], v8 offset:1280
    v_cvt_pk_bf16_f32 v28, v120, v121
    v_cvt_pk_bf16_f32 v29, v122, v123
    s_waitcnt lgkmcnt(3)
    v_mfma_f32_16x16x32_f16 v[20:23], v[72:75], v[108:111], v[20:23]
    v_lshlrev_b32 v120, 16, v28
    v_and_b32 v121, 0xffff0000, v28
    v_mfma_f32_16x16x32_f16 v[24:27], v[40:43], v[108:111], v[24:27]
    ds_read_b128 v[36:39], v8 offset:1344
    v_lshlrev_b32 v122, 16, v29
    v_and_b32 v123, 0xffff0000, v29
    s_waitcnt lgkmcnt(3)
    v_mfma_f32_16x16x32_f16 v[20:23], v[76:79], v[112:115], v[20:23]
    v_fma_mix_f32 v108, v30, v17, 0 op_sel_hi:[1,0,0]
    v_fma_mix_f32 v109, v30, v17, 0 op_sel:[1,0,0] op_sel_hi:[1,0,0]
    v_mfma_f32_16x16x32_f16 v[24:27], v[44:47], v[112:115], v[24:27]
    ds_read_b128 v[124:127], v8 offset:1408
    v_fma_mix_f32 v110, v31, v17, 0 op_sel_hi:[1,0,0]
    v_fma_mix_f32 v111, v31, v17, 0 op_sel:[1,0,0] op_sel_hi:[1,0,0]
    s_waitcnt lgkmcnt(3)
    v_mfma_f32_16x16x32_f16 v[20:23], v[80:83], v[116:119], v[20:23]
    v_cvt_pk_bf16_f32 v30, v108, v109
    v_cvt_pk_bf16_f32 v31, v110, v111
    v_mfma_f32_16x16x32_f16 v[24:27], v[48:51], v[116:119], v[24:27]
    ds_read_b128 v[40:43], v8 offset:1472
    v_lshlrev_b32 v108, 16, v30
    v_and_b32 v109, 0xffff0000, v30
    s_waitcnt lgkmcnt(3)
    v_mfma_f32_16x16x32_f16 v[20:23], v[84:87], v[32:35], v[20:23]
    v_lshlrev_b32 v110, 16, v31
    v_and_b32 v111, 0xffff0000, v31
    v_mfma_f32_16x16x32_f16 v[24:27], v[52:55], v[32:35], v[24:27]
    ds_read_b128 v[44:47], v8 offset:1536
    s_waitcnt lgkmcnt(3)
    v_mfma_f32_16x16x32_f16 v[20:23], v[88:91], v[36:39], v[20:23]
    ds_read_b128 v[112:115], v8 offset:1600
    v_mfma_f32_16x16x32_f16 v[24:27], v[56:59], v[36:39], v[24:27]
    ds_read_b128 v[48:51], v8 offset:1664
    s_waitcnt lgkmcnt(4)
    v_mfma_f32_16x16x32_f16 v[20:23], v[92:95], v[124:127], v[20:23]
    ds_read_b128 v[116:119], v8 offset:1728
    v_mfma_f32_16x16x32_f16 v[24:27], v[60:63], v[124:127], v[24:27]
    ds_read_b128 v[52:55], v8 offset:1792
    s_waitcnt lgkmcnt(5)
    v_mfma_f32_16x16x32_f16 v[20:23], v[96:99], v[40:43], v[20:23]
    ds_read_b128 v[32:35], v8 offset:1856
    v_mfma_f32_16x16x32_f16 v[24:27], v[64:67], v[40:43], v[24:27]
    ds_read_b32 v18, v14 offset:76
    ds_read_b128 v[56:59], v8 offset:1920
    s_waitcnt lgkmcnt(7)
    v_mfma_f32_16x16x32_f16 v[24:27], v[68:71], v[44:47], v[24:27]
    ds_read_b128 v[36:39], v8 offset:1984
    s_waitcnt lgkmcnt(7)
    v_mfma_f32_16x16x32_f16 v[24:27], v[72:75], v[112:115], v[24:27]
    ds_read2_b32 v[60:61], v11 offset0:16 offset1:17
    ds_read2_b32 v[62:63], v11 offset0:18 offset1:19
    s_waitcnt lgkmcnt(8)
    v_mfma_f32_16x16x32_f16 v[24:27], v[76:79], v[48:51], v[24:27]
    s_waitcnt lgkmcnt(4)
    v_cmp_ne_u32 vcc, s84, v18
    s_cbranch_vccnz WS_35
WB_36:
    ds_read_b64_tr_b16 v[124:125], v9 offset:0
    ds_read_b64_tr_b16 v[126:127], v9 offset:64
    ds_read_b64_tr_b16 v[64:65], v9 offset:3088
    ds_read_b64_tr_b16 v[66:67], v9 offset:3152
    v_mfma_f32_16x16x32_f16 v[24:27], v[80:83], v[116:119], v[24:27]
    v_mfma_f32_16x16x32_f16 v[24:27], v[84:87], v[52:55], v[24:27]
    ds_read_b64_tr_b16 v[40:41], v9 offset:512
    ds_read_b64_tr_b16 v[42:43], v9 offset:576
    ds_read2_b32 v[68:69], v11 offset0:80 offset1:81
    ds_read2_b32 v[70:71], v11 offset0:82 offset1:83
    v_mfma_f32_16x16x32_f16 v[24:27], v[88:91], v[32:35], v[24:27]
    s_waitcnt lgkmcnt(11)
    v_mfma_f32_16x16x32_f16 v[24:27], v[92:95], v[56:59], v[24:27]
    ds_read_b64_tr_b16 v[44:45], v9 offset:3600
    ds_read_b64_tr_b16 v[46:47], v9 offset:3664
    s_waitcnt lgkmcnt(12)
    v_mfma_f32_16x16x32_f16 v[24:27], v[96:99], v[36:39], v[24:27]
    s_waitcnt lgkmcnt(8)
    v_mfma_f32_16x16x32_f16 v[20:23], v[124:127], v[100:103], v[20:23]
    s_waitcnt lgkmcnt(6)
    v_mfma_f32_16x16x32_f16 v[20:23], v[64:67], v[104:107], v[20:23]
    v_mfma_f32_16x16x32_f16 v[24:27], v[124:127], v[60:63], v[24:27]
    s_waitcnt lgkmcnt(4)
    v_mfma_f32_16x16x32_f16 v[24:27], v[40:43], v[100:103], v[24:27]
    s_nop 4
    v_mul_f32 v20, v20, v16
    v_mul_f32 v21, v21, v16
    s_waitcnt lgkmcnt(2)
    v_mfma_f32_16x16x32_f16 v[24:27], v[64:67], v[68:71], v[24:27]
    v_mul_f32 v22, v22, v16
    v_mul_f32 v23, v23, v16
    s_waitcnt lgkmcnt(0)
    v_mfma_f32_16x16x32_f16 v[24:27], v[44:47], v[104:107], v[24:27]
    v_cvt_pk_bf16_f32 v28, v20, v21
    v_cvt_pk_bf16_f32 v29, v22, v23
    v_lshlrev_b32 v20, 16, v28
    v_and_b32 v21, 0xffff0000, v28
    v_lshlrev_b32 v22, 16, v29
    v_and_b32 v23, 0xffff0000, v29
    v_add_f32 v20, v20, v120
    v_add_f32 v21, v21, v121
    v_add_f32 v22, v22, v122
    v_add_f32 v23, v23, v123
    v_cvt_pk_bf16_f32 v28, v20, v21
    v_cvt_pk_bf16_f32 v29, v22, v23
    v_min_u32 v28, -2, v28
    v_min_u32 v29, -2, v29
    ds_read_u8 v18, v4 offset:161
    ds_read_b128 v[20:23], v12 offset:47616
    v_mul_f32 v24, v24, v16
    v_mul_f32 v25, v25, v16
    v_mul_f32 v26, v26, v16
    v_mul_f32 v27, v27, v16
    v_cvt_pk_bf16_f32 v30, v24, v25
    v_cvt_pk_bf16_f32 v31, v26, v27
    v_lshlrev_b32 v24, 16, v30
    v_and_b32 v25, 0xffff0000, v30
    v_lshlrev_b32 v26, 16, v31
    v_and_b32 v27, 0xffff0000, v31
    v_add_f32 v24, v24, v108
    v_add_f32 v25, v25, v109
    v_add_f32 v26, v26, v110
    v_add_f32 v27, v27, v111
    v_cvt_pk_bf16_f32 v30, v24, v25
    v_cvt_pk_bf16_f32 v31, v26, v27
    v_min_u32 v30, -2, v30
    v_min_u32 v31, -2, v31
    s_branch CVE_32
CV_30:
    ds_read2_b32 v[32:33], v7 offset0:128 offset1:129
    ds_read2_b32 v[34:35], v7 offset0:130 offset1:131
    ds_read2_b32 v[36:37], v6 offset0:0 offset1:1
    ds_read2_b32 v[38:39], v6 offset0:2 offset1:3
    ds_read2_b32 v[40:41], v6 offset0:16 offset1:17
    ds_read2_b32 v[42:43], v6 offset0:18 offset1:19
    ds_read2_b32 v[44:45], v6 offset0:32 offset1:33
    ds_read2_b32 v[46:47], v6 offset0:34 offset1:35
    ds_read2_b32 v[48:49], v6 offset0:48 offset1:49
    ds_read2_b32 v[50:51], v6 offset0:50 offset1:51
    ds_read2_b32 v[52:53], v6 offset0:64 offset1:65
    ds_read2_b32 v[54:55], v6 offset0:66 offset1:67
    ds_read2_b32 v[56:57], v6 offset0:80 offset1:81
    ds_read2_b32 v[58:59], v6 offset0:82 offset1:83
    ds_read2_b32 v[60:61], v6 offset0:96 offset1:97
    ds_read2_b32 v[62:63], v6 offset0:98 offset1:99
    ds_read2_b32 v[64:65], v6 offset0:112 offset1:113
    ds_read2_b32 v[66:67], v6 offset0:114 offset1:115
    ds_read2_b32 v[68:69], v6 offset0:128 offset1:129
    ds_read2_b32 v[70:71], v6 offset0:130 offset1:131
    ds_read2_b32 v[72:73], v6 offset0:144 offset1:145
    ds_read2_b32 v[74:75], v6 offset0:146 offset1:147
    ds_read2_b32 v[76:77], v6 offset0:160 offset1:161
    ds_read2_b32 v[78:79], v6 offset0:162 offset1:163
    ds_read2_b32 v[80:81], v6 offset0:176 offset1:177
    ds_read2_b32 v[82:83], v6 offset0:178 offset1:179
    ds_read2_b32 v[84:85], v6 offset0:192 offset1:193
    ds_read2_b32 v[86:87], v6 offset0:194 offset1:195
    ds_read2_b32 v[88:89], v6 offset0:208 offset1:209
    ds_read2_b32 v[90:91], v6 offset0:210 offset1:211
    ds_read2_b32 v[92:93], v6 offset0:224 offset1:225
    ds_read2_b32 v[94:95], v6 offset0:226 offset1:227
    ds_read2_b32 v[96:97], v6 offset0:240 offset1:241
    ds_read2_b32 v[98:99], v6 offset0:242 offset1:243
    ds_read2_b32 v[100:101], v7 offset0:96 offset1:97
    ds_read2_b32 v[102:103], v7 offset0:98 offset1:99
    ds_read2_b32 v[104:105], v11 offset0:0 offset1:1
    ds_read2_b32 v[106:107], v11 offset0:2 offset1:3
    v_lshlrev_b32 v18, 3, v3
    v_sub_u32 v18, v8, v18
    v_lshrrev_b32 v19, 2, v2
    v_lshl_add_u32 v19, v19, 2, v3
    v_and_b32 v28, 3, v2
    v_lshlrev_b32 v28, 4, v28
    v_mul_u32_u24 v19, s8, v19
    v_xor_b32 v19, s10, v19
    s_waitcnt lgkmcnt(0)
    v_mov_b32 v7, v18
    v_add_u32 v6, v19, v28
    v_xor_b32 v12, s9, v12
W_37:
    ds_read_b32 v18, v4 offset:16
    s_sub_u32 s39, s39, 1
    s_cbranch_scc1 KS_ABORT
    s_waitcnt lgkmcnt(0)
    v_cmp_ne_u32 vcc, s84, v18
    s_cbranch_vccnz W_37
    s_setprio 1
    ds_read_b128 v[108:111], v8 offset:448
    ds_read_b128 v[112:115], v8 offset:960
    ds_read_b128 v[116:119], v8 offset:1472
    ds_read_b128 v[120:123], v8 offset:1536
    ds_read_b128 v[124:127], v8 offset:1600
    s_waitcnt lgkmcnt(4)
    v_mfma_f32_16x16x32_f16 v[20:23], v[32:35], v[108:111], 0
    ds_read_b128 v[108:111], v8 offset:1664
    s_waitcnt lgkmcnt(4)
    v_mfma_f32_16x16x32_f16 v[24:27], v[32:35], v[112:115], 0
    ds_read_b128 v[32:35], v8 offset:1728
    ds_read_b128 v[112:115], v8 offset:1792
    s_waitcnt lgkmcnt(5)
    v_mfma_f32_16x16x32_f16 v[20:23], v[36:39], v[116:119], v[20:23]
    ds_read_b128 v[116:119], v8 offset:1856
    ds_read_b64 v[28:29], v7 offset:2528
    ds_read_b64 v[30:31], v7 offset:3040
    s_waitcnt lgkmcnt(7)
    v_mfma_f32_16x16x32_f16 v[20:23], v[40:43], v[120:123], v[20:23]
    ds_read_b128 v[120:123], v8 offset:1920
    s_waitcnt lgkmcnt(7)
    v_mfma_f32_16x16x32_f16 v[20:23], v[44:47], v[124:127], v[20:23]
    ds_read_b128 v[124:127], v8 offset:1984
    s_waitcnt lgkmcnt(7)
    v_mfma_f32_16x16x32_f16 v[20:23], v[48:51], v[108:111], v[20:23]
    ds_read_b128 v[108:111], v8 offset:2048
    s_waitcnt lgkmcnt(7)
    v_mfma_f32_16x16x32_f16 v[20:23], v[52:55], v[32:35], v[20:23]
    s_waitcnt lgkmcnt(6)
    v_mfma_f32_16x16x32_f16 v[20:23], v[56:59], v[112:115], v[20:23]
    ds_read_b128 v[32:35], v8 offset:2112
    s_waitcnt lgkmcnt(6)
    v_mfma_f32_16x16x32_f16 v[20:23], v[60:63], v[116:119], v[20:23]
    s_waitcnt lgkmcnt(4)
    v_fma_mix_f32 v116, v28, v17, 0 op_sel_hi:[1,0,0]
    v_fma_mix_f32 v117, v28, v17, 0 op_sel:[1,0,0] op_sel_hi:[1,0,0]
    s_waitcnt lgkmcnt(3)
    v_mfma_f32_16x16x32_f16 v[20:23], v[64:67], v[120:123], v[20:23]
    ds_read_b128 v[112:115], v8 offset:2176
    v_fma_mix_f32 v118, v29, v17, 0 op_sel_hi:[1,0,0]
    v_fma_mix_f32 v119, v29, v17, 0 op_sel:[1,0,0] op_sel_hi:[1,0,0]
    s_waitcnt lgkmcnt(3)
    v_mfma_f32_16x16x32_f16 v[20:23], v[68:71], v[124:127], v[20:23]
    v_cvt_pk_bf16_f32 v28, v116, v117
    v_cvt_pk_bf16_f32 v29, v118, v119
    v_mfma_f32_16x16x32_f16 v[24:27], v[36:39], v[124:127], v[24:27]
    ds_read_b128 v[120:123], v8 offset:2240
    v_lshlrev_b32 v116, 16, v28
    v_and_b32 v117, 0xffff0000, v28
    s_waitcnt lgkmcnt(3)
    v_mfma_f32_16x16x32_f16 v[20:23], v[72:75], v[108:111], v[20:23]
    v_lshlrev_b32 v118, 16, v29
    v_and_b32 v119, 0xffff0000, v29
    v_mfma_f32_16x16x32_f16 v[24:27], v[40:43], v[108:111], v[24:27]
    ds_read_b128 v[36:39], v8 offset:2304
    v_fma_mix_f32 v108, v30, v17, 0 op_sel_hi:[1,0,0]
    v_fma_mix_f32 v109, v30, v17, 0 op_sel:[1,0,0] op_sel_hi:[1,0,0]
    s_waitcnt lgkmcnt(3)
    v_mfma_f32_16x16x32_f16 v[20:23], v[76:79], v[32:35], v[20:23]
    v_fma_mix_f32 v110, v31, v17, 0 op_sel_hi:[1,0,0]
    v_fma_mix_f32 v111, v31, v17, 0 op_sel:[1,0,0] op_sel_hi:[1,0,0]
    v_mfma_f32_16x16x32_f16 v[24:27], v[44:47], v[32:35], v[24:27]
    ds_read_b128 v[124:127], v8 offset:2368
    v_cvt_pk_bf16_f32 v30, v108, v109
    v_cvt_pk_bf16_f32 v31, v110, v111
    s_waitcnt lgkmcnt(3)
    v_mfma_f32_16x16x32_f16 v[20:23], v[80:83], v[112:115], v[20:23]
    v_lshlrev_b32 v108, 16, v30
    v_and_b32 v109, 0xffff0000, v30
    v_mfma_f32_16x16x32_f16 v[24:27], v[48:51], v[112:115], v[24:27]
    ds_read_b128 v[40:43], v8 offset:2432
    v_lshlrev_b32 v110, 16, v31
    v_and_b32 v111, 0xffff0000, v31
    s_waitcnt lgkmcnt(3)
    v_mfma_f32_16x16x32_f16 v[20:23], v[84:87], v[120:123], v[20:23]
    v_mfma_f32_16x16x32_f16 v[24:27], v[52:55], v[120:123], v[24:27]
    ds_read_b128 v[44:47], v8 offset:2496
    s_waitcnt lgkmcnt(3)
    v_mfma_f32_16x16x32_f16 v[20:23], v[88:91], v[36:39], v[20:23]
    v_mfma_f32_16x16x32_f16 v[24:27], v[56:59], v[36:39], v[24:27]
    ds_read_b128 v[32:35], v8 offset:2560
    s_waitcnt lgkmcnt(3)
    v_mfma_f32_16x16x32_f16 v[20:23], v[92:95], v[124:127], v[20:23]
    ds_read_b128 v[48:51], v8 offset:2624
    v_mfma_f32_16x16x32_f16 v[24:27], v[60:63], v[124:127], v[24:27]
    ds_read_b128 v[112:115], v8 offset:2688
    s_waitcnt lgkmcnt(4)
    v_mfma_f32_16x16x32_f16 v[20:23], v[96:99], v[40:43], v[20:23]
    ds_read_b128 v[52:55], v8 offset:2752
    v_mfma_f32_16x16x32_f16 v[24:27], v[64:67], v[40:43], v[24:27]
    ds_read_b128 v[120:123], v8 offset:2816
    s_waitcnt lgkmcnt(5)
    v_mfma_f32_16x16x32_f16 v[20:23], v[100:103], v[44:47], v[20:23]
    ds_read_b128 v[56:59], v8 offset:2880
    v_mfma_f32_16x16x32_f16 v[24:27], v[68:71], v[44:47], v[24:27]
    ds_read_b32 v18, v14 offset:76
    ds_read_b128 v[36:39], v8 offset:2944
    s_waitcnt lgkmcnt(7)
    v_mfma_f32_16x16x32_f16 v[24:27], v[72:75], v[32:35], v[24:27]
    ds_read_b128 v[60:63], v8 offset:3008
    s_waitcnt lgkmcnt(7)
    v_mfma_f32_16x16x32_f16 v[24:27], v[76:79], v[48:51], v[24:27]
    ds_read2_b32 v[124:125], v11 offset0:16 offset1:17
    ds_read2_b32 v[126:127], v11 offset0:18 offset1:19
    ds_read2_b32 v[64:65], v11 offset0:32 offset1:33
    ds_read2_b32 v[66:67], v11 offset0:34 offset1:35
    s_waitcnt lgkmcnt(10)
    v_mfma_f32_16x16x32_f16 v[24:27], v[80:83], v[112:115], v[24:27]
    s_waitcnt lgkmcnt(6)
    v_cmp_ne_u32 vcc, s84, v18
    s_cbranch_vccnz WS_38
WB_39:
    ds_read_b64_tr_b16 v[40:41], v9 offset:0
    ds_read_b64_tr_b16 v[42:43], v9 offset:64
    ds_read_b64_tr_b16 v[68:69], v9 offset:512
    ds_read_b64_tr_b16 v[70:71], v9 offset:576
    v_mfma_f32_16x16x32_f16 v[24:27], v[84:87], v[52:55], v[24:27]
    ds_read_b64_tr_b16 v[44:45], v9 offset:1024
    ds_read_b64_tr_b16 v[46:47], v9 offset:1088
    v_mfma_f32_16x16x32_f16 v[24:27], v[88:91], v[120:123], v[24:27]
    ds_read_b64_tr_b16 v[72:73], v9 offset:3088
    ds_read_b64_tr_b16 v[74:75], v9 offset:3152
    ds_read2_b32 v[32:33], v11 offset0:64 offset1:65
    ds_read2_b32 v[34:35], v11 offset0:66 offset1:67
    v_mfma_f32_16x16x32_f16 v[24:27], v[92:95], v[56:59], v[24:27]
    ds_read_b64_tr_b16 v[76:77], v9 offset:3600
    ds_read_b64_tr_b16 v[78:79], v9 offset:3664
    ds_read2_b32 v[48:49], v11 offset0:80 offset1:81
    ds_read2_b32 v[50:51], v11 offset0:82 offset1:83
    v_mfma_f32_16x16x32_f16 v[24:27], v[96:99], v[36:39], v[24:27]
    ds_read_b64_tr_b16 v[80:81], v9 offset:4112
    ds_read_b64_tr_b16 v[82:83], v9 offset:4176
    ds_read2_b32 v[112:113], v11 offset0:96 offset1:97
    ds_read2_b32 v[114:115], v11 offset0:98 offset1:99
    v_mfma_f32_16x16x32_f16 v[24:27], v[100:103], v[60:63], v[24:27]
    ds_read_b64_tr_b16 v[84:85], v10 offset:6176
    ds_read_b64_tr_b16 v[86:87], v10 offset:6304
    ds_read2_b32 v[52:53], v13 offset0:24 offset1:25
    ds_read2_b32 v[54:55], v13 offset0:26 offset1:27
    v_mfma_f32_16x16x32_f16 v[20:23], v[40:43], v[104:107], v[20:23]
    ds_read_b64_tr_b16 v[88:89], v10 offset:8224
    ds_read_b64_tr_b16 v[90:91], v10 offset:8352
    ds_read2_b32 v[120:121], v13 offset0:120 offset1:121
    ds_read2_b32 v[122:123], v13 offset0:122 offset1:123
    v_mfma_f32_16x16x32_f16 v[20:23], v[68:71], v[124:127], v[20:23]
    v_mfma_f32_16x16x32_f16 v[20:23], v[44:47], v[64:67], v[20:23]
    v_mfma_f32_16x16x32_f16 v[20:23], v[72:75], v[32:35], v[20:23]
    ds_read_b64_tr_b16 v[92:93], v9 offset:1536
    ds_read_b64_tr_b16 v[94:95], v9 offset:1600
    s_waitcnt lgkmcnt(14)
    v_mfma_f32_16x16x32_f16 v[20:23], v[76:79], v[48:51], v[20:23]
    s_waitcnt lgkmcnt(10)
    v_mfma_f32_16x16x32_f16 v[20:23], v[80:83], v[112:115], v[20:23]
    s_waitcnt lgkmcnt(6)
    v_mfma_f32_16x16x32_f16 v[20:23], v[84:87], v[52:55], v[20:23]
    ds_read_b64_tr_b16 v[56:57], v9 offset:4624
    ds_read_b64_tr_b16 v[58:59], v9 offset:4688
    ds_read2_b32 v[96:97], v13 offset0:16 offset1:17
    ds_read2_b32 v[98:99], v13 offset0:18 offset1:19
    s_waitcnt lgkmcnt(6)
    v_mfma_f32_16x16x32_f16 v[20:23], v[88:91], v[120:123], v[20:23]
    ds_read2_b32 v[36:37], v13 offset0:112 offset1:113
    ds_read2_b32 v[38:39], v13 offset0:114 offset1:115
    v_mfma_f32_16x16x32_f16 v[24:27], v[68:71], v[104:107], v[24:27]
    v_mfma_f32_16x16x32_f16 v[24:27], v[44:47], v[124:127], v[24:27]
    s_nop 3
    v_mul_f32 v20, v20, v16
    v_mul_f32 v21, v21, v16
    s_waitcnt lgkmcnt(6)
    v_mfma_f32_16x16x32_f16 v[24:27], v[92:95], v[64:67], v[24:27]
    v_mul_f32 v22, v22, v16
    v_mul_f32 v23, v23, v16
    v_mfma_f32_16x16x32_f16 v[24:27], v[76:79], v[32:35], v[24:27]
    v_cvt_pk_bf16_f32 v28, v20, v21
    v_cvt_pk_bf16_f32 v29, v22, v23
    v_mfma_f32_16x16x32_f16 v[24:27], v[80:83], v[48:51], v[24:27]
    v_lshlrev_b32 v20, 16, v28
    v_and_b32 v21, 0xffff0000, v28
    s_waitcnt lgkmcnt(4)
    v_mfma_f32_16x16x32_f16 v[24:27], v[56:59], v[112:115], v[24:27]
    v_lshlrev_b32 v22, 16, v29
    v_and_b32 v23, 0xffff0000, v29
    s_waitcnt lgkmcnt(2)
    v_mfma_f32_16x16x32_f16 v[24:27], v[84:87], v[96:99], v[24:27]
    v_add_f32 v20, v20, v116
    v_add_f32 v21, v21, v117
    s_waitcnt lgkmcnt(0)
    v_mfma_f32_16x16x32_f16 v[24:27], v[88:91], v[36:39], v[24:27]
    v_add_f32 v22, v22, v118
    v_add_f32 v23, v23, v119
    v_cvt_pk_bf16_f32 v28, v20, v21
    v_cvt_pk_bf16_f32 v29, v22, v23
    v_min_u32 v28, -2, v28
    v_min_u32 v29, -2, v29
    ds_read_u8 v18, v4 offset:162
    ds_read_b128 v[20:23], v12 offset:48640
    v_mul_f32 v24, v24, v16
    v_mul_f32 v25, v25, v16
    v_mul_f32 v26, v26, v16
    v_mul_f32 v27, v27, v16
    v_cvt_pk_bf16_f32 v30, v24, v25
    v_cvt_pk_bf16_f32 v31, v26, v27
    v_lshlrev_b32 v24, 16, v30
    v_and_b32 v25, 0xffff0000, v30
    v_lshlrev_b32 v26, 16, v31
    v_and_b32 v27, 0xffff0000, v31
    v_add_f32 v24, v24, v108
    v_add_f32 v25, v25, v109
    v_add_f32 v26, v26, v110
    v_add_f32 v27, v27, v111
    v_cvt_pk_bf16_f32 v30, v24, v25
    v_cvt_pk_bf16_f32 v31, v26, v27
    v_min_u32 v30, -2, v30
    v_min_u32 v31, -2, v31
    s_branch CVE_32
CV_31:
    ds_read2_b32 v[32:33], v7 offset0:128 offset1:129
    ds_read2_b32 v[34:35], v7 offset0:130 offset1:131
    ds_read2_b32 v[36:37], v6 offset0:0 offset1:1
    ds_read2_b32 v[38:39], v6 offset0:2 offset1:3
    ds_read2_b32 v[40:41], v6 offset0:16 offset1:17
    ds_read2_b32 v[42:43], v6 offset0:18 offset1:19
    ds_read2_b32 v[44:45], v6 offset0:32 offset1:33
    ds_read2_b32 v[46:47], v6 offset0:34 offset1:35
    ds_read2_b32 v[48:49], v6 offset0:48 offset1:49
    ds_read2_b32 v[50:51], v6 offset0:50 offset1:51
    ds_read2_b32 v[52:53], v6 offset0:64 offset1:65
    ds_read2_b32 v[54:55], v6 offset0:66 offset1:67
    ds_read2_b32 v[56:57], v6 offset0:80 offset1:81
    ds_read2_b32 v[58:59], v6 offset0:82 offset1:83
    ds_read2_b32 v[60:61], v6 offset0:96 offset1:97
    ds_read2_b32 v[62:63], v6 offset0:98 offset1:99
    ds_read2_b32 v[64:65], v6 offset0:112 offset1:113
    ds_read2_b32 v[66:67], v6 offset0:114 offset1:115
    ds_read2_b32 v[68:69], v6 offset0:128 offset1:129
    ds_read2_b32 v[70:71], v6 offset0:130 offset1:131
    ds_read2_b32 v[72:73], v6 offset0:144 offset1:145
    ds_read2_b32 v[74:75], v6 offset0:146 offset1:147
    ds_read2_b32 v[76:77], v6 offset0:160 offset1:161
    ds_read2_b32 v[78:79], v6 offset0:162 offset1:163
    ds_read2_b32 v[80:81], v6 offset0:176 offset1:177
    ds_read2_b32 v[82:83], v6 offset0:178 offset1:179
    ds_read2_b32 v[84:85], v6 offset0:192 offset1:193
    ds_read2_b32 v[86:87], v6 offset0:194 offset1:195
    ds_read2_b32 v[88:89], v6 offset0:208 offset1:209
    ds_read2_b32 v[90:91], v6 offset0:210 offset1:211
    ds_read2_b32 v[92:93], v6 offset0:224 offset1:225
    ds_read2_b32 v[94:95], v6 offset0:226 offset1:227
    ds_read2_b32 v[96:97], v6 offset0:240 offset1:241
    ds_read2_b32 v[98:99], v6 offset0:242 offset1:243
    ds_read2_b32 v[100:101], v7 offset0:96 offset1:97
    ds_read2_b32 v[102:103], v7 offset0:98 offset1:99
    ds_read2_b32 v[104:105], v11 offset0:0 offset1:1
    ds_read2_b32 v[106:107], v11 offset0:2 offset1:3
    v_lshlrev_b32 v18, 3, v3
    v_sub_u32 v18, v8, v18
    v_lshrrev_b32 v19, 2, v2
    v_lshl_add_u32 v19, v19, 2, v3
    v_and_b32 v28, 3, v2
    v_lshlrev_b32 v28, 4, v28
    v_mul_u32_u24 v19, s8, v19
    v_xor_b32 v19, s10, v19
    s_waitcnt lgkmcnt(0)
    v_mov_b32 v7, v18
    v_add_u32 v6, v19, v28
    v_xor_b32 v12, s9, v12
W_40:
    ds_read_b32 v18, v4 offset:16
    s_sub_u32 s39, s39, 1
    s_cbranch_scc1 KS_ABORT
    s_waitcnt lgkmcnt(0)
    v_cmp_ne_u32 vcc, s84, v18
    s_cbranch_vccnz W_40
    s_setprio 1
    ds_read_b128 v[108:111], v8 offset:1472
    ds_read_b128 v[112:115], v8 offset:1984
    ds_read_b128 v[116:119], v8 offset:2496
    ds_read_b128 v[120:123], v8 offset:2560
    ds_read_b128 v[124:127], v8 offset:2624
    s_waitcnt lgkmcnt(4)
    v_mfma_f32_16x16x32_f16 v[20:23], v[32:35], v[108:111], 0
    ds_read_b128 v[108:111], v8 offset:2688
    s_waitcnt lgkmcnt(4)
    v_mfma_f32_16x16x32_f16 v[24:27], v[32:35], v[112:115], 0
    ds_read_b128 v[32:35], v8 offset:2752
    ds_read_b128 v[112:115], v8 offset:2816
    s_waitcnt lgkmcnt(5)
    v_mfma_f32_16x16x32_f16 v[20:23], v[36:39], v[116:119], v[20:23]
    ds_read_b128 v[116:119], v8 offset:2880
    ds_read_b64 v[28:29], v7 offset:3552
    ds_read_b64 v[30:31], v7 offset:4064
    s_waitcnt lgkmcnt(7)
    v_mfma_f32_16x16x32_f16 v[20:23], v[40:43], v[120:123], v[20:23]
    ds_read_b128 v[120:123], v8 offset:2944
    s_waitcnt lgkmcnt(7)
    v_mfma_f32_16x16x32_f16 v[20:23], v[44:47], v[124:127], v[20:23]
    ds_read_b128 v[124:127], v8 offset:3008
    s_waitcnt lgkmcnt(7)
    v_mfma_f32_16x16x32_f16 v[20:23], v[48:51], v[108:111], v[20:23]
    ds_read_b128 v[108:111], v8 offset:3072
    s_waitcnt lgkmcnt(7)
    v_mfma_f32_16x16x32_f16 v[20:23], v[52:55], v[32:35], v[20:23]
    s_waitcnt lgkmcnt(6)
    v_mfma_f32_16x16x32_f16 v[20:23], v[56:59], v[112:115], v[20:23]
    ds_read_b128 v[32:35], v8 offset:3136
    s_waitcnt lgkmcnt(6)
    v_mfma_f32_16x16x32_f16 v[20:23], v[60:63], v[116:119], v[20:23]
    s_waitcnt lgkmcnt(4)
    v_fma_mix_f32 v116, v28, v17, 0 op_sel_hi:[1,0,0]
    v_fma_mix_f32 v117, v28, v17, 0 op_sel:[1,0,0] op_sel_hi:[1,0,0]
    s_waitcnt lgkmcnt(3)
    v_mfma_f32_16x16x32_f16 v[20:23], v[64:67], v[120:123], v[20:23]
    ds_read_b128 v[112:115], v8 offset:3200
    v_fma_mix_f32 v118, v29, v17, 0 op_sel_hi:[1,0,0]
    v_fma_mix_f32 v119, v29, v17, 0 op_sel:[1,0,0] op_sel_hi:[1,0,0]
    s_waitcnt lgkmcnt(3)
    v_mfma_f32_16x16x32_f16 v[20:23], v[68:71], v[124:127], v[20:23]
    v_cvt_pk_bf16_f32 v28, v116, v117
    v_cvt_pk_bf16_f32 v29, v118, v119
    v_mfma_f32_16x16x32_f16 v[24:27], v[36:39], v[124:127], v[24:27]
    ds_read_b128 v[120:123], v8 offset:3264
    v_lshlrev_b32 v116, 16, v28
    v_and_b32 v117, 0xffff0000, v28
    s_waitcnt lgkmcnt(3)
    v_mfma_f32_16x16x32_f16 v[20:23], v[72:75], v[108:111], v[20:23]
    v_lshlrev_b32 v118, 16, v29
    v_and_b32 v119, 0xffff0000, v29
    v_mfma_f32_16x16x32_f16 v[24:27], v[40:43], v[108:111], v[24:27]
    ds_read_b128 v[36:39], v8 offset:3328
    v_fma_mix_f32 v108, v30, v17, 0 op_sel_hi:[1,0,0]
    v_fma_mix_f32 v109, v30, v17, 0 op_sel:[1,0,0] op_sel_hi:[1,0,0]
    s_waitcnt lgkmcnt(3)
    v_mfma_f32_16x16x32_f16 v[20:23], v[76:79], v[32:35], v[20:23]
    v_fma_mix_f32 v110, v31, v17, 0 op_sel_hi:[1,0,0]
    v_fma_mix_f32 v111, v31, v17, 0 op_sel:[1,0,0] op_sel_hi:[1,0,0]
    v_mfma_f32_16x16x32_f16 v[24:27], v[44:47], v[32:35], v[24:27]
    ds_read_b128 v[124:127], v8 offset:3392
    v_cvt_pk_bf16_f32 v30, v108, v109
    v_cvt_pk_bf16_f32 v31, v110, v111
    s_waitcnt lgkmcnt(3)
    v_mfma_f32_16x16x32_f16 v[20:23], v[80:83], v[112:115], v[20:23]
    v_lshlrev_b32 v108, 16, v30
    v_and_b32 v109, 0xffff0000, v30
    v_mfma_f32_16x16x32_f16 v[24:27], v[48:51], v[112:115], v[24:27]
    ds_read_b128 v[40:43], v8 offset:3456
    v_lshlrev_b32 v110, 16, v31
    v_and_b32 v111, 0xffff0000, v31
    s_waitcnt lgkmcnt(3)
    v_mfma_f32_16x16x32_f16 v[20:23], v[84:87], v[120:123], v[20:23]
    v_mfma_f32_16x16x32_f16 v[24:27], v[52:55], v[120:123], v[24:27]
    ds_read_b128 v[44:47], v8 offset:3520
    s_waitcnt lgkmcnt(3)
    v_mfma_f32_16x16x32_f16 v[20:23], v[88:91], v[36:39], v[20:23]
    v_mfma_f32_16x16x32_f16 v[24:27], v[56:59], v[36:39], v[24:27]
    ds_read_b128 v[32:35], v8 offset:3584
    s_waitcnt lgkmcnt(3)
    v_mfma_f32_16x16x32_f16 v[20:23], v[92:95], v[124:127], v[20:23]
    ds_read_b128 v[48:51], v8 offset:3648
    v_mfma_f32_16x16x32_f16 v[24:27], v[60:63], v[124:127], v[24:27]
    ds_read_b128 v[112:115], v8 offset:3712
    s_waitcnt lgkmcnt(4)
    v_mfma_f32_16x16x32_f16 v[20:23], v[96:99], v[40:43], v[20:23]
    ds_read_b128 v[52:55], v8 offset:3776
    v_mfma_f32_16x16x32_f16 v[24:27], v[64:67], v[40:43], v[24:27]
    ds_read_b128 v[120:123], v8 offset:3840
    s_waitcnt lgkmcnt(5)
    v_mfma_f32_16x16x32_f16 v[20:23], v[100:103], v[44:47], v[20:23]
    ds_read_b128 v[56:59], v8 offset:3904
    v_mfma_f32_16x16x32_f16 v[24:27], v[68:71], v[44:47], v[24:27]
    ds_read_b32 v18, v14 offset:76
    ds_read_b128 v[36:39], v8 offset:3968
    s_waitcnt lgkmcnt(7)
    v_mfma_f32_16x16x32_f16 v[24:27], v[72:75], v[32:35], v[24:27]
    ds_read_b128 v[60:63], v8 offset:4032
    s_waitcnt lgkmcnt(7)
    v_mfma_f32_16x16x32_f16 v[24:27], v[76:79], v[48:51], v[24:27]
    ds_read2_b32 v[124:125], v11 offset0:16 offset1:17
    ds_read2_b32 v[126:127], v11 offset0:18 offset1:19
    ds_read2_b32 v[64:65], v11 offset0:32 offset1:33
    ds_read2_b32 v[66:67], v11 offset0:34 offset1:35
    s_waitcnt lgkmcnt(10)
    v_mfma_f32_16x16x32_f16 v[24:27], v[80:83], v[112:115], v[24:27]
    s_waitcnt lgkmcnt(6)
    v_cmp_ne_u32 vcc, s84, v18
    s_cbranch_vccnz WS_41
WB_42:
    ds_read_b64_tr_b16 v[40:41], v9 offset:1024
    ds_read_b64_tr_b16 v[42:43], v9 offset:1088
    ds_read_b64_tr_b16 v[68:69], v9 offset:1536
    ds_read_b64_tr_b16 v[70:71], v9 offset:1600
    v_mfma_f32_16x16x32_f16 v[24:27], v[84:87], v[52:55], v[24:27]
    ds_read_b64_tr_b16 v[44:45], v9 offset:2048
    ds_read_b64_tr_b16 v[46:47], v9 offset:2112
    v_mfma_f32_16x16x32_f16 v[24:27], v[88:91], v[120:123], v[24:27]
    ds_read_b64_tr_b16 v[72:73], v9 offset:4112
    ds_read_b64_tr_b16 v[74:75], v9 offset:4176
    ds_read2_b32 v[32:33], v11 offset0:64 offset1:65
    ds_read2_b32 v[34:35], v11 offset0:66 offset1:67
    v_mfma_f32_16x16x32_f16 v[24:27], v[92:95], v[56:59], v[24:27]
    ds_read_b64_tr_b16 v[76:77], v9 offset:4624
    ds_read_b64_tr_b16 v[78:79], v9 offset:4688
    ds_read2_b32 v[48:49], v11 offset0:80 offset1:81
    ds_read2_b32 v[50:51], v11 offset0:82 offset1:83
    v_mfma_f32_16x16x32_f16 v[24:27], v[96:99], v[36:39], v[24:27]
    ds_read_b64_tr_b16 v[80:81], v9 offset:5136
    ds_read_b64_tr_b16 v[82:83], v9 offset:5200
    ds_read2_b32 v[112:113], v11 offset0:96 offset1:97
    ds_read2_b32 v[114:115], v11 offset0:98 offset1:99
    v_mfma_f32_16x16x32_f16 v[24:27], v[100:103], v[60:63], v[24:27]
    ds_read_b64_tr_b16 v[84:85], v10 offset:6176
    ds_read_b64_tr_b16 v[86:87], v10 offset:6304
    ds_read2_b32 v[52:53], v13 offset0:8 offset1:9
    ds_read2_b32 v[54:55], v13 offset0:10 offset1:11
    v_mfma_f32_16x16x32_f16 v[20:23], v[40:43], v[104:107], v[20:23]
    ds_read_b64_tr_b16 v[88:89], v10 offset:7200
    ds_read_b64_tr_b16 v[90:91], v10 offset:7328
    ds_read2_b32 v[120:121], v13 offset0:24 offset1:25
    ds_read2_b32 v[122:123], v13 offset0:26 offset1:27
    v_mfma_f32_16x16x32_f16 v[20:23], v[68:71], v[124:127], v[20:23]
    ds_read_b64_tr_b16 v[92:93], v10 offset:8224
    ds_read_b64_tr_b16 v[94:95], v10 offset:8352
    ds_read2_b32 v[56:57], v13 offset0:104 offset1:105
    ds_read2_b32 v[58:59], v13 offset0:106 offset1:107
    v_mfma_f32_16x16x32_f16 v[20:23], v[44:47], v[64:67], v[20:23]
    ds_read_b64_tr_b16 v[96:97], v10 offset:9248
    ds_read_b64_tr_b16 v[98:99], v10 offset:9376
    ds_read2_b32 v[36:37], v13 offset0:120 offset1:121
    ds_read2_b32 v[38:39], v13 offset0:122 offset1:123
    v_mfma_f32_16x16x32_f16 v[20:23], v[72:75], v[32:35], v[20:23]
    v_mfma_f32_16x16x32_f16 v[20:23], v[76:79], v[48:51], v[20:23]
    v_mfma_f32_16x16x32_f16 v[20:23], v[80:83], v[112:115], v[20:23]
    ds_read_b64_tr_b16 v[100:101], v9 offset:2560
    ds_read_b64_tr_b16 v[102:103], v9 offset:2624
    s_waitcnt lgkmcnt(14)
    v_mfma_f32_16x16x32_f16 v[20:23], v[84:87], v[52:55], v[20:23]
    s_waitcnt lgkmcnt(10)
    v_mfma_f32_16x16x32_f16 v[20:23], v[88:91], v[120:123], v[20:23]
    s_waitcnt lgkmcnt(6)
    v_mfma_f32_16x16x32_f16 v[20:23], v[92:95], v[56:59], v[20:23]
    ds_read_b64_tr_b16 v[60:61], v9 offset:5648
    ds_read_b64_tr_b16 v[62:63], v9 offset:5712
    ds_read2_b32 v[40:41], v13 offset0:0 offset1:1
    ds_read2_b32 v[42:43], v13 offset0:2 offset1:3
    s_waitcnt lgkmcnt(6)
    v_mfma_f32_16x16x32_f16 v[20:23], v[96:99], v[36:39], v[20:23]
    ds_read2_b32 v[72:73], v13 offset0:16 offset1:17
    ds_read2_b32 v[74:75], v13 offset0:18 offset1:19
    ds_read2_b32 v[52:53], v13 offset0:96 offset1:97
    ds_read2_b32 v[54:55], v13 offset0:98 offset1:99
    v_mfma_f32_16x16x32_f16 v[24:27], v[68:71], v[104:107], v[24:27]
    ds_read2_b32 v[120:121], v13 offset0:112 offset1:113
    ds_read2_b32 v[122:123], v13 offset0:114 offset1:115
    v_mfma_f32_16x16x32_f16 v[24:27], v[44:47], v[124:127], v[24:27]
    v_mul_f32 v20, v20, v16
    v_mul_f32 v21, v21, v16
    s_waitcnt lgkmcnt(10)
    v_mfma_f32_16x16x32_f16 v[24:27], v[100:103], v[64:67], v[24:27]
    v_mul_f32 v22, v22, v16
    v_mul_f32 v23, v23, v16
    v_mfma_f32_16x16x32_f16 v[24:27], v[76:79], v[32:35], v[24:27]
    v_cvt_pk_bf16_f32 v28, v20, v21
    v_cvt_pk_bf16_f32 v29, v22, v23
    v_mfma_f32_16x16x32_f16 v[24:27], v[80:83], v[48:51], v[24:27]
    v_lshlrev_b32 v20, 16, v28
    v_and_b32 v21, 0xffff0000, v28
    s_waitcnt lgkmcnt(8)
    v_mfma_f32_16x16x32_f16 v[24:27], v[60:63], v[112:115], v[24:27]
    v_lshlrev_b32 v22, 16, v29
    v_and_b32 v23, 0xffff0000, v29
    s_waitcnt lgkmcnt(6)
    v_mfma_f32_16x16x32_f16 v[24:27], v[84:87], v[40:43], v[24:27]
    v_add_f32 v20, v20, v116
    v_add_f32 v21, v21, v117
    s_waitcnt lgkmcnt(4)
    v_mfma_f32_16x16x32_f16 v[24:27], v[88:91], v[72:75], v[24:27]
    v_add_f32 v22, v22, v118
    v_add_f32 v23, v23, v119
    s_waitcnt lgkmcnt(2)
    v_mfma_f32_16x16x32_f16 v[24:27], v[92:95], v[52:55], v[24:27]
    v_cvt_pk_bf16_f32 v28, v20, v21
    v_cvt_pk_bf16_f32 v29, v22, v23
    s_waitcnt lgkmcnt(0)
    v_mfma_f32_16x16x32_f16 v[24:27], v[96:99], v[120:123], v[24:27]
    v_min_u32 v28, -2, v28
    v_min_u32 v29, -2, v29
    ds_read_u8 v18, v4 offset:163
    ds_read_b128 v[20:23], v12 offset:49664
    s_nop 3
    v_mul_f32 v24, v24, v16
    v_mul_f32 v25, v25, v16
    v_mul_f32 v26, v26, v16
    v_mul_f32 v27, v27, v16
    v_cvt_pk_bf16_f32 v30, v24, v25
    v_cvt_pk_bf16_f32 v31, v26, v27
    v_lshlrev_b32 v24, 16, v30
    v_and_b32 v25, 0xffff0000, v30
    v_lshlrev_b32 v26, 16, v31
    v_and_b32 v27, 0xffff0000, v31
    v_add_f32 v24, v24, v108
    v_add_f32 v25, v25, v109
    v_add_f32 v26, v26, v110
    v_add_f32 v27, v27, v111
    v_cvt_pk_bf16_f32 v30, v24, v25
    v_cvt_pk_bf16_f32 v31, v26, v27
    v_min_u32 v30, -2, v30
    v_min_u32 v31, -2, v31
CVE_32:
    s_waitcnt lgkmcnt(0)
    s_cmp_lg_u32 s87, 1
    s_cbranch_scc1 ZA_43
    v_cmp_ne_u32 vcc, 1, v18
    s_cbranch_vccnz ZS_45
ZB_46:
    s_mov_b64 exec, s[12:13]
    v_swap_b32 v28, v20
    v_swap_b32 v29, v21
    v_swap_b32 v30, v22
    v_swap_b32 v31, v23
    s_mov_b64 exec, -1
    buffer_store_dwordx4 v[28:31], v6, s[64:67], s7 offen sc1
    buffer_store_dwordx4 v[20:23], v6, s[64:67], s6 offen sc1
    s_branch ZD_48
WS_35:
W_49:
    ds_read_b32 v18, v14 offset:76
    s_sub_u32 s39, s39, 1
    s_cbranch_scc1 KS_ABORT
    s_waitcnt lgkmcnt(0)
    v_cmp_ne_u32 vcc, s84, v18
    s_cbranch_vccnz W_49
    s_branch WB_36
WS_38:
W_50:
    ds_read_b32 v18, v14 offset:76
    s_sub_u32 s39, s39, 1
    s_cbranch_scc1 KS_ABORT
    s_waitcnt lgkmcnt(0)
    v_cmp_ne_u32 vcc, s84, v18
    s_cbranch_vccnz W_50
    s_branch WB_39
WS_41:
W_51:
    ds_read_b32 v18, v14 offset:76
    s_sub_u32 s39, s39, 1
    s_cbranch_scc1 KS_ABORT
    s_waitcnt lgkmcnt(0)
    v_cmp_ne_u32 vcc, s84, v18
    s_cbranch_vccnz W_51
    s_branch WB_42
ZS_45:
    v_mov_b32 v19, s86
ZW_52:
    ds_read_u8 v18, v19 offset:160
    s_sub_u32 s39, s39, 1
    s_cbranch_scc1 KS_ABORT
    s_waitcnt lgkmcnt(0)
    v_cmp_ne_u32 vcc, 1, v18
    s_cbranch_vccnz ZW_52
    v_lshl_add_u32 v19, v19, 10, v12
    ds_read_b128 v[20:23], v19 offset:46592
    s_waitcnt lgkmcnt(0)
    s_branch ZB_46
ZA_43:
    s_cmp_lg_u32 s87, 0
    s_cbranch_scc1 ZC_44
    v_mov_b32 v19, s86
    v_lshl_add_u32 v18, v19, 10, v12
    ds_write_b128 v18, v[28:31] offset:46592
    ds_write_b8 v19, v5 offset:160
    s_branch ZD_48
ZC_44:
    buffer_store_dwordx4 v[28:31], v6, s[64:67], s6 offen sc1
ZD_48:
    s_lshl_b32 s92, s87, 2
    s_add_u32 s92, s92, s86
    v_mov_b32 v8, s92
    s_waitcnt vmcnt(0)
    ds_write_b8 v8, v5 offset:48
    s_cmp_lt_u32 s41, 18
    s_cbranch_scc1 KS_T
    s_waitcnt lgkmcnt(0)
    s_endpgm
KS_X:
    s_cmp_lt_u32 s41, 24
    s_cbranch_scc1 KS_X2
    s_setprio 2
KS_XC:
    s_mov_b32 s87, 2
    s_add_u32 s86, s38, 3
    s_and_b32 s86, s86, 3
    s_lshl_b32 s88, s40, 3
    s_and_b32 s92, s41, 7
    s_add_u32 s88, s88, s92
    s_add_u32 s88, s88, 512
    s_lshl_b32 s92, s86, 11
    s_add_u32 s92, s92, 146048
    v_lshl_add_u32 v28, v1, 3, s92
    s_branch KS_GRP
KS_X2:
    s_cmp_lt_u32 s41, 8
    s_cbranch_scc1 KS_X3
    s_sub_u32 s97, s38, 8
    s_branch KS_LN1
KS_X3:
    s_lshl_b32 s92, s2, 4
    s_add_u32 s92, s92, s38
    s_cmp_lg_u32 s92, 44
    s_cbranch_scc1 KS_X3B
    s_setprio 3
    s_memrealtime s[92:93]
    v_and_b32 v6, 3, v1
    v_lshlrev_b32 v7, 2, v6
    v_min_u32 v6, 2, v6
    v_lshlrev_b32 v6, 2, v6
    v_cmp_eq_u32 vcc, 3, v1
    s_waitcnt lgkmcnt(0)
    v_mov_b32 v8, s92
    v_mov_b32 v9, s93
    v_alignbit_b32 v8, v8, v8, v6
    v_cndmask_b32 v9, v4, v9, vcc
    v_xor_b32 v8, v8, v9
    v_and_b32 v9, 0xf0000fff, v8
    v_and_b32 v10, 0xfff000, v8
    v_lshl_or_b32 v9, v10, 4, v9
    v_lshrrev_b32 v10, 12, v8
    v_and_b32 v10, 0xf000, v10
    v_or3_b32 v9, v9, v10, v9
    v_or_b32 v9, 0x80000000, v9
    s_mov_b64 exec, 15
    global_store_dword v7, v9, s[34:35] sc1
    s_mov_b64 exec, -1
    s_setprio 0
KS_X3B:
    s_setprio 3
    s_branch KS_XC
    s_waitcnt lgkmcnt(0)
    s_barrier
    s_branch KS_G
KS_X4:
    s_cmp_lt_u32 s41, 18
    s_cbranch_scc1 KS_G
    s_waitcnt vmcnt(0) lgkmcnt(0)
    s_endpgm
KS_L:
    v_lshlrev_b32 v6, 2, v0
    ds_write_b32 v6, v4
    v_mov_b32 v8, 0
    v_mov_b32 v9, 0
    s_min_u32 s92, s38, 2
    s_mul_i32 s92, s92, 4672
    v_min_u32 v6, 59, v1
    v_lshl_add_u32 v6, v6, 3, s92
    ds_write_b64 v6, v[8:9] offset:3072
    s_mov_b32 s97, s38
    s_sub_u32 s92, s41, 8
    s_cmp_lt_u32 s92, 16
    s_cbranch_scc0 KS_L0
KS_LN1:
    s_setprio 3
    s_sub_u32 s92, s41, 8
    s_and_b32 s88, s92, 7
    s_lshr_b32 s92, s92, 3
    s_lshl_b32 s92, s92, 4
    s_add_u32 s88, s88, s92
    s_and_b32 s92, s40, 1
    s_lshl_b32 s92, s92, 3
    s_add_u32 s88, s88, s92
    s_lshr_b32 s92, s40, 1
    s_lshl_b32 s92, s92, 5
    s_add_u32 s88, s88, s92
    v_lshrrev_b32 v36, 5, v1
    v_and_b32 v37, 31, v1
    v_mul_u32_u24 v38, 1152, v36
    v_lshl_add_u32 v39, v37, 2, v38
    v_lshl_add_u32 v38, v37, 4, v38
    s_mul_i32 s93, s88, 18432
    s_mul_i32 s94, s97, 2304
    s_add_u32 s93, s93, s94
    s_waitcnt lgkmcnt(0)
    s_mov_b32 s64, s4
    s_mov_b32 s65, s5
    s_mov_b32 s66, 0x240000
    s_mov_b32 s67, 0x20000
    buffer_load_dwordx4 v[26:29], v38, s[64:67], s93 offen
    buffer_load_dwordx4 v[30:33], v38, s[64:67], s93 offen offset:512
    buffer_load_dword v34, v39, s[64:67], s93 offen offset:1024
    s_barrier
    s_lshr_b32 s93, s97, 2
    s_lshl_b32 s93, s93, 6
    s_add_u32 s94, s94, s93
    s_add_u32 s94, s94, 17088
    v_lshl_add_u32 v35, v37, 1, v36
    s_mov_b32 s98, 0x05040100
    s_mov_b32 s99, 0x07060302
    s_waitcnt vmcnt(2)
    v_lshlrev_b32 v8, 16, v26
    v_and_b32 v9, 0xffff0000, v26
    v_lshlrev_b32 v10, 16, v27
    v_and_b32 v11, 0xffff0000, v27
    v_lshlrev_b32 v12, 16, v28
    v_and_b32 v13, 0xffff0000, v28
    v_lshlrev_b32 v14, 16, v29
    v_and_b32 v15, 0xffff0000, v29
    s_waitcnt vmcnt(1)
    v_lshlrev_b32 v16, 16, v30
    v_and_b32 v17, 0xffff0000, v30
    v_lshlrev_b32 v18, 16, v31
    v_and_b32 v19, 0xffff0000, v31
    v_lshlrev_b32 v20, 16, v32
    v_and_b32 v21, 0xffff0000, v32
    v_lshlrev_b32 v22, 16, v33
    v_and_b32 v23, 0xffff0000, v33
    s_waitcnt vmcnt(0)
    v_lshlrev_b32 v24, 16, v34
    v_and_b32 v25, 0xffff0000, v34
    v_lshl_add_u32 v6, v35, 4, s94
    v_lshl_add_u32 v7, v35, 2, s94
    v_mul_u32_u24 v35, 0x20202, v36
    v_lshl_add_u32 v35, v36, 25, v35
    v_add_u32 v35, 0x05040100, v35
    v_pk_add_f32 v[40:41], v[8:9], v[10:11]
    v_pk_add_f32 v[42:43], v[12:13], v[14:15]
    v_pk_add_f32 v[40:41], v[40:41], v[16:17]
    v_pk_add_f32 v[42:43], v[42:43], v[18:19]
    v_pk_add_f32 v[40:41], v[40:41], v[20:21]
    v_pk_add_f32 v[42:43], v[42:43], v[22:23]
    v_pk_add_f32 v[40:41], v[40:41], v[24:25]
    v_pk_add_f32 v[40:41], v[40:41], v[42:43]
    v_add_f32 v40, v40, v41
    s_nop 1
    v_add_f32_dpp v40, v40, v40 row_ror:8 row_mask:0xf bank_mask:0xf
    s_nop 1
    v_add_f32_dpp v40, v40, v40 row_ror:4 row_mask:0xf bank_mask:0xf
    s_nop 1
    v_add_f32_dpp v40, v40, v40 row_ror:2 row_mask:0xf bank_mask:0xf
    s_nop 1
    v_add_f32_dpp v40, v40, v40 row_ror:1 row_mask:0xf bank_mask:0xf
    v_mov_b32 v42, v40
    s_nop 1
    v_permlane16_swap_b32 v40, v42
    v_add_f32 v40, v40, v42
    v_mul_f32 v44, 0x3ae38e39, v40
    v_mov_b32 v45, v44
    v_cvt_pk_bf16_f32 v36, v44, v44
    v_and_b32 v36, 0xffff0000, v36
    v_mov_b32 v37, v36
    v_pk_add_f32 v[38:39], v[8:9], v[44:45] neg_lo:[0,1] neg_hi:[0,1]
    v_pk_mul_f32 v[40:41], v[38:39], v[38:39]
    v_pk_add_f32 v[38:39], v[10:11], v[44:45] neg_lo:[0,1] neg_hi:[0,1]
    v_pk_mul_f32 v[42:43], v[38:39], v[38:39]
    v_pk_add_f32 v[38:39], v[12:13], v[44:45] neg_lo:[0,1] neg_hi:[0,1]
    v_pk_fma_f32 v[40:41], v[38:39], v[38:39], v[40:41]
    v_pk_add_f32 v[38:39], v[14:15], v[44:45] neg_lo:[0,1] neg_hi:[0,1]
    v_pk_fma_f32 v[42:43], v[38:39], v[38:39], v[42:43]
    v_pk_add_f32 v[38:39], v[16:17], v[44:45] neg_lo:[0,1] neg_hi:[0,1]
    v_pk_fma_f32 v[40:41], v[38:39], v[38:39], v[40:41]
    v_pk_add_f32 v[38:39], v[18:19], v[44:45] neg_lo:[0,1] neg_hi:[0,1]
    v_pk_fma_f32 v[42:43], v[38:39], v[38:39], v[42:43]
    v_pk_add_f32 v[38:39], v[20:21], v[44:45] neg_lo:[0,1] neg_hi:[0,1]
    v_pk_fma_f32 v[40:41], v[38:39], v[38:39], v[40:41]
    v_pk_add_f32 v[38:39], v[22:23], v[44:45] neg_lo:[0,1] neg_hi:[0,1]
    v_pk_fma_f32 v[42:43], v[38:39], v[38:39], v[42:43]
    v_pk_add_f32 v[38:39], v[24:25], v[44:45] neg_lo:[0,1] neg_hi:[0,1]
    v_pk_fma_f32 v[40:41], v[38:39], v[38:39], v[40:41]
    v_pk_add_f32 v[40:41], v[40:41], v[42:43]
    v_add_f32 v40, v40, v41
    s_nop 1
    v_add_f32_dpp v40, v40, v40 row_ror:8 row_mask:0xf bank_mask:0xf
    s_nop 1
    v_add_f32_dpp v40, v40, v40 row_ror:4 row_mask:0xf bank_mask:0xf
    s_nop 1
    v_add_f32_dpp v40, v40, v40 row_ror:2 row_mask:0xf bank_mask:0xf
    s_nop 1
    v_add_f32_dpp v40, v40, v40 row_ror:1 row_mask:0xf bank_mask:0xf
    v_mov_b32 v42, v40
    s_nop 1
    v_permlane16_swap_b32 v40, v42
    v_add_f32 v40, v40, v42
    v_mul_f32 v40, 0x3ae38e39, v40
    v_cvt_pk_bf16_f32 v40, v40, v40
    v_and_b32 v40, 0xffff0000, v40
    v_add_f32 v40, 0x3727c5ac, v40
    v_cvt_pk_bf16_f32 v40, v40, v40
    v_and_b32 v40, 0xffff0000, v40
    v_sqrt_f32 v40, v40
    s_nop 0
    v_cvt_pk_bf16_f32 v40, v40, v40
    v_and_b32 v40, 0xffff0000, v40
    v_rcp_f32 v38, v40
    s_nop 0
    v_mov_b32 v39, v38
    v_pk_add_f32 v[40:41], v[8:9], v[36:37] neg_lo:[0,1] neg_hi:[0,1]
    v_cvt_pk_bf16_f32 v42, v40, v41
    v_lshlrev_b32 v40, 16, v42
    v_and_b32 v41, 0xffff0000, v42
    v_pk_mul_f32 v[40:41], v[40:41], v[38:39]
    v_cvt_pk_bf16_f32 v42, v40, v41
    v_lshlrev_b32 v40, 16, v42
    v_and_b32 v41, 0xffff0000, v42
    v_cvt_pk_f16_f32 v26, v40, v41
    v_pk_add_f32 v[40:41], v[10:11], v[36:37] neg_lo:[0,1] neg_hi:[0,1]
    v_cvt_pk_bf16_f32 v42, v40, v41
    v_lshlrev_b32 v40, 16, v42
    v_and_b32 v41, 0xffff0000, v42
    v_pk_mul_f32 v[40:41], v[40:41], v[38:39]
    v_cvt_pk_bf16_f32 v42, v40, v41
    v_lshlrev_b32 v40, 16, v42
    v_and_b32 v41, 0xffff0000, v42
    v_cvt_pk_f16_f32 v27, v40, v41
    v_pk_add_f32 v[40:41], v[12:13], v[36:37] neg_lo:[0,1] neg_hi:[0,1]
    v_cvt_pk_bf16_f32 v42, v40, v41
    v_lshlrev_b32 v40, 16, v42
    v_and_b32 v41, 0xffff0000, v42
    v_pk_mul_f32 v[40:41], v[40:41], v[38:39]
    v_cvt_pk_bf16_f32 v42, v40, v41
    v_lshlrev_b32 v40, 16, v42
    v_and_b32 v41, 0xffff0000, v42
    v_cvt_pk_f16_f32 v28, v40, v41
    v_and_b32 v59, 3, v1
    v_lshlrev_b32 v59, 2, v59
    global_load_dword v58, v59, s[34:35] sc1
    v_pk_add_f32 v[40:41], v[14:15], v[36:37] neg_lo:[0,1] neg_hi:[0,1]
    v_cvt_pk_bf16_f32 v42, v40, v41
    v_lshlrev_b32 v40, 16, v42
    v_and_b32 v41, 0xffff0000, v42
    v_pk_mul_f32 v[40:41], v[40:41], v[38:39]
    v_cvt_pk_bf16_f32 v42, v40, v41
    v_lshlrev_b32 v40, 16, v42
    v_and_b32 v41, 0xffff0000, v42
    v_cvt_pk_f16_f32 v29, v40, v41
    v_permlane32_swap_b32 v26, v28
    s_nop 0
    v_permlane32_swap_b32 v27, v29
    v_perm_b32 v8, v28, v26, s98
    v_perm_b32 v9, v28, v26, s99
    v_perm_b32 v10, v29, v27, s98
    v_perm_b32 v11, v29, v27, s99
    ds_write_b128 v6, v[8:11] offset:0
    v_pk_add_f32 v[40:41], v[16:17], v[36:37] neg_lo:[0,1] neg_hi:[0,1]
    v_cvt_pk_bf16_f32 v42, v40, v41
    v_lshlrev_b32 v40, 16, v42
    v_and_b32 v41, 0xffff0000, v42
    v_pk_mul_f32 v[40:41], v[40:41], v[38:39]
    v_cvt_pk_bf16_f32 v42, v40, v41
    v_lshlrev_b32 v40, 16, v42
    v_and_b32 v41, 0xffff0000, v42
    v_cvt_pk_f16_f32 v30, v40, v41
    v_pk_add_f32 v[40:41], v[18:19], v[36:37] neg_lo:[0,1] neg_hi:[0,1]
    v_cvt_pk_bf16_f32 v42, v40, v41
    v_lshlrev_b32 v40, 16, v42
    v_and_b32 v41, 0xffff0000, v42
    v_pk_mul_f32 v[40:41], v[40:41], v[38:39]
    v_cvt_pk_bf16_f32 v42, v40, v41
    v_lshlrev_b32 v40, 16, v42
    v_and_b32 v41, 0xffff0000, v42
    v_cvt_pk_f16_f32 v31, v40, v41
    v_pk_add_f32 v[40:41], v[20:21], v[36:37] neg_lo:[0,1] neg_hi:[0,1]
    v_cvt_pk_bf16_f32 v42, v40, v41
    v_lshlrev_b32 v40, 16, v42
    v_and_b32 v41, 0xffff0000, v42
    v_pk_mul_f32 v[40:41], v[40:41], v[38:39]
    v_cvt_pk_bf16_f32 v42, v40, v41
    v_lshlrev_b32 v40, 16, v42
    v_and_b32 v41, 0xffff0000, v42
    v_cvt_pk_f16_f32 v32, v40, v41
    v_pk_add_f32 v[40:41], v[22:23], v[36:37] neg_lo:[0,1] neg_hi:[0,1]
    v_cvt_pk_bf16_f32 v42, v40, v41
    v_lshlrev_b32 v40, 16, v42
    v_and_b32 v41, 0xffff0000, v42
    v_pk_mul_f32 v[40:41], v[40:41], v[38:39]
    v_cvt_pk_bf16_f32 v42, v40, v41
    v_lshlrev_b32 v40, 16, v42
    v_and_b32 v41, 0xffff0000, v42
    v_cvt_pk_f16_f32 v33, v40, v41
    v_permlane32_swap_b32 v30, v32
    s_nop 0
    v_permlane32_swap_b32 v31, v33
    v_perm_b32 v16, v32, v30, s98
    v_perm_b32 v17, v32, v30, s99
    v_perm_b32 v18, v33, v31, s98
    v_perm_b32 v19, v33, v31, s99
    ds_write_b128 v6, v[16:19] offset:1024
    v_pk_add_f32 v[40:41], v[24:25], v[36:37] neg_lo:[0,1] neg_hi:[0,1]
    v_cvt_pk_bf16_f32 v42, v40, v41
    v_lshlrev_b32 v40, 16, v42
    v_and_b32 v41, 0xffff0000, v42
    v_pk_mul_f32 v[40:41], v[40:41], v[38:39]
    v_cvt_pk_bf16_f32 v42, v40, v41
    v_lshlrev_b32 v40, 16, v42
    v_and_b32 v41, 0xffff0000, v42
    v_cvt_pk_f16_f32 v34, v40, v41
    v_mov_b32 v40, v34
    s_nop 1
    v_permlane32_swap_b32 v34, v40
    v_perm_b32 v40, v40, v34, v35
    ds_write_b32 v7, v40 offset:2048
    v_mov_b32 v6, s97
    ds_write_b8 v6, v5 offset:0
    s_setprio 0
    s_cmp_ge_u32 s97, 4
    s_cbranch_scc1 KS_X4
    s_setprio 3
    s_mov_b32 s72, s36
    s_mov_b32 s73, s37
    s_mov_b32 s74, 0x240000
    s_mov_b32 s75, 0x20000
    v_and_b32 v6, 1, v0
    v_mul_u32_u24 v6, 9280, v6
    v_lshrrev_b32 v7, 1, v0
    v_lshl_add_u32 v6, v7, 2, v6
    v_add_u32 v6, 17088, v6
    v_lshrrev_b32 v7, 2, v0
    v_mul_u32_u24 v7, 0x2080, v7
    v_and_b32 v8, 3, v0
    v_lshl_add_u32 v7, v8, 4, v7
    s_lshl_b32 s92, s88, 6
    v_xor_b32 v7, s92, v7
    s_mov_b32 s92, 0
    s_add_u32 s93, s92, 524288
    s_add_u32 s94, s92, 1048576
    s_add_u32 s95, s92, 1572864
    s_add_u32 s96, s92, 2097152
    s_waitcnt vmcnt(0)
DBP_55:
    v_cmp_eq_u32 vcc, 0, v58
    s_cbranch_vccz DBG_56
    s_sleep 1
    global_load_dword v58, v59, s[34:35] sc1
    s_sub_u32 s39, s39, 1
    s_cbranch_scc1 KS_ABORT
    s_waitcnt vmcnt(0)
    s_branch DBP_55
DBG_56:
    ds_write_b32 v59, v58 offset:224
    s_mov_b32 s98, 0x70007
    v_lshrrev_b32 v57, 3, v58
    v_lshrrev_b32 v56, 6, v58
    v_lshrrev_b32 v55, 9, v58
W_57:
    ds_read_b64 v[20:21], v4 offset:0
    s_sub_u32 s39, s39, 1
    s_cbranch_scc1 KS_ABORT
    s_waitcnt lgkmcnt(0)
    v_and_b32 v20, v20, v21
    v_cmp_ne_u32 vcc, s84, v20
    s_cbranch_vccnz W_57
    ds_read2st64_b32 v[20:21], v6 offset0:0 offset1:9
    ds_read2st64_b32 v[22:23], v6 offset0:18 offset1:27
    ds_read2st64_b32 v[24:25], v6 offset0:2 offset1:11
    ds_read2st64_b32 v[26:27], v6 offset0:20 offset1:29
    ds_read2st64_b32 v[28:29], v6 offset0:4 offset1:13
    ds_read2st64_b32 v[30:31], v6 offset0:22 offset1:31
    ds_read2st64_b32 v[32:33], v6 offset0:6 offset1:15
    ds_read2st64_b32 v[34:35], v6 offset0:24 offset1:33
    ds_read2st64_b32 v[36:37], v6 offset0:8 offset1:17
    ds_read2st64_b32 v[38:39], v6 offset0:26 offset1:35
    s_waitcnt lgkmcnt(8)
    v_bfi_b32 v20, s98, v58, v20
    v_bfi_b32 v21, s98, v57, v21
    v_bfi_b32 v22, s98, v56, v22
    v_bfi_b32 v23, s98, v55, v23
    buffer_store_dwordx4 v[20:23], v7, s[72:75], s92 offen sc1
    s_waitcnt lgkmcnt(6)
    v_bfi_b32 v24, s98, v58, v24
    v_bfi_b32 v25, s98, v57, v25
    v_bfi_b32 v26, s98, v56, v26
    v_bfi_b32 v27, s98, v55, v27
    buffer_store_dwordx4 v[24:27], v7, s[72:75], s93 offen sc1
    s_waitcnt lgkmcnt(4)
    v_bfi_b32 v28, s98, v58, v28
    v_bfi_b32 v29, s98, v57, v29
    v_bfi_b32 v30, s98, v56, v30
    v_bfi_b32 v31, s98, v55, v31
    buffer_store_dwordx4 v[28:31], v7, s[72:75], s94 offen sc1
    s_waitcnt lgkmcnt(2)
    v_bfi_b32 v32, s98, v58, v32
    v_bfi_b32 v33, s98, v57, v33
    v_bfi_b32 v34, s98, v56, v34
    v_bfi_b32 v35, s98, v55, v35
    buffer_store_dwordx4 v[32:35], v7, s[72:75], s95 offen sc1
    s_waitcnt lgkmcnt(0)
    v_bfi_b32 v36, s98, v58, v36
    v_bfi_b32 v37, s98, v57, v37
    v_bfi_b32 v38, s98, v56, v38
    v_bfi_b32 v39, s98, v55, v39
    buffer_store_dwordx4 v[36:39], v7, s[72:75], s96 offen sc1
    v_mov_b32 v6, s97
    ds_write_b8 v6, v5 offset:200
    v_mul_u32_u24 v46, 57, v1
    v_lshrrev_b32 v46, 9, v46
    v_mul_u32_u24 v47, 9, v46
    v_sub_u32 v47, v1, v47
    v_mul_u32_u24 v46, 9216, v46
    v_lshl_add_u32 v46, v47, 7, v46
    s_cmp_ge_u32 s41, 18
    s_cbranch_scc1 KS_LL2
    s_branch KS_LLE
KS_LL2:
    s_mul_i32 s94, s38, 6
    s_add_u32 s94, s94, s41
    s_sub_u32 s94, s94, 18
    s_bitcmp1_b32 s94, 0
    s_cselect_b32 s72, s28, s26
    s_cselect_b32 s73, s29, s27
    s_mov_b32 s74, 0x510000
    s_mov_b32 s75, 0x20000
    s_lshr_b32 s95, s94, 1
    s_mul_i32 s95, s95, 64512
    s_mul_i32 s96, s40, 1152
    s_add_u32 s95, s95, s96
    s_add_u32 s96, s95, 2644992
    buffer_load_dword v47, v46, s[72:75], s96 offen nt
    buffer_load_dword v47, v46, s[72:75], s96 offen sc1
KS_LLE:
    s_mov_b32 s87, 1
    s_branch KS_L2B
KS_L0:
    s_and_b32 s92, s41, 15
    s_lshl_b32 s93, s40, 4
    s_add_u32 s92, s92, s93
    v_and_b32 v59, 3, v1
    v_lshlrev_b32 v59, 2, v59
    s_lshl_b32 s96, s92, 6
    s_add_u32 s93, s96, 0xb00000
    v_add_u32 v7, s93, v59
    s_mul_i32 s93, s92, 18560
    s_add_u32 s93, s93, 0x600000
    v_lshlrev_b32 v6, 4, v0
    v_mov_b32 v12, -1
    v_mov_b32 v13, -1
    v_mov_b32 v14, -1
    v_mov_b32 v15, -1
    s_setprio 3
    v_mul_u32_u24 v16, 57, v1
    v_lshrrev_b32 v16, 9, v16
    v_mul_u32_u24 v17, 9, v16
    v_sub_u32 v17, v1, v17
    v_mul_u32_u24 v16, 9216, v16
    v_lshl_add_u32 v16, v17, 7, v16
    s_waitcnt lgkmcnt(0)
    s_add_u32 s68, s36, s93
    s_addc_u32 s69, s37, 0
    s_mov_b32 s70, 18560
    s_mov_b32 s71, 0x20000
    s_barrier
W_58:
    s_sleep 2
    ds_read_b32 v8, v4 offset:36
    s_sub_u32 s39, s39, 1
    s_cbranch_scc1 KS_ABORT
    s_waitcnt lgkmcnt(0)
    v_cmp_eq_u32 vcc, 0, v8
    s_cbranch_vccnz W_58
    s_movk_i32 s92, 0
    buffer_store_dwordx4 v[12:15], v6, s[68:71], s92 offen sc1
    s_movk_i32 s92, 4096
    buffer_store_dwordx4 v[12:15], v6, s[68:71], s92 offen sc1
    s_movk_i32 s92, 8192
    buffer_store_dwordx4 v[12:15], v6, s[68:71], s92 offen sc1
    s_movk_i32 s92, 12288
    buffer_store_dwordx4 v[12:15], v6, s[68:71], s92 offen sc1
    s_movk_i32 s92, 16384
    buffer_store_dwordx4 v[12:15], v6, s[68:71], s92 offen sc1
    global_load_dword v58, v59, s[34:35] sc1
    s_waitcnt vmcnt(0)
DBP_59:
    v_cmp_eq_u32 vcc, 0, v58
    s_cbranch_vccz DBG_60
    s_sleep 1
    global_load_dword v58, v59, s[34:35] sc1
    s_sub_u32 s39, s39, 1
    s_cbranch_scc1 KS_ABORT
    s_waitcnt vmcnt(0)
    s_branch DBP_59
DBG_60:
    ds_write_b32 v59, v58 offset:224
    s_mov_b64 exec, 1
    ds_add_rtn_u32 v8, v4, v5 offset:8
    s_mov_b64 exec, -1
    v_lshrrev_b32 v57, 3, v58
    v_lshrrev_b32 v56, 6, v58
    v_lshrrev_b32 v55, 9, v58
    s_waitcnt lgkmcnt(0)
    v_readfirstlane_b32 s92, v8
    s_cmp_lg_u32 s92, 3
    s_cbranch_scc1 KS_L2
    s_mov_b64 exec, 15
    global_store_dword v7, v58, s[36:37] sc1
    s_mov_b64 exec, -1
    s_and_b32 s94, s41, 7
    s_cmp_ge_u32 s41, 8
    s_cbranch_scc1 KS_L1C
    s_branch KS_L2
KS_L1C:
    s_bitcmp1_b32 s94, 0
    s_cselect_b32 s72, s28, s26
    s_cselect_b32 s73, s29, s27
    s_mov_b32 s74, 0x510000
    s_mov_b32 s75, 0x20000
    s_lshr_b32 s95, s94, 1
    s_mul_i32 s95, s95, 64512
    s_mul_i32 s96, s40, 1152
    s_add_u32 s95, s95, s96
    s_add_u32 s96, s95, 3419136
    buffer_load_dword v18, v16, s[72:75], s96 offen nt
    buffer_load_dword v18, v16, s[72:75], s96 offen sc1
    s_add_u32 s96, s95, 3677184
    buffer_load_dword v18, v16, s[72:75], s96 offen nt
    buffer_load_dword v18, v16, s[72:75], s96 offen sc1
    s_add_u32 s96, s95, 3935232
    buffer_load_dword v18, v16, s[72:75], s96 offen nt
    buffer_load_dword v18, v16, s[72:75], s96 offen sc1
    s_add_u32 s96, s95, 4193280
    buffer_load_dword v18, v16, s[72:75], s96 offen nt
    buffer_load_dword v18, v16, s[72:75], s96 offen sc1
KS_L2:
    s_mov_b32 s87, 0
KS_L2B:
    s_mov_b32 s64, s36
    s_mov_b32 s65, s37
    s_mov_b32 s66, 0x240000
    s_mov_b32 s67, 0x20000
    v_lshrrev_b32 v7, 1, v1
    v_lshlrev_b32 v7, 6, v7
    v_and_b32 v10, 1, v1
    v_lshl_add_u32 v7, v10, 4, v7
    v_lshlrev_b32 v9, 4, v1
    s_lshl_b32 s92, s38, 11
    s_lshl_b32 s93, s90, 13
    s_add_u32 s93, s93, s92
    s_lshl_b32 s94, s90, 7
    s_and_b32 s95, s94, 0x380
    v_xor_b32 v13, s95, v9
    s_and_b32 s94, s94, 0x1c00
    s_xor_b32 s93, s93, s94
    s_xor_b32 s97, s93, 0x400
    s_lshl_b32 s95, s40, 3
    s_add_u32 s95, s95, s41
    s_add_u32 s95, s95, 488
    s_lshr_b32 s96, s95, 1
    s_lshl_b32 s96, s96, 13
    s_and_b32 s95, s95, 1
    s_lshl_b32 s95, s95, 5
    s_add_u32 s95, s95, s96
    s_add_u32 s95, s95, s92
    s_lshr_b32 s96, s96, 6
    s_and_b32 s94, s96, 0x780
    v_xor_b32 v7, s94, v7
    s_and_b32 s96, s96, 0x1800
    s_xor_b32 s95, s95, s96
    s_cmp_lt_u32 s41, 24
    s_cselect_b32 s95, 2359296, s95
    s_cselect_b32 s94, 0, 0x70007
    v_mov_b32_dpp v64, v58 quad_perm:[0,1,0,1] row_mask:0xf bank_mask:0xf
    v_mov_b32_dpp v65, v58 quad_perm:[2,3,2,3] row_mask:0xf bank_mask:0xf
    s_bitcmp1_b32 s41, 0
    s_cselect_b64 vcc, -1, 0
    v_cndmask_b32 v64, v64, v65, vcc
    v_and_b32 v60, 0x70007, v58
    v_and_b32 v61, 0x70007, v57
    v_and_b32 v62, 0x70007, v56
    v_and_b32 v63, 0x70007, v55
    v_lshrrev_b32 v67, 9, v64
    v_lshrrev_b32 v66, 6, v64
    v_lshrrev_b32 v65, 3, v64
    v_and_b32 v64, s94, v64
    v_and_b32 v65, s94, v65
    v_and_b32 v66, s94, v66
    v_and_b32 v67, s94, v67
    s_lshl_b32 s96, s38, 10
    s_add_u32 s96, s96, 3552
    v_bfe_u32 v11, v1, 1, 1
    v_mul_u32_u24 v11, 4672, v11
    v_lshl_add_u32 v11, v10, 4, v11
    v_lshrrev_b32 v10, 2, v1
    v_lshl_add_u32 v11, v10, 5, v11
    v_add_u32 v11, s96, v11
    v_add_u32 v10, s96, v9
    v_mov_b32 v116, s38
    s_add_u32 s92, s92, 0xb00000
    v_lshrrev_b32 v12, 2, v1
    v_lshl_add_u32 v12, v12, 6, v59
    v_add_u32 v12, s92, v12
    s_cmp_lt_u32 s41, 8
    s_cselect_b32 s94, 4, 0
    s_cmp_ge_u32 s41, 24
    s_cselect_b32 s94, 4, s94
    v_mov_b32 v14, s94
    s_setprio 0
    s_waitcnt vmcnt(0)
W_61:
    s_sleep 2
    ds_read_b32 v8, v14 offset:64
    s_sub_u32 s39, s39, 1
    s_cbranch_scc1 KS_ABORT
    s_waitcnt lgkmcnt(0)
    v_cmp_ne_u32 vcc, s84, v8
    s_cbranch_vccnz W_61
    s_setprio 3
    s_branch UPE_63
UP_62:
    s_sleep 2
UPE_63:
    global_load_dword v32, v12, s[36:37] sc1
    global_load_dword v33, v12, s[36:37] offset:1024 sc1
    buffer_load_dwordx4 v[20:23], v13, s[64:67], s93 offen sc1
    buffer_load_dwordx4 v[24:27], v13, s[64:67], s97 offen sc1
    buffer_load_dwordx4 v[28:31], v7, s[64:67], s95 offen sc1
    s_sub_u32 s39, s39, 1
    s_cbranch_scc1 KS_ABORT
    s_waitcnt vmcnt(2)
    v_xor_b32 v32, v58, v32
    v_xor_b32 v33, v58, v33
    v_xor_b32 v20, v60, v20
    v_xor_b32 v21, v61, v21
    v_xor_b32 v22, v62, v22
    v_xor_b32 v23, v63, v23
    v_or3_b32 v44, v20, v21, v21
    v_or3_b32 v44, v22, v23, v44
    s_waitcnt vmcnt(1)
    v_xor_b32 v24, v60, v24
    v_xor_b32 v25, v61, v25
    v_xor_b32 v26, v62, v26
    v_xor_b32 v27, v63, v27
    v_or3_b32 v44, v24, v25, v44
    v_or3_b32 v44, v26, v27, v44
    s_waitcnt vmcnt(0)
    v_xor_b32 v28, v64, v28
    v_xor_b32 v29, v65, v29
    v_xor_b32 v30, v66, v30
    v_xor_b32 v31, v67, v31
    v_or3_b32 v44, v28, v29, v44
    v_or3_b32 v44, v30, v31, v44
    v_and_b32 v44, 0x70007, v44
    v_or3_b32 v44, v44, v32, v33
    v_cmp_ne_u32 vcc, 0, v44
    s_cbranch_vccnz UP_62
    ds_write_b128 v11, v[20:23]
    ds_write_b128 v11, v[24:27] offset:512
    ds_write_b128 v10, v[28:31] offset:9344
    ds_write_b8 v116, v5 offset:16
    s_cmp_eq_u32 s38, 2
    s_cbranch_scc1 WJ2_66
    s_add_u32 s92, s38, 1
    s_lshr_b32 s92, s92, 2
    s_cmp_eq_u32 s38, 1
    s_cselect_b32 s92, 2, s92
    s_lshl_b32 s92, s92, 10
    v_lshl_add_u32 v10, v1, 4, s92
    v_add_u32 v11, 35840, v10
W_67:
    ds_read_b32 v12, v4 offset:16
    s_sub_u32 s39, s39, 1
    s_cbranch_scc1 KS_ABORT
    s_waitcnt lgkmcnt(0)
    v_cmp_ne_u32 vcc, s84, v12
    s_cbranch_vccnz W_67
    s_setprio 3
    ds_read_b128 v[20:23], v10 offset:3520
    ds_read_b128 v[24:27], v10 offset:3536
    ds_read_b64 v[28:29], v10 offset:3552
    ds_read_b128 v[32:35], v10 offset:8192
    ds_read_b128 v[36:39], v10 offset:8208
    ds_read_b64 v[40:41], v10 offset:8224
    ds_read_b128 v[44:47], v10 offset:12864
    ds_read_b128 v[48:51], v10 offset:12880
    ds_read_b64 v[52:53], v10 offset:12896
    s_cmp_eq_u32 s38, 1
    s_cbranch_scc1 WJ1_65
    ds_read_b32 v12, v4 offset:68
    s_waitcnt lgkmcnt(7)
    v_alignbit_b32 v57, v22, v21, 16
    v_alignbit_b32 v58, v23, v22, 16
    v_alignbit_b32 v59, v24, v23, 16
    v_alignbit_b32 v60, v25, v24, 16
    v_alignbit_b32 v61, v26, v25, 16
    v_alignbit_b32 v62, v27, v26, 16
    v_alignbit_b32 v63, v28, v27, 16
    v_alignbit_b32 v64, v29, v28, 16
    v_pk_add_f16 v66, v57, v22
    v_pk_add_f16 v67, v58, v23
    v_pk_add_f16 v68, v59, v24
    v_pk_add_f16 v69, v60, v25
    v_pk_add_f16 v70, v61, v26
    v_pk_add_f16 v71, v62, v27
    v_pk_add_f16 v72, v63, v28
    v_pk_add_f16 v73, v64, v29
    v_pk_add_f16 v80, v66, v58
    v_pk_add_f16 v81, v67, v59
    v_pk_add_f16 v82, v68, v60
    v_pk_add_f16 v83, v69, v61
    v_pk_add_f16 v74, v67, v68
    v_pk_add_f16 v75, v68, v69
    v_pk_add_f16 v76, v69, v70
    v_pk_add_f16 v77, v70, v71
    v_pk_add_f16 v78, v71, v72
    v_pk_add_f16 v79, v72, v73
    s_waitcnt lgkmcnt(0)
    v_cmp_eq_u32 vcc, s84, v12
    s_cbranch_vccnz WJK_68
W_69:
    s_sleep 1
    ds_read_b32 v12, v4 offset:68
    s_sub_u32 s39, s39, 1
    s_cbranch_scc1 KS_ABORT
    s_waitcnt lgkmcnt(0)
    v_cmp_ne_u32 vcc, s84, v12
    s_cbranch_vccnz W_69
WJK_68:
    ds_write_b128 v11, v[80:83] offset:0
    v_pk_add_f16 v87, v22, v74
    v_pk_add_f16 v88, v23, v75
    v_pk_add_f16 v89, v24, v76
    v_pk_add_f16 v90, v25, v77
    v_pk_add_f16 v91, v26, v78
    ds_write_b128 v11, v[88:91] offset:3104
    v_pk_add_f16 v84, v70, v62
    v_pk_add_f16 v85, v71, v63
    v_pk_add_f16 v86, v72, v64
    v_pk_add_f16 v92, v74, v83
    v_pk_add_f16 v93, v75, v84
    v_pk_add_f16 v94, v76, v85
    v_pk_add_f16 v95, v77, v86
    ds_write_b128 v11, v[92:95] offset:6176
    v_pk_add_f16 v96, v87, v76
    v_pk_add_f16 v97, v88, v77
    v_pk_add_f16 v98, v89, v78
    v_pk_add_f16 v99, v90, v79
    ds_write_b128 v11, v[96:99] offset:8240
    ds_write_b8 v116, v5 offset:76
    ds_read_b32 v12, v4 offset:84
    v_alignbit_b32 v57, v34, v33, 16
    v_alignbit_b32 v58, v35, v34, 16
    v_alignbit_b32 v59, v36, v35, 16
    v_alignbit_b32 v60, v37, v36, 16
    v_alignbit_b32 v61, v38, v37, 16
    v_alignbit_b32 v62, v39, v38, 16
    v_alignbit_b32 v63, v40, v39, 16
    v_alignbit_b32 v64, v41, v40, 16
    v_pk_add_f16 v66, v57, v34
    v_pk_add_f16 v67, v58, v35
    v_pk_add_f16 v68, v59, v36
    v_pk_add_f16 v69, v60, v37
    v_pk_add_f16 v70, v61, v38
    v_pk_add_f16 v71, v62, v39
    v_pk_add_f16 v72, v63, v40
    v_pk_add_f16 v73, v64, v41
    v_pk_add_f16 v80, v66, v58
    v_pk_add_f16 v81, v67, v59
    v_pk_add_f16 v82, v68, v60
    v_pk_add_f16 v83, v69, v61
    v_pk_add_f16 v74, v67, v68
    v_pk_add_f16 v75, v68, v69
    v_pk_add_f16 v76, v69, v70
    v_pk_add_f16 v77, v70, v71
    v_pk_add_f16 v78, v71, v72
    v_pk_add_f16 v79, v72, v73
    s_waitcnt lgkmcnt(0)
    v_cmp_eq_u32 vcc, s84, v12
    s_cbranch_vccnz WJK_70
W_71:
    s_sleep 1
    ds_read_b32 v12, v4 offset:84
    s_sub_u32 s39, s39, 1
    s_cbranch_scc1 KS_ABORT
    s_waitcnt lgkmcnt(0)
    v_cmp_ne_u32 vcc, s84, v12
    s_cbranch_vccnz W_71
WJK_70:
    ds_write_b128 v11, v[80:83] offset:36672
    v_pk_add_f16 v87, v34, v74
    v_pk_add_f16 v88, v35, v75
    v_pk_add_f16 v89, v36, v76
    v_pk_add_f16 v90, v37, v77
    v_pk_add_f16 v91, v38, v78
    ds_write_b128 v11, v[88:91] offset:39776
    v_pk_add_f16 v84, v70, v62
    v_pk_add_f16 v85, v71, v63
    v_pk_add_f16 v86, v72, v64
    v_pk_add_f16 v92, v74, v83
    v_pk_add_f16 v93, v75, v84
    v_pk_add_f16 v94, v76, v85
    v_pk_add_f16 v95, v77, v86
    ds_write_b128 v11, v[92:95] offset:42848
    v_pk_add_f16 v96, v87, v76
    v_pk_add_f16 v97, v88, v77
    v_pk_add_f16 v98, v89, v78
    v_pk_add_f16 v99, v90, v79
    ds_write_b128 v11, v[96:99] offset:44912
    ds_write_b8 v116, v5 offset:92
    s_cmp_lt_u32 s41, 24
    s_cbranch_scc1 WJE_64
    ds_read_b32 v12, v4 offset:100
    v_alignbit_b32 v57, v46, v45, 16
    v_alignbit_b32 v58, v47, v46, 16
    v_alignbit_b32 v59, v48, v47, 16
    v_alignbit_b32 v60, v49, v48, 16
    v_alignbit_b32 v61, v50, v49, 16
    v_alignbit_b32 v62, v51, v50, 16
    v_alignbit_b32 v63, v52, v51, 16
    v_alignbit_b32 v64, v53, v52, 16
    v_pk_add_f16 v66, v57, v46
    v_pk_add_f16 v67, v58, v47
    v_pk_add_f16 v68, v59, v48
    v_pk_add_f16 v69, v60, v49
    v_pk_add_f16 v70, v61, v50
    v_pk_add_f16 v71, v62, v51
    v_pk_add_f16 v72, v63, v52
    v_pk_add_f16 v73, v64, v53
    v_pk_add_f16 v80, v66, v58
    v_pk_add_f16 v81, v67, v59
    v_pk_add_f16 v82, v68, v60
    v_pk_add_f16 v83, v69, v61
    v_pk_add_f16 v74, v67, v68
    v_pk_add_f16 v75, v68, v69
    v_pk_add_f16 v76, v69, v70
    v_pk_add_f16 v77, v70, v71
    v_pk_add_f16 v78, v71, v72
    v_pk_add_f16 v79, v72, v73
    s_waitcnt lgkmcnt(0)
    v_cmp_eq_u32 vcc, s84, v12
    s_cbranch_vccnz WJK_72
W_73:
    s_sleep 1
    ds_read_b32 v12, v4 offset:100
    s_sub_u32 s39, s39, 1
    s_cbranch_scc1 KS_ABORT
    s_waitcnt lgkmcnt(0)
    v_cmp_ne_u32 vcc, s84, v12
    s_cbranch_vccnz W_73
WJK_72:
    v_add_u32 v11, 73344, v11
    ds_write_b128 v11, v[80:83] offset:0
    v_pk_add_f16 v87, v46, v74
    v_pk_add_f16 v88, v47, v75
    v_pk_add_f16 v89, v48, v76
    v_pk_add_f16 v90, v49, v77
    v_pk_add_f16 v91, v50, v78
    ds_write_b128 v11, v[88:91] offset:3104
    v_pk_add_f16 v84, v70, v62
    v_pk_add_f16 v85, v71, v63
    v_pk_add_f16 v86, v72, v64
    v_pk_add_f16 v92, v74, v83
    v_pk_add_f16 v93, v75, v84
    v_pk_add_f16 v94, v76, v85
    v_pk_add_f16 v95, v77, v86
    ds_write_b128 v11, v[92:95] offset:6176
    v_pk_add_f16 v96, v87, v76
    v_pk_add_f16 v97, v88, v77
    v_pk_add_f16 v98, v89, v78
    v_pk_add_f16 v99, v90, v79
    ds_write_b128 v11, v[96:99] offset:8240
    ds_write_b8 v116, v5 offset:108
    s_branch WJE_64
WJ1_65:
    ds_read_b32 v12, v4 offset:68
    s_waitcnt lgkmcnt(7)
    v_alignbit_b32 v57, v22, v21, 16
    v_alignbit_b32 v58, v23, v22, 16
    v_alignbit_b32 v59, v24, v23, 16
    v_alignbit_b32 v60, v25, v24, 16
    v_alignbit_b32 v61, v26, v25, 16
    v_alignbit_b32 v62, v27, v26, 16
    v_alignbit_b32 v63, v28, v27, 16
    v_pk_add_f16 v66, v57, v22
    v_pk_add_f16 v67, v58, v23
    v_pk_add_f16 v68, v59, v24
    v_pk_add_f16 v69, v60, v25
    v_pk_add_f16 v70, v61, v26
    v_pk_add_f16 v71, v62, v27
    v_pk_add_f16 v72, v63, v28
    v_pk_add_f16 v80, v66, v58
    v_pk_add_f16 v81, v67, v59
    v_pk_add_f16 v82, v68, v60
    v_pk_add_f16 v83, v69, v61
    v_pk_add_f16 v75, v68, v69
    v_pk_add_f16 v76, v69, v70
    v_pk_add_f16 v77, v70, v71
    v_pk_add_f16 v78, v71, v72
    s_waitcnt lgkmcnt(0)
    v_cmp_eq_u32 vcc, s84, v12
    s_cbranch_vccnz WJK_74
W_75:
    s_sleep 1
    ds_read_b32 v12, v4 offset:68
    s_sub_u32 s39, s39, 1
    s_cbranch_scc1 KS_ABORT
    s_waitcnt lgkmcnt(0)
    v_cmp_ne_u32 vcc, s84, v12
    s_cbranch_vccnz W_75
WJK_74:
    ds_write_b128 v11, v[80:83] offset:0
    v_pk_add_f16 v88, v23, v75
    v_pk_add_f16 v89, v24, v76
    v_pk_add_f16 v90, v25, v77
    v_pk_add_f16 v91, v26, v78
    ds_write_b128 v11, v[88:91] offset:3104
    ds_write_b8 v116, v5 offset:76
    ds_read_b32 v12, v4 offset:84
    v_alignbit_b32 v57, v34, v33, 16
    v_alignbit_b32 v58, v35, v34, 16
    v_alignbit_b32 v59, v36, v35, 16
    v_alignbit_b32 v60, v37, v36, 16
    v_alignbit_b32 v61, v38, v37, 16
    v_alignbit_b32 v62, v39, v38, 16
    v_alignbit_b32 v63, v40, v39, 16
    v_pk_add_f16 v66, v57, v34
    v_pk_add_f16 v67, v58, v35
    v_pk_add_f16 v68, v59, v36
    v_pk_add_f16 v69, v60, v37
    v_pk_add_f16 v70, v61, v38
    v_pk_add_f16 v71, v62, v39
    v_pk_add_f16 v72, v63, v40
    v_pk_add_f16 v80, v66, v58
    v_pk_add_f16 v81, v67, v59
    v_pk_add_f16 v82, v68, v60
    v_pk_add_f16 v83, v69, v61
    v_pk_add_f16 v75, v68, v69
    v_pk_add_f16 v76, v69, v70
    v_pk_add_f16 v77, v70, v71
    v_pk_add_f16 v78, v71, v72
    s_waitcnt lgkmcnt(0)
    v_cmp_eq_u32 vcc, s84, v12
    s_cbranch_vccnz WJK_76
W_77:
    s_sleep 1
    ds_read_b32 v12, v4 offset:84
    s_sub_u32 s39, s39, 1
    s_cbranch_scc1 KS_ABORT
    s_waitcnt lgkmcnt(0)
    v_cmp_ne_u32 vcc, s84, v12
    s_cbranch_vccnz W_77
WJK_76:
    ds_write_b128 v11, v[80:83] offset:36672
    v_pk_add_f16 v88, v35, v75
    v_pk_add_f16 v89, v36, v76
    v_pk_add_f16 v90, v37, v77
    v_pk_add_f16 v91, v38, v78
    ds_write_b128 v11, v[88:91] offset:39776
    ds_write_b8 v116, v5 offset:92
    s_cmp_lt_u32 s41, 24
    s_cbranch_scc1 WJE_64
    ds_read_b32 v12, v4 offset:100
    v_alignbit_b32 v57, v46, v45, 16
    v_alignbit_b32 v58, v47, v46, 16
    v_alignbit_b32 v59, v48, v47, 16
    v_alignbit_b32 v60, v49, v48, 16
    v_alignbit_b32 v61, v50, v49, 16
    v_alignbit_b32 v62, v51, v50, 16
    v_alignbit_b32 v63, v52, v51, 16
    v_pk_add_f16 v66, v57, v46
    v_pk_add_f16 v67, v58, v47
    v_pk_add_f16 v68, v59, v48
    v_pk_add_f16 v69, v60, v49
    v_pk_add_f16 v70, v61, v50
    v_pk_add_f16 v71, v62, v51
    v_pk_add_f16 v72, v63, v52
    v_pk_add_f16 v80, v66, v58
    v_pk_add_f16 v81, v67, v59
    v_pk_add_f16 v82, v68, v60
    v_pk_add_f16 v83, v69, v61
    v_pk_add_f16 v75, v68, v69
    v_pk_add_f16 v76, v69, v70
    v_pk_add_f16 v77, v70, v71
    v_pk_add_f16 v78, v71, v72
    s_waitcnt lgkmcnt(0)
    v_cmp_eq_u32 vcc, s84, v12
    s_cbranch_vccnz WJK_78
W_79:
    s_sleep 1
    ds_read_b32 v12, v4 offset:100
    s_sub_u32 s39, s39, 1
    s_cbranch_scc1 KS_ABORT
    s_waitcnt lgkmcnt(0)
    v_cmp_ne_u32 vcc, s84, v12
    s_cbranch_vccnz W_79
WJK_78:
    v_add_u32 v11, 73344, v11
    ds_write_b128 v11, v[80:83] offset:0
    v_pk_add_f16 v88, v47, v75
    v_pk_add_f16 v89, v48, v76
    v_pk_add_f16 v90, v49, v77
    v_pk_add_f16 v91, v50, v78
    ds_write_b128 v11, v[88:91] offset:3104
    ds_write_b8 v116, v5 offset:108
    s_branch WJE_64
WJ2_66:
    ds_write_b8 v116, v5 offset:76
    ds_write_b8 v116, v5 offset:92
    ds_write_b8 v116, v5 offset:108
    s_sub_u32 s94, s41, 18
    s_and_b32 s94, s94, 31
    s_cmp_ge_u32 s94, 14
    s_cbranch_scc1 WJE_64
    v_mul_u32_u24 v100, 57, v1
    v_lshrrev_b32 v100, 9, v100
    v_mul_u32_u24 v101, 9, v100
    v_sub_u32 v101, v1, v101
    v_mul_u32_u24 v100, 9216, v100
    v_lshl_add_u32 v100, v101, 7, v100
W_80:
    s_sleep 1
    ds_read_b32 v12, v4 offset:16
    s_sub_u32 s39, s39, 1
    s_cbranch_scc1 KS_ABORT
    s_waitcnt lgkmcnt(0)
    v_cmp_ne_u32 vcc, s84, v12
    s_cbranch_vccnz W_80
    s_bitcmp1_b32 s94, 0
    s_cselect_b32 s72, s28, s26
    s_cselect_b32 s73, s29, s27
    s_mov_b32 s74, 0x510000
    s_mov_b32 s75, 0x20000
    s_lshr_b32 s95, s94, 1
    s_mul_i32 s95, s95, 64512
    s_mul_i32 s96, s40, 1152
    s_add_u32 s95, s95, s96
    s_add_u32 s96, s95, 4451328
    buffer_load_dword v102, v100, s[72:75], s96 offen nt
    buffer_load_dword v102, v100, s[72:75], s96 offen sc1
    s_add_u32 s96, s95, 4902912
    buffer_load_dword v102, v100, s[72:75], s96 offen nt
    buffer_load_dword v102, v100, s[72:75], s96 offen sc1
KS_PF2D:
WJE_64:
    s_setprio 0
    s_lshr_b32 s92, s90, 6
    s_lshl_b32 s92, s92, 9
    s_bfe_u32 s93, s90, 0x20004
    s_lshl_b32 s93, s93, 6
    s_add_u32 s92, s92, s93
    s_and_b32 s93, s90, 3
    s_lshl_b32 s93, s93, 4
    s_add_u32 s92, s92, s93
    s_and_b32 s93, s90, 12
    s_add_u32 s92, s92, s93
    s_lshr_b32 s93, s38, 1
    s_lshl_b32 s93, s93, 8
    s_add_u32 s92, s92, s93
    s_and_b32 s93, s38, 1
    s_lshl_b32 s93, s93, 1
    s_add_u32 s92, s92, s93
    v_lshrrev_b32 v113, 5, v1
    v_and_b32 v114, 31, v1
    v_add_u32 v112, s92, v113
    v_mul_u32_u24 v115, 1152, v112
    v_lshl_add_u32 v8, v114, 2, v115
    v_lshl_add_u32 v115, v114, 4, v115
    v_lshlrev_b32 v7, 2, v114
    v_lshlrev_b32 v6, 4, v114
    v_bfe_u32 v111, v1, 3, 1
    v_add_u32 v111, s92, v111
    v_mul_u32_u24 v111, 1152, v111
    v_and_b32 v9, 7, v1
    v_lshl_add_u32 v111, v9, 4, v111
    s_mov_b32 s64, s4
    s_mov_b32 s65, s5
    s_mov_b32 s66, 0x240000
    s_mov_b32 s67, 0x20000
    s_mov_b32 s68, s24
    s_mov_b32 s69, s25
    s_mov_b32 s70, 0x480
    s_mov_b32 s71, 0x20000
    buffer_load_dwordx4 v[10:13], v115, s[64:67], 0 offen
    buffer_load_dwordx4 v[14:17], v115, s[64:67], 0 offen offset:512
    buffer_load_dword v18, v8, s[64:67], 0 offen offset:1024
    buffer_load_dwordx4 v[50:53], v6, s[68:71], 0 offen
    buffer_load_dwordx4 v[54:57], v6, s[68:71], 0 offen offset:512
    buffer_load_dword v58, v7, s[68:71], 0 offen offset:1024
KS_L4:
    s_add_u32 s64, s36, 0x600000
    s_addc_u32 s65, s37, 0
    s_mov_b32 s66, 0x240000
    s_mov_b32 s67, 0x20000
    s_mov_b32 s68, s32
    s_mov_b32 s69, s33
    s_mov_b32 s70, 0x240000
    s_mov_b32 s71, 0x20000
    s_add_u32 s72, s36, 0x300000
    s_addc_u32 s73, s37, 0
    s_mov_b32 s74, 0x240000
    s_mov_b32 s75, 0x20000
    s_add_u32 s76, s36, 0x840000
    s_addc_u32 s77, s37, 0
    s_mov_b32 s78, 0x3000
    s_mov_b32 s79, 0x20000
    s_not_b32 s93, s90
    v_xor_b32 v8, s93, v0
    v_lshrrev_b32 v6, 1, v0
    v_lshlrev_b32 v6, 6, v6
    v_and_b32 v8, 1, v8
    v_lshl_add_u32 v6, v8, 4, v6
    s_lshr_b32 s92, s90, 2
    s_lshl_b32 s92, s92, 15
    s_and_b32 s93, s90, 1
    s_lshl_b32 s93, s93, 14
    s_add_u32 s92, s92, s93
    s_and_b32 s93, s90, 2
    s_lshl_b32 s93, s93, 4
    s_add_u32 s92, s92, s93
    s_lshr_b32 s94, s90, 2
    s_lshl_b32 s94, s94, 12
    s_and_b32 s93, s90, 3
    s_lshl_b32 s93, s93, 4
    s_add_u32 s94, s94, s93
    s_lshl_b32 s93, s38, 10
    s_add_u32 s94, s94, s93
    s_add_u32 s94, s94, 0x200000
    v_lshlrev_b32 v9, 6, v2
    s_lshl_b32 s93, s90, 5
    s_and_b32 s95, s93, 0x1f80
    v_xor_b32 v6, s95, v6
    s_and_b32 s95, s93, 0x380
    v_xor_b32 v9, s95, v9
    s_and_b32 s95, s93, 0xc00
    s_xor_b32 s94, s94, s95
    s_and_b32 s93, s90, 1
    s_lshl_b32 s93, s93, 13
    s_xor_b32 s92, s92, s93
    s_xor_b32 s93, s92, 0x2000
    s_mul_i32 s95, s38, 2304
    s_add_u32 s95, s95, 17088
    v_lshl_add_u32 v117, v114, 5, s95
    v_lshl_add_u32 v110, v114, 3, s95
    s_lshl_b32 s95, s38, 9
    s_add_u32 s95, s95, 26368
    v_lshl_add_u32 v108, v1, 2, s95
    v_lshl_add_u32 v109, v1, 4, s95
    s_mov_b32 s95, 0x02020202
    v_mul_lo_u32 v118, v113, s95
    v_add_u32 v118, 0x05040100, v118
    v_lshlrev_b32 v8, 2, v0
    v_add_u32 v8, 17088, v8
    s_lshl_b32 s95, s38, 6
    s_add_u32 s95, s95, 19136
    v_lshl_add_u32 v119, v2, 2, s95
    s_waitcnt vmcnt(0)
    v_lshlrev_b32 v20, 16, v10
    v_and_b32 v21, 0xffff0000, v10
    v_lshlrev_b32 v22, 16, v11
    v_and_b32 v23, 0xffff0000, v11
    v_lshlrev_b32 v24, 16, v12
    v_and_b32 v25, 0xffff0000, v12
    v_lshlrev_b32 v26, 16, v13
    v_and_b32 v27, 0xffff0000, v13
    v_lshlrev_b32 v28, 16, v14
    v_and_b32 v29, 0xffff0000, v14
    v_lshlrev_b32 v30, 16, v15
    v_and_b32 v31, 0xffff0000, v15
    v_lshlrev_b32 v32, 16, v16
    v_and_b32 v33, 0xffff0000, v16
    v_lshlrev_b32 v34, 16, v17
    v_and_b32 v35, 0xffff0000, v17
    v_lshlrev_b32 v36, 16, v18
    v_and_b32 v37, 0xffff0000, v18
W_81:
    s_sleep 1
    ds_read_b32 v60, v4 offset:52
    s_sub_u32 s39, s39, 1
    s_cbranch_scc1 KS_ABORT
    s_waitcnt lgkmcnt(0)
    v_cmp_ne_u32 vcc, s84, v60
    s_cbranch_vccnz W_81
    s_setprio 3
    s_branch ZPE_83
ZP_82:
    s_sleep 1
ZPE_83:
    buffer_load_dwordx4 v[68:71], v4, s[64:67], s94 offen sc1
    s_sub_u32 s39, s39, 1
    s_cbranch_scc1 KS_ABORT
    s_waitcnt vmcnt(0)
    v_max3_u32 v44, v68, v69, v70
    v_max_u32 v44, v44, v71
    v_cmp_eq_u32 vcc, -1, v44
    s_cbranch_vccnz ZP_82
    s_branch ZPE_85
ZP_84:
    s_sleep 1
ZPE_85:
    buffer_load_dwordx4 v[60:63], v6, s[64:67], s92 offen sc1
    buffer_load_dwordx4 v[64:67], v6, s[64:67], s93 offen sc1
    buffer_load_dwordx4 v[68:71], v9, s[64:67], s94 offen sc1
    s_sub_u32 s39, s39, 1
    s_cbranch_scc1 KS_ABORT
    s_waitcnt vmcnt(0)
    v_max3_u32 v44, v60, v61, v62
    v_max3_u32 v44, v44, v63, v64
    v_max3_u32 v44, v44, v65, v66
    v_max3_u32 v44, v44, v67, v68
    v_max3_u32 v44, v44, v69, v70
    v_max_u32 v44, v44, v71
    v_cmp_eq_u32 vcc, -1, v44
    s_cbranch_vccnz ZP_84
    ds_write2st64_b32 v8, v60, v61 offset0:0 offset1:9
    ds_write2st64_b32 v8, v62, v63 offset0:18 offset1:27
    ds_write2st64_b32 v8, v64, v65 offset0:4 offset1:13
    ds_write2st64_b32 v8, v66, v67 offset0:22 offset1:31
    ds_write2st64_b32 v119, v68, v69 offset0:0 offset1:9
    ds_write2st64_b32 v119, v70, v71 offset0:18 offset1:27
    ds_write_b8 v116, v5 offset:20
W_86:
    ds_read_b32 v60, v4 offset:20
    s_sub_u32 s39, s39, 1
    s_cbranch_scc1 KS_ABORT
    s_waitcnt lgkmcnt(0)
    v_cmp_ne_u32 vcc, s84, v60
    s_cbranch_vccnz W_86
    ds_read_b128 v[60:63], v117 offset:0
    ds_read_b128 v[64:67], v117 offset:16
    ds_read_b128 v[68:71], v117 offset:1024
    ds_read_b128 v[72:75], v117 offset:1040
    ds_read_b64 v[76:77], v110 offset:2048
    s_waitcnt lgkmcnt(4)
    v_perm_b32 v44, v61, v60, v118
    v_lshlrev_b32 v46, 16, v44
    v_and_b32 v47, 0xffff0000, v44
    v_pk_add_f32 v[46:47], v[46:47], v[20:21]
    v_cvt_pk_bf16_f32 v44, v46, v47
    v_lshlrev_b32 v20, 16, v44
    v_and_b32 v21, 0xffff0000, v44
    v_perm_b32 v44, v63, v62, v118
    v_lshlrev_b32 v46, 16, v44
    v_and_b32 v47, 0xffff0000, v44
    v_pk_add_f32 v[46:47], v[46:47], v[22:23]
    v_cvt_pk_bf16_f32 v44, v46, v47
    v_lshlrev_b32 v22, 16, v44
    v_and_b32 v23, 0xffff0000, v44
    s_waitcnt lgkmcnt(3)
    v_perm_b32 v44, v65, v64, v118
    v_lshlrev_b32 v46, 16, v44
    v_and_b32 v47, 0xffff0000, v44
    v_pk_add_f32 v[46:47], v[46:47], v[24:25]
    v_cvt_pk_bf16_f32 v44, v46, v47
    v_lshlrev_b32 v24, 16, v44
    v_and_b32 v25, 0xffff0000, v44
    v_perm_b32 v44, v67, v66, v118
    v_lshlrev_b32 v46, 16, v44
    v_and_b32 v47, 0xffff0000, v44
    v_pk_add_f32 v[46:47], v[46:47], v[26:27]
    v_cvt_pk_bf16_f32 v44, v46, v47
    v_lshlrev_b32 v26, 16, v44
    v_and_b32 v27, 0xffff0000, v44
    s_waitcnt lgkmcnt(2)
    v_perm_b32 v44, v69, v68, v118
    v_lshlrev_b32 v46, 16, v44
    v_and_b32 v47, 0xffff0000, v44
    v_pk_add_f32 v[46:47], v[46:47], v[28:29]
    v_cvt_pk_bf16_f32 v44, v46, v47
    v_lshlrev_b32 v28, 16, v44
    v_and_b32 v29, 0xffff0000, v44
    v_perm_b32 v44, v71, v70, v118
    v_lshlrev_b32 v46, 16, v44
    v_and_b32 v47, 0xffff0000, v44
    v_pk_add_f32 v[46:47], v[46:47], v[30:31]
    v_cvt_pk_bf16_f32 v44, v46, v47
    v_lshlrev_b32 v30, 16, v44
    v_and_b32 v31, 0xffff0000, v44
    s_waitcnt lgkmcnt(1)
    v_perm_b32 v44, v73, v72, v118
    v_lshlrev_b32 v46, 16, v44
    v_and_b32 v47, 0xffff0000, v44
    v_pk_add_f32 v[46:47], v[46:47], v[32:33]
    v_cvt_pk_bf16_f32 v44, v46, v47
    v_lshlrev_b32 v32, 16, v44
    v_and_b32 v33, 0xffff0000, v44
    v_perm_b32 v44, v75, v74, v118
    v_lshlrev_b32 v46, 16, v44
    v_and_b32 v47, 0xffff0000, v44
    v_pk_add_f32 v[46:47], v[46:47], v[34:35]
    v_cvt_pk_bf16_f32 v44, v46, v47
    v_lshlrev_b32 v34, 16, v44
    v_and_b32 v35, 0xffff0000, v44
    s_waitcnt lgkmcnt(0)
    v_perm_b32 v44, v77, v76, v118
    v_lshlrev_b32 v46, 16, v44
    v_and_b32 v47, 0xffff0000, v44
    v_pk_add_f32 v[46:47], v[46:47], v[36:37]
    v_cvt_pk_bf16_f32 v44, v46, v47
    v_lshlrev_b32 v36, 16, v44
    v_and_b32 v37, 0xffff0000, v44
    v_pk_add_f32 v[44:45], v[20:21], v[22:23]
    v_pk_add_f32 v[46:47], v[24:25], v[26:27]
    v_pk_add_f32 v[44:45], v[44:45], v[28:29]
    v_pk_add_f32 v[46:47], v[46:47], v[30:31]
    v_pk_add_f32 v[44:45], v[44:45], v[32:33]
    v_pk_add_f32 v[46:47], v[46:47], v[34:35]
    v_pk_add_f32 v[44:45], v[44:45], v[36:37]
    v_pk_add_f32 v[44:45], v[44:45], v[46:47]
    v_add_f32 v44, v44, v45
    s_nop 1
    v_add_f32_dpp v44, v44, v44 row_ror:8 row_mask:0xf bank_mask:0xf
    s_nop 1
    v_add_f32_dpp v44, v44, v44 row_ror:4 row_mask:0xf bank_mask:0xf
    s_nop 1
    v_add_f32_dpp v44, v44, v44 row_ror:2 row_mask:0xf bank_mask:0xf
    s_nop 1
    v_add_f32_dpp v44, v44, v44 row_ror:1 row_mask:0xf bank_mask:0xf
    v_mov_b32 v46, v44
    s_nop 1
    v_permlane16_swap_b32 v44, v46
    v_add_f32 v44, v44, v46
    v_mul_f32 v48, 0x3ae38e39, v44
    v_mov_b32 v49, v48
    v_cvt_pk_bf16_f32 v40, v48, v48
    v_and_b32 v40, 0xffff0000, v40
    v_mov_b32 v41, v40
    v_pk_add_f32 v[42:43], v[20:21], v[48:49] neg_lo:[0,1] neg_hi:[0,1]
    v_pk_mul_f32 v[44:45], v[42:43], v[42:43]
    v_pk_add_f32 v[42:43], v[22:23], v[48:49] neg_lo:[0,1] neg_hi:[0,1]
    v_pk_mul_f32 v[46:47], v[42:43], v[42:43]
    v_pk_add_f32 v[42:43], v[24:25], v[48:49] neg_lo:[0,1] neg_hi:[0,1]
    v_pk_fma_f32 v[44:45], v[42:43], v[42:43], v[44:45]
    v_pk_add_f32 v[42:43], v[26:27], v[48:49] neg_lo:[0,1] neg_hi:[0,1]
    v_pk_fma_f32 v[46:47], v[42:43], v[42:43], v[46:47]
    v_pk_add_f32 v[42:43], v[28:29], v[48:49] neg_lo:[0,1] neg_hi:[0,1]
    v_pk_fma_f32 v[44:45], v[42:43], v[42:43], v[44:45]
    v_pk_add_f32 v[42:43], v[30:31], v[48:49] neg_lo:[0,1] neg_hi:[0,1]
    v_pk_fma_f32 v[46:47], v[42:43], v[42:43], v[46:47]
    v_pk_add_f32 v[42:43], v[32:33], v[48:49] neg_lo:[0,1] neg_hi:[0,1]
    v_pk_fma_f32 v[44:45], v[42:43], v[42:43], v[44:45]
    v_pk_add_f32 v[42:43], v[34:35], v[48:49] neg_lo:[0,1] neg_hi:[0,1]
    v_pk_fma_f32 v[46:47], v[42:43], v[42:43], v[46:47]
    v_pk_add_f32 v[42:43], v[36:37], v[48:49] neg_lo:[0,1] neg_hi:[0,1]
    v_pk_fma_f32 v[44:45], v[42:43], v[42:43], v[44:45]
    v_pk_add_f32 v[44:45], v[44:45], v[46:47]
    v_add_f32 v44, v44, v45
    s_nop 1
    v_add_f32_dpp v44, v44, v44 row_ror:8 row_mask:0xf bank_mask:0xf
    s_nop 1
    v_add_f32_dpp v44, v44, v44 row_ror:4 row_mask:0xf bank_mask:0xf
    s_nop 1
    v_add_f32_dpp v44, v44, v44 row_ror:2 row_mask:0xf bank_mask:0xf
    s_nop 1
    v_add_f32_dpp v44, v44, v44 row_ror:1 row_mask:0xf bank_mask:0xf
    v_mov_b32 v46, v44
    s_nop 1
    v_permlane16_swap_b32 v44, v46
    v_add_f32 v44, v44, v46
    v_mul_f32 v44, 0x3ae38e39, v44
    v_cvt_pk_bf16_f32 v44, v44, v44
    v_and_b32 v44, 0xffff0000, v44
    v_add_f32 v44, 0x3727c5ac, v44
    v_cvt_pk_bf16_f32 v44, v44, v44
    v_and_b32 v44, 0xffff0000, v44
    v_sqrt_f32 v44, v44
    s_nop 0
    v_cvt_pk_bf16_f32 v44, v44, v44
    v_and_b32 v44, 0xffff0000, v44
    v_rcp_f32 v42, v44
    s_nop 0
    v_mov_b32 v43, v42
    v_mov_b32 v60, 0
    v_mov_b32 v61, 0
    v_pk_add_f32 v[44:45], v[20:21], v[40:41] neg_lo:[0,1] neg_hi:[0,1]
    v_cvt_pk_bf16_f32 v10, v44, v45
    v_lshlrev_b32 v44, 16, v10
    v_and_b32 v45, 0xffff0000, v10
    v_pk_mul_f32 v[44:45], v[44:45], v[42:43]
    v_cvt_pk_bf16_f32 v10, v44, v45
    v_lshlrev_b32 v44, 16, v10
    v_and_b32 v45, 0xffff0000, v10
    v_lshlrev_b32 v46, 16, v50
    v_and_b32 v47, 0xffff0000, v50
    v_pk_fma_f32 v[60:61], v[44:45], v[46:47], v[60:61]
    v_pk_add_f32 v[20:21], v[44:45], v[20:21]
    v_pk_add_f32 v[44:45], v[22:23], v[40:41] neg_lo:[0,1] neg_hi:[0,1]
    v_cvt_pk_bf16_f32 v11, v44, v45
    v_lshlrev_b32 v44, 16, v11
    v_and_b32 v45, 0xffff0000, v11
    v_pk_mul_f32 v[44:45], v[44:45], v[42:43]
    v_cvt_pk_bf16_f32 v11, v44, v45
    v_lshlrev_b32 v44, 16, v11
    v_and_b32 v45, 0xffff0000, v11
    v_lshlrev_b32 v46, 16, v51
    v_and_b32 v47, 0xffff0000, v51
    v_pk_fma_f32 v[60:61], v[44:45], v[46:47], v[60:61]
    v_pk_add_f32 v[22:23], v[44:45], v[22:23]
    v_pk_add_f32 v[44:45], v[24:25], v[40:41] neg_lo:[0,1] neg_hi:[0,1]
    v_cvt_pk_bf16_f32 v12, v44, v45
    v_lshlrev_b32 v44, 16, v12
    v_and_b32 v45, 0xffff0000, v12
    v_pk_mul_f32 v[44:45], v[44:45], v[42:43]
    v_cvt_pk_bf16_f32 v12, v44, v45
    v_lshlrev_b32 v44, 16, v12
    v_and_b32 v45, 0xffff0000, v12
    v_lshlrev_b32 v46, 16, v52
    v_and_b32 v47, 0xffff0000, v52
    v_pk_fma_f32 v[60:61], v[44:45], v[46:47], v[60:61]
    v_pk_add_f32 v[24:25], v[44:45], v[24:25]
    v_pk_add_f32 v[44:45], v[26:27], v[40:41] neg_lo:[0,1] neg_hi:[0,1]
    v_cvt_pk_bf16_f32 v13, v44, v45
    v_lshlrev_b32 v44, 16, v13
    v_and_b32 v45, 0xffff0000, v13
    v_pk_mul_f32 v[44:45], v[44:45], v[42:43]
    v_cvt_pk_bf16_f32 v13, v44, v45
    v_lshlrev_b32 v44, 16, v13
    v_and_b32 v45, 0xffff0000, v13
    v_lshlrev_b32 v46, 16, v53
    v_and_b32 v47, 0xffff0000, v53
    v_pk_fma_f32 v[60:61], v[44:45], v[46:47], v[60:61]
    v_pk_add_f32 v[26:27], v[44:45], v[26:27]
    v_pk_add_f32 v[44:45], v[28:29], v[40:41] neg_lo:[0,1] neg_hi:[0,1]
    v_cvt_pk_bf16_f32 v14, v44, v45
    v_lshlrev_b32 v44, 16, v14
    v_and_b32 v45, 0xffff0000, v14
    v_pk_mul_f32 v[44:45], v[44:45], v[42:43]
    v_cvt_pk_bf16_f32 v14, v44, v45
    v_lshlrev_b32 v44, 16, v14
    v_and_b32 v45, 0xffff0000, v14
    v_lshlrev_b32 v46, 16, v54
    v_and_b32 v47, 0xffff0000, v54
    v_pk_fma_f32 v[60:61], v[44:45], v[46:47], v[60:61]
    v_pk_add_f32 v[28:29], v[44:45], v[28:29]
    v_pk_add_f32 v[44:45], v[30:31], v[40:41] neg_lo:[0,1] neg_hi:[0,1]
    v_cvt_pk_bf16_f32 v15, v44, v45
    v_lshlrev_b32 v44, 16, v15
    v_and_b32 v45, 0xffff0000, v15
    v_pk_mul_f32 v[44:45], v[44:45], v[42:43]
    v_cvt_pk_bf16_f32 v15, v44, v45
    v_lshlrev_b32 v44, 16, v15
    v_and_b32 v45, 0xffff0000, v15
    v_lshlrev_b32 v46, 16, v55
    v_and_b32 v47, 0xffff0000, v55
    v_pk_fma_f32 v[60:61], v[44:45], v[46:47], v[60:61]
    v_pk_add_f32 v[30:31], v[44:45], v[30:31]
    v_pk_add_f32 v[44:45], v[32:33], v[40:41] neg_lo:[0,1] neg_hi:[0,1]
    v_cvt_pk_bf16_f32 v16, v44, v45
    v_lshlrev_b32 v44, 16, v16
    v_and_b32 v45, 0xffff0000, v16
    v_pk_mul_f32 v[44:45], v[44:45], v[42:43]
    v_cvt_pk_bf16_f32 v16, v44, v45
    v_lshlrev_b32 v44, 16, v16
    v_and_b32 v45, 0xffff0000, v16
    v_lshlrev_b32 v46, 16, v56
    v_and_b32 v47, 0xffff0000, v56
    v_pk_fma_f32 v[60:61], v[44:45], v[46:47], v[60:61]
    v_pk_add_f32 v[32:33], v[44:45], v[32:33]
    v_pk_add_f32 v[44:45], v[34:35], v[40:41] neg_lo:[0,1] neg_hi:[0,1]
    v_cvt_pk_bf16_f32 v17, v44, v45
    v_lshlrev_b32 v44, 16, v17
    v_and_b32 v45, 0xffff0000, v17
    v_pk_mul_f32 v[44:45], v[44:45], v[42:43]
    v_cvt_pk_bf16_f32 v17, v44, v45
    v_lshlrev_b32 v44, 16, v17
    v_and_b32 v45, 0xffff0000, v17
    v_lshlrev_b32 v46, 16, v57
    v_and_b32 v47, 0xffff0000, v57
    v_pk_fma_f32 v[60:61], v[44:45], v[46:47], v[60:61]
    v_pk_add_f32 v[34:35], v[44:45], v[34:35]
    v_pk_add_f32 v[44:45], v[36:37], v[40:41] neg_lo:[0,1] neg_hi:[0,1]
    v_cvt_pk_bf16_f32 v18, v44, v45
    v_lshlrev_b32 v44, 16, v18
    v_and_b32 v45, 0xffff0000, v18
    v_pk_mul_f32 v[44:45], v[44:45], v[42:43]
    v_cvt_pk_bf16_f32 v18, v44, v45
    v_lshlrev_b32 v44, 16, v18
    v_and_b32 v45, 0xffff0000, v18
    v_lshlrev_b32 v46, 16, v58
    v_and_b32 v47, 0xffff0000, v58
    v_pk_fma_f32 v[60:61], v[44:45], v[46:47], v[60:61]
    v_pk_add_f32 v[36:37], v[44:45], v[36:37]
    v_add_f32 v60, v60, v61
    s_nop 1
    v_add_f32_dpp v60, v60, v60 row_ror:8 row_mask:0xf bank_mask:0xf
    s_nop 1
    v_add_f32_dpp v60, v60, v60 row_ror:4 row_mask:0xf bank_mask:0xf
    s_nop 1
    v_add_f32_dpp v60, v60, v60 row_ror:2 row_mask:0xf bank_mask:0xf
    s_nop 1
    v_add_f32_dpp v60, v60, v60 row_ror:1 row_mask:0xf bank_mask:0xf
    v_mov_b32 v61, v60
    s_nop 1
    v_permlane16_swap_b32 v60, v61
    v_add_f32 v60, v60, v61
    v_cvt_pk_bf16_f32 v60, v60, v60
    v_ashrrev_i32 v61, 31, v60
    v_or_b32 v61, 0x80000000, v61
    v_xor_b32 v60, v60, v61
    v_and_b32 v60, 0xffff0000, v60
    v_sub_u32 v62, 0x87ff, v112
    v_or_b32 v60, v60, v62
    v_lshl_add_u32 v61, v116, 1, v113
    v_lshlrev_b32 v61, 2, v61
    s_mov_b32 exec_lo, 1
    s_mov_b32 exec_hi, 1
    ds_write_b32 v61, v60 offset:800
    s_mov_b64 exec, 1
    ds_add_rtn_u32 v62, v4, v5 offset:12
    s_mov_b64 exec, 3
    v_lshlrev_b32 v61, 4, v114
    s_lshl_b32 s92, s90, 5
    ds_read_b128 v[64:67], v61 offset:800
    s_waitcnt lgkmcnt(1)
    v_readfirstlane_b32 s93, v62
    s_cmp_lg_u32 s93, 3
    s_cbranch_scc1 KS_NOKEY
    s_waitcnt lgkmcnt(0)
    buffer_store_dwordx4 v[64:67], v61, s[76:79], s92 offen sc1
KS_NOKEY:
    s_mov_b64 exec, -1
    v_cvt_pk_bf16_f32 v58, v36, v37
    ds_write_b32 v108, v18
    ds_write_b32 v108, v58 offset:256
    ds_read_b128 v[64:67], v109
    buffer_store_dwordx4 v[10:13], v115, s[72:75], 0 offen sc1
    buffer_store_dwordx4 v[14:17], v115, s[72:75], 0 offen offset:512 sc1
    v_cvt_pk_bf16_f32 v50, v20, v21
    v_cvt_pk_bf16_f32 v51, v22, v23
    v_cvt_pk_bf16_f32 v52, v24, v25
    v_cvt_pk_bf16_f32 v53, v26, v27
    v_cvt_pk_bf16_f32 v54, v28, v29
    v_cvt_pk_bf16_f32 v55, v30, v31
    v_cvt_pk_bf16_f32 v56, v32, v33
    v_cvt_pk_bf16_f32 v57, v34, v35
    s_mov_b64 exec, 0xffff
    s_waitcnt lgkmcnt(0)
    buffer_store_dwordx4 v[64:67], v111, s[72:75], 0 offen offset:1024 sc1
    s_mov_b64 exec, 0xffff0000
    buffer_store_dwordx4 v[64:67], v111, s[68:71], 0 offen offset:1024 sc1
    s_mov_b64 exec, -1
    buffer_store_dwordx4 v[50:53], v115, s[68:71], 0 offen sc1
    buffer_store_dwordx4 v[54:57], v115, s[68:71], 0 offen offset:512 sc1
    s_cmp_lg_u32 s93, 3
    s_cbranch_scc1 KS_NOKEY2
    s_waitcnt vmcnt(6)
    ds_write_b32 v4, v5 offset:24
KS_NOKEY2:
    s_waitcnt vmcnt(0)
    s_mov_b64 exec, 1
    ds_add_rtn_u32 v62, v4, v5 offset:176
    s_waitcnt lgkmcnt(0)
    v_cmp_eq_u32 vcc, 3, v62
    s_and_b64 exec, exec, vcc
    s_cbranch_execz KS_NOF2
    s_lshl_b32 s92, s2, 4
    s_add_u32 s92, s92, 8192
    buffer_store_dword v5, v4, s[76:79], s92 offen sc1
KS_NOF2:
    s_mov_b64 exec, -1
    s_setprio 0
    s_cmp_lt_u32 s41, 18
    s_cbranch_scc1 KS_B
    s_waitcnt lgkmcnt(0)
    s_endpgm
KS_T:
    s_setprio 0
    s_cmp_ge_u32 s38, 10
    s_cbranch_scc1 KS_P
    v_and_b32 v6, 1, v1
    v_subrev_u32 v6, 1, v6
    v_and_b32 v7, 7, v1
    v_lshlrev_b32 v7, 2, v7
    s_add_u32 s76, s36, 0x840000
    s_addc_u32 s77, s37, 0
    s_mov_b32 s78, 0x3000
    s_mov_b32 s79, 0x20000
    s_cmp_eq_u32 s38, 9
    s_cbranch_scc1 KS_W9
    s_cmp_eq_u32 s38, 8
    s_cbranch_scc1 KS_L2W
    s_sub_u32 s93, s38, 4
    s_lshl_b32 s92, s93, 10
    v_lshl_add_u32 v33, v1, 4, s92
    s_movk_i32 s92, 4096
    s_lshl_b32 s93, s93, 7
    v_lshlrev_b32 v32, 4, v2
    v_lshl_add_u32 v32, v3, 5, v32
    v_add_u32 v32, s93, v32
W_87:
    s_sleep 1
    ds_read_b32 v8, v4 offset:24
    s_sub_u32 s39, s39, 1
    s_cbranch_scc1 KS_ABORT
    s_waitcnt lgkmcnt(0)
    v_cmp_eq_u32 vcc, 0, v8
    s_cbranch_vccnz W_87
    s_setprio 2
    s_sleep 20
    s_branch ZPE_89
ZP_88:
    s_sleep 4
ZPE_89:
    buffer_load_dwordx4 v[8:11], v33, s[76:79], 0 offen sc1
    buffer_load_dwordx4 v[12:15], v33, s[76:79], s92 offen sc1
    s_sub_u32 s39, s39, 1
    s_cbranch_scc1 KS_ABORT
    s_waitcnt vmcnt(0)
    v_max3_u32 v44, v8, v9, v10
    v_max3_u32 v44, v44, v11, v12
    v_max3_u32 v44, v44, v13, v14
    v_max_u32 v44, v44, v15
    v_cmp_eq_u32 vcc, -1, v44
    s_cbranch_vccnz ZP_88
    ds_write_b32 v4, v5 offset:196
    v_max_u32 v16, v8, v9
    v_min_u32 v9, v8, v9
    v_max_u32 v17, v12, v13
    v_min_u32 v13, v12, v13
    v_max_u32 v18, v10, v11
    v_min_u32 v11, v10, v11
    v_max_u32 v19, v14, v15
    v_min_u32 v15, v14, v15
    v_max_u32 v20, v16, v18
    v_min_u32 v18, v16, v18
    v_max_u32 v21, v17, v19
    v_min_u32 v19, v17, v19
    v_max_u32 v22, v9, v11
    v_min_u32 v11, v9, v11
    v_max_u32 v23, v13, v15
    v_min_u32 v15, v13, v15
    v_max_u32 v24, v22, v18
    v_min_u32 v18, v22, v18
    v_max_u32 v25, v23, v19
    v_min_u32 v19, v23, v19
    v_mov_b32_dpp v26, v11 quad_perm:[1,0,3,2] row_mask:0xf bank_mask:0xf
    v_mov_b32_dpp v27, v18 quad_perm:[1,0,3,2] row_mask:0xf bank_mask:0xf
    v_mov_b32_dpp v8, v24 quad_perm:[1,0,3,2] row_mask:0xf bank_mask:0xf
    v_mov_b32_dpp v12, v20 quad_perm:[1,0,3,2] row_mask:0xf bank_mask:0xf
    v_med3_u32 v26, v20, v26, v6
    v_med3_u32 v27, v24, v27, v6
    v_med3_u32 v8, v18, v8, v6
    v_med3_u32 v12, v11, v12, v6
    v_max_u32 v10, v26, v8
    v_min_u32 v8, v26, v8
    v_max_u32 v14, v27, v12
    v_min_u32 v12, v27, v12
    v_max_u32 v16, v10, v14
    v_min_u32 v14, v10, v14
    v_max_u32 v17, v8, v12
    v_min_u32 v12, v8, v12
    v_mov_b32_dpp v9, v15 quad_perm:[1,0,3,2] row_mask:0xf bank_mask:0xf
    v_mov_b32_dpp v13, v19 quad_perm:[1,0,3,2] row_mask:0xf bank_mask:0xf
    v_mov_b32_dpp v22, v25 quad_perm:[1,0,3,2] row_mask:0xf bank_mask:0xf
    v_mov_b32_dpp v23, v21 quad_perm:[1,0,3,2] row_mask:0xf bank_mask:0xf
    v_med3_u32 v9, v21, v9, v6
    v_med3_u32 v13, v25, v13, v6
    v_med3_u32 v22, v19, v22, v6
    v_med3_u32 v23, v15, v23, v6
    v_max_u32 v20, v9, v22
    v_min_u32 v22, v9, v22
    v_max_u32 v24, v13, v23
    v_min_u32 v23, v13, v23
    v_max_u32 v18, v20, v24
    v_min_u32 v24, v20, v24
    v_max_u32 v11, v22, v23
    v_min_u32 v23, v22, v23
    s_nop 1
    v_max_u32_dpp v16, v23, v16 quad_perm:[1,0,3,2] row_mask:0xf bank_mask:0xf
    v_max_u32_dpp v14, v11, v14 quad_perm:[1,0,3,2] row_mask:0xf bank_mask:0xf
    v_max_u32_dpp v17, v24, v17 quad_perm:[1,0,3,2] row_mask:0xf bank_mask:0xf
    v_max_u32_dpp v12, v18, v12 quad_perm:[1,0,3,2] row_mask:0xf bank_mask:0xf
    v_mov_b32_dpp v26, v16 quad_perm:[1,0,3,2] row_mask:0xf bank_mask:0xf
    v_mov_b32_dpp v27, v14 quad_perm:[1,0,3,2] row_mask:0xf bank_mask:0xf
    v_mov_b32_dpp v10, v17 quad_perm:[1,0,3,2] row_mask:0xf bank_mask:0xf
    v_mov_b32_dpp v8, v12 quad_perm:[1,0,3,2] row_mask:0xf bank_mask:0xf
    v_med3_u32 v26, v16, v26, v6
    v_med3_u32 v27, v14, v27, v6
    v_med3_u32 v10, v17, v10, v6
    v_med3_u32 v8, v12, v8, v6
    v_max_u32 v21, v26, v10
    v_min_u32 v10, v26, v10
    v_max_u32 v25, v27, v8
    v_min_u32 v8, v27, v8
    v_max_u32 v19, v21, v25
    v_min_u32 v25, v21, v25
    v_max_u32 v15, v10, v8
    v_min_u32 v8, v10, v8
    s_nop 1
    v_max_u32_dpp v9, v8, v19 quad_perm:[3,2,1,0] row_mask:0xf bank_mask:0xf
    v_max_u32_dpp v13, v15, v25 quad_perm:[3,2,1,0] row_mask:0xf bank_mask:0xf
    v_max_u32_dpp v20, v25, v15 quad_perm:[3,2,1,0] row_mask:0xf bank_mask:0xf
    v_max_u32_dpp v22, v19, v8 quad_perm:[3,2,1,0] row_mask:0xf bank_mask:0xf
    v_mov_b32_dpp v18, v9 quad_perm:[1,0,3,2] row_mask:0xf bank_mask:0xf
    v_mov_b32_dpp v24, v13 quad_perm:[1,0,3,2] row_mask:0xf bank_mask:0xf
    v_mov_b32_dpp v11, v20 quad_perm:[1,0,3,2] row_mask:0xf bank_mask:0xf
    v_mov_b32_dpp v23, v22 quad_perm:[1,0,3,2] row_mask:0xf bank_mask:0xf
    v_med3_u32 v18, v9, v18, v6
    v_med3_u32 v24, v13, v24, v6
    v_med3_u32 v11, v20, v11, v6
    v_med3_u32 v23, v22, v23, v6
    v_max_u32 v16, v18, v11
    v_min_u32 v11, v18, v11
    v_max_u32 v14, v24, v23
    v_min_u32 v23, v24, v23
    v_max_u32 v17, v16, v14
    v_min_u32 v14, v16, v14
    v_max_u32 v12, v11, v23
    v_min_u32 v23, v11, v23
    s_nop 1
    v_max_u32_dpp v26, v23, v17 row_half_mirror row_mask:0xf bank_mask:0xf
    v_max_u32_dpp v27, v12, v14 row_half_mirror row_mask:0xf bank_mask:0xf
    v_max_u32_dpp v21, v14, v12 row_half_mirror row_mask:0xf bank_mask:0xf
    v_max_u32_dpp v10, v17, v23 row_half_mirror row_mask:0xf bank_mask:0xf
    v_mov_b32_dpp v19, v26 quad_perm:[1,0,3,2] row_mask:0xf bank_mask:0xf
    v_mov_b32_dpp v25, v27 quad_perm:[1,0,3,2] row_mask:0xf bank_mask:0xf
    v_mov_b32_dpp v15, v21 quad_perm:[1,0,3,2] row_mask:0xf bank_mask:0xf
    v_mov_b32_dpp v8, v10 quad_perm:[1,0,3,2] row_mask:0xf bank_mask:0xf
    v_med3_u32 v19, v26, v19, v6
    v_med3_u32 v25, v27, v25, v6
    v_med3_u32 v15, v21, v15, v6
    v_med3_u32 v8, v10, v8, v6
    v_max_u32 v9, v19, v15
    v_min_u32 v15, v19, v15
    v_max_u32 v13, v25, v8
    v_min_u32 v8, v25, v8
    v_max_u32 v20, v9, v13
    v_min_u32 v13, v9, v13
    v_max_u32 v22, v15, v8
    v_min_u32 v8, v15, v8
    s_nop 1
    v_max_u32_dpp v18, v8, v20 row_mirror row_mask:0xf bank_mask:0xf
    v_max_u32_dpp v24, v22, v13 row_mirror row_mask:0xf bank_mask:0xf
    v_max_u32_dpp v16, v13, v22 row_mirror row_mask:0xf bank_mask:0xf
    v_max_u32_dpp v11, v20, v8 row_mirror row_mask:0xf bank_mask:0xf
    v_mov_b32_dpp v17, v18 quad_perm:[1,0,3,2] row_mask:0xf bank_mask:0xf
    v_mov_b32_dpp v14, v24 quad_perm:[1,0,3,2] row_mask:0xf bank_mask:0xf
    v_mov_b32_dpp v12, v16 quad_perm:[1,0,3,2] row_mask:0xf bank_mask:0xf
    v_mov_b32_dpp v23, v11 quad_perm:[1,0,3,2] row_mask:0xf bank_mask:0xf
    v_med3_u32 v17, v18, v17, v6
    v_med3_u32 v14, v24, v14, v6
    v_med3_u32 v12, v16, v12, v6
    v_med3_u32 v23, v11, v23, v6
    v_max_u32 v26, v17, v12
    v_min_u32 v12, v17, v12
    v_max_u32 v27, v14, v23
    v_min_u32 v23, v14, v23
    v_max_u32 v21, v26, v27
    v_min_u32 v27, v26, v27
    v_max_u32 v10, v12, v23
    v_min_u32 v23, v12, v23
    v_mov_b32 v28, v21
    v_mov_b32 v29, v27
    v_mov_b32 v30, v10
    v_mov_b32 v31, v23
    s_mov_b32 exec_lo, 0x00030003
    s_mov_b32 exec_hi, 0x00030003
    ds_write_b128 v32, v[28:31] offset:256
    s_mov_b64 exec, -1
    s_setprio 0
    s_branch KS_B
KS_L2W:
    s_add_u32 s72, s36, 0x300000
    s_addc_u32 s73, s37, 0
    s_mov_b32 s74, 0x240000
    s_mov_b32 s75, 0x20000
    s_mov_b32 s92, 0xcccccccc
    s_mov_b32 s93, 0xcccccccc
    s_mov_b32 s94, 0xf0f0f0f0
    s_mov_b32 s95, 0xf0f0f0f0
    s_movk_i32 s96, 1152
    v_lshrrev_b32 v34, 3, v1
    v_lshlrev_b32 v34, 4, v34
    v_lshlrev_b32 v33, 4, v2
W_90:
    s_sleep 1
    ds_read_b32 v8, v4 offset:24
    s_sub_u32 s39, s39, 1
    s_cbranch_scc1 KS_ABORT
    s_waitcnt lgkmcnt(0)
    v_cmp_eq_u32 vcc, 0, v8
    s_cbranch_vccnz W_90
    s_setprio 2
KS_L2POLL:
    ds_read_b128 v[8:11], v33 offset:256
    ds_read_b128 v[12:15], v33 offset:512
    s_sub_u32 s39, s39, 1
    s_cbranch_scc1 KS_ABORT
    s_waitcnt lgkmcnt(0)
    v_min3_u32 v16, v8, v9, v10
    v_min3_u32 v17, v11, v12, v13
    v_min3_u32 v16, v16, v14, v15
    v_min_u32 v16, v16, v17
    v_cmp_eq_u32 vcc, 0, v16
    s_cbranch_vccnz KS_L2POLL
    v_max_u32_dpp v8, v15, v8 quad_perm:[1,0,3,2] row_mask:0xf bank_mask:0xf
    v_max_u32_dpp v9, v14, v9 quad_perm:[1,0,3,2] row_mask:0xf bank_mask:0xf
    v_max_u32_dpp v10, v13, v10 quad_perm:[1,0,3,2] row_mask:0xf bank_mask:0xf
    v_max_u32_dpp v11, v12, v11 quad_perm:[1,0,3,2] row_mask:0xf bank_mask:0xf
    v_mov_b32_dpp v16, v8 quad_perm:[1,0,3,2] row_mask:0xf bank_mask:0xf
    v_mov_b32_dpp v17, v9 quad_perm:[1,0,3,2] row_mask:0xf bank_mask:0xf
    v_mov_b32_dpp v18, v10 quad_perm:[1,0,3,2] row_mask:0xf bank_mask:0xf
    v_mov_b32_dpp v19, v11 quad_perm:[1,0,3,2] row_mask:0xf bank_mask:0xf
    v_med3_u32 v16, v8, v16, v6
    v_med3_u32 v17, v9, v17, v6
    v_med3_u32 v18, v10, v18, v6
    v_med3_u32 v19, v11, v19, v6
    v_max_u32 v20, v16, v18
    v_min_u32 v18, v16, v18
    v_max_u32 v21, v17, v19
    v_min_u32 v19, v17, v19
    v_max_u32 v22, v20, v21
    v_min_u32 v21, v20, v21
    v_max_u32 v23, v18, v19
    v_min_u32 v19, v18, v19
    s_nop 1
    v_max_u32_dpp v24, v19, v22 quad_perm:[3,2,1,0] row_mask:0xf bank_mask:0xf
    v_max_u32_dpp v25, v23, v21 quad_perm:[3,2,1,0] row_mask:0xf bank_mask:0xf
    v_max_u32_dpp v26, v21, v23 quad_perm:[3,2,1,0] row_mask:0xf bank_mask:0xf
    v_max_u32_dpp v27, v22, v19 quad_perm:[3,2,1,0] row_mask:0xf bank_mask:0xf
    v_mov_b32_dpp v12, v24 quad_perm:[1,0,3,2] row_mask:0xf bank_mask:0xf
    v_mov_b32_dpp v13, v25 quad_perm:[1,0,3,2] row_mask:0xf bank_mask:0xf
    v_mov_b32_dpp v14, v26 quad_perm:[1,0,3,2] row_mask:0xf bank_mask:0xf
    v_mov_b32_dpp v15, v27 quad_perm:[1,0,3,2] row_mask:0xf bank_mask:0xf
    v_med3_u32 v12, v24, v12, v6
    v_med3_u32 v13, v25, v13, v6
    v_med3_u32 v14, v26, v14, v6
    v_med3_u32 v15, v27, v15, v6
    v_max_u32 v8, v12, v14
    v_min_u32 v14, v12, v14
    v_max_u32 v9, v13, v15
    v_min_u32 v15, v13, v15
    v_max_u32 v10, v8, v9
    v_min_u32 v9, v8, v9
    v_max_u32 v11, v14, v15
    v_min_u32 v15, v14, v15
    s_nop 1
    v_max_u32_dpp v16, v15, v10 row_half_mirror row_mask:0xf bank_mask:0xf
    v_max_u32_dpp v17, v11, v9 row_half_mirror row_mask:0xf bank_mask:0xf
    v_max_u32_dpp v20, v9, v11 row_half_mirror row_mask:0xf bank_mask:0xf
    v_max_u32_dpp v18, v10, v15 row_half_mirror row_mask:0xf bank_mask:0xf
    v_mov_b32_dpp v22, v16 quad_perm:[1,0,3,2] row_mask:0xf bank_mask:0xf
    v_mov_b32_dpp v21, v17 quad_perm:[1,0,3,2] row_mask:0xf bank_mask:0xf
    v_mov_b32_dpp v23, v20 quad_perm:[1,0,3,2] row_mask:0xf bank_mask:0xf
    v_mov_b32_dpp v19, v18 quad_perm:[1,0,3,2] row_mask:0xf bank_mask:0xf
    v_med3_u32 v22, v16, v22, v6
    v_med3_u32 v21, v17, v21, v6
    v_med3_u32 v23, v20, v23, v6
    v_med3_u32 v19, v18, v19, v6
    v_max_u32 v24, v22, v23
    v_min_u32 v23, v22, v23
    v_max_u32 v25, v21, v19
    v_min_u32 v19, v21, v19
    v_max_u32 v26, v24, v25
    v_min_u32 v25, v24, v25
    v_max_u32 v27, v23, v19
    v_min_u32 v19, v23, v19
    s_nop 1
    v_max_u32_dpp v12, v19, v26 row_mirror row_mask:0xf bank_mask:0xf
    v_max_u32_dpp v13, v27, v25 row_mirror row_mask:0xf bank_mask:0xf
    v_max_u32_dpp v8, v25, v27 row_mirror row_mask:0xf bank_mask:0xf
    v_max_u32_dpp v14, v26, v19 row_mirror row_mask:0xf bank_mask:0xf
    ds_read_b32 v35, v4 offset:28
    v_cndmask_b32 v30, v12, v13, s[92:93]
    v_cndmask_b32 v31, v8, v14, s[92:93]
    v_cndmask_b32 v30, v30, v31, s[94:95]
    s_nop 1
    v_mov_b32_dpp v30, v30 row_shr:8 row_mask:0xf bank_mask:0xc
    v_and_b32 v31, 0x7ff, v30
    v_sub_u32 v31, 2047, v31
    v_mad_u32_u24 v31, v31, s96, v34
    s_waitcnt lgkmcnt(0)
    v_cmp_ne_u32 vcc, 0, v35
    s_cbranch_vccnz KS_RW1
W_91:
    ds_read_b32 v35, v4 offset:28
    s_sub_u32 s39, s39, 1
    s_cbranch_scc1 KS_ABORT
    s_waitcnt lgkmcnt(0)
    v_cmp_eq_u32 vcc, 0, v35
    s_cbranch_vccnz W_91
KS_RW1:
    s_mov_b32 m0, 17088
    s_nop 0
    buffer_load_dwordx4 v31, s[72:75], 0 offen offset:0 sc1 lds
    s_mov_b32 m0, 17984
    s_nop 0
    buffer_load_dwordx4 v31, s[72:75], 0 offen offset:128 sc1 lds
    s_mov_b32 m0, 18880
    s_nop 0
    buffer_load_dwordx4 v31, s[72:75], 0 offen offset:256 sc1 lds
    s_mov_b32 m0, 19776
    s_nop 0
    buffer_load_dwordx4 v31, s[72:75], 0 offen offset:384 sc1 lds
    s_mov_b32 m0, 20672
    s_nop 0
    buffer_load_dwordx4 v31, s[72:75], 0 offen offset:512 sc1 lds
    s_mov_b32 m0, 21568
    s_nop 0
    buffer_load_dwordx4 v31, s[72:75], 0 offen offset:640 sc1 lds
    s_mov_b32 m0, 22464
    s_nop 0
    buffer_load_dwordx4 v31, s[72:75], 0 offen offset:768 sc1 lds
    s_mov_b32 m0, 23360
    s_nop 0
    buffer_load_dwordx4 v31, s[72:75], 0 offen offset:896 sc1 lds
    s_mov_b32 m0, 24256
    s_nop 0
    buffer_load_dwordx4 v31, s[72:75], 0 offen offset:1024 sc1 lds
    ds_write_b32 v7, v30 offset:768
    s_waitcnt vmcnt(0)
    ds_write_b32 v4, v5 offset:32
    s_setprio 0
    s_branch KS_B
KS_W9:
    v_lshlrev_b32 v33, 4, v1
    s_movk_i32 s92, 0x2000
    s_add_u32 s72, s36, 0x300000
    s_addc_u32 s73, s37, 0
    s_mov_b32 s74, 0x240000
    s_mov_b32 s75, 0x20000
    s_add_u32 s64, s36, 0x600000
    s_addc_u32 s65, s37, 0
    s_mov_b32 s66, 0x240000
    s_mov_b32 s67, 0x20000
    s_mov_b32 s68, s4
    s_mov_b32 s69, s5
    s_mov_b32 s70, 0x240000
    s_mov_b32 s71, 0x20000
    v_bfe_u32 v43, v1, 2, 3
    s_lshl_b32 s93, s89, 3
    v_add_u32 v43, s93, v43
    v_bfe_u32 v40, v43, 4, 1
    v_and_b32 v41, 3, v1
    v_lshl_add_u32 v40, v40, 2, v41
    v_lshlrev_b32 v40, 2, v40
    v_lshrrev_b32 v41, 5, v43
    v_lshlrev_b32 v41, 4, v41
    v_and_b32 v42, 15, v43
    v_add_u32 v41, v41, v42
W_92:
    s_sleep 1
    ds_read_b32 v8, v4 offset:196
    s_sub_u32 s39, s39, 1
    s_cbranch_scc1 KS_ABORT
    s_waitcnt lgkmcnt(0)
    v_cmp_eq_u32 vcc, 0, v8
    s_cbranch_vccnz W_92
    s_sleep 8
    s_setprio 2
    s_branch ZPE_94
ZP_93:
    s_sleep 4
ZPE_94:
    buffer_load_dword v8, v33, s[76:79], s92 offen offset:0 sc1
    buffer_load_dword v9, v33, s[76:79], s92 offen offset:1024 sc1
    buffer_load_dword v10, v33, s[76:79], s92 offen offset:2048 sc1
    buffer_load_dword v11, v33, s[76:79], s92 offen offset:3072 sc1
    s_sub_u32 s39, s39, 1
    s_cbranch_scc1 KS_ABORT
    s_waitcnt vmcnt(0)
    v_max3_u32 v44, v8, v9, v10
    v_max_u32 v44, v44, v11
    v_cmp_eq_u32 vcc, -1, v44
    s_cbranch_vccnz ZP_93
    ds_write_b32 v4, v5 offset:28
    s_setprio 0
W_95:
    s_sleep 1
    ds_read_b32 v12, v7 offset:768
    s_sub_u32 s39, s39, 1
    s_cbranch_scc1 KS_ABORT
    s_waitcnt lgkmcnt(0)
    v_cmp_eq_u32 vcc, 0, v12
    s_cbranch_vccnz W_95
    ds_read_b32 v19, v40 offset:768
    s_waitcnt lgkmcnt(0)
    v_and_b32 v14, 0x7ff, v19
    v_sub_u32 v14, 2047, v14
    v_mul_u32_u24 v23, 1152, v14
    v_lshl_add_u32 v23, v41, 1, v23
    buffer_load_ushort v20, v23, s[72:75], 0 offen sc1
    buffer_load_ushort v17, v23, s[68:71], 0 offen
    v_lshrrev_b32 v15, 9, v14
    v_bfe_u32 v16, v14, 6, 2
    v_lshl_add_u32 v15, v15, 2, v16
    v_bfe_u32 v16, v14, 2, 2
    v_lshl_add_u32 v15, v15, 2, v16
    v_bfe_u32 v16, v14, 4, 1
    v_bfe_u32 v24, v14, 8, 1
    v_and_b32 v25, 3, v14
    v_lshl_add_u32 v24, v24, 2, v25
    v_lshlrev_b32 v24, 1, v24
    v_bfe_u32 v25, v14, 5, 1
    v_lshl_add_u32 v24, v25, 5, v24
    v_lshl_add_u32 v25, v15, 1, v16
    v_lshl_add_u32 v25, v25, 14, v24
    v_lshrrev_b32 v26, 1, v41
    v_lshl_add_u32 v25, v26, 6, v25
    v_xor_b32 v26, v41, v16
    v_not_b32 v26, v26
    v_and_b32 v26, 1, v26
    v_lshl_add_u32 v25, v26, 4, v25
    v_lshl_add_u32 v26, v15, 12, v24
    v_lshl_add_u32 v26, v16, 4, v26
    v_lshl_add_u32 v26, v41, 6, v26
    v_add_u32 v26, 2064384, v26
    v_lshl_add_u32 v27, v16, 6, v15
    v_lshlrev_b32 v27, 7, v27
    v_xor_b32 v25, v27, v25
    v_and_b32 v27, 0xf80, v27
    v_xor_b32 v26, v27, v26
    v_cmp_gt_u32 vcc, 0x200, v41
    s_nop 1
    v_cndmask_b32 v25, v26, v25, vcc
    buffer_load_ushort v18, v25, s[64:67], 0 offen sc1
    s_add_u32 s72, s36, 0xb10000
    s_addc_u32 s73, s37, 0
    s_mov_b32 s74, 0x40
    s_mov_b32 s75, 0x20000
    v_ashrrev_i32 v22, 31, v19
    v_not_b32 v22, v22
    v_or_b32 v22, 0x80000000, v22
    v_xor_b32 v22, v19, v22
    v_and_b32 v22, 0xffff0000, v22
    v_mul_f32 v22, 0xbfb8aa3b, v22
    v_exp_f32 v22, v22
    s_nop 0
    v_add_f32 v22, 1.0, v22
    v_rcp_f32 v22, v22
    s_nop 0
    v_cvt_pk_bf16_f32 v22, v22, v22
    v_lshlrev_b32 v22, 16, v22
    v_and_b32 v14, 31, v1
    v_lshlrev_b32 v14, 4, v14
    s_waitcnt vmcnt(0)
    v_lshlrev_b32 v17, 16, v17
    v_lshlrev_b32 v18, 16, v18
    v_add_f32 v17, v17, v18
    v_cvt_pk_bf16_f32 v17, v17, v17
    v_and_b32 v21, 0xffff0000, v17
    v_lshlrev_b32 v20, 16, v20
    ds_write_b128 v14, v[20:23] offset:1536
    s_cmp_lg_u32 s2, 0
    s_cbranch_scc1 KS_W9E
    buffer_store_dword v12, v7, s[72:75], 0 offen
KS_W9E:
    s_waitcnt lgkmcnt(0)
    s_endpgm
KS_B:
    s_add_u32 s64, s36, 0x850000
    s_addc_u32 s65, s37, 0
    s_mov_b32 s66, 0x28c800
    s_mov_b32 s67, 0x20000
    v_bfe_u32 v16, v1, 2, 2
    v_lshl_add_u32 v16, v3, 3, v16
    v_mul_u32_u24 v16, 1152, v16
    v_and_b32 v17, 3, v1
    v_lshl_add_u32 v16, v17, 3, v16
    s_lshl_b32 s92, s38, 7
    s_add_u32 s92, s92, 109184
    v_add_u32 v16, s92, v16
    v_lshlrev_b32 v18, 2, v17
    ds_read_b32 v24, v18 offset:224
    s_movk_i32 s94, 0xff
W_96:
    ds_read_b32 v17, v4 offset:40
    s_sub_u32 s39, s39, 1
    s_cbranch_scc1 KS_ABORT
    s_waitcnt lgkmcnt(0)
    v_cmp_ne_u32 vcc, s84, v17
    s_cbranch_vccnz W_96
    v_lshrrev_b32 v25, 8, v24
    v_lshrrev_b32 v26, 16, v24
    v_lshrrev_b32 v27, 24, v24
    ds_read_b64_tr_b16 v[48:49], v16 offset:0
    ds_read_b64_tr_b16 v[50:51], v16 offset:4608
    ds_read_b64_tr_b16 v[52:53], v16 offset:32
    ds_read_b64_tr_b16 v[54:55], v16 offset:4640
    ds_read_b64_tr_b16 v[56:57], v16 offset:64
    ds_read_b64_tr_b16 v[58:59], v16 offset:4672
    ds_read_b64_tr_b16 v[60:61], v16 offset:96
    ds_read_b64_tr_b16 v[62:63], v16 offset:4704
    v_and_b32 v16, 7, v2
    v_lshlrev_b32 v16, 6, v16
    v_lshl_add_u32 v16, v3, 4, v16
    s_mul_i32 s92, s89, 18560
    s_lshl_b32 s93, s38, 11
    s_add_u32 s92, s92, s93
    v_lshlrev_b32 v17, 4, v1
    s_waitcnt lgkmcnt(0)
    s_barrier
    s_barrier
    ds_read_b128 v[20:23], v16 offset:1024
    s_waitcnt lgkmcnt(0)
    v_mfma_f32_16x16x32_bf16 v[32:35], v[20:23], v[48:51], 0
    v_mfma_f32_16x16x32_bf16 v[36:39], v[20:23], v[52:55], 0
    v_mfma_f32_16x16x32_bf16 v[40:43], v[20:23], v[56:59], 0
    v_mfma_f32_16x16x32_bf16 v[44:47], v[20:23], v[60:63], 0
    s_nop 5
    v_permlane32_swap_b32 v32, v36
    v_permlane32_swap_b32 v33, v37
    v_permlane32_swap_b32 v34, v38
    v_permlane32_swap_b32 v35, v39
    v_bfi_b32 v32, s94, v24, v32
    v_bfi_b32 v33, s94, v25, v33
    v_bfi_b32 v34, s94, v26, v34
    v_bfi_b32 v35, s94, v27, v35
    buffer_store_dwordx4 v[32:35], v17, s[64:67], s92 offen offset:0 sc1
    v_permlane32_swap_b32 v40, v44
    v_permlane32_swap_b32 v41, v45
    v_permlane32_swap_b32 v42, v46
    v_permlane32_swap_b32 v43, v47
    v_bfi_b32 v40, s94, v24, v40
    v_bfi_b32 v41, s94, v25, v41
    v_bfi_b32 v42, s94, v26, v42
    v_bfi_b32 v43, s94, v27, v43
    buffer_store_dwordx4 v[40:43], v17, s[64:67], s92 offen offset:1024 sc1
    s_waitcnt vmcnt(0)
    s_barrier
    s_endpgm
KS_G0:
    ds_write_b8 v15, v5 offset:68
    s_setprio 0
KS_G:
    s_mov_b32 s98, 0x05040100
    s_mov_b32 s99, 0x07060302
    s_waitcnt vmcnt(0)
    s_sub_u32 s87, s38, 12
    s_mul_i32 s92, s87, 9
    s_add_u32 s92, s92, 1
    s_lshr_b32 s86, s92, 1
    s_lshl_b32 s92, s86, 5
    v_lshl_add_u32 v7, v3, 3, s92
    v_mul_u32_u24 v7, 9216, v7
    v_and_b32 v6, 7, v2
    v_lshl_add_u32 v7, v6, 3, v7
    s_lshl_b32 s92, s89, 6
    v_add_u32 v7, s92, v7
    v_cmp_gt_u32 vcc, 8, v2
    s_mov_b32 s76, 9216
    s_mov_b32 s77, 0
    s_mov_b32 s78, 230400
    s_mov_b32 s79, 0
    v_mov_b32 v46, s26
    v_mov_b32 v47, s27
    v_mov_b32 v6, s28
    v_cndmask_b32 v46, v6, v46, vcc
    v_mov_b32 v6, s29
    v_cndmask_b32 v47, v6, v47, vcc
    v_add_co_u32 v46, vcc, v46, v7
    s_nop 1
    v_addc_co_u32 v47, vcc, 0, v47, vcc
    s_mov_b32 s68, s30
    s_mov_b32 s69, s31
    s_mov_b32 s70, 0x510000
    s_mov_b32 s71, 0x20000
    v_lshlrev_b32 v8, 4, v1
    s_mul_i32 s92, s89, 36864
    s_mul_i32 s93, s87, 9216
    s_add_u32 s92, s92, s93
    s_add_u32 s93, s93, 109184
    s_cmp_lt_u32 s41, 8
    s_cselect_b32 s94, 0, 100
    v_mov_b32 v9, s94
W_97:
    s_sleep 2
    ds_read_b32 v10, v9 offset:100
    s_sub_u32 s39, s39, 1
    s_cbranch_scc1 KS_ABORT
    s_waitcnt lgkmcnt(0)
    v_cmp_ne_u32 vcc, s84, v10
    s_cbranch_vccnz W_97
    s_add_u32 m0, s93, 0
    s_nop 0
    buffer_load_dwordx4 v8, s[68:71], s92 offen offset:0 nt lds
    buffer_load_dwordx4 v8, s[68:71], s92 offen offset:1024 nt lds
    buffer_load_dwordx4 v8, s[68:71], s92 offen offset:2048 nt lds
    buffer_load_dwordx4 v8, s[68:71], s92 offen offset:3072 nt lds
    s_add_u32 m0, s93, 4096
    s_add_u32 s92, s92, 4096
    buffer_load_dwordx4 v8, s[68:71], s92 offen offset:0 nt lds
    buffer_load_dwordx4 v8, s[68:71], s92 offen offset:1024 nt lds
    buffer_load_dwordx4 v8, s[68:71], s92 offen offset:2048 nt lds
    buffer_load_dwordx4 v8, s[68:71], s92 offen offset:3072 nt lds
    s_add_u32 m0, s93, 8192
    s_add_u32 s92, s92, 4096
    buffer_load_dwordx4 v8, s[68:71], s92 offen offset:0 nt lds
    s_lshr_b32 s92, 3, s87
    s_bitcmp1_b32 s92, 0
    s_cbranch_scc0 KS_GN0
    global_load_dwordx2 v[48:49], v[46:47], off nt
    v_lshl_add_u64 v[46:47], v[46:47], 0, s[76:77]
    global_load_dwordx2 v[50:51], v[46:47], off nt
    v_lshl_add_u64 v[46:47], v[46:47], 0, s[76:77]
    global_load_dwordx2 v[52:53], v[46:47], off nt
    v_lshl_add_u64 v[46:47], v[46:47], 0, s[76:77]
    global_load_dwordx2 v[54:55], v[46:47], off nt
    v_lshl_add_u64 v[46:47], v[46:47], 0, s[76:77]
    global_load_dwordx2 v[56:57], v[46:47], off nt
    v_lshl_add_u64 v[46:47], v[46:47], 0, s[76:77]
    global_load_dwordx2 v[58:59], v[46:47], off nt
    v_lshl_add_u64 v[46:47], v[46:47], 0, s[76:77]
    global_load_dwordx2 v[60:61], v[46:47], off nt
    v_lshl_add_u64 v[46:47], v[46:47], 0, s[76:77]
    global_load_dwordx2 v[62:63], v[46:47], off nt
    v_lshl_add_u64 v[46:47], v[46:47], 0, s[78:79]
    global_load_dwordx2 v[64:65], v[46:47], off nt
    v_lshl_add_u64 v[46:47], v[46:47], 0, s[76:77]
    global_load_dwordx2 v[66:67], v[46:47], off nt
    v_lshl_add_u64 v[46:47], v[46:47], 0, s[76:77]
    global_load_dwordx2 v[68:69], v[46:47], off nt
    v_lshl_add_u64 v[46:47], v[46:47], 0, s[76:77]
    global_load_dwordx2 v[70:71], v[46:47], off nt
    v_lshl_add_u64 v[46:47], v[46:47], 0, s[76:77]
    global_load_dwordx2 v[72:73], v[46:47], off nt
    v_lshl_add_u64 v[46:47], v[46:47], 0, s[76:77]
    global_load_dwordx2 v[74:75], v[46:47], off nt
    v_lshl_add_u64 v[46:47], v[46:47], 0, s[76:77]
    global_load_dwordx2 v[76:77], v[46:47], off nt
    v_lshl_add_u64 v[46:47], v[46:47], 0, s[76:77]
    global_load_dwordx2 v[78:79], v[46:47], off nt
    v_lshl_add_u64 v[46:47], v[46:47], 0, s[78:79]
    global_load_dwordx2 v[80:81], v[46:47], off nt
    v_lshl_add_u64 v[46:47], v[46:47], 0, s[76:77]
    global_load_dwordx2 v[82:83], v[46:47], off nt
    v_lshl_add_u64 v[46:47], v[46:47], 0, s[76:77]
    global_load_dwordx2 v[84:85], v[46:47], off nt
    v_lshl_add_u64 v[46:47], v[46:47], 0, s[76:77]
    global_load_dwordx2 v[86:87], v[46:47], off nt
    v_lshl_add_u64 v[46:47], v[46:47], 0, s[76:77]
    global_load_dwordx2 v[88:89], v[46:47], off nt
    v_lshl_add_u64 v[46:47], v[46:47], 0, s[76:77]
    global_load_dwordx2 v[90:91], v[46:47], off nt
    v_lshl_add_u64 v[46:47], v[46:47], 0, s[76:77]
    global_load_dwordx2 v[92:93], v[46:47], off nt
    v_lshl_add_u64 v[46:47], v[46:47], 0, s[76:77]
    global_load_dwordx2 v[94:95], v[46:47], off nt
    v_lshl_add_u64 v[46:47], v[46:47], 0, s[78:79]
    global_load_dwordx2 v[96:97], v[46:47], off nt
    v_lshl_add_u64 v[46:47], v[46:47], 0, s[76:77]
    global_load_dwordx2 v[98:99], v[46:47], off nt
    v_lshl_add_u64 v[46:47], v[46:47], 0, s[76:77]
    global_load_dwordx2 v[100:101], v[46:47], off nt
    v_lshl_add_u64 v[46:47], v[46:47], 0, s[76:77]
    global_load_dwordx2 v[102:103], v[46:47], off nt
    v_lshl_add_u64 v[46:47], v[46:47], 0, s[76:77]
    global_load_dwordx2 v[104:105], v[46:47], off nt
    v_lshl_add_u64 v[46:47], v[46:47], 0, s[76:77]
    global_load_dwordx2 v[106:107], v[46:47], off nt
    v_lshl_add_u64 v[46:47], v[46:47], 0, s[76:77]
    global_load_dwordx2 v[108:109], v[46:47], off nt
    v_lshl_add_u64 v[46:47], v[46:47], 0, s[76:77]
    global_load_dwordx2 v[110:111], v[46:47], off nt
    v_lshl_add_u64 v[46:47], v[46:47], 0, s[78:79]
    s_bitcmp1_b32 s87, 0
    s_cbranch_scc1 KS_G4
    global_load_dwordx2 v[112:113], v[46:47], off nt
    v_lshl_add_u64 v[46:47], v[46:47], 0, s[76:77]
    global_load_dwordx2 v[114:115], v[46:47], off nt
    v_lshl_add_u64 v[46:47], v[46:47], 0, s[76:77]
    global_load_dwordx2 v[116:117], v[46:47], off nt
    v_lshl_add_u64 v[46:47], v[46:47], 0, s[76:77]
    global_load_dwordx2 v[118:119], v[46:47], off nt
    v_lshl_add_u64 v[46:47], v[46:47], 0, s[76:77]
    global_load_dwordx2 v[120:121], v[46:47], off nt
    v_lshl_add_u64 v[46:47], v[46:47], 0, s[76:77]
    global_load_dwordx2 v[122:123], v[46:47], off nt
    v_lshl_add_u64 v[46:47], v[46:47], 0, s[76:77]
    global_load_dwordx2 v[124:125], v[46:47], off nt
    v_lshl_add_u64 v[46:47], v[46:47], 0, s[76:77]
    global_load_dwordx2 v[126:127], v[46:47], off nt
    s_branch KS_G4
KS_GN0:
    s_lshr_b32 s92, 3, s87
    s_bitcmp1_b32 s92, 0
    s_cbranch_scc0 GT_98
W_99:
    s_sleep 2
    ds_read_b32 v10, v4 offset:16
    s_sub_u32 s39, s39, 1
    s_cbranch_scc1 KS_ABORT
    s_waitcnt lgkmcnt(0)
    v_cmp_ne_u32 vcc, s84, v10
    s_cbranch_vccnz W_99
GT_98:
    s_lshr_b32 s92, 12, s87
    s_bitcmp1_b32 s92, 0
    s_cbranch_scc0 GT_100
W_101:
    s_sleep 2
    ds_read_b32 v10, v4 offset:52
    s_sub_u32 s39, s39, 1
    s_cbranch_scc1 KS_ABORT
    s_waitcnt lgkmcnt(0)
    v_cmp_ne_u32 vcc, s84, v10
    s_cbranch_vccnz W_101
    s_setprio 1
GT_100:
    global_load_dwordx2 v[48:49], v[46:47], off
    v_lshl_add_u64 v[46:47], v[46:47], 0, s[76:77]
    global_load_dwordx2 v[50:51], v[46:47], off
    v_lshl_add_u64 v[46:47], v[46:47], 0, s[76:77]
    global_load_dwordx2 v[52:53], v[46:47], off
    v_lshl_add_u64 v[46:47], v[46:47], 0, s[76:77]
    global_load_dwordx2 v[54:55], v[46:47], off
    v_lshl_add_u64 v[46:47], v[46:47], 0, s[76:77]
    global_load_dwordx2 v[56:57], v[46:47], off
    v_lshl_add_u64 v[46:47], v[46:47], 0, s[76:77]
    global_load_dwordx2 v[58:59], v[46:47], off
    v_lshl_add_u64 v[46:47], v[46:47], 0, s[76:77]
    global_load_dwordx2 v[60:61], v[46:47], off
    v_lshl_add_u64 v[46:47], v[46:47], 0, s[76:77]
    global_load_dwordx2 v[62:63], v[46:47], off
    v_lshl_add_u64 v[46:47], v[46:47], 0, s[78:79]
    global_load_dwordx2 v[64:65], v[46:47], off
    v_lshl_add_u64 v[46:47], v[46:47], 0, s[76:77]
    global_load_dwordx2 v[66:67], v[46:47], off
    v_lshl_add_u64 v[46:47], v[46:47], 0, s[76:77]
    global_load_dwordx2 v[68:69], v[46:47], off
    v_lshl_add_u64 v[46:47], v[46:47], 0, s[76:77]
    global_load_dwordx2 v[70:71], v[46:47], off
    v_lshl_add_u64 v[46:47], v[46:47], 0, s[76:77]
    global_load_dwordx2 v[72:73], v[46:47], off
    v_lshl_add_u64 v[46:47], v[46:47], 0, s[76:77]
    global_load_dwordx2 v[74:75], v[46:47], off
    v_lshl_add_u64 v[46:47], v[46:47], 0, s[76:77]
    global_load_dwordx2 v[76:77], v[46:47], off
    v_lshl_add_u64 v[46:47], v[46:47], 0, s[76:77]
    global_load_dwordx2 v[78:79], v[46:47], off
    v_lshl_add_u64 v[46:47], v[46:47], 0, s[78:79]
    global_load_dwordx2 v[80:81], v[46:47], off
    v_lshl_add_u64 v[46:47], v[46:47], 0, s[76:77]
    global_load_dwordx2 v[82:83], v[46:47], off
    v_lshl_add_u64 v[46:47], v[46:47], 0, s[76:77]
    global_load_dwordx2 v[84:85], v[46:47], off
    v_lshl_add_u64 v[46:47], v[46:47], 0, s[76:77]
    global_load_dwordx2 v[86:87], v[46:47], off
    v_lshl_add_u64 v[46:47], v[46:47], 0, s[76:77]
    global_load_dwordx2 v[88:89], v[46:47], off
    v_lshl_add_u64 v[46:47], v[46:47], 0, s[76:77]
    global_load_dwordx2 v[90:91], v[46:47], off
    v_lshl_add_u64 v[46:47], v[46:47], 0, s[76:77]
    global_load_dwordx2 v[92:93], v[46:47], off
    v_lshl_add_u64 v[46:47], v[46:47], 0, s[76:77]
    global_load_dwordx2 v[94:95], v[46:47], off
    v_lshl_add_u64 v[46:47], v[46:47], 0, s[78:79]
    global_load_dwordx2 v[96:97], v[46:47], off
    v_lshl_add_u64 v[46:47], v[46:47], 0, s[76:77]
    global_load_dwordx2 v[98:99], v[46:47], off
    v_lshl_add_u64 v[46:47], v[46:47], 0, s[76:77]
    global_load_dwordx2 v[100:101], v[46:47], off
    v_lshl_add_u64 v[46:47], v[46:47], 0, s[76:77]
    global_load_dwordx2 v[102:103], v[46:47], off
    v_lshl_add_u64 v[46:47], v[46:47], 0, s[76:77]
    global_load_dwordx2 v[104:105], v[46:47], off
    v_lshl_add_u64 v[46:47], v[46:47], 0, s[76:77]
    global_load_dwordx2 v[106:107], v[46:47], off
    v_lshl_add_u64 v[46:47], v[46:47], 0, s[76:77]
    global_load_dwordx2 v[108:109], v[46:47], off
    v_lshl_add_u64 v[46:47], v[46:47], 0, s[76:77]
    global_load_dwordx2 v[110:111], v[46:47], off
    v_lshl_add_u64 v[46:47], v[46:47], 0, s[78:79]
    s_bitcmp1_b32 s87, 0
    s_cbranch_scc1 KS_G4
    global_load_dwordx2 v[112:113], v[46:47], off
    v_lshl_add_u64 v[46:47], v[46:47], 0, s[76:77]
    global_load_dwordx2 v[114:115], v[46:47], off
    v_lshl_add_u64 v[46:47], v[46:47], 0, s[76:77]
    global_load_dwordx2 v[116:117], v[46:47], off
    v_lshl_add_u64 v[46:47], v[46:47], 0, s[76:77]
    global_load_dwordx2 v[118:119], v[46:47], off
    v_lshl_add_u64 v[46:47], v[46:47], 0, s[76:77]
    global_load_dwordx2 v[120:121], v[46:47], off
    v_lshl_add_u64 v[46:47], v[46:47], 0, s[76:77]
    global_load_dwordx2 v[122:123], v[46:47], off
    v_lshl_add_u64 v[46:47], v[46:47], 0, s[76:77]
    global_load_dwordx2 v[124:125], v[46:47], off
    v_lshl_add_u64 v[46:47], v[46:47], 0, s[76:77]
    global_load_dwordx2 v[126:127], v[46:47], off
KS_G4:
    v_mov_b32 v6, s87
    ds_write_b8 v6, v5 offset:192
    s_waitcnt vmcnt(0)
    ds_write_b8 v6, v5 offset:40
    v_perm_b32 v32, v50, v48, s98
    v_perm_b32 v33, v54, v52, s98
    v_perm_b32 v34, v58, v56, s98
    v_perm_b32 v35, v62, v60, s98
    v_perm_b32 v36, v50, v48, s99
    v_perm_b32 v37, v54, v52, s99
    v_perm_b32 v38, v58, v56, s99
    v_perm_b32 v39, v62, v60, s99
    v_perm_b32 v40, v51, v49, s98
    v_perm_b32 v41, v55, v53, s98
    v_perm_b32 v42, v59, v57, s98
    v_perm_b32 v43, v63, v61, s98
    v_perm_b32 v44, v51, v49, s99
    v_perm_b32 v45, v55, v53, s99
    v_perm_b32 v46, v59, v57, s99
    v_perm_b32 v47, v63, v61, s99
    v_perm_b32 v48, v66, v64, s98
    v_perm_b32 v49, v70, v68, s98
    v_perm_b32 v50, v74, v72, s98
    v_perm_b32 v51, v78, v76, s98
    v_perm_b32 v52, v66, v64, s99
    v_perm_b32 v53, v70, v68, s99
    v_perm_b32 v54, v74, v72, s99
    v_perm_b32 v55, v78, v76, s99
    v_perm_b32 v56, v67, v65, s98
    v_perm_b32 v57, v71, v69, s98
    v_perm_b32 v58, v75, v73, s98
    v_perm_b32 v59, v79, v77, s98
    v_perm_b32 v60, v67, v65, s99
    v_perm_b32 v61, v71, v69, s99
    v_perm_b32 v62, v75, v73, s99
    v_perm_b32 v63, v79, v77, s99
    v_perm_b32 v64, v82, v80, s98
    v_perm_b32 v65, v86, v84, s98
    v_perm_b32 v66, v90, v88, s98
    v_perm_b32 v67, v94, v92, s98
    v_perm_b32 v68, v82, v80, s99
    v_perm_b32 v69, v86, v84, s99
    v_perm_b32 v70, v90, v88, s99
    v_perm_b32 v71, v94, v92, s99
    v_perm_b32 v72, v83, v81, s98
    v_perm_b32 v73, v87, v85, s98
    v_perm_b32 v74, v91, v89, s98
    v_perm_b32 v75, v95, v93, s98
    v_perm_b32 v76, v83, v81, s99
    v_perm_b32 v77, v87, v85, s99
    v_perm_b32 v78, v91, v89, s99
    v_perm_b32 v79, v95, v93, s99
    v_perm_b32 v80, v98, v96, s98
    v_perm_b32 v81, v102, v100, s98
    v_perm_b32 v82, v106, v104, s98
    v_perm_b32 v83, v110, v108, s98
    v_perm_b32 v84, v98, v96, s99
    v_perm_b32 v85, v102, v100, s99
    v_perm_b32 v86, v106, v104, s99
    v_perm_b32 v87, v110, v108, s99
    v_perm_b32 v88, v99, v97, s98
    v_perm_b32 v89, v103, v101, s98
    v_perm_b32 v90, v107, v105, s98
    v_perm_b32 v91, v111, v109, s98
    v_perm_b32 v92, v99, v97, s99
    v_perm_b32 v93, v103, v101, s99
    v_perm_b32 v94, v107, v105, s99
    v_perm_b32 v95, v111, v109, s99
    v_perm_b32 v96, v114, v112, s98
    v_perm_b32 v97, v118, v116, s98
    v_perm_b32 v98, v122, v120, s98
    v_perm_b32 v99, v126, v124, s98
    v_perm_b32 v100, v114, v112, s99
    v_perm_b32 v101, v118, v116, s99
    v_perm_b32 v102, v122, v120, s99
    v_perm_b32 v103, v126, v124, s99
    v_perm_b32 v104, v115, v113, s98
    v_perm_b32 v105, v119, v117, s98
    v_perm_b32 v106, v123, v121, s98
    v_perm_b32 v107, v127, v125, s98
    v_perm_b32 v108, v115, v113, s99
    v_perm_b32 v109, v119, v117, s99
    v_perm_b32 v110, v123, v121, s99
    v_perm_b32 v111, v127, v125, s99
    s_lshl_b32 s92, s86, 9
    s_add_u32 s92, s92, 17088
    v_and_b32 v6, 7, v2
    v_lshl_add_u32 v7, v6, 4, s92
    v_lshl_add_u32 v7, v3, 7, v7
    s_lshl_b32 s92, s87, 6
    v_add_u32 v11, s92, v1
    v_lshrrev_b32 v8, 5, v11
    v_and_b32 v9, 31, v11
    v_and_b32 v10, 3, v9
    v_lshlrev_b32 v10, 9, v10
    v_lshrrev_b32 v9, 2, v9
    v_lshl_add_u32 v10, v9, 4, v10
    v_lshrrev_b32 v9, 2, v8
    v_lshl_add_u32 v10, v9, 8, v10
    v_and_b32 v9, 3, v8
    v_lshl_add_u32 v10, v9, 2, v10
    v_lshlrev_b32 v11, 1, v11
    s_lshl_b32 s92, s87, 11
    v_lshl_add_u32 v9, v1, 4, s92
W_102:
    s_sleep 2
    ds_read_b32 v12, v4 offset:768
    s_sub_u32 s39, s39, 1
    s_cbranch_scc1 KS_ABORT
    s_waitcnt lgkmcnt(0)
    v_cmp_eq_u32 vcc, 0, v12
    s_cbranch_vccnz W_102
    s_setprio 2
W_103:
    ds_read_b32 v12, v4 offset:32
    s_sub_u32 s39, s39, 1
    s_cbranch_scc1 KS_ABORT
    s_waitcnt lgkmcnt(0)
    v_cmp_eq_u32 vcc, 0, v12
    s_cbranch_vccnz W_103
    ds_read_b128 v[12:15], v7 offset:0
    ds_read_b128 v[16:19], v7 offset:512
    ds_read_b128 v[20:23], v7 offset:1024
    ds_read_b128 v[24:27], v7 offset:1536
    ds_read_b128 v[28:31], v7 offset:2048
    s_waitcnt lgkmcnt(4)
    v_mfma_f32_16x16x32_bf16 v[112:115], v[12:15], v[32:35], 0
    v_mfma_f32_16x16x32_bf16 v[116:119], v[12:15], v[36:39], 0
    v_mfma_f32_16x16x32_bf16 v[120:123], v[12:15], v[40:43], 0
    v_mfma_f32_16x16x32_bf16 v[124:127], v[12:15], v[44:47], 0
    s_waitcnt lgkmcnt(3)
    v_mfma_f32_16x16x32_bf16 v[112:115], v[16:19], v[48:51], v[112:115]
    v_mfma_f32_16x16x32_bf16 v[116:119], v[16:19], v[52:55], v[116:119]
    v_mfma_f32_16x16x32_bf16 v[120:123], v[16:19], v[56:59], v[120:123]
    v_mfma_f32_16x16x32_bf16 v[124:127], v[16:19], v[60:63], v[124:127]
    s_waitcnt lgkmcnt(2)
    v_mfma_f32_16x16x32_bf16 v[112:115], v[20:23], v[64:67], v[112:115]
    v_mfma_f32_16x16x32_bf16 v[116:119], v[20:23], v[68:71], v[116:119]
    v_mfma_f32_16x16x32_bf16 v[120:123], v[20:23], v[72:75], v[120:123]
    v_mfma_f32_16x16x32_bf16 v[124:127], v[20:23], v[76:79], v[124:127]
    s_waitcnt lgkmcnt(1)
    v_mfma_f32_16x16x32_bf16 v[112:115], v[24:27], v[80:83], v[112:115]
    v_mfma_f32_16x16x32_bf16 v[116:119], v[24:27], v[84:87], v[116:119]
    v_mfma_f32_16x16x32_bf16 v[120:123], v[24:27], v[88:91], v[120:123]
    v_mfma_f32_16x16x32_bf16 v[124:127], v[24:27], v[92:95], v[124:127]
    s_bitcmp1_b32 s87, 0
    s_cbranch_scc1 KS_G5
    s_waitcnt lgkmcnt(0)
    v_mfma_f32_16x16x32_bf16 v[112:115], v[28:31], v[96:99], v[112:115]
    v_mfma_f32_16x16x32_bf16 v[116:119], v[28:31], v[100:103], v[116:119]
    v_mfma_f32_16x16x32_bf16 v[120:123], v[28:31], v[104:107], v[120:123]
    v_mfma_f32_16x16x32_bf16 v[124:127], v[28:31], v[108:111], v[124:127]
KS_G5:
    s_mov_b32 exec_lo, -1
    s_mov_b32 exec_hi, 0
    s_nop 5
    ds_write_b128 v9, v[112:115] offset:26368
    ds_write_b128 v9, v[116:119] offset:26880
    ds_write_b128 v9, v[120:123] offset:27392
    ds_write_b128 v9, v[124:127] offset:27904
    s_mov_b64 exec, -1
    s_waitcnt lgkmcnt(0)
    s_barrier
    ds_read_b32 v32, v10 offset:26368
    ds_read_b32 v33, v10 offset:26496
    ds_read_b32 v34, v10 offset:28416
    ds_read_b32 v35, v10 offset:28544
    ds_read_b32 v36, v10 offset:30464
    ds_read_b32 v37, v10 offset:30592
    ds_read_b32 v38, v10 offset:32512
    ds_read_b32 v39, v10 offset:32640
    s_waitcnt lgkmcnt(4)
    v_pk_add_f32 v[32:33], v[32:33], v[34:35]
    s_waitcnt lgkmcnt(0)
    v_pk_add_f32 v[36:37], v[36:37], v[38:39]
    v_pk_add_f32 v[32:33], v[32:33], v[36:37]
    v_cvt_pk_bf16_f32 v34, v32, v33
    v_lshlrev_b32 v32, 16, v34
    v_and_b32 v33, 0xffff0000, v34
    v_mul_f32 v34, 0xbfb8aa3b, v32
    v_exp_f32 v34, v34
    s_nop 0
    v_add_f32 v34, 1.0, v34
    v_rcp_f32 v34, v34
    s_nop 0
    v_mul_f32 v34, v32, v34
    v_cvt_pk_bf16_f32 v34, v34, v34
    v_lshlrev_b32 v34, 16, v34
    v_mul_f32 v34, v34, v33
    v_cvt_pk_bf16_f32 v34, v34, v34
    ds_write_b16 v11, v34 offset:1024
    s_waitcnt lgkmcnt(0)
    s_barrier
    s_branch KS_P2
KS_P:
    s_branch KS_P1
    s_mov_b32 s68, s30
    s_mov_b32 s69, s31
    s_mov_b32 s70, 0x510000
    s_mov_b32 s71, 0x20000
    s_sub_u32 s94, s38, 10
    v_lshlrev_b32 v6, 4, v1
    s_mul_i32 s92, s89, 36864
    s_mul_i32 s93, s94, 18432
    s_add_u32 s92, s92, s93
    s_add_u32 s93, s93, 109184
    s_lshl_b32 s94, s94, 1
    v_mov_b32 v7, s94
    v_mov_b32 v8, s84
W_104:
    s_sleep 2
    ds_read_b32 v10, v4 offset:20
    s_sub_u32 s39, s39, 1
    s_cbranch_scc1 KS_ABORT
    s_waitcnt lgkmcnt(0)
    v_cmp_ne_u32 vcc, s84, v10
    s_cbranch_vccnz W_104
    s_setprio 1
    s_add_u32 m0, s93, 0
    s_nop 0
    buffer_load_dwordx4 v6, s[68:71], s92 offen offset:0 nt lds
    buffer_load_dwordx4 v6, s[68:71], s92 offen offset:1024 nt lds
    buffer_load_dwordx4 v6, s[68:71], s92 offen offset:2048 nt lds
    buffer_load_dwordx4 v6, s[68:71], s92 offen offset:3072 nt lds
    s_add_u32 m0, s93, 4096
    s_add_u32 s92, s92, 4096
    buffer_load_dwordx4 v6, s[68:71], s92 offen offset:0 nt lds
    buffer_load_dwordx4 v6, s[68:71], s92 offen offset:1024 nt lds
    buffer_load_dwordx4 v6, s[68:71], s92 offen offset:2048 nt lds
    buffer_load_dwordx4 v6, s[68:71], s92 offen offset:3072 nt lds
    s_add_u32 m0, s93, 8192
    s_add_u32 s92, s92, 4096
    buffer_load_dwordx4 v6, s[68:71], s92 offen offset:0 nt lds
    buffer_load_dwordx4 v6, s[68:71], s92 offen offset:1024 nt lds
    buffer_load_dwordx4 v6, s[68:71], s92 offen offset:2048 nt lds
    buffer_load_dwordx4 v6, s[68:71], s92 offen offset:3072 nt lds
    s_add_u32 m0, s93, 12288
    s_add_u32 s92, s92, 4096
    buffer_load_dwordx4 v6, s[68:71], s92 offen offset:0 nt lds
    buffer_load_dwordx4 v6, s[68:71], s92 offen offset:1024 nt lds
    buffer_load_dwordx4 v6, s[68:71], s92 offen offset:2048 nt lds
    buffer_load_dwordx4 v6, s[68:71], s92 offen offset:3072 nt lds
    s_add_u32 m0, s93, 16384
    s_add_u32 s92, s92, 4096
    buffer_load_dwordx4 v6, s[68:71], s92 offen offset:0 nt lds
    buffer_load_dwordx4 v6, s[68:71], s92 offen offset:1024 nt lds
    s_waitcnt vmcnt(0)
    ds_write_b16 v7, v8 offset:40
KS_P1:
    s_setprio 0
    s_waitcnt lgkmcnt(0)
    s_barrier
    s_barrier
    s_setprio 2
KS_P2:
    s_sub_u32 s87, s38, 10
    s_add_u32 s64, s36, 0x850000
    s_addc_u32 s65, s37, 0
    s_mov_b32 s66, 0x28c800
    s_mov_b32 s67, 0x20000
    s_mov_b32 s68, s32
    s_mov_b32 s69, s33
    s_mov_b32 s70, 0x240000
    s_mov_b32 s71, 0x20000
    v_lshrrev_b32 v8, 3, v1
    v_mul_u32_u24 v8, 18560, v8
    v_and_b32 v9, 7, v1
    v_lshl_add_u32 v8, v9, 4, v8
    s_mul_i32 s92, s87, 445440
    s_lshl_b32 s93, s89, 7
    s_add_u32 s92, s92, s93
    s_add_u32 s93, s92, 148480
    s_add_u32 s94, s92, 296960
    s_lshl_b32 s95, s87, 7
    v_lshl_add_u32 v6, v9, 4, s95
    v_lshl_add_u32 v6, v3, 2, v6
    v_lshlrev_b32 v12, 2, v1
    v_add_u32 v12, 2048, v12
    v_lshlrev_b32 v13, 4, v1
    v_and_b32 v14, 12, v12
    ds_read_b32 v24, v14 offset:224
    s_waitcnt lgkmcnt(0)
    v_lshrrev_b32 v25, 8, v24
    v_lshrrev_b32 v26, 16, v24
    v_lshrrev_b32 v27, 24, v24
    s_barrier
    s_branch PPE_106
PP_105:
    s_sleep 1
PPE_106:
    buffer_load_dwordx4 v[32:35], v8, s[64:67], s92 offen sc1
    buffer_load_dwordx4 v[36:39], v8, s[64:67], s93 offen sc1
    buffer_load_dwordx4 v[40:43], v8, s[64:67], s94 offen sc1
    s_sub_u32 s39, s39, 1
    s_cbranch_scc1 KS_ABORT
    s_waitcnt vmcnt(2)
    v_xor_b32 v44, v24, v32
    v_xor_b32 v45, v25, v33
    v_bitop3_b32 v44, v44, v26, v34 bitop3:0xf6
    v_bitop3_b32 v45, v45, v27, v35 bitop3:0xf6
    s_waitcnt vmcnt(1)
    v_bitop3_b32 v44, v44, v24, v36 bitop3:0xf6
    v_bitop3_b32 v45, v45, v25, v37 bitop3:0xf6
    v_bitop3_b32 v44, v44, v26, v38 bitop3:0xf6
    v_bitop3_b32 v45, v45, v27, v39 bitop3:0xf6
    s_waitcnt vmcnt(0)
    v_bitop3_b32 v44, v44, v24, v40 bitop3:0xf6
    v_bitop3_b32 v45, v45, v25, v41 bitop3:0xf6
    v_bitop3_b32 v44, v44, v26, v42 bitop3:0xf6
    v_bitop3_b32 v45, v45, v27, v43 bitop3:0xf6
    v_or_b32 v44, v44, v45
    v_and_b32 v44, 0xff, v44
    v_cmp_ne_u32 vcc, 0, v44
    s_cbranch_vccnz PP_105
    v_pk_add_f32 v[32:33], v[32:33], v[36:37]
    v_pk_add_f32 v[34:35], v[34:35], v[38:39]
    v_pk_add_f32 v[32:33], v[32:33], v[40:41]
    v_pk_add_f32 v[34:35], v[34:35], v[42:43]
    s_nop 0
    v_add_f32_dpp v32, v32, v32 row_ror:8 row_mask:0xf bank_mask:0xf
    v_add_f32_dpp v33, v33, v33 row_ror:8 row_mask:0xf bank_mask:0xf
    v_add_f32_dpp v34, v34, v34 row_ror:8 row_mask:0xf bank_mask:0xf
    v_add_f32_dpp v35, v35, v35 row_ror:8 row_mask:0xf bank_mask:0xf
    v_permlane16_swap_b32 v32, v33
    s_nop 0
    v_permlane16_swap_b32 v34, v35
    v_add_f32 v32, v32, v33
    v_add_f32 v34, v34, v35
    s_nop 1
    v_permlane32_swap_b32 v32, v34
    v_add_f32 v32, v32, v34
    ds_write_b32 v6, v32 offset:2048
    s_waitcnt lgkmcnt(0)
    s_barrier
    s_cmp_lg_u32 s87, 0
    s_cbranch_scc1 KS_PEND
    s_mov_b32 exec_lo, -1
    s_mov_b32 exec_hi, 0
    ds_read2_b32 v[32:33], v12 offset0:0 offset1:32
    ds_read2_b32 v[34:35], v12 offset0:64 offset1:96
    ds_read2_b32 v[36:37], v12 offset0:128 offset1:160
    ds_read_b128 v[40:43], v13 offset:1536
    s_waitcnt lgkmcnt(0)
    v_pk_add_f32 v[32:33], v[32:33], v[34:35]
    v_pk_add_f32 v[32:33], v[32:33], v[36:37]
    v_add_f32 v8, v32, v33
    v_cvt_pk_bf16_f32 v8, v8, v8
    v_lshlrev_b32 v8, 16, v8
    v_mul_f32 v8, v8, v42
    v_cvt_pk_bf16_f32 v8, v8, v8
    v_lshlrev_b32 v8, 16, v8
    v_add_f32 v8, v8, v40
    v_cvt_pk_bf16_f32 v8, v8, v8
    v_lshlrev_b32 v8, 16, v8
    v_add_f32 v8, v8, v41
    v_cvt_pk_bf16_f32 v8, v8, v8
    buffer_store_short v8, v43, s[68:71], 0 offen
KS_PEND:
KS_ABORT:
KS_END:
    s_endpgm
.section .rodata,"a"
.p2align 6
.amdhsa_kernel sequential_preLN__ssm_conv_s4__moe_arch_mod__prompt_kernel
  .amdhsa_next_free_vgpr 128
  .amdhsa_next_free_sgpr 100
  .amdhsa_accum_offset 128
  .amdhsa_group_segment_fixed_size 0
  .amdhsa_kernarg_size 136
  .amdhsa_user_sgpr_count 2
  .amdhsa_user_sgpr_kernarg_segment_ptr 1
  .amdhsa_system_sgpr_workgroup_id_x 1
  .amdhsa_float_denorm_mode_32 3
.end_amdhsa_kernel
```

```asm
; @launch grid=(256,1,1) block=(1024,1,1) lds=154240
.amdgcn_target "amdgcn-amd-amdhsa--gfx950"
.text
.globl sequential_preLN__ssm_conv_s4__moe_arch_mod__prompt_kernel
.p2align 8
.type sequential_preLN__ssm_conv_s4__moe_arch_mod__prompt_kernel,@function
sequential_preLN__ssm_conv_s4__moe_arch_mod__prompt_kernel:
    s_cmp_ge_u32 s2, 256
    s_cbranch_scc1 KS_END
    s_load_dwordx16 s[4:19], s[0:1], 0
    s_load_dwordx16 s[20:35], s[0:1], 64
    s_load_dwordx2 s[36:37], s[0:1], 128
    v_readfirstlane_b32 s38, v0
    s_lshr_b32 s38, s38, 6
    s_and_b32 s40, s2, 7
    s_lshr_b32 s41, s2, 3
    s_cmp_lg_u32 s38, 0
    s_cbranch_scc1 KS_CPE
    s_getpc_b64 s[42:43]
KS_PC:
    s_and_b32 s92, s41, 3
    s_lshl_b32 s92, s92, 13
    v_and_b32 v126, 63, v0
    v_lshl_add_u32 v126, v126, 7, s92
    v_min_u32 v126, KS_END-KS_PC, v126
    global_load_dword v127, v126, s[42:43]
KS_CPE:
    s_add_u32 s92, s38, 8
    s_sub_u32 s93, s38, 4
    s_cmp_lt_u32 s38, 8
    s_cselect_b32 s92, s92, s93
    s_cmp_lt_u32 s38, 4
    s_cselect_b32 s38, s38, s92
    v_and_b32 v1, 63, v0
    v_and_b32 v2, 15, v1
    v_lshrrev_b32 v3, 4, v1
    v_mov_b32 v4, 0
    v_mov_b32 v5, 1
    s_mov_b32 s39, 524288
    s_mov_b32 s84, 0x01010101
    s_lshl_b32 s90, s40, 5
    s_add_u32 s90, s90, s41
    s_mul_i32 s89, s40, 18
    s_add_u32 s89, s89, s41
    s_cmp_lt_u32 s38, 4
    s_cbranch_scc1 KS_L
    s_cmp_ge_u32 s38, 12
    s_cbranch_scc1 KS_X
    s_setprio 2
    s_lshr_b32 s87, s38, 2
    s_sub_u32 s87, s87, 1
    s_mul_i32 s86, s87, 3
    s_xor_b32 s86, s86, s38
    s_and_b32 s86, s86, 3
    s_lshl_b32 s88, s90, 1
    s_add_u32 s88, s88, s87
    s_lshl_b32 s92, s86, 11
    s_add_u32 s92, s92, 146048
    v_lshl_add_u32 v28, v1, 3, s92
    s_cmp_eq_u32 s86, 3
    s_cbranch_scc1 PX_1
    v_lshlrev_b32 v26, 3, v2
    v_mov_b32 v21, 0x80
    s_cmp_eq_u32 s86, 1
    s_cbranch_scc1 PX_2
    s_cmp_eq_u32 s86, 2
    s_cbranch_scc1 PX_3
    v_lshl_add_u32 v26, v3, 1, v26
    v_mov_b32 v22, 1
    s_branch PX_4
PX_2:
    v_cmp_gt_u32 vcc, 2, v3
    v_lshl_add_u32 v20, v3, 2, v26
    v_add_u32 v20, 256, v20
    v_lshl_add_u32 v26, v3, 8, v26
    v_cndmask_b32 v26, v26, v20, vcc
    v_cndmask_b32 v22, v21, 2, vcc
    v_cndmask_b32 v21, 4, v21, vcc
    s_branch PX_4
PX_3:
    v_lshl_add_u32 v26, v3, 9, v26
    v_add_u32 v26, 0x400, v26
    v_mov_b32 v22, 0x100
PX_4:
    v_mad_u32_u24 v26, v22, s87, v26
    v_add_u32 v27, v26, v21
    s_movk_i32 s96, 31232
    s_movk_i32 s97, -19072
    s_lshl_b32 s95, s87, 9
    v_cvt_f32_u32 v20, v26
    v_max_u32 v22, 0x800, v26
    v_cvt_f32_u32 v21, v27
    v_max_u32 v23, 0x800, v27
    v_cmp_gt_u32 vcc, 0x80, v26
    v_lshrrev_b32 v24, 16, v20
    v_add3_u32 v24, v24, v22, s97
    v_cndmask_b32 v24, v24, v26, vcc
    v_cmp_gt_u32 vcc, 0x80, v27
    v_lshrrev_b32 v25, 16, v21
    v_add3_u32 v25, v25, v23, s97
    v_cndmask_b32 v25, v25, v27, vcc
    v_min_u32 v24, 642, v24
    v_lshl_add_u32 v24, v24, 1, s96
    v_min_u32 v25, 642, v25
    v_lshl_add_u32 v25, v25, 1, s96
    v_add_u32 v29, s95, v28
    v_lshl_or_b32 v24, v25, 16, v24
    v_lshl_or_b32 v25, v27, 16, v26
    ds_write_b64 v29, v[24:25]
PX_1:
KS_GRP:
    s_lshl_b32 s92, s88, 8
    v_lshl_add_u32 v20, v1, 2, s92
    s_lshl_b32 s92, s88, 1
    v_mov_b32 v21, s92
    s_mul_i32 s85, s87, 36672
    s_add_u32 s85, s85, 35840
    s_waitcnt lgkmcnt(0)
    global_load_ushort v46, v21, s[18:19]
    global_load_dword v40, v20, s[6:7]
    global_load_dword v41, v20, s[8:9]
    global_load_dword v42, v20, s[10:11]
    global_load_dword v43, v20, s[12:13]
    global_load_dword v44, v20, s[14:15]
    global_load_dword v45, v20, s[16:17]
    global_load_ushort v107, v21, s[20:21]
    s_barrier
    s_movk_i32 s96, 31232
    s_cmp_eq_u32 s87, 2
    s_cbranch_scc1 PREE_7
    v_mov_b32 v32, 641
    s_cmp_eq_u32 s87, 1
    s_cbranch_scc1 PREB_5
    v_mov_b32 v33, 32514
    s_cmp_eq_u32 s86, 1
    s_cbranch_scc1 PRE_9
    s_cmp_eq_u32 s86, 2
    s_cbranch_scc1 PRE_10
    s_cmp_eq_u32 s86, 3
    s_cbranch_scc1 PRE_11
    v_lshlrev_b32 v23, 1, v1
    v_sub_u32 v30, 93, v23
    v_cmp_lt_u32 vcc, 61, v30
    v_lshlrev_b32 v31, 2, v30
    v_add_u32 v31, 32010, v31
    v_cndmask_b32 v24, v31, v33, vcc
    v_sub_u32 v30, 92, v23
    v_cmp_lt_u32 vcc, 61, v30
    v_lshlrev_b32 v31, 2, v30
    v_add_u32 v31, 32010, v31
    v_cndmask_b32 v25, v31, v33, vcc
    v_sub_u32 v30, 94, v23
    v_cmp_lt_u32 vcc, 62, v30
    v_lshlrev_b32 v31, 2, v30
    v_add_u32 v31, 32008, v31
    v_cndmask_b32 v26, v31, v33, vcc
    v_sub_u32 v30, 93, v23
    v_cmp_lt_u32 vcc, 62, v30
    v_lshlrev_b32 v31, 2, v30
    v_add_u32 v31, 32008, v31
    v_cndmask_b32 v27, v31, v33, vcc
    s_branch PREW_6
PRE_9:
    v_min_u32 v23, 47, v1
    v_lshlrev_b32 v23, 1, v23
    v_sub_u32 v30, 64, v23
    v_cmp_lt_u32 vcc, 63, v30
    v_lshlrev_b32 v31, 2, v30
    v_add_u32 v31, 32258, v31
    v_cndmask_b32 v24, v31, v33, vcc
    v_sub_u32 v30, 63, v23
    v_cmp_lt_u32 vcc, 63, v30
    v_lshlrev_b32 v31, 2, v30
    v_add_u32 v31, 32258, v31
    v_cndmask_b32 v25, v31, v33, vcc
    v_sub_u32 v30, 62, v23
    v_cmp_lt_u32 vcc, 63, v30
    v_lshlrev_b32 v31, 2, v30
    v_add_u32 v31, 32258, v31
    v_cndmask_b32 v27, v31, v33, vcc
    v_mov_b32 v26, v25
    s_branch PREW_6
PRE_10:
    v_min_u32 v23, 47, v1
    v_lshlrev_b32 v23, 1, v23
    v_sub_u32 v30, 64, v23
    v_cmp_lt_u32 vcc, 63, v30
    v_lshlrev_b32 v31, 2, v30
    v_add_u32 v31, 32260, v31
    v_cndmask_b32 v24, v31, v33, vcc
    v_sub_u32 v30, 63, v23
    v_cmp_lt_u32 vcc, 63, v30
    v_lshlrev_b32 v31, 2, v30
    v_add_u32 v31, 32260, v31
    v_cndmask_b32 v25, v31, v33, vcc
    v_sub_u32 v30, 62, v23
    v_cmp_lt_u32 vcc, 63, v30
    v_lshlrev_b32 v31, 2, v30
    v_add_u32 v31, 32260, v31
    v_cndmask_b32 v27, v31, v33, vcc
    v_mov_b32 v26, v25
    s_branch PREW_6
PRE_11:
    v_cmp_gt_u32 vcc, 9, v1
    v_add_u32 v23, 0x100, v1
    v_mov_b32 v33, 0x200
    v_cndmask_b32 v23, v23, v1, vcc
    v_lshlrev_b32 v23, 1, v23
    v_sub_u32 v30, 544, v23
    v_cvt_f32_i32 v31, v30
    v_cmp_gt_u32 vcc, 0x100, v30
    v_cvt_pk_bf16_f32 v31, v31, v31
    v_and_b32 v31, 0xffff, v31
    v_subrev_u32 v31, 0x4280, v31
    v_cndmask_b32 v31, v31, v30, vcc
    v_cmp_lt_u32 vcc, 0x20d, v30
    v_or_b32 v30, 1, v23
    s_nop 0
    v_cndmask_b32 v31, v31, v32, vcc
    v_cmp_eq_u32 vcc, 0x25d, v30
    s_nop 1
    v_cndmask_b32 v31, v31, v33, vcc
    v_lshl_add_u32 v24, v31, 1, s96
    v_add_u32 v23, 1, v23
    v_sub_u32 v30, 544, v23
    v_cvt_f32_i32 v31, v30
    v_cmp_gt_u32 vcc, 0x100, v30
    v_cvt_pk_bf16_f32 v31, v31, v31
    v_and_b32 v31, 0xffff, v31
    v_subrev_u32 v31, 0x4280, v31
    v_cndmask_b32 v31, v31, v30, vcc
    v_cmp_lt_u32 vcc, 0x20d, v30
    v_or_b32 v30, 1, v23
    s_nop 0
    v_cndmask_b32 v31, v31, v32, vcc
    v_cmp_eq_u32 vcc, 0x25d, v30
    s_nop 1
    v_cndmask_b32 v31, v31, v33, vcc
    v_lshl_add_u32 v25, v31, 1, s96
    v_add_u32 v23, 1, v23
    v_sub_u32 v30, 544, v23
    v_cvt_f32_i32 v31, v30
    v_cmp_gt_u32 vcc, 0x100, v30
    v_cvt_pk_bf16_f32 v31, v31, v31
    v_and_b32 v31, 0xffff, v31
    v_subrev_u32 v31, 0x4280, v31
    v_cndmask_b32 v31, v31, v30, vcc
    v_cmp_lt_u32 vcc, 0x20d, v30
    v_or_b32 v30, 1, v23
    s_nop 0
    v_cndmask_b32 v31, v31, v32, vcc
    v_cmp_eq_u32 vcc, 0x25d, v30
    s_nop 1
    v_cndmask_b32 v31, v31, v33, vcc
    v_lshl_add_u32 v27, v31, 1, s96
    v_mov_b32 v26, v25
    s_branch PREW_6
PREB_5:
    s_lshl_b32 s93, s86, 7
    s_add_u32 s93, s93, 18
    v_lshl_add_u32 v23, v1, 1, s93
    v_sub_u32 v30, 544, v23
    v_cvt_f32_i32 v31, v30
    v_cmp_gt_u32 vcc, 0x100, v30
    v_cvt_pk_bf16_f32 v31, v31, v31
    v_and_b32 v31, 0xffff, v31
    v_subrev_u32 v31, 0x4280, v31
    v_cndmask_b32 v31, v31, v30, vcc
    v_cmp_lt_u32 vcc, 0x20d, v30
    s_nop 1
    v_cndmask_b32 v31, v31, v32, vcc
    v_lshl_add_u32 v24, v31, 1, s96
    v_add_u32 v23, 1, v23
    v_sub_u32 v30, 544, v23
    v_cvt_f32_i32 v31, v30
    v_cmp_gt_u32 vcc, 0x100, v30
    v_cvt_pk_bf16_f32 v31, v31, v31
    v_and_b32 v31, 0xffff, v31
    v_subrev_u32 v31, 0x4280, v31
    v_cndmask_b32 v31, v31, v30, vcc
    v_cmp_lt_u32 vcc, 0x20d, v30
    s_nop 1
    v_cndmask_b32 v31, v31, v32, vcc
    v_lshl_add_u32 v25, v31, 1, s96
    v_add_u32 v23, 1, v23
    v_sub_u32 v30, 544, v23
    v_cvt_f32_i32 v31, v30
    v_cmp_gt_u32 vcc, 0x100, v30
    v_cvt_pk_bf16_f32 v31, v31, v31
    v_and_b32 v31, 0xffff, v31
    v_subrev_u32 v31, 0x4280, v31
    v_cndmask_b32 v31, v31, v30, vcc
    v_cmp_lt_u32 vcc, 0x20d, v30
    s_nop 1
    v_cndmask_b32 v31, v31, v32, vcc
    v_lshl_add_u32 v26, v31, 1, s96
    s_sub_u32 s93, s86, 1
    s_cmp_lt_u32 s93, 2
    s_cselect_b32 s94, 47, 63
    s_mul_i32 s93, s93, 384
    s_add_u32 s93, s93, 35664
    s_cmp_eq_u32 s86, 0
    s_cselect_b32 s93, 35152, s93
    s_cmp_eq_u32 s86, 3
    s_cselect_b32 s93, 32528, s93
    s_cselect_b32 s95, 0x100, 0
    v_cmp_gt_u32 vcc, 9, v1
    v_min_u32 v23, s94, v1
    v_add_u32 v30, s95, v23
    v_cndmask_b32 v23, v30, v23, vcc
    v_lshl_add_u32 v27, v23, 2, s93
    v_lshl_or_b32 v24, v25, 16, v24
    v_lshl_or_b32 v25, v27, 16, v26
    ds_write_b64 v28, v[24:25] offset:1024
    v_mov_b32 v24, s86
    ds_write_b8 v24, v5 offset:212
    s_branch PREE_7
PREW_6:
    v_lshl_or_b32 v24, v25, 16, v24
    v_lshl_or_b32 v25, v27, 16, v26
    ds_write_b64 v28, v[24:25] offset:1536
    v_mov_b32 v24, s86
    ds_write_b8 v24, v5 offset:208
PREE_7:
    s_mul_i32 s93, s86, 8704
    s_min_u32 s94, s93, 22304
    s_add_u32 s94, s94, s85
    s_lshl_b32 s92, s87, 4
    v_mov_b32 v14, s92
    v_add_u32 v15, s86, v14
    v_lshl_add_u32 v72, v1, 3, s94
    v_add_u32 v73, 2176, v72
    v_add_u32 v74, 4352, v72
    v_add_u32 v75, 6528, v72
    v_mul_u32_u24 v126, 544, v2
    v_lshl_add_u32 v126, v3, 4, v126
    v_add_u32 v126, s85, v126
    v_add_u32 v127, s93, v126
    v_lshlrev_b32 v20, 3, v3
    v_sub_u32 v20, v20, v2
    v_add_u32 v21, 16, v20
    v_lshrrev_b32 v21, 1, v21
    v_and_b32 v22, 1, v2
    s_add_u32 s92, s85, 32528
    v_lshl_add_u32 v21, v21, 2, s92
    s_movk_i32 s92, 1344
    s_movk_i32 s94, 192
    v_mad_u32_u24 v6, v22, s92, v21
    v_add_u32 v7, 640, v6
    v_mad_u32_u24 v23, v22, s94, v21
    v_add_u32 v13, 3136, v23
    v_lshlrev_b32 v23, 2, v3
    v_sub_u32 v23, v23, v2
    s_add_u32 s92, s85, 35212
    v_lshl_add_u32 v11, v23, 2, s92
    s_mul_i32 s94, s87, 4672
    s_add_u32 s94, s94, 3072
    v_lshl_add_u32 v23, v2, 5, s94
    v_lshl_add_u32 v8, v3, 4, v23
    v_bfe_u32 v20, v1, 2, 2
    v_and_b32 v21, 3, v1
    v_lshl_add_u32 v20, v3, 3, v20
    v_lshlrev_b32 v105, 2, v21
    v_lshl_add_u32 v21, v21, 3, s85
    v_lshl_add_u32 v9, v20, 4, v21
    v_lshl_add_u32 v10, v20, 5, v21
    v_lshlrev_b32 v12, 4, v1
    s_add_u32 s64, s36, 0x600000
    s_addc_u32 s65, s37, 0
    s_mov_b32 s66, 0x240000
    s_mov_b32 s67, 0x20000
    s_mov_b32 s10, 0x8080
    s_lshl_b32 s92, s86, 19
    s_lshl_b32 s93, s90, 6
    s_add_u32 s92, s92, s93
    s_lshl_b32 s93, s86, 16
    s_lshl_b32 s95, s88, 6
    s_add_u32 s93, s93, s95
    s_add_u32 s93, s93, 2064384
    s_cmp_eq_u32 s87, 2
    s_cselect_b32 s6, s93, s92
    s_cselect_b32 s8, 0x1080, s10
    s_cselect_b32 s92, 1, 3
    s_and_b32 s92, s92, s86
    s_lshl_b32 s92, s92, 11
    s_xor_b32 s6, s6, s92
    s_and_b32 s10, s6, 0x7c0
    s_xor_b32 s6, s6, s10
    s_xor_b32 s7, s6, 0x6000
    s_and_b32 s9, s87, 1
    s_lshl_b32 s9, s9, 4
    s_mov_b32 s12, 0x55555555
    s_mov_b32 s13, 0x55555555
    s_lshl_b32 s92, s86, 8
    s_add_u32 s92, s92, s85
    s_add_u32 s92, s92, 36
    v_lshl_add_u32 v124, v1, 2, s92
    s_movk_i32 s92, 192
    s_cmp_eq_u32 s86, 0
    s_cselect_b32 s92, 256, s92
    s_cmp_eq_u32 s86, 3
    s_cselect_b32 s92, 1344, s92
    v_mov_b32 v20, s85
    ds_write_b16 v20, v4 offset:32514
    s_mov_b32 s18, s92
    v_mov_b32 v125, v28
W_12:
    ds_read_b64 v[18:19], v4 offset:208
    s_sub_u32 s39, s39, 1
    s_cbranch_scc1 KS_ABORT
    s_waitcnt lgkmcnt(0)
    v_and_b32 v18, v18, v19
    v_cmp_ne_u32 vcc, s84, v18
    s_cbranch_vccnz W_12
    ds_read2st64_b64 v[28:31], v125 offset0:0 offset1:1
    ds_read2st64_b64 v[32:35], v125 offset0:2 offset1:3
    s_waitcnt lgkmcnt(0)
    v_add_u32_sdwa v108, s85, v28 dst_sel:DWORD dst_unused:UNUSED_PAD src0_sel:DWORD src1_sel:WORD_0
    v_add_u32_sdwa v109, s85, v28 dst_sel:DWORD dst_unused:UNUSED_PAD src0_sel:DWORD src1_sel:WORD_1
    v_cvt_f32_u32_sdwa v110, v29 dst_sel:DWORD dst_unused:UNUSED_PAD src0_sel:WORD_0
    v_cvt_f32_u32_sdwa v111, v29 dst_sel:DWORD dst_unused:UNUSED_PAD src0_sel:WORD_1
    v_add_u32_sdwa v112, s85, v30 dst_sel:DWORD dst_unused:UNUSED_PAD src0_sel:DWORD src1_sel:WORD_0
    v_add_u32_sdwa v113, s85, v30 dst_sel:DWORD dst_unused:UNUSED_PAD src0_sel:DWORD src1_sel:WORD_1
    v_cvt_f32_u32_sdwa v114, v31 dst_sel:DWORD dst_unused:UNUSED_PAD src0_sel:WORD_0
    v_cvt_f32_u32_sdwa v115, v31 dst_sel:DWORD dst_unused:UNUSED_PAD src0_sel:WORD_1
    v_add_u32_sdwa v116, s85, v32 dst_sel:DWORD dst_unused:UNUSED_PAD src0_sel:DWORD src1_sel:WORD_0
    v_add_u32_sdwa v117, s85, v32 dst_sel:DWORD dst_unused:UNUSED_PAD src0_sel:DWORD src1_sel:WORD_1
    v_add_u32_sdwa v118, s85, v33 dst_sel:DWORD dst_unused:UNUSED_PAD src0_sel:DWORD src1_sel:WORD_0
    v_add_u32_sdwa v119, s85, v33 dst_sel:DWORD dst_unused:UNUSED_PAD src0_sel:DWORD src1_sel:WORD_1
    v_add_u32_sdwa v120, s85, v34 dst_sel:DWORD dst_unused:UNUSED_PAD src0_sel:DWORD src1_sel:WORD_0
    v_add_u32_sdwa v121, s85, v34 dst_sel:DWORD dst_unused:UNUSED_PAD src0_sel:DWORD src1_sel:WORD_1
    v_add_u32_sdwa v122, s85, v35 dst_sel:DWORD dst_unused:UNUSED_PAD src0_sel:DWORD src1_sel:WORD_0
    v_add_u32_sdwa v123, s85, v35 dst_sel:DWORD dst_unused:UNUSED_PAD src0_sel:DWORD src1_sel:WORD_1
    v_add_u32 v125, s18, v119
    s_lshl_b32 s92, s87, 5
    s_add_u32 s92, s92, s41
    s_cmp_ge_u32 s92, 88
    s_cbranch_scc1 KC_RECV
    s_mov_b32 s92, 0x3fb8aa3b
    s_mov_b32 s93, 0x32a57060
    s_mov_b32 s94, 0x3e22f983
    s_mov_b32 s95, 0x31dc9c88
    s_waitcnt vmcnt(7)
    v_lshlrev_b32 v16, 16, v46
    v_mul_f32 v17, s92, v16
    v_fma_f32 v19, v16, s92, -v17
    v_fmac_f32 v19, s93, v16
    v_exp_f32 v17, v17
    v_mul_f32 v19, 0x3f317218, v19
    v_fmac_f32 v17, v17, v19
    v_cvt_pk_bf16_f32 v17, v17, v17
    v_and_b32 v16, 0xffff0000, v17
    s_waitcnt vmcnt(5)
    ds_write_b32 v4, v5 offset:36
    v_lshlrev_b32 v20, 16, v40
    v_and_b32 v21, 0xffff0000, v40
    v_lshlrev_b32 v22, 16, v41
    v_and_b32 v23, 0xffff0000, v41
    v_pk_mul_f32 v[20:21], v[20:21], v[16:17] op_sel_hi:[1,0]
    v_pk_mul_f32 v[22:23], v[22:23], v[16:17] op_sel_hi:[1,0]
    v_max_f32 v36, v20, v21
    v_pk_mul_f32 v[68:69], v[22:23], s[94:95] op_sel_hi:[1,0]
    v_pk_fma_f32 v[70:71], v[22:23], s[94:95], v[68:69] op_sel_hi:[1,0,1] neg_lo:[0,0,1] neg_hi:[0,0,1]
    v_pk_fma_f32 v[70:71], v[22:23], s[94:95], v[70:71] op_sel:[0,1,0]
    s_cmp_eq_u32 s86, 3
    s_cbranch_scc1 SK_14
    s_waitcnt vmcnt(1)
    v_lshlrev_b32 v24, 16, v42
    v_and_b32 v25, 0xffff0000, v42
    v_lshlrev_b32 v26, 16, v43
    v_and_b32 v27, 0xffff0000, v43
    v_lshlrev_b32 v28, 16, v44
    v_and_b32 v29, 0xffff0000, v44
    v_lshlrev_b32 v30, 16, v45
    v_and_b32 v31, 0xffff0000, v45
    v_pk_mul_f32 v[24:25], v[24:25], v[16:17] op_sel_hi:[1,0]
    v_pk_mul_f32 v[26:27], v[26:27], v[16:17] op_sel_hi:[1,0]
    v_pk_mul_f32 v[90:91], v[30:31], v[26:27]
    v_pk_mul_f32 v[92:93], v[30:31], v[24:25]
    v_pk_fma_f32 v[34:35], v[28:29], v[26:27], v[92:93]
    v_pk_fma_f32 v[32:33], v[28:29], v[24:25], v[90:91] neg_lo:[0,0,1] neg_hi:[0,0,1]
    v_max3_f32 v37, abs(v34), abs(v35), abs(v32)
    v_max_f32 v37, v37, abs(v33)
SK_14:
    s_waitcnt vmcnt(0)
    s_nop 0
    v_permlane32_swap_b32 v36, v37
    v_max_f32 v36, v36, v37
    s_nop 1
    v_max_f32_dpp v36, v36, v36 row_ror:8 row_mask:0xf bank_mask:0xf
    s_nop 1
    v_max_f32_dpp v36, v36, v36 row_ror:4 row_mask:0xf bank_mask:0xf
    s_nop 1
    v_max_f32_dpp v36, v36, v36 row_ror:2 row_mask:0xf bank_mask:0xf
    s_nop 1
    v_max_f32_dpp v36, v36, v36 row_ror:1 row_mask:0xf bank_mask:0xf
    v_mov_b32 v38, v36
    s_nop 1
    v_permlane16_swap_b32 v36, v38
    v_max_f32 v36, v36, v38
    s_nop 0
    v_readlane_b32 s14, v36, 0
    v_readlane_b32 s15, v36, 32
    s_add_u32 s15, s15, 0x7fffff
    s_lshr_b32 s15, s15, 23
    s_max_u32 s15, s15, 24
    s_sub_u32 s16, 269, s15
    s_lshl_b32 s16, s16, 23
    v_subrev_f32 v20, s14, v20
    v_subrev_f32 v21, s14, v21
    v_mul_f32 v20, 0x3fb8aa3b, v20
    v_mul_f32 v21, 0x3fb8aa3b, v21
    s_cmp_eq_u32 s86, 3
    s_cbranch_scc1 JOB_18
    s_cmp_eq_u32 s86, 1
    s_cbranch_scc1 JOB_16
    s_cmp_eq_u32 s86, 2
    s_cbranch_scc1 JOB_17
    v_mul_f32 v91, 0x43000000, v68
    v_mul_f32 v90, 0x43000000, v20
    v_mul_f32 v95, 0x43000000, v69
    v_mul_f32 v94, 0x43000000, v21
    v_fract_f32 v91, v91
    v_fract_f32 v95, v95
    v_fmac_f32 v91, 0x43000000, v70
    v_fmac_f32 v95, 0x43000000, v71
    v_exp_f32 v90, v90
    v_cos_f32 v92, v91
    v_sin_f32 v91, v91
    v_exp_f32 v94, v94
    v_cos_f32 v96, v95
    v_sin_f32 v95, v95
    v_mul_f32 v44, v90, v92
    v_mul_f32 v46, v90, v91
    v_mul_f32 v45, v94, v96
    v_mul_f32 v47, v94, v95
    v_pk_mul_f32 v[32:33], v[32:33], s[16:17] op_sel_hi:[1,0]
    v_pk_mul_f32 v[34:35], v[34:35], s[16:17] op_sel_hi:[1,0]
    v_fract_f32 v91, v68
    v_fract_f32 v95, v69
    v_fmac_f32 v91, 1.0, v70
    v_fmac_f32 v95, 1.0, v71
    v_exp_f32 v90, v20
    v_cos_f32 v92, v91
    v_sin_f32 v91, v91
    v_exp_f32 v94, v21
    v_cos_f32 v96, v95
    v_sin_f32 v95, v95
    v_mul_f32 v40, v90, v92
    v_mul_f32 v42, v90, v91
    v_mul_f32 v41, v94, v96
    v_mul_f32 v43, v94, v95
    v_pk_mul_f32 v[90:91], v[34:35], v[46:47]
    v_pk_mul_f32 v[94:95], v[34:35], v[42:43]
    v_pk_mul_f32 v[92:93], v[34:35], v[44:45]
    v_pk_mul_f32 v[96:97], v[34:35], v[40:41]
    v_pk_fma_f32 v[62:63], v[32:33], v[46:47], v[92:93]
    v_pk_fma_f32 v[54:55], v[32:33], v[42:43], v[96:97]
    v_pk_fma_f32 v[60:61], v[32:33], v[44:45], v[90:91] neg_lo:[0,0,1] neg_hi:[0,0,1]
    v_pk_fma_f32 v[52:53], v[32:33], v[40:41], v[94:95] neg_lo:[0,0,1] neg_hi:[0,0,1]
    v_cvt_pk_f16_f32 v98, v32, v34
    v_cvt_pk_f16_f32 v99, v33, v35
    v_cvt_pk_f16_f32 v100, v60, v62
    v_cvt_pk_f16_f32 v101, v61, v63
    ds_write2_b64 v72, v[98:99], v[100:101] offset0:0 offset1:68
    v_pk_mul_f32 v[90:91], v[54:55], v[46:47]
    v_pk_mul_f32 v[94:95], v[54:55], v[42:43]
    v_pk_mul_f32 v[92:93], v[54:55], v[44:45]
    v_pk_mul_f32 v[96:97], v[54:55], v[40:41]
    v_pk_fma_f32 v[62:63], v[52:53], v[46:47], v[92:93]
    v_pk_fma_f32 v[58:59], v[52:53], v[42:43], v[96:97]
    v_pk_fma_f32 v[60:61], v[52:53], v[44:45], v[90:91] neg_lo:[0,0,1] neg_hi:[0,0,1]
    v_pk_fma_f32 v[56:57], v[52:53], v[40:41], v[94:95] neg_lo:[0,0,1] neg_hi:[0,0,1]
    v_cvt_pk_f16_f32 v76, v52, v54
    v_cvt_pk_f16_f32 v77, v53, v55
    v_cvt_pk_f16_f32 v78, v60, v62
    v_cvt_pk_f16_f32 v79, v61, v63
    ds_write2_b64 v72, v[76:77], v[78:79] offset0:136 offset1:204
    v_pk_mul_f32 v[90:91], v[58:59], v[46:47]
    v_pk_mul_f32 v[94:95], v[58:59], v[42:43]
    v_pk_mul_f32 v[92:93], v[58:59], v[44:45]
    v_pk_mul_f32 v[96:97], v[58:59], v[40:41]
    v_pk_fma_f32 v[62:63], v[56:57], v[46:47], v[92:93]
    v_pk_fma_f32 v[54:55], v[56:57], v[42:43], v[96:97]
    v_pk_fma_f32 v[60:61], v[56:57], v[44:45], v[90:91] neg_lo:[0,0,1] neg_hi:[0,0,1]
    v_pk_fma_f32 v[52:53], v[56:57], v[40:41], v[94:95] neg_lo:[0,0,1] neg_hi:[0,0,1]
    v_cvt_pk_f16_f32 v98, v56, v58
    v_cvt_pk_f16_f32 v99, v57, v59
    v_cvt_pk_f16_f32 v100, v60, v62
    v_cvt_pk_f16_f32 v101, v61, v63
    ds_write2_b64 v73, v[98:99], v[100:101] offset0:0 offset1:68
    v_pk_mul_f32 v[90:91], v[54:55], v[46:47]
    v_pk_mul_f32 v[94:95], v[54:55], v[42:43]
    v_pk_mul_f32 v[92:93], v[54:55], v[44:45]
    v_pk_mul_f32 v[96:97], v[54:55], v[40:41]
    v_pk_fma_f32 v[62:63], v[52:53], v[46:47], v[92:93]
    v_pk_fma_f32 v[58:59], v[52:53], v[42:43], v[96:97]
    v_pk_fma_f32 v[60:61], v[52:53], v[44:45], v[90:91] neg_lo:[0,0,1] neg_hi:[0,0,1]
    v_pk_fma_f32 v[56:57], v[52:53], v[40:41], v[94:95] neg_lo:[0,0,1] neg_hi:[0,0,1]
    v_cvt_pk_f16_f32 v76, v52, v54
    v_cvt_pk_f16_f32 v77, v53, v55
    v_cvt_pk_f16_f32 v78, v60, v62
    v_cvt_pk_f16_f32 v79, v61, v63
    ds_write2_b64 v73, v[76:77], v[78:79] offset0:136 offset1:204
    v_pk_mul_f32 v[90:91], v[58:59], v[46:47]
    v_pk_mul_f32 v[94:95], v[58:59], v[42:43]
    v_pk_mul_f32 v[92:93], v[58:59], v[44:45]
    v_pk_mul_f32 v[96:97], v[58:59], v[40:41]
    v_pk_fma_f32 v[62:63], v[56:57], v[46:47], v[92:93]
    v_pk_fma_f32 v[54:55], v[56:57], v[42:43], v[96:97]
    v_pk_fma_f32 v[60:61], v[56:57], v[44:45], v[90:91] neg_lo:[0,0,1] neg_hi:[0,0,1]
    v_pk_fma_f32 v[52:53], v[56:57], v[40:41], v[94:95] neg_lo:[0,0,1] neg_hi:[0,0,1]
    v_cvt_pk_f16_f32 v98, v56, v58
    v_cvt_pk_f16_f32 v99, v57, v59
    v_cvt_pk_f16_f32 v100, v60, v62
    v_cvt_pk_f16_f32 v101, v61, v63
    ds_write2_b64 v74, v[98:99], v[100:101] offset0:0 offset1:68
    v_pk_mul_f32 v[90:91], v[54:55], v[46:47]
    v_pk_mul_f32 v[94:95], v[54:55], v[42:43]
    v_pk_mul_f32 v[92:93], v[54:55], v[44:45]
    v_pk_mul_f32 v[96:97], v[54:55], v[40:41]
    v_pk_fma_f32 v[62:63], v[52:53], v[46:47], v[92:93]
    v_pk_fma_f32 v[58:59], v[52:53], v[42:43], v[96:97]
    v_pk_fma_f32 v[60:61], v[52:53], v[44:45], v[90:91] neg_lo:[0,0,1] neg_hi:[0,0,1]
    v_pk_fma_f32 v[56:57], v[52:53], v[40:41], v[94:95] neg_lo:[0,0,1] neg_hi:[0,0,1]
    v_cvt_pk_f16_f32 v76, v52, v54
    v_cvt_pk_f16_f32 v77, v53, v55
    v_cvt_pk_f16_f32 v78, v60, v62
    v_cvt_pk_f16_f32 v79, v61, v63
    ds_write2_b64 v74, v[76:77], v[78:79] offset0:136 offset1:204
    v_pk_mul_f32 v[90:91], v[58:59], v[46:47]
    v_pk_mul_f32 v[94:95], v[58:59], v[42:43]
    v_pk_mul_f32 v[92:93], v[58:59], v[44:45]
    v_pk_mul_f32 v[96:97], v[58:59], v[40:41]
    v_pk_fma_f32 v[62:63], v[56:57], v[46:47], v[92:93]
    v_pk_fma_f32 v[54:55], v[56:57], v[42:43], v[96:97]
    v_pk_fma_f32 v[60:61], v[56:57], v[44:45], v[90:91] neg_lo:[0,0,1] neg_hi:[0,0,1]
    v_pk_fma_f32 v[52:53], v[56:57], v[40:41], v[94:95] neg_lo:[0,0,1] neg_hi:[0,0,1]
    v_cvt_pk_f16_f32 v98, v56, v58
    v_cvt_pk_f16_f32 v99, v57, v59
    v_cvt_pk_f16_f32 v100, v60, v62
    v_cvt_pk_f16_f32 v101, v61, v63
    ds_write2_b64 v75, v[98:99], v[100:101] offset0:0 offset1:68
    v_pk_mul_f32 v[90:91], v[54:55], v[46:47]
    v_pk_mul_f32 v[92:93], v[54:55], v[44:45]
    v_pk_fma_f32 v[62:63], v[52:53], v[46:47], v[92:93]
    v_pk_fma_f32 v[60:61], v[52:53], v[44:45], v[90:91] neg_lo:[0,0,1] neg_hi:[0,0,1]
    v_cvt_pk_f16_f32 v76, v52, v54
    v_cvt_pk_f16_f32 v77, v53, v55
    v_cvt_pk_f16_f32 v78, v60, v62
    v_cvt_pk_f16_f32 v79, v61, v63
    ds_write2_b64 v75, v[76:77], v[78:79] offset0:136 offset1:204
    s_branch JOBJ_19
JOB_16:
    v_mul_f32 v91, 0x43000000, v68
    v_mul_f32 v90, 0x43000000, v20
    v_mul_f32 v95, 0x43000000, v69
    v_mul_f32 v94, 0x43000000, v21
    v_fract_f32 v91, v91
    v_fract_f32 v95, v95
    v_fmac_f32 v91, 0x43000000, v70
    v_fmac_f32 v95, 0x43000000, v71
    v_exp_f32 v90, v90
    v_cos_f32 v92, v91
    v_sin_f32 v91, v91
    v_exp_f32 v94, v94
    v_cos_f32 v96, v95
    v_sin_f32 v95, v95
    v_mul_f32 v44, v90, v92
    v_mul_f32 v46, v90, v91
    v_mul_f32 v45, v94, v96
    v_mul_f32 v47, v94, v95
    v_pk_mul_f32 v[32:33], v[32:33], s[16:17] op_sel_hi:[1,0]
    v_pk_mul_f32 v[34:35], v[34:35], s[16:17] op_sel_hi:[1,0]
    v_pk_mul_f32 v[90:91], v[46:47], v[46:47]
    v_pk_mul_f32 v[92:93], v[44:45], v[46:47]
    v_pk_fma_f32 v[48:49], v[44:45], v[44:45], v[90:91] neg_lo:[0,0,1] neg_hi:[0,0,1]
    v_pk_add_f32 v[50:51], v[92:93], v[92:93]
    v_mul_f32 v91, 2.0, v68
    v_mul_f32 v90, 2.0, v20
    v_mul_f32 v95, 2.0, v69
    v_mul_f32 v94, 2.0, v21
    v_fract_f32 v91, v91
    v_fract_f32 v95, v95
    v_fmac_f32 v91, 2.0, v70
    v_fmac_f32 v95, 2.0, v71
    v_exp_f32 v90, v90
    v_cos_f32 v92, v91
    v_sin_f32 v91, v91
    v_exp_f32 v94, v94
    v_cos_f32 v96, v95
    v_sin_f32 v95, v95
    v_mul_f32 v40, v90, v92
    v_mul_f32 v42, v90, v91
    v_mul_f32 v41, v94, v96
    v_mul_f32 v43, v94, v95
    v_pk_mul_f32 v[90:91], v[34:35], v[50:51]
    v_pk_mul_f32 v[92:93], v[34:35], v[48:49]
    v_pk_fma_f32 v[54:55], v[32:33], v[50:51], v[92:93]
    v_pk_fma_f32 v[52:53], v[32:33], v[48:49], v[90:91] neg_lo:[0,0,1] neg_hi:[0,0,1]
    v_pk_mul_f32 v[90:91], v[54:55], v[50:51]
    v_pk_mul_f32 v[92:93], v[54:55], v[48:49]
    v_pk_fma_f32 v[66:67], v[52:53], v[50:51], v[92:93]
    v_pk_fma_f32 v[64:65], v[52:53], v[48:49], v[90:91] neg_lo:[0,0,1] neg_hi:[0,0,1]
    v_pk_mul_f32 v[90:91], v[54:55], v[46:47]
    v_pk_mul_f32 v[94:95], v[54:55], v[42:43]
    v_pk_mul_f32 v[92:93], v[54:55], v[44:45]
    v_pk_mul_f32 v[96:97], v[54:55], v[40:41]
    v_pk_fma_f32 v[62:63], v[52:53], v[46:47], v[92:93]
    v_pk_fma_f32 v[58:59], v[52:53], v[42:43], v[96:97]
    v_pk_fma_f32 v[60:61], v[52:53], v[44:45], v[90:91] neg_lo:[0,0,1] neg_hi:[0,0,1]
    v_pk_fma_f32 v[56:57], v[52:53], v[40:41], v[94:95] neg_lo:[0,0,1] neg_hi:[0,0,1]
    v_cvt_pk_f16_f32 v98, v52, v54
    v_cvt_pk_f16_f32 v99, v53, v55
    v_cvt_pk_f16_f32 v100, v60, v62
    v_cvt_pk_f16_f32 v101, v61, v63
    ds_write2_b64 v72, v[98:99], v[100:101] offset0:0 offset1:68
    v_pk_mul_f32 v[90:91], v[58:59], v[46:47]
    v_pk_mul_f32 v[94:95], v[58:59], v[42:43]
    v_pk_mul_f32 v[92:93], v[58:59], v[44:45]
    v_pk_mul_f32 v[96:97], v[58:59], v[40:41]
    v_pk_fma_f32 v[62:63], v[56:57], v[46:47], v[92:93]
    v_pk_fma_f32 v[54:55], v[56:57], v[42:43], v[96:97]
    v_pk_fma_f32 v[60:61], v[56:57], v[44:45], v[90:91] neg_lo:[0,0,1] neg_hi:[0,0,1]
    v_pk_fma_f32 v[52:53], v[56:57], v[40:41], v[94:95] neg_lo:[0,0,1] neg_hi:[0,0,1]
    v_cvt_pk_f16_f32 v76, v56, v58
    v_cvt_pk_f16_f32 v77, v57, v59
    v_cvt_pk_f16_f32 v78, v60, v62
    v_cvt_pk_f16_f32 v79, v61, v63
    ds_write2_b64 v72, v[76:77], v[78:79] offset0:136 offset1:204
    v_pk_mul_f32 v[90:91], v[54:55], v[46:47]
    v_pk_mul_f32 v[94:95], v[54:55], v[42:43]
    v_pk_mul_f32 v[92:93], v[54:55], v[44:45]
    v_pk_mul_f32 v[96:97], v[54:55], v[40:41]
    v_pk_fma_f32 v[62:63], v[52:53], v[46:47], v[92:93]
    v_pk_fma_f32 v[58:59], v[52:53], v[42:43], v[96:97]
    v_pk_fma_f32 v[60:61], v[52:53], v[44:45], v[90:91] neg_lo:[0,0,1] neg_hi:[0,0,1]
    v_pk_fma_f32 v[56:57], v[52:53], v[40:41], v[94:95] neg_lo:[0,0,1] neg_hi:[0,0,1]
    v_cvt_pk_f16_f32 v98, v52, v54
    v_cvt_pk_f16_f32 v99, v53, v55
    v_cvt_pk_f16_f32 v100, v60, v62
    v_cvt_pk_f16_f32 v101, v61, v63
    ds_write2_b64 v73, v[98:99], v[100:101] offset0:0 offset1:68
    v_pk_mul_f32 v[90:91], v[58:59], v[46:47]
    v_pk_mul_f32 v[94:95], v[42:43], v[42:43]
    v_pk_mul_f32 v[92:93], v[58:59], v[44:45]
    v_pk_mul_f32 v[96:97], v[40:41], v[42:43]
    v_pk_fma_f32 v[62:63], v[56:57], v[46:47], v[92:93]
    v_pk_fma_f32 v[48:49], v[40:41], v[40:41], v[94:95] neg_lo:[0,0,1] neg_hi:[0,0,1]
    v_pk_fma_f32 v[60:61], v[56:57], v[44:45], v[90:91] neg_lo:[0,0,1] neg_hi:[0,0,1]
    v_pk_add_f32 v[50:51], v[96:97], v[96:97]
    v_cvt_pk_f16_f32 v76, v56, v58
    v_cvt_pk_f16_f32 v77, v57, v59
    v_cvt_pk_f16_f32 v78, v60, v62
    v_cvt_pk_f16_f32 v79, v61, v63
    ds_write2_b64 v73, v[76:77], v[78:79] offset0:136 offset1:204
    v_pk_mul_f32 v[90:91], v[66:67], v[50:51]
    v_pk_mul_f32 v[94:95], v[66:67], v[46:47]
    v_pk_mul_f32 v[92:93], v[66:67], v[48:49]
    v_pk_mul_f32 v[96:97], v[66:67], v[44:45]
    v_pk_fma_f32 v[62:63], v[64:65], v[50:51], v[92:93]
    v_pk_fma_f32 v[54:55], v[64:65], v[46:47], v[96:97]
    v_pk_fma_f32 v[60:61], v[64:65], v[48:49], v[90:91] neg_lo:[0,0,1] neg_hi:[0,0,1]
    v_pk_fma_f32 v[52:53], v[64:65], v[44:45], v[94:95] neg_lo:[0,0,1] neg_hi:[0,0,1]
    v_cvt_pk_f16_f32 v98, v64, v66
    v_cvt_pk_f16_f32 v99, v65, v67
    v_cvt_pk_f16_f32 v100, v60, v62
    v_cvt_pk_f16_f32 v101, v61, v63
    ds_write2_b64 v74, v[98:99], v[100:101] offset0:0 offset1:68
    v_pk_mul_f32 v[90:91], v[54:55], v[50:51]
    v_pk_mul_f32 v[94:95], v[54:55], v[46:47]
    v_pk_mul_f32 v[92:93], v[54:55], v[48:49]
    v_pk_mul_f32 v[96:97], v[54:55], v[44:45]
    v_pk_fma_f32 v[62:63], v[52:53], v[50:51], v[92:93]
    v_pk_fma_f32 v[58:59], v[52:53], v[46:47], v[96:97]
    v_pk_fma_f32 v[60:61], v[52:53], v[48:49], v[90:91] neg_lo:[0,0,1] neg_hi:[0,0,1]
    v_pk_fma_f32 v[56:57], v[52:53], v[44:45], v[94:95] neg_lo:[0,0,1] neg_hi:[0,0,1]
    v_cvt_pk_f16_f32 v76, v52, v54
    v_cvt_pk_f16_f32 v77, v53, v55
    v_cvt_pk_f16_f32 v78, v60, v62
    v_cvt_pk_f16_f32 v79, v61, v63
    ds_write2_b64 v74, v[76:77], v[78:79] offset0:136 offset1:204
    v_pk_mul_f32 v[90:91], v[58:59], v[50:51]
    v_pk_mul_f32 v[94:95], v[58:59], v[46:47]
    v_pk_mul_f32 v[92:93], v[58:59], v[48:49]
    v_pk_mul_f32 v[96:97], v[58:59], v[44:45]
    v_pk_fma_f32 v[62:63], v[56:57], v[50:51], v[92:93]
    v_pk_fma_f32 v[54:55], v[56:57], v[46:47], v[96:97]
    v_pk_fma_f32 v[60:61], v[56:57], v[48:49], v[90:91] neg_lo:[0,0,1] neg_hi:[0,0,1]
    v_pk_fma_f32 v[52:53], v[56:57], v[44:45], v[94:95] neg_lo:[0,0,1] neg_hi:[0,0,1]
    v_cvt_pk_f16_f32 v98, v56, v58
    v_cvt_pk_f16_f32 v99, v57, v59
    v_cvt_pk_f16_f32 v100, v60, v62
    v_cvt_pk_f16_f32 v101, v61, v63
    ds_write2_b64 v75, v[98:99], v[100:101] offset0:0 offset1:68
    v_pk_mul_f32 v[90:91], v[54:55], v[50:51]
    v_pk_mul_f32 v[92:93], v[54:55], v[48:49]
    v_pk_fma_f32 v[62:63], v[52:53], v[50:51], v[92:93]
    v_pk_fma_f32 v[60:61], v[52:53], v[48:49], v[90:91] neg_lo:[0,0,1] neg_hi:[0,0,1]
    v_cvt_pk_f16_f32 v76, v52, v54
    v_cvt_pk_f16_f32 v77, v53, v55
    v_cvt_pk_f16_f32 v78, v60, v62
    v_cvt_pk_f16_f32 v79, v61, v63
    ds_write2_b64 v75, v[76:77], v[78:79] offset0:136 offset1:204
    s_branch JOBJ_19
JOB_18:
    v_mul_f32 v91, 0x41000000, v68
    v_mul_f32 v90, 0x41000000, v20
    v_mul_f32 v95, 0x41000000, v69
    v_mul_f32 v94, 0x41000000, v21
    v_fract_f32 v91, v91
    v_fract_f32 v95, v95
    v_fmac_f32 v91, 0x41000000, v70
    v_fmac_f32 v95, 0x41000000, v71
    v_exp_f32 v90, v90
    v_cos_f32 v92, v91
    v_sin_f32 v91, v91
    v_exp_f32 v94, v94
    v_cos_f32 v96, v95
    v_sin_f32 v95, v95
    v_mul_f32 v40, v90, v92
    v_mul_f32 v42, v90, -v91
    v_mul_f32 v41, v94, v96
    v_mul_f32 v43, v94, -v95
    v_mov_b32 v52, 0x47000000
    v_mov_b32 v53, 0x47000000
    v_mov_b32 v54, 0
    v_mov_b32 v55, 0
    v_pk_mul_f32 v[90:91], v[42:43], v[42:43]
    v_pk_mul_f32 v[60:61], v[40:41], v[52:53]
    v_pk_mul_f32 v[92:93], v[40:41], v[42:43]
    v_pk_mul_f32 v[62:63], v[42:43], v[52:53]
    v_pk_fma_f32 v[44:45], v[40:41], v[40:41], v[90:91] neg_lo:[0,0,1] neg_hi:[0,0,1]
    v_pk_add_f32 v[46:47], v[92:93], v[92:93]
    v_pk_mul_f32 v[56:57], v[44:45], v[52:53]
    v_pk_mul_f32 v[94:95], v[62:63], v[46:47]
    v_pk_mul_f32 v[58:59], v[46:47], v[52:53]
    v_pk_mul_f32 v[96:97], v[62:63], v[44:45]
    v_pk_fma_f32 v[66:67], v[60:61], v[46:47], v[96:97]
    v_pk_fma_f32 v[64:65], v[60:61], v[44:45], v[94:95] neg_lo:[0,0,1] neg_hi:[0,0,1]
    v_cvt_pk_f16_f32 v98, v52, v54
    v_cvt_pk_f16_f32 v99, v53, v55
    v_cvt_pk_f16_f32 v100, v60, v62
    v_cvt_pk_f16_f32 v101, v61, v63
    ds_write2_b64 v72, v[98:99], v[100:101] offset0:0 offset1:68
    v_pk_mul_f32 v[90:91], v[58:59], v[46:47]
    v_pk_mul_f32 v[94:95], v[66:67], v[46:47]
    v_pk_mul_f32 v[92:93], v[58:59], v[44:45]
    v_pk_mul_f32 v[96:97], v[66:67], v[44:45]
    v_pk_fma_f32 v[54:55], v[56:57], v[46:47], v[92:93]
    v_pk_fma_f32 v[62:63], v[64:65], v[46:47], v[96:97]
    v_pk_fma_f32 v[52:53], v[56:57], v[44:45], v[90:91] neg_lo:[0,0,1] neg_hi:[0,0,1]
    v_pk_fma_f32 v[60:61], v[64:65], v[44:45], v[94:95] neg_lo:[0,0,1] neg_hi:[0,0,1]
    v_cvt_pk_f16_f32 v76, v56, v58
    v_cvt_pk_f16_f32 v77, v57, v59
    v_cvt_pk_f16_f32 v78, v64, v66
    v_cvt_pk_f16_f32 v79, v65, v67
    ds_write2_b64 v72, v[76:77], v[78:79] offset0:136 offset1:204
    v_pk_mul_f32 v[90:91], v[54:55], v[46:47]
    v_pk_mul_f32 v[94:95], v[62:63], v[46:47]
    v_pk_mul_f32 v[92:93], v[54:55], v[44:45]
    v_pk_mul_f32 v[96:97], v[62:63], v[44:45]
    v_pk_fma_f32 v[58:59], v[52:53], v[46:47], v[92:93]
    v_pk_fma_f32 v[66:67], v[60:61], v[46:47], v[96:97]
    v_pk_fma_f32 v[56:57], v[52:53], v[44:45], v[90:91] neg_lo:[0,0,1] neg_hi:[0,0,1]
    v_pk_fma_f32 v[64:65], v[60:61], v[44:45], v[94:95] neg_lo:[0,0,1] neg_hi:[0,0,1]
    v_cvt_pk_f16_f32 v98, v52, v54
    v_cvt_pk_f16_f32 v99, v53, v55
    v_cvt_pk_f16_f32 v100, v60, v62
    v_cvt_pk_f16_f32 v101, v61, v63
    ds_write2_b64 v73, v[98:99], v[100:101] offset0:0 offset1:68
    v_pk_mul_f32 v[90:91], v[58:59], v[46:47]
    v_pk_mul_f32 v[94:95], v[66:67], v[46:47]
    v_pk_mul_f32 v[92:93], v[58:59], v[44:45]
    v_pk_mul_f32 v[96:97], v[66:67], v[44:45]
    v_pk_fma_f32 v[54:55], v[56:57], v[46:47], v[92:93]
    v_pk_fma_f32 v[62:63], v[64:65], v[46:47], v[96:97]
    v_pk_fma_f32 v[52:53], v[56:57], v[44:45], v[90:91] neg_lo:[0,0,1] neg_hi:[0,0,1]
    v_pk_fma_f32 v[60:61], v[64:65], v[44:45], v[94:95] neg_lo:[0,0,1] neg_hi:[0,0,1]
    v_cvt_pk_f16_f32 v76, v56, v58
    v_cvt_pk_f16_f32 v77, v57, v59
    v_cvt_pk_f16_f32 v78, v64, v66
    v_cvt_pk_f16_f32 v79, v65, v67
    ds_write2_b64 v73, v[76:77], v[78:79] offset0:136 offset1:204
    v_pk_mul_f32 v[90:91], v[54:55], v[46:47]
    v_pk_mul_f32 v[94:95], v[62:63], v[46:47]
    v_pk_mul_f32 v[92:93], v[54:55], v[44:45]
    v_pk_mul_f32 v[96:97], v[62:63], v[44:45]
    v_pk_fma_f32 v[58:59], v[52:53], v[46:47], v[92:93]
    v_pk_fma_f32 v[66:67], v[60:61], v[46:47], v[96:97]
    v_pk_fma_f32 v[56:57], v[52:53], v[44:45], v[90:91] neg_lo:[0,0,1] neg_hi:[0,0,1]
    v_pk_fma_f32 v[64:65], v[60:61], v[44:45], v[94:95] neg_lo:[0,0,1] neg_hi:[0,0,1]
    v_cvt_pk_f16_f32 v98, v52, v54
    v_cvt_pk_f16_f32 v99, v53, v55
    v_cvt_pk_f16_f32 v100, v60, v62
    v_cvt_pk_f16_f32 v101, v61, v63
    ds_write2_b64 v74, v[98:99], v[100:101] offset0:0 offset1:68
    v_pk_mul_f32 v[90:91], v[58:59], v[46:47]
    v_pk_mul_f32 v[94:95], v[66:67], v[46:47]
    v_pk_mul_f32 v[92:93], v[58:59], v[44:45]
    v_pk_mul_f32 v[96:97], v[66:67], v[44:45]
    v_pk_fma_f32 v[54:55], v[56:57], v[46:47], v[92:93]
    v_pk_fma_f32 v[62:63], v[64:65], v[46:47], v[96:97]
    v_pk_fma_f32 v[52:53], v[56:57], v[44:45], v[90:91] neg_lo:[0,0,1] neg_hi:[0,0,1]
    v_pk_fma_f32 v[60:61], v[64:65], v[44:45], v[94:95] neg_lo:[0,0,1] neg_hi:[0,0,1]
    v_cvt_pk_f16_f32 v76, v56, v58
    v_cvt_pk_f16_f32 v77, v57, v59
    v_cvt_pk_f16_f32 v78, v64, v66
    v_cvt_pk_f16_f32 v79, v65, v67
    ds_write2_b64 v74, v[76:77], v[78:79] offset0:136 offset1:204
    v_pk_mul_f32 v[90:91], v[54:55], v[46:47]
    v_pk_mul_f32 v[94:95], v[62:63], v[46:47]
    v_pk_mul_f32 v[92:93], v[54:55], v[44:45]
    v_pk_mul_f32 v[96:97], v[62:63], v[44:45]
    v_pk_fma_f32 v[58:59], v[52:53], v[46:47], v[92:93]
    v_pk_fma_f32 v[66:67], v[60:61], v[46:47], v[96:97]
    v_pk_fma_f32 v[56:57], v[52:53], v[44:45], v[90:91] neg_lo:[0,0,1] neg_hi:[0,0,1]
    v_pk_fma_f32 v[64:65], v[60:61], v[44:45], v[94:95] neg_lo:[0,0,1] neg_hi:[0,0,1]
    v_cvt_pk_f16_f32 v98, v52, v54
    v_cvt_pk_f16_f32 v99, v53, v55
    v_cvt_pk_f16_f32 v100, v60, v62
    v_cvt_pk_f16_f32 v101, v61, v63
    ds_write2_b64 v75, v[98:99], v[100:101] offset0:0 offset1:68
    v_cvt_pk_f16_f32 v76, v56, v58
    v_cvt_pk_f16_f32 v77, v57, v59
    v_cvt_pk_f16_f32 v78, v64, v66
    v_cvt_pk_f16_f32 v79, v65, v67
    ds_write2_b64 v75, v[76:77], v[78:79] offset0:136 offset1:204
    ds_write_b8 v15, v5 offset:64
    s_cmp_eq_u32 s87, 2
    s_cbranch_scc1 KS_G0
    s_branch EXP_13
KC_SEND:
W_20:
    ds_read_b32 v104, v105 offset:224
    s_sub_u32 s39, s39, 1
    s_cbranch_scc1 KS_ABORT
    s_waitcnt lgkmcnt(0)
    v_cmp_eq_u32 vcc, 0, v104
    s_cbranch_vccnz W_20
    s_lshl_b32 s92, s88, 12
    s_lshl_b32 s93, s86, 10
    s_add_u32 s92, s92, s93
    s_add_u32 s92, s92, 0x920000
    v_add_u32 v24, s92, v12
    s_mov_b32 s93, 0xffff
    v_lshlrev_b32 v25, 16, v104
    v_cvt_f16_f32 v20, v20
    v_cvt_f16_f32 v21, v21
    v_cvt_f16_f32 v22, v22
    v_cvt_f16_f32 v23, v23
    s_cmp_lg_u32 s86, 2
    s_cbranch_scc1 KC_S2
    s_mov_b32 exec_lo, 0
    s_mov_b32 exec_hi, 0xffff0000
    v_mov_b32 v20, v106
    v_lshrrev_b32 v21, 16, v106
    s_mov_b64 exec, -1
KC_S2:
    v_bfi_b32 v20, s93, v20, v104
    v_bfi_b32 v21, s93, v21, v25
    v_bfi_b32 v22, s93, v22, v104
    v_bfi_b32 v23, s93, v23, v25
    global_store_dwordx4 v24, v[20:23], s[36:37] sc1
    s_branch KS_G0
KC_RECV:
    s_cmp_eq_u32 s86, 3
    s_cbranch_scc1 EXP_13
    s_lshl_b32 s92, s88, 12
    s_lshl_b32 s93, s86, 10
    s_add_u32 s92, s92, s93
    s_add_u32 s92, s92, 0x920000
    v_add_u32 v24, s92, v12
W_21:
    s_sleep 2
    ds_read_b32 v104, v105 offset:224
    s_sub_u32 s39, s39, 1
    s_cbranch_scc1 KS_ABORT
    s_waitcnt lgkmcnt(0)
    v_cmp_eq_u32 vcc, 0, v104
    s_cbranch_vccnz W_21
    v_lshlrev_b32 v25, 16, v104
W_22:
    s_sleep 2
    ds_read_b32 v17, v4 offset:68
    s_sub_u32 s39, s39, 1
    s_cbranch_scc1 KS_ABORT
    s_waitcnt lgkmcnt(0)
    v_cmp_ne_u32 vcc, s84, v17
    s_cbranch_vccnz W_22
    s_branch KPE_24
KP_23:
    s_sleep 2
KPE_24:
    global_load_dwordx4 v[20:23], v24, s[36:37] sc1
    s_sub_u32 s39, s39, 1
    s_cbranch_scc1 KS_ABORT
    s_waitcnt vmcnt(0)
    v_xor_b32 v20, v104, v20
    v_xor_b32 v21, v25, v21
    v_xor_b32 v22, v104, v22
    v_xor_b32 v23, v25, v23
    v_or3_b32 v26, v20, v21, v22
    v_or_b32 v26, v26, v23
    v_cmp_lt_u32 vcc, 0xffff, v26
    s_cbranch_vccnz KP_23
    v_xor_b32 v20, v104, v20
    v_xor_b32 v22, v104, v22
    ds_write_b16 v108, v20
    ds_write_b16 v109, v21
    ds_write_b16 v112, v22
    ds_write_b16 v113, v23
    s_cmp_lg_u32 s86, 2
    s_cbranch_scc1 EXP_13
    v_and_b32 v20, 0xffff, v20
    v_lshl_or_b32 v20, v21, 16, v20
    v_lshlrev_b32 v21, 16, v107
    s_mov_b32 exec_lo, 0
    s_mov_b32 exec_hi, 0x10000
    ds_write_b64 v14, v[20:21] offset:832
    s_mov_b64 exec, -1
    s_branch EXP_13
JOB_17:
    v_mul_f32 v91, 0x43000000, v68
    v_mul_f32 v90, 0x43000000, v20
    v_mul_f32 v95, 0x43000000, v69
    v_mul_f32 v94, 0x43000000, v21
    v_fract_f32 v91, v91
    v_fract_f32 v95, v95
    v_fmac_f32 v91, 0x43000000, v70
    v_fmac_f32 v95, 0x43000000, v71
    v_exp_f32 v90, v90
    v_cos_f32 v92, v91
    v_sin_f32 v91, v91
    v_exp_f32 v94, v94
    v_cos_f32 v96, v95
    v_sin_f32 v95, v95
    v_mul_f32 v44, v90, v92
    v_mul_f32 v46, v90, v91
    v_mul_f32 v45, v94, v96
    v_mul_f32 v47, v94, v95
    v_pk_mul_f32 v[32:33], v[32:33], s[16:17] op_sel_hi:[1,0]
    v_pk_mul_f32 v[34:35], v[34:35], s[16:17] op_sel_hi:[1,0]
    v_pk_mul_f32 v[90:91], v[46:47], v[46:47]
    v_pk_mul_f32 v[94:95], v[34:35], v[46:47]
    v_pk_mul_f32 v[92:93], v[44:45], v[46:47]
    v_pk_mul_f32 v[96:97], v[34:35], v[44:45]
    v_pk_fma_f32 v[40:41], v[44:45], v[44:45], v[90:91] neg_lo:[0,0,1] neg_hi:[0,0,1]
    v_pk_fma_f32 v[66:67], v[32:33], v[46:47], v[96:97]
    v_pk_add_f32 v[42:43], v[92:93], v[92:93]
    v_pk_fma_f32 v[64:65], v[32:33], v[44:45], v[94:95] neg_lo:[0,0,1] neg_hi:[0,0,1]
    v_pk_mul_f32 v[90:91], v[42:43], v[42:43]
    v_pk_mul_f32 v[92:93], v[40:41], v[42:43]
    v_pk_fma_f32 v[48:49], v[40:41], v[40:41], v[90:91] neg_lo:[0,0,1] neg_hi:[0,0,1]
    v_pk_add_f32 v[50:51], v[92:93], v[92:93]
    v_pk_mul_f32 v[90:91], v[50:51], v[50:51]
    v_pk_mul_f32 v[92:93], v[48:49], v[50:51]
    v_pk_fma_f32 v[48:49], v[48:49], v[48:49], v[90:91] neg_lo:[0,0,1] neg_hi:[0,0,1]
    v_pk_add_f32 v[50:51], v[92:93], v[92:93]
    v_pk_mul_f32 v[90:91], v[34:35], v[50:51]
    v_pk_mul_f32 v[94:95], v[66:67], v[50:51]
    v_pk_mul_f32 v[92:93], v[34:35], v[48:49]
    v_pk_mul_f32 v[96:97], v[66:67], v[48:49]
    v_pk_fma_f32 v[54:55], v[32:33], v[50:51], v[92:93]
    v_pk_fma_f32 v[62:63], v[64:65], v[50:51], v[96:97]
    v_pk_fma_f32 v[52:53], v[32:33], v[48:49], v[90:91] neg_lo:[0,0,1] neg_hi:[0,0,1]
    v_pk_fma_f32 v[60:61], v[64:65], v[48:49], v[94:95] neg_lo:[0,0,1] neg_hi:[0,0,1]
    v_pk_mul_f32 v[90:91], v[54:55], v[42:43]
    v_pk_mul_f32 v[94:95], v[62:63], v[42:43]
    v_pk_mul_f32 v[92:93], v[54:55], v[40:41]
    v_pk_mul_f32 v[96:97], v[62:63], v[40:41]
    v_pk_fma_f32 v[58:59], v[52:53], v[42:43], v[92:93]
    v_pk_fma_f32 v[66:67], v[60:61], v[42:43], v[96:97]
    v_pk_fma_f32 v[56:57], v[52:53], v[40:41], v[90:91] neg_lo:[0,0,1] neg_hi:[0,0,1]
    v_pk_fma_f32 v[64:65], v[60:61], v[40:41], v[94:95] neg_lo:[0,0,1] neg_hi:[0,0,1]
    v_cvt_pk_f16_f32 v98, v52, v54
    v_cvt_pk_f16_f32 v99, v53, v55
    v_cvt_pk_f16_f32 v100, v60, v62
    v_cvt_pk_f16_f32 v101, v61, v63
    ds_write2_b64 v72, v[98:99], v[100:101] offset0:0 offset1:68
    v_pk_mul_f32 v[90:91], v[58:59], v[42:43]
    v_pk_mul_f32 v[94:95], v[66:67], v[42:43]
    v_pk_mul_f32 v[92:93], v[58:59], v[40:41]
    v_pk_mul_f32 v[96:97], v[66:67], v[40:41]
    v_pk_fma_f32 v[54:55], v[56:57], v[42:43], v[92:93]
    v_pk_fma_f32 v[62:63], v[64:65], v[42:43], v[96:97]
    v_pk_fma_f32 v[52:53], v[56:57], v[40:41], v[90:91] neg_lo:[0,0,1] neg_hi:[0,0,1]
    v_pk_fma_f32 v[60:61], v[64:65], v[40:41], v[94:95] neg_lo:[0,0,1] neg_hi:[0,0,1]
    v_cvt_pk_f16_f32 v76, v56, v58
    v_cvt_pk_f16_f32 v77, v57, v59
    v_cvt_pk_f16_f32 v78, v64, v66
    v_cvt_pk_f16_f32 v79, v65, v67
    ds_write2_b64 v72, v[76:77], v[78:79] offset0:136 offset1:204
    v_pk_mul_f32 v[90:91], v[54:55], v[42:43]
    v_pk_mul_f32 v[94:95], v[62:63], v[42:43]
    v_pk_mul_f32 v[92:93], v[54:55], v[40:41]
    v_pk_mul_f32 v[96:97], v[62:63], v[40:41]
    v_pk_fma_f32 v[58:59], v[52:53], v[42:43], v[92:93]
    v_pk_fma_f32 v[66:67], v[60:61], v[42:43], v[96:97]
    v_pk_fma_f32 v[56:57], v[52:53], v[40:41], v[90:91] neg_lo:[0,0,1] neg_hi:[0,0,1]
    v_pk_fma_f32 v[64:65], v[60:61], v[40:41], v[94:95] neg_lo:[0,0,1] neg_hi:[0,0,1]
    v_cvt_pk_f16_f32 v98, v52, v54
    v_cvt_pk_f16_f32 v99, v53, v55
    v_cvt_pk_f16_f32 v100, v60, v62
    v_cvt_pk_f16_f32 v101, v61, v63
    ds_write2_b64 v73, v[98:99], v[100:101] offset0:0 offset1:68
    v_pk_mul_f32 v[90:91], v[58:59], v[42:43]
    v_pk_mul_f32 v[92:93], v[58:59], v[40:41]
    v_pk_fma_f32 v[54:55], v[56:57], v[42:43], v[92:93]
    v_pk_fma_f32 v[52:53], v[56:57], v[40:41], v[90:91] neg_lo:[0,0,1] neg_hi:[0,0,1]
    v_cvt_pk_f16_f32 v76, v56, v58
    v_cvt_pk_f16_f32 v77, v57, v59
    v_cvt_pk_f16_f32 v78, v64, v66
    v_cvt_pk_f16_f32 v79, v65, v67
    ds_write2_b64 v73, v[76:77], v[78:79] offset0:136 offset1:204
    v_cvt_pk_f16_f32 v98, v52, v54
    v_cvt_pk_f16_f32 v99, v53, v55
    v_mov_b32 v36, 0x4538aa3b
    v_mul_f32 v24, s14, v36
    v_max_f32 v24, 0, v24
    v_exp_f32 v24, v24
    ds_write_b64 v74, v[98:99] offset:0
    s_sub_u32 s11, s15, 7
    s_lshl_b32 s11, s11, 23
    v_lshlrev_b32 v25, 16, v107
    v_mul_f32 v24, s11, v24
    v_mov_b32 v106, v24
    ds_write_b64 v14, v[24:25] offset:832
JOBJ_19:
    ds_write_b8 v15, v5 offset:64
    ds_read_b128 v[40:43], v127 offset:0
    ds_read_b128 v[44:47], v127 offset:64
    ds_read_b128 v[48:51], v127 offset:128
    ds_read_b128 v[52:55], v127 offset:192
    ds_read_b128 v[56:59], v127 offset:256
    ds_read_b128 v[60:63], v127 offset:320
    ds_read_b128 v[64:67], v127 offset:384
    ds_read_b128 v[68:71], v127 offset:448
    v_mov_b32 v36, 0x3fb8aa3b
    v_mul_f32 v36, s14, v36
    v_mul_f32 v37, 0x45000000, v36
    v_max_f32 v37, 0, v37
    v_add_f32 v37, 0x41b80000, v37
    v_fma_f32 v110, v110, v36, -v37
    v_fma_f32 v111, v111, v36, -v37
    v_fma_f32 v114, v114, v36, -v37
    v_fma_f32 v115, v115, v36, -v37
    v_exp_f32 v110, v110
    v_exp_f32 v111, v111
    v_exp_f32 v114, v114
    v_exp_f32 v115, v115
W_25:
    ds_read_u8 v17, v14 offset:67
    s_sub_u32 s39, s39, 1
    s_cbranch_scc1 KS_ABORT
    s_waitcnt lgkmcnt(0)
    v_cmp_eq_u32 vcc, 0, v17
    s_cbranch_vccnz W_25
    ds_read_b128 v[72:75], v126 offset:22304
    ds_read_b128 v[76:79], v126 offset:22368
    ds_read_b128 v[80:83], v126 offset:22432
    ds_read_b128 v[84:87], v126 offset:22496
    ds_read_b128 v[88:91], v126 offset:22560
    ds_read_b128 v[92:95], v126 offset:22624
    ds_read_b128 v[96:99], v126 offset:22688
    ds_read_b128 v[100:103], v126 offset:22752
    s_waitcnt lgkmcnt(7)
    v_mfma_f32_16x16x32_f16 v[20:23], v[40:43], v[72:75], 0
    s_waitcnt lgkmcnt(6)
    v_mfma_f32_16x16x32_f16 v[24:27], v[44:47], v[76:79], 0
    s_waitcnt lgkmcnt(5)
    v_mfma_f32_16x16x32_f16 v[20:23], v[48:51], v[80:83], v[20:23]
    s_waitcnt lgkmcnt(4)
    v_mfma_f32_16x16x32_f16 v[24:27], v[52:55], v[84:87], v[24:27]
    s_waitcnt lgkmcnt(3)
    v_mfma_f32_16x16x32_f16 v[20:23], v[56:59], v[88:91], v[20:23]
    s_waitcnt lgkmcnt(2)
    v_mfma_f32_16x16x32_f16 v[24:27], v[60:63], v[92:95], v[24:27]
    s_waitcnt lgkmcnt(1)
    v_mfma_f32_16x16x32_f16 v[20:23], v[64:67], v[96:99], v[20:23]
    s_waitcnt lgkmcnt(0)
    v_mfma_f32_16x16x32_f16 v[24:27], v[68:71], v[100:103], v[24:27]
    s_nop 7
    v_add_f32 v20, v20, v24
    v_add_f32 v21, v21, v25
    v_add_f32 v22, v22, v26
    v_add_f32 v23, v23, v27
    v_mul_f32 v20, v20, v110
    v_mul_f32 v21, v21, v111
    v_mul_f32 v22, v22, v114
    v_mul_f32 v23, v23, v115
    s_cmp_eq_u32 s87, 2
    s_cbranch_scc1 KC_SEND
    v_cvt_f16_f32 v20, v20
    ds_write_b16 v108, v20
    v_cvt_f16_f32 v21, v21
    ds_write_b16 v109, v21
    v_cvt_f16_f32 v22, v22
    ds_write_b16 v112, v22
    v_cvt_f16_f32 v23, v23
    ds_write_b16 v113, v23
EXP_13:
    ds_write_b8 v15, v5 offset:68
    v_mov_b32 v28, 0
    v_mov_b32 v29, 0
    v_mov_b32 v30, 0
    v_mov_b32 v31, 0
    v_mov_b32 v32, s85
    s_waitcnt vmcnt(0)
W_26:
    ds_read_b32 v20, v14 offset:68
    s_sub_u32 s39, s39, 1
    s_cbranch_scc1 KS_ABORT
    s_waitcnt lgkmcnt(0)
    v_cmp_ne_u32 vcc, s84, v20
    s_cbranch_vccnz W_26
    ds_read_u16 v20, v116
    ds_read_u16 v21, v117
    ds_read_u16 v22, v118
    ds_read_u16 v23, v120
    ds_read_u16 v24, v121
    ds_read_u16 v25, v122
    ds_read_u16 v26, v123
    s_mov_b64 exec, 1
    ds_write_b128 v32, v[28:31] offset:3088
    ds_write_b128 v32, v[28:31] offset:8224
    ds_write_b128 v32, v[28:31] offset:3072
    s_mov_b64 exec, -1
    s_waitcnt lgkmcnt(7)
    v_lshl_or_b32 v28, v21, 16, v20
    v_lshl_or_b32 v29, v22, 16, v21
    ds_write_b32 v124, v28 offset:32528
    ds_write_b32 v124, v29 offset:33872
    s_waitcnt lgkmcnt(5)
    v_lshl_or_b32 v30, v24, 16, v23
    v_lshl_or_b32 v31, v26, 16, v25
    ds_write_b32 v119, v30
    ds_write_b32 v125, v31
    ds_write_b8 v15, v5 offset:72
W_27:
    ds_read_b32 v20, v14 offset:72
    s_sub_u32 s39, s39, 1
    s_cbranch_scc1 KS_ABORT
    s_waitcnt lgkmcnt(0)
    v_cmp_ne_u32 vcc, s84, v20
    s_cbranch_vccnz W_27
    ds_read_b64 v[16:17], v14 offset:832
    s_cmp_eq_u32 s86, 1
    s_cbranch_scc1 CV_29
    s_cmp_eq_u32 s86, 2
    s_cbranch_scc1 CV_30
    s_cmp_eq_u32 s86, 3
    s_cbranch_scc1 CV_31
    ds_read2_b32 v[32:33], v6 offset0:144 offset1:145
    ds_read2_b32 v[34:35], v6 offset0:146 offset1:147
    ds_read2_b32 v[36:37], v6 offset0:16 offset1:17
    ds_read2_b32 v[38:39], v6 offset0:18 offset1:19
    ds_read2_b32 v[40:41], v6 offset0:160 offset1:161
    ds_read2_b32 v[42:43], v6 offset0:162 offset1:163
    ds_read2_b32 v[44:45], v6 offset0:32 offset1:33
    ds_read2_b32 v[46:47], v6 offset0:34 offset1:35
    ds_read2_b32 v[48:49], v6 offset0:176 offset1:177
    ds_read2_b32 v[50:51], v6 offset0:178 offset1:179
    ds_read2_b32 v[52:53], v6 offset0:48 offset1:49
    ds_read2_b32 v[54:55], v6 offset0:50 offset1:51
    ds_read2_b32 v[56:57], v6 offset0:192 offset1:193
    ds_read2_b32 v[58:59], v6 offset0:194 offset1:195
    ds_read2_b32 v[60:61], v6 offset0:64 offset1:65
    ds_read2_b32 v[62:63], v6 offset0:66 offset1:67
    ds_read2_b32 v[64:65], v6 offset0:208 offset1:209
    ds_read2_b32 v[66:67], v6 offset0:210 offset1:211
    ds_read2_b32 v[68:69], v6 offset0:80 offset1:81
    ds_read2_b32 v[70:71], v6 offset0:82 offset1:83
    ds_read2_b32 v[72:73], v6 offset0:224 offset1:225
    ds_read2_b32 v[74:75], v6 offset0:226 offset1:227
    ds_read2_b32 v[76:77], v6 offset0:96 offset1:97
    ds_read2_b32 v[78:79], v6 offset0:98 offset1:99
    ds_read2_b32 v[80:81], v6 offset0:240 offset1:241
    ds_read2_b32 v[82:83], v6 offset0:242 offset1:243
    ds_read2_b32 v[84:85], v6 offset0:112 offset1:113
    ds_read2_b32 v[86:87], v6 offset0:114 offset1:115
    ds_read2_b32 v[88:89], v7 offset0:96 offset1:97
    ds_read2_b32 v[90:91], v7 offset0:98 offset1:99
    ds_read2_b32 v[92:93], v6 offset0:128 offset1:129
    ds_read2_b32 v[94:95], v6 offset0:130 offset1:131
    v_lshlrev_b32 v18, 3, v3
    v_sub_u32 v18, v8, v18
    v_lshrrev_b32 v19, 2, v2
    v_lshl_add_u32 v19, v19, 2, v3
    v_and_b32 v28, 3, v2
    v_lshlrev_b32 v28, 4, v28
    v_mul_u32_u24 v19, s8, v19
    v_xor_b32 v19, s10, v19
    s_waitcnt lgkmcnt(0)
    v_mov_b32 v7, v18
    v_add_u32 v6, v19, v28
    v_xor_b32 v12, s9, v12
W_33:
    ds_read_b32 v18, v4 offset:16
    s_sub_u32 s39, s39, 1
    s_cbranch_scc1 KS_ABORT
    s_waitcnt lgkmcnt(0)
    v_cmp_ne_u32 vcc, s84, v18
    s_cbranch_vccnz W_33
    s_setprio 1
    ds_read_b128 v[96:99], v8 offset:0
    ds_read_b128 v[100:103], v8 offset:64
    ds_read_b128 v[104:107], v8 offset:128
    ds_read_b128 v[108:111], v8 offset:192
    s_waitcnt lgkmcnt(3)
    v_mfma_f32_16x16x32_f16 v[20:23], v[32:35], v[96:99], 0
    v_mfma_f32_16x16x32_f16 v[24:27], v[36:39], v[96:99], 0
    ds_read_b128 v[112:115], v8 offset:256
    s_waitcnt lgkmcnt(3)
    v_mfma_f32_16x16x32_f16 v[20:23], v[40:43], v[100:103], v[20:23]
    ds_read_b64 v[28:29], v7 offset:480
    ds_read_b64 v[30:31], v7 offset:992
    v_mfma_f32_16x16x32_f16 v[24:27], v[44:47], v[100:103], v[24:27]
    ds_read_b128 v[116:119], v8 offset:320
    s_waitcnt lgkmcnt(5)
    v_mfma_f32_16x16x32_f16 v[20:23], v[48:51], v[104:107], v[20:23]
    v_mfma_f32_16x16x32_f16 v[24:27], v[52:55], v[104:107], v[24:27]
    ds_read_b128 v[120:123], v8 offset:384
    s_waitcnt lgkmcnt(2)
    v_fma_mix_f32 v104, v28, v17, 0 op_sel_hi:[1,0,0]
    v_fma_mix_f32 v105, v28, v17, 0 op_sel:[1,0,0] op_sel_hi:[1,0,0]
    v_mfma_f32_16x16x32_f16 v[20:23], v[56:59], v[108:111], v[20:23]
    v_fma_mix_f32 v106, v29, v17, 0 op_sel_hi:[1,0,0]
    v_fma_mix_f32 v107, v29, v17, 0 op_sel:[1,0,0] op_sel_hi:[1,0,0]
    v_mfma_f32_16x16x32_f16 v[24:27], v[60:63], v[108:111], v[24:27]
    ds_read_b128 v[124:127], v8 offset:448
    v_cvt_pk_bf16_f32 v28, v104, v105
    v_cvt_pk_bf16_f32 v29, v106, v107
    v_mfma_f32_16x16x32_f16 v[20:23], v[64:67], v[112:115], v[20:23]
    v_lshlrev_b32 v104, 16, v28
    v_and_b32 v105, 0xffff0000, v28
    v_mfma_f32_16x16x32_f16 v[24:27], v[68:71], v[112:115], v[24:27]
    ds_read_b128 v[36:39], v8 offset:512
    v_lshlrev_b32 v106, 16, v29
    v_and_b32 v107, 0xffff0000, v29
    s_waitcnt lgkmcnt(3)
    v_mfma_f32_16x16x32_f16 v[20:23], v[72:75], v[116:119], v[20:23]
    ds_read_b128 v[96:99], v8 offset:576
    v_fma_mix_f32 v112, v30, v17, 0 op_sel_hi:[1,0,0]
    v_fma_mix_f32 v113, v30, v17, 0 op_sel:[1,0,0] op_sel_hi:[1,0,0]
    v_mfma_f32_16x16x32_f16 v[24:27], v[76:79], v[116:119], v[24:27]
    ds_read_b128 v[44:47], v8 offset:640
    v_fma_mix_f32 v114, v31, v17, 0 op_sel_hi:[1,0,0]
    v_fma_mix_f32 v115, v31, v17, 0 op_sel:[1,0,0] op_sel_hi:[1,0,0]
    s_waitcnt lgkmcnt(4)
    v_mfma_f32_16x16x32_f16 v[20:23], v[80:83], v[120:123], v[20:23]
    ds_read_b128 v[100:103], v8 offset:704
    v_cvt_pk_bf16_f32 v30, v112, v113
    v_cvt_pk_bf16_f32 v31, v114, v115
    v_mfma_f32_16x16x32_f16 v[24:27], v[84:87], v[120:123], v[24:27]
    ds_read_b128 v[52:55], v8 offset:768
    v_lshlrev_b32 v112, 16, v30
    v_and_b32 v113, 0xffff0000, v30
    s_waitcnt lgkmcnt(5)
    v_mfma_f32_16x16x32_f16 v[20:23], v[88:91], v[124:127], v[20:23]
    ds_read_b128 v[60:63], v8 offset:832
    v_lshlrev_b32 v114, 16, v31
    v_and_b32 v115, 0xffff0000, v31
    v_mfma_f32_16x16x32_f16 v[24:27], v[92:95], v[124:127], v[24:27]
    ds_read_b128 v[108:111], v8 offset:896
    s_waitcnt lgkmcnt(6)
    v_mfma_f32_16x16x32_f16 v[24:27], v[32:35], v[36:39], v[24:27]
    ds_read_b128 v[68:71], v8 offset:960
    v_mul_f32 v20, v20, v16
    v_mul_f32 v21, v21, v16
    s_waitcnt lgkmcnt(6)
    v_mfma_f32_16x16x32_f16 v[24:27], v[40:43], v[96:99], v[24:27]
    v_mul_f32 v22, v22, v16
    v_mul_f32 v23, v23, v16
    s_waitcnt lgkmcnt(5)
    v_mfma_f32_16x16x32_f16 v[24:27], v[48:51], v[44:47], v[24:27]
    v_cvt_pk_bf16_f32 v28, v20, v21
    v_cvt_pk_bf16_f32 v29, v22, v23
    s_waitcnt lgkmcnt(4)
    v_mfma_f32_16x16x32_f16 v[24:27], v[56:59], v[100:103], v[24:27]
    v_lshlrev_b32 v20, 16, v28
    v_and_b32 v21, 0xffff0000, v28
    s_waitcnt lgkmcnt(3)
    v_mfma_f32_16x16x32_f16 v[24:27], v[64:67], v[52:55], v[24:27]
    v_lshlrev_b32 v22, 16, v29
    v_and_b32 v23, 0xffff0000, v29
    s_waitcnt lgkmcnt(2)
    v_mfma_f32_16x16x32_f16 v[24:27], v[72:75], v[60:63], v[24:27]
    v_add_f32 v20, v20, v104
    v_add_f32 v21, v21, v105
    s_waitcnt lgkmcnt(1)
    v_mfma_f32_16x16x32_f16 v[24:27], v[80:83], v[108:111], v[24:27]
    v_add_f32 v22, v22, v106
    v_add_f32 v23, v23, v107
    s_waitcnt lgkmcnt(0)
    v_mfma_f32_16x16x32_f16 v[24:27], v[88:91], v[68:71], v[24:27]
    v_cvt_pk_bf16_f32 v28, v20, v21
    v_cvt_pk_bf16_f32 v29, v22, v23
    v_min_u32 v28, -2, v28
    v_min_u32 v29, -2, v29
    ds_read_u8 v18, v4 offset:160
    ds_read_b128 v[20:23], v12 offset:46592
    s_nop 1
    v_mul_f32 v24, v24, v16
    v_mul_f32 v25, v25, v16
    v_mul_f32 v26, v26, v16
    v_mul_f32 v27, v27, v16
    v_cvt_pk_bf16_f32 v30, v24, v25
    v_cvt_pk_bf16_f32 v31, v26, v27
    v_lshlrev_b32 v24, 16, v30
    v_and_b32 v25, 0xffff0000, v30
    v_lshlrev_b32 v26, 16, v31
    v_and_b32 v27, 0xffff0000, v31
    v_add_f32 v24, v24, v112
    v_add_f32 v25, v25, v113
    v_add_f32 v26, v26, v114
    v_add_f32 v27, v27, v115
    v_cvt_pk_bf16_f32 v30, v24, v25
    v_cvt_pk_bf16_f32 v31, v26, v27
    v_min_u32 v30, -2, v30
    v_min_u32 v31, -2, v31
    s_branch CVE_32
CV_29:
    ds_read2_b32 v[32:33], v6 offset0:0 offset1:1
    ds_read2_b32 v[34:35], v6 offset0:2 offset1:3
    ds_read2_b32 v[36:37], v6 offset0:16 offset1:17
    ds_read2_b32 v[38:39], v6 offset0:18 offset1:19
    ds_read2_b32 v[40:41], v6 offset0:32 offset1:33
    ds_read2_b32 v[42:43], v6 offset0:34 offset1:35
    ds_read2_b32 v[44:45], v6 offset0:48 offset1:49
    ds_read2_b32 v[46:47], v6 offset0:50 offset1:51
    ds_read2_b32 v[48:49], v6 offset0:64 offset1:65
    ds_read2_b32 v[50:51], v6 offset0:66 offset1:67
    ds_read2_b32 v[52:53], v6 offset0:80 offset1:81
    ds_read2_b32 v[54:55], v6 offset0:82 offset1:83
    ds_read2_b32 v[56:57], v6 offset0:96 offset1:97
    ds_read2_b32 v[58:59], v6 offset0:98 offset1:99
    ds_read2_b32 v[60:61], v6 offset0:112 offset1:113
    ds_read2_b32 v[62:63], v6 offset0:114 offset1:115
    ds_read2_b32 v[64:65], v6 offset0:128 offset1:129
    ds_read2_b32 v[66:67], v6 offset0:130 offset1:131
    ds_read2_b32 v[68:69], v6 offset0:144 offset1:145
    ds_read2_b32 v[70:71], v6 offset0:146 offset1:147
    ds_read2_b32 v[72:73], v6 offset0:160 offset1:161
    ds_read2_b32 v[74:75], v6 offset0:162 offset1:163
    ds_read2_b32 v[76:77], v6 offset0:176 offset1:177
    ds_read2_b32 v[78:79], v6 offset0:178 offset1:179
    ds_read2_b32 v[80:81], v6 offset0:192 offset1:193
    ds_read2_b32 v[82:83], v6 offset0:194 offset1:195
    ds_read2_b32 v[84:85], v6 offset0:208 offset1:209
    ds_read2_b32 v[86:87], v6 offset0:210 offset1:211
    ds_read2_b32 v[88:89], v6 offset0:224 offset1:225
    ds_read2_b32 v[90:91], v6 offset0:226 offset1:227
    ds_read2_b32 v[92:93], v6 offset0:240 offset1:241
    ds_read2_b32 v[94:95], v6 offset0:242 offset1:243
    ds_read2_b32 v[96:97], v7 offset0:96 offset1:97
    ds_read2_b32 v[98:99], v7 offset0:98 offset1:99
    ds_read2_b32 v[100:101], v11 offset0:32 offset1:33
    ds_read2_b32 v[102:103], v11 offset0:34 offset1:35
    ds_read2_b32 v[104:105], v11 offset0:96 offset1:97
    ds_read2_b32 v[106:107], v11 offset0:98 offset1:99
    v_lshlrev_b32 v18, 3, v3
    v_sub_u32 v18, v8, v18
    v_lshrrev_b32 v19, 2, v2
    v_lshl_add_u32 v19, v19, 2, v3
    v_and_b32 v28, 3, v2
    v_lshlrev_b32 v28, 4, v28
    v_mul_u32_u24 v19, s8, v19
    v_xor_b32 v19, s10, v19
    s_waitcnt lgkmcnt(0)
    v_mov_b32 v7, v18
    v_add_u32 v6, v19, v28
    v_xor_b32 v12, s9, v12
W_34:
    ds_read_b32 v18, v4 offset:16
    s_sub_u32 s39, s39, 1
    s_cbranch_scc1 KS_ABORT
    s_waitcnt lgkmcnt(0)
    v_cmp_ne_u32 vcc, s84, v18
    s_cbranch_vccnz W_34
    s_setprio 1
    ds_read_b128 v[108:111], v8 offset:448
    ds_read_b128 v[112:115], v8 offset:512
    ds_read_b128 v[116:119], v8 offset:576
    ds_read_b128 v[120:123], v8 offset:640
    ds_read_b128 v[124:127], v8 offset:704
    s_waitcnt lgkmcnt(4)
    v_mfma_f32_16x16x32_f16 v[20:23], v[32:35], v[108:111], 0
    ds_read_b128 v[108:111], v8 offset:768
    s_waitcnt lgkmcnt(4)
    v_mfma_f32_16x16x32_f16 v[20:23], v[36:39], v[112:115], v[20:23]
    ds_read_b128 v[112:115], v8 offset:832
    s_waitcnt lgkmcnt(4)
    v_mfma_f32_16x16x32_f16 v[20:23], v[40:43], v[116:119], v[20:23]
    ds_read_b128 v[116:119], v8 offset:896
    ds_read_b64 v[28:29], v7 offset:1504
    ds_read_b64 v[30:31], v7 offset:2016
    s_waitcnt lgkmcnt(6)
    v_mfma_f32_16x16x32_f16 v[20:23], v[44:47], v[120:123], v[20:23]
    ds_read_b128 v[120:123], v8 offset:960
    s_waitcnt lgkmcnt(6)
    v_mfma_f32_16x16x32_f16 v[20:23], v[48:51], v[124:127], v[20:23]
    ds_read_b128 v[124:127], v8 offset:1024
    s_waitcnt lgkmcnt(6)
    v_mfma_f32_16x16x32_f16 v[20:23], v[52:55], v[108:111], v[20:23]
    ds_read_b128 v[108:111], v8 offset:1088
    s_waitcnt lgkmcnt(6)
    v_mfma_f32_16x16x32_f16 v[20:23], v[56:59], v[112:115], v[20:23]
    s_waitcnt lgkmcnt(5)
    v_mfma_f32_16x16x32_f16 v[20:23], v[60:63], v[116:119], v[20:23]
    ds_read_b128 v[112:115], v8 offset:1152
    s_waitcnt lgkmcnt(3)
    v_mfma_f32_16x16x32_f16 v[20:23], v[64:67], v[120:123], v[20:23]
    v_mfma_f32_16x16x32_f16 v[24:27], v[32:35], v[120:123], 0
    ds_read_b128 v[116:119], v8 offset:1216
    v_fma_mix_f32 v120, v28, v17, 0 op_sel_hi:[1,0,0]
    v_fma_mix_f32 v121, v28, v17, 0 op_sel:[1,0,0] op_sel_hi:[1,0,0]
    s_waitcnt lgkmcnt(3)
    v_mfma_f32_16x16x32_f16 v[20:23], v[68:71], v[124:127], v[20:23]
    v_fma_mix_f32 v122, v29, v17, 0 op_sel_hi:[1,0,0]
    v_fma_mix_f32 v123, v29, v17, 0 op_sel:[1,0,0] op_sel_hi:[1,0,0]
    v_mfma_f32_16x16x32_f16 v[24:27], v[36:39], v[124:127], v[24:27]
    ds_read_b128 v[32:35], v8 offset:1280
    v_cvt_pk_bf16_f32 v28, v120, v121
    v_cvt_pk_bf16_f32 v29, v122, v123
    s_waitcnt lgkmcnt(3)
    v_mfma_f32_16x16x32_f16 v[20:23], v[72:75], v[108:111], v[20:23]
    v_lshlrev_b32 v120, 16, v28
    v_and_b32 v121, 0xffff0000, v28
    v_mfma_f32_16x16x32_f16 v[24:27], v[40:43], v[108:111], v[24:27]
    ds_read_b128 v[36:39], v8 offset:1344
    v_lshlrev_b32 v122, 16, v29
    v_and_b32 v123, 0xffff0000, v29
    s_waitcnt lgkmcnt(3)
    v_mfma_f32_16x16x32_f16 v[20:23], v[76:79], v[112:115], v[20:23]
    v_fma_mix_f32 v108, v30, v17, 0 op_sel_hi:[1,0,0]
    v_fma_mix_f32 v109, v30, v17, 0 op_sel:[1,0,0] op_sel_hi:[1,0,0]
    v_mfma_f32_16x16x32_f16 v[24:27], v[44:47], v[112:115], v[24:27]
    ds_read_b128 v[124:127], v8 offset:1408
    v_fma_mix_f32 v110, v31, v17, 0 op_sel_hi:[1,0,0]
    v_fma_mix_f32 v111, v31, v17, 0 op_sel:[1,0,0] op_sel_hi:[1,0,0]
    s_waitcnt lgkmcnt(3)
    v_mfma_f32_16x16x32_f16 v[20:23], v[80:83], v[116:119], v[20:23]
    v_cvt_pk_bf16_f32 v30, v108, v109
    v_cvt_pk_bf16_f32 v31, v110, v111
    v_mfma_f32_16x16x32_f16 v[24:27], v[48:51], v[116:119], v[24:27]
    ds_read_b128 v[40:43], v8 offset:1472
    v_lshlrev_b32 v108, 16, v30
    v_and_b32 v109, 0xffff0000, v30
    s_waitcnt lgkmcnt(3)
    v_mfma_f32_16x16x32_f16 v[20:23], v[84:87], v[32:35], v[20:23]
    v_lshlrev_b32 v110, 16, v31
    v_and_b32 v111, 0xffff0000, v31
    v_mfma_f32_16x16x32_f16 v[24:27], v[52:55], v[32:35], v[24:27]
    ds_read_b128 v[44:47], v8 offset:1536
    s_waitcnt lgkmcnt(3)
    v_mfma_f32_16x16x32_f16 v[20:23], v[88:91], v[36:39], v[20:23]
    ds_read_b128 v[112:115], v8 offset:1600
    v_mfma_f32_16x16x32_f16 v[24:27], v[56:59], v[36:39], v[24:27]
    ds_read_b128 v[48:51], v8 offset:1664
    s_waitcnt lgkmcnt(4)
    v_mfma_f32_16x16x32_f16 v[20:23], v[92:95], v[124:127], v[20:23]
    ds_read_b128 v[116:119], v8 offset:1728
    v_mfma_f32_16x16x32_f16 v[24:27], v[60:63], v[124:127], v[24:27]
    ds_read_b128 v[52:55], v8 offset:1792
    s_waitcnt lgkmcnt(5)
    v_mfma_f32_16x16x32_f16 v[20:23], v[96:99], v[40:43], v[20:23]
    ds_read_b128 v[32:35], v8 offset:1856
    v_mfma_f32_16x16x32_f16 v[24:27], v[64:67], v[40:43], v[24:27]
    ds_read_b32 v18, v14 offset:76
    ds_read_b128 v[56:59], v8 offset:1920
    s_waitcnt lgkmcnt(7)
    v_mfma_f32_16x16x32_f16 v[24:27], v[68:71], v[44:47], v[24:27]
    ds_read_b128 v[36:39], v8 offset:1984
    s_waitcnt lgkmcnt(7)
    v_mfma_f32_16x16x32_f16 v[24:27], v[72:75], v[112:115], v[24:27]
    ds_read2_b32 v[60:61], v11 offset0:16 offset1:17
    ds_read2_b32 v[62:63], v11 offset0:18 offset1:19
    s_waitcnt lgkmcnt(8)
    v_mfma_f32_16x16x32_f16 v[24:27], v[76:79], v[48:51], v[24:27]
    s_waitcnt lgkmcnt(4)
    v_cmp_ne_u32 vcc, s84, v18
    s_cbranch_vccnz WS_35
WB_36:
    ds_read_b64_tr_b16 v[124:125], v9 offset:0
    ds_read_b64_tr_b16 v[126:127], v9 offset:64
    ds_read_b64_tr_b16 v[64:65], v9 offset:3088
    ds_read_b64_tr_b16 v[66:67], v9 offset:3152
    v_mfma_f32_16x16x32_f16 v[24:27], v[80:83], v[116:119], v[24:27]
    v_mfma_f32_16x16x32_f16 v[24:27], v[84:87], v[52:55], v[24:27]
    ds_read_b64_tr_b16 v[40:41], v9 offset:512
    ds_read_b64_tr_b16 v[42:43], v9 offset:576
    ds_read2_b32 v[68:69], v11 offset0:80 offset1:81
    ds_read2_b32 v[70:71], v11 offset0:82 offset1:83
    v_mfma_f32_16x16x32_f16 v[24:27], v[88:91], v[32:35], v[24:27]
    s_waitcnt lgkmcnt(11)
    v_mfma_f32_16x16x32_f16 v[24:27], v[92:95], v[56:59], v[24:27]
    ds_read_b64_tr_b16 v[44:45], v9 offset:3600
    ds_read_b64_tr_b16 v[46:47], v9 offset:3664
    s_waitcnt lgkmcnt(12)
    v_mfma_f32_16x16x32_f16 v[24:27], v[96:99], v[36:39], v[24:27]
    s_waitcnt lgkmcnt(8)
    v_mfma_f32_16x16x32_f16 v[20:23], v[124:127], v[100:103], v[20:23]
    s_waitcnt lgkmcnt(6)
    v_mfma_f32_16x16x32_f16 v[20:23], v[64:67], v[104:107], v[20:23]
    v_mfma_f32_16x16x32_f16 v[24:27], v[124:127], v[60:63], v[24:27]
    s_waitcnt lgkmcnt(4)
    v_mfma_f32_16x16x32_f16 v[24:27], v[40:43], v[100:103], v[24:27]
    s_nop 4
    v_mul_f32 v20, v20, v16
    v_mul_f32 v21, v21, v16
    s_waitcnt lgkmcnt(2)
    v_mfma_f32_16x16x32_f16 v[24:27], v[64:67], v[68:71], v[24:27]
    v_mul_f32 v22, v22, v16
    v_mul_f32 v23, v23, v16
    s_waitcnt lgkmcnt(0)
    v_mfma_f32_16x16x32_f16 v[24:27], v[44:47], v[104:107], v[24:27]
    v_cvt_pk_bf16_f32 v28, v20, v21
    v_cvt_pk_bf16_f32 v29, v22, v23
    v_lshlrev_b32 v20, 16, v28
    v_and_b32 v21, 0xffff0000, v28
    v_lshlrev_b32 v22, 16, v29
    v_and_b32 v23, 0xffff0000, v29
    v_add_f32 v20, v20, v120
    v_add_f32 v21, v21, v121
    v_add_f32 v22, v22, v122
    v_add_f32 v23, v23, v123
    v_cvt_pk_bf16_f32 v28, v20, v21
    v_cvt_pk_bf16_f32 v29, v22, v23
    v_min_u32 v28, -2, v28
    v_min_u32 v29, -2, v29
    ds_read_u8 v18, v4 offset:161
    ds_read_b128 v[20:23], v12 offset:47616
    v_mul_f32 v24, v24, v16
    v_mul_f32 v25, v25, v16
    v_mul_f32 v26, v26, v16
    v_mul_f32 v27, v27, v16
    v_cvt_pk_bf16_f32 v30, v24, v25
    v_cvt_pk_bf16_f32 v31, v26, v27
    v_lshlrev_b32 v24, 16, v30
    v_and_b32 v25, 0xffff0000, v30
    v_lshlrev_b32 v26, 16, v31
    v_and_b32 v27, 0xffff0000, v31
    v_add_f32 v24, v24, v108
    v_add_f32 v25, v25, v109
    v_add_f32 v26, v26, v110
    v_add_f32 v27, v27, v111
    v_cvt_pk_bf16_f32 v30, v24, v25
    v_cvt_pk_bf16_f32 v31, v26, v27
    v_min_u32 v30, -2, v30
    v_min_u32 v31, -2, v31
    s_branch CVE_32
CV_30:
    ds_read2_b32 v[32:33], v7 offset0:128 offset1:129
    ds_read2_b32 v[34:35], v7 offset0:130 offset1:131
    ds_read2_b32 v[36:37], v6 offset0:0 offset1:1
    ds_read2_b32 v[38:39], v6 offset0:2 offset1:3
    ds_read2_b32 v[40:41], v6 offset0:16 offset1:17
    ds_read2_b32 v[42:43], v6 offset0:18 offset1:19
    ds_read2_b32 v[44:45], v6 offset0:32 offset1:33
    ds_read2_b32 v[46:47], v6 offset0:34 offset1:35
    ds_read2_b32 v[48:49], v6 offset0:48 offset1:49
    ds_read2_b32 v[50:51], v6 offset0:50 offset1:51
    ds_read2_b32 v[52:53], v6 offset0:64 offset1:65
    ds_read2_b32 v[54:55], v6 offset0:66 offset1:67
    ds_read2_b32 v[56:57], v6 offset0:80 offset1:81
    ds_read2_b32 v[58:59], v6 offset0:82 offset1:83
    ds_read2_b32 v[60:61], v6 offset0:96 offset1:97
    ds_read2_b32 v[62:63], v6 offset0:98 offset1:99
    ds_read2_b32 v[64:65], v6 offset0:112 offset1:113
    ds_read2_b32 v[66:67], v6 offset0:114 offset1:115
    ds_read2_b32 v[68:69], v6 offset0:128 offset1:129
    ds_read2_b32 v[70:71], v6 offset0:130 offset1:131
    ds_read2_b32 v[72:73], v6 offset0:144 offset1:145
    ds_read2_b32 v[74:75], v6 offset0:146 offset1:147
    ds_read2_b32 v[76:77], v6 offset0:160 offset1:161
    ds_read2_b32 v[78:79], v6 offset0:162 offset1:163
    ds_read2_b32 v[80:81], v6 offset0:176 offset1:177
    ds_read2_b32 v[82:83], v6 offset0:178 offset1:179
    ds_read2_b32 v[84:85], v6 offset0:192 offset1:193
    ds_read2_b32 v[86:87], v6 offset0:194 offset1:195
    ds_read2_b32 v[88:89], v6 offset0:208 offset1:209
    ds_read2_b32 v[90:91], v6 offset0:210 offset1:211
    ds_read2_b32 v[92:93], v6 offset0:224 offset1:225
    ds_read2_b32 v[94:95], v6 offset0:226 offset1:227
    ds_read2_b32 v[96:97], v6 offset0:240 offset1:241
    ds_read2_b32 v[98:99], v6 offset0:242 offset1:243
    ds_read2_b32 v[100:101], v7 offset0:96 offset1:97
    ds_read2_b32 v[102:103], v7 offset0:98 offset1:99
    ds_read2_b32 v[104:105], v11 offset0:0 offset1:1
    ds_read2_b32 v[106:107], v11 offset0:2 offset1:3
    v_lshlrev_b32 v18, 3, v3
    v_sub_u32 v18, v8, v18
    v_lshrrev_b32 v19, 2, v2
    v_lshl_add_u32 v19, v19, 2, v3
    v_and_b32 v28, 3, v2
    v_lshlrev_b32 v28, 4, v28
    v_mul_u32_u24 v19, s8, v19
    v_xor_b32 v19, s10, v19
    s_waitcnt lgkmcnt(0)
    v_mov_b32 v7, v18
    v_add_u32 v6, v19, v28
    v_xor_b32 v12, s9, v12
W_37:
    ds_read_b32 v18, v4 offset:16
    s_sub_u32 s39, s39, 1
    s_cbranch_scc1 KS_ABORT
    s_waitcnt lgkmcnt(0)
    v_cmp_ne_u32 vcc, s84, v18
    s_cbranch_vccnz W_37
    s_setprio 1
    ds_read_b128 v[108:111], v8 offset:448
    ds_read_b128 v[112:115], v8 offset:960
    ds_read_b128 v[116:119], v8 offset:1472
    ds_read_b128 v[120:123], v8 offset:1536
    ds_read_b128 v[124:127], v8 offset:1600
    s_waitcnt lgkmcnt(4)
    v_mfma_f32_16x16x32_f16 v[20:23], v[32:35], v[108:111], 0
    ds_read_b128 v[108:111], v8 offset:1664
    s_waitcnt lgkmcnt(4)
    v_mfma_f32_16x16x32_f16 v[24:27], v[32:35], v[112:115], 0
    ds_read_b128 v[32:35], v8 offset:1728
    ds_read_b128 v[112:115], v8 offset:1792
    s_waitcnt lgkmcnt(5)
    v_mfma_f32_16x16x32_f16 v[20:23], v[36:39], v[116:119], v[20:23]
    ds_read_b128 v[116:119], v8 offset:1856
    ds_read_b64 v[28:29], v7 offset:2528
    ds_read_b64 v[30:31], v7 offset:3040
    s_waitcnt lgkmcnt(7)
    v_mfma_f32_16x16x32_f16 v[20:23], v[40:43], v[120:123], v[20:23]
    ds_read_b128 v[120:123], v8 offset:1920
    s_waitcnt lgkmcnt(7)
    v_mfma_f32_16x16x32_f16 v[20:23], v[44:47], v[124:127], v[20:23]
    ds_read_b128 v[124:127], v8 offset:1984
    s_waitcnt lgkmcnt(7)
    v_mfma_f32_16x16x32_f16 v[20:23], v[48:51], v[108:111], v[20:23]
    ds_read_b128 v[108:111], v8 offset:2048
    s_waitcnt lgkmcnt(7)
    v_mfma_f32_16x16x32_f16 v[20:23], v[52:55], v[32:35], v[20:23]
    s_waitcnt lgkmcnt(6)
    v_mfma_f32_16x16x32_f16 v[20:23], v[56:59], v[112:115], v[20:23]
    ds_read_b128 v[32:35], v8 offset:2112
    s_waitcnt lgkmcnt(6)
    v_mfma_f32_16x16x32_f16 v[20:23], v[60:63], v[116:119], v[20:23]
    s_waitcnt lgkmcnt(4)
    v_fma_mix_f32 v116, v28, v17, 0 op_sel_hi:[1,0,0]
    v_fma_mix_f32 v117, v28, v17, 0 op_sel:[1,0,0] op_sel_hi:[1,0,0]
    s_waitcnt lgkmcnt(3)
    v_mfma_f32_16x16x32_f16 v[20:23], v[64:67], v[120:123], v[20:23]
    ds_read_b128 v[112:115], v8 offset:2176
    v_fma_mix_f32 v118, v29, v17, 0 op_sel_hi:[1,0,0]
    v_fma_mix_f32 v119, v29, v17, 0 op_sel:[1,0,0] op_sel_hi:[1,0,0]
    s_waitcnt lgkmcnt(3)
    v_mfma_f32_16x16x32_f16 v[20:23], v[68:71], v[124:127], v[20:23]
    v_cvt_pk_bf16_f32 v28, v116, v117
    v_cvt_pk_bf16_f32 v29, v118, v119
    v_mfma_f32_16x16x32_f16 v[24:27], v[36:39], v[124:127], v[24:27]
    ds_read_b128 v[120:123], v8 offset:2240
    v_lshlrev_b32 v116, 16, v28
    v_and_b32 v117, 0xffff0000, v28
    s_waitcnt lgkmcnt(3)
    v_mfma_f32_16x16x32_f16 v[20:23], v[72:75], v[108:111], v[20:23]
    v_lshlrev_b32 v118, 16, v29
    v_and_b32 v119, 0xffff0000, v29
    v_mfma_f32_16x16x32_f16 v[24:27], v[40:43], v[108:111], v[24:27]
    ds_read_b128 v[36:39], v8 offset:2304
    v_fma_mix_f32 v108, v30, v17, 0 op_sel_hi:[1,0,0]
    v_fma_mix_f32 v109, v30, v17, 0 op_sel:[1,0,0] op_sel_hi:[1,0,0]
    s_waitcnt lgkmcnt(3)
    v_mfma_f32_16x16x32_f16 v[20:23], v[76:79], v[32:35], v[20:23]
    v_fma_mix_f32 v110, v31, v17, 0 op_sel_hi:[1,0,0]
    v_fma_mix_f32 v111, v31, v17, 0 op_sel:[1,0,0] op_sel_hi:[1,0,0]
    v_mfma_f32_16x16x32_f16 v[24:27], v[44:47], v[32:35], v[24:27]
    ds_read_b128 v[124:127], v8 offset:2368
    v_cvt_pk_bf16_f32 v30, v108, v109
    v_cvt_pk_bf16_f32 v31, v110, v111
    s_waitcnt lgkmcnt(3)
    v_mfma_f32_16x16x32_f16 v[20:23], v[80:83], v[112:115], v[20:23]
    v_lshlrev_b32 v108, 16, v30
    v_and_b32 v109, 0xffff0000, v30
    v_mfma_f32_16x16x32_f16 v[24:27], v[48:51], v[112:115], v[24:27]
    ds_read_b128 v[40:43], v8 offset:2432
    v_lshlrev_b32 v110, 16, v31
    v_and_b32 v111, 0xffff0000, v31
    s_waitcnt lgkmcnt(3)
    v_mfma_f32_16x16x32_f16 v[20:23], v[84:87], v[120:123], v[20:23]
    v_mfma_f32_16x16x32_f16 v[24:27], v[52:55], v[120:123], v[24:27]
    ds_read_b128 v[44:47], v8 offset:2496
    s_waitcnt lgkmcnt(3)
    v_mfma_f32_16x16x32_f16 v[20:23], v[88:91], v[36:39], v[20:23]
    v_mfma_f32_16x16x32_f16 v[24:27], v[56:59], v[36:39], v[24:27]
    ds_read_b128 v[32:35], v8 offset:2560
    s_waitcnt lgkmcnt(3)
    v_mfma_f32_16x16x32_f16 v[20:23], v[92:95], v[124:127], v[20:23]
    ds_read_b128 v[48:51], v8 offset:2624
    v_mfma_f32_16x16x32_f16 v[24:27], v[60:63], v[124:127], v[24:27]
    ds_read_b128 v[112:115], v8 offset:2688
    s_waitcnt lgkmcnt(4)
    v_mfma_f32_16x16x32_f16 v[20:23], v[96:99], v[40:43], v[20:23]
    ds_read_b128 v[52:55], v8 offset:2752
    v_mfma_f32_16x16x32_f16 v[24:27], v[64:67], v[40:43], v[24:27]
    ds_read_b128 v[120:123], v8 offset:2816
    s_waitcnt lgkmcnt(5)
    v_mfma_f32_16x16x32_f16 v[20:23], v[100:103], v[44:47], v[20:23]
    ds_read_b128 v[56:59], v8 offset:2880
    v_mfma_f32_16x16x32_f16 v[24:27], v[68:71], v[44:47], v[24:27]
    ds_read_b32 v18, v14 offset:76
    ds_read_b128 v[36:39], v8 offset:2944
    s_waitcnt lgkmcnt(7)
    v_mfma_f32_16x16x32_f16 v[24:27], v[72:75], v[32:35], v[24:27]
    ds_read_b128 v[60:63], v8 offset:3008
    s_waitcnt lgkmcnt(7)
    v_mfma_f32_16x16x32_f16 v[24:27], v[76:79], v[48:51], v[24:27]
    ds_read2_b32 v[124:125], v11 offset0:16 offset1:17
    ds_read2_b32 v[126:127], v11 offset0:18 offset1:19
    ds_read2_b32 v[64:65], v11 offset0:32 offset1:33
    ds_read2_b32 v[66:67], v11 offset0:34 offset1:35
    s_waitcnt lgkmcnt(10)
    v_mfma_f32_16x16x32_f16 v[24:27], v[80:83], v[112:115], v[24:27]
    s_waitcnt lgkmcnt(6)
    v_cmp_ne_u32 vcc, s84, v18
    s_cbranch_vccnz WS_38
WB_39:
    ds_read_b64_tr_b16 v[40:41], v9 offset:0
    ds_read_b64_tr_b16 v[42:43], v9 offset:64
    ds_read_b64_tr_b16 v[68:69], v9 offset:512
    ds_read_b64_tr_b16 v[70:71], v9 offset:576
    v_mfma_f32_16x16x32_f16 v[24:27], v[84:87], v[52:55], v[24:27]
    ds_read_b64_tr_b16 v[44:45], v9 offset:1024
    ds_read_b64_tr_b16 v[46:47], v9 offset:1088
    v_mfma_f32_16x16x32_f16 v[24:27], v[88:91], v[120:123], v[24:27]
    ds_read_b64_tr_b16 v[72:73], v9 offset:3088
    ds_read_b64_tr_b16 v[74:75], v9 offset:3152
    ds_read2_b32 v[32:33], v11 offset0:64 offset1:65
    ds_read2_b32 v[34:35], v11 offset0:66 offset1:67
    v_mfma_f32_16x16x32_f16 v[24:27], v[92:95], v[56:59], v[24:27]
    ds_read_b64_tr_b16 v[76:77], v9 offset:3600
    ds_read_b64_tr_b16 v[78:79], v9 offset:3664
    ds_read2_b32 v[48:49], v11 offset0:80 offset1:81
    ds_read2_b32 v[50:51], v11 offset0:82 offset1:83
    v_mfma_f32_16x16x32_f16 v[24:27], v[96:99], v[36:39], v[24:27]
    ds_read_b64_tr_b16 v[80:81], v9 offset:4112
    ds_read_b64_tr_b16 v[82:83], v9 offset:4176
    ds_read2_b32 v[112:113], v11 offset0:96 offset1:97
    ds_read2_b32 v[114:115], v11 offset0:98 offset1:99
    v_mfma_f32_16x16x32_f16 v[24:27], v[100:103], v[60:63], v[24:27]
    ds_read_b64_tr_b16 v[84:85], v10 offset:6176
    ds_read_b64_tr_b16 v[86:87], v10 offset:6304
    ds_read2_b32 v[52:53], v13 offset0:24 offset1:25
    ds_read2_b32 v[54:55], v13 offset0:26 offset1:27
    v_mfma_f32_16x16x32_f16 v[20:23], v[40:43], v[104:107], v[20:23]
    ds_read_b64_tr_b16 v[88:89], v10 offset:8224
    ds_read_b64_tr_b16 v[90:91], v10 offset:8352
    ds_read2_b32 v[120:121], v13 offset0:120 offset1:121
    ds_read2_b32 v[122:123], v13 offset0:122 offset1:123
    v_mfma_f32_16x16x32_f16 v[20:23], v[68:71], v[124:127], v[20:23]
    v_mfma_f32_16x16x32_f16 v[20:23], v[44:47], v[64:67], v[20:23]
    v_mfma_f32_16x16x32_f16 v[20:23], v[72:75], v[32:35], v[20:23]
    ds_read_b64_tr_b16 v[92:93], v9 offset:1536
    ds_read_b64_tr_b16 v[94:95], v9 offset:1600
    s_waitcnt lgkmcnt(14)
    v_mfma_f32_16x16x32_f16 v[20:23], v[76:79], v[48:51], v[20:23]
    s_waitcnt lgkmcnt(10)
    v_mfma_f32_16x16x32_f16 v[20:23], v[80:83], v[112:115], v[20:23]
    s_waitcnt lgkmcnt(6)
    v_mfma_f32_16x16x32_f16 v[20:23], v[84:87], v[52:55], v[20:23]
    ds_read_b64_tr_b16 v[56:57], v9 offset:4624
    ds_read_b64_tr_b16 v[58:59], v9 offset:4688
    ds_read2_b32 v[96:97], v13 offset0:16 offset1:17
    ds_read2_b32 v[98:99], v13 offset0:18 offset1:19
    s_waitcnt lgkmcnt(6)
    v_mfma_f32_16x16x32_f16 v[20:23], v[88:91], v[120:123], v[20:23]
    ds_read2_b32 v[36:37], v13 offset0:112 offset1:113
    ds_read2_b32 v[38:39], v13 offset0:114 offset1:115
    v_mfma_f32_16x16x32_f16 v[24:27], v[68:71], v[104:107], v[24:27]
    v_mfma_f32_16x16x32_f16 v[24:27], v[44:47], v[124:127], v[24:27]
    s_nop 3
    v_mul_f32 v20, v20, v16
    v_mul_f32 v21, v21, v16
    s_waitcnt lgkmcnt(6)
    v_mfma_f32_16x16x32_f16 v[24:27], v[92:95], v[64:67], v[24:27]
    v_mul_f32 v22, v22, v16
    v_mul_f32 v23, v23, v16
    v_mfma_f32_16x16x32_f16 v[24:27], v[76:79], v[32:35], v[24:27]
    v_cvt_pk_bf16_f32 v28, v20, v21
    v_cvt_pk_bf16_f32 v29, v22, v23
    v_mfma_f32_16x16x32_f16 v[24:27], v[80:83], v[48:51], v[24:27]
    v_lshlrev_b32 v20, 16, v28
    v_and_b32 v21, 0xffff0000, v28
    s_waitcnt lgkmcnt(4)
    v_mfma_f32_16x16x32_f16 v[24:27], v[56:59], v[112:115], v[24:27]
    v_lshlrev_b32 v22, 16, v29
    v_and_b32 v23, 0xffff0000, v29
    s_waitcnt lgkmcnt(2)
    v_mfma_f32_16x16x32_f16 v[24:27], v[84:87], v[96:99], v[24:27]
    v_add_f32 v20, v20, v116
    v_add_f32 v21, v21, v117
    s_waitcnt lgkmcnt(0)
    v_mfma_f32_16x16x32_f16 v[24:27], v[88:91], v[36:39], v[24:27]
    v_add_f32 v22, v22, v118
    v_add_f32 v23, v23, v119
    v_cvt_pk_bf16_f32 v28, v20, v21
    v_cvt_pk_bf16_f32 v29, v22, v23
    v_min_u32 v28, -2, v28
    v_min_u32 v29, -2, v29
    ds_read_u8 v18, v4 offset:162
    ds_read_b128 v[20:23], v12 offset:48640
    v_mul_f32 v24, v24, v16
    v_mul_f32 v25, v25, v16
    v_mul_f32 v26, v26, v16
    v_mul_f32 v27, v27, v16
    v_cvt_pk_bf16_f32 v30, v24, v25
    v_cvt_pk_bf16_f32 v31, v26, v27
    v_lshlrev_b32 v24, 16, v30
    v_and_b32 v25, 0xffff0000, v30
    v_lshlrev_b32 v26, 16, v31
    v_and_b32 v27, 0xffff0000, v31
    v_add_f32 v24, v24, v108
    v_add_f32 v25, v25, v109
    v_add_f32 v26, v26, v110
    v_add_f32 v27, v27, v111
    v_cvt_pk_bf16_f32 v30, v24, v25
    v_cvt_pk_bf16_f32 v31, v26, v27
    v_min_u32 v30, -2, v30
    v_min_u32 v31, -2, v31
    s_branch CVE_32
CV_31:
    ds_read2_b32 v[32:33], v7 offset0:128 offset1:129
    ds_read2_b32 v[34:35], v7 offset0:130 offset1:131
    ds_read2_b32 v[36:37], v6 offset0:0 offset1:1
    ds_read2_b32 v[38:39], v6 offset0:2 offset1:3
    ds_read2_b32 v[40:41], v6 offset0:16 offset1:17
    ds_read2_b32 v[42:43], v6 offset0:18 offset1:19
    ds_read2_b32 v[44:45], v6 offset0:32 offset1:33
    ds_read2_b32 v[46:47], v6 offset0:34 offset1:35
    ds_read2_b32 v[48:49], v6 offset0:48 offset1:49
    ds_read2_b32 v[50:51], v6 offset0:50 offset1:51
    ds_read2_b32 v[52:53], v6 offset0:64 offset1:65
    ds_read2_b32 v[54:55], v6 offset0:66 offset1:67
    ds_read2_b32 v[56:57], v6 offset0:80 offset1:81
    ds_read2_b32 v[58:59], v6 offset0:82 offset1:83
    ds_read2_b32 v[60:61], v6 offset0:96 offset1:97
    ds_read2_b32 v[62:63], v6 offset0:98 offset1:99
    ds_read2_b32 v[64:65], v6 offset0:112 offset1:113
    ds_read2_b32 v[66:67], v6 offset0:114 offset1:115
    ds_read2_b32 v[68:69], v6 offset0:128 offset1:129
    ds_read2_b32 v[70:71], v6 offset0:130 offset1:131
    ds_read2_b32 v[72:73], v6 offset0:144 offset1:145
    ds_read2_b32 v[74:75], v6 offset0:146 offset1:147
    ds_read2_b32 v[76:77], v6 offset0:160 offset1:161
    ds_read2_b32 v[78:79], v6 offset0:162 offset1:163
    ds_read2_b32 v[80:81], v6 offset0:176 offset1:177
    ds_read2_b32 v[82:83], v6 offset0:178 offset1:179
    ds_read2_b32 v[84:85], v6 offset0:192 offset1:193
    ds_read2_b32 v[86:87], v6 offset0:194 offset1:195
    ds_read2_b32 v[88:89], v6 offset0:208 offset1:209
    ds_read2_b32 v[90:91], v6 offset0:210 offset1:211
    ds_read2_b32 v[92:93], v6 offset0:224 offset1:225
    ds_read2_b32 v[94:95], v6 offset0:226 offset1:227
    ds_read2_b32 v[96:97], v6 offset0:240 offset1:241
    ds_read2_b32 v[98:99], v6 offset0:242 offset1:243
    ds_read2_b32 v[100:101], v7 offset0:96 offset1:97
    ds_read2_b32 v[102:103], v7 offset0:98 offset1:99
    ds_read2_b32 v[104:105], v11 offset0:0 offset1:1
    ds_read2_b32 v[106:107], v11 offset0:2 offset1:3
    v_lshlrev_b32 v18, 3, v3
    v_sub_u32 v18, v8, v18
    v_lshrrev_b32 v19, 2, v2
    v_lshl_add_u32 v19, v19, 2, v3
    v_and_b32 v28, 3, v2
    v_lshlrev_b32 v28, 4, v28
    v_mul_u32_u24 v19, s8, v19
    v_xor_b32 v19, s10, v19
    s_waitcnt lgkmcnt(0)
    v_mov_b32 v7, v18
    v_add_u32 v6, v19, v28
    v_xor_b32 v12, s9, v12
W_40:
    ds_read_b32 v18, v4 offset:16
    s_sub_u32 s39, s39, 1
    s_cbranch_scc1 KS_ABORT
    s_waitcnt lgkmcnt(0)
    v_cmp_ne_u32 vcc, s84, v18
    s_cbranch_vccnz W_40
    s_setprio 1
    ds_read_b128 v[108:111], v8 offset:1472
    ds_read_b128 v[112:115], v8 offset:1984
    ds_read_b128 v[116:119], v8 offset:2496
    ds_read_b128 v[120:123], v8 offset:2560
    ds_read_b128 v[124:127], v8 offset:2624
    s_waitcnt lgkmcnt(4)
    v_mfma_f32_16x16x32_f16 v[20:23], v[32:35], v[108:111], 0
    ds_read_b128 v[108:111], v8 offset:2688
    s_waitcnt lgkmcnt(4)
    v_mfma_f32_16x16x32_f16 v[24:27], v[32:35], v[112:115], 0
    ds_read_b128 v[32:35], v8 offset:2752
    ds_read_b128 v[112:115], v8 offset:2816
    s_waitcnt lgkmcnt(5)
    v_mfma_f32_16x16x32_f16 v[20:23], v[36:39], v[116:119], v[20:23]
    ds_read_b128 v[116:119], v8 offset:2880
    ds_read_b64 v[28:29], v7 offset:3552
    ds_read_b64 v[30:31], v7 offset:4064
    s_waitcnt lgkmcnt(7)
    v_mfma_f32_16x16x32_f16 v[20:23], v[40:43], v[120:123], v[20:23]
    ds_read_b128 v[120:123], v8 offset:2944
    s_waitcnt lgkmcnt(7)
    v_mfma_f32_16x16x32_f16 v[20:23], v[44:47], v[124:127], v[20:23]
    ds_read_b128 v[124:127], v8 offset:3008
    s_waitcnt lgkmcnt(7)
    v_mfma_f32_16x16x32_f16 v[20:23], v[48:51], v[108:111], v[20:23]
    ds_read_b128 v[108:111], v8 offset:3072
    s_waitcnt lgkmcnt(7)
    v_mfma_f32_16x16x32_f16 v[20:23], v[52:55], v[32:35], v[20:23]
    s_waitcnt lgkmcnt(6)
    v_mfma_f32_16x16x32_f16 v[20:23], v[56:59], v[112:115], v[20:23]
    ds_read_b128 v[32:35], v8 offset:3136
    s_waitcnt lgkmcnt(6)
    v_mfma_f32_16x16x32_f16 v[20:23], v[60:63], v[116:119], v[20:23]
    s_waitcnt lgkmcnt(4)
    v_fma_mix_f32 v116, v28, v17, 0 op_sel_hi:[1,0,0]
    v_fma_mix_f32 v117, v28, v17, 0 op_sel:[1,0,0] op_sel_hi:[1,0,0]
    s_waitcnt lgkmcnt(3)
    v_mfma_f32_16x16x32_f16 v[20:23], v[64:67], v[120:123], v[20:23]
    ds_read_b128 v[112:115], v8 offset:3200
    v_fma_mix_f32 v118, v29, v17, 0 op_sel_hi:[1,0,0]
    v_fma_mix_f32 v119, v29, v17, 0 op_sel:[1,0,0] op_sel_hi:[1,0,0]
    s_waitcnt lgkmcnt(3)
    v_mfma_f32_16x16x32_f16 v[20:23], v[68:71], v[124:127], v[20:23]
    v_cvt_pk_bf16_f32 v28, v116, v117
    v_cvt_pk_bf16_f32 v29, v118, v119
    v_mfma_f32_16x16x32_f16 v[24:27], v[36:39], v[124:127], v[24:27]
    ds_read_b128 v[120:123], v8 offset:3264
    v_lshlrev_b32 v116, 16, v28
    v_and_b32 v117, 0xffff0000, v28
    s_waitcnt lgkmcnt(3)
    v_mfma_f32_16x16x32_f16 v[20:23], v[72:75], v[108:111], v[20:23]
    v_lshlrev_b32 v118, 16, v29
    v_and_b32 v119, 0xffff0000, v29
    v_mfma_f32_16x16x32_f16 v[24:27], v[40:43], v[108:111], v[24:27]
    ds_read_b128 v[36:39], v8 offset:3328
    v_fma_mix_f32 v108, v30, v17, 0 op_sel_hi:[1,0,0]
    v_fma_mix_f32 v109, v30, v17, 0 op_sel:[1,0,0] op_sel_hi:[1,0,0]
    s_waitcnt lgkmcnt(3)
    v_mfma_f32_16x16x32_f16 v[20:23], v[76:79], v[32:35], v[20:23]
    v_fma_mix_f32 v110, v31, v17, 0 op_sel_hi:[1,0,0]
    v_fma_mix_f32 v111, v31, v17, 0 op_sel:[1,0,0] op_sel_hi:[1,0,0]
    v_mfma_f32_16x16x32_f16 v[24:27], v[44:47], v[32:35], v[24:27]
    ds_read_b128 v[124:127], v8 offset:3392
    v_cvt_pk_bf16_f32 v30, v108, v109
    v_cvt_pk_bf16_f32 v31, v110, v111
    s_waitcnt lgkmcnt(3)
    v_mfma_f32_16x16x32_f16 v[20:23], v[80:83], v[112:115], v[20:23]
    v_lshlrev_b32 v108, 16, v30
    v_and_b32 v109, 0xffff0000, v30
    v_mfma_f32_16x16x32_f16 v[24:27], v[48:51], v[112:115], v[24:27]
    ds_read_b128 v[40:43], v8 offset:3456
    v_lshlrev_b32 v110, 16, v31
    v_and_b32 v111, 0xffff0000, v31
    s_waitcnt lgkmcnt(3)
    v_mfma_f32_16x16x32_f16 v[20:23], v[84:87], v[120:123], v[20:23]
    v_mfma_f32_16x16x32_f16 v[24:27], v[52:55], v[120:123], v[24:27]
    ds_read_b128 v[44:47], v8 offset:3520
    s_waitcnt lgkmcnt(3)
    v_mfma_f32_16x16x32_f16 v[20:23], v[88:91], v[36:39], v[20:23]
    v_mfma_f32_16x16x32_f16 v[24:27], v[56:59], v[36:39], v[24:27]
    ds_read_b128 v[32:35], v8 offset:3584
    s_waitcnt lgkmcnt(3)
    v_mfma_f32_16x16x32_f16 v[20:23], v[92:95], v[124:127], v[20:23]
    ds_read_b128 v[48:51], v8 offset:3648
    v_mfma_f32_16x16x32_f16 v[24:27], v[60:63], v[124:127], v[24:27]
    ds_read_b128 v[112:115], v8 offset:3712
    s_waitcnt lgkmcnt(4)
    v_mfma_f32_16x16x32_f16 v[20:23], v[96:99], v[40:43], v[20:23]
    ds_read_b128 v[52:55], v8 offset:3776
    v_mfma_f32_16x16x32_f16 v[24:27], v[64:67], v[40:43], v[24:27]
    ds_read_b128 v[120:123], v8 offset:3840
    s_waitcnt lgkmcnt(5)
    v_mfma_f32_16x16x32_f16 v[20:23], v[100:103], v[44:47], v[20:23]
    ds_read_b128 v[56:59], v8 offset:3904
    v_mfma_f32_16x16x32_f16 v[24:27], v[68:71], v[44:47], v[24:27]
    ds_read_b32 v18, v14 offset:76
    ds_read_b128 v[36:39], v8 offset:3968
    s_waitcnt lgkmcnt(7)
    v_mfma_f32_16x16x32_f16 v[24:27], v[72:75], v[32:35], v[24:27]
    ds_read_b128 v[60:63], v8 offset:4032
    s_waitcnt lgkmcnt(7)
    v_mfma_f32_16x16x32_f16 v[24:27], v[76:79], v[48:51], v[24:27]
    ds_read2_b32 v[124:125], v11 offset0:16 offset1:17
    ds_read2_b32 v[126:127], v11 offset0:18 offset1:19
    ds_read2_b32 v[64:65], v11 offset0:32 offset1:33
    ds_read2_b32 v[66:67], v11 offset0:34 offset1:35
    s_waitcnt lgkmcnt(10)
    v_mfma_f32_16x16x32_f16 v[24:27], v[80:83], v[112:115], v[24:27]
    s_waitcnt lgkmcnt(6)
    v_cmp_ne_u32 vcc, s84, v18
    s_cbranch_vccnz WS_41
WB_42:
    ds_read_b64_tr_b16 v[40:41], v9 offset:1024
    ds_read_b64_tr_b16 v[42:43], v9 offset:1088
    ds_read_b64_tr_b16 v[68:69], v9 offset:1536
    ds_read_b64_tr_b16 v[70:71], v9 offset:1600
    v_mfma_f32_16x16x32_f16 v[24:27], v[84:87], v[52:55], v[24:27]
    ds_read_b64_tr_b16 v[44:45], v9 offset:2048
    ds_read_b64_tr_b16 v[46:47], v9 offset:2112
    v_mfma_f32_16x16x32_f16 v[24:27], v[88:91], v[120:123], v[24:27]
    ds_read_b64_tr_b16 v[72:73], v9 offset:4112
    ds_read_b64_tr_b16 v[74:75], v9 offset:4176
    ds_read2_b32 v[32:33], v11 offset0:64 offset1:65
    ds_read2_b32 v[34:35], v11 offset0:66 offset1:67
    v_mfma_f32_16x16x32_f16 v[24:27], v[92:95], v[56:59], v[24:27]
    ds_read_b64_tr_b16 v[76:77], v9 offset:4624
    ds_read_b64_tr_b16 v[78:79], v9 offset:4688
    ds_read2_b32 v[48:49], v11 offset0:80 offset1:81
    ds_read2_b32 v[50:51], v11 offset0:82 offset1:83
    v_mfma_f32_16x16x32_f16 v[24:27], v[96:99], v[36:39], v[24:27]
    ds_read_b64_tr_b16 v[80:81], v9 offset:5136
    ds_read_b64_tr_b16 v[82:83], v9 offset:5200
    ds_read2_b32 v[112:113], v11 offset0:96 offset1:97
    ds_read2_b32 v[114:115], v11 offset0:98 offset1:99
    v_mfma_f32_16x16x32_f16 v[24:27], v[100:103], v[60:63], v[24:27]
    ds_read_b64_tr_b16 v[84:85], v10 offset:6176
    ds_read_b64_tr_b16 v[86:87], v10 offset:6304
    ds_read2_b32 v[52:53], v13 offset0:8 offset1:9
    ds_read2_b32 v[54:55], v13 offset0:10 offset1:11
    v_mfma_f32_16x16x32_f16 v[20:23], v[40:43], v[104:107], v[20:23]
    ds_read_b64_tr_b16 v[88:89], v10 offset:7200
    ds_read_b64_tr_b16 v[90:91], v10 offset:7328
    ds_read2_b32 v[120:121], v13 offset0:24 offset1:25
    ds_read2_b32 v[122:123], v13 offset0:26 offset1:27
    v_mfma_f32_16x16x32_f16 v[20:23], v[68:71], v[124:127], v[20:23]
    ds_read_b64_tr_b16 v[92:93], v10 offset:8224
    ds_read_b64_tr_b16 v[94:95], v10 offset:8352
    ds_read2_b32 v[56:57], v13 offset0:104 offset1:105
    ds_read2_b32 v[58:59], v13 offset0:106 offset1:107
    v_mfma_f32_16x16x32_f16 v[20:23], v[44:47], v[64:67], v[20:23]
    ds_read_b64_tr_b16 v[96:97], v10 offset:9248
    ds_read_b64_tr_b16 v[98:99], v10 offset:9376
    ds_read2_b32 v[36:37], v13 offset0:120 offset1:121
    ds_read2_b32 v[38:39], v13 offset0:122 offset1:123
    v_mfma_f32_16x16x32_f16 v[20:23], v[72:75], v[32:35], v[20:23]
    v_mfma_f32_16x16x32_f16 v[20:23], v[76:79], v[48:51], v[20:23]
    v_mfma_f32_16x16x32_f16 v[20:23], v[80:83], v[112:115], v[20:23]
    ds_read_b64_tr_b16 v[100:101], v9 offset:2560
    ds_read_b64_tr_b16 v[102:103], v9 offset:2624
    s_waitcnt lgkmcnt(14)
    v_mfma_f32_16x16x32_f16 v[20:23], v[84:87], v[52:55], v[20:23]
    s_waitcnt lgkmcnt(10)
    v_mfma_f32_16x16x32_f16 v[20:23], v[88:91], v[120:123], v[20:23]
    s_waitcnt lgkmcnt(6)
    v_mfma_f32_16x16x32_f16 v[20:23], v[92:95], v[56:59], v[20:23]
    ds_read_b64_tr_b16 v[60:61], v9 offset:5648
    ds_read_b64_tr_b16 v[62:63], v9 offset:5712
    ds_read2_b32 v[40:41], v13 offset0:0 offset1:1
    ds_read2_b32 v[42:43], v13 offset0:2 offset1:3
    s_waitcnt lgkmcnt(6)
    v_mfma_f32_16x16x32_f16 v[20:23], v[96:99], v[36:39], v[20:23]
    ds_read2_b32 v[72:73], v13 offset0:16 offset1:17
    ds_read2_b32 v[74:75], v13 offset0:18 offset1:19
    ds_read2_b32 v[52:53], v13 offset0:96 offset1:97
    ds_read2_b32 v[54:55], v13 offset0:98 offset1:99
    v_mfma_f32_16x16x32_f16 v[24:27], v[68:71], v[104:107], v[24:27]
    ds_read2_b32 v[120:121], v13 offset0:112 offset1:113
    ds_read2_b32 v[122:123], v13 offset0:114 offset1:115
    v_mfma_f32_16x16x32_f16 v[24:27], v[44:47], v[124:127], v[24:27]
    v_mul_f32 v20, v20, v16
    v_mul_f32 v21, v21, v16
    s_waitcnt lgkmcnt(10)
    v_mfma_f32_16x16x32_f16 v[24:27], v[100:103], v[64:67], v[24:27]
    v_mul_f32 v22, v22, v16
    v_mul_f32 v23, v23, v16
    v_mfma_f32_16x16x32_f16 v[24:27], v[76:79], v[32:35], v[24:27]
    v_cvt_pk_bf16_f32 v28, v20, v21
    v_cvt_pk_bf16_f32 v29, v22, v23
    v_mfma_f32_16x16x32_f16 v[24:27], v[80:83], v[48:51], v[24:27]
    v_lshlrev_b32 v20, 16, v28
    v_and_b32 v21, 0xffff0000, v28
    s_waitcnt lgkmcnt(8)
    v_mfma_f32_16x16x32_f16 v[24:27], v[60:63], v[112:115], v[24:27]
    v_lshlrev_b32 v22, 16, v29
    v_and_b32 v23, 0xffff0000, v29
    s_waitcnt lgkmcnt(6)
    v_mfma_f32_16x16x32_f16 v[24:27], v[84:87], v[40:43], v[24:27]
    v_add_f32 v20, v20, v116
    v_add_f32 v21, v21, v117
    s_waitcnt lgkmcnt(4)
    v_mfma_f32_16x16x32_f16 v[24:27], v[88:91], v[72:75], v[24:27]
    v_add_f32 v22, v22, v118
    v_add_f32 v23, v23, v119
    s_waitcnt lgkmcnt(2)
    v_mfma_f32_16x16x32_f16 v[24:27], v[92:95], v[52:55], v[24:27]
    v_cvt_pk_bf16_f32 v28, v20, v21
    v_cvt_pk_bf16_f32 v29, v22, v23
    s_waitcnt lgkmcnt(0)
    v_mfma_f32_16x16x32_f16 v[24:27], v[96:99], v[120:123], v[24:27]
    v_min_u32 v28, -2, v28
    v_min_u32 v29, -2, v29
    ds_read_u8 v18, v4 offset:163
    ds_read_b128 v[20:23], v12 offset:49664
    s_nop 3
    v_mul_f32 v24, v24, v16
    v_mul_f32 v25, v25, v16
    v_mul_f32 v26, v26, v16
    v_mul_f32 v27, v27, v16
    v_cvt_pk_bf16_f32 v30, v24, v25
    v_cvt_pk_bf16_f32 v31, v26, v27
    v_lshlrev_b32 v24, 16, v30
    v_and_b32 v25, 0xffff0000, v30
    v_lshlrev_b32 v26, 16, v31
    v_and_b32 v27, 0xffff0000, v31
    v_add_f32 v24, v24, v108
    v_add_f32 v25, v25, v109
    v_add_f32 v26, v26, v110
    v_add_f32 v27, v27, v111
    v_cvt_pk_bf16_f32 v30, v24, v25
    v_cvt_pk_bf16_f32 v31, v26, v27
    v_min_u32 v30, -2, v30
    v_min_u32 v31, -2, v31
CVE_32:
    s_waitcnt lgkmcnt(0)
    s_cmp_lg_u32 s87, 1
    s_cbranch_scc1 ZA_43
    v_cmp_ne_u32 vcc, 1, v18
    s_cbranch_vccnz ZS_45
ZB_46:
    s_mov_b64 exec, s[12:13]
    v_swap_b32 v28, v20
    v_swap_b32 v29, v21
    v_swap_b32 v30, v22
    v_swap_b32 v31, v23
    s_mov_b64 exec, -1
    buffer_store_dwordx4 v[28:31], v6, s[64:67], s7 offen sc1
    buffer_store_dwordx4 v[20:23], v6, s[64:67], s6 offen sc1
    s_branch ZD_48
WS_35:
W_49:
    ds_read_b32 v18, v14 offset:76
    s_sub_u32 s39, s39, 1
    s_cbranch_scc1 KS_ABORT
    s_waitcnt lgkmcnt(0)
    v_cmp_ne_u32 vcc, s84, v18
    s_cbranch_vccnz W_49
    s_branch WB_36
WS_38:
W_50:
    ds_read_b32 v18, v14 offset:76
    s_sub_u32 s39, s39, 1
    s_cbranch_scc1 KS_ABORT
    s_waitcnt lgkmcnt(0)
    v_cmp_ne_u32 vcc, s84, v18
    s_cbranch_vccnz W_50
    s_branch WB_39
WS_41:
W_51:
    ds_read_b32 v18, v14 offset:76
    s_sub_u32 s39, s39, 1
    s_cbranch_scc1 KS_ABORT
    s_waitcnt lgkmcnt(0)
    v_cmp_ne_u32 vcc, s84, v18
    s_cbranch_vccnz W_51
    s_branch WB_42
ZS_45:
    v_mov_b32 v19, s86
ZW_52:
    ds_read_u8 v18, v19 offset:160
    s_sub_u32 s39, s39, 1
    s_cbranch_scc1 KS_ABORT
    s_waitcnt lgkmcnt(0)
    v_cmp_ne_u32 vcc, 1, v18
    s_cbranch_vccnz ZW_52
    v_lshl_add_u32 v19, v19, 10, v12
    ds_read_b128 v[20:23], v19 offset:46592
    s_waitcnt lgkmcnt(0)
    s_branch ZB_46
ZA_43:
    s_cmp_lg_u32 s87, 0
    s_cbranch_scc1 ZC_44
    v_mov_b32 v19, s86
    v_lshl_add_u32 v18, v19, 10, v12
    ds_write_b128 v18, v[28:31] offset:46592
    ds_write_b8 v19, v5 offset:160
    s_branch ZD_48
ZC_44:
    buffer_store_dwordx4 v[28:31], v6, s[64:67], s6 offen sc1
ZD_48:
    s_lshl_b32 s92, s87, 2
    s_add_u32 s92, s92, s86
    v_mov_b32 v8, s92
    s_waitcnt vmcnt(0)
    ds_write_b8 v8, v5 offset:48
    s_cmp_lt_u32 s41, 18
    s_cbranch_scc1 KS_T
    s_waitcnt lgkmcnt(0)
    s_endpgm
KS_X:
    s_cmp_lt_u32 s41, 24
    s_cbranch_scc1 KS_X2
    s_setprio 2
KS_XC:
    s_mov_b32 s87, 2
    s_add_u32 s86, s38, 3
    s_and_b32 s86, s86, 3
    s_lshl_b32 s88, s40, 3
    s_and_b32 s92, s41, 7
    s_add_u32 s88, s88, s92
    s_add_u32 s88, s88, 512
    s_lshl_b32 s92, s86, 11
    s_add_u32 s92, s92, 146048
    v_lshl_add_u32 v28, v1, 3, s92
    s_branch KS_GRP
KS_X2:
    s_cmp_lt_u32 s41, 8
    s_cbranch_scc1 KS_X3
    s_sub_u32 s97, s38, 8
    s_branch KS_LN1
KS_X3:
    s_lshl_b32 s92, s2, 4
    s_add_u32 s92, s92, s38
    s_cmp_lg_u32 s92, 44
    s_cbranch_scc1 KS_X3B
    s_setprio 3
    s_memrealtime s[92:93]
    v_and_b32 v6, 3, v1
    v_lshlrev_b32 v7, 2, v6
    v_min_u32 v6, 2, v6
    v_lshlrev_b32 v6, 2, v6
    v_cmp_eq_u32 vcc, 3, v1
    s_waitcnt lgkmcnt(0)
    v_mov_b32 v8, s92
    v_mov_b32 v9, s93
    v_alignbit_b32 v8, v8, v8, v6
    v_cndmask_b32 v9, v4, v9, vcc
    v_xor_b32 v8, v8, v9
    v_and_b32 v9, 0xf0000fff, v8
    v_and_b32 v10, 0xfff000, v8
    v_lshl_or_b32 v9, v10, 4, v9
    v_lshrrev_b32 v10, 12, v8
    v_and_b32 v10, 0xf000, v10
    v_or3_b32 v9, v9, v10, v9
    v_or_b32 v9, 0x80000000, v9
    s_mov_b64 exec, 15
    global_store_dword v7, v9, s[34:35] sc1
    s_mov_b64 exec, -1
    s_setprio 0
KS_X3B:
    s_setprio 3
    s_branch KS_XC
    s_waitcnt lgkmcnt(0)
    s_barrier
    s_branch KS_G
KS_X4:
    s_cmp_lt_u32 s41, 18
    s_cbranch_scc1 KS_G
    s_waitcnt vmcnt(0) lgkmcnt(0)
    s_endpgm
KS_L:
    v_lshlrev_b32 v6, 2, v0
    ds_write_b32 v6, v4
    v_mov_b32 v8, 0
    v_mov_b32 v9, 0
    s_min_u32 s92, s38, 2
    s_mul_i32 s92, s92, 4672
    v_min_u32 v6, 59, v1
    v_lshl_add_u32 v6, v6, 3, s92
    ds_write_b64 v6, v[8:9] offset:3072
    s_mov_b32 s97, s38
    s_sub_u32 s92, s41, 8
    s_cmp_lt_u32 s92, 16
    s_cbranch_scc0 KS_L0
KS_LN1:
    s_setprio 3
    s_sub_u32 s92, s41, 8
    s_and_b32 s88, s92, 7
    s_lshr_b32 s92, s92, 3
    s_lshl_b32 s92, s92, 4
    s_add_u32 s88, s88, s92
    s_and_b32 s92, s40, 1
    s_lshl_b32 s92, s92, 3
    s_add_u32 s88, s88, s92
    s_lshr_b32 s92, s40, 1
    s_lshl_b32 s92, s92, 5
    s_add_u32 s88, s88, s92
    v_lshrrev_b32 v36, 5, v1
    v_and_b32 v37, 31, v1
    v_mul_u32_u24 v38, 1152, v36
    v_lshl_add_u32 v39, v37, 2, v38
    v_lshl_add_u32 v38, v37, 4, v38
    s_mul_i32 s93, s88, 18432
    s_mul_i32 s94, s97, 2304
    s_add_u32 s93, s93, s94
    s_waitcnt lgkmcnt(0)
    s_mov_b32 s64, s4
    s_mov_b32 s65, s5
    s_mov_b32 s66, 0x240000
    s_mov_b32 s67, 0x20000
    buffer_load_dwordx4 v[26:29], v38, s[64:67], s93 offen
    buffer_load_dwordx4 v[30:33], v38, s[64:67], s93 offen offset:512
    buffer_load_dword v34, v39, s[64:67], s93 offen offset:1024
    s_barrier
    s_lshr_b32 s93, s97, 2
    s_lshl_b32 s93, s93, 6
    s_add_u32 s94, s94, s93
    s_add_u32 s94, s94, 17088
    v_lshl_add_u32 v35, v37, 1, v36
    s_mov_b32 s98, 0x05040100
    s_mov_b32 s99, 0x07060302
    s_cmp_lt_u32 s97, 4
    s_cbranch_scc1 LN1A_53
    s_cmp_ge_u32 s41, 18
    s_cbranch_scc1 LN1A_53
    s_mov_b32 s68, s30
    s_mov_b32 s69, s31
    s_mov_b32 s70, 0x510000
    s_mov_b32 s71, 0x20000
    v_lshlrev_b32 v46, 4, v1
    s_mul_i32 s92, s89, 36864
    s_mul_i32 s93, s97, 9216
    s_add_u32 s92, s92, s93
    s_sub_u32 s92, s92, 36864
    s_add_u32 s93, s93, 72320
    s_add_u32 m0, s93, 0
    s_nop 0
    buffer_load_dwordx4 v46, s[68:71], s92 offen offset:0 nt lds
    buffer_load_dwordx4 v46, s[68:71], s92 offen offset:1024 nt lds
    buffer_load_dwordx4 v46, s[68:71], s92 offen offset:2048 nt lds
    buffer_load_dwordx4 v46, s[68:71], s92 offen offset:3072 nt lds
    s_add_u32 m0, s93, 4096
    s_add_u32 s92, s92, 4096
    buffer_load_dwordx4 v46, s[68:71], s92 offen offset:0 nt lds
    buffer_load_dwordx4 v46, s[68:71], s92 offen offset:1024 nt lds
    buffer_load_dwordx4 v46, s[68:71], s92 offen offset:2048 nt lds
    buffer_load_dwordx4 v46, s[68:71], s92 offen offset:3072 nt lds
    s_add_u32 m0, s93, 8192
    s_add_u32 s92, s92, 4096
    buffer_load_dwordx4 v46, s[68:71], s92 offen offset:0 nt lds
    s_waitcnt vmcnt(11)
    v_lshlrev_b32 v8, 16, v26
    v_and_b32 v9, 0xffff0000, v26
    v_lshlrev_b32 v10, 16, v27
    v_and_b32 v11, 0xffff0000, v27
    v_lshlrev_b32 v12, 16, v28
    v_and_b32 v13, 0xffff0000, v28
    v_lshlrev_b32 v14, 16, v29
    v_and_b32 v15, 0xffff0000, v29
    s_waitcnt vmcnt(10)
    v_lshlrev_b32 v16, 16, v30
    v_and_b32 v17, 0xffff0000, v30
    v_lshlrev_b32 v18, 16, v31
    v_and_b32 v19, 0xffff0000, v31
    v_lshlrev_b32 v20, 16, v32
    v_and_b32 v21, 0xffff0000, v32
    v_lshlrev_b32 v22, 16, v33
    v_and_b32 v23, 0xffff0000, v33
    s_waitcnt vmcnt(9)
    v_lshlrev_b32 v24, 16, v34
    v_and_b32 v25, 0xffff0000, v34
    s_branch LN1B_54
LN1A_53:
    s_waitcnt vmcnt(2)
    v_lshlrev_b32 v8, 16, v26
    v_and_b32 v9, 0xffff0000, v26
    v_lshlrev_b32 v10, 16, v27
    v_and_b32 v11, 0xffff0000, v27
    v_lshlrev_b32 v12, 16, v28
    v_and_b32 v13, 0xffff0000, v28
    v_lshlrev_b32 v14, 16, v29
    v_and_b32 v15, 0xffff0000, v29
    s_waitcnt vmcnt(1)
    v_lshlrev_b32 v16, 16, v30
    v_and_b32 v17, 0xffff0000, v30
    v_lshlrev_b32 v18, 16, v31
    v_and_b32 v19, 0xffff0000, v31
    v_lshlrev_b32 v20, 16, v32
    v_and_b32 v21, 0xffff0000, v32
    v_lshlrev_b32 v22, 16, v33
    v_and_b32 v23, 0xffff0000, v33
    s_waitcnt vmcnt(0)
    v_lshlrev_b32 v24, 16, v34
    v_and_b32 v25, 0xffff0000, v34
    s_nop 1
LN1B_54:
    v_lshl_add_u32 v6, v35, 4, s94
    v_lshl_add_u32 v7, v35, 2, s94
    v_mul_u32_u24 v35, 0x20202, v36
    v_lshl_add_u32 v35, v36, 25, v35
    v_add_u32 v35, 0x05040100, v35
    v_pk_add_f32 v[40:41], v[8:9], v[10:11]
    v_pk_add_f32 v[42:43], v[12:13], v[14:15]
    v_pk_add_f32 v[40:41], v[40:41], v[16:17]
    v_pk_add_f32 v[42:43], v[42:43], v[18:19]
    v_pk_add_f32 v[40:41], v[40:41], v[20:21]
    v_pk_add_f32 v[42:43], v[42:43], v[22:23]
    v_pk_add_f32 v[40:41], v[40:41], v[24:25]
    v_pk_add_f32 v[40:41], v[40:41], v[42:43]
    v_add_f32 v40, v40, v41
    s_nop 1
    v_add_f32_dpp v40, v40, v40 row_ror:8 row_mask:0xf bank_mask:0xf
    s_nop 1
    v_add_f32_dpp v40, v40, v40 row_ror:4 row_mask:0xf bank_mask:0xf
    s_nop 1
    v_add_f32_dpp v40, v40, v40 row_ror:2 row_mask:0xf bank_mask:0xf
    s_nop 1
    v_add_f32_dpp v40, v40, v40 row_ror:1 row_mask:0xf bank_mask:0xf
    v_mov_b32 v42, v40
    s_nop 1
    v_permlane16_swap_b32 v40, v42
    v_add_f32 v40, v40, v42
    v_mul_f32 v44, 0x3ae38e39, v40
    v_mov_b32 v45, v44
    v_cvt_pk_bf16_f32 v36, v44, v44
    v_and_b32 v36, 0xffff0000, v36
    v_mov_b32 v37, v36
    v_pk_add_f32 v[38:39], v[8:9], v[44:45] neg_lo:[0,1] neg_hi:[0,1]
    v_pk_mul_f32 v[40:41], v[38:39], v[38:39]
    v_pk_add_f32 v[38:39], v[10:11], v[44:45] neg_lo:[0,1] neg_hi:[0,1]
    v_pk_mul_f32 v[42:43], v[38:39], v[38:39]
    v_pk_add_f32 v[38:39], v[12:13], v[44:45] neg_lo:[0,1] neg_hi:[0,1]
    v_pk_fma_f32 v[40:41], v[38:39], v[38:39], v[40:41]
    v_pk_add_f32 v[38:39], v[14:15], v[44:45] neg_lo:[0,1] neg_hi:[0,1]
    v_pk_fma_f32 v[42:43], v[38:39], v[38:39], v[42:43]
    v_pk_add_f32 v[38:39], v[16:17], v[44:45] neg_lo:[0,1] neg_hi:[0,1]
    v_pk_fma_f32 v[40:41], v[38:39], v[38:39], v[40:41]
    v_pk_add_f32 v[38:39], v[18:19], v[44:45] neg_lo:[0,1] neg_hi:[0,1]
    v_pk_fma_f32 v[42:43], v[38:39], v[38:39], v[42:43]
    v_pk_add_f32 v[38:39], v[20:21], v[44:45] neg_lo:[0,1] neg_hi:[0,1]
    v_pk_fma_f32 v[40:41], v[38:39], v[38:39], v[40:41]
    v_pk_add_f32 v[38:39], v[22:23], v[44:45] neg_lo:[0,1] neg_hi:[0,1]
    v_pk_fma_f32 v[42:43], v[38:39], v[38:39], v[42:43]
    v_pk_add_f32 v[38:39], v[24:25], v[44:45] neg_lo:[0,1] neg_hi:[0,1]
    v_pk_fma_f32 v[40:41], v[38:39], v[38:39], v[40:41]
    v_pk_add_f32 v[40:41], v[40:41], v[42:43]
    v_add_f32 v40, v40, v41
    s_nop 1
    v_add_f32_dpp v40, v40, v40 row_ror:8 row_mask:0xf bank_mask:0xf
    s_nop 1
    v_add_f32_dpp v40, v40, v40 row_ror:4 row_mask:0xf bank_mask:0xf
    s_nop 1
    v_add_f32_dpp v40, v40, v40 row_ror:2 row_mask:0xf bank_mask:0xf
    s_nop 1
    v_add_f32_dpp v40, v40, v40 row_ror:1 row_mask:0xf bank_mask:0xf
    v_mov_b32 v42, v40
    s_nop 1
    v_permlane16_swap_b32 v40, v42
    v_add_f32 v40, v40, v42
    v_mul_f32 v40, 0x3ae38e39, v40
    v_cvt_pk_bf16_f32 v40, v40, v40
    v_and_b32 v40, 0xffff0000, v40
    v_add_f32 v40, 0x3727c5ac, v40
    v_cvt_pk_bf16_f32 v40, v40, v40
    v_and_b32 v40, 0xffff0000, v40
    v_sqrt_f32 v40, v40
    s_nop 0
    v_cvt_pk_bf16_f32 v40, v40, v40
    v_and_b32 v40, 0xffff0000, v40
    v_rcp_f32 v38, v40
    s_nop 0
    v_mov_b32 v39, v38
    v_pk_add_f32 v[40:41], v[8:9], v[36:37] neg_lo:[0,1] neg_hi:[0,1]
    v_cvt_pk_bf16_f32 v42, v40, v41
    v_lshlrev_b32 v40, 16, v42
    v_and_b32 v41, 0xffff0000, v42
    v_pk_mul_f32 v[40:41], v[40:41], v[38:39]
    v_cvt_pk_bf16_f32 v42, v40, v41
    v_lshlrev_b32 v40, 16, v42
    v_and_b32 v41, 0xffff0000, v42
    v_cvt_pk_f16_f32 v26, v40, v41
    v_pk_add_f32 v[40:41], v[10:11], v[36:37] neg_lo:[0,1] neg_hi:[0,1]
    v_cvt_pk_bf16_f32 v42, v40, v41
    v_lshlrev_b32 v40, 16, v42
    v_and_b32 v41, 0xffff0000, v42
    v_pk_mul_f32 v[40:41], v[40:41], v[38:39]
    v_cvt_pk_bf16_f32 v42, v40, v41
    v_lshlrev_b32 v40, 16, v42
    v_and_b32 v41, 0xffff0000, v42
    v_cvt_pk_f16_f32 v27, v40, v41
    v_pk_add_f32 v[40:41], v[12:13], v[36:37] neg_lo:[0,1] neg_hi:[0,1]
    v_cvt_pk_bf16_f32 v42, v40, v41
    v_lshlrev_b32 v40, 16, v42
    v_and_b32 v41, 0xffff0000, v42
    v_pk_mul_f32 v[40:41], v[40:41], v[38:39]
    v_cvt_pk_bf16_f32 v42, v40, v41
    v_lshlrev_b32 v40, 16, v42
    v_and_b32 v41, 0xffff0000, v42
    v_cvt_pk_f16_f32 v28, v40, v41
    v_and_b32 v59, 3, v1
    v_lshlrev_b32 v59, 2, v59
    global_load_dword v58, v59, s[34:35] sc1
    v_pk_add_f32 v[40:41], v[14:15], v[36:37] neg_lo:[0,1] neg_hi:[0,1]
    v_cvt_pk_bf16_f32 v42, v40, v41
    v_lshlrev_b32 v40, 16, v42
    v_and_b32 v41, 0xffff0000, v42
    v_pk_mul_f32 v[40:41], v[40:41], v[38:39]
    v_cvt_pk_bf16_f32 v42, v40, v41
    v_lshlrev_b32 v40, 16, v42
    v_and_b32 v41, 0xffff0000, v42
    v_cvt_pk_f16_f32 v29, v40, v41
    v_permlane32_swap_b32 v26, v28
    s_nop 0
    v_permlane32_swap_b32 v27, v29
    v_perm_b32 v8, v28, v26, s98
    v_perm_b32 v9, v28, v26, s99
    v_perm_b32 v10, v29, v27, s98
    v_perm_b32 v11, v29, v27, s99
    ds_write_b128 v6, v[8:11] offset:0
    v_pk_add_f32 v[40:41], v[16:17], v[36:37] neg_lo:[0,1] neg_hi:[0,1]
    v_cvt_pk_bf16_f32 v42, v40, v41
    v_lshlrev_b32 v40, 16, v42
    v_and_b32 v41, 0xffff0000, v42
    v_pk_mul_f32 v[40:41], v[40:41], v[38:39]
    v_cvt_pk_bf16_f32 v42, v40, v41
    v_lshlrev_b32 v40, 16, v42
    v_and_b32 v41, 0xffff0000, v42
    v_cvt_pk_f16_f32 v30, v40, v41
    v_pk_add_f32 v[40:41], v[18:19], v[36:37] neg_lo:[0,1] neg_hi:[0,1]
    v_cvt_pk_bf16_f32 v42, v40, v41
    v_lshlrev_b32 v40, 16, v42
    v_and_b32 v41, 0xffff0000, v42
    v_pk_mul_f32 v[40:41], v[40:41], v[38:39]
    v_cvt_pk_bf16_f32 v42, v40, v41
    v_lshlrev_b32 v40, 16, v42
    v_and_b32 v41, 0xffff0000, v42
    v_cvt_pk_f16_f32 v31, v40, v41
    v_pk_add_f32 v[40:41], v[20:21], v[36:37] neg_lo:[0,1] neg_hi:[0,1]
    v_cvt_pk_bf16_f32 v42, v40, v41
    v_lshlrev_b32 v40, 16, v42
    v_and_b32 v41, 0xffff0000, v42
    v_pk_mul_f32 v[40:41], v[40:41], v[38:39]
    v_cvt_pk_bf16_f32 v42, v40, v41
    v_lshlrev_b32 v40, 16, v42
    v_and_b32 v41, 0xffff0000, v42
    v_cvt_pk_f16_f32 v32, v40, v41
    v_pk_add_f32 v[40:41], v[22:23], v[36:37] neg_lo:[0,1] neg_hi:[0,1]
    v_cvt_pk_bf16_f32 v42, v40, v41
    v_lshlrev_b32 v40, 16, v42
    v_and_b32 v41, 0xffff0000, v42
    v_pk_mul_f32 v[40:41], v[40:41], v[38:39]
    v_cvt_pk_bf16_f32 v42, v40, v41
    v_lshlrev_b32 v40, 16, v42
    v_and_b32 v41, 0xffff0000, v42
    v_cvt_pk_f16_f32 v33, v40, v41
    v_permlane32_swap_b32 v30, v32
    s_nop 0
    v_permlane32_swap_b32 v31, v33
    v_perm_b32 v16, v32, v30, s98
    v_perm_b32 v17, v32, v30, s99
    v_perm_b32 v18, v33, v31, s98
    v_perm_b32 v19, v33, v31, s99
    ds_write_b128 v6, v[16:19] offset:1024
    v_pk_add_f32 v[40:41], v[24:25], v[36:37] neg_lo:[0,1] neg_hi:[0,1]
    v_cvt_pk_bf16_f32 v42, v40, v41
    v_lshlrev_b32 v40, 16, v42
    v_and_b32 v41, 0xffff0000, v42
    v_pk_mul_f32 v[40:41], v[40:41], v[38:39]
    v_cvt_pk_bf16_f32 v42, v40, v41
    v_lshlrev_b32 v40, 16, v42
    v_and_b32 v41, 0xffff0000, v42
    v_cvt_pk_f16_f32 v34, v40, v41
    v_mov_b32 v40, v34
    s_nop 1
    v_permlane32_swap_b32 v34, v40
    v_perm_b32 v40, v40, v34, v35
    ds_write_b32 v7, v40 offset:2048
    v_mov_b32 v6, s97
    ds_write_b8 v6, v5 offset:0
    s_setprio 0
    s_cmp_ge_u32 s97, 4
    s_cbranch_scc1 KS_X4
    s_setprio 3
    s_mov_b32 s72, s36
    s_mov_b32 s73, s37
    s_mov_b32 s74, 0x240000
    s_mov_b32 s75, 0x20000
    v_and_b32 v6, 1, v0
    v_mul_u32_u24 v6, 9280, v6
    v_lshrrev_b32 v7, 1, v0
    v_lshl_add_u32 v6, v7, 2, v6
    v_add_u32 v6, 17088, v6
    v_lshrrev_b32 v7, 2, v0
    v_mul_u32_u24 v7, 0x2080, v7
    v_and_b32 v8, 3, v0
    v_lshl_add_u32 v7, v8, 4, v7
    s_lshl_b32 s92, s88, 6
    v_xor_b32 v7, s92, v7
    s_mov_b32 s92, 0
    s_add_u32 s93, s92, 524288
    s_add_u32 s94, s92, 1048576
    s_add_u32 s95, s92, 1572864
    s_add_u32 s96, s92, 2097152
    s_waitcnt vmcnt(0)
DBP_55:
    v_cmp_eq_u32 vcc, 0, v58
    s_cbranch_vccz DBG_56
    s_sleep 1
    global_load_dword v58, v59, s[34:35] sc1
    s_sub_u32 s39, s39, 1
    s_cbranch_scc1 KS_ABORT
    s_waitcnt vmcnt(0)
    s_branch DBP_55
DBG_56:
    ds_write_b32 v59, v58 offset:224
    s_mov_b32 s98, 0x70007
    v_lshrrev_b32 v57, 3, v58
    v_lshrrev_b32 v56, 6, v58
    v_lshrrev_b32 v55, 9, v58
W_57:
    ds_read_b64 v[20:21], v4 offset:0
    s_sub_u32 s39, s39, 1
    s_cbranch_scc1 KS_ABORT
    s_waitcnt lgkmcnt(0)
    v_and_b32 v20, v20, v21
    v_cmp_ne_u32 vcc, s84, v20
    s_cbranch_vccnz W_57
    ds_read2st64_b32 v[20:21], v6 offset0:0 offset1:9
    ds_read2st64_b32 v[22:23], v6 offset0:18 offset1:27
    ds_read2st64_b32 v[24:25], v6 offset0:2 offset1:11
    ds_read2st64_b32 v[26:27], v6 offset0:20 offset1:29
    ds_read2st64_b32 v[28:29], v6 offset0:4 offset1:13
    ds_read2st64_b32 v[30:31], v6 offset0:22 offset1:31
    ds_read2st64_b32 v[32:33], v6 offset0:6 offset1:15
    ds_read2st64_b32 v[34:35], v6 offset0:24 offset1:33
    ds_read2st64_b32 v[36:37], v6 offset0:8 offset1:17
    ds_read2st64_b32 v[38:39], v6 offset0:26 offset1:35
    s_waitcnt lgkmcnt(8)
    v_bfi_b32 v20, s98, v58, v20
    v_bfi_b32 v21, s98, v57, v21
    v_bfi_b32 v22, s98, v56, v22
    v_bfi_b32 v23, s98, v55, v23
    buffer_store_dwordx4 v[20:23], v7, s[72:75], s92 offen sc1
    s_waitcnt lgkmcnt(6)
    v_bfi_b32 v24, s98, v58, v24
    v_bfi_b32 v25, s98, v57, v25
    v_bfi_b32 v26, s98, v56, v26
    v_bfi_b32 v27, s98, v55, v27
    buffer_store_dwordx4 v[24:27], v7, s[72:75], s93 offen sc1
    s_waitcnt lgkmcnt(4)
    v_bfi_b32 v28, s98, v58, v28
    v_bfi_b32 v29, s98, v57, v29
    v_bfi_b32 v30, s98, v56, v30
    v_bfi_b32 v31, s98, v55, v31
    buffer_store_dwordx4 v[28:31], v7, s[72:75], s94 offen sc1
    s_waitcnt lgkmcnt(2)
    v_bfi_b32 v32, s98, v58, v32
    v_bfi_b32 v33, s98, v57, v33
    v_bfi_b32 v34, s98, v56, v34
    v_bfi_b32 v35, s98, v55, v35
    buffer_store_dwordx4 v[32:35], v7, s[72:75], s95 offen sc1
    s_waitcnt lgkmcnt(0)
    v_bfi_b32 v36, s98, v58, v36
    v_bfi_b32 v37, s98, v57, v37
    v_bfi_b32 v38, s98, v56, v38
    v_bfi_b32 v39, s98, v55, v39
    buffer_store_dwordx4 v[36:39], v7, s[72:75], s96 offen sc1
    v_mov_b32 v6, s97
    ds_write_b8 v6, v5 offset:200
    v_mul_u32_u24 v46, 57, v1
    v_lshrrev_b32 v46, 9, v46
    v_mul_u32_u24 v47, 9, v46
    v_sub_u32 v47, v1, v47
    v_mul_u32_u24 v46, 9216, v46
    v_lshl_add_u32 v46, v47, 7, v46
    s_cmp_ge_u32 s41, 18
    s_cbranch_scc1 KS_LL2
    s_branch KS_LLE
KS_LL2:
    s_mul_i32 s94, s38, 6
    s_add_u32 s94, s94, s41
    s_sub_u32 s94, s94, 18
    s_bitcmp1_b32 s94, 0
    s_cselect_b32 s72, s28, s26
    s_cselect_b32 s73, s29, s27
    s_mov_b32 s74, 0x510000
    s_mov_b32 s75, 0x20000
    s_lshr_b32 s95, s94, 1
    s_mul_i32 s95, s95, 64512
    s_mul_i32 s96, s40, 1152
    s_add_u32 s95, s95, s96
    s_add_u32 s96, s95, 2644992
    buffer_load_dword v47, v46, s[72:75], s96 offen nt
    buffer_load_dword v47, v46, s[72:75], s96 offen sc1
KS_LLE:
    s_mov_b32 s87, 1
    s_branch KS_L2B
KS_L0:
    s_and_b32 s92, s41, 15
    s_lshl_b32 s93, s40, 4
    s_add_u32 s92, s92, s93
    v_and_b32 v59, 3, v1
    v_lshlrev_b32 v59, 2, v59
    s_lshl_b32 s96, s92, 6
    s_add_u32 s93, s96, 0xb00000
    v_add_u32 v7, s93, v59
    s_mul_i32 s93, s92, 18560
    s_add_u32 s93, s93, 0x600000
    v_lshlrev_b32 v6, 4, v0
    v_mov_b32 v12, -1
    v_mov_b32 v13, -1
    v_mov_b32 v14, -1
    v_mov_b32 v15, -1
    s_setprio 3
    v_mul_u32_u24 v16, 57, v1
    v_lshrrev_b32 v16, 9, v16
    v_mul_u32_u24 v17, 9, v16
    v_sub_u32 v17, v1, v17
    v_mul_u32_u24 v16, 9216, v16
    v_lshl_add_u32 v16, v17, 7, v16
    s_waitcnt lgkmcnt(0)
    s_add_u32 s68, s36, s93
    s_addc_u32 s69, s37, 0
    s_mov_b32 s70, 18560
    s_mov_b32 s71, 0x20000
    s_barrier
W_58:
    s_sleep 2
    ds_read_b32 v8, v4 offset:36
    s_sub_u32 s39, s39, 1
    s_cbranch_scc1 KS_ABORT
    s_waitcnt lgkmcnt(0)
    v_cmp_eq_u32 vcc, 0, v8
    s_cbranch_vccnz W_58
    s_movk_i32 s92, 0
    buffer_store_dwordx4 v[12:15], v6, s[68:71], s92 offen sc1
    s_movk_i32 s92, 4096
    buffer_store_dwordx4 v[12:15], v6, s[68:71], s92 offen sc1
    s_movk_i32 s92, 8192
    buffer_store_dwordx4 v[12:15], v6, s[68:71], s92 offen sc1
    s_movk_i32 s92, 12288
    buffer_store_dwordx4 v[12:15], v6, s[68:71], s92 offen sc1
    s_movk_i32 s92, 16384
    buffer_store_dwordx4 v[12:15], v6, s[68:71], s92 offen sc1
    global_load_dword v58, v59, s[34:35] sc1
    s_waitcnt vmcnt(0)
DBP_59:
    v_cmp_eq_u32 vcc, 0, v58
    s_cbranch_vccz DBG_60
    s_sleep 1
    global_load_dword v58, v59, s[34:35] sc1
    s_sub_u32 s39, s39, 1
    s_cbranch_scc1 KS_ABORT
    s_waitcnt vmcnt(0)
    s_branch DBP_59
DBG_60:
    ds_write_b32 v59, v58 offset:224
    s_mov_b64 exec, 1
    ds_add_rtn_u32 v8, v4, v5 offset:8
    s_mov_b64 exec, -1
    v_lshrrev_b32 v57, 3, v58
    v_lshrrev_b32 v56, 6, v58
    v_lshrrev_b32 v55, 9, v58
    s_waitcnt lgkmcnt(0)
    v_readfirstlane_b32 s92, v8
    s_cmp_lg_u32 s92, 3
    s_cbranch_scc1 KS_L2
    s_mov_b64 exec, 15
    global_store_dword v7, v58, s[36:37] sc1
    s_mov_b64 exec, -1
    s_and_b32 s94, s41, 7
    s_cmp_ge_u32 s41, 8
    s_cbranch_scc1 KS_L1C
    s_branch KS_L2
KS_L1C:
    s_bitcmp1_b32 s94, 0
    s_cselect_b32 s72, s28, s26
    s_cselect_b32 s73, s29, s27
    s_mov_b32 s74, 0x510000
    s_mov_b32 s75, 0x20000
    s_lshr_b32 s95, s94, 1
    s_mul_i32 s95, s95, 64512
    s_mul_i32 s96, s40, 1152
    s_add_u32 s95, s95, s96
    s_add_u32 s96, s95, 3419136
    buffer_load_dword v18, v16, s[72:75], s96 offen nt
    buffer_load_dword v18, v16, s[72:75], s96 offen sc1
    s_add_u32 s96, s95, 3677184
    buffer_load_dword v18, v16, s[72:75], s96 offen nt
    buffer_load_dword v18, v16, s[72:75], s96 offen sc1
    s_add_u32 s96, s95, 3935232
    buffer_load_dword v18, v16, s[72:75], s96 offen nt
    buffer_load_dword v18, v16, s[72:75], s96 offen sc1
    s_add_u32 s96, s95, 4193280
    buffer_load_dword v18, v16, s[72:75], s96 offen nt
    buffer_load_dword v18, v16, s[72:75], s96 offen sc1
KS_L2:
    s_mov_b32 s87, 0
KS_L2B:
    s_mov_b32 s64, s36
    s_mov_b32 s65, s37
    s_mov_b32 s66, 0x240000
    s_mov_b32 s67, 0x20000
    v_lshrrev_b32 v7, 1, v1
    v_lshlrev_b32 v7, 6, v7
    v_and_b32 v10, 1, v1
    v_lshl_add_u32 v7, v10, 4, v7
    v_lshlrev_b32 v9, 4, v1
    s_lshl_b32 s92, s38, 11
    s_lshl_b32 s93, s90, 13
    s_add_u32 s93, s93, s92
    s_lshl_b32 s94, s90, 7
    s_and_b32 s95, s94, 0x380
    v_xor_b32 v13, s95, v9
    s_and_b32 s94, s94, 0x1c00
    s_xor_b32 s93, s93, s94
    s_xor_b32 s97, s93, 0x400
    s_lshl_b32 s95, s40, 3
    s_add_u32 s95, s95, s41
    s_add_u32 s95, s95, 488
    s_lshr_b32 s96, s95, 1
    s_lshl_b32 s96, s96, 13
    s_and_b32 s95, s95, 1
    s_lshl_b32 s95, s95, 5
    s_add_u32 s95, s95, s96
    s_add_u32 s95, s95, s92
    s_lshr_b32 s96, s96, 6
    s_and_b32 s94, s96, 0x780
    v_xor_b32 v7, s94, v7
    s_and_b32 s96, s96, 0x1800
    s_xor_b32 s95, s95, s96
    s_cmp_lt_u32 s41, 24
    s_cselect_b32 s95, 2359296, s95
    s_cselect_b32 s94, 0, 0x70007
    v_mov_b32_dpp v64, v58 quad_perm:[0,1,0,1] row_mask:0xf bank_mask:0xf
    v_mov_b32_dpp v65, v58 quad_perm:[2,3,2,3] row_mask:0xf bank_mask:0xf
    s_bitcmp1_b32 s41, 0
    s_cselect_b64 vcc, -1, 0
    v_cndmask_b32 v64, v64, v65, vcc
    v_and_b32 v60, 0x70007, v58
    v_and_b32 v61, 0x70007, v57
    v_and_b32 v62, 0x70007, v56
    v_and_b32 v63, 0x70007, v55
    v_lshrrev_b32 v67, 9, v64
    v_lshrrev_b32 v66, 6, v64
    v_lshrrev_b32 v65, 3, v64
    v_and_b32 v64, s94, v64
    v_and_b32 v65, s94, v65
    v_and_b32 v66, s94, v66
    v_and_b32 v67, s94, v67
    s_lshl_b32 s96, s38, 10
    s_add_u32 s96, s96, 3552
    v_bfe_u32 v11, v1, 1, 1
    v_mul_u32_u24 v11, 4672, v11
    v_lshl_add_u32 v11, v10, 4, v11
    v_lshrrev_b32 v10, 2, v1
    v_lshl_add_u32 v11, v10, 5, v11
    v_add_u32 v11, s96, v11
    v_add_u32 v10, s96, v9
    v_mov_b32 v116, s38
    s_add_u32 s92, s92, 0xb00000
    v_lshrrev_b32 v12, 2, v1
    v_lshl_add_u32 v12, v12, 6, v59
    v_add_u32 v12, s92, v12
    s_cmp_lt_u32 s41, 8
    s_cselect_b32 s94, 20, 4
    s_cmp_ge_u32 s41, 24
    s_cselect_b32 s94, 24, s94
    v_mov_b32 v14, s94
    s_setprio 0
    s_waitcnt vmcnt(0)
    ds_write_b8 v116, v5 offset:204
W_61:
    s_sleep 2
    ds_read_b32 v8, v14 offset:64
    s_sub_u32 s39, s39, 1
    s_cbranch_scc1 KS_ABORT
    s_waitcnt lgkmcnt(0)
    v_cmp_ne_u32 vcc, s84, v8
    s_cbranch_vccnz W_61
    s_setprio 3
    s_branch UPE_63
UP_62:
    s_sleep 2
UPE_63:
    global_load_dword v32, v12, s[36:37] sc1
    global_load_dword v33, v12, s[36:37] offset:1024 sc1
    buffer_load_dwordx4 v[20:23], v13, s[64:67], s93 offen sc1
    buffer_load_dwordx4 v[24:27], v13, s[64:67], s97 offen sc1
    buffer_load_dwordx4 v[28:31], v7, s[64:67], s95 offen sc1
    s_sub_u32 s39, s39, 1
    s_cbranch_scc1 KS_ABORT
    s_waitcnt vmcnt(2)
    v_xor_b32 v32, v58, v32
    v_xor_b32 v33, v58, v33
    v_xor_b32 v20, v60, v20
    v_xor_b32 v21, v61, v21
    v_xor_b32 v22, v62, v22
    v_xor_b32 v23, v63, v23
    v_or3_b32 v44, v20, v21, v21
    v_or3_b32 v44, v22, v23, v44
    s_waitcnt vmcnt(1)
    v_xor_b32 v24, v60, v24
    v_xor_b32 v25, v61, v25
    v_xor_b32 v26, v62, v26
    v_xor_b32 v27, v63, v27
    v_or3_b32 v44, v24, v25, v44
    v_or3_b32 v44, v26, v27, v44
    s_waitcnt vmcnt(0)
    v_xor_b32 v28, v64, v28
    v_xor_b32 v29, v65, v29
    v_xor_b32 v30, v66, v30
    v_xor_b32 v31, v67, v31
    v_or3_b32 v44, v28, v29, v44
    v_or3_b32 v44, v30, v31, v44
    v_and_b32 v44, 0x70007, v44
    v_or3_b32 v44, v44, v32, v33
    v_cmp_ne_u32 vcc, 0, v44
    s_cbranch_vccnz UP_62
    ds_write_b128 v11, v[20:23]
    ds_write_b128 v11, v[24:27] offset:512
    ds_write_b128 v10, v[28:31] offset:9344
    ds_write_b8 v116, v5 offset:16
    s_cmp_eq_u32 s38, 2
    s_cbranch_scc1 WJ2_66
    s_add_u32 s92, s38, 1
    s_lshr_b32 s92, s92, 2
    s_cmp_eq_u32 s38, 1
    s_cselect_b32 s92, 2, s92
    s_lshl_b32 s92, s92, 10
    v_lshl_add_u32 v10, v1, 4, s92
    v_add_u32 v11, 35840, v10
W_67:
    ds_read_b32 v12, v4 offset:16
    s_sub_u32 s39, s39, 1
    s_cbranch_scc1 KS_ABORT
    s_waitcnt lgkmcnt(0)
    v_cmp_ne_u32 vcc, s84, v12
    s_cbranch_vccnz W_67
    s_setprio 3
    ds_read_b128 v[20:23], v10 offset:3520
    ds_read_b128 v[24:27], v10 offset:3536
    ds_read_b64 v[28:29], v10 offset:3552
    ds_read_b128 v[32:35], v10 offset:8192
    ds_read_b128 v[36:39], v10 offset:8208
    ds_read_b64 v[40:41], v10 offset:8224
    ds_read_b128 v[44:47], v10 offset:12864
    ds_read_b128 v[48:51], v10 offset:12880
    ds_read_b64 v[52:53], v10 offset:12896
    s_cmp_eq_u32 s38, 1
    s_cbranch_scc1 WJ1_65
    ds_read_b32 v12, v4 offset:68
    s_waitcnt lgkmcnt(7)
    v_alignbit_b32 v57, v22, v21, 16
    v_alignbit_b32 v58, v23, v22, 16
    v_alignbit_b32 v59, v24, v23, 16
    v_alignbit_b32 v60, v25, v24, 16
    v_alignbit_b32 v61, v26, v25, 16
    v_alignbit_b32 v62, v27, v26, 16
    v_alignbit_b32 v63, v28, v27, 16
    v_alignbit_b32 v64, v29, v28, 16
    v_pk_add_f16 v66, v57, v22
    v_pk_add_f16 v67, v58, v23
    v_pk_add_f16 v68, v59, v24
    v_pk_add_f16 v69, v60, v25
    v_pk_add_f16 v70, v61, v26
    v_pk_add_f16 v71, v62, v27
    v_pk_add_f16 v72, v63, v28
    v_pk_add_f16 v73, v64, v29
    v_pk_add_f16 v80, v66, v58
    v_pk_add_f16 v81, v67, v59
    v_pk_add_f16 v82, v68, v60
    v_pk_add_f16 v83, v69, v61
    v_pk_add_f16 v74, v67, v68
    v_pk_add_f16 v75, v68, v69
    v_pk_add_f16 v76, v69, v70
    v_pk_add_f16 v77, v70, v71
    v_pk_add_f16 v78, v71, v72
    v_pk_add_f16 v79, v72, v73
    s_waitcnt lgkmcnt(0)
    v_cmp_eq_u32 vcc, s84, v12
    s_cbranch_vccnz WJK_68
W_69:
    s_sleep 1
    ds_read_b32 v12, v4 offset:68
    s_sub_u32 s39, s39, 1
    s_cbranch_scc1 KS_ABORT
    s_waitcnt lgkmcnt(0)
    v_cmp_ne_u32 vcc, s84, v12
    s_cbranch_vccnz W_69
WJK_68:
    ds_write_b128 v11, v[80:83] offset:0
    v_pk_add_f16 v87, v22, v74
    v_pk_add_f16 v88, v23, v75
    v_pk_add_f16 v89, v24, v76
    v_pk_add_f16 v90, v25, v77
    v_pk_add_f16 v91, v26, v78
    ds_write_b128 v11, v[88:91] offset:3104
    v_pk_add_f16 v84, v70, v62
    v_pk_add_f16 v85, v71, v63
    v_pk_add_f16 v86, v72, v64
    v_pk_add_f16 v92, v74, v83
    v_pk_add_f16 v93, v75, v84
    v_pk_add_f16 v94, v76, v85
    v_pk_add_f16 v95, v77, v86
    ds_write_b128 v11, v[92:95] offset:6176
    v_pk_add_f16 v96, v87, v76
    v_pk_add_f16 v97, v88, v77
    v_pk_add_f16 v98, v89, v78
    v_pk_add_f16 v99, v90, v79
    ds_write_b128 v11, v[96:99] offset:8240
    ds_write_b8 v116, v5 offset:76
    ds_read_b32 v12, v4 offset:84
    v_alignbit_b32 v57, v34, v33, 16
    v_alignbit_b32 v58, v35, v34, 16
    v_alignbit_b32 v59, v36, v35, 16
    v_alignbit_b32 v60, v37, v36, 16
    v_alignbit_b32 v61, v38, v37, 16
    v_alignbit_b32 v62, v39, v38, 16
    v_alignbit_b32 v63, v40, v39, 16
    v_alignbit_b32 v64, v41, v40, 16
    v_pk_add_f16 v66, v57, v34
    v_pk_add_f16 v67, v58, v35
    v_pk_add_f16 v68, v59, v36
    v_pk_add_f16 v69, v60, v37
    v_pk_add_f16 v70, v61, v38
    v_pk_add_f16 v71, v62, v39
    v_pk_add_f16 v72, v63, v40
    v_pk_add_f16 v73, v64, v41
    v_pk_add_f16 v80, v66, v58
    v_pk_add_f16 v81, v67, v59
    v_pk_add_f16 v82, v68, v60
    v_pk_add_f16 v83, v69, v61
    v_pk_add_f16 v74, v67, v68
    v_pk_add_f16 v75, v68, v69
    v_pk_add_f16 v76, v69, v70
    v_pk_add_f16 v77, v70, v71
    v_pk_add_f16 v78, v71, v72
    v_pk_add_f16 v79, v72, v73
    s_waitcnt lgkmcnt(0)
    v_cmp_eq_u32 vcc, s84, v12
    s_cbranch_vccnz WJK_70
W_71:
    s_sleep 1
    ds_read_b32 v12, v4 offset:84
    s_sub_u32 s39, s39, 1
    s_cbranch_scc1 KS_ABORT
    s_waitcnt lgkmcnt(0)
    v_cmp_ne_u32 vcc, s84, v12
    s_cbranch_vccnz W_71
WJK_70:
    ds_write_b128 v11, v[80:83] offset:36672
    v_pk_add_f16 v87, v34, v74
    v_pk_add_f16 v88, v35, v75
    v_pk_add_f16 v89, v36, v76
    v_pk_add_f16 v90, v37, v77
    v_pk_add_f16 v91, v38, v78
    ds_write_b128 v11, v[88:91] offset:39776
    v_pk_add_f16 v84, v70, v62
    v_pk_add_f16 v85, v71, v63
    v_pk_add_f16 v86, v72, v64
    v_pk_add_f16 v92, v74, v83
    v_pk_add_f16 v93, v75, v84
    v_pk_add_f16 v94, v76, v85
    v_pk_add_f16 v95, v77, v86
    ds_write_b128 v11, v[92:95] offset:42848
    v_pk_add_f16 v96, v87, v76
    v_pk_add_f16 v97, v88, v77
    v_pk_add_f16 v98, v89, v78
    v_pk_add_f16 v99, v90, v79
    ds_write_b128 v11, v[96:99] offset:44912
    ds_write_b8 v116, v5 offset:92
    s_cmp_lt_u32 s41, 24
    s_cbranch_scc1 WJE_64
    ds_read_b32 v12, v4 offset:100
    v_alignbit_b32 v57, v46, v45, 16
    v_alignbit_b32 v58, v47, v46, 16
    v_alignbit_b32 v59, v48, v47, 16
    v_alignbit_b32 v60, v49, v48, 16
    v_alignbit_b32 v61, v50, v49, 16
    v_alignbit_b32 v62, v51, v50, 16
    v_alignbit_b32 v63, v52, v51, 16
    v_alignbit_b32 v64, v53, v52, 16
    v_pk_add_f16 v66, v57, v46
    v_pk_add_f16 v67, v58, v47
    v_pk_add_f16 v68, v59, v48
    v_pk_add_f16 v69, v60, v49
    v_pk_add_f16 v70, v61, v50
    v_pk_add_f16 v71, v62, v51
    v_pk_add_f16 v72, v63, v52
    v_pk_add_f16 v73, v64, v53
    v_pk_add_f16 v80, v66, v58
    v_pk_add_f16 v81, v67, v59
    v_pk_add_f16 v82, v68, v60
    v_pk_add_f16 v83, v69, v61
    v_pk_add_f16 v74, v67, v68
    v_pk_add_f16 v75, v68, v69
    v_pk_add_f16 v76, v69, v70
    v_pk_add_f16 v77, v70, v71
    v_pk_add_f16 v78, v71, v72
    v_pk_add_f16 v79, v72, v73
    s_waitcnt lgkmcnt(0)
    v_cmp_eq_u32 vcc, s84, v12
    s_cbranch_vccnz WJK_72
W_73:
    s_sleep 1
    ds_read_b32 v12, v4 offset:100
    s_sub_u32 s39, s39, 1
    s_cbranch_scc1 KS_ABORT
    s_waitcnt lgkmcnt(0)
    v_cmp_ne_u32 vcc, s84, v12
    s_cbranch_vccnz W_73
WJK_72:
    v_add_u32 v11, 73344, v11
    ds_write_b128 v11, v[80:83] offset:0
    v_pk_add_f16 v87, v46, v74
    v_pk_add_f16 v88, v47, v75
    v_pk_add_f16 v89, v48, v76
    v_pk_add_f16 v90, v49, v77
    v_pk_add_f16 v91, v50, v78
    ds_write_b128 v11, v[88:91] offset:3104
    v_pk_add_f16 v84, v70, v62
    v_pk_add_f16 v85, v71, v63
    v_pk_add_f16 v86, v72, v64
    v_pk_add_f16 v92, v74, v83
    v_pk_add_f16 v93, v75, v84
    v_pk_add_f16 v94, v76, v85
    v_pk_add_f16 v95, v77, v86
    ds_write_b128 v11, v[92:95] offset:6176
    v_pk_add_f16 v96, v87, v76
    v_pk_add_f16 v97, v88, v77
    v_pk_add_f16 v98, v89, v78
    v_pk_add_f16 v99, v90, v79
    ds_write_b128 v11, v[96:99] offset:8240
    ds_write_b8 v116, v5 offset:108
    s_branch WJE_64
WJ1_65:
    ds_read_b32 v12, v4 offset:68
    s_waitcnt lgkmcnt(7)
    v_alignbit_b32 v57, v22, v21, 16
    v_alignbit_b32 v58, v23, v22, 16
    v_alignbit_b32 v59, v24, v23, 16
    v_alignbit_b32 v60, v25, v24, 16
    v_alignbit_b32 v61, v26, v25, 16
    v_alignbit_b32 v62, v27, v26, 16
    v_alignbit_b32 v63, v28, v27, 16
    v_pk_add_f16 v66, v57, v22
    v_pk_add_f16 v67, v58, v23
    v_pk_add_f16 v68, v59, v24
    v_pk_add_f16 v69, v60, v25
    v_pk_add_f16 v70, v61, v26
    v_pk_add_f16 v71, v62, v27
    v_pk_add_f16 v72, v63, v28
    v_pk_add_f16 v80, v66, v58
    v_pk_add_f16 v81, v67, v59
    v_pk_add_f16 v82, v68, v60
    v_pk_add_f16 v83, v69, v61
    v_pk_add_f16 v75, v68, v69
    v_pk_add_f16 v76, v69, v70
    v_pk_add_f16 v77, v70, v71
    v_pk_add_f16 v78, v71, v72
    s_waitcnt lgkmcnt(0)
    v_cmp_eq_u32 vcc, s84, v12
    s_cbranch_vccnz WJK_74
W_75:
    s_sleep 1
    ds_read_b32 v12, v4 offset:68
    s_sub_u32 s39, s39, 1
    s_cbranch_scc1 KS_ABORT
    s_waitcnt lgkmcnt(0)
    v_cmp_ne_u32 vcc, s84, v12
    s_cbranch_vccnz W_75
WJK_74:
    ds_write_b128 v11, v[80:83] offset:0
    v_pk_add_f16 v88, v23, v75
    v_pk_add_f16 v89, v24, v76
    v_pk_add_f16 v90, v25, v77
    v_pk_add_f16 v91, v26, v78
    ds_write_b128 v11, v[88:91] offset:3104
    ds_write_b8 v116, v5 offset:76
    ds_read_b32 v12, v4 offset:84
    v_alignbit_b32 v57, v34, v33, 16
    v_alignbit_b32 v58, v35, v34, 16
    v_alignbit_b32 v59, v36, v35, 16
    v_alignbit_b32 v60, v37, v36, 16
    v_alignbit_b32 v61, v38, v37, 16
    v_alignbit_b32 v62, v39, v38, 16
    v_alignbit_b32 v63, v40, v39, 16
    v_pk_add_f16 v66, v57, v34
    v_pk_add_f16 v67, v58, v35
    v_pk_add_f16 v68, v59, v36
    v_pk_add_f16 v69, v60, v37
    v_pk_add_f16 v70, v61, v38
    v_pk_add_f16 v71, v62, v39
    v_pk_add_f16 v72, v63, v40
    v_pk_add_f16 v80, v66, v58
    v_pk_add_f16 v81, v67, v59
    v_pk_add_f16 v82, v68, v60
    v_pk_add_f16 v83, v69, v61
    v_pk_add_f16 v75, v68, v69
    v_pk_add_f16 v76, v69, v70
    v_pk_add_f16 v77, v70, v71
    v_pk_add_f16 v78, v71, v72
    s_waitcnt lgkmcnt(0)
    v_cmp_eq_u32 vcc, s84, v12
    s_cbranch_vccnz WJK_76
W_77:
    s_sleep 1
    ds_read_b32 v12, v4 offset:84
    s_sub_u32 s39, s39, 1
    s_cbranch_scc1 KS_ABORT
    s_waitcnt lgkmcnt(0)
    v_cmp_ne_u32 vcc, s84, v12
    s_cbranch_vccnz W_77
WJK_76:
    ds_write_b128 v11, v[80:83] offset:36672
    v_pk_add_f16 v88, v35, v75
    v_pk_add_f16 v89, v36, v76
    v_pk_add_f16 v90, v37, v77
    v_pk_add_f16 v91, v38, v78
    ds_write_b128 v11, v[88:91] offset:39776
    ds_write_b8 v116, v5 offset:92
    s_cmp_lt_u32 s41, 24
    s_cbranch_scc1 WJE_64
    ds_read_b32 v12, v4 offset:100
    v_alignbit_b32 v57, v46, v45, 16
    v_alignbit_b32 v58, v47, v46, 16
    v_alignbit_b32 v59, v48, v47, 16
    v_alignbit_b32 v60, v49, v48, 16
    v_alignbit_b32 v61, v50, v49, 16
    v_alignbit_b32 v62, v51, v50, 16
    v_alignbit_b32 v63, v52, v51, 16
    v_pk_add_f16 v66, v57, v46
    v_pk_add_f16 v67, v58, v47
    v_pk_add_f16 v68, v59, v48
    v_pk_add_f16 v69, v60, v49
    v_pk_add_f16 v70, v61, v50
    v_pk_add_f16 v71, v62, v51
    v_pk_add_f16 v72, v63, v52
    v_pk_add_f16 v80, v66, v58
    v_pk_add_f16 v81, v67, v59
    v_pk_add_f16 v82, v68, v60
    v_pk_add_f16 v83, v69, v61
    v_pk_add_f16 v75, v68, v69
    v_pk_add_f16 v76, v69, v70
    v_pk_add_f16 v77, v70, v71
    v_pk_add_f16 v78, v71, v72
    s_waitcnt lgkmcnt(0)
    v_cmp_eq_u32 vcc, s84, v12
    s_cbranch_vccnz WJK_78
W_79:
    s_sleep 1
    ds_read_b32 v12, v4 offset:100
    s_sub_u32 s39, s39, 1
    s_cbranch_scc1 KS_ABORT
    s_waitcnt lgkmcnt(0)
    v_cmp_ne_u32 vcc, s84, v12
    s_cbranch_vccnz W_79
WJK_78:
    v_add_u32 v11, 73344, v11
    ds_write_b128 v11, v[80:83] offset:0
    v_pk_add_f16 v88, v47, v75
    v_pk_add_f16 v89, v48, v76
    v_pk_add_f16 v90, v49, v77
    v_pk_add_f16 v91, v50, v78
    ds_write_b128 v11, v[88:91] offset:3104
    ds_write_b8 v116, v5 offset:108
    s_branch WJE_64
WJ2_66:
    ds_write_b8 v116, v5 offset:76
    ds_write_b8 v116, v5 offset:92
    ds_write_b8 v116, v5 offset:108
    s_sub_u32 s94, s41, 18
    s_and_b32 s94, s94, 31
    s_cmp_ge_u32 s94, 14
    s_cbranch_scc1 WJE_64
    v_mul_u32_u24 v100, 57, v1
    v_lshrrev_b32 v100, 9, v100
    v_mul_u32_u24 v101, 9, v100
    v_sub_u32 v101, v1, v101
    v_mul_u32_u24 v100, 9216, v100
    v_lshl_add_u32 v100, v101, 7, v100
W_80:
    s_sleep 1
    ds_read_b32 v12, v4 offset:16
    s_sub_u32 s39, s39, 1
    s_cbranch_scc1 KS_ABORT
    s_waitcnt lgkmcnt(0)
    v_cmp_ne_u32 vcc, s84, v12
    s_cbranch_vccnz W_80
    s_bitcmp1_b32 s94, 0
    s_cselect_b32 s72, s28, s26
    s_cselect_b32 s73, s29, s27
    s_mov_b32 s74, 0x510000
    s_mov_b32 s75, 0x20000
    s_lshr_b32 s95, s94, 1
    s_mul_i32 s95, s95, 64512
    s_mul_i32 s96, s40, 1152
    s_add_u32 s95, s95, s96
    s_add_u32 s96, s95, 4451328
    buffer_load_dword v102, v100, s[72:75], s96 offen nt
    buffer_load_dword v102, v100, s[72:75], s96 offen sc1
    s_add_u32 s96, s95, 4902912
    buffer_load_dword v102, v100, s[72:75], s96 offen nt
    buffer_load_dword v102, v100, s[72:75], s96 offen sc1
KS_PF2D:
WJE_64:
    s_setprio 0
    s_lshr_b32 s92, s90, 6
    s_lshl_b32 s92, s92, 9
    s_bfe_u32 s93, s90, 0x20004
    s_lshl_b32 s93, s93, 6
    s_add_u32 s92, s92, s93
    s_and_b32 s93, s90, 3
    s_lshl_b32 s93, s93, 4
    s_add_u32 s92, s92, s93
    s_and_b32 s93, s90, 12
    s_add_u32 s92, s92, s93
    s_lshr_b32 s93, s38, 1
    s_lshl_b32 s93, s93, 8
    s_add_u32 s92, s92, s93
    s_and_b32 s93, s38, 1
    s_lshl_b32 s93, s93, 1
    s_add_u32 s92, s92, s93
    v_lshrrev_b32 v113, 5, v1
    v_and_b32 v114, 31, v1
    v_add_u32 v112, s92, v113
    v_mul_u32_u24 v115, 1152, v112
    v_lshl_add_u32 v8, v114, 2, v115
    v_lshl_add_u32 v115, v114, 4, v115
    v_lshlrev_b32 v7, 2, v114
    v_lshlrev_b32 v6, 4, v114
    v_bfe_u32 v111, v1, 3, 1
    v_add_u32 v111, s92, v111
    v_mul_u32_u24 v111, 1152, v111
    v_and_b32 v9, 7, v1
    v_lshl_add_u32 v111, v9, 4, v111
    s_mov_b32 s64, s4
    s_mov_b32 s65, s5
    s_mov_b32 s66, 0x240000
    s_mov_b32 s67, 0x20000
    s_mov_b32 s68, s24
    s_mov_b32 s69, s25
    s_mov_b32 s70, 0x480
    s_mov_b32 s71, 0x20000
    buffer_load_dwordx4 v[10:13], v115, s[64:67], 0 offen
    buffer_load_dwordx4 v[14:17], v115, s[64:67], 0 offen offset:512
    buffer_load_dword v18, v8, s[64:67], 0 offen offset:1024
    buffer_load_dwordx4 v[50:53], v6, s[68:71], 0 offen
    buffer_load_dwordx4 v[54:57], v6, s[68:71], 0 offen offset:512
    buffer_load_dword v58, v7, s[68:71], 0 offen offset:1024
KS_L4:
    s_add_u32 s64, s36, 0x600000
    s_addc_u32 s65, s37, 0
    s_mov_b32 s66, 0x240000
    s_mov_b32 s67, 0x20000
    s_mov_b32 s68, s32
    s_mov_b32 s69, s33
    s_mov_b32 s70, 0x240000
    s_mov_b32 s71, 0x20000
    s_add_u32 s72, s36, 0x300000
    s_addc_u32 s73, s37, 0
    s_mov_b32 s74, 0x240000
    s_mov_b32 s75, 0x20000
    s_add_u32 s76, s36, 0x840000
    s_addc_u32 s77, s37, 0
    s_mov_b32 s78, 0x3000
    s_mov_b32 s79, 0x20000
    s_not_b32 s93, s90
    v_xor_b32 v8, s93, v0
    v_lshrrev_b32 v6, 1, v0
    v_lshlrev_b32 v6, 6, v6
    v_and_b32 v8, 1, v8
    v_lshl_add_u32 v6, v8, 4, v6
    s_lshr_b32 s92, s90, 2
    s_lshl_b32 s92, s92, 15
    s_and_b32 s93, s90, 1
    s_lshl_b32 s93, s93, 14
    s_add_u32 s92, s92, s93
    s_and_b32 s93, s90, 2
    s_lshl_b32 s93, s93, 4
    s_add_u32 s92, s92, s93
    s_lshr_b32 s94, s90, 2
    s_lshl_b32 s94, s94, 12
    s_and_b32 s93, s90, 3
    s_lshl_b32 s93, s93, 4
    s_add_u32 s94, s94, s93
    s_lshl_b32 s93, s38, 10
    s_add_u32 s94, s94, s93
    s_add_u32 s94, s94, 0x200000
    v_lshlrev_b32 v9, 6, v2
    s_lshl_b32 s93, s90, 5
    s_and_b32 s95, s93, 0x1f80
    v_xor_b32 v6, s95, v6
    s_and_b32 s95, s93, 0x380
    v_xor_b32 v9, s95, v9
    s_and_b32 s95, s93, 0xc00
    s_xor_b32 s94, s94, s95
    s_and_b32 s93, s90, 1
    s_lshl_b32 s93, s93, 13
    s_xor_b32 s92, s92, s93
    s_xor_b32 s93, s92, 0x2000
    s_mul_i32 s95, s38, 2304
    s_add_u32 s95, s95, 17088
    v_lshl_add_u32 v117, v114, 5, s95
    v_lshl_add_u32 v110, v114, 3, s95
    s_lshl_b32 s95, s38, 9
    s_add_u32 s95, s95, 26368
    v_lshl_add_u32 v108, v1, 2, s95
    v_lshl_add_u32 v109, v1, 4, s95
    s_mov_b32 s95, 0x02020202
    v_mul_lo_u32 v118, v113, s95
    v_add_u32 v118, 0x05040100, v118
    v_lshlrev_b32 v8, 2, v0
    v_add_u32 v8, 17088, v8
    s_lshl_b32 s95, s38, 6
    s_add_u32 s95, s95, 19136
    v_lshl_add_u32 v119, v2, 2, s95
    s_waitcnt vmcnt(0)
    v_lshlrev_b32 v20, 16, v10
    v_and_b32 v21, 0xffff0000, v10
    v_lshlrev_b32 v22, 16, v11
    v_and_b32 v23, 0xffff0000, v11
    v_lshlrev_b32 v24, 16, v12
    v_and_b32 v25, 0xffff0000, v12
    v_lshlrev_b32 v26, 16, v13
    v_and_b32 v27, 0xffff0000, v13
    v_lshlrev_b32 v28, 16, v14
    v_and_b32 v29, 0xffff0000, v14
    v_lshlrev_b32 v30, 16, v15
    v_and_b32 v31, 0xffff0000, v15
    v_lshlrev_b32 v32, 16, v16
    v_and_b32 v33, 0xffff0000, v16
    v_lshlrev_b32 v34, 16, v17
    v_and_b32 v35, 0xffff0000, v17
    v_lshlrev_b32 v36, 16, v18
    v_and_b32 v37, 0xffff0000, v18
W_81:
    s_sleep 1
    ds_read_b32 v60, v4 offset:52
    s_sub_u32 s39, s39, 1
    s_cbranch_scc1 KS_ABORT
    s_waitcnt lgkmcnt(0)
    v_cmp_ne_u32 vcc, s84, v60
    s_cbranch_vccnz W_81
    s_setprio 3
    s_branch ZPE_83
ZP_82:
    s_sleep 1
ZPE_83:
    buffer_load_dwordx4 v[68:71], v4, s[64:67], s94 offen sc1
    s_sub_u32 s39, s39, 1
    s_cbranch_scc1 KS_ABORT
    s_waitcnt vmcnt(0)
    v_max3_u32 v44, v68, v69, v70
    v_max_u32 v44, v44, v71
    v_cmp_eq_u32 vcc, -1, v44
    s_cbranch_vccnz ZP_82
    s_branch ZPE_85
ZP_84:
    s_sleep 1
ZPE_85:
    buffer_load_dwordx4 v[60:63], v6, s[64:67], s92 offen sc1
    buffer_load_dwordx4 v[64:67], v6, s[64:67], s93 offen sc1
    buffer_load_dwordx4 v[68:71], v9, s[64:67], s94 offen sc1
    s_sub_u32 s39, s39, 1
    s_cbranch_scc1 KS_ABORT
    s_waitcnt vmcnt(0)
    v_max3_u32 v44, v60, v61, v62
    v_max3_u32 v44, v44, v63, v64
    v_max3_u32 v44, v44, v65, v66
    v_max3_u32 v44, v44, v67, v68
    v_max3_u32 v44, v44, v69, v70
    v_max_u32 v44, v44, v71
    v_cmp_eq_u32 vcc, -1, v44
    s_cbranch_vccnz ZP_84
    ds_write2st64_b32 v8, v60, v61 offset0:0 offset1:9
    ds_write2st64_b32 v8, v62, v63 offset0:18 offset1:27
    ds_write2st64_b32 v8, v64, v65 offset0:4 offset1:13
    ds_write2st64_b32 v8, v66, v67 offset0:22 offset1:31
    ds_write2st64_b32 v119, v68, v69 offset0:0 offset1:9
    ds_write2st64_b32 v119, v70, v71 offset0:18 offset1:27
    ds_write_b8 v116, v5 offset:20
W_86:
    ds_read_b32 v60, v4 offset:20
    s_sub_u32 s39, s39, 1
    s_cbranch_scc1 KS_ABORT
    s_waitcnt lgkmcnt(0)
    v_cmp_ne_u32 vcc, s84, v60
    s_cbranch_vccnz W_86
    ds_read_b128 v[60:63], v117 offset:0
    ds_read_b128 v[64:67], v117 offset:16
    ds_read_b128 v[68:71], v117 offset:1024
    ds_read_b128 v[72:75], v117 offset:1040
    ds_read_b64 v[76:77], v110 offset:2048
    s_waitcnt lgkmcnt(4)
    v_perm_b32 v44, v61, v60, v118
    v_lshlrev_b32 v46, 16, v44
    v_and_b32 v47, 0xffff0000, v44
    v_pk_add_f32 v[46:47], v[46:47], v[20:21]
    v_cvt_pk_bf16_f32 v44, v46, v47
    v_lshlrev_b32 v20, 16, v44
    v_and_b32 v21, 0xffff0000, v44
    v_perm_b32 v44, v63, v62, v118
    v_lshlrev_b32 v46, 16, v44
    v_and_b32 v47, 0xffff0000, v44
    v_pk_add_f32 v[46:47], v[46:47], v[22:23]
    v_cvt_pk_bf16_f32 v44, v46, v47
    v_lshlrev_b32 v22, 16, v44
    v_and_b32 v23, 0xffff0000, v44
    s_waitcnt lgkmcnt(3)
    v_perm_b32 v44, v65, v64, v118
    v_lshlrev_b32 v46, 16, v44
    v_and_b32 v47, 0xffff0000, v44
    v_pk_add_f32 v[46:47], v[46:47], v[24:25]
    v_cvt_pk_bf16_f32 v44, v46, v47
    v_lshlrev_b32 v24, 16, v44
    v_and_b32 v25, 0xffff0000, v44
    v_perm_b32 v44, v67, v66, v118
    v_lshlrev_b32 v46, 16, v44
    v_and_b32 v47, 0xffff0000, v44
    v_pk_add_f32 v[46:47], v[46:47], v[26:27]
    v_cvt_pk_bf16_f32 v44, v46, v47
    v_lshlrev_b32 v26, 16, v44
    v_and_b32 v27, 0xffff0000, v44
    s_waitcnt lgkmcnt(2)
    v_perm_b32 v44, v69, v68, v118
    v_lshlrev_b32 v46, 16, v44
    v_and_b32 v47, 0xffff0000, v44
    v_pk_add_f32 v[46:47], v[46:47], v[28:29]
    v_cvt_pk_bf16_f32 v44, v46, v47
    v_lshlrev_b32 v28, 16, v44
    v_and_b32 v29, 0xffff0000, v44
    v_perm_b32 v44, v71, v70, v118
    v_lshlrev_b32 v46, 16, v44
    v_and_b32 v47, 0xffff0000, v44
    v_pk_add_f32 v[46:47], v[46:47], v[30:31]
    v_cvt_pk_bf16_f32 v44, v46, v47
    v_lshlrev_b32 v30, 16, v44
    v_and_b32 v31, 0xffff0000, v44
    s_waitcnt lgkmcnt(1)
    v_perm_b32 v44, v73, v72, v118
    v_lshlrev_b32 v46, 16, v44
    v_and_b32 v47, 0xffff0000, v44
    v_pk_add_f32 v[46:47], v[46:47], v[32:33]
    v_cvt_pk_bf16_f32 v44, v46, v47
    v_lshlrev_b32 v32, 16, v44
    v_and_b32 v33, 0xffff0000, v44
    v_perm_b32 v44, v75, v74, v118
    v_lshlrev_b32 v46, 16, v44
    v_and_b32 v47, 0xffff0000, v44
    v_pk_add_f32 v[46:47], v[46:47], v[34:35]
    v_cvt_pk_bf16_f32 v44, v46, v47
    v_lshlrev_b32 v34, 16, v44
    v_and_b32 v35, 0xffff0000, v44
    s_waitcnt lgkmcnt(0)
    v_perm_b32 v44, v77, v76, v118
    v_lshlrev_b32 v46, 16, v44
    v_and_b32 v47, 0xffff0000, v44
    v_pk_add_f32 v[46:47], v[46:47], v[36:37]
    v_cvt_pk_bf16_f32 v44, v46, v47
    v_lshlrev_b32 v36, 16, v44
    v_and_b32 v37, 0xffff0000, v44
    v_pk_add_f32 v[44:45], v[20:21], v[22:23]
    v_pk_add_f32 v[46:47], v[24:25], v[26:27]
    v_pk_add_f32 v[44:45], v[44:45], v[28:29]
    v_pk_add_f32 v[46:47], v[46:47], v[30:31]
    v_pk_add_f32 v[44:45], v[44:45], v[32:33]
    v_pk_add_f32 v[46:47], v[46:47], v[34:35]
    v_pk_add_f32 v[44:45], v[44:45], v[36:37]
    v_pk_add_f32 v[44:45], v[44:45], v[46:47]
    v_add_f32 v44, v44, v45
    s_nop 1
    v_add_f32_dpp v44, v44, v44 row_ror:8 row_mask:0xf bank_mask:0xf
    s_nop 1
    v_add_f32_dpp v44, v44, v44 row_ror:4 row_mask:0xf bank_mask:0xf
    s_nop 1
    v_add_f32_dpp v44, v44, v44 row_ror:2 row_mask:0xf bank_mask:0xf
    s_nop 1
    v_add_f32_dpp v44, v44, v44 row_ror:1 row_mask:0xf bank_mask:0xf
    v_mov_b32 v46, v44
    s_nop 1
    v_permlane16_swap_b32 v44, v46
    v_add_f32 v44, v44, v46
    v_mul_f32 v48, 0x3ae38e39, v44
    v_mov_b32 v49, v48
    v_cvt_pk_bf16_f32 v40, v48, v48
    v_and_b32 v40, 0xffff0000, v40
    v_mov_b32 v41, v40
    v_pk_add_f32 v[42:43], v[20:21], v[48:49] neg_lo:[0,1] neg_hi:[0,1]
    v_pk_mul_f32 v[44:45], v[42:43], v[42:43]
    v_pk_add_f32 v[42:43], v[22:23], v[48:49] neg_lo:[0,1] neg_hi:[0,1]
    v_pk_mul_f32 v[46:47], v[42:43], v[42:43]
    v_pk_add_f32 v[42:43], v[24:25], v[48:49] neg_lo:[0,1] neg_hi:[0,1]
    v_pk_fma_f32 v[44:45], v[42:43], v[42:43], v[44:45]
    v_pk_add_f32 v[42:43], v[26:27], v[48:49] neg_lo:[0,1] neg_hi:[0,1]
    v_pk_fma_f32 v[46:47], v[42:43], v[42:43], v[46:47]
    v_pk_add_f32 v[42:43], v[28:29], v[48:49] neg_lo:[0,1] neg_hi:[0,1]
    v_pk_fma_f32 v[44:45], v[42:43], v[42:43], v[44:45]
    v_pk_add_f32 v[42:43], v[30:31], v[48:49] neg_lo:[0,1] neg_hi:[0,1]
    v_pk_fma_f32 v[46:47], v[42:43], v[42:43], v[46:47]
    v_pk_add_f32 v[42:43], v[32:33], v[48:49] neg_lo:[0,1] neg_hi:[0,1]
    v_pk_fma_f32 v[44:45], v[42:43], v[42:43], v[44:45]
    v_pk_add_f32 v[42:43], v[34:35], v[48:49] neg_lo:[0,1] neg_hi:[0,1]
    v_pk_fma_f32 v[46:47], v[42:43], v[42:43], v[46:47]
    v_pk_add_f32 v[42:43], v[36:37], v[48:49] neg_lo:[0,1] neg_hi:[0,1]
    v_pk_fma_f32 v[44:45], v[42:43], v[42:43], v[44:45]
    v_pk_add_f32 v[44:45], v[44:45], v[46:47]
    v_add_f32 v44, v44, v45
    s_nop 1
    v_add_f32_dpp v44, v44, v44 row_ror:8 row_mask:0xf bank_mask:0xf
    s_nop 1
    v_add_f32_dpp v44, v44, v44 row_ror:4 row_mask:0xf bank_mask:0xf
    s_nop 1
    v_add_f32_dpp v44, v44, v44 row_ror:2 row_mask:0xf bank_mask:0xf
    s_nop 1
    v_add_f32_dpp v44, v44, v44 row_ror:1 row_mask:0xf bank_mask:0xf
    v_mov_b32 v46, v44
    s_nop 1
    v_permlane16_swap_b32 v44, v46
    v_add_f32 v44, v44, v46
    v_mul_f32 v44, 0x3ae38e39, v44
    v_cvt_pk_bf16_f32 v44, v44, v44
    v_and_b32 v44, 0xffff0000, v44
    v_add_f32 v44, 0x3727c5ac, v44
    v_cvt_pk_bf16_f32 v44, v44, v44
    v_and_b32 v44, 0xffff0000, v44
    v_sqrt_f32 v44, v44
    s_nop 0
    v_cvt_pk_bf16_f32 v44, v44, v44
    v_and_b32 v44, 0xffff0000, v44
    v_rcp_f32 v42, v44
    s_nop 0
    v_mov_b32 v43, v42
    v_mov_b32 v60, 0
    v_mov_b32 v61, 0
    v_pk_add_f32 v[44:45], v[20:21], v[40:41] neg_lo:[0,1] neg_hi:[0,1]
    v_cvt_pk_bf16_f32 v10, v44, v45
    v_lshlrev_b32 v44, 16, v10
    v_and_b32 v45, 0xffff0000, v10
    v_pk_mul_f32 v[44:45], v[44:45], v[42:43]
    v_cvt_pk_bf16_f32 v10, v44, v45
    v_lshlrev_b32 v44, 16, v10
    v_and_b32 v45, 0xffff0000, v10
    v_lshlrev_b32 v46, 16, v50
    v_and_b32 v47, 0xffff0000, v50
    v_pk_fma_f32 v[60:61], v[44:45], v[46:47], v[60:61]
    v_pk_add_f32 v[20:21], v[44:45], v[20:21]
    v_pk_add_f32 v[44:45], v[22:23], v[40:41] neg_lo:[0,1] neg_hi:[0,1]
    v_cvt_pk_bf16_f32 v11, v44, v45
    v_lshlrev_b32 v44, 16, v11
    v_and_b32 v45, 0xffff0000, v11
    v_pk_mul_f32 v[44:45], v[44:45], v[42:43]
    v_cvt_pk_bf16_f32 v11, v44, v45
    v_lshlrev_b32 v44, 16, v11
    v_and_b32 v45, 0xffff0000, v11
    v_lshlrev_b32 v46, 16, v51
    v_and_b32 v47, 0xffff0000, v51
    v_pk_fma_f32 v[60:61], v[44:45], v[46:47], v[60:61]
    v_pk_add_f32 v[22:23], v[44:45], v[22:23]
    v_pk_add_f32 v[44:45], v[24:25], v[40:41] neg_lo:[0,1] neg_hi:[0,1]
    v_cvt_pk_bf16_f32 v12, v44, v45
    v_lshlrev_b32 v44, 16, v12
    v_and_b32 v45, 0xffff0000, v12
    v_pk_mul_f32 v[44:45], v[44:45], v[42:43]
    v_cvt_pk_bf16_f32 v12, v44, v45
    v_lshlrev_b32 v44, 16, v12
    v_and_b32 v45, 0xffff0000, v12
    v_lshlrev_b32 v46, 16, v52
    v_and_b32 v47, 0xffff0000, v52
    v_pk_fma_f32 v[60:61], v[44:45], v[46:47], v[60:61]
    v_pk_add_f32 v[24:25], v[44:45], v[24:25]
    v_pk_add_f32 v[44:45], v[26:27], v[40:41] neg_lo:[0,1] neg_hi:[0,1]
    v_cvt_pk_bf16_f32 v13, v44, v45
    v_lshlrev_b32 v44, 16, v13
    v_and_b32 v45, 0xffff0000, v13
    v_pk_mul_f32 v[44:45], v[44:45], v[42:43]
    v_cvt_pk_bf16_f32 v13, v44, v45
    v_lshlrev_b32 v44, 16, v13
    v_and_b32 v45, 0xffff0000, v13
    v_lshlrev_b32 v46, 16, v53
    v_and_b32 v47, 0xffff0000, v53
    v_pk_fma_f32 v[60:61], v[44:45], v[46:47], v[60:61]
    v_pk_add_f32 v[26:27], v[44:45], v[26:27]
    v_pk_add_f32 v[44:45], v[28:29], v[40:41] neg_lo:[0,1] neg_hi:[0,1]
    v_cvt_pk_bf16_f32 v14, v44, v45
    v_lshlrev_b32 v44, 16, v14
    v_and_b32 v45, 0xffff0000, v14
    v_pk_mul_f32 v[44:45], v[44:45], v[42:43]
    v_cvt_pk_bf16_f32 v14, v44, v45
    v_lshlrev_b32 v44, 16, v14
    v_and_b32 v45, 0xffff0000, v14
    v_lshlrev_b32 v46, 16, v54
    v_and_b32 v47, 0xffff0000, v54
    v_pk_fma_f32 v[60:61], v[44:45], v[46:47], v[60:61]
    v_pk_add_f32 v[28:29], v[44:45], v[28:29]
    v_pk_add_f32 v[44:45], v[30:31], v[40:41] neg_lo:[0,1] neg_hi:[0,1]
    v_cvt_pk_bf16_f32 v15, v44, v45
    v_lshlrev_b32 v44, 16, v15
    v_and_b32 v45, 0xffff0000, v15
    v_pk_mul_f32 v[44:45], v[44:45], v[42:43]
    v_cvt_pk_bf16_f32 v15, v44, v45
    v_lshlrev_b32 v44, 16, v15
    v_and_b32 v45, 0xffff0000, v15
    v_lshlrev_b32 v46, 16, v55
    v_and_b32 v47, 0xffff0000, v55
    v_pk_fma_f32 v[60:61], v[44:45], v[46:47], v[60:61]
    v_pk_add_f32 v[30:31], v[44:45], v[30:31]
    v_pk_add_f32 v[44:45], v[32:33], v[40:41] neg_lo:[0,1] neg_hi:[0,1]
    v_cvt_pk_bf16_f32 v16, v44, v45
    v_lshlrev_b32 v44, 16, v16
    v_and_b32 v45, 0xffff0000, v16
    v_pk_mul_f32 v[44:45], v[44:45], v[42:43]
    v_cvt_pk_bf16_f32 v16, v44, v45
    v_lshlrev_b32 v44, 16, v16
    v_and_b32 v45, 0xffff0000, v16
    v_lshlrev_b32 v46, 16, v56
    v_and_b32 v47, 0xffff0000, v56
    v_pk_fma_f32 v[60:61], v[44:45], v[46:47], v[60:61]
    v_pk_add_f32 v[32:33], v[44:45], v[32:33]
    v_pk_add_f32 v[44:45], v[34:35], v[40:41] neg_lo:[0,1] neg_hi:[0,1]
    v_cvt_pk_bf16_f32 v17, v44, v45
    v_lshlrev_b32 v44, 16, v17
    v_and_b32 v45, 0xffff0000, v17
    v_pk_mul_f32 v[44:45], v[44:45], v[42:43]
    v_cvt_pk_bf16_f32 v17, v44, v45
    v_lshlrev_b32 v44, 16, v17
    v_and_b32 v45, 0xffff0000, v17
    v_lshlrev_b32 v46, 16, v57
    v_and_b32 v47, 0xffff0000, v57
    v_pk_fma_f32 v[60:61], v[44:45], v[46:47], v[60:61]
    v_pk_add_f32 v[34:35], v[44:45], v[34:35]
    v_pk_add_f32 v[44:45], v[36:37], v[40:41] neg_lo:[0,1] neg_hi:[0,1]
    v_cvt_pk_bf16_f32 v18, v44, v45
    v_lshlrev_b32 v44, 16, v18
    v_and_b32 v45, 0xffff0000, v18
    v_pk_mul_f32 v[44:45], v[44:45], v[42:43]
    v_cvt_pk_bf16_f32 v18, v44, v45
    v_lshlrev_b32 v44, 16, v18
    v_and_b32 v45, 0xffff0000, v18
    v_lshlrev_b32 v46, 16, v58
    v_and_b32 v47, 0xffff0000, v58
    v_pk_fma_f32 v[60:61], v[44:45], v[46:47], v[60:61]
    v_pk_add_f32 v[36:37], v[44:45], v[36:37]
    v_add_f32 v60, v60, v61
    s_nop 1
    v_add_f32_dpp v60, v60, v60 row_ror:8 row_mask:0xf bank_mask:0xf
    s_nop 1
    v_add_f32_dpp v60, v60, v60 row_ror:4 row_mask:0xf bank_mask:0xf
    s_nop 1
    v_add_f32_dpp v60, v60, v60 row_ror:2 row_mask:0xf bank_mask:0xf
    s_nop 1
    v_add_f32_dpp v60, v60, v60 row_ror:1 row_mask:0xf bank_mask:0xf
    v_mov_b32 v61, v60
    s_nop 1
    v_permlane16_swap_b32 v60, v61
    v_add_f32 v60, v60, v61
    v_cvt_pk_bf16_f32 v60, v60, v60
    v_ashrrev_i32 v61, 31, v60
    v_or_b32 v61, 0x80000000, v61
    v_xor_b32 v60, v60, v61
    v_and_b32 v60, 0xffff0000, v60
    v_sub_u32 v62, 0x87ff, v112
    v_or_b32 v60, v60, v62
    v_lshl_add_u32 v61, v116, 1, v113
    v_lshlrev_b32 v61, 2, v61
    s_mov_b32 exec_lo, 1
    s_mov_b32 exec_hi, 1
    ds_write_b32 v61, v60 offset:800
    s_mov_b64 exec, 1
    ds_add_rtn_u32 v62, v4, v5 offset:12
    s_mov_b64 exec, 3
    v_lshlrev_b32 v61, 4, v114
    s_lshl_b32 s92, s90, 5
    ds_read_b128 v[64:67], v61 offset:800
    s_waitcnt lgkmcnt(1)
    v_readfirstlane_b32 s93, v62
    s_cmp_lg_u32 s93, 3
    s_cbranch_scc1 KS_NOKEY
    s_waitcnt lgkmcnt(0)
    buffer_store_dwordx4 v[64:67], v61, s[76:79], s92 offen sc1
KS_NOKEY:
    s_mov_b64 exec, -1
    v_cvt_pk_bf16_f32 v58, v36, v37
    ds_write_b32 v108, v18
    ds_write_b32 v108, v58 offset:256
    ds_read_b128 v[64:67], v109
    buffer_store_dwordx4 v[10:13], v115, s[72:75], 0 offen sc1
    buffer_store_dwordx4 v[14:17], v115, s[72:75], 0 offen offset:512 sc1
    v_cvt_pk_bf16_f32 v50, v20, v21
    v_cvt_pk_bf16_f32 v51, v22, v23
    v_cvt_pk_bf16_f32 v52, v24, v25
    v_cvt_pk_bf16_f32 v53, v26, v27
    v_cvt_pk_bf16_f32 v54, v28, v29
    v_cvt_pk_bf16_f32 v55, v30, v31
    v_cvt_pk_bf16_f32 v56, v32, v33
    v_cvt_pk_bf16_f32 v57, v34, v35
    s_mov_b64 exec, 0xffff
    s_waitcnt lgkmcnt(0)
    buffer_store_dwordx4 v[64:67], v111, s[72:75], 0 offen offset:1024 sc1
    s_mov_b64 exec, 0xffff0000
    buffer_store_dwordx4 v[64:67], v111, s[68:71], 0 offen offset:1024 sc1
    s_mov_b64 exec, -1
    buffer_store_dwordx4 v[50:53], v115, s[68:71], 0 offen sc1
    buffer_store_dwordx4 v[54:57], v115, s[68:71], 0 offen offset:512 sc1
    s_cmp_lg_u32 s93, 3
    s_cbranch_scc1 KS_NOKEY2
    s_waitcnt vmcnt(6)
    ds_write_b32 v4, v5 offset:24
KS_NOKEY2:
    s_waitcnt vmcnt(0)
    s_mov_b64 exec, 1
    ds_add_rtn_u32 v62, v4, v5 offset:176
    s_waitcnt lgkmcnt(0)
    v_cmp_eq_u32 vcc, 3, v62
    s_and_b64 exec, exec, vcc
    s_cbranch_execz KS_NOF2
    s_lshl_b32 s92, s2, 4
    s_add_u32 s92, s92, 8192
    buffer_store_dword v5, v4, s[76:79], s92 offen sc1
KS_NOF2:
    s_mov_b64 exec, -1
    s_setprio 0
    s_cmp_lt_u32 s41, 18
    s_cbranch_scc1 KS_B
    s_waitcnt lgkmcnt(0)
    s_endpgm
KS_T:
    s_setprio 0
    s_cmp_ge_u32 s38, 10
    s_cbranch_scc1 KS_P
    v_and_b32 v6, 1, v1
    v_subrev_u32 v6, 1, v6
    v_and_b32 v7, 7, v1
    v_lshlrev_b32 v7, 2, v7
    s_add_u32 s76, s36, 0x840000
    s_addc_u32 s77, s37, 0
    s_mov_b32 s78, 0x3000
    s_mov_b32 s79, 0x20000
    s_cmp_eq_u32 s38, 9
    s_cbranch_scc1 KS_W9
    s_cmp_eq_u32 s38, 8
    s_cbranch_scc1 KS_L2W
    s_sub_u32 s93, s38, 4
    s_lshl_b32 s92, s93, 10
    v_lshl_add_u32 v33, v1, 4, s92
    s_movk_i32 s92, 4096
    s_lshl_b32 s93, s93, 7
    v_lshlrev_b32 v32, 4, v2
    v_lshl_add_u32 v32, v3, 5, v32
    v_add_u32 v32, s93, v32
W_87:
    s_sleep 1
    ds_read_b32 v8, v4 offset:24
    s_sub_u32 s39, s39, 1
    s_cbranch_scc1 KS_ABORT
    s_waitcnt lgkmcnt(0)
    v_cmp_eq_u32 vcc, 0, v8
    s_cbranch_vccnz W_87
    s_setprio 2
    s_sleep 12
    s_branch ZPE_89
ZP_88:
    s_sleep 4
ZPE_89:
    buffer_load_dwordx4 v[8:11], v33, s[76:79], 0 offen sc1
    buffer_load_dwordx4 v[12:15], v33, s[76:79], s92 offen sc1
    s_sub_u32 s39, s39, 1
    s_cbranch_scc1 KS_ABORT
    s_waitcnt vmcnt(0)
    v_max3_u32 v44, v8, v9, v10
    v_max3_u32 v44, v44, v11, v12
    v_max3_u32 v44, v44, v13, v14
    v_max_u32 v44, v44, v15
    v_cmp_eq_u32 vcc, -1, v44
    s_cbranch_vccnz ZP_88
    ds_write_b32 v4, v5 offset:196
    v_max_u32 v16, v8, v9
    v_min_u32 v9, v8, v9
    v_max_u32 v17, v12, v13
    v_min_u32 v13, v12, v13
    v_max_u32 v18, v10, v11
    v_min_u32 v11, v10, v11
    v_max_u32 v19, v14, v15
    v_min_u32 v15, v14, v15
    v_max_u32 v20, v16, v18
    v_min_u32 v18, v16, v18
    v_max_u32 v21, v17, v19
    v_min_u32 v19, v17, v19
    v_max_u32 v22, v9, v11
    v_min_u32 v11, v9, v11
    v_max_u32 v23, v13, v15
    v_min_u32 v15, v13, v15
    v_max_u32 v24, v22, v18
    v_min_u32 v18, v22, v18
    v_max_u32 v25, v23, v19
    v_min_u32 v19, v23, v19
    v_mov_b32_dpp v26, v11 quad_perm:[1,0,3,2] row_mask:0xf bank_mask:0xf
    v_mov_b32_dpp v27, v18 quad_perm:[1,0,3,2] row_mask:0xf bank_mask:0xf
    v_mov_b32_dpp v8, v24 quad_perm:[1,0,3,2] row_mask:0xf bank_mask:0xf
    v_mov_b32_dpp v12, v20 quad_perm:[1,0,3,2] row_mask:0xf bank_mask:0xf
    v_med3_u32 v26, v20, v26, v6
    v_med3_u32 v27, v24, v27, v6
    v_med3_u32 v8, v18, v8, v6
    v_med3_u32 v12, v11, v12, v6
    v_max_u32 v10, v26, v8
    v_min_u32 v8, v26, v8
    v_max_u32 v14, v27, v12
    v_min_u32 v12, v27, v12
    v_max_u32 v16, v10, v14
    v_min_u32 v14, v10, v14
    v_max_u32 v17, v8, v12
    v_min_u32 v12, v8, v12
    v_mov_b32_dpp v9, v15 quad_perm:[1,0,3,2] row_mask:0xf bank_mask:0xf
    v_mov_b32_dpp v13, v19 quad_perm:[1,0,3,2] row_mask:0xf bank_mask:0xf
    v_mov_b32_dpp v22, v25 quad_perm:[1,0,3,2] row_mask:0xf bank_mask:0xf
    v_mov_b32_dpp v23, v21 quad_perm:[1,0,3,2] row_mask:0xf bank_mask:0xf
    v_med3_u32 v9, v21, v9, v6
    v_med3_u32 v13, v25, v13, v6
    v_med3_u32 v22, v19, v22, v6
    v_med3_u32 v23, v15, v23, v6
    v_max_u32 v20, v9, v22
    v_min_u32 v22, v9, v22
    v_max_u32 v24, v13, v23
    v_min_u32 v23, v13, v23
    v_max_u32 v18, v20, v24
    v_min_u32 v24, v20, v24
    v_max_u32 v11, v22, v23
    v_min_u32 v23, v22, v23
    s_nop 1
    v_max_u32_dpp v16, v23, v16 quad_perm:[1,0,3,2] row_mask:0xf bank_mask:0xf
    v_max_u32_dpp v14, v11, v14 quad_perm:[1,0,3,2] row_mask:0xf bank_mask:0xf
    v_max_u32_dpp v17, v24, v17 quad_perm:[1,0,3,2] row_mask:0xf bank_mask:0xf
    v_max_u32_dpp v12, v18, v12 quad_perm:[1,0,3,2] row_mask:0xf bank_mask:0xf
    v_mov_b32_dpp v26, v16 quad_perm:[1,0,3,2] row_mask:0xf bank_mask:0xf
    v_mov_b32_dpp v27, v14 quad_perm:[1,0,3,2] row_mask:0xf bank_mask:0xf
    v_mov_b32_dpp v10, v17 quad_perm:[1,0,3,2] row_mask:0xf bank_mask:0xf
    v_mov_b32_dpp v8, v12 quad_perm:[1,0,3,2] row_mask:0xf bank_mask:0xf
    v_med3_u32 v26, v16, v26, v6
    v_med3_u32 v27, v14, v27, v6
    v_med3_u32 v10, v17, v10, v6
    v_med3_u32 v8, v12, v8, v6
    v_max_u32 v21, v26, v10
    v_min_u32 v10, v26, v10
    v_max_u32 v25, v27, v8
    v_min_u32 v8, v27, v8
    v_max_u32 v19, v21, v25
    v_min_u32 v25, v21, v25
    v_max_u32 v15, v10, v8
    v_min_u32 v8, v10, v8
    s_nop 1
    v_max_u32_dpp v9, v8, v19 quad_perm:[3,2,1,0] row_mask:0xf bank_mask:0xf
    v_max_u32_dpp v13, v15, v25 quad_perm:[3,2,1,0] row_mask:0xf bank_mask:0xf
    v_max_u32_dpp v20, v25, v15 quad_perm:[3,2,1,0] row_mask:0xf bank_mask:0xf
    v_max_u32_dpp v22, v19, v8 quad_perm:[3,2,1,0] row_mask:0xf bank_mask:0xf
    v_mov_b32_dpp v18, v9 quad_perm:[1,0,3,2] row_mask:0xf bank_mask:0xf
    v_mov_b32_dpp v24, v13 quad_perm:[1,0,3,2] row_mask:0xf bank_mask:0xf
    v_mov_b32_dpp v11, v20 quad_perm:[1,0,3,2] row_mask:0xf bank_mask:0xf
    v_mov_b32_dpp v23, v22 quad_perm:[1,0,3,2] row_mask:0xf bank_mask:0xf
    v_med3_u32 v18, v9, v18, v6
    v_med3_u32 v24, v13, v24, v6
    v_med3_u32 v11, v20, v11, v6
    v_med3_u32 v23, v22, v23, v6
    v_max_u32 v16, v18, v11
    v_min_u32 v11, v18, v11
    v_max_u32 v14, v24, v23
    v_min_u32 v23, v24, v23
    v_max_u32 v17, v16, v14
    v_min_u32 v14, v16, v14
    v_max_u32 v12, v11, v23
    v_min_u32 v23, v11, v23
    s_nop 1
    v_max_u32_dpp v26, v23, v17 row_half_mirror row_mask:0xf bank_mask:0xf
    v_max_u32_dpp v27, v12, v14 row_half_mirror row_mask:0xf bank_mask:0xf
    v_max_u32_dpp v21, v14, v12 row_half_mirror row_mask:0xf bank_mask:0xf
    v_max_u32_dpp v10, v17, v23 row_half_mirror row_mask:0xf bank_mask:0xf
    v_mov_b32_dpp v19, v26 quad_perm:[1,0,3,2] row_mask:0xf bank_mask:0xf
    v_mov_b32_dpp v25, v27 quad_perm:[1,0,3,2] row_mask:0xf bank_mask:0xf
    v_mov_b32_dpp v15, v21 quad_perm:[1,0,3,2] row_mask:0xf bank_mask:0xf
    v_mov_b32_dpp v8, v10 quad_perm:[1,0,3,2] row_mask:0xf bank_mask:0xf
    v_med3_u32 v19, v26, v19, v6
    v_med3_u32 v25, v27, v25, v6
    v_med3_u32 v15, v21, v15, v6
    v_med3_u32 v8, v10, v8, v6
    v_max_u32 v9, v19, v15
    v_min_u32 v15, v19, v15
    v_max_u32 v13, v25, v8
    v_min_u32 v8, v25, v8
    v_max_u32 v20, v9, v13
    v_min_u32 v13, v9, v13
    v_max_u32 v22, v15, v8
    v_min_u32 v8, v15, v8
    s_nop 1
    v_max_u32_dpp v18, v8, v20 row_mirror row_mask:0xf bank_mask:0xf
    v_max_u32_dpp v24, v22, v13 row_mirror row_mask:0xf bank_mask:0xf
    v_max_u32_dpp v16, v13, v22 row_mirror row_mask:0xf bank_mask:0xf
    v_max_u32_dpp v11, v20, v8 row_mirror row_mask:0xf bank_mask:0xf
    v_mov_b32_dpp v17, v18 quad_perm:[1,0,3,2] row_mask:0xf bank_mask:0xf
    v_mov_b32_dpp v14, v24 quad_perm:[1,0,3,2] row_mask:0xf bank_mask:0xf
    v_mov_b32_dpp v12, v16 quad_perm:[1,0,3,2] row_mask:0xf bank_mask:0xf
    v_mov_b32_dpp v23, v11 quad_perm:[1,0,3,2] row_mask:0xf bank_mask:0xf
    v_med3_u32 v17, v18, v17, v6
    v_med3_u32 v14, v24, v14, v6
    v_med3_u32 v12, v16, v12, v6
    v_med3_u32 v23, v11, v23, v6
    v_max_u32 v26, v17, v12
    v_min_u32 v12, v17, v12
    v_max_u32 v27, v14, v23
    v_min_u32 v23, v14, v23
    v_max_u32 v21, v26, v27
    v_min_u32 v27, v26, v27
    v_max_u32 v10, v12, v23
    v_min_u32 v23, v12, v23
    v_mov_b32 v28, v21
    v_mov_b32 v29, v27
    v_mov_b32 v30, v10
    v_mov_b32 v31, v23
    s_mov_b32 exec_lo, 0x00030003
    s_mov_b32 exec_hi, 0x00030003
    ds_write_b128 v32, v[28:31] offset:256
    s_mov_b64 exec, -1
    s_setprio 0
    s_branch KS_B
KS_L2W:
    s_add_u32 s72, s36, 0x300000
    s_addc_u32 s73, s37, 0
    s_mov_b32 s74, 0x240000
    s_mov_b32 s75, 0x20000
    s_mov_b32 s92, 0xcccccccc
    s_mov_b32 s93, 0xcccccccc
    s_mov_b32 s94, 0xf0f0f0f0
    s_mov_b32 s95, 0xf0f0f0f0
    s_movk_i32 s96, 1152
    v_lshrrev_b32 v34, 3, v1
    v_lshlrev_b32 v34, 4, v34
    v_lshlrev_b32 v33, 4, v2
W_90:
    s_sleep 1
    ds_read_b32 v8, v4 offset:24
    s_sub_u32 s39, s39, 1
    s_cbranch_scc1 KS_ABORT
    s_waitcnt lgkmcnt(0)
    v_cmp_eq_u32 vcc, 0, v8
    s_cbranch_vccnz W_90
    s_setprio 2
KS_L2POLL:
    ds_read_b128 v[8:11], v33 offset:256
    ds_read_b128 v[12:15], v33 offset:512
    s_sub_u32 s39, s39, 1
    s_cbranch_scc1 KS_ABORT
    s_waitcnt lgkmcnt(0)
    v_min3_u32 v16, v8, v9, v10
    v_min3_u32 v17, v11, v12, v13
    v_min3_u32 v16, v16, v14, v15
    v_min_u32 v16, v16, v17
    v_cmp_eq_u32 vcc, 0, v16
    s_cbranch_vccnz KS_L2POLL
    v_max_u32_dpp v8, v15, v8 quad_perm:[1,0,3,2] row_mask:0xf bank_mask:0xf
    v_max_u32_dpp v9, v14, v9 quad_perm:[1,0,3,2] row_mask:0xf bank_mask:0xf
    v_max_u32_dpp v10, v13, v10 quad_perm:[1,0,3,2] row_mask:0xf bank_mask:0xf
    v_max_u32_dpp v11, v12, v11 quad_perm:[1,0,3,2] row_mask:0xf bank_mask:0xf
    v_mov_b32_dpp v16, v8 quad_perm:[1,0,3,2] row_mask:0xf bank_mask:0xf
    v_mov_b32_dpp v17, v9 quad_perm:[1,0,3,2] row_mask:0xf bank_mask:0xf
    v_mov_b32_dpp v18, v10 quad_perm:[1,0,3,2] row_mask:0xf bank_mask:0xf
    v_mov_b32_dpp v19, v11 quad_perm:[1,0,3,2] row_mask:0xf bank_mask:0xf
    v_med3_u32 v16, v8, v16, v6
    v_med3_u32 v17, v9, v17, v6
    v_med3_u32 v18, v10, v18, v6
    v_med3_u32 v19, v11, v19, v6
    v_max_u32 v20, v16, v18
    v_min_u32 v18, v16, v18
    v_max_u32 v21, v17, v19
    v_min_u32 v19, v17, v19
    v_max_u32 v22, v20, v21
    v_min_u32 v21, v20, v21
    v_max_u32 v23, v18, v19
    v_min_u32 v19, v18, v19
    s_nop 1
    v_max_u32_dpp v24, v19, v22 quad_perm:[3,2,1,0] row_mask:0xf bank_mask:0xf
    v_max_u32_dpp v25, v23, v21 quad_perm:[3,2,1,0] row_mask:0xf bank_mask:0xf
    v_max_u32_dpp v26, v21, v23 quad_perm:[3,2,1,0] row_mask:0xf bank_mask:0xf
    v_max_u32_dpp v27, v22, v19 quad_perm:[3,2,1,0] row_mask:0xf bank_mask:0xf
    v_mov_b32_dpp v12, v24 quad_perm:[1,0,3,2] row_mask:0xf bank_mask:0xf
    v_mov_b32_dpp v13, v25 quad_perm:[1,0,3,2] row_mask:0xf bank_mask:0xf
    v_mov_b32_dpp v14, v26 quad_perm:[1,0,3,2] row_mask:0xf bank_mask:0xf
    v_mov_b32_dpp v15, v27 quad_perm:[1,0,3,2] row_mask:0xf bank_mask:0xf
    v_med3_u32 v12, v24, v12, v6
    v_med3_u32 v13, v25, v13, v6
    v_med3_u32 v14, v26, v14, v6
    v_med3_u32 v15, v27, v15, v6
    v_max_u32 v8, v12, v14
    v_min_u32 v14, v12, v14
    v_max_u32 v9, v13, v15
    v_min_u32 v15, v13, v15
    v_max_u32 v10, v8, v9
    v_min_u32 v9, v8, v9
    v_max_u32 v11, v14, v15
    v_min_u32 v15, v14, v15
    s_nop 1
    v_max_u32_dpp v16, v15, v10 row_half_mirror row_mask:0xf bank_mask:0xf
    v_max_u32_dpp v17, v11, v9 row_half_mirror row_mask:0xf bank_mask:0xf
    v_max_u32_dpp v20, v9, v11 row_half_mirror row_mask:0xf bank_mask:0xf
    v_max_u32_dpp v18, v10, v15 row_half_mirror row_mask:0xf bank_mask:0xf
    v_mov_b32_dpp v22, v16 quad_perm:[1,0,3,2] row_mask:0xf bank_mask:0xf
    v_mov_b32_dpp v21, v17 quad_perm:[1,0,3,2] row_mask:0xf bank_mask:0xf
    v_mov_b32_dpp v23, v20 quad_perm:[1,0,3,2] row_mask:0xf bank_mask:0xf
    v_mov_b32_dpp v19, v18 quad_perm:[1,0,3,2] row_mask:0xf bank_mask:0xf
    v_med3_u32 v22, v16, v22, v6
    v_med3_u32 v21, v17, v21, v6
    v_med3_u32 v23, v20, v23, v6
    v_med3_u32 v19, v18, v19, v6
    v_max_u32 v24, v22, v23
    v_min_u32 v23, v22, v23
    v_max_u32 v25, v21, v19
    v_min_u32 v19, v21, v19
    v_max_u32 v26, v24, v25
    v_min_u32 v25, v24, v25
    v_max_u32 v27, v23, v19
    v_min_u32 v19, v23, v19
    s_nop 1
    v_max_u32_dpp v12, v19, v26 row_mirror row_mask:0xf bank_mask:0xf
    v_max_u32_dpp v13, v27, v25 row_mirror row_mask:0xf bank_mask:0xf
    v_max_u32_dpp v8, v25, v27 row_mirror row_mask:0xf bank_mask:0xf
    v_max_u32_dpp v14, v26, v19 row_mirror row_mask:0xf bank_mask:0xf
    ds_read_b32 v35, v4 offset:28
    v_cndmask_b32 v30, v12, v13, s[92:93]
    v_cndmask_b32 v31, v8, v14, s[92:93]
    v_cndmask_b32 v30, v30, v31, s[94:95]
    s_nop 1
    v_mov_b32_dpp v30, v30 row_shr:8 row_mask:0xf bank_mask:0xc
    v_and_b32 v31, 0x7ff, v30
    v_sub_u32 v31, 2047, v31
    v_mad_u32_u24 v31, v31, s96, v34
    s_waitcnt lgkmcnt(0)
    v_cmp_ne_u32 vcc, 0, v35
    s_cbranch_vccnz KS_RW1
W_91:
    ds_read_b32 v35, v4 offset:28
    s_sub_u32 s39, s39, 1
    s_cbranch_scc1 KS_ABORT
    s_waitcnt lgkmcnt(0)
    v_cmp_eq_u32 vcc, 0, v35
    s_cbranch_vccnz W_91
KS_RW1:
    s_mov_b32 m0, 17088
    s_nop 0
    buffer_load_dwordx4 v31, s[72:75], 0 offen offset:0 sc1 lds
    s_mov_b32 m0, 17984
    s_nop 0
    buffer_load_dwordx4 v31, s[72:75], 0 offen offset:128 sc1 lds
    s_mov_b32 m0, 18880
    s_nop 0
    buffer_load_dwordx4 v31, s[72:75], 0 offen offset:256 sc1 lds
    s_mov_b32 m0, 19776
    s_nop 0
    buffer_load_dwordx4 v31, s[72:75], 0 offen offset:384 sc1 lds
    s_mov_b32 m0, 20672
    s_nop 0
    buffer_load_dwordx4 v31, s[72:75], 0 offen offset:512 sc1 lds
    s_mov_b32 m0, 21568
    s_nop 0
    buffer_load_dwordx4 v31, s[72:75], 0 offen offset:640 sc1 lds
    s_mov_b32 m0, 22464
    s_nop 0
    buffer_load_dwordx4 v31, s[72:75], 0 offen offset:768 sc1 lds
    s_mov_b32 m0, 23360
    s_nop 0
    buffer_load_dwordx4 v31, s[72:75], 0 offen offset:896 sc1 lds
    s_mov_b32 m0, 24256
    s_nop 0
    buffer_load_dwordx4 v31, s[72:75], 0 offen offset:1024 sc1 lds
    ds_write_b32 v7, v30 offset:768
    s_waitcnt vmcnt(0)
    ds_write_b32 v4, v5 offset:32
    s_setprio 0
    s_branch KS_B
KS_W9:
    v_lshlrev_b32 v33, 4, v1
    s_movk_i32 s92, 0x2000
    s_add_u32 s72, s36, 0x300000
    s_addc_u32 s73, s37, 0
    s_mov_b32 s74, 0x240000
    s_mov_b32 s75, 0x20000
    s_add_u32 s64, s36, 0x600000
    s_addc_u32 s65, s37, 0
    s_mov_b32 s66, 0x240000
    s_mov_b32 s67, 0x20000
    s_mov_b32 s68, s4
    s_mov_b32 s69, s5
    s_mov_b32 s70, 0x240000
    s_mov_b32 s71, 0x20000
    v_bfe_u32 v43, v1, 2, 3
    s_lshl_b32 s93, s89, 3
    v_add_u32 v43, s93, v43
    v_bfe_u32 v40, v43, 4, 1
    v_and_b32 v41, 3, v1
    v_lshl_add_u32 v40, v40, 2, v41
    v_lshlrev_b32 v40, 2, v40
    v_lshrrev_b32 v41, 5, v43
    v_lshlrev_b32 v41, 4, v41
    v_and_b32 v42, 15, v43
    v_add_u32 v41, v41, v42
W_92:
    s_sleep 1
    ds_read_b32 v8, v4 offset:196
    s_sub_u32 s39, s39, 1
    s_cbranch_scc1 KS_ABORT
    s_waitcnt lgkmcnt(0)
    v_cmp_eq_u32 vcc, 0, v8
    s_cbranch_vccnz W_92
    s_sleep 8
    s_setprio 2
    s_branch ZPE_94
ZP_93:
    s_sleep 4
ZPE_94:
    buffer_load_dword v8, v33, s[76:79], s92 offen offset:0 sc1
    buffer_load_dword v9, v33, s[76:79], s92 offen offset:1024 sc1
    buffer_load_dword v10, v33, s[76:79], s92 offen offset:2048 sc1
    buffer_load_dword v11, v33, s[76:79], s92 offen offset:3072 sc1
    s_sub_u32 s39, s39, 1
    s_cbranch_scc1 KS_ABORT
    s_waitcnt vmcnt(0)
    v_max3_u32 v44, v8, v9, v10
    v_max_u32 v44, v44, v11
    v_cmp_eq_u32 vcc, -1, v44
    s_cbranch_vccnz ZP_93
    ds_write_b32 v4, v5 offset:28
    s_setprio 0
W_95:
    s_sleep 1
    ds_read_b32 v12, v7 offset:768
    s_sub_u32 s39, s39, 1
    s_cbranch_scc1 KS_ABORT
    s_waitcnt lgkmcnt(0)
    v_cmp_eq_u32 vcc, 0, v12
    s_cbranch_vccnz W_95
    ds_read_b32 v19, v40 offset:768
    s_waitcnt lgkmcnt(0)
    v_and_b32 v14, 0x7ff, v19
    v_sub_u32 v14, 2047, v14
    v_mul_u32_u24 v23, 1152, v14
    v_lshl_add_u32 v23, v41, 1, v23
    buffer_load_ushort v20, v23, s[72:75], 0 offen sc1
    buffer_load_ushort v17, v23, s[68:71], 0 offen
    v_lshrrev_b32 v15, 9, v14
    v_bfe_u32 v16, v14, 6, 2
    v_lshl_add_u32 v15, v15, 2, v16
    v_bfe_u32 v16, v14, 2, 2
    v_lshl_add_u32 v15, v15, 2, v16
    v_bfe_u32 v16, v14, 4, 1
    v_bfe_u32 v24, v14, 8, 1
    v_and_b32 v25, 3, v14
    v_lshl_add_u32 v24, v24, 2, v25
    v_lshlrev_b32 v24, 1, v24
    v_bfe_u32 v25, v14, 5, 1
    v_lshl_add_u32 v24, v25, 5, v24
    v_lshl_add_u32 v25, v15, 1, v16
    v_lshl_add_u32 v25, v25, 14, v24
    v_lshrrev_b32 v26, 1, v41
    v_lshl_add_u32 v25, v26, 6, v25
    v_xor_b32 v26, v41, v16
    v_not_b32 v26, v26
    v_and_b32 v26, 1, v26
    v_lshl_add_u32 v25, v26, 4, v25
    v_lshl_add_u32 v26, v15, 12, v24
    v_lshl_add_u32 v26, v16, 4, v26
    v_lshl_add_u32 v26, v41, 6, v26
    v_add_u32 v26, 2064384, v26
    v_lshl_add_u32 v27, v16, 6, v15
    v_lshlrev_b32 v27, 7, v27
    v_xor_b32 v25, v27, v25
    v_and_b32 v27, 0xf80, v27
    v_xor_b32 v26, v27, v26
    v_cmp_gt_u32 vcc, 0x200, v41
    s_nop 1
    v_cndmask_b32 v25, v26, v25, vcc
    buffer_load_ushort v18, v25, s[64:67], 0 offen sc1
    s_add_u32 s72, s36, 0xb10000
    s_addc_u32 s73, s37, 0
    s_mov_b32 s74, 0x40
    s_mov_b32 s75, 0x20000
    v_ashrrev_i32 v22, 31, v19
    v_not_b32 v22, v22
    v_or_b32 v22, 0x80000000, v22
    v_xor_b32 v22, v19, v22
    v_and_b32 v22, 0xffff0000, v22
    v_mul_f32 v22, 0xbfb8aa3b, v22
    v_exp_f32 v22, v22
    s_nop 0
    v_add_f32 v22, 1.0, v22
    v_rcp_f32 v22, v22
    s_nop 0
    v_cvt_pk_bf16_f32 v22, v22, v22
    v_lshlrev_b32 v22, 16, v22
    v_and_b32 v14, 31, v1
    v_lshlrev_b32 v14, 4, v14
    s_waitcnt vmcnt(0)
    v_lshlrev_b32 v17, 16, v17
    v_lshlrev_b32 v18, 16, v18
    v_add_f32 v17, v17, v18
    v_cvt_pk_bf16_f32 v17, v17, v17
    v_and_b32 v21, 0xffff0000, v17
    v_lshlrev_b32 v20, 16, v20
    ds_write_b128 v14, v[20:23] offset:1536
    s_cmp_lg_u32 s2, 0
    s_cbranch_scc1 KS_W9E
    buffer_store_dword v12, v7, s[72:75], 0 offen
KS_W9E:
    s_waitcnt lgkmcnt(0)
    s_endpgm
KS_B:
    s_add_u32 s64, s36, 0x850000
    s_addc_u32 s65, s37, 0
    s_mov_b32 s66, 0x28c800
    s_mov_b32 s67, 0x20000
    v_bfe_u32 v16, v1, 2, 2
    v_lshl_add_u32 v16, v3, 3, v16
    v_mul_u32_u24 v16, 1152, v16
    v_and_b32 v17, 3, v1
    v_lshl_add_u32 v16, v17, 3, v16
    s_lshl_b32 s92, s38, 7
    s_add_u32 s92, s92, 109184
    v_add_u32 v16, s92, v16
    v_lshlrev_b32 v18, 2, v17
    ds_read_b32 v24, v18 offset:224
    s_movk_i32 s94, 0xff
W_96:
    ds_read_b32 v17, v4 offset:40
    s_sub_u32 s39, s39, 1
    s_cbranch_scc1 KS_ABORT
    s_waitcnt lgkmcnt(0)
    v_cmp_ne_u32 vcc, s84, v17
    s_cbranch_vccnz W_96
    v_lshrrev_b32 v25, 8, v24
    v_lshrrev_b32 v26, 16, v24
    v_lshrrev_b32 v27, 24, v24
    ds_read_b64_tr_b16 v[48:49], v16 offset:0
    ds_read_b64_tr_b16 v[50:51], v16 offset:4608
    ds_read_b64_tr_b16 v[52:53], v16 offset:32
    ds_read_b64_tr_b16 v[54:55], v16 offset:4640
    ds_read_b64_tr_b16 v[56:57], v16 offset:64
    ds_read_b64_tr_b16 v[58:59], v16 offset:4672
    ds_read_b64_tr_b16 v[60:61], v16 offset:96
    ds_read_b64_tr_b16 v[62:63], v16 offset:4704
    v_and_b32 v16, 7, v2
    v_lshlrev_b32 v16, 6, v16
    v_lshl_add_u32 v16, v3, 4, v16
    s_mul_i32 s92, s89, 18560
    s_lshl_b32 s93, s38, 11
    s_add_u32 s92, s92, s93
    v_lshlrev_b32 v17, 4, v1
    s_waitcnt lgkmcnt(0)
    s_barrier
    s_barrier
    ds_read_b128 v[20:23], v16 offset:1024
    s_waitcnt lgkmcnt(0)
    v_mfma_f32_16x16x32_bf16 v[32:35], v[20:23], v[48:51], 0
    v_mfma_f32_16x16x32_bf16 v[36:39], v[20:23], v[52:55], 0
    v_mfma_f32_16x16x32_bf16 v[40:43], v[20:23], v[56:59], 0
    v_mfma_f32_16x16x32_bf16 v[44:47], v[20:23], v[60:63], 0
    s_nop 5
    v_permlane32_swap_b32 v32, v36
    v_permlane32_swap_b32 v33, v37
    v_permlane32_swap_b32 v34, v38
    v_permlane32_swap_b32 v35, v39
    v_bfi_b32 v32, s94, v24, v32
    v_bfi_b32 v33, s94, v25, v33
    v_bfi_b32 v34, s94, v26, v34
    v_bfi_b32 v35, s94, v27, v35
    buffer_store_dwordx4 v[32:35], v17, s[64:67], s92 offen offset:0 sc1
    v_permlane32_swap_b32 v40, v44
    v_permlane32_swap_b32 v41, v45
    v_permlane32_swap_b32 v42, v46
    v_permlane32_swap_b32 v43, v47
    v_bfi_b32 v40, s94, v24, v40
    v_bfi_b32 v41, s94, v25, v41
    v_bfi_b32 v42, s94, v26, v42
    v_bfi_b32 v43, s94, v27, v43
    buffer_store_dwordx4 v[40:43], v17, s[64:67], s92 offen offset:1024 sc1
    s_waitcnt vmcnt(0)
    s_barrier
    s_endpgm
KS_G0:
    ds_write_b8 v15, v5 offset:68
    s_setprio 0
KS_G:
    s_mov_b32 s98, 0x05040100
    s_mov_b32 s99, 0x07060302
    s_waitcnt vmcnt(0)
    s_sub_u32 s87, s38, 12
    s_mul_i32 s92, s87, 9
    s_add_u32 s92, s92, 1
    s_lshr_b32 s86, s92, 1
    s_lshl_b32 s92, s86, 5
    v_lshl_add_u32 v7, v3, 3, s92
    v_mul_u32_u24 v7, 9216, v7
    v_and_b32 v6, 7, v2
    v_lshl_add_u32 v7, v6, 3, v7
    s_lshl_b32 s92, s89, 6
    v_add_u32 v7, s92, v7
    v_cmp_gt_u32 vcc, 8, v2
    s_mov_b32 s76, 9216
    s_mov_b32 s77, 0
    s_mov_b32 s78, 230400
    s_mov_b32 s79, 0
    v_mov_b32 v46, s26
    v_mov_b32 v47, s27
    v_mov_b32 v6, s28
    v_cndmask_b32 v46, v6, v46, vcc
    v_mov_b32 v6, s29
    v_cndmask_b32 v47, v6, v47, vcc
    v_add_co_u32 v46, vcc, v46, v7
    s_nop 1
    v_addc_co_u32 v47, vcc, 0, v47, vcc
    s_mov_b32 s68, s30
    s_mov_b32 s69, s31
    s_mov_b32 s70, 0x510000
    s_mov_b32 s71, 0x20000
    v_lshlrev_b32 v8, 4, v1
    s_mul_i32 s92, s89, 36864
    s_mul_i32 s93, s87, 9216
    s_add_u32 s92, s92, s93
    s_add_u32 s93, s93, 109184
    s_cmp_lt_u32 s41, 8
    s_cselect_b32 s94, 0, 100
    v_mov_b32 v9, s94
W_97:
    s_sleep 2
    ds_read_b32 v10, v9 offset:100
    s_sub_u32 s39, s39, 1
    s_cbranch_scc1 KS_ABORT
    s_waitcnt lgkmcnt(0)
    v_cmp_ne_u32 vcc, s84, v10
    s_cbranch_vccnz W_97
    s_cmp_ge_u32 s41, 8
    s_cbranch_scc1 KS_GD1
    s_add_u32 m0, s93, 0
    s_nop 0
    buffer_load_dwordx4 v8, s[68:71], s92 offen offset:0 nt lds
    buffer_load_dwordx4 v8, s[68:71], s92 offen offset:1024 nt lds
    buffer_load_dwordx4 v8, s[68:71], s92 offen offset:2048 nt lds
    buffer_load_dwordx4 v8, s[68:71], s92 offen offset:3072 nt lds
    s_add_u32 m0, s93, 4096
    s_add_u32 s92, s92, 4096
    buffer_load_dwordx4 v8, s[68:71], s92 offen offset:0 nt lds
    buffer_load_dwordx4 v8, s[68:71], s92 offen offset:1024 nt lds
    buffer_load_dwordx4 v8, s[68:71], s92 offen offset:2048 nt lds
    buffer_load_dwordx4 v8, s[68:71], s92 offen offset:3072 nt lds
    s_add_u32 m0, s93, 8192
    s_add_u32 s92, s92, 4096
    buffer_load_dwordx4 v8, s[68:71], s92 offen offset:0 nt lds
KS_GD1:
    s_lshr_b32 s92, 12, s87
    s_bitcmp1_b32 s92, 0
    s_cbranch_scc0 GT_98
W_99:
    s_sleep 2
    ds_read_b32 v10, v4 offset:52
    s_sub_u32 s39, s39, 1
    s_cbranch_scc1 KS_ABORT
    s_waitcnt lgkmcnt(0)
    v_cmp_ne_u32 vcc, s84, v10
    s_cbranch_vccnz W_99
    s_setprio 1
GT_98:
    s_lshr_b32 s92, 3, s87
    s_bitcmp1_b32 s92, 0
    s_cbranch_scc0 KS_GN0
    global_load_dwordx2 v[48:49], v[46:47], off nt
    v_lshl_add_u64 v[46:47], v[46:47], 0, s[76:77]
    global_load_dwordx2 v[50:51], v[46:47], off nt
    v_lshl_add_u64 v[46:47], v[46:47], 0, s[76:77]
    global_load_dwordx2 v[52:53], v[46:47], off nt
    v_lshl_add_u64 v[46:47], v[46:47], 0, s[76:77]
    global_load_dwordx2 v[54:55], v[46:47], off nt
    v_lshl_add_u64 v[46:47], v[46:47], 0, s[76:77]
    global_load_dwordx2 v[56:57], v[46:47], off nt
    v_lshl_add_u64 v[46:47], v[46:47], 0, s[76:77]
    global_load_dwordx2 v[58:59], v[46:47], off nt
    v_lshl_add_u64 v[46:47], v[46:47], 0, s[76:77]
    global_load_dwordx2 v[60:61], v[46:47], off nt
    v_lshl_add_u64 v[46:47], v[46:47], 0, s[76:77]
    global_load_dwordx2 v[62:63], v[46:47], off nt
    v_lshl_add_u64 v[46:47], v[46:47], 0, s[78:79]
    global_load_dwordx2 v[64:65], v[46:47], off nt
    v_lshl_add_u64 v[46:47], v[46:47], 0, s[76:77]
    global_load_dwordx2 v[66:67], v[46:47], off nt
    v_lshl_add_u64 v[46:47], v[46:47], 0, s[76:77]
    global_load_dwordx2 v[68:69], v[46:47], off nt
    v_lshl_add_u64 v[46:47], v[46:47], 0, s[76:77]
    global_load_dwordx2 v[70:71], v[46:47], off nt
    v_lshl_add_u64 v[46:47], v[46:47], 0, s[76:77]
    global_load_dwordx2 v[72:73], v[46:47], off nt
    v_lshl_add_u64 v[46:47], v[46:47], 0, s[76:77]
    global_load_dwordx2 v[74:75], v[46:47], off nt
    v_lshl_add_u64 v[46:47], v[46:47], 0, s[76:77]
    global_load_dwordx2 v[76:77], v[46:47], off nt
    v_lshl_add_u64 v[46:47], v[46:47], 0, s[76:77]
    global_load_dwordx2 v[78:79], v[46:47], off nt
    v_lshl_add_u64 v[46:47], v[46:47], 0, s[78:79]
    global_load_dwordx2 v[80:81], v[46:47], off nt
    v_lshl_add_u64 v[46:47], v[46:47], 0, s[76:77]
    global_load_dwordx2 v[82:83], v[46:47], off nt
    v_lshl_add_u64 v[46:47], v[46:47], 0, s[76:77]
    global_load_dwordx2 v[84:85], v[46:47], off nt
    v_lshl_add_u64 v[46:47], v[46:47], 0, s[76:77]
    global_load_dwordx2 v[86:87], v[46:47], off nt
    v_lshl_add_u64 v[46:47], v[46:47], 0, s[76:77]
    global_load_dwordx2 v[88:89], v[46:47], off nt
    v_lshl_add_u64 v[46:47], v[46:47], 0, s[76:77]
    global_load_dwordx2 v[90:91], v[46:47], off nt
    v_lshl_add_u64 v[46:47], v[46:47], 0, s[76:77]
    global_load_dwordx2 v[92:93], v[46:47], off nt
    v_lshl_add_u64 v[46:47], v[46:47], 0, s[76:77]
    global_load_dwordx2 v[94:95], v[46:47], off nt
    v_lshl_add_u64 v[46:47], v[46:47], 0, s[78:79]
    global_load_dwordx2 v[96:97], v[46:47], off nt
    v_lshl_add_u64 v[46:47], v[46:47], 0, s[76:77]
    global_load_dwordx2 v[98:99], v[46:47], off nt
    v_lshl_add_u64 v[46:47], v[46:47], 0, s[76:77]
    global_load_dwordx2 v[100:101], v[46:47], off nt
    v_lshl_add_u64 v[46:47], v[46:47], 0, s[76:77]
    global_load_dwordx2 v[102:103], v[46:47], off nt
    v_lshl_add_u64 v[46:47], v[46:47], 0, s[76:77]
    global_load_dwordx2 v[104:105], v[46:47], off nt
    v_lshl_add_u64 v[46:47], v[46:47], 0, s[76:77]
    global_load_dwordx2 v[106:107], v[46:47], off nt
    v_lshl_add_u64 v[46:47], v[46:47], 0, s[76:77]
    global_load_dwordx2 v[108:109], v[46:47], off nt
    v_lshl_add_u64 v[46:47], v[46:47], 0, s[76:77]
    global_load_dwordx2 v[110:111], v[46:47], off nt
    v_lshl_add_u64 v[46:47], v[46:47], 0, s[78:79]
    s_bitcmp1_b32 s87, 0
    s_cbranch_scc1 KS_G4
    global_load_dwordx2 v[112:113], v[46:47], off nt
    v_lshl_add_u64 v[46:47], v[46:47], 0, s[76:77]
    global_load_dwordx2 v[114:115], v[46:47], off nt
    v_lshl_add_u64 v[46:47], v[46:47], 0, s[76:77]
    global_load_dwordx2 v[116:117], v[46:47], off nt
    v_lshl_add_u64 v[46:47], v[46:47], 0, s[76:77]
    global_load_dwordx2 v[118:119], v[46:47], off nt
    v_lshl_add_u64 v[46:47], v[46:47], 0, s[76:77]
    global_load_dwordx2 v[120:121], v[46:47], off nt
    v_lshl_add_u64 v[46:47], v[46:47], 0, s[76:77]
    global_load_dwordx2 v[122:123], v[46:47], off nt
    v_lshl_add_u64 v[46:47], v[46:47], 0, s[76:77]
    global_load_dwordx2 v[124:125], v[46:47], off nt
    v_lshl_add_u64 v[46:47], v[46:47], 0, s[76:77]
    global_load_dwordx2 v[126:127], v[46:47], off nt
    s_branch KS_G4
KS_GN0:
    global_load_dwordx2 v[48:49], v[46:47], off
    v_lshl_add_u64 v[46:47], v[46:47], 0, s[76:77]
    global_load_dwordx2 v[50:51], v[46:47], off
    v_lshl_add_u64 v[46:47], v[46:47], 0, s[76:77]
    global_load_dwordx2 v[52:53], v[46:47], off
    v_lshl_add_u64 v[46:47], v[46:47], 0, s[76:77]
    global_load_dwordx2 v[54:55], v[46:47], off
    v_lshl_add_u64 v[46:47], v[46:47], 0, s[76:77]
    global_load_dwordx2 v[56:57], v[46:47], off
    v_lshl_add_u64 v[46:47], v[46:47], 0, s[76:77]
    global_load_dwordx2 v[58:59], v[46:47], off
    v_lshl_add_u64 v[46:47], v[46:47], 0, s[76:77]
    global_load_dwordx2 v[60:61], v[46:47], off
    v_lshl_add_u64 v[46:47], v[46:47], 0, s[76:77]
    global_load_dwordx2 v[62:63], v[46:47], off
    v_lshl_add_u64 v[46:47], v[46:47], 0, s[78:79]
    global_load_dwordx2 v[64:65], v[46:47], off
    v_lshl_add_u64 v[46:47], v[46:47], 0, s[76:77]
    global_load_dwordx2 v[66:67], v[46:47], off
    v_lshl_add_u64 v[46:47], v[46:47], 0, s[76:77]
    global_load_dwordx2 v[68:69], v[46:47], off
    v_lshl_add_u64 v[46:47], v[46:47], 0, s[76:77]
    global_load_dwordx2 v[70:71], v[46:47], off
    v_lshl_add_u64 v[46:47], v[46:47], 0, s[76:77]
    global_load_dwordx2 v[72:73], v[46:47], off
    v_lshl_add_u64 v[46:47], v[46:47], 0, s[76:77]
    global_load_dwordx2 v[74:75], v[46:47], off
    v_lshl_add_u64 v[46:47], v[46:47], 0, s[76:77]
    global_load_dwordx2 v[76:77], v[46:47], off
    v_lshl_add_u64 v[46:47], v[46:47], 0, s[76:77]
    global_load_dwordx2 v[78:79], v[46:47], off
    v_lshl_add_u64 v[46:47], v[46:47], 0, s[78:79]
    global_load_dwordx2 v[80:81], v[46:47], off
    v_lshl_add_u64 v[46:47], v[46:47], 0, s[76:77]
    global_load_dwordx2 v[82:83], v[46:47], off
    v_lshl_add_u64 v[46:47], v[46:47], 0, s[76:77]
    global_load_dwordx2 v[84:85], v[46:47], off
    v_lshl_add_u64 v[46:47], v[46:47], 0, s[76:77]
    global_load_dwordx2 v[86:87], v[46:47], off
    v_lshl_add_u64 v[46:47], v[46:47], 0, s[76:77]
    global_load_dwordx2 v[88:89], v[46:47], off
    v_lshl_add_u64 v[46:47], v[46:47], 0, s[76:77]
    global_load_dwordx2 v[90:91], v[46:47], off
    v_lshl_add_u64 v[46:47], v[46:47], 0, s[76:77]
    global_load_dwordx2 v[92:93], v[46:47], off
    v_lshl_add_u64 v[46:47], v[46:47], 0, s[76:77]
    global_load_dwordx2 v[94:95], v[46:47], off
    v_lshl_add_u64 v[46:47], v[46:47], 0, s[78:79]
    global_load_dwordx2 v[96:97], v[46:47], off
    v_lshl_add_u64 v[46:47], v[46:47], 0, s[76:77]
    global_load_dwordx2 v[98:99], v[46:47], off
    v_lshl_add_u64 v[46:47], v[46:47], 0, s[76:77]
    global_load_dwordx2 v[100:101], v[46:47], off
    v_lshl_add_u64 v[46:47], v[46:47], 0, s[76:77]
    global_load_dwordx2 v[102:103], v[46:47], off
    v_lshl_add_u64 v[46:47], v[46:47], 0, s[76:77]
    global_load_dwordx2 v[104:105], v[46:47], off
    v_lshl_add_u64 v[46:47], v[46:47], 0, s[76:77]
    global_load_dwordx2 v[106:107], v[46:47], off
    v_lshl_add_u64 v[46:47], v[46:47], 0, s[76:77]
    global_load_dwordx2 v[108:109], v[46:47], off
    v_lshl_add_u64 v[46:47], v[46:47], 0, s[76:77]
    global_load_dwordx2 v[110:111], v[46:47], off
    v_lshl_add_u64 v[46:47], v[46:47], 0, s[78:79]
    s_bitcmp1_b32 s87, 0
    s_cbranch_scc1 KS_G4
    global_load_dwordx2 v[112:113], v[46:47], off
    v_lshl_add_u64 v[46:47], v[46:47], 0, s[76:77]
    global_load_dwordx2 v[114:115], v[46:47], off
    v_lshl_add_u64 v[46:47], v[46:47], 0, s[76:77]
    global_load_dwordx2 v[116:117], v[46:47], off
    v_lshl_add_u64 v[46:47], v[46:47], 0, s[76:77]
    global_load_dwordx2 v[118:119], v[46:47], off
    v_lshl_add_u64 v[46:47], v[46:47], 0, s[76:77]
    global_load_dwordx2 v[120:121], v[46:47], off
    v_lshl_add_u64 v[46:47], v[46:47], 0, s[76:77]
    global_load_dwordx2 v[122:123], v[46:47], off
    v_lshl_add_u64 v[46:47], v[46:47], 0, s[76:77]
    global_load_dwordx2 v[124:125], v[46:47], off
    v_lshl_add_u64 v[46:47], v[46:47], 0, s[76:77]
    global_load_dwordx2 v[126:127], v[46:47], off
KS_G4:
    v_mov_b32 v6, s87
    ds_write_b8 v6, v5 offset:192
    s_waitcnt vmcnt(0)
    ds_write_b8 v6, v5 offset:40
    v_perm_b32 v32, v50, v48, s98
    v_perm_b32 v33, v54, v52, s98
    v_perm_b32 v34, v58, v56, s98
    v_perm_b32 v35, v62, v60, s98
    v_perm_b32 v36, v50, v48, s99
    v_perm_b32 v37, v54, v52, s99
    v_perm_b32 v38, v58, v56, s99
    v_perm_b32 v39, v62, v60, s99
    v_perm_b32 v40, v51, v49, s98
    v_perm_b32 v41, v55, v53, s98
    v_perm_b32 v42, v59, v57, s98
    v_perm_b32 v43, v63, v61, s98
    v_perm_b32 v44, v51, v49, s99
    v_perm_b32 v45, v55, v53, s99
    v_perm_b32 v46, v59, v57, s99
    v_perm_b32 v47, v63, v61, s99
    v_perm_b32 v48, v66, v64, s98
    v_perm_b32 v49, v70, v68, s98
    v_perm_b32 v50, v74, v72, s98
    v_perm_b32 v51, v78, v76, s98
    v_perm_b32 v52, v66, v64, s99
    v_perm_b32 v53, v70, v68, s99
    v_perm_b32 v54, v74, v72, s99
    v_perm_b32 v55, v78, v76, s99
    v_perm_b32 v56, v67, v65, s98
    v_perm_b32 v57, v71, v69, s98
    v_perm_b32 v58, v75, v73, s98
    v_perm_b32 v59, v79, v77, s98
    v_perm_b32 v60, v67, v65, s99
    v_perm_b32 v61, v71, v69, s99
    v_perm_b32 v62, v75, v73, s99
    v_perm_b32 v63, v79, v77, s99
    v_perm_b32 v64, v82, v80, s98
    v_perm_b32 v65, v86, v84, s98
    v_perm_b32 v66, v90, v88, s98
    v_perm_b32 v67, v94, v92, s98
    v_perm_b32 v68, v82, v80, s99
    v_perm_b32 v69, v86, v84, s99
    v_perm_b32 v70, v90, v88, s99
    v_perm_b32 v71, v94, v92, s99
    v_perm_b32 v72, v83, v81, s98
    v_perm_b32 v73, v87, v85, s98
    v_perm_b32 v74, v91, v89, s98
    v_perm_b32 v75, v95, v93, s98
    v_perm_b32 v76, v83, v81, s99
    v_perm_b32 v77, v87, v85, s99
    v_perm_b32 v78, v91, v89, s99
    v_perm_b32 v79, v95, v93, s99
    v_perm_b32 v80, v98, v96, s98
    v_perm_b32 v81, v102, v100, s98
    v_perm_b32 v82, v106, v104, s98
    v_perm_b32 v83, v110, v108, s98
    v_perm_b32 v84, v98, v96, s99
    v_perm_b32 v85, v102, v100, s99
    v_perm_b32 v86, v106, v104, s99
    v_perm_b32 v87, v110, v108, s99
    v_perm_b32 v88, v99, v97, s98
    v_perm_b32 v89, v103, v101, s98
    v_perm_b32 v90, v107, v105, s98
    v_perm_b32 v91, v111, v109, s98
    v_perm_b32 v92, v99, v97, s99
    v_perm_b32 v93, v103, v101, s99
    v_perm_b32 v94, v107, v105, s99
    v_perm_b32 v95, v111, v109, s99
    v_perm_b32 v96, v114, v112, s98
    v_perm_b32 v97, v118, v116, s98
    v_perm_b32 v98, v122, v120, s98
    v_perm_b32 v99, v126, v124, s98
    v_perm_b32 v100, v114, v112, s99
    v_perm_b32 v101, v118, v116, s99
    v_perm_b32 v102, v122, v120, s99
    v_perm_b32 v103, v126, v124, s99
    v_perm_b32 v104, v115, v113, s98
    v_perm_b32 v105, v119, v117, s98
    v_perm_b32 v106, v123, v121, s98
    v_perm_b32 v107, v127, v125, s98
    v_perm_b32 v108, v115, v113, s99
    v_perm_b32 v109, v119, v117, s99
    v_perm_b32 v110, v123, v121, s99
    v_perm_b32 v111, v127, v125, s99
    s_lshl_b32 s92, s86, 9
    s_add_u32 s92, s92, 17088
    v_and_b32 v6, 7, v2
    v_lshl_add_u32 v7, v6, 4, s92
    v_lshl_add_u32 v7, v3, 7, v7
    s_lshl_b32 s92, s87, 6
    v_add_u32 v11, s92, v1
    v_lshrrev_b32 v8, 5, v11
    v_and_b32 v9, 31, v11
    v_and_b32 v10, 3, v9
    v_lshlrev_b32 v10, 9, v10
    v_lshrrev_b32 v9, 2, v9
    v_lshl_add_u32 v10, v9, 4, v10
    v_lshrrev_b32 v9, 2, v8
    v_lshl_add_u32 v10, v9, 8, v10
    v_and_b32 v9, 3, v8
    v_lshl_add_u32 v10, v9, 2, v10
    v_lshlrev_b32 v11, 1, v11
    s_lshl_b32 s92, s87, 11
    v_lshl_add_u32 v9, v1, 4, s92
W_100:
    s_sleep 2
    ds_read_b32 v12, v4 offset:768
    s_sub_u32 s39, s39, 1
    s_cbranch_scc1 KS_ABORT
    s_waitcnt lgkmcnt(0)
    v_cmp_eq_u32 vcc, 0, v12
    s_cbranch_vccnz W_100
    s_setprio 2
W_101:
    ds_read_b32 v12, v4 offset:32
    s_sub_u32 s39, s39, 1
    s_cbranch_scc1 KS_ABORT
    s_waitcnt lgkmcnt(0)
    v_cmp_eq_u32 vcc, 0, v12
    s_cbranch_vccnz W_101
    ds_read_b128 v[12:15], v7 offset:0
    ds_read_b128 v[16:19], v7 offset:512
    ds_read_b128 v[20:23], v7 offset:1024
    ds_read_b128 v[24:27], v7 offset:1536
    ds_read_b128 v[28:31], v7 offset:2048
    s_waitcnt lgkmcnt(4)
    v_mfma_f32_16x16x32_bf16 v[112:115], v[12:15], v[32:35], 0
    v_mfma_f32_16x16x32_bf16 v[116:119], v[12:15], v[36:39], 0
    v_mfma_f32_16x16x32_bf16 v[120:123], v[12:15], v[40:43], 0
    v_mfma_f32_16x16x32_bf16 v[124:127], v[12:15], v[44:47], 0
    s_waitcnt lgkmcnt(3)
    v_mfma_f32_16x16x32_bf16 v[112:115], v[16:19], v[48:51], v[112:115]
    v_mfma_f32_16x16x32_bf16 v[116:119], v[16:19], v[52:55], v[116:119]
    v_mfma_f32_16x16x32_bf16 v[120:123], v[16:19], v[56:59], v[120:123]
    v_mfma_f32_16x16x32_bf16 v[124:127], v[16:19], v[60:63], v[124:127]
    s_waitcnt lgkmcnt(2)
    v_mfma_f32_16x16x32_bf16 v[112:115], v[20:23], v[64:67], v[112:115]
    v_mfma_f32_16x16x32_bf16 v[116:119], v[20:23], v[68:71], v[116:119]
    v_mfma_f32_16x16x32_bf16 v[120:123], v[20:23], v[72:75], v[120:123]
    v_mfma_f32_16x16x32_bf16 v[124:127], v[20:23], v[76:79], v[124:127]
    s_waitcnt lgkmcnt(1)
    v_mfma_f32_16x16x32_bf16 v[112:115], v[24:27], v[80:83], v[112:115]
    v_mfma_f32_16x16x32_bf16 v[116:119], v[24:27], v[84:87], v[116:119]
    v_mfma_f32_16x16x32_bf16 v[120:123], v[24:27], v[88:91], v[120:123]
    v_mfma_f32_16x16x32_bf16 v[124:127], v[24:27], v[92:95], v[124:127]
    s_bitcmp1_b32 s87, 0
    s_cbranch_scc1 KS_G5
    s_waitcnt lgkmcnt(0)
    v_mfma_f32_16x16x32_bf16 v[112:115], v[28:31], v[96:99], v[112:115]
    v_mfma_f32_16x16x32_bf16 v[116:119], v[28:31], v[100:103], v[116:119]
    v_mfma_f32_16x16x32_bf16 v[120:123], v[28:31], v[104:107], v[120:123]
    v_mfma_f32_16x16x32_bf16 v[124:127], v[28:31], v[108:111], v[124:127]
KS_G5:
    s_mov_b32 exec_lo, -1
    s_mov_b32 exec_hi, 0
    s_nop 5
    ds_write_b128 v9, v[112:115] offset:26368
    ds_write_b128 v9, v[116:119] offset:26880
    ds_write_b128 v9, v[120:123] offset:27392
    ds_write_b128 v9, v[124:127] offset:27904
    s_mov_b64 exec, -1
    s_waitcnt lgkmcnt(0)
    s_barrier
    ds_read_b32 v32, v10 offset:26368
    ds_read_b32 v33, v10 offset:26496
    ds_read_b32 v34, v10 offset:28416
    ds_read_b32 v35, v10 offset:28544
    ds_read_b32 v36, v10 offset:30464
    ds_read_b32 v37, v10 offset:30592
    ds_read_b32 v38, v10 offset:32512
    ds_read_b32 v39, v10 offset:32640
    s_waitcnt lgkmcnt(4)
    v_pk_add_f32 v[32:33], v[32:33], v[34:35]
    s_waitcnt lgkmcnt(0)
    v_pk_add_f32 v[36:37], v[36:37], v[38:39]
    v_pk_add_f32 v[32:33], v[32:33], v[36:37]
    v_cvt_pk_bf16_f32 v34, v32, v33
    v_lshlrev_b32 v32, 16, v34
    v_and_b32 v33, 0xffff0000, v34
    v_mul_f32 v34, 0xbfb8aa3b, v32
    v_exp_f32 v34, v34
    s_nop 0
    v_add_f32 v34, 1.0, v34
    v_rcp_f32 v34, v34
    s_nop 0
    v_mul_f32 v34, v32, v34
    v_cvt_pk_bf16_f32 v34, v34, v34
    v_lshlrev_b32 v34, 16, v34
    v_mul_f32 v34, v34, v33
    v_cvt_pk_bf16_f32 v34, v34, v34
    ds_write_b16 v11, v34 offset:1024
    s_waitcnt lgkmcnt(0)
    s_barrier
    s_branch KS_P2
KS_P:
    s_branch KS_P1
    s_mov_b32 s68, s30
    s_mov_b32 s69, s31
    s_mov_b32 s70, 0x510000
    s_mov_b32 s71, 0x20000
    s_sub_u32 s94, s38, 10
    v_lshlrev_b32 v6, 4, v1
    s_mul_i32 s92, s89, 36864
    s_mul_i32 s93, s94, 18432
    s_add_u32 s92, s92, s93
    s_add_u32 s93, s93, 109184
    s_lshl_b32 s94, s94, 1
    v_mov_b32 v7, s94
    v_mov_b32 v8, s84
W_102:
    s_sleep 2
    ds_read_b32 v10, v4 offset:20
    s_sub_u32 s39, s39, 1
    s_cbranch_scc1 KS_ABORT
    s_waitcnt lgkmcnt(0)
    v_cmp_ne_u32 vcc, s84, v10
    s_cbranch_vccnz W_102
    s_setprio 1
    s_add_u32 m0, s93, 0
    s_nop 0
    buffer_load_dwordx4 v6, s[68:71], s92 offen offset:0 nt lds
    buffer_load_dwordx4 v6, s[68:71], s92 offen offset:1024 nt lds
    buffer_load_dwordx4 v6, s[68:71], s92 offen offset:2048 nt lds
    buffer_load_dwordx4 v6, s[68:71], s92 offen offset:3072 nt lds
    s_add_u32 m0, s93, 4096
    s_add_u32 s92, s92, 4096
    buffer_load_dwordx4 v6, s[68:71], s92 offen offset:0 nt lds
    buffer_load_dwordx4 v6, s[68:71], s92 offen offset:1024 nt lds
    buffer_load_dwordx4 v6, s[68:71], s92 offen offset:2048 nt lds
    buffer_load_dwordx4 v6, s[68:71], s92 offen offset:3072 nt lds
    s_add_u32 m0, s93, 8192
    s_add_u32 s92, s92, 4096
    buffer_load_dwordx4 v6, s[68:71], s92 offen offset:0 nt lds
    buffer_load_dwordx4 v6, s[68:71], s92 offen offset:1024 nt lds
    buffer_load_dwordx4 v6, s[68:71], s92 offen offset:2048 nt lds
    buffer_load_dwordx4 v6, s[68:71], s92 offen offset:3072 nt lds
    s_add_u32 m0, s93, 12288
    s_add_u32 s92, s92, 4096
    buffer_load_dwordx4 v6, s[68:71], s92 offen offset:0 nt lds
    buffer_load_dwordx4 v6, s[68:71], s92 offen offset:1024 nt lds
    buffer_load_dwordx4 v6, s[68:71], s92 offen offset:2048 nt lds
    buffer_load_dwordx4 v6, s[68:71], s92 offen offset:3072 nt lds
    s_add_u32 m0, s93, 16384
    s_add_u32 s92, s92, 4096
    buffer_load_dwordx4 v6, s[68:71], s92 offen offset:0 nt lds
    buffer_load_dwordx4 v6, s[68:71], s92 offen offset:1024 nt lds
    s_waitcnt vmcnt(0)
    ds_write_b16 v7, v8 offset:40
KS_P1:
    s_setprio 0
    s_waitcnt lgkmcnt(0)
    s_barrier
    s_barrier
    s_setprio 2
KS_P2:
    s_sub_u32 s87, s38, 10
    s_add_u32 s64, s36, 0x850000
    s_addc_u32 s65, s37, 0
    s_mov_b32 s66, 0x28c800
    s_mov_b32 s67, 0x20000
    s_mov_b32 s68, s32
    s_mov_b32 s69, s33
    s_mov_b32 s70, 0x240000
    s_mov_b32 s71, 0x20000
    v_lshrrev_b32 v8, 3, v1
    v_mul_u32_u24 v8, 18560, v8
    v_and_b32 v9, 7, v1
    v_lshl_add_u32 v8, v9, 4, v8
    s_mul_i32 s92, s87, 445440
    s_lshl_b32 s93, s89, 7
    s_add_u32 s92, s92, s93
    s_add_u32 s93, s92, 148480
    s_add_u32 s94, s92, 296960
    s_lshl_b32 s95, s87, 7
    v_lshl_add_u32 v6, v9, 4, s95
    v_lshl_add_u32 v6, v3, 2, v6
    v_lshlrev_b32 v12, 2, v1
    v_add_u32 v12, 2048, v12
    v_lshlrev_b32 v13, 4, v1
    v_and_b32 v14, 12, v12
    ds_read_b32 v24, v14 offset:224
    s_waitcnt lgkmcnt(0)
    v_lshrrev_b32 v25, 8, v24
    v_lshrrev_b32 v26, 16, v24
    v_lshrrev_b32 v27, 24, v24
    s_barrier
    s_branch PPE_104
PP_103:
    s_sleep 1
PPE_104:
    buffer_load_dwordx4 v[32:35], v8, s[64:67], s92 offen sc1
    buffer_load_dwordx4 v[36:39], v8, s[64:67], s93 offen sc1
    buffer_load_dwordx4 v[40:43], v8, s[64:67], s94 offen sc1
    s_sub_u32 s39, s39, 1
    s_cbranch_scc1 KS_ABORT
    s_waitcnt vmcnt(2)
    v_xor_b32 v44, v24, v32
    v_xor_b32 v45, v25, v33
    v_bitop3_b32 v44, v44, v26, v34 bitop3:0xf6
    v_bitop3_b32 v45, v45, v27, v35 bitop3:0xf6
    s_waitcnt vmcnt(1)
    v_bitop3_b32 v44, v44, v24, v36 bitop3:0xf6
    v_bitop3_b32 v45, v45, v25, v37 bitop3:0xf6
    v_bitop3_b32 v44, v44, v26, v38 bitop3:0xf6
    v_bitop3_b32 v45, v45, v27, v39 bitop3:0xf6
    s_waitcnt vmcnt(0)
    v_bitop3_b32 v44, v44, v24, v40 bitop3:0xf6
    v_bitop3_b32 v45, v45, v25, v41 bitop3:0xf6
    v_bitop3_b32 v44, v44, v26, v42 bitop3:0xf6
    v_bitop3_b32 v45, v45, v27, v43 bitop3:0xf6
    v_or_b32 v44, v44, v45
    v_and_b32 v44, 0xff, v44
    v_cmp_ne_u32 vcc, 0, v44
    s_cbranch_vccnz PP_103
    v_pk_add_f32 v[32:33], v[32:33], v[36:37]
    v_pk_add_f32 v[34:35], v[34:35], v[38:39]
    v_pk_add_f32 v[32:33], v[32:33], v[40:41]
    v_pk_add_f32 v[34:35], v[34:35], v[42:43]
    s_nop 0
    v_add_f32_dpp v32, v32, v32 row_ror:8 row_mask:0xf bank_mask:0xf
    v_add_f32_dpp v33, v33, v33 row_ror:8 row_mask:0xf bank_mask:0xf
    v_add_f32_dpp v34, v34, v34 row_ror:8 row_mask:0xf bank_mask:0xf
    v_add_f32_dpp v35, v35, v35 row_ror:8 row_mask:0xf bank_mask:0xf
    v_permlane16_swap_b32 v32, v33
    s_nop 0
    v_permlane16_swap_b32 v34, v35
    v_add_f32 v32, v32, v33
    v_add_f32 v34, v34, v35
    s_nop 1
    v_permlane32_swap_b32 v32, v34
    v_add_f32 v32, v32, v34
    ds_write_b32 v6, v32 offset:2048
    s_waitcnt lgkmcnt(0)
    s_barrier
    s_cmp_lg_u32 s87, 0
    s_cbranch_scc1 KS_PEND
    s_mov_b32 exec_lo, -1
    s_mov_b32 exec_hi, 0
    ds_read2_b32 v[32:33], v12 offset0:0 offset1:32
    ds_read2_b32 v[34:35], v12 offset0:64 offset1:96
    ds_read2_b32 v[36:37], v12 offset0:128 offset1:160
    ds_read_b128 v[40:43], v13 offset:1536
    s_waitcnt lgkmcnt(0)
    v_pk_add_f32 v[32:33], v[32:33], v[34:35]
    v_pk_add_f32 v[32:33], v[32:33], v[36:37]
    v_add_f32 v8, v32, v33
    v_cvt_pk_bf16_f32 v8, v8, v8
    v_lshlrev_b32 v8, 16, v8
    v_mul_f32 v8, v8, v42
    v_cvt_pk_bf16_f32 v8, v8, v8
    v_lshlrev_b32 v8, 16, v8
    v_add_f32 v8, v8, v40
    v_cvt_pk_bf16_f32 v8, v8, v8
    v_lshlrev_b32 v8, 16, v8
    v_add_f32 v8, v8, v41
    v_cvt_pk_bf16_f32 v8, v8, v8
    buffer_store_short v8, v43, s[68:71], 0 offen
KS_PEND:
KS_ABORT:
KS_END:
    s_endpgm
.section .rodata,"a"
.p2align 6
.amdhsa_kernel sequential_preLN__ssm_conv_s4__moe_arch_mod__prompt_kernel
  .amdhsa_next_free_vgpr 128
  .amdhsa_next_free_sgpr 100
  .amdhsa_accum_offset 128
  .amdhsa_group_segment_fixed_size 0
  .amdhsa_kernarg_size 136
  .amdhsa_user_sgpr_count 2
  .amdhsa_user_sgpr_kernarg_segment_ptr 1
  .amdhsa_system_sgpr_workgroup_id_x 1
  .amdhsa_float_denorm_mode_32 3
.end_amdhsa_kernel
```

```asm
; @launch grid=(256,1,1) block=(1024,1,1) lds=154240
.amdgcn_target "amdgcn-amd-amdhsa--gfx950"
.text
.globl sequential_preLN__ssm_conv_s4__moe_arch_mod__prompt_kernel
.p2align 8
.type sequential_preLN__ssm_conv_s4__moe_arch_mod__prompt_kernel,@function
sequential_preLN__ssm_conv_s4__moe_arch_mod__prompt_kernel:
    s_cmp_ge_u32 s2, 256
    s_cbranch_scc1 KS_END
    s_load_dwordx16 s[4:19], s[0:1], 0
    s_load_dwordx16 s[20:35], s[0:1], 64
    s_load_dwordx2 s[36:37], s[0:1], 128
    v_readfirstlane_b32 s38, v0
    s_lshr_b32 s38, s38, 6
    s_and_b32 s40, s2, 7
    s_lshr_b32 s41, s2, 3
    s_cmp_lg_u32 s38, 0
    s_cbranch_scc1 KS_CPE
    s_getpc_b64 s[42:43]
KS_PC:
    s_and_b32 s92, s41, 7
    s_mul_i32 s92, s92, 4608
    v_and_b32 v126, 63, v0
    v_lshl_add_u32 v126, v126, 7, s92
    v_min_u32 v126, KS_END-KS_PC, v126
    global_load_dword v127, v126, s[42:43]
KS_CPE:
    s_add_u32 s92, s38, 8
    s_sub_u32 s93, s38, 4
    s_cmp_lt_u32 s38, 8
    s_cselect_b32 s92, s92, s93
    s_cmp_lt_u32 s38, 4
    s_cselect_b32 s38, s38, s92
    v_and_b32 v1, 63, v0
    v_and_b32 v2, 15, v1
    v_lshrrev_b32 v3, 4, v1
    v_mov_b32 v4, 0
    v_mov_b32 v5, 1
    s_mov_b32 s39, 524288
    s_mov_b32 s84, 0x01010101
    s_lshl_b32 s90, s40, 5
    s_add_u32 s90, s90, s41
    s_mul_i32 s89, s40, 18
    s_add_u32 s89, s89, s41
    s_cmp_lt_u32 s38, 4
    s_cbranch_scc1 KS_L
    s_cmp_ge_u32 s38, 12
    s_cbranch_scc1 KS_X
    s_setprio 2
    s_lshr_b32 s87, s38, 2
    s_sub_u32 s87, s87, 1
    s_mul_i32 s86, s87, 3
    s_xor_b32 s86, s86, s38
    s_and_b32 s86, s86, 3
    s_lshl_b32 s88, s90, 1
    s_add_u32 s88, s88, s87
    s_lshl_b32 s92, s86, 11
    s_add_u32 s92, s92, 146048
    v_lshl_add_u32 v28, v1, 3, s92
    s_cmp_eq_u32 s86, 3
    s_cbranch_scc1 PX_1
    v_lshlrev_b32 v26, 3, v2
    v_mov_b32 v21, 0x80
    s_cmp_eq_u32 s86, 1
    s_cbranch_scc1 PX_2
    s_cmp_eq_u32 s86, 2
    s_cbranch_scc1 PX_3
    v_lshl_add_u32 v26, v3, 1, v26
    v_mov_b32 v22, 1
    s_branch PX_4
PX_2:
    v_cmp_gt_u32 vcc, 2, v3
    v_lshl_add_u32 v20, v3, 2, v26
    v_add_u32 v20, 256, v20
    v_lshl_add_u32 v26, v3, 8, v26
    v_cndmask_b32 v26, v26, v20, vcc
    v_cndmask_b32 v22, v21, 2, vcc
    v_cndmask_b32 v21, 4, v21, vcc
    s_branch PX_4
PX_3:
    v_lshl_add_u32 v26, v3, 9, v26
    v_add_u32 v26, 0x400, v26
    v_mov_b32 v22, 0x100
PX_4:
    v_mad_u32_u24 v26, v22, s87, v26
    v_add_u32 v27, v26, v21
    s_movk_i32 s96, 31232
    s_movk_i32 s97, -19072
    s_lshl_b32 s95, s87, 9
    v_cvt_f32_u32 v20, v26
    v_max_u32 v22, 0x800, v26
    v_cvt_f32_u32 v21, v27
    v_max_u32 v23, 0x800, v27
    v_cmp_gt_u32 vcc, 0x80, v26
    v_lshrrev_b32 v24, 16, v20
    v_add3_u32 v24, v24, v22, s97
    v_cndmask_b32 v24, v24, v26, vcc
    v_cmp_gt_u32 vcc, 0x80, v27
    v_lshrrev_b32 v25, 16, v21
    v_add3_u32 v25, v25, v23, s97
    v_cndmask_b32 v25, v25, v27, vcc
    v_min_u32 v24, 642, v24
    v_lshl_add_u32 v24, v24, 1, s96
    v_min_u32 v25, 642, v25
    v_lshl_add_u32 v25, v25, 1, s96
    v_add_u32 v29, s95, v28
    v_lshl_or_b32 v24, v25, 16, v24
    v_lshl_or_b32 v25, v27, 16, v26
    ds_write_b64 v29, v[24:25]
PX_1:
KS_GRP:
    s_lshl_b32 s92, s88, 8
    v_lshl_add_u32 v20, v1, 2, s92
    s_lshl_b32 s92, s88, 1
    v_mov_b32 v21, s92
    s_mul_i32 s85, s87, 36672
    s_add_u32 s85, s85, 35840
    s_waitcnt lgkmcnt(0)
    global_load_ushort v46, v21, s[18:19]
    global_load_dword v40, v20, s[6:7]
    global_load_dword v41, v20, s[8:9]
    global_load_dword v42, v20, s[10:11]
    global_load_dword v43, v20, s[12:13]
    global_load_dword v44, v20, s[14:15]
    global_load_dword v45, v20, s[16:17]
    global_load_ushort v107, v21, s[20:21]
    s_barrier
    s_movk_i32 s96, 31232
    s_cmp_eq_u32 s87, 2
    s_cbranch_scc1 PREE_7
    v_mov_b32 v32, 641
    s_cmp_eq_u32 s87, 1
    s_cbranch_scc1 PREB_5
    v_mov_b32 v33, 32514
    s_cmp_eq_u32 s86, 1
    s_cbranch_scc1 PRE_9
    s_cmp_eq_u32 s86, 2
    s_cbranch_scc1 PRE_10
    s_cmp_eq_u32 s86, 3
    s_cbranch_scc1 PRE_11
    v_lshlrev_b32 v23, 1, v1
    v_sub_u32 v30, 93, v23
    v_cmp_lt_u32 vcc, 61, v30
    v_lshlrev_b32 v31, 2, v30
    v_add_u32 v31, 32010, v31
    v_cndmask_b32 v24, v31, v33, vcc
    v_sub_u32 v30, 92, v23
    v_cmp_lt_u32 vcc, 61, v30
    v_lshlrev_b32 v31, 2, v30
    v_add_u32 v31, 32010, v31
    v_cndmask_b32 v25, v31, v33, vcc
    v_sub_u32 v30, 94, v23
    v_cmp_lt_u32 vcc, 62, v30
    v_lshlrev_b32 v31, 2, v30
    v_add_u32 v31, 32008, v31
    v_cndmask_b32 v26, v31, v33, vcc
    v_sub_u32 v30, 93, v23
    v_cmp_lt_u32 vcc, 62, v30
    v_lshlrev_b32 v31, 2, v30
    v_add_u32 v31, 32008, v31
    v_cndmask_b32 v27, v31, v33, vcc
    s_branch PREW_6
PRE_9:
    v_min_u32 v23, 47, v1
    v_lshlrev_b32 v23, 1, v23
    v_sub_u32 v30, 64, v23
    v_cmp_lt_u32 vcc, 63, v30
    v_lshlrev_b32 v31, 2, v30
    v_add_u32 v31, 32258, v31
    v_cndmask_b32 v24, v31, v33, vcc
    v_sub_u32 v30, 63, v23
    v_cmp_lt_u32 vcc, 63, v30
    v_lshlrev_b32 v31, 2, v30
    v_add_u32 v31, 32258, v31
    v_cndmask_b32 v25, v31, v33, vcc
    v_sub_u32 v30, 62, v23
    v_cmp_lt_u32 vcc, 63, v30
    v_lshlrev_b32 v31, 2, v30
    v_add_u32 v31, 32258, v31
    v_cndmask_b32 v27, v31, v33, vcc
    v_mov_b32 v26, v25
    s_branch PREW_6
PRE_10:
    v_min_u32 v23, 47, v1
    v_lshlrev_b32 v23, 1, v23
    v_sub_u32 v30, 64, v23
    v_cmp_lt_u32 vcc, 63, v30
    v_lshlrev_b32 v31, 2, v30
    v_add_u32 v31, 32260, v31
    v_cndmask_b32 v24, v31, v33, vcc
    v_sub_u32 v30, 63, v23
    v_cmp_lt_u32 vcc, 63, v30
    v_lshlrev_b32 v31, 2, v30
    v_add_u32 v31, 32260, v31
    v_cndmask_b32 v25, v31, v33, vcc
    v_sub_u32 v30, 62, v23
    v_cmp_lt_u32 vcc, 63, v30
    v_lshlrev_b32 v31, 2, v30
    v_add_u32 v31, 32260, v31
    v_cndmask_b32 v27, v31, v33, vcc
    v_mov_b32 v26, v25
    s_branch PREW_6
PRE_11:
    v_cmp_gt_u32 vcc, 9, v1
    v_add_u32 v23, 0x100, v1
    v_mov_b32 v33, 0x200
    v_cndmask_b32 v23, v23, v1, vcc
    v_lshlrev_b32 v23, 1, v23
    v_sub_u32 v30, 544, v23
    v_cvt_f32_i32 v31, v30
    v_cmp_gt_u32 vcc, 0x100, v30
    v_cvt_pk_bf16_f32 v31, v31, v31
    v_and_b32 v31, 0xffff, v31
    v_subrev_u32 v31, 0x4280, v31
    v_cndmask_b32 v31, v31, v30, vcc
    v_cmp_lt_u32 vcc, 0x20d, v30
    v_or_b32 v30, 1, v23
    s_nop 0
    v_cndmask_b32 v31, v31, v32, vcc
    v_cmp_eq_u32 vcc, 0x25d, v30
    s_nop 1
    v_cndmask_b32 v31, v31, v33, vcc
    v_lshl_add_u32 v24, v31, 1, s96
    v_add_u32 v23, 1, v23
    v_sub_u32 v30, 544, v23
    v_cvt_f32_i32 v31, v30
    v_cmp_gt_u32 vcc, 0x100, v30
    v_cvt_pk_bf16_f32 v31, v31, v31
    v_and_b32 v31, 0xffff, v31
    v_subrev_u32 v31, 0x4280, v31
    v_cndmask_b32 v31, v31, v30, vcc
    v_cmp_lt_u32 vcc, 0x20d, v30
    v_or_b32 v30, 1, v23
    s_nop 0
    v_cndmask_b32 v31, v31, v32, vcc
    v_cmp_eq_u32 vcc, 0x25d, v30
    s_nop 1
    v_cndmask_b32 v31, v31, v33, vcc
    v_lshl_add_u32 v25, v31, 1, s96
    v_add_u32 v23, 1, v23
    v_sub_u32 v30, 544, v23
    v_cvt_f32_i32 v31, v30
    v_cmp_gt_u32 vcc, 0x100, v30
    v_cvt_pk_bf16_f32 v31, v31, v31
    v_and_b32 v31, 0xffff, v31
    v_subrev_u32 v31, 0x4280, v31
    v_cndmask_b32 v31, v31, v30, vcc
    v_cmp_lt_u32 vcc, 0x20d, v30
    v_or_b32 v30, 1, v23
    s_nop 0
    v_cndmask_b32 v31, v31, v32, vcc
    v_cmp_eq_u32 vcc, 0x25d, v30
    s_nop 1
    v_cndmask_b32 v31, v31, v33, vcc
    v_lshl_add_u32 v27, v31, 1, s96
    v_mov_b32 v26, v25
    s_branch PREW_6
PREB_5:
    s_lshl_b32 s93, s86, 7
    s_add_u32 s93, s93, 18
    v_lshl_add_u32 v23, v1, 1, s93
    v_sub_u32 v30, 544, v23
    v_cvt_f32_i32 v31, v30
    v_cmp_gt_u32 vcc, 0x100, v30
    v_cvt_pk_bf16_f32 v31, v31, v31
    v_and_b32 v31, 0xffff, v31
    v_subrev_u32 v31, 0x4280, v31
    v_cndmask_b32 v31, v31, v30, vcc
    v_cmp_lt_u32 vcc, 0x20d, v30
    s_nop 1
    v_cndmask_b32 v31, v31, v32, vcc
    v_lshl_add_u32 v24, v31, 1, s96
    v_add_u32 v23, 1, v23
    v_sub_u32 v30, 544, v23
    v_cvt_f32_i32 v31, v30
    v_cmp_gt_u32 vcc, 0x100, v30
    v_cvt_pk_bf16_f32 v31, v31, v31
    v_and_b32 v31, 0xffff, v31
    v_subrev_u32 v31, 0x4280, v31
    v_cndmask_b32 v31, v31, v30, vcc
    v_cmp_lt_u32 vcc, 0x20d, v30
    s_nop 1
    v_cndmask_b32 v31, v31, v32, vcc
    v_lshl_add_u32 v25, v31, 1, s96
    v_add_u32 v23, 1, v23
    v_sub_u32 v30, 544, v23
    v_cvt_f32_i32 v31, v30
    v_cmp_gt_u32 vcc, 0x100, v30
    v_cvt_pk_bf16_f32 v31, v31, v31
    v_and_b32 v31, 0xffff, v31
    v_subrev_u32 v31, 0x4280, v31
    v_cndmask_b32 v31, v31, v30, vcc
    v_cmp_lt_u32 vcc, 0x20d, v30
    s_nop 1
    v_cndmask_b32 v31, v31, v32, vcc
    v_lshl_add_u32 v26, v31, 1, s96
    s_sub_u32 s93, s86, 1
    s_cmp_lt_u32 s93, 2
    s_cselect_b32 s94, 47, 63
    s_mul_i32 s93, s93, 384
    s_add_u32 s93, s93, 35664
    s_cmp_eq_u32 s86, 0
    s_cselect_b32 s93, 35152, s93
    s_cmp_eq_u32 s86, 3
    s_cselect_b32 s93, 32528, s93
    s_cselect_b32 s95, 0x100, 0
    v_cmp_gt_u32 vcc, 9, v1
    v_min_u32 v23, s94, v1
    v_add_u32 v30, s95, v23
    v_cndmask_b32 v23, v30, v23, vcc
    v_lshl_add_u32 v27, v23, 2, s93
    v_lshl_or_b32 v24, v25, 16, v24
    v_lshl_or_b32 v25, v27, 16, v26
    ds_write_b64 v28, v[24:25] offset:1024
    v_mov_b32 v24, s86
    ds_write_b8 v24, v5 offset:212
    s_branch PREE_7
PREW_6:
    v_lshl_or_b32 v24, v25, 16, v24
    v_lshl_or_b32 v25, v27, 16, v26
    ds_write_b64 v28, v[24:25] offset:1536
    v_mov_b32 v24, s86
    ds_write_b8 v24, v5 offset:208
PREE_7:
    s_mul_i32 s93, s86, 8704
    s_min_u32 s94, s93, 22304
    s_add_u32 s94, s94, s85
    s_lshl_b32 s92, s87, 4
    v_mov_b32 v14, s92
    v_add_u32 v15, s86, v14
    v_lshl_add_u32 v72, v1, 3, s94
    v_add_u32 v73, 2176, v72
    v_add_u32 v74, 4352, v72
    v_add_u32 v75, 6528, v72
    v_mul_u32_u24 v126, 544, v2
    v_lshl_add_u32 v126, v3, 4, v126
    v_add_u32 v126, s85, v126
    v_add_u32 v127, s93, v126
    v_lshlrev_b32 v20, 3, v3
    v_sub_u32 v20, v20, v2
    v_add_u32 v21, 16, v20
    v_lshrrev_b32 v21, 1, v21
    v_and_b32 v22, 1, v2
    s_add_u32 s92, s85, 32528
    v_lshl_add_u32 v21, v21, 2, s92
    s_movk_i32 s92, 1344
    s_movk_i32 s94, 192
    v_mad_u32_u24 v6, v22, s92, v21
    v_add_u32 v7, 640, v6
    v_mad_u32_u24 v23, v22, s94, v21
    v_add_u32 v13, 3136, v23
    v_lshlrev_b32 v23, 2, v3
    v_sub_u32 v23, v23, v2
    s_add_u32 s92, s85, 35212
    v_lshl_add_u32 v11, v23, 2, s92
    s_mul_i32 s94, s87, 4672
    s_add_u32 s94, s94, 3072
    v_lshl_add_u32 v23, v2, 5, s94
    v_lshl_add_u32 v8, v3, 4, v23
    v_bfe_u32 v20, v1, 2, 2
    v_and_b32 v21, 3, v1
    v_lshl_add_u32 v20, v3, 3, v20
    v_lshlrev_b32 v105, 2, v21
    v_lshl_add_u32 v21, v21, 3, s85
    v_lshl_add_u32 v9, v20, 4, v21
    v_lshl_add_u32 v10, v20, 5, v21
    v_lshlrev_b32 v12, 4, v1
    s_add_u32 s64, s36, 0x600000
    s_addc_u32 s65, s37, 0
    s_mov_b32 s66, 0x240000
    s_mov_b32 s67, 0x20000
    s_mov_b32 s10, 0x8080
    s_lshl_b32 s92, s86, 19
    s_lshl_b32 s93, s90, 6
    s_add_u32 s92, s92, s93
    s_lshl_b32 s93, s86, 16
    s_lshl_b32 s95, s88, 6
    s_add_u32 s93, s93, s95
    s_add_u32 s93, s93, 2064384
    s_cmp_eq_u32 s87, 2
    s_cselect_b32 s6, s93, s92
    s_cselect_b32 s8, 0x1080, s10
    s_cselect_b32 s92, 1, 3
    s_and_b32 s92, s92, s86
    s_lshl_b32 s92, s92, 11
    s_xor_b32 s6, s6, s92
    s_and_b32 s10, s6, 0x7c0
    s_xor_b32 s6, s6, s10
    s_xor_b32 s7, s6, 0x6000
    s_and_b32 s9, s87, 1
    s_lshl_b32 s9, s9, 4
    s_mov_b32 s12, 0x55555555
    s_mov_b32 s13, 0x55555555
    s_lshl_b32 s92, s86, 8
    s_add_u32 s92, s92, s85
    s_add_u32 s92, s92, 36
    v_lshl_add_u32 v124, v1, 2, s92
    s_movk_i32 s92, 192
    s_cmp_eq_u32 s86, 0
    s_cselect_b32 s92, 256, s92
    s_cmp_eq_u32 s86, 3
    s_cselect_b32 s92, 1344, s92
    v_mov_b32 v20, s85
    ds_write_b16 v20, v4 offset:32514
    s_mov_b32 s18, s92
    v_mov_b32 v125, v28
W_12:
    ds_read_b64 v[18:19], v4 offset:208
    s_sub_u32 s39, s39, 1
    s_cbranch_scc1 KS_ABORT
    s_waitcnt lgkmcnt(0)
    v_and_b32 v18, v18, v19
    v_cmp_ne_u32 vcc, s84, v18
    s_cbranch_vccnz W_12
    ds_read2st64_b64 v[28:31], v125 offset0:0 offset1:1
    ds_read2st64_b64 v[32:35], v125 offset0:2 offset1:3
    s_waitcnt lgkmcnt(0)
    v_add_u32_sdwa v108, s85, v28 dst_sel:DWORD dst_unused:UNUSED_PAD src0_sel:DWORD src1_sel:WORD_0
    v_add_u32_sdwa v109, s85, v28 dst_sel:DWORD dst_unused:UNUSED_PAD src0_sel:DWORD src1_sel:WORD_1
    v_cvt_f32_u32_sdwa v110, v29 dst_sel:DWORD dst_unused:UNUSED_PAD src0_sel:WORD_0
    v_cvt_f32_u32_sdwa v111, v29 dst_sel:DWORD dst_unused:UNUSED_PAD src0_sel:WORD_1
    v_add_u32_sdwa v112, s85, v30 dst_sel:DWORD dst_unused:UNUSED_PAD src0_sel:DWORD src1_sel:WORD_0
    v_add_u32_sdwa v113, s85, v30 dst_sel:DWORD dst_unused:UNUSED_PAD src0_sel:DWORD src1_sel:WORD_1
    v_cvt_f32_u32_sdwa v114, v31 dst_sel:DWORD dst_unused:UNUSED_PAD src0_sel:WORD_0
    v_cvt_f32_u32_sdwa v115, v31 dst_sel:DWORD dst_unused:UNUSED_PAD src0_sel:WORD_1
    v_add_u32_sdwa v116, s85, v32 dst_sel:DWORD dst_unused:UNUSED_PAD src0_sel:DWORD src1_sel:WORD_0
    v_add_u32_sdwa v117, s85, v32 dst_sel:DWORD dst_unused:UNUSED_PAD src0_sel:DWORD src1_sel:WORD_1
    v_add_u32_sdwa v118, s85, v33 dst_sel:DWORD dst_unused:UNUSED_PAD src0_sel:DWORD src1_sel:WORD_0
    v_add_u32_sdwa v119, s85, v33 dst_sel:DWORD dst_unused:UNUSED_PAD src0_sel:DWORD src1_sel:WORD_1
    v_add_u32_sdwa v120, s85, v34 dst_sel:DWORD dst_unused:UNUSED_PAD src0_sel:DWORD src1_sel:WORD_0
    v_add_u32_sdwa v121, s85, v34 dst_sel:DWORD dst_unused:UNUSED_PAD src0_sel:DWORD src1_sel:WORD_1
    v_add_u32_sdwa v122, s85, v35 dst_sel:DWORD dst_unused:UNUSED_PAD src0_sel:DWORD src1_sel:WORD_0
    v_add_u32_sdwa v123, s85, v35 dst_sel:DWORD dst_unused:UNUSED_PAD src0_sel:DWORD src1_sel:WORD_1
    v_add_u32 v125, s18, v119
    s_lshl_b32 s92, s87, 5
    s_add_u32 s92, s92, s41
    s_cmp_ge_u32 s92, 88
    s_cbranch_scc1 KC_RECV
    s_mov_b32 s92, 0x3fb8aa3b
    s_mov_b32 s93, 0x32a57060
    s_mov_b32 s94, 0x3e22f983
    s_mov_b32 s95, 0x31dc9c88
    s_waitcnt vmcnt(7)
    v_lshlrev_b32 v16, 16, v46
    v_mul_f32 v17, s92, v16
    v_fma_f32 v19, v16, s92, -v17
    v_fmac_f32 v19, s93, v16
    v_exp_f32 v17, v17
    v_mul_f32 v19, 0x3f317218, v19
    v_fmac_f32 v17, v17, v19
    v_cvt_pk_bf16_f32 v16, 0, v17
    s_waitcnt vmcnt(5)
    ds_write_b32 v4, v5 offset:36
    v_lshlrev_b32 v20, 16, v40
    v_and_b32 v21, 0xffff0000, v40
    v_lshlrev_b32 v22, 16, v41
    v_and_b32 v23, 0xffff0000, v41
    v_pk_mul_f32 v[20:21], v[20:21], v[16:17] op_sel_hi:[1,0]
    v_pk_mul_f32 v[22:23], v[22:23], v[16:17] op_sel_hi:[1,0]
    v_max_f32 v36, v20, v21
    v_pk_mul_f32 v[68:69], v[22:23], s[94:95] op_sel_hi:[1,0]
    v_pk_fma_f32 v[70:71], v[22:23], s[94:95], v[68:69] op_sel_hi:[1,0,1] neg_lo:[0,0,1] neg_hi:[0,0,1]
    v_pk_fma_f32 v[70:71], v[22:23], s[94:95], v[70:71] op_sel:[0,1,0]
    s_cmp_eq_u32 s86, 3
    s_cbranch_scc1 SK_14
    s_waitcnt vmcnt(1)
    v_lshlrev_b32 v24, 16, v42
    v_and_b32 v25, 0xffff0000, v42
    v_lshlrev_b32 v26, 16, v43
    v_and_b32 v27, 0xffff0000, v43
    v_lshlrev_b32 v28, 16, v44
    v_and_b32 v29, 0xffff0000, v44
    v_lshlrev_b32 v30, 16, v45
    v_and_b32 v31, 0xffff0000, v45
    v_pk_mul_f32 v[24:25], v[24:25], v[16:17] op_sel_hi:[1,0]
    v_pk_mul_f32 v[26:27], v[26:27], v[16:17] op_sel_hi:[1,0]
    v_pk_mul_f32 v[90:91], v[30:31], v[26:27]
    v_pk_mul_f32 v[92:93], v[30:31], v[24:25]
    v_pk_fma_f32 v[34:35], v[28:29], v[26:27], v[92:93]
    v_pk_fma_f32 v[32:33], v[28:29], v[24:25], v[90:91] neg_lo:[0,0,1] neg_hi:[0,0,1]
    v_max3_f32 v37, abs(v34), abs(v35), abs(v32)
    v_max_f32 v37, v37, abs(v33)
SK_14:
    s_waitcnt vmcnt(0)
    s_nop 0
    v_permlane32_swap_b32 v36, v37
    v_max_f32 v36, v36, v37
    s_nop 1
    v_max_f32_dpp v36, v36, v36 row_ror:8 row_mask:0xf bank_mask:0xf
    s_nop 1
    v_max_f32_dpp v36, v36, v36 row_ror:4 row_mask:0xf bank_mask:0xf
    s_nop 1
    v_max_f32_dpp v36, v36, v36 row_ror:2 row_mask:0xf bank_mask:0xf
    s_nop 1
    v_max_f32_dpp v36, v36, v36 row_ror:1 row_mask:0xf bank_mask:0xf
    v_mov_b32 v38, v36
    s_nop 1
    v_permlane16_swap_b32 v36, v38
    v_max_f32 v36, v36, v38
    s_nop 0
    v_readlane_b32 s14, v36, 0
    v_readlane_b32 s15, v36, 32
    s_add_u32 s15, s15, 0x7fffff
    s_lshr_b32 s15, s15, 23
    s_max_u32 s15, s15, 24
    s_sub_u32 s16, 269, s15
    s_lshl_b32 s16, s16, 23
    v_subrev_f32 v20, s14, v20
    v_subrev_f32 v21, s14, v21
    v_mul_f32 v20, 0x3fb8aa3b, v20
    v_mul_f32 v21, 0x3fb8aa3b, v21
    s_cmp_eq_u32 s86, 3
    s_cbranch_scc1 JOB_18
    s_cmp_eq_u32 s86, 1
    s_cbranch_scc1 JOB_16
    s_cmp_eq_u32 s86, 2
    s_cbranch_scc1 JOB_17
    v_mul_f32 v91, 0x43000000, v68
    v_mul_f32 v90, 0x43000000, v20
    v_mul_f32 v95, 0x43000000, v69
    v_mul_f32 v94, 0x43000000, v21
    v_fract_f32 v91, v91
    v_fract_f32 v95, v95
    v_fmac_f32 v91, 0x43000000, v70
    v_fmac_f32 v95, 0x43000000, v71
    v_exp_f32 v90, v90
    v_cos_f32 v92, v91
    v_sin_f32 v91, v91
    v_exp_f32 v94, v94
    v_cos_f32 v96, v95
    v_sin_f32 v95, v95
    v_mul_f32 v44, v90, v92
    v_mul_f32 v46, v90, v91
    v_mul_f32 v45, v94, v96
    v_mul_f32 v47, v94, v95
    v_pk_mul_f32 v[32:33], v[32:33], s[16:17] op_sel_hi:[1,0]
    v_pk_mul_f32 v[34:35], v[34:35], s[16:17] op_sel_hi:[1,0]
    v_fract_f32 v91, v68
    v_fract_f32 v95, v69
    v_fmac_f32 v91, 1.0, v70
    v_fmac_f32 v95, 1.0, v71
    v_exp_f32 v90, v20
    v_cos_f32 v92, v91
    v_sin_f32 v91, v91
    v_exp_f32 v94, v21
    v_cos_f32 v96, v95
    v_sin_f32 v95, v95
    v_mul_f32 v40, v90, v92
    v_mul_f32 v42, v90, v91
    v_mul_f32 v41, v94, v96
    v_mul_f32 v43, v94, v95
    v_pk_mul_f32 v[90:91], v[34:35], v[46:47]
    v_pk_mul_f32 v[94:95], v[34:35], v[42:43]
    v_pk_mul_f32 v[92:93], v[34:35], v[44:45]
    v_pk_mul_f32 v[96:97], v[34:35], v[40:41]
    v_pk_fma_f32 v[62:63], v[32:33], v[46:47], v[92:93]
    v_pk_fma_f32 v[54:55], v[32:33], v[42:43], v[96:97]
    v_pk_fma_f32 v[60:61], v[32:33], v[44:45], v[90:91] neg_lo:[0,0,1] neg_hi:[0,0,1]
    v_pk_fma_f32 v[52:53], v[32:33], v[40:41], v[94:95] neg_lo:[0,0,1] neg_hi:[0,0,1]
    v_cvt_pk_f16_f32 v98, v32, v34
    v_cvt_pk_f16_f32 v99, v33, v35
    v_cvt_pk_f16_f32 v100, v60, v62
    v_cvt_pk_f16_f32 v101, v61, v63
    ds_write2_b64 v72, v[98:99], v[100:101] offset0:0 offset1:68
    v_pk_mul_f32 v[90:91], v[54:55], v[46:47]
    v_pk_mul_f32 v[94:95], v[54:55], v[42:43]
    v_pk_mul_f32 v[92:93], v[54:55], v[44:45]
    v_pk_mul_f32 v[96:97], v[54:55], v[40:41]
    v_pk_fma_f32 v[62:63], v[52:53], v[46:47], v[92:93]
    v_pk_fma_f32 v[58:59], v[52:53], v[42:43], v[96:97]
    v_pk_fma_f32 v[60:61], v[52:53], v[44:45], v[90:91] neg_lo:[0,0,1] neg_hi:[0,0,1]
    v_pk_fma_f32 v[56:57], v[52:53], v[40:41], v[94:95] neg_lo:[0,0,1] neg_hi:[0,0,1]
    v_cvt_pk_f16_f32 v76, v52, v54
    v_cvt_pk_f16_f32 v77, v53, v55
    v_cvt_pk_f16_f32 v78, v60, v62
    v_cvt_pk_f16_f32 v79, v61, v63
    ds_write2_b64 v72, v[76:77], v[78:79] offset0:136 offset1:204
    v_pk_mul_f32 v[90:91], v[58:59], v[46:47]
    v_pk_mul_f32 v[94:95], v[58:59], v[42:43]
    v_pk_mul_f32 v[92:93], v[58:59], v[44:45]
    v_pk_mul_f32 v[96:97], v[58:59], v[40:41]
    v_pk_fma_f32 v[62:63], v[56:57], v[46:47], v[92:93]
    v_pk_fma_f32 v[54:55], v[56:57], v[42:43], v[96:97]
    v_pk_fma_f32 v[60:61], v[56:57], v[44:45], v[90:91] neg_lo:[0,0,1] neg_hi:[0,0,1]
    v_pk_fma_f32 v[52:53], v[56:57], v[40:41], v[94:95] neg_lo:[0,0,1] neg_hi:[0,0,1]
    v_cvt_pk_f16_f32 v98, v56, v58
    v_cvt_pk_f16_f32 v99, v57, v59
    v_cvt_pk_f16_f32 v100, v60, v62
    v_cvt_pk_f16_f32 v101, v61, v63
    ds_write2_b64 v73, v[98:99], v[100:101] offset0:0 offset1:68
    v_pk_mul_f32 v[90:91], v[54:55], v[46:47]
    v_pk_mul_f32 v[94:95], v[54:55], v[42:43]
    v_pk_mul_f32 v[92:93], v[54:55], v[44:45]
    v_pk_mul_f32 v[96:97], v[54:55], v[40:41]
    v_pk_fma_f32 v[62:63], v[52:53], v[46:47], v[92:93]
    v_pk_fma_f32 v[58:59], v[52:53], v[42:43], v[96:97]
    v_pk_fma_f32 v[60:61], v[52:53], v[44:45], v[90:91] neg_lo:[0,0,1] neg_hi:[0,0,1]
    v_pk_fma_f32 v[56:57], v[52:53], v[40:41], v[94:95] neg_lo:[0,0,1] neg_hi:[0,0,1]
    v_cvt_pk_f16_f32 v76, v52, v54
    v_cvt_pk_f16_f32 v77, v53, v55
    v_cvt_pk_f16_f32 v78, v60, v62
    v_cvt_pk_f16_f32 v79, v61, v63
    ds_write2_b64 v73, v[76:77], v[78:79] offset0:136 offset1:204
    v_pk_mul_f32 v[90:91], v[58:59], v[46:47]
    v_pk_mul_f32 v[94:95], v[58:59], v[42:43]
    v_pk_mul_f32 v[92:93], v[58:59], v[44:45]
    v_pk_mul_f32 v[96:97], v[58:59], v[40:41]
    v_pk_fma_f32 v[62:63], v[56:57], v[46:47], v[92:93]
    v_pk_fma_f32 v[54:55], v[56:57], v[42:43], v[96:97]
    v_pk_fma_f32 v[60:61], v[56:57], v[44:45], v[90:91] neg_lo:[0,0,1] neg_hi:[0,0,1]
    v_pk_fma_f32 v[52:53], v[56:57], v[40:41], v[94:95] neg_lo:[0,0,1] neg_hi:[0,0,1]
    v_cvt_pk_f16_f32 v98, v56, v58
    v_cvt_pk_f16_f32 v99, v57, v59
    v_cvt_pk_f16_f32 v100, v60, v62
    v_cvt_pk_f16_f32 v101, v61, v63
    ds_write2_b64 v74, v[98:99], v[100:101] offset0:0 offset1:68
    v_pk_mul_f32 v[90:91], v[54:55], v[46:47]
    v_pk_mul_f32 v[94:95], v[54:55], v[42:43]
    v_pk_mul_f32 v[92:93], v[54:55], v[44:45]
    v_pk_mul_f32 v[96:97], v[54:55], v[40:41]
    v_pk_fma_f32 v[62:63], v[52:53], v[46:47], v[92:93]
    v_pk_fma_f32 v[58:59], v[52:53], v[42:43], v[96:97]
    v_pk_fma_f32 v[60:61], v[52:53], v[44:45], v[90:91] neg_lo:[0,0,1] neg_hi:[0,0,1]
    v_pk_fma_f32 v[56:57], v[52:53], v[40:41], v[94:95] neg_lo:[0,0,1] neg_hi:[0,0,1]
    v_cvt_pk_f16_f32 v76, v52, v54
    v_cvt_pk_f16_f32 v77, v53, v55
    v_cvt_pk_f16_f32 v78, v60, v62
    v_cvt_pk_f16_f32 v79, v61, v63
    ds_write2_b64 v74, v[76:77], v[78:79] offset0:136 offset1:204
    v_pk_mul_f32 v[90:91], v[58:59], v[46:47]
    v_pk_mul_f32 v[94:95], v[58:59], v[42:43]
    v_pk_mul_f32 v[92:93], v[58:59], v[44:45]
    v_pk_mul_f32 v[96:97], v[58:59], v[40:41]
    v_pk_fma_f32 v[62:63], v[56:57], v[46:47], v[92:93]
    v_pk_fma_f32 v[54:55], v[56:57], v[42:43], v[96:97]
    v_pk_fma_f32 v[60:61], v[56:57], v[44:45], v[90:91] neg_lo:[0,0,1] neg_hi:[0,0,1]
    v_pk_fma_f32 v[52:53], v[56:57], v[40:41], v[94:95] neg_lo:[0,0,1] neg_hi:[0,0,1]
    v_cvt_pk_f16_f32 v98, v56, v58
    v_cvt_pk_f16_f32 v99, v57, v59
    v_cvt_pk_f16_f32 v100, v60, v62
    v_cvt_pk_f16_f32 v101, v61, v63
    ds_write2_b64 v75, v[98:99], v[100:101] offset0:0 offset1:68
    v_pk_mul_f32 v[90:91], v[54:55], v[46:47]
    v_pk_mul_f32 v[92:93], v[54:55], v[44:45]
    v_pk_fma_f32 v[62:63], v[52:53], v[46:47], v[92:93]
    v_pk_fma_f32 v[60:61], v[52:53], v[44:45], v[90:91] neg_lo:[0,0,1] neg_hi:[0,0,1]
    v_cvt_pk_f16_f32 v76, v52, v54
    v_cvt_pk_f16_f32 v77, v53, v55
    v_cvt_pk_f16_f32 v78, v60, v62
    v_cvt_pk_f16_f32 v79, v61, v63
    ds_write2_b64 v75, v[76:77], v[78:79] offset0:136 offset1:204
    s_branch JOBJ_19
JOB_16:
    v_mul_f32 v91, 0x43000000, v68
    v_mul_f32 v90, 0x43000000, v20
    v_mul_f32 v95, 0x43000000, v69
    v_mul_f32 v94, 0x43000000, v21
    v_fract_f32 v91, v91
    v_fract_f32 v95, v95
    v_fmac_f32 v91, 0x43000000, v70
    v_fmac_f32 v95, 0x43000000, v71
    v_exp_f32 v90, v90
    v_cos_f32 v92, v91
    v_sin_f32 v91, v91
    v_exp_f32 v94, v94
    v_cos_f32 v96, v95
    v_sin_f32 v95, v95
    v_mul_f32 v44, v90, v92
    v_mul_f32 v46, v90, v91
    v_mul_f32 v45, v94, v96
    v_mul_f32 v47, v94, v95
    v_pk_mul_f32 v[32:33], v[32:33], s[16:17] op_sel_hi:[1,0]
    v_pk_mul_f32 v[34:35], v[34:35], s[16:17] op_sel_hi:[1,0]
    v_pk_mul_f32 v[90:91], v[46:47], v[46:47]
    v_pk_mul_f32 v[92:93], v[44:45], v[46:47]
    v_pk_fma_f32 v[48:49], v[44:45], v[44:45], v[90:91] neg_lo:[0,0,1] neg_hi:[0,0,1]
    v_pk_add_f32 v[50:51], v[92:93], v[92:93]
    v_mul_f32 v91, 2.0, v68
    v_mul_f32 v90, 2.0, v20
    v_mul_f32 v95, 2.0, v69
    v_mul_f32 v94, 2.0, v21
    v_fract_f32 v91, v91
    v_fract_f32 v95, v95
    v_fmac_f32 v91, 2.0, v70
    v_fmac_f32 v95, 2.0, v71
    v_exp_f32 v90, v90
    v_cos_f32 v92, v91
    v_sin_f32 v91, v91
    v_exp_f32 v94, v94
    v_cos_f32 v96, v95
    v_sin_f32 v95, v95
    v_mul_f32 v40, v90, v92
    v_mul_f32 v42, v90, v91
    v_mul_f32 v41, v94, v96
    v_mul_f32 v43, v94, v95
    v_pk_mul_f32 v[90:91], v[34:35], v[50:51]
    v_pk_mul_f32 v[92:93], v[34:35], v[48:49]
    v_pk_fma_f32 v[54:55], v[32:33], v[50:51], v[92:93]
    v_pk_fma_f32 v[52:53], v[32:33], v[48:49], v[90:91] neg_lo:[0,0,1] neg_hi:[0,0,1]
    v_pk_mul_f32 v[90:91], v[54:55], v[50:51]
    v_pk_mul_f32 v[92:93], v[54:55], v[48:49]
    v_pk_fma_f32 v[66:67], v[52:53], v[50:51], v[92:93]
    v_pk_fma_f32 v[64:65], v[52:53], v[48:49], v[90:91] neg_lo:[0,0,1] neg_hi:[0,0,1]
    v_pk_mul_f32 v[90:91], v[54:55], v[46:47]
    v_pk_mul_f32 v[94:95], v[54:55], v[42:43]
    v_pk_mul_f32 v[92:93], v[54:55], v[44:45]
    v_pk_mul_f32 v[96:97], v[54:55], v[40:41]
    v_pk_fma_f32 v[62:63], v[52:53], v[46:47], v[92:93]
    v_pk_fma_f32 v[58:59], v[52:53], v[42:43], v[96:97]
    v_pk_fma_f32 v[60:61], v[52:53], v[44:45], v[90:91] neg_lo:[0,0,1] neg_hi:[0,0,1]
    v_pk_fma_f32 v[56:57], v[52:53], v[40:41], v[94:95] neg_lo:[0,0,1] neg_hi:[0,0,1]
    v_cvt_pk_f16_f32 v98, v52, v54
    v_cvt_pk_f16_f32 v99, v53, v55
    v_cvt_pk_f16_f32 v100, v60, v62
    v_cvt_pk_f16_f32 v101, v61, v63
    ds_write2_b64 v72, v[98:99], v[100:101] offset0:0 offset1:68
    v_pk_mul_f32 v[90:91], v[58:59], v[46:47]
    v_pk_mul_f32 v[94:95], v[58:59], v[42:43]
    v_pk_mul_f32 v[92:93], v[58:59], v[44:45]
    v_pk_mul_f32 v[96:97], v[58:59], v[40:41]
    v_pk_fma_f32 v[62:63], v[56:57], v[46:47], v[92:93]
    v_pk_fma_f32 v[54:55], v[56:57], v[42:43], v[96:97]
    v_pk_fma_f32 v[60:61], v[56:57], v[44:45], v[90:91] neg_lo:[0,0,1] neg_hi:[0,0,1]
    v_pk_fma_f32 v[52:53], v[56:57], v[40:41], v[94:95] neg_lo:[0,0,1] neg_hi:[0,0,1]
    v_cvt_pk_f16_f32 v76, v56, v58
    v_cvt_pk_f16_f32 v77, v57, v59
    v_cvt_pk_f16_f32 v78, v60, v62
    v_cvt_pk_f16_f32 v79, v61, v63
    ds_write2_b64 v72, v[76:77], v[78:79] offset0:136 offset1:204
    v_pk_mul_f32 v[90:91], v[54:55], v[46:47]
    v_pk_mul_f32 v[94:95], v[54:55], v[42:43]
    v_pk_mul_f32 v[92:93], v[54:55], v[44:45]
    v_pk_mul_f32 v[96:97], v[54:55], v[40:41]
    v_pk_fma_f32 v[62:63], v[52:53], v[46:47], v[92:93]
    v_pk_fma_f32 v[58:59], v[52:53], v[42:43], v[96:97]
    v_pk_fma_f32 v[60:61], v[52:53], v[44:45], v[90:91] neg_lo:[0,0,1] neg_hi:[0,0,1]
    v_pk_fma_f32 v[56:57], v[52:53], v[40:41], v[94:95] neg_lo:[0,0,1] neg_hi:[0,0,1]
    v_cvt_pk_f16_f32 v98, v52, v54
    v_cvt_pk_f16_f32 v99, v53, v55
    v_cvt_pk_f16_f32 v100, v60, v62
    v_cvt_pk_f16_f32 v101, v61, v63
    ds_write2_b64 v73, v[98:99], v[100:101] offset0:0 offset1:68
    v_pk_mul_f32 v[90:91], v[58:59], v[46:47]
    v_pk_mul_f32 v[94:95], v[42:43], v[42:43]
    v_pk_mul_f32 v[92:93], v[58:59], v[44:45]
    v_pk_mul_f32 v[96:97], v[40:41], v[42:43]
    v_pk_fma_f32 v[62:63], v[56:57], v[46:47], v[92:93]
    v_pk_fma_f32 v[48:49], v[40:41], v[40:41], v[94:95] neg_lo:[0,0,1] neg_hi:[0,0,1]
    v_pk_fma_f32 v[60:61], v[56:57], v[44:45], v[90:91] neg_lo:[0,0,1] neg_hi:[0,0,1]
    v_pk_add_f32 v[50:51], v[96:97], v[96:97]
    v_cvt_pk_f16_f32 v76, v56, v58
    v_cvt_pk_f16_f32 v77, v57, v59
    v_cvt_pk_f16_f32 v78, v60, v62
    v_cvt_pk_f16_f32 v79, v61, v63
    ds_write2_b64 v73, v[76:77], v[78:79] offset0:136 offset1:204
    v_pk_mul_f32 v[90:91], v[66:67], v[50:51]
    v_pk_mul_f32 v[94:95], v[66:67], v[46:47]
    v_pk_mul_f32 v[92:93], v[66:67], v[48:49]
    v_pk_mul_f32 v[96:97], v[66:67], v[44:45]
    v_pk_fma_f32 v[62:63], v[64:65], v[50:51], v[92:93]
    v_pk_fma_f32 v[54:55], v[64:65], v[46:47], v[96:97]
    v_pk_fma_f32 v[60:61], v[64:65], v[48:49], v[90:91] neg_lo:[0,0,1] neg_hi:[0,0,1]
    v_pk_fma_f32 v[52:53], v[64:65], v[44:45], v[94:95] neg_lo:[0,0,1] neg_hi:[0,0,1]
    v_cvt_pk_f16_f32 v98, v64, v66
    v_cvt_pk_f16_f32 v99, v65, v67
    v_cvt_pk_f16_f32 v100, v60, v62
    v_cvt_pk_f16_f32 v101, v61, v63
    ds_write2_b64 v74, v[98:99], v[100:101] offset0:0 offset1:68
    v_pk_mul_f32 v[90:91], v[54:55], v[50:51]
    v_pk_mul_f32 v[94:95], v[54:55], v[46:47]
    v_pk_mul_f32 v[92:93], v[54:55], v[48:49]
    v_pk_mul_f32 v[96:97], v[54:55], v[44:45]
    v_pk_fma_f32 v[62:63], v[52:53], v[50:51], v[92:93]
    v_pk_fma_f32 v[58:59], v[52:53], v[46:47], v[96:97]
    v_pk_fma_f32 v[60:61], v[52:53], v[48:49], v[90:91] neg_lo:[0,0,1] neg_hi:[0,0,1]
    v_pk_fma_f32 v[56:57], v[52:53], v[44:45], v[94:95] neg_lo:[0,0,1] neg_hi:[0,0,1]
    v_cvt_pk_f16_f32 v76, v52, v54
    v_cvt_pk_f16_f32 v77, v53, v55
    v_cvt_pk_f16_f32 v78, v60, v62
    v_cvt_pk_f16_f32 v79, v61, v63
    ds_write2_b64 v74, v[76:77], v[78:79] offset0:136 offset1:204
    v_pk_mul_f32 v[90:91], v[58:59], v[50:51]
    v_pk_mul_f32 v[94:95], v[58:59], v[46:47]
    v_pk_mul_f32 v[92:93], v[58:59], v[48:49]
    v_pk_mul_f32 v[96:97], v[58:59], v[44:45]
    v_pk_fma_f32 v[62:63], v[56:57], v[50:51], v[92:93]
    v_pk_fma_f32 v[54:55], v[56:57], v[46:47], v[96:97]
    v_pk_fma_f32 v[60:61], v[56:57], v[48:49], v[90:91] neg_lo:[0,0,1] neg_hi:[0,0,1]
    v_pk_fma_f32 v[52:53], v[56:57], v[44:45], v[94:95] neg_lo:[0,0,1] neg_hi:[0,0,1]
    v_cvt_pk_f16_f32 v98, v56, v58
    v_cvt_pk_f16_f32 v99, v57, v59
    v_cvt_pk_f16_f32 v100, v60, v62
    v_cvt_pk_f16_f32 v101, v61, v63
    ds_write2_b64 v75, v[98:99], v[100:101] offset0:0 offset1:68
    v_pk_mul_f32 v[90:91], v[54:55], v[50:51]
    v_pk_mul_f32 v[92:93], v[54:55], v[48:49]
    v_pk_fma_f32 v[62:63], v[52:53], v[50:51], v[92:93]
    v_pk_fma_f32 v[60:61], v[52:53], v[48:49], v[90:91] neg_lo:[0,0,1] neg_hi:[0,0,1]
    v_cvt_pk_f16_f32 v76, v52, v54
    v_cvt_pk_f16_f32 v77, v53, v55
    v_cvt_pk_f16_f32 v78, v60, v62
    v_cvt_pk_f16_f32 v79, v61, v63
    ds_write2_b64 v75, v[76:77], v[78:79] offset0:136 offset1:204
    s_branch JOBJ_19
JOB_18:
    v_mul_f32 v91, 0x41000000, v68
    v_mul_f32 v90, 0x41000000, v20
    v_mul_f32 v95, 0x41000000, v69
    v_mul_f32 v94, 0x41000000, v21
    v_fract_f32 v91, v91
    v_fract_f32 v95, v95
    v_fmac_f32 v91, 0x41000000, v70
    v_fmac_f32 v95, 0x41000000, v71
    v_exp_f32 v90, v90
    v_cos_f32 v92, v91
    v_sin_f32 v91, v91
    v_exp_f32 v94, v94
    v_cos_f32 v96, v95
    v_sin_f32 v95, v95
    v_mul_f32 v40, v90, v92
    v_mul_f32 v42, v90, -v91
    v_mul_f32 v41, v94, v96
    v_mul_f32 v43, v94, -v95
    v_mov_b32 v52, 0x47000000
    v_mov_b32 v53, 0x47000000
    v_mov_b32 v54, 0
    v_mov_b32 v55, 0
    v_pk_mul_f32 v[90:91], v[42:43], v[42:43]
    v_pk_mul_f32 v[60:61], v[40:41], v[52:53]
    v_pk_mul_f32 v[92:93], v[40:41], v[42:43]
    v_pk_mul_f32 v[62:63], v[42:43], v[52:53]
    v_pk_fma_f32 v[44:45], v[40:41], v[40:41], v[90:91] neg_lo:[0,0,1] neg_hi:[0,0,1]
    v_pk_add_f32 v[46:47], v[92:93], v[92:93]
    v_pk_mul_f32 v[56:57], v[44:45], v[52:53]
    v_pk_mul_f32 v[94:95], v[62:63], v[46:47]
    v_pk_mul_f32 v[58:59], v[46:47], v[52:53]
    v_pk_mul_f32 v[96:97], v[62:63], v[44:45]
    v_pk_fma_f32 v[66:67], v[60:61], v[46:47], v[96:97]
    v_pk_fma_f32 v[64:65], v[60:61], v[44:45], v[94:95] neg_lo:[0,0,1] neg_hi:[0,0,1]
    v_cvt_pk_f16_f32 v98, v52, v54
    v_cvt_pk_f16_f32 v99, v53, v55
    v_cvt_pk_f16_f32 v100, v60, v62
    v_cvt_pk_f16_f32 v101, v61, v63
    ds_write2_b64 v72, v[98:99], v[100:101] offset0:0 offset1:68
    v_pk_mul_f32 v[90:91], v[58:59], v[46:47]
    v_pk_mul_f32 v[94:95], v[66:67], v[46:47]
    v_pk_mul_f32 v[92:93], v[58:59], v[44:45]
    v_pk_mul_f32 v[96:97], v[66:67], v[44:45]
    v_pk_fma_f32 v[54:55], v[56:57], v[46:47], v[92:93]
    v_pk_fma_f32 v[62:63], v[64:65], v[46:47], v[96:97]
    v_pk_fma_f32 v[52:53], v[56:57], v[44:45], v[90:91] neg_lo:[0,0,1] neg_hi:[0,0,1]
    v_pk_fma_f32 v[60:61], v[64:65], v[44:45], v[94:95] neg_lo:[0,0,1] neg_hi:[0,0,1]
    v_cvt_pk_f16_f32 v76, v56, v58
    v_cvt_pk_f16_f32 v77, v57, v59
    v_cvt_pk_f16_f32 v78, v64, v66
    v_cvt_pk_f16_f32 v79, v65, v67
    ds_write2_b64 v72, v[76:77], v[78:79] offset0:136 offset1:204
    v_pk_mul_f32 v[90:91], v[54:55], v[46:47]
    v_pk_mul_f32 v[94:95], v[62:63], v[46:47]
    v_pk_mul_f32 v[92:93], v[54:55], v[44:45]
    v_pk_mul_f32 v[96:97], v[62:63], v[44:45]
    v_pk_fma_f32 v[58:59], v[52:53], v[46:47], v[92:93]
    v_pk_fma_f32 v[66:67], v[60:61], v[46:47], v[96:97]
    v_pk_fma_f32 v[56:57], v[52:53], v[44:45], v[90:91] neg_lo:[0,0,1] neg_hi:[0,0,1]
    v_pk_fma_f32 v[64:65], v[60:61], v[44:45], v[94:95] neg_lo:[0,0,1] neg_hi:[0,0,1]
    v_cvt_pk_f16_f32 v98, v52, v54
    v_cvt_pk_f16_f32 v99, v53, v55
    v_cvt_pk_f16_f32 v100, v60, v62
    v_cvt_pk_f16_f32 v101, v61, v63
    ds_write2_b64 v73, v[98:99], v[100:101] offset0:0 offset1:68
    v_pk_mul_f32 v[90:91], v[58:59], v[46:47]
    v_pk_mul_f32 v[94:95], v[66:67], v[46:47]
    v_pk_mul_f32 v[92:93], v[58:59], v[44:45]
    v_pk_mul_f32 v[96:97], v[66:67], v[44:45]
    v_pk_fma_f32 v[54:55], v[56:57], v[46:47], v[92:93]
    v_pk_fma_f32 v[62:63], v[64:65], v[46:47], v[96:97]
    v_pk_fma_f32 v[52:53], v[56:57], v[44:45], v[90:91] neg_lo:[0,0,1] neg_hi:[0,0,1]
    v_pk_fma_f32 v[60:61], v[64:65], v[44:45], v[94:95] neg_lo:[0,0,1] neg_hi:[0,0,1]
    v_cvt_pk_f16_f32 v76, v56, v58
    v_cvt_pk_f16_f32 v77, v57, v59
    v_cvt_pk_f16_f32 v78, v64, v66
    v_cvt_pk_f16_f32 v79, v65, v67
    ds_write2_b64 v73, v[76:77], v[78:79] offset0:136 offset1:204
    v_pk_mul_f32 v[90:91], v[54:55], v[46:47]
    v_pk_mul_f32 v[94:95], v[62:63], v[46:47]
    v_pk_mul_f32 v[92:93], v[54:55], v[44:45]
    v_pk_mul_f32 v[96:97], v[62:63], v[44:45]
    v_pk_fma_f32 v[58:59], v[52:53], v[46:47], v[92:93]
    v_pk_fma_f32 v[66:67], v[60:61], v[46:47], v[96:97]
    v_pk_fma_f32 v[56:57], v[52:53], v[44:45], v[90:91] neg_lo:[0,0,1] neg_hi:[0,0,1]
    v_pk_fma_f32 v[64:65], v[60:61], v[44:45], v[94:95] neg_lo:[0,0,1] neg_hi:[0,0,1]
    v_cvt_pk_f16_f32 v98, v52, v54
    v_cvt_pk_f16_f32 v99, v53, v55
    v_cvt_pk_f16_f32 v100, v60, v62
    v_cvt_pk_f16_f32 v101, v61, v63
    ds_write2_b64 v74, v[98:99], v[100:101] offset0:0 offset1:68
    v_pk_mul_f32 v[90:91], v[58:59], v[46:47]
    v_pk_mul_f32 v[94:95], v[66:67], v[46:47]
    v_pk_mul_f32 v[92:93], v[58:59], v[44:45]
    v_pk_mul_f32 v[96:97], v[66:67], v[44:45]
    v_pk_fma_f32 v[54:55], v[56:57], v[46:47], v[92:93]
    v_pk_fma_f32 v[62:63], v[64:65], v[46:47], v[96:97]
    v_pk_fma_f32 v[52:53], v[56:57], v[44:45], v[90:91] neg_lo:[0,0,1] neg_hi:[0,0,1]
    v_pk_fma_f32 v[60:61], v[64:65], v[44:45], v[94:95] neg_lo:[0,0,1] neg_hi:[0,0,1]
    v_cvt_pk_f16_f32 v76, v56, v58
    v_cvt_pk_f16_f32 v77, v57, v59
    v_cvt_pk_f16_f32 v78, v64, v66
    v_cvt_pk_f16_f32 v79, v65, v67
    ds_write2_b64 v74, v[76:77], v[78:79] offset0:136 offset1:204
    v_pk_mul_f32 v[90:91], v[54:55], v[46:47]
    v_pk_mul_f32 v[94:95], v[62:63], v[46:47]
    v_pk_mul_f32 v[92:93], v[54:55], v[44:45]
    v_pk_mul_f32 v[96:97], v[62:63], v[44:45]
    v_pk_fma_f32 v[58:59], v[52:53], v[46:47], v[92:93]
    v_pk_fma_f32 v[66:67], v[60:61], v[46:47], v[96:97]
    v_pk_fma_f32 v[56:57], v[52:53], v[44:45], v[90:91] neg_lo:[0,0,1] neg_hi:[0,0,1]
    v_pk_fma_f32 v[64:65], v[60:61], v[44:45], v[94:95] neg_lo:[0,0,1] neg_hi:[0,0,1]
    v_cvt_pk_f16_f32 v98, v52, v54
    v_cvt_pk_f16_f32 v99, v53, v55
    v_cvt_pk_f16_f32 v100, v60, v62
    v_cvt_pk_f16_f32 v101, v61, v63
    ds_write2_b64 v75, v[98:99], v[100:101] offset0:0 offset1:68
    v_cvt_pk_f16_f32 v76, v56, v58
    v_cvt_pk_f16_f32 v77, v57, v59
    v_cvt_pk_f16_f32 v78, v64, v66
    v_cvt_pk_f16_f32 v79, v65, v67
    ds_write2_b64 v75, v[76:77], v[78:79] offset0:136 offset1:204
    ds_write_b8 v15, v5 offset:64
    s_cmp_eq_u32 s87, 2
    s_cbranch_scc1 KS_G0
    s_branch EXP_13
KC_SEND:
W_20:
    ds_read_b32 v104, v105 offset:224
    s_sub_u32 s39, s39, 1
    s_cbranch_scc1 KS_ABORT
    s_waitcnt lgkmcnt(0)
    v_cmp_eq_u32 vcc, 0, v104
    s_cbranch_vccnz W_20
    s_lshl_b32 s92, s88, 12
    s_lshl_b32 s93, s86, 10
    s_add_u32 s92, s92, s93
    s_add_u32 s92, s92, 0x920000
    v_add_u32 v24, s92, v12
    s_mov_b32 s93, 0xffff
    v_lshlrev_b32 v25, 16, v104
    v_cvt_f16_f32 v20, v20
    v_cvt_f16_f32 v21, v21
    v_cvt_f16_f32 v22, v22
    v_cvt_f16_f32 v23, v23
    s_cmp_lg_u32 s86, 2
    s_cbranch_scc1 KC_S2
    s_mov_b32 exec_lo, 0
    s_mov_b32 exec_hi, 0xffff0000
    v_mov_b32 v20, v106
    v_lshrrev_b32 v21, 16, v106
    s_mov_b64 exec, -1
KC_S2:
    v_bfi_b32 v20, s93, v20, v104
    v_bfi_b32 v21, s93, v21, v25
    v_bfi_b32 v22, s93, v22, v104
    v_bfi_b32 v23, s93, v23, v25
    global_store_dwordx4 v24, v[20:23], s[36:37] sc1
    s_branch KS_G0
KC_RECV:
    s_cmp_eq_u32 s86, 3
    s_cbranch_scc1 EXP_13
    s_lshl_b32 s92, s88, 12
    s_lshl_b32 s93, s86, 10
    s_add_u32 s92, s92, s93
    s_add_u32 s92, s92, 0x920000
    v_add_u32 v24, s92, v12
W_21:
    s_sleep 2
    ds_read_b32 v104, v105 offset:224
    s_sub_u32 s39, s39, 1
    s_cbranch_scc1 KS_ABORT
    s_waitcnt lgkmcnt(0)
    v_cmp_eq_u32 vcc, 0, v104
    s_cbranch_vccnz W_21
    v_lshlrev_b32 v25, 16, v104
W_22:
    s_sleep 2
    ds_read_b32 v17, v4 offset:68
    s_sub_u32 s39, s39, 1
    s_cbranch_scc1 KS_ABORT
    s_waitcnt lgkmcnt(0)
    v_cmp_ne_u32 vcc, s84, v17
    s_cbranch_vccnz W_22
    s_branch KPE_24
KP_23:
    s_sleep 2
KPE_24:
    global_load_dwordx4 v[20:23], v24, s[36:37] sc1
    s_sub_u32 s39, s39, 1
    s_cbranch_scc1 KS_ABORT
    s_waitcnt vmcnt(0)
    v_xor_b32 v20, v104, v20
    v_xor_b32 v21, v25, v21
    v_xor_b32 v22, v104, v22
    v_xor_b32 v23, v25, v23
    v_or3_b32 v26, v20, v21, v22
    v_or_b32 v26, v26, v23
    v_cmp_lt_u32 vcc, 0xffff, v26
    s_cbranch_vccnz KP_23
    v_xor_b32 v20, v104, v20
    v_xor_b32 v22, v104, v22
    ds_write_b16 v108, v20
    ds_write_b16 v109, v21
    ds_write_b16 v112, v22
    ds_write_b16 v113, v23
    s_cmp_lg_u32 s86, 2
    s_cbranch_scc1 EXP_13
    v_and_b32 v20, 0xffff, v20
    v_lshl_or_b32 v20, v21, 16, v20
    v_lshlrev_b32 v21, 16, v107
    s_mov_b32 exec_lo, 0
    s_mov_b32 exec_hi, 0x10000
    ds_write_b64 v14, v[20:21] offset:832
    s_mov_b64 exec, -1
    s_branch EXP_13
JOB_17:
    v_mul_f32 v91, 0x43000000, v68
    v_mul_f32 v90, 0x43000000, v20
    v_mul_f32 v95, 0x43000000, v69
    v_mul_f32 v94, 0x43000000, v21
    v_fract_f32 v91, v91
    v_fract_f32 v95, v95
    v_fmac_f32 v91, 0x43000000, v70
    v_fmac_f32 v95, 0x43000000, v71
    v_exp_f32 v90, v90
    v_cos_f32 v92, v91
    v_sin_f32 v91, v91
    v_exp_f32 v94, v94
    v_cos_f32 v96, v95
    v_sin_f32 v95, v95
    v_mul_f32 v44, v90, v92
    v_mul_f32 v46, v90, v91
    v_mul_f32 v45, v94, v96
    v_mul_f32 v47, v94, v95
    v_pk_mul_f32 v[32:33], v[32:33], s[16:17] op_sel_hi:[1,0]
    v_pk_mul_f32 v[34:35], v[34:35], s[16:17] op_sel_hi:[1,0]
    v_pk_mul_f32 v[90:91], v[46:47], v[46:47]
    v_pk_mul_f32 v[94:95], v[34:35], v[46:47]
    v_pk_mul_f32 v[92:93], v[44:45], v[46:47]
    v_pk_mul_f32 v[96:97], v[34:35], v[44:45]
    v_pk_fma_f32 v[40:41], v[44:45], v[44:45], v[90:91] neg_lo:[0,0,1] neg_hi:[0,0,1]
    v_pk_fma_f32 v[66:67], v[32:33], v[46:47], v[96:97]
    v_pk_add_f32 v[42:43], v[92:93], v[92:93]
    v_pk_fma_f32 v[64:65], v[32:33], v[44:45], v[94:95] neg_lo:[0,0,1] neg_hi:[0,0,1]
    v_pk_mul_f32 v[90:91], v[42:43], v[42:43]
    v_pk_mul_f32 v[92:93], v[40:41], v[42:43]
    v_pk_fma_f32 v[48:49], v[40:41], v[40:41], v[90:91] neg_lo:[0,0,1] neg_hi:[0,0,1]
    v_pk_add_f32 v[50:51], v[92:93], v[92:93]
    v_pk_mul_f32 v[90:91], v[50:51], v[50:51]
    v_pk_mul_f32 v[92:93], v[48:49], v[50:51]
    v_pk_fma_f32 v[48:49], v[48:49], v[48:49], v[90:91] neg_lo:[0,0,1] neg_hi:[0,0,1]
    v_pk_add_f32 v[50:51], v[92:93], v[92:93]
    v_pk_mul_f32 v[90:91], v[34:35], v[50:51]
    v_pk_mul_f32 v[94:95], v[66:67], v[50:51]
    v_pk_mul_f32 v[92:93], v[34:35], v[48:49]
    v_pk_mul_f32 v[96:97], v[66:67], v[48:49]
    v_pk_fma_f32 v[54:55], v[32:33], v[50:51], v[92:93]
    v_pk_fma_f32 v[62:63], v[64:65], v[50:51], v[96:97]
    v_pk_fma_f32 v[52:53], v[32:33], v[48:49], v[90:91] neg_lo:[0,0,1] neg_hi:[0,0,1]
    v_pk_fma_f32 v[60:61], v[64:65], v[48:49], v[94:95] neg_lo:[0,0,1] neg_hi:[0,0,1]
    v_pk_mul_f32 v[90:91], v[54:55], v[42:43]
    v_pk_mul_f32 v[94:95], v[62:63], v[42:43]
    v_pk_mul_f32 v[92:93], v[54:55], v[40:41]
    v_pk_mul_f32 v[96:97], v[62:63], v[40:41]
    v_pk_fma_f32 v[58:59], v[52:53], v[42:43], v[92:93]
    v_pk_fma_f32 v[66:67], v[60:61], v[42:43], v[96:97]
    v_pk_fma_f32 v[56:57], v[52:53], v[40:41], v[90:91] neg_lo:[0,0,1] neg_hi:[0,0,1]
    v_pk_fma_f32 v[64:65], v[60:61], v[40:41], v[94:95] neg_lo:[0,0,1] neg_hi:[0,0,1]
    v_cvt_pk_f16_f32 v98, v52, v54
    v_cvt_pk_f16_f32 v99, v53, v55
    v_cvt_pk_f16_f32 v100, v60, v62
    v_cvt_pk_f16_f32 v101, v61, v63
    ds_write2_b64 v72, v[98:99], v[100:101] offset0:0 offset1:68
    v_pk_mul_f32 v[90:91], v[58:59], v[42:43]
    v_pk_mul_f32 v[94:95], v[66:67], v[42:43]
    v_pk_mul_f32 v[92:93], v[58:59], v[40:41]
    v_pk_mul_f32 v[96:97], v[66:67], v[40:41]
    v_pk_fma_f32 v[54:55], v[56:57], v[42:43], v[92:93]
    v_pk_fma_f32 v[62:63], v[64:65], v[42:43], v[96:97]
    v_pk_fma_f32 v[52:53], v[56:57], v[40:41], v[90:91] neg_lo:[0,0,1] neg_hi:[0,0,1]
    v_pk_fma_f32 v[60:61], v[64:65], v[40:41], v[94:95] neg_lo:[0,0,1] neg_hi:[0,0,1]
    v_cvt_pk_f16_f32 v76, v56, v58
    v_cvt_pk_f16_f32 v77, v57, v59
    v_cvt_pk_f16_f32 v78, v64, v66
    v_cvt_pk_f16_f32 v79, v65, v67
    ds_write2_b64 v72, v[76:77], v[78:79] offset0:136 offset1:204
    v_pk_mul_f32 v[90:91], v[54:55], v[42:43]
    v_pk_mul_f32 v[94:95], v[62:63], v[42:43]
    v_pk_mul_f32 v[92:93], v[54:55], v[40:41]
    v_pk_mul_f32 v[96:97], v[62:63], v[40:41]
    v_pk_fma_f32 v[58:59], v[52:53], v[42:43], v[92:93]
    v_pk_fma_f32 v[66:67], v[60:61], v[42:43], v[96:97]
    v_pk_fma_f32 v[56:57], v[52:53], v[40:41], v[90:91] neg_lo:[0,0,1] neg_hi:[0,0,1]
    v_pk_fma_f32 v[64:65], v[60:61], v[40:41], v[94:95] neg_lo:[0,0,1] neg_hi:[0,0,1]
    v_cvt_pk_f16_f32 v98, v52, v54
    v_cvt_pk_f16_f32 v99, v53, v55
    v_cvt_pk_f16_f32 v100, v60, v62
    v_cvt_pk_f16_f32 v101, v61, v63
    ds_write2_b64 v73, v[98:99], v[100:101] offset0:0 offset1:68
    v_pk_mul_f32 v[90:91], v[58:59], v[42:43]
    v_pk_mul_f32 v[92:93], v[58:59], v[40:41]
    v_pk_fma_f32 v[54:55], v[56:57], v[42:43], v[92:93]
    v_pk_fma_f32 v[52:53], v[56:57], v[40:41], v[90:91] neg_lo:[0,0,1] neg_hi:[0,0,1]
    v_cvt_pk_f16_f32 v76, v56, v58
    v_cvt_pk_f16_f32 v77, v57, v59
    v_cvt_pk_f16_f32 v78, v64, v66
    v_cvt_pk_f16_f32 v79, v65, v67
    ds_write2_b64 v73, v[76:77], v[78:79] offset0:136 offset1:204
    v_cvt_pk_f16_f32 v98, v52, v54
    v_cvt_pk_f16_f32 v99, v53, v55
    v_mov_b32 v36, 0x4538aa3b
    v_mul_f32 v24, s14, v36
    v_max_f32 v24, 0, v24
    v_exp_f32 v24, v24
    ds_write_b64 v74, v[98:99] offset:0
    s_sub_u32 s11, s15, 7
    s_lshl_b32 s11, s11, 23
    v_lshlrev_b32 v25, 16, v107
    v_mul_f32 v24, s11, v24
    v_mov_b32 v106, v24
    ds_write_b64 v14, v[24:25] offset:832
JOBJ_19:
    ds_write_b8 v15, v5 offset:64
    ds_read_b128 v[40:43], v127 offset:0
    ds_read_b128 v[44:47], v127 offset:64
    ds_read_b128 v[48:51], v127 offset:128
    ds_read_b128 v[52:55], v127 offset:192
    ds_read_b128 v[56:59], v127 offset:256
    ds_read_b128 v[60:63], v127 offset:320
    ds_read_b128 v[64:67], v127 offset:384
    ds_read_b128 v[68:71], v127 offset:448
    v_mov_b32 v36, 0x3fb8aa3b
    v_mul_f32 v36, s14, v36
    v_mul_f32 v37, 0x45000000, v36
    v_max_f32 v37, 0, v37
    v_add_f32 v37, 0x41b80000, v37
    v_fma_f32 v110, v110, v36, -v37
    v_fma_f32 v111, v111, v36, -v37
    v_fma_f32 v114, v114, v36, -v37
    v_fma_f32 v115, v115, v36, -v37
    v_exp_f32 v110, v110
    v_exp_f32 v111, v111
    v_exp_f32 v114, v114
    v_exp_f32 v115, v115
W_25:
    ds_read_u8 v17, v14 offset:67
    s_sub_u32 s39, s39, 1
    s_cbranch_scc1 KS_ABORT
    s_waitcnt lgkmcnt(0)
    v_cmp_eq_u32 vcc, 0, v17
    s_cbranch_vccnz W_25
    ds_read_b128 v[72:75], v126 offset:22304
    ds_read_b128 v[76:79], v126 offset:22368
    ds_read_b128 v[80:83], v126 offset:22432
    ds_read_b128 v[84:87], v126 offset:22496
    ds_read_b128 v[88:91], v126 offset:22560
    ds_read_b128 v[92:95], v126 offset:22624
    ds_read_b128 v[96:99], v126 offset:22688
    ds_read_b128 v[100:103], v126 offset:22752
    s_waitcnt lgkmcnt(7)
    v_mfma_f32_16x16x32_f16 v[20:23], v[40:43], v[72:75], 0
    s_waitcnt lgkmcnt(6)
    v_mfma_f32_16x16x32_f16 v[24:27], v[44:47], v[76:79], 0
    s_waitcnt lgkmcnt(5)
    v_mfma_f32_16x16x32_f16 v[20:23], v[48:51], v[80:83], v[20:23]
    s_waitcnt lgkmcnt(4)
    v_mfma_f32_16x16x32_f16 v[24:27], v[52:55], v[84:87], v[24:27]
    s_waitcnt lgkmcnt(3)
    v_mfma_f32_16x16x32_f16 v[20:23], v[56:59], v[88:91], v[20:23]
    s_waitcnt lgkmcnt(2)
    v_mfma_f32_16x16x32_f16 v[24:27], v[60:63], v[92:95], v[24:27]
    s_waitcnt lgkmcnt(1)
    v_mfma_f32_16x16x32_f16 v[20:23], v[64:67], v[96:99], v[20:23]
    s_waitcnt lgkmcnt(0)
    v_mfma_f32_16x16x32_f16 v[24:27], v[68:71], v[100:103], v[24:27]
    s_nop 7
    v_add_f32 v20, v20, v24
    v_add_f32 v21, v21, v25
    v_add_f32 v22, v22, v26
    v_add_f32 v23, v23, v27
    v_mul_f32 v20, v20, v110
    v_mul_f32 v21, v21, v111
    v_mul_f32 v22, v22, v114
    v_mul_f32 v23, v23, v115
    s_cmp_eq_u32 s87, 2
    s_cbranch_scc1 KC_SEND
    v_cvt_f16_f32 v20, v20
    ds_write_b16 v108, v20
    v_cvt_f16_f32 v21, v21
    ds_write_b16 v109, v21
    v_cvt_f16_f32 v22, v22
    ds_write_b16 v112, v22
    v_cvt_f16_f32 v23, v23
    ds_write_b16 v113, v23
EXP_13:
    ds_write_b8 v15, v5 offset:68
    v_mov_b32 v28, 0
    v_mov_b32 v29, 0
    v_mov_b32 v30, 0
    v_mov_b32 v31, 0
    v_mov_b32 v32, s85
    s_waitcnt vmcnt(0)
W_26:
    ds_read_b32 v20, v14 offset:68
    s_sub_u32 s39, s39, 1
    s_cbranch_scc1 KS_ABORT
    s_waitcnt lgkmcnt(0)
    v_cmp_ne_u32 vcc, s84, v20
    s_cbranch_vccnz W_26
    ds_read_u16 v20, v116
    ds_read_u16 v21, v117
    ds_read_u16 v22, v118
    ds_read_u16 v23, v120
    ds_read_u16 v24, v121
    ds_read_u16 v25, v122
    ds_read_u16 v26, v123
    s_mov_b64 exec, 1
    ds_write_b128 v32, v[28:31] offset:3088
    ds_write_b128 v32, v[28:31] offset:8224
    ds_write_b128 v32, v[28:31] offset:3072
    s_mov_b64 exec, -1
    s_waitcnt lgkmcnt(7)
    v_lshl_or_b32 v28, v21, 16, v20
    v_lshl_or_b32 v29, v22, 16, v21
    ds_write_b32 v124, v28 offset:32528
    ds_write_b32 v124, v29 offset:33872
    s_waitcnt lgkmcnt(5)
    v_lshl_or_b32 v30, v24, 16, v23
    v_lshl_or_b32 v31, v26, 16, v25
    ds_write_b32 v119, v30
    ds_write_b32 v125, v31
    ds_write_b8 v15, v5 offset:72
W_27:
    ds_read_b32 v20, v14 offset:72
    s_sub_u32 s39, s39, 1
    s_cbranch_scc1 KS_ABORT
    s_waitcnt lgkmcnt(0)
    v_cmp_ne_u32 vcc, s84, v20
    s_cbranch_vccnz W_27
    ds_read_b64 v[16:17], v14 offset:832
    s_cmp_eq_u32 s86, 1
    s_cbranch_scc1 CV_29
    s_cmp_eq_u32 s86, 2
    s_cbranch_scc1 CV_30
    s_cmp_eq_u32 s86, 3
    s_cbranch_scc1 CV_31
    ds_read2_b32 v[32:33], v6 offset0:144 offset1:145
    ds_read2_b32 v[34:35], v6 offset0:146 offset1:147
    ds_read2_b32 v[36:37], v6 offset0:16 offset1:17
    ds_read2_b32 v[38:39], v6 offset0:18 offset1:19
    ds_read2_b32 v[40:41], v6 offset0:160 offset1:161
    ds_read2_b32 v[42:43], v6 offset0:162 offset1:163
    ds_read2_b32 v[44:45], v6 offset0:32 offset1:33
    ds_read2_b32 v[46:47], v6 offset0:34 offset1:35
    ds_read2_b32 v[48:49], v6 offset0:176 offset1:177
    ds_read2_b32 v[50:51], v6 offset0:178 offset1:179
    ds_read2_b32 v[52:53], v6 offset0:48 offset1:49
    ds_read2_b32 v[54:55], v6 offset0:50 offset1:51
    ds_read2_b32 v[56:57], v6 offset0:192 offset1:193
    ds_read2_b32 v[58:59], v6 offset0:194 offset1:195
    ds_read2_b32 v[60:61], v6 offset0:64 offset1:65
    ds_read2_b32 v[62:63], v6 offset0:66 offset1:67
    ds_read2_b32 v[64:65], v6 offset0:208 offset1:209
    ds_read2_b32 v[66:67], v6 offset0:210 offset1:211
    ds_read2_b32 v[68:69], v6 offset0:80 offset1:81
    ds_read2_b32 v[70:71], v6 offset0:82 offset1:83
    ds_read2_b32 v[72:73], v6 offset0:224 offset1:225
    ds_read2_b32 v[74:75], v6 offset0:226 offset1:227
    ds_read2_b32 v[76:77], v6 offset0:96 offset1:97
    ds_read2_b32 v[78:79], v6 offset0:98 offset1:99
    ds_read2_b32 v[80:81], v6 offset0:240 offset1:241
    ds_read2_b32 v[82:83], v6 offset0:242 offset1:243
    ds_read2_b32 v[84:85], v6 offset0:112 offset1:113
    ds_read2_b32 v[86:87], v6 offset0:114 offset1:115
    ds_read2_b32 v[88:89], v7 offset0:96 offset1:97
    ds_read2_b32 v[90:91], v7 offset0:98 offset1:99
    ds_read2_b32 v[92:93], v6 offset0:128 offset1:129
    ds_read2_b32 v[94:95], v6 offset0:130 offset1:131
    v_lshlrev_b32 v18, 3, v3
    v_sub_u32 v18, v8, v18
    v_lshrrev_b32 v19, 2, v2
    v_lshl_add_u32 v19, v19, 2, v3
    v_and_b32 v28, 3, v2
    v_lshlrev_b32 v28, 4, v28
    v_mul_u32_u24 v19, s8, v19
    v_xor_b32 v19, s10, v19
    s_waitcnt lgkmcnt(0)
    v_mov_b32 v7, v18
    v_add_u32 v6, v19, v28
    v_xor_b32 v12, s9, v12
W_33:
    ds_read_b32 v18, v4 offset:16
    s_sub_u32 s39, s39, 1
    s_cbranch_scc1 KS_ABORT
    s_waitcnt lgkmcnt(0)
    v_cmp_ne_u32 vcc, s84, v18
    s_cbranch_vccnz W_33
    s_setprio 1
    ds_read_b128 v[96:99], v8 offset:0
    ds_read_b128 v[100:103], v8 offset:64
    ds_read_b128 v[104:107], v8 offset:128
    ds_read_b128 v[108:111], v8 offset:192
    s_waitcnt lgkmcnt(3)
    v_mfma_f32_16x16x32_f16 v[20:23], v[32:35], v[96:99], 0
    v_mfma_f32_16x16x32_f16 v[24:27], v[36:39], v[96:99], 0
    ds_read_b128 v[112:115], v8 offset:256
    s_waitcnt lgkmcnt(3)
    v_mfma_f32_16x16x32_f16 v[20:23], v[40:43], v[100:103], v[20:23]
    ds_read_b64 v[28:29], v7 offset:480
    ds_read_b64 v[30:31], v7 offset:992
    v_mfma_f32_16x16x32_f16 v[24:27], v[44:47], v[100:103], v[24:27]
    ds_read_b128 v[116:119], v8 offset:320
    s_waitcnt lgkmcnt(5)
    v_mfma_f32_16x16x32_f16 v[20:23], v[48:51], v[104:107], v[20:23]
    v_mfma_f32_16x16x32_f16 v[24:27], v[52:55], v[104:107], v[24:27]
    ds_read_b128 v[120:123], v8 offset:384
    s_waitcnt lgkmcnt(2)
    v_fma_mix_f32 v104, v28, v17, 0 op_sel_hi:[1,0,0]
    v_fma_mix_f32 v105, v28, v17, 0 op_sel:[1,0,0] op_sel_hi:[1,0,0]
    v_mfma_f32_16x16x32_f16 v[20:23], v[56:59], v[108:111], v[20:23]
    v_fma_mix_f32 v106, v29, v17, 0 op_sel_hi:[1,0,0]
    v_fma_mix_f32 v107, v29, v17, 0 op_sel:[1,0,0] op_sel_hi:[1,0,0]
    v_mfma_f32_16x16x32_f16 v[24:27], v[60:63], v[108:111], v[24:27]
    ds_read_b128 v[124:127], v8 offset:448
    v_cvt_pk_bf16_f32 v104, 0, v104
    v_cvt_pk_bf16_f32 v105, 0, v105
    v_mfma_f32_16x16x32_f16 v[20:23], v[64:67], v[112:115], v[20:23]
    v_cvt_pk_bf16_f32 v106, 0, v106
    v_cvt_pk_bf16_f32 v107, 0, v107
    v_mfma_f32_16x16x32_f16 v[24:27], v[68:71], v[112:115], v[24:27]
    ds_read_b128 v[36:39], v8 offset:512
    v_fma_mix_f32 v112, v30, v17, 0 op_sel_hi:[1,0,0]
    v_fma_mix_f32 v113, v30, v17, 0 op_sel:[1,0,0] op_sel_hi:[1,0,0]
    s_waitcnt lgkmcnt(3)
    v_mfma_f32_16x16x32_f16 v[20:23], v[72:75], v[116:119], v[20:23]
    ds_read_b128 v[96:99], v8 offset:576
    v_fma_mix_f32 v114, v31, v17, 0 op_sel_hi:[1,0,0]
    v_fma_mix_f32 v115, v31, v17, 0 op_sel:[1,0,0] op_sel_hi:[1,0,0]
    v_mfma_f32_16x16x32_f16 v[24:27], v[76:79], v[116:119], v[24:27]
    ds_read_b128 v[44:47], v8 offset:640
    v_cvt_pk_bf16_f32 v112, 0, v112
    v_cvt_pk_bf16_f32 v113, 0, v113
    s_waitcnt lgkmcnt(4)
    v_mfma_f32_16x16x32_f16 v[20:23], v[80:83], v[120:123], v[20:23]
    ds_read_b128 v[100:103], v8 offset:704
    v_cvt_pk_bf16_f32 v114, 0, v114
    v_cvt_pk_bf16_f32 v115, 0, v115
    v_mfma_f32_16x16x32_f16 v[24:27], v[84:87], v[120:123], v[24:27]
    ds_read_b128 v[52:55], v8 offset:768
    s_waitcnt lgkmcnt(5)
    v_mfma_f32_16x16x32_f16 v[20:23], v[88:91], v[124:127], v[20:23]
    ds_read_b128 v[60:63], v8 offset:832
    v_mfma_f32_16x16x32_f16 v[24:27], v[92:95], v[124:127], v[24:27]
    ds_read_b128 v[108:111], v8 offset:896
    s_waitcnt lgkmcnt(6)
    v_mfma_f32_16x16x32_f16 v[24:27], v[32:35], v[36:39], v[24:27]
    ds_read_b128 v[68:71], v8 offset:960
    s_nop 1
    v_mul_f32 v20, v20, v16
    v_mul_f32 v21, v21, v16
    s_waitcnt lgkmcnt(6)
    v_mfma_f32_16x16x32_f16 v[24:27], v[40:43], v[96:99], v[24:27]
    v_mul_f32 v22, v22, v16
    v_mul_f32 v23, v23, v16
    s_waitcnt lgkmcnt(5)
    v_mfma_f32_16x16x32_f16 v[24:27], v[48:51], v[44:47], v[24:27]
    v_cvt_pk_bf16_f32 v20, 0, v20
    v_cvt_pk_bf16_f32 v21, 0, v21
    s_waitcnt lgkmcnt(4)
    v_mfma_f32_16x16x32_f16 v[24:27], v[56:59], v[100:103], v[24:27]
    v_cvt_pk_bf16_f32 v22, 0, v22
    v_cvt_pk_bf16_f32 v23, 0, v23
    s_waitcnt lgkmcnt(3)
    v_mfma_f32_16x16x32_f16 v[24:27], v[64:67], v[52:55], v[24:27]
    v_add_f32 v20, v20, v104
    v_add_f32 v21, v21, v105
    s_waitcnt lgkmcnt(2)
    v_mfma_f32_16x16x32_f16 v[24:27], v[72:75], v[60:63], v[24:27]
    v_add_f32 v22, v22, v106
    v_add_f32 v23, v23, v107
    s_waitcnt lgkmcnt(1)
    v_mfma_f32_16x16x32_f16 v[24:27], v[80:83], v[108:111], v[24:27]
    v_cvt_pk_bf16_f32 v28, v20, v21
    v_cvt_pk_bf16_f32 v29, v22, v23
    s_waitcnt lgkmcnt(0)
    v_mfma_f32_16x16x32_f16 v[24:27], v[88:91], v[68:71], v[24:27]
    v_min_u32 v28, -2, v28
    v_min_u32 v29, -2, v29
    ds_read_u8 v18, v4 offset:160
    ds_read_b128 v[20:23], v12 offset:46592
    s_nop 3
    v_mul_f32 v24, v24, v16
    v_mul_f32 v25, v25, v16
    v_mul_f32 v26, v26, v16
    v_mul_f32 v27, v27, v16
    v_cvt_pk_bf16_f32 v24, 0, v24
    v_cvt_pk_bf16_f32 v25, 0, v25
    v_cvt_pk_bf16_f32 v26, 0, v26
    v_cvt_pk_bf16_f32 v27, 0, v27
    v_add_f32 v24, v24, v112
    v_add_f32 v25, v25, v113
    v_add_f32 v26, v26, v114
    v_add_f32 v27, v27, v115
    v_cvt_pk_bf16_f32 v30, v24, v25
    v_cvt_pk_bf16_f32 v31, v26, v27
    v_min_u32 v30, -2, v30
    v_min_u32 v31, -2, v31
    s_branch CVE_32
CV_29:
    ds_read2_b32 v[32:33], v6 offset0:0 offset1:1
    ds_read2_b32 v[34:35], v6 offset0:2 offset1:3
    ds_read2_b32 v[36:37], v6 offset0:16 offset1:17
    ds_read2_b32 v[38:39], v6 offset0:18 offset1:19
    ds_read2_b32 v[40:41], v6 offset0:32 offset1:33
    ds_read2_b32 v[42:43], v6 offset0:34 offset1:35
    ds_read2_b32 v[44:45], v6 offset0:48 offset1:49
    ds_read2_b32 v[46:47], v6 offset0:50 offset1:51
    ds_read2_b32 v[48:49], v6 offset0:64 offset1:65
    ds_read2_b32 v[50:51], v6 offset0:66 offset1:67
    ds_read2_b32 v[52:53], v6 offset0:80 offset1:81
    ds_read2_b32 v[54:55], v6 offset0:82 offset1:83
    ds_read2_b32 v[56:57], v6 offset0:96 offset1:97
    ds_read2_b32 v[58:59], v6 offset0:98 offset1:99
    ds_read2_b32 v[60:61], v6 offset0:112 offset1:113
    ds_read2_b32 v[62:63], v6 offset0:114 offset1:115
    ds_read2_b32 v[64:65], v6 offset0:128 offset1:129
    ds_read2_b32 v[66:67], v6 offset0:130 offset1:131
    ds_read2_b32 v[68:69], v6 offset0:144 offset1:145
    ds_read2_b32 v[70:71], v6 offset0:146 offset1:147
    ds_read2_b32 v[72:73], v6 offset0:160 offset1:161
    ds_read2_b32 v[74:75], v6 offset0:162 offset1:163
    ds_read2_b32 v[76:77], v6 offset0:176 offset1:177
    ds_read2_b32 v[78:79], v6 offset0:178 offset1:179
    ds_read2_b32 v[80:81], v6 offset0:192 offset1:193
    ds_read2_b32 v[82:83], v6 offset0:194 offset1:195
    ds_read2_b32 v[84:85], v6 offset0:208 offset1:209
    ds_read2_b32 v[86:87], v6 offset0:210 offset1:211
    ds_read2_b32 v[88:89], v6 offset0:224 offset1:225
    ds_read2_b32 v[90:91], v6 offset0:226 offset1:227
    ds_read2_b32 v[92:93], v6 offset0:240 offset1:241
    ds_read2_b32 v[94:95], v6 offset0:242 offset1:243
    ds_read2_b32 v[96:97], v7 offset0:96 offset1:97
    ds_read2_b32 v[98:99], v7 offset0:98 offset1:99
    ds_read2_b32 v[100:101], v11 offset0:32 offset1:33
    ds_read2_b32 v[102:103], v11 offset0:34 offset1:35
    ds_read2_b32 v[104:105], v11 offset0:96 offset1:97
    ds_read2_b32 v[106:107], v11 offset0:98 offset1:99
    v_lshlrev_b32 v18, 3, v3
    v_sub_u32 v18, v8, v18
    v_lshrrev_b32 v19, 2, v2
    v_lshl_add_u32 v19, v19, 2, v3
    v_and_b32 v28, 3, v2
    v_lshlrev_b32 v28, 4, v28
    v_mul_u32_u24 v19, s8, v19
    v_xor_b32 v19, s10, v19
    s_waitcnt lgkmcnt(0)
    v_mov_b32 v7, v18
    v_add_u32 v6, v19, v28
    v_xor_b32 v12, s9, v12
W_34:
    ds_read_b32 v18, v4 offset:16
    s_sub_u32 s39, s39, 1
    s_cbranch_scc1 KS_ABORT
    s_waitcnt lgkmcnt(0)
    v_cmp_ne_u32 vcc, s84, v18
    s_cbranch_vccnz W_34
    s_setprio 1
    ds_read_b128 v[108:111], v8 offset:448
    ds_read_b128 v[112:115], v8 offset:512
    ds_read_b128 v[116:119], v8 offset:576
    ds_read_b128 v[120:123], v8 offset:640
    ds_read_b128 v[124:127], v8 offset:704
    s_waitcnt lgkmcnt(4)
    v_mfma_f32_16x16x32_f16 v[20:23], v[32:35], v[108:111], 0
    ds_read_b128 v[108:111], v8 offset:768
    s_waitcnt lgkmcnt(4)
    v_mfma_f32_16x16x32_f16 v[20:23], v[36:39], v[112:115], v[20:23]
    ds_read_b128 v[112:115], v8 offset:832
    s_waitcnt lgkmcnt(4)
    v_mfma_f32_16x16x32_f16 v[20:23], v[40:43], v[116:119], v[20:23]
    ds_read_b128 v[116:119], v8 offset:896
    ds_read_b64 v[28:29], v7 offset:1504
    ds_read_b64 v[30:31], v7 offset:2016
    s_waitcnt lgkmcnt(6)
    v_mfma_f32_16x16x32_f16 v[20:23], v[44:47], v[120:123], v[20:23]
    ds_read_b128 v[120:123], v8 offset:960
    s_waitcnt lgkmcnt(6)
    v_mfma_f32_16x16x32_f16 v[20:23], v[48:51], v[124:127], v[20:23]
    ds_read_b128 v[124:127], v8 offset:1024
    s_waitcnt lgkmcnt(6)
    v_mfma_f32_16x16x32_f16 v[20:23], v[52:55], v[108:111], v[20:23]
    ds_read_b128 v[108:111], v8 offset:1088
    s_waitcnt lgkmcnt(6)
    v_mfma_f32_16x16x32_f16 v[20:23], v[56:59], v[112:115], v[20:23]
    s_waitcnt lgkmcnt(5)
    v_mfma_f32_16x16x32_f16 v[20:23], v[60:63], v[116:119], v[20:23]
    ds_read_b128 v[112:115], v8 offset:1152
    s_waitcnt lgkmcnt(3)
    v_mfma_f32_16x16x32_f16 v[20:23], v[64:67], v[120:123], v[20:23]
    v_mfma_f32_16x16x32_f16 v[24:27], v[32:35], v[120:123], 0
    ds_read_b128 v[116:119], v8 offset:1216
    v_fma_mix_f32 v120, v28, v17, 0 op_sel_hi:[1,0,0]
    v_fma_mix_f32 v121, v28, v17, 0 op_sel:[1,0,0] op_sel_hi:[1,0,0]
    s_waitcnt lgkmcnt(3)
    v_mfma_f32_16x16x32_f16 v[20:23], v[68:71], v[124:127], v[20:23]
    v_fma_mix_f32 v122, v29, v17, 0 op_sel_hi:[1,0,0]
    v_fma_mix_f32 v123, v29, v17, 0 op_sel:[1,0,0] op_sel_hi:[1,0,0]
    v_mfma_f32_16x16x32_f16 v[24:27], v[36:39], v[124:127], v[24:27]
    ds_read_b128 v[32:35], v8 offset:1280
    v_cvt_pk_bf16_f32 v120, 0, v120
    v_cvt_pk_bf16_f32 v121, 0, v121
    s_waitcnt lgkmcnt(3)
    v_mfma_f32_16x16x32_f16 v[20:23], v[72:75], v[108:111], v[20:23]
    v_cvt_pk_bf16_f32 v122, 0, v122
    v_cvt_pk_bf16_f32 v123, 0, v123
    v_mfma_f32_16x16x32_f16 v[24:27], v[40:43], v[108:111], v[24:27]
    ds_read_b128 v[36:39], v8 offset:1344
    v_fma_mix_f32 v108, v30, v17, 0 op_sel_hi:[1,0,0]
    v_fma_mix_f32 v109, v30, v17, 0 op_sel:[1,0,0] op_sel_hi:[1,0,0]
    s_waitcnt lgkmcnt(3)
    v_mfma_f32_16x16x32_f16 v[20:23], v[76:79], v[112:115], v[20:23]
    v_fma_mix_f32 v110, v31, v17, 0 op_sel_hi:[1,0,0]
    v_fma_mix_f32 v111, v31, v17, 0 op_sel:[1,0,0] op_sel_hi:[1,0,0]
    v_mfma_f32_16x16x32_f16 v[24:27], v[44:47], v[112:115], v[24:27]
    ds_read_b128 v[124:127], v8 offset:1408
    v_cvt_pk_bf16_f32 v108, 0, v108
    v_cvt_pk_bf16_f32 v109, 0, v109
    s_waitcnt lgkmcnt(3)
    v_mfma_f32_16x16x32_f16 v[20:23], v[80:83], v[116:119], v[20:23]
    v_cvt_pk_bf16_f32 v110, 0, v110
    v_cvt_pk_bf16_f32 v111, 0, v111
    v_mfma_f32_16x16x32_f16 v[24:27], v[48:51], v[116:119], v[24:27]
    ds_read_b128 v[40:43], v8 offset:1472
    s_waitcnt lgkmcnt(3)
    v_mfma_f32_16x16x32_f16 v[20:23], v[84:87], v[32:35], v[20:23]
    v_mfma_f32_16x16x32_f16 v[24:27], v[52:55], v[32:35], v[24:27]
    ds_read_b128 v[44:47], v8 offset:1536
    s_waitcnt lgkmcnt(3)
    v_mfma_f32_16x16x32_f16 v[20:23], v[88:91], v[36:39], v[20:23]
    ds_read_b128 v[112:115], v8 offset:1600
    v_mfma_f32_16x16x32_f16 v[24:27], v[56:59], v[36:39], v[24:27]
    ds_read_b128 v[48:51], v8 offset:1664
    s_waitcnt lgkmcnt(4)
    v_mfma_f32_16x16x32_f16 v[20:23], v[92:95], v[124:127], v[20:23]
    ds_read_b128 v[116:119], v8 offset:1728
    v_mfma_f32_16x16x32_f16 v[24:27], v[60:63], v[124:127], v[24:27]
    ds_read_b128 v[52:55], v8 offset:1792
    s_waitcnt lgkmcnt(5)
    v_mfma_f32_16x16x32_f16 v[20:23], v[96:99], v[40:43], v[20:23]
    ds_read_b128 v[32:35], v8 offset:1856
    v_mfma_f32_16x16x32_f16 v[24:27], v[64:67], v[40:43], v[24:27]
    ds_read_b32 v18, v14 offset:76
    ds_read_b128 v[56:59], v8 offset:1920
    s_waitcnt lgkmcnt(7)
    v_mfma_f32_16x16x32_f16 v[24:27], v[68:71], v[44:47], v[24:27]
    ds_read_b128 v[36:39], v8 offset:1984
    s_waitcnt lgkmcnt(7)
    v_mfma_f32_16x16x32_f16 v[24:27], v[72:75], v[112:115], v[24:27]
    ds_read2_b32 v[60:61], v11 offset0:16 offset1:17
    ds_read2_b32 v[62:63], v11 offset0:18 offset1:19
    s_waitcnt lgkmcnt(8)
    v_mfma_f32_16x16x32_f16 v[24:27], v[76:79], v[48:51], v[24:27]
    s_waitcnt lgkmcnt(4)
    v_cmp_ne_u32 vcc, s84, v18
    s_cbranch_vccnz WS_35
WB_36:
    ds_read_b64_tr_b16 v[124:125], v9 offset:0
    ds_read_b64_tr_b16 v[126:127], v9 offset:64
    ds_read_b64_tr_b16 v[64:65], v9 offset:3088
    ds_read_b64_tr_b16 v[66:67], v9 offset:3152
    v_mfma_f32_16x16x32_f16 v[24:27], v[80:83], v[116:119], v[24:27]
    v_mfma_f32_16x16x32_f16 v[24:27], v[84:87], v[52:55], v[24:27]
    ds_read_b64_tr_b16 v[40:41], v9 offset:512
    ds_read_b64_tr_b16 v[42:43], v9 offset:576
    ds_read2_b32 v[68:69], v11 offset0:80 offset1:81
    ds_read2_b32 v[70:71], v11 offset0:82 offset1:83
    v_mfma_f32_16x16x32_f16 v[24:27], v[88:91], v[32:35], v[24:27]
    s_waitcnt lgkmcnt(11)
    v_mfma_f32_16x16x32_f16 v[24:27], v[92:95], v[56:59], v[24:27]
    ds_read_b64_tr_b16 v[44:45], v9 offset:3600
    ds_read_b64_tr_b16 v[46:47], v9 offset:3664
    s_waitcnt lgkmcnt(12)
    v_mfma_f32_16x16x32_f16 v[24:27], v[96:99], v[36:39], v[24:27]
    s_waitcnt lgkmcnt(8)
    v_mfma_f32_16x16x32_f16 v[20:23], v[124:127], v[100:103], v[20:23]
    s_waitcnt lgkmcnt(6)
    v_mfma_f32_16x16x32_f16 v[20:23], v[64:67], v[104:107], v[20:23]
    v_mfma_f32_16x16x32_f16 v[24:27], v[124:127], v[60:63], v[24:27]
    s_waitcnt lgkmcnt(4)
    v_mfma_f32_16x16x32_f16 v[24:27], v[40:43], v[100:103], v[24:27]
    s_nop 4
    v_mul_f32 v20, v20, v16
    v_mul_f32 v21, v21, v16
    s_waitcnt lgkmcnt(2)
    v_mfma_f32_16x16x32_f16 v[24:27], v[64:67], v[68:71], v[24:27]
    v_mul_f32 v22, v22, v16
    v_mul_f32 v23, v23, v16
    s_waitcnt lgkmcnt(0)
    v_mfma_f32_16x16x32_f16 v[24:27], v[44:47], v[104:107], v[24:27]
    v_cvt_pk_bf16_f32 v20, 0, v20
    v_cvt_pk_bf16_f32 v21, 0, v21
    v_cvt_pk_bf16_f32 v22, 0, v22
    v_cvt_pk_bf16_f32 v23, 0, v23
    v_add_f32 v20, v20, v120
    v_add_f32 v21, v21, v121
    v_add_f32 v22, v22, v122
    v_add_f32 v23, v23, v123
    v_cvt_pk_bf16_f32 v28, v20, v21
    v_cvt_pk_bf16_f32 v29, v22, v23
    v_min_u32 v28, -2, v28
    v_min_u32 v29, -2, v29
    ds_read_u8 v18, v4 offset:161
    ds_read_b128 v[20:23], v12 offset:47616
    v_mul_f32 v24, v24, v16
    v_mul_f32 v25, v25, v16
    v_mul_f32 v26, v26, v16
    v_mul_f32 v27, v27, v16
    v_cvt_pk_bf16_f32 v24, 0, v24
    v_cvt_pk_bf16_f32 v25, 0, v25
    v_cvt_pk_bf16_f32 v26, 0, v26
    v_cvt_pk_bf16_f32 v27, 0, v27
    v_add_f32 v24, v24, v108
    v_add_f32 v25, v25, v109
    v_add_f32 v26, v26, v110
    v_add_f32 v27, v27, v111
    v_cvt_pk_bf16_f32 v30, v24, v25
    v_cvt_pk_bf16_f32 v31, v26, v27
    v_min_u32 v30, -2, v30
    v_min_u32 v31, -2, v31
    s_branch CVE_32
CV_30:
    ds_read2_b32 v[32:33], v7 offset0:128 offset1:129
    ds_read2_b32 v[34:35], v7 offset0:130 offset1:131
    ds_read2_b32 v[36:37], v6 offset0:0 offset1:1
    ds_read2_b32 v[38:39], v6 offset0:2 offset1:3
    ds_read2_b32 v[40:41], v6 offset0:16 offset1:17
    ds_read2_b32 v[42:43], v6 offset0:18 offset1:19
    ds_read2_b32 v[44:45], v6 offset0:32 offset1:33
    ds_read2_b32 v[46:47], v6 offset0:34 offset1:35
    ds_read2_b32 v[48:49], v6 offset0:48 offset1:49
    ds_read2_b32 v[50:51], v6 offset0:50 offset1:51
    ds_read2_b32 v[52:53], v6 offset0:64 offset1:65
    ds_read2_b32 v[54:55], v6 offset0:66 offset1:67
    ds_read2_b32 v[56:57], v6 offset0:80 offset1:81
    ds_read2_b32 v[58:59], v6 offset0:82 offset1:83
    ds_read2_b32 v[60:61], v6 offset0:96 offset1:97
    ds_read2_b32 v[62:63], v6 offset0:98 offset1:99
    ds_read2_b32 v[64:65], v6 offset0:112 offset1:113
    ds_read2_b32 v[66:67], v6 offset0:114 offset1:115
    ds_read2_b32 v[68:69], v6 offset0:128 offset1:129
    ds_read2_b32 v[70:71], v6 offset0:130 offset1:131
    ds_read2_b32 v[72:73], v6 offset0:144 offset1:145
    ds_read2_b32 v[74:75], v6 offset0:146 offset1:147
    ds_read2_b32 v[76:77], v6 offset0:160 offset1:161
    ds_read2_b32 v[78:79], v6 offset0:162 offset1:163
    ds_read2_b32 v[80:81], v6 offset0:176 offset1:177
    ds_read2_b32 v[82:83], v6 offset0:178 offset1:179
    ds_read2_b32 v[84:85], v6 offset0:192 offset1:193
    ds_read2_b32 v[86:87], v6 offset0:194 offset1:195
    ds_read2_b32 v[88:89], v6 offset0:208 offset1:209
    ds_read2_b32 v[90:91], v6 offset0:210 offset1:211
    ds_read2_b32 v[92:93], v6 offset0:224 offset1:225
    ds_read2_b32 v[94:95], v6 offset0:226 offset1:227
    ds_read2_b32 v[96:97], v6 offset0:240 offset1:241
    ds_read2_b32 v[98:99], v6 offset0:242 offset1:243
    ds_read2_b32 v[100:101], v7 offset0:96 offset1:97
    ds_read2_b32 v[102:103], v7 offset0:98 offset1:99
    ds_read2_b32 v[104:105], v11 offset0:0 offset1:1
    ds_read2_b32 v[106:107], v11 offset0:2 offset1:3
    v_lshlrev_b32 v18, 3, v3
    v_sub_u32 v18, v8, v18
    v_lshrrev_b32 v19, 2, v2
    v_lshl_add_u32 v19, v19, 2, v3
    v_and_b32 v28, 3, v2
    v_lshlrev_b32 v28, 4, v28
    v_mul_u32_u24 v19, s8, v19
    v_xor_b32 v19, s10, v19
    s_waitcnt lgkmcnt(0)
    v_mov_b32 v7, v18
    v_add_u32 v6, v19, v28
    v_xor_b32 v12, s9, v12
W_37:
    ds_read_b32 v18, v4 offset:16
    s_sub_u32 s39, s39, 1
    s_cbranch_scc1 KS_ABORT
    s_waitcnt lgkmcnt(0)
    v_cmp_ne_u32 vcc, s84, v18
    s_cbranch_vccnz W_37
    s_setprio 1
    ds_read_b128 v[108:111], v8 offset:448
    ds_read_b128 v[112:115], v8 offset:960
    ds_read_b128 v[116:119], v8 offset:1472
    ds_read_b128 v[120:123], v8 offset:1536
    ds_read_b128 v[124:127], v8 offset:1600
    s_waitcnt lgkmcnt(4)
    v_mfma_f32_16x16x32_f16 v[20:23], v[32:35], v[108:111], 0
    ds_read_b128 v[108:111], v8 offset:1664
    s_waitcnt lgkmcnt(4)
    v_mfma_f32_16x16x32_f16 v[24:27], v[32:35], v[112:115], 0
    ds_read_b128 v[32:35], v8 offset:1728
    ds_read_b128 v[112:115], v8 offset:1792
    s_waitcnt lgkmcnt(5)
    v_mfma_f32_16x16x32_f16 v[20:23], v[36:39], v[116:119], v[20:23]
    ds_read_b128 v[116:119], v8 offset:1856
    ds_read_b64 v[28:29], v7 offset:2528
    ds_read_b64 v[30:31], v7 offset:3040
    s_waitcnt lgkmcnt(7)
    v_mfma_f32_16x16x32_f16 v[20:23], v[40:43], v[120:123], v[20:23]
    ds_read_b128 v[120:123], v8 offset:1920
    s_waitcnt lgkmcnt(7)
    v_mfma_f32_16x16x32_f16 v[20:23], v[44:47], v[124:127], v[20:23]
    ds_read_b128 v[124:127], v8 offset:1984
    s_waitcnt lgkmcnt(7)
    v_mfma_f32_16x16x32_f16 v[20:23], v[48:51], v[108:111], v[20:23]
    ds_read_b128 v[108:111], v8 offset:2048
    s_waitcnt lgkmcnt(7)
    v_mfma_f32_16x16x32_f16 v[20:23], v[52:55], v[32:35], v[20:23]
    s_waitcnt lgkmcnt(6)
    v_mfma_f32_16x16x32_f16 v[20:23], v[56:59], v[112:115], v[20:23]
    ds_read_b128 v[32:35], v8 offset:2112
    s_waitcnt lgkmcnt(6)
    v_mfma_f32_16x16x32_f16 v[20:23], v[60:63], v[116:119], v[20:23]
    s_waitcnt lgkmcnt(4)
    v_fma_mix_f32 v116, v28, v17, 0 op_sel_hi:[1,0,0]
    v_fma_mix_f32 v117, v28, v17, 0 op_sel:[1,0,0] op_sel_hi:[1,0,0]
    s_waitcnt lgkmcnt(3)
    v_mfma_f32_16x16x32_f16 v[20:23], v[64:67], v[120:123], v[20:23]
    ds_read_b128 v[112:115], v8 offset:2176
    v_fma_mix_f32 v118, v29, v17, 0 op_sel_hi:[1,0,0]
    v_fma_mix_f32 v119, v29, v17, 0 op_sel:[1,0,0] op_sel_hi:[1,0,0]
    s_waitcnt lgkmcnt(3)
    v_mfma_f32_16x16x32_f16 v[20:23], v[68:71], v[124:127], v[20:23]
    v_cvt_pk_bf16_f32 v116, 0, v116
    v_cvt_pk_bf16_f32 v117, 0, v117
    v_mfma_f32_16x16x32_f16 v[24:27], v[36:39], v[124:127], v[24:27]
    ds_read_b128 v[120:123], v8 offset:2240
    v_cvt_pk_bf16_f32 v118, 0, v118
    v_cvt_pk_bf16_f32 v119, 0, v119
    s_waitcnt lgkmcnt(3)
    v_mfma_f32_16x16x32_f16 v[20:23], v[72:75], v[108:111], v[20:23]
    v_fma_mix_f32 v124, v30, v17, 0 op_sel_hi:[1,0,0]
    v_fma_mix_f32 v125, v30, v17, 0 op_sel:[1,0,0] op_sel_hi:[1,0,0]
    v_mfma_f32_16x16x32_f16 v[24:27], v[40:43], v[108:111], v[24:27]
    ds_read_b128 v[36:39], v8 offset:2304
    v_fma_mix_f32 v126, v31, v17, 0 op_sel_hi:[1,0,0]
    v_fma_mix_f32 v127, v31, v17, 0 op_sel:[1,0,0] op_sel_hi:[1,0,0]
    s_waitcnt lgkmcnt(3)
    v_mfma_f32_16x16x32_f16 v[20:23], v[76:79], v[32:35], v[20:23]
    v_cvt_pk_bf16_f32 v124, 0, v124
    v_cvt_pk_bf16_f32 v125, 0, v125
    v_mfma_f32_16x16x32_f16 v[24:27], v[44:47], v[32:35], v[24:27]
    ds_read_b128 v[40:43], v8 offset:2368
    v_cvt_pk_bf16_f32 v126, 0, v126
    v_cvt_pk_bf16_f32 v127, 0, v127
    s_waitcnt lgkmcnt(3)
    v_mfma_f32_16x16x32_f16 v[20:23], v[80:83], v[112:115], v[20:23]
    v_mfma_f32_16x16x32_f16 v[24:27], v[48:51], v[112:115], v[24:27]
    ds_read_b128 v[108:111], v8 offset:2432
    s_waitcnt lgkmcnt(3)
    v_mfma_f32_16x16x32_f16 v[20:23], v[84:87], v[120:123], v[20:23]
    v_mfma_f32_16x16x32_f16 v[24:27], v[52:55], v[120:123], v[24:27]
    ds_read_b128 v[44:47], v8 offset:2496
    s_waitcnt lgkmcnt(3)
    v_mfma_f32_16x16x32_f16 v[20:23], v[88:91], v[36:39], v[20:23]
    v_mfma_f32_16x16x32_f16 v[24:27], v[56:59], v[36:39], v[24:27]
    ds_read_b128 v[32:35], v8 offset:2560
    s_waitcnt lgkmcnt(3)
    v_mfma_f32_16x16x32_f16 v[20:23], v[92:95], v[40:43], v[20:23]
    ds_read_b128 v[48:51], v8 offset:2624
    v_mfma_f32_16x16x32_f16 v[24:27], v[60:63], v[40:43], v[24:27]
    ds_read_b128 v[112:115], v8 offset:2688
    s_waitcnt lgkmcnt(4)
    v_mfma_f32_16x16x32_f16 v[20:23], v[96:99], v[108:111], v[20:23]
    ds_read_b128 v[52:55], v8 offset:2752
    v_mfma_f32_16x16x32_f16 v[24:27], v[64:67], v[108:111], v[24:27]
    ds_read_b128 v[120:123], v8 offset:2816
    s_waitcnt lgkmcnt(5)
    v_mfma_f32_16x16x32_f16 v[20:23], v[100:103], v[44:47], v[20:23]
    ds_read_b128 v[56:59], v8 offset:2880
    v_mfma_f32_16x16x32_f16 v[24:27], v[68:71], v[44:47], v[24:27]
    ds_read_b32 v18, v14 offset:76
    ds_read_b128 v[36:39], v8 offset:2944
    s_waitcnt lgkmcnt(7)
    v_mfma_f32_16x16x32_f16 v[24:27], v[72:75], v[32:35], v[24:27]
    ds_read_b128 v[60:63], v8 offset:3008
    s_waitcnt lgkmcnt(7)
    v_mfma_f32_16x16x32_f16 v[24:27], v[76:79], v[48:51], v[24:27]
    ds_read2_b32 v[40:41], v11 offset0:16 offset1:17
    ds_read2_b32 v[42:43], v11 offset0:18 offset1:19
    ds_read2_b32 v[64:65], v11 offset0:32 offset1:33
    ds_read2_b32 v[66:67], v11 offset0:34 offset1:35
    s_waitcnt lgkmcnt(10)
    v_mfma_f32_16x16x32_f16 v[24:27], v[80:83], v[112:115], v[24:27]
    s_waitcnt lgkmcnt(6)
    v_cmp_ne_u32 vcc, s84, v18
    s_cbranch_vccnz WS_38
WB_39:
    ds_read_b64_tr_b16 v[108:109], v9 offset:0
    ds_read_b64_tr_b16 v[110:111], v9 offset:64
    ds_read_b64_tr_b16 v[68:69], v9 offset:512
    ds_read_b64_tr_b16 v[70:71], v9 offset:576
    v_mfma_f32_16x16x32_f16 v[24:27], v[84:87], v[52:55], v[24:27]
    ds_read_b64_tr_b16 v[44:45], v9 offset:1024
    ds_read_b64_tr_b16 v[46:47], v9 offset:1088
    v_mfma_f32_16x16x32_f16 v[24:27], v[88:91], v[120:123], v[24:27]
    ds_read_b64_tr_b16 v[72:73], v9 offset:3088
    ds_read_b64_tr_b16 v[74:75], v9 offset:3152
    ds_read2_b32 v[32:33], v11 offset0:64 offset1:65
    ds_read2_b32 v[34:35], v11 offset0:66 offset1:67
    v_mfma_f32_16x16x32_f16 v[24:27], v[92:95], v[56:59], v[24:27]
    ds_read_b64_tr_b16 v[76:77], v9 offset:3600
    ds_read_b64_tr_b16 v[78:79], v9 offset:3664
    ds_read2_b32 v[48:49], v11 offset0:80 offset1:81
    ds_read2_b32 v[50:51], v11 offset0:82 offset1:83
    v_mfma_f32_16x16x32_f16 v[24:27], v[96:99], v[36:39], v[24:27]
    ds_read_b64_tr_b16 v[80:81], v9 offset:4112
    ds_read_b64_tr_b16 v[82:83], v9 offset:4176
    ds_read2_b32 v[112:113], v11 offset0:96 offset1:97
    ds_read2_b32 v[114:115], v11 offset0:98 offset1:99
    v_mfma_f32_16x16x32_f16 v[24:27], v[100:103], v[60:63], v[24:27]
    ds_read_b64_tr_b16 v[84:85], v10 offset:6176
    ds_read_b64_tr_b16 v[86:87], v10 offset:6304
    ds_read2_b32 v[52:53], v13 offset0:24 offset1:25
    ds_read2_b32 v[54:55], v13 offset0:26 offset1:27
    v_mfma_f32_16x16x32_f16 v[20:23], v[108:111], v[104:107], v[20:23]
    ds_read_b64_tr_b16 v[88:89], v10 offset:8224
    ds_read_b64_tr_b16 v[90:91], v10 offset:8352
    ds_read2_b32 v[120:121], v13 offset0:120 offset1:121
    ds_read2_b32 v[122:123], v13 offset0:122 offset1:123
    v_mfma_f32_16x16x32_f16 v[20:23], v[68:71], v[40:43], v[20:23]
    v_mfma_f32_16x16x32_f16 v[20:23], v[44:47], v[64:67], v[20:23]
    v_mfma_f32_16x16x32_f16 v[20:23], v[72:75], v[32:35], v[20:23]
    ds_read_b64_tr_b16 v[92:93], v9 offset:1536
    ds_read_b64_tr_b16 v[94:95], v9 offset:1600
    s_waitcnt lgkmcnt(14)
    v_mfma_f32_16x16x32_f16 v[20:23], v[76:79], v[48:51], v[20:23]
    s_waitcnt lgkmcnt(10)
    v_mfma_f32_16x16x32_f16 v[20:23], v[80:83], v[112:115], v[20:23]
    s_waitcnt lgkmcnt(6)
    v_mfma_f32_16x16x32_f16 v[20:23], v[84:87], v[52:55], v[20:23]
    ds_read_b64_tr_b16 v[56:57], v9 offset:4624
    ds_read_b64_tr_b16 v[58:59], v9 offset:4688
    ds_read2_b32 v[96:97], v13 offset0:16 offset1:17
    ds_read2_b32 v[98:99], v13 offset0:18 offset1:19
    s_waitcnt lgkmcnt(6)
    v_mfma_f32_16x16x32_f16 v[20:23], v[88:91], v[120:123], v[20:23]
    ds_read2_b32 v[36:37], v13 offset0:112 offset1:113
    ds_read2_b32 v[38:39], v13 offset0:114 offset1:115
    v_mfma_f32_16x16x32_f16 v[24:27], v[68:71], v[104:107], v[24:27]
    v_mfma_f32_16x16x32_f16 v[24:27], v[44:47], v[40:43], v[24:27]
    s_nop 3
    v_mul_f32 v20, v20, v16
    v_mul_f32 v21, v21, v16
    s_waitcnt lgkmcnt(6)
    v_mfma_f32_16x16x32_f16 v[24:27], v[92:95], v[64:67], v[24:27]
    v_mul_f32 v22, v22, v16
    v_mul_f32 v23, v23, v16
    v_mfma_f32_16x16x32_f16 v[24:27], v[76:79], v[32:35], v[24:27]
    v_cvt_pk_bf16_f32 v20, 0, v20
    v_cvt_pk_bf16_f32 v21, 0, v21
    v_mfma_f32_16x16x32_f16 v[24:27], v[80:83], v[48:51], v[24:27]
    v_cvt_pk_bf16_f32 v22, 0, v22
    v_cvt_pk_bf16_f32 v23, 0, v23
    s_waitcnt lgkmcnt(4)
    v_mfma_f32_16x16x32_f16 v[24:27], v[56:59], v[112:115], v[24:27]
    v_add_f32 v20, v20, v116
    v_add_f32 v21, v21, v117
    s_waitcnt lgkmcnt(2)
    v_mfma_f32_16x16x32_f16 v[24:27], v[84:87], v[96:99], v[24:27]
    v_add_f32 v22, v22, v118
    v_add_f32 v23, v23, v119
    s_waitcnt lgkmcnt(0)
    v_mfma_f32_16x16x32_f16 v[24:27], v[88:91], v[36:39], v[24:27]
    v_cvt_pk_bf16_f32 v28, v20, v21
    v_cvt_pk_bf16_f32 v29, v22, v23
    v_min_u32 v28, -2, v28
    v_min_u32 v29, -2, v29
    ds_read_u8 v18, v4 offset:162
    ds_read_b128 v[20:23], v12 offset:48640
    s_nop 1
    v_mul_f32 v24, v24, v16
    v_mul_f32 v25, v25, v16
    v_mul_f32 v26, v26, v16
    v_mul_f32 v27, v27, v16
    v_cvt_pk_bf16_f32 v24, 0, v24
    v_cvt_pk_bf16_f32 v25, 0, v25
    v_cvt_pk_bf16_f32 v26, 0, v26
    v_cvt_pk_bf16_f32 v27, 0, v27
    v_add_f32 v24, v24, v124
    v_add_f32 v25, v25, v125
    v_add_f32 v26, v26, v126
    v_add_f32 v27, v27, v127
    v_cvt_pk_bf16_f32 v30, v24, v25
    v_cvt_pk_bf16_f32 v31, v26, v27
    v_min_u32 v30, -2, v30
    v_min_u32 v31, -2, v31
    s_branch CVE_32
CV_31:
    ds_read2_b32 v[32:33], v7 offset0:128 offset1:129
    ds_read2_b32 v[34:35], v7 offset0:130 offset1:131
    ds_read2_b32 v[36:37], v6 offset0:0 offset1:1
    ds_read2_b32 v[38:39], v6 offset0:2 offset1:3
    ds_read2_b32 v[40:41], v6 offset0:16 offset1:17
    ds_read2_b32 v[42:43], v6 offset0:18 offset1:19
    ds_read2_b32 v[44:45], v6 offset0:32 offset1:33
    ds_read2_b32 v[46:47], v6 offset0:34 offset1:35
    ds_read2_b32 v[48:49], v6 offset0:48 offset1:49
    ds_read2_b32 v[50:51], v6 offset0:50 offset1:51
    ds_read2_b32 v[52:53], v6 offset0:64 offset1:65
    ds_read2_b32 v[54:55], v6 offset0:66 offset1:67
    ds_read2_b32 v[56:57], v6 offset0:80 offset1:81
    ds_read2_b32 v[58:59], v6 offset0:82 offset1:83
    ds_read2_b32 v[60:61], v6 offset0:96 offset1:97
    ds_read2_b32 v[62:63], v6 offset0:98 offset1:99
    ds_read2_b32 v[64:65], v6 offset0:112 offset1:113
    ds_read2_b32 v[66:67], v6 offset0:114 offset1:115
    ds_read2_b32 v[68:69], v6 offset0:128 offset1:129
    ds_read2_b32 v[70:71], v6 offset0:130 offset1:131
    ds_read2_b32 v[72:73], v6 offset0:144 offset1:145
    ds_read2_b32 v[74:75], v6 offset0:146 offset1:147
    ds_read2_b32 v[76:77], v6 offset0:160 offset1:161
    ds_read2_b32 v[78:79], v6 offset0:162 offset1:163
    ds_read2_b32 v[80:81], v6 offset0:176 offset1:177
    ds_read2_b32 v[82:83], v6 offset0:178 offset1:179
    ds_read2_b32 v[84:85], v6 offset0:192 offset1:193
    ds_read2_b32 v[86:87], v6 offset0:194 offset1:195
    ds_read2_b32 v[88:89], v6 offset0:208 offset1:209
    ds_read2_b32 v[90:91], v6 offset0:210 offset1:211
    ds_read2_b32 v[92:93], v6 offset0:224 offset1:225
    ds_read2_b32 v[94:95], v6 offset0:226 offset1:227
    ds_read2_b32 v[96:97], v6 offset0:240 offset1:241
    ds_read2_b32 v[98:99], v6 offset0:242 offset1:243
    ds_read2_b32 v[100:101], v7 offset0:96 offset1:97
    ds_read2_b32 v[102:103], v7 offset0:98 offset1:99
    ds_read2_b32 v[104:105], v11 offset0:0 offset1:1
    ds_read2_b32 v[106:107], v11 offset0:2 offset1:3
    v_lshlrev_b32 v18, 3, v3
    v_sub_u32 v18, v8, v18
    v_lshrrev_b32 v19, 2, v2
    v_lshl_add_u32 v19, v19, 2, v3
    v_and_b32 v28, 3, v2
    v_lshlrev_b32 v28, 4, v28
    v_mul_u32_u24 v19, s8, v19
    v_xor_b32 v19, s10, v19
    s_waitcnt lgkmcnt(0)
    v_mov_b32 v7, v18
    v_add_u32 v6, v19, v28
    v_xor_b32 v12, s9, v12
W_40:
    ds_read_b32 v18, v4 offset:16
    s_sub_u32 s39, s39, 1
    s_cbranch_scc1 KS_ABORT
    s_waitcnt lgkmcnt(0)
    v_cmp_ne_u32 vcc, s84, v18
    s_cbranch_vccnz W_40
    s_setprio 1
    ds_read_b128 v[108:111], v8 offset:1472
    ds_read_b128 v[112:115], v8 offset:1984
    ds_read_b128 v[116:119], v8 offset:2496
    ds_read_b128 v[120:123], v8 offset:2560
    ds_read_b128 v[124:127], v8 offset:2624
    s_waitcnt lgkmcnt(4)
    v_mfma_f32_16x16x32_f16 v[20:23], v[32:35], v[108:111], 0
    ds_read_b128 v[108:111], v8 offset:2688
    s_waitcnt lgkmcnt(4)
    v_mfma_f32_16x16x32_f16 v[24:27], v[32:35], v[112:115], 0
    ds_read_b128 v[32:35], v8 offset:2752
    ds_read_b128 v[112:115], v8 offset:2816
    s_waitcnt lgkmcnt(5)
    v_mfma_f32_16x16x32_f16 v[20:23], v[36:39], v[116:119], v[20:23]
    ds_read_b128 v[116:119], v8 offset:2880
    ds_read_b64 v[28:29], v7 offset:3552
    ds_read_b64 v[30:31], v7 offset:4064
    s_waitcnt lgkmcnt(7)
    v_mfma_f32_16x16x32_f16 v[20:23], v[40:43], v[120:123], v[20:23]
    ds_read_b128 v[120:123], v8 offset:2944
    s_waitcnt lgkmcnt(7)
    v_mfma_f32_16x16x32_f16 v[20:23], v[44:47], v[124:127], v[20:23]
    ds_read_b128 v[124:127], v8 offset:3008
    s_waitcnt lgkmcnt(7)
    v_mfma_f32_16x16x32_f16 v[20:23], v[48:51], v[108:111], v[20:23]
    ds_read_b128 v[108:111], v8 offset:3072
    s_waitcnt lgkmcnt(7)
    v_mfma_f32_16x16x32_f16 v[20:23], v[52:55], v[32:35], v[20:23]
    s_waitcnt lgkmcnt(6)
    v_mfma_f32_16x16x32_f16 v[20:23], v[56:59], v[112:115], v[20:23]
    ds_read_b128 v[32:35], v8 offset:3136
    s_waitcnt lgkmcnt(6)
    v_mfma_f32_16x16x32_f16 v[20:23], v[60:63], v[116:119], v[20:23]
    s_waitcnt lgkmcnt(4)
    v_fma_mix_f32 v116, v28, v17, 0 op_sel_hi:[1,0,0]
    v_fma_mix_f32 v117, v28, v17, 0 op_sel:[1,0,0] op_sel_hi:[1,0,0]
    s_waitcnt lgkmcnt(3)
    v_mfma_f32_16x16x32_f16 v[20:23], v[64:67], v[120:123], v[20:23]
    ds_read_b128 v[112:115], v8 offset:3200
    v_fma_mix_f32 v118, v29, v17, 0 op_sel_hi:[1,0,0]
    v_fma_mix_f32 v119, v29, v17, 0 op_sel:[1,0,0] op_sel_hi:[1,0,0]
    s_waitcnt lgkmcnt(3)
    v_mfma_f32_16x16x32_f16 v[20:23], v[68:71], v[124:127], v[20:23]
    v_cvt_pk_bf16_f32 v116, 0, v116
    v_cvt_pk_bf16_f32 v117, 0, v117
    v_mfma_f32_16x16x32_f16 v[24:27], v[36:39], v[124:127], v[24:27]
    ds_read_b128 v[120:123], v8 offset:3264
    v_cvt_pk_bf16_f32 v118, 0, v118
    v_cvt_pk_bf16_f32 v119, 0, v119
    s_waitcnt lgkmcnt(3)
    v_mfma_f32_16x16x32_f16 v[20:23], v[72:75], v[108:111], v[20:23]
    v_fma_mix_f32 v124, v30, v17, 0 op_sel_hi:[1,0,0]
    v_fma_mix_f32 v125, v30, v17, 0 op_sel:[1,0,0] op_sel_hi:[1,0,0]
    v_mfma_f32_16x16x32_f16 v[24:27], v[40:43], v[108:111], v[24:27]
    ds_read_b128 v[36:39], v8 offset:3328
    v_fma_mix_f32 v126, v31, v17, 0 op_sel_hi:[1,0,0]
    v_fma_mix_f32 v127, v31, v17, 0 op_sel:[1,0,0] op_sel_hi:[1,0,0]
    s_waitcnt lgkmcnt(3)
    v_mfma_f32_16x16x32_f16 v[20:23], v[76:79], v[32:35], v[20:23]
    v_cvt_pk_bf16_f32 v124, 0, v124
    v_cvt_pk_bf16_f32 v125, 0, v125
    v_mfma_f32_16x16x32_f16 v[24:27], v[44:47], v[32:35], v[24:27]
    ds_read_b128 v[40:43], v8 offset:3392
    v_cvt_pk_bf16_f32 v126, 0, v126
    v_cvt_pk_bf16_f32 v127, 0, v127
    s_waitcnt lgkmcnt(3)
    v_mfma_f32_16x16x32_f16 v[20:23], v[80:83], v[112:115], v[20:23]
    v_mfma_f32_16x16x32_f16 v[24:27], v[48:51], v[112:115], v[24:27]
    ds_read_b128 v[108:111], v8 offset:3456
    s_waitcnt lgkmcnt(3)
    v_mfma_f32_16x16x32_f16 v[20:23], v[84:87], v[120:123], v[20:23]
    v_mfma_f32_16x16x32_f16 v[24:27], v[52:55], v[120:123], v[24:27]
    ds_read_b128 v[44:47], v8 offset:3520
    s_waitcnt lgkmcnt(3)
    v_mfma_f32_16x16x32_f16 v[20:23], v[88:91], v[36:39], v[20:23]
    v_mfma_f32_16x16x32_f16 v[24:27], v[56:59], v[36:39], v[24:27]
    ds_read_b128 v[32:35], v8 offset:3584
    s_waitcnt lgkmcnt(3)
    v_mfma_f32_16x16x32_f16 v[20:23], v[92:95], v[40:43], v[20:23]
    ds_read_b128 v[48:51], v8 offset:3648
    v_mfma_f32_16x16x32_f16 v[24:27], v[60:63], v[40:43], v[24:27]
    ds_read_b128 v[112:115], v8 offset:3712
    s_waitcnt lgkmcnt(4)
    v_mfma_f32_16x16x32_f16 v[20:23], v[96:99], v[108:111], v[20:23]
    ds_read_b128 v[52:55], v8 offset:3776
    v_mfma_f32_16x16x32_f16 v[24:27], v[64:67], v[108:111], v[24:27]
    ds_read_b128 v[120:123], v8 offset:3840
    s_waitcnt lgkmcnt(5)
    v_mfma_f32_16x16x32_f16 v[20:23], v[100:103], v[44:47], v[20:23]
    ds_read_b128 v[56:59], v8 offset:3904
    v_mfma_f32_16x16x32_f16 v[24:27], v[68:71], v[44:47], v[24:27]
    ds_read_b32 v18, v14 offset:76
    ds_read_b128 v[36:39], v8 offset:3968
    s_waitcnt lgkmcnt(7)
    v_mfma_f32_16x16x32_f16 v[24:27], v[72:75], v[32:35], v[24:27]
    ds_read_b128 v[60:63], v8 offset:4032
    s_waitcnt lgkmcnt(7)
    v_mfma_f32_16x16x32_f16 v[24:27], v[76:79], v[48:51], v[24:27]
    ds_read2_b32 v[40:41], v11 offset0:16 offset1:17
    ds_read2_b32 v[42:43], v11 offset0:18 offset1:19
    ds_read2_b32 v[64:65], v11 offset0:32 offset1:33
    ds_read2_b32 v[66:67], v11 offset0:34 offset1:35
    s_waitcnt lgkmcnt(10)
    v_mfma_f32_16x16x32_f16 v[24:27], v[80:83], v[112:115], v[24:27]
    s_waitcnt lgkmcnt(6)
    v_cmp_ne_u32 vcc, s84, v18
    s_cbranch_vccnz WS_41
WB_42:
    ds_read_b64_tr_b16 v[108:109], v9 offset:1024
    ds_read_b64_tr_b16 v[110:111], v9 offset:1088
    ds_read_b64_tr_b16 v[68:69], v9 offset:1536
    ds_read_b64_tr_b16 v[70:71], v9 offset:1600
    v_mfma_f32_16x16x32_f16 v[24:27], v[84:87], v[52:55], v[24:27]
    ds_read_b64_tr_b16 v[44:45], v9 offset:2048
    ds_read_b64_tr_b16 v[46:47], v9 offset:2112
    v_mfma_f32_16x16x32_f16 v[24:27], v[88:91], v[120:123], v[24:27]
    ds_read_b64_tr_b16 v[72:73], v9 offset:4112
    ds_read_b64_tr_b16 v[74:75], v9 offset:4176
    ds_read2_b32 v[32:33], v11 offset0:64 offset1:65
    ds_read2_b32 v[34:35], v11 offset0:66 offset1:67
    v_mfma_f32_16x16x32_f16 v[24:27], v[92:95], v[56:59], v[24:27]
    ds_read_b64_tr_b16 v[76:77], v9 offset:4624
    ds_read_b64_tr_b16 v[78:79], v9 offset:4688
    ds_read2_b32 v[48:49], v11 offset0:80 offset1:81
    ds_read2_b32 v[50:51], v11 offset0:82 offset1:83
    v_mfma_f32_16x16x32_f16 v[24:27], v[96:99], v[36:39], v[24:27]
    ds_read_b64_tr_b16 v[80:81], v9 offset:5136
    ds_read_b64_tr_b16 v[82:83], v9 offset:5200
    ds_read2_b32 v[112:113], v11 offset0:96 offset1:97
    ds_read2_b32 v[114:115], v11 offset0:98 offset1:99
    v_mfma_f32_16x16x32_f16 v[24:27], v[100:103], v[60:63], v[24:27]
    ds_read_b64_tr_b16 v[84:85], v10 offset:6176
    ds_read_b64_tr_b16 v[86:87], v10 offset:6304
    ds_read2_b32 v[52:53], v13 offset0:8 offset1:9
    ds_read2_b32 v[54:55], v13 offset0:10 offset1:11
    v_mfma_f32_16x16x32_f16 v[20:23], v[108:111], v[104:107], v[20:23]
    ds_read_b64_tr_b16 v[88:89], v10 offset:7200
    ds_read_b64_tr_b16 v[90:91], v10 offset:7328
    ds_read2_b32 v[120:121], v13 offset0:24 offset1:25
    ds_read2_b32 v[122:123], v13 offset0:26 offset1:27
    v_mfma_f32_16x16x32_f16 v[20:23], v[68:71], v[40:43], v[20:23]
    ds_read_b64_tr_b16 v[92:93], v10 offset:8224
    ds_read_b64_tr_b16 v[94:95], v10 offset:8352
    ds_read2_b32 v[56:57], v13 offset0:104 offset1:105
    ds_read2_b32 v[58:59], v13 offset0:106 offset1:107
    v_mfma_f32_16x16x32_f16 v[20:23], v[44:47], v[64:67], v[20:23]
    ds_read_b64_tr_b16 v[96:97], v10 offset:9248
    ds_read_b64_tr_b16 v[98:99], v10 offset:9376
    ds_read2_b32 v[36:37], v13 offset0:120 offset1:121
    ds_read2_b32 v[38:39], v13 offset0:122 offset1:123
    v_mfma_f32_16x16x32_f16 v[20:23], v[72:75], v[32:35], v[20:23]
    v_mfma_f32_16x16x32_f16 v[20:23], v[76:79], v[48:51], v[20:23]
    v_mfma_f32_16x16x32_f16 v[20:23], v[80:83], v[112:115], v[20:23]
    ds_read_b64_tr_b16 v[100:101], v9 offset:2560
    ds_read_b64_tr_b16 v[102:103], v9 offset:2624
    s_waitcnt lgkmcnt(14)
    v_mfma_f32_16x16x32_f16 v[20:23], v[84:87], v[52:55], v[20:23]
    s_waitcnt lgkmcnt(10)
    v_mfma_f32_16x16x32_f16 v[20:23], v[88:91], v[120:123], v[20:23]
    s_waitcnt lgkmcnt(6)
    v_mfma_f32_16x16x32_f16 v[20:23], v[92:95], v[56:59], v[20:23]
    ds_read_b64_tr_b16 v[60:61], v9 offset:5648
    ds_read_b64_tr_b16 v[62:63], v9 offset:5712
    ds_read2_b32 v[108:109], v13 offset0:0 offset1:1
    ds_read2_b32 v[110:111], v13 offset0:2 offset1:3
    s_waitcnt lgkmcnt(6)
    v_mfma_f32_16x16x32_f16 v[20:23], v[96:99], v[36:39], v[20:23]
    ds_read2_b32 v[72:73], v13 offset0:16 offset1:17
    ds_read2_b32 v[74:75], v13 offset0:18 offset1:19
    ds_read2_b32 v[52:53], v13 offset0:96 offset1:97
    ds_read2_b32 v[54:55], v13 offset0:98 offset1:99
    v_mfma_f32_16x16x32_f16 v[24:27], v[68:71], v[104:107], v[24:27]
    ds_read2_b32 v[120:121], v13 offset0:112 offset1:113
    ds_read2_b32 v[122:123], v13 offset0:114 offset1:115
    v_mfma_f32_16x16x32_f16 v[24:27], v[44:47], v[40:43], v[24:27]
    v_mul_f32 v20, v20, v16
    v_mul_f32 v21, v21, v16
    s_waitcnt lgkmcnt(10)
    v_mfma_f32_16x16x32_f16 v[24:27], v[100:103], v[64:67], v[24:27]
    v_mul_f32 v22, v22, v16
    v_mul_f32 v23, v23, v16
    v_mfma_f32_16x16x32_f16 v[24:27], v[76:79], v[32:35], v[24:27]
    v_cvt_pk_bf16_f32 v20, 0, v20
    v_cvt_pk_bf16_f32 v21, 0, v21
    v_mfma_f32_16x16x32_f16 v[24:27], v[80:83], v[48:51], v[24:27]
    v_cvt_pk_bf16_f32 v22, 0, v22
    v_cvt_pk_bf16_f32 v23, 0, v23
    s_waitcnt lgkmcnt(8)
    v_mfma_f32_16x16x32_f16 v[24:27], v[60:63], v[112:115], v[24:27]
    v_add_f32 v20, v20, v116
    v_add_f32 v21, v21, v117
    s_waitcnt lgkmcnt(6)
    v_mfma_f32_16x16x32_f16 v[24:27], v[84:87], v[108:111], v[24:27]
    v_add_f32 v22, v22, v118
    v_add_f32 v23, v23, v119
    s_waitcnt lgkmcnt(4)
    v_mfma_f32_16x16x32_f16 v[24:27], v[88:91], v[72:75], v[24:27]
    v_cvt_pk_bf16_f32 v28, v20, v21
    v_cvt_pk_bf16_f32 v29, v22, v23
    s_waitcnt lgkmcnt(2)
    v_mfma_f32_16x16x32_f16 v[24:27], v[92:95], v[52:55], v[24:27]
    v_min_u32 v28, -2, v28
    v_min_u32 v29, -2, v29
    s_waitcnt lgkmcnt(0)
    v_mfma_f32_16x16x32_f16 v[24:27], v[96:99], v[120:123], v[24:27]
    ds_read_u8 v18, v4 offset:163
    ds_read_b128 v[20:23], v12 offset:49664
    s_nop 5
    v_mul_f32 v24, v24, v16
    v_mul_f32 v25, v25, v16
    v_mul_f32 v26, v26, v16
    v_mul_f32 v27, v27, v16
    v_cvt_pk_bf16_f32 v24, 0, v24
    v_cvt_pk_bf16_f32 v25, 0, v25
    v_cvt_pk_bf16_f32 v26, 0, v26
    v_cvt_pk_bf16_f32 v27, 0, v27
    v_add_f32 v24, v24, v124
    v_add_f32 v25, v25, v125
    v_add_f32 v26, v26, v126
    v_add_f32 v27, v27, v127
    v_cvt_pk_bf16_f32 v30, v24, v25
    v_cvt_pk_bf16_f32 v31, v26, v27
    v_min_u32 v30, -2, v30
    v_min_u32 v31, -2, v31
CVE_32:
    s_waitcnt lgkmcnt(0)
    s_cmp_lg_u32 s87, 1
    s_cbranch_scc1 ZA_43
    v_cmp_ne_u32 vcc, 1, v18
    s_cbranch_vccnz ZS_45
ZB_46:
    s_mov_b64 exec, s[12:13]
    v_swap_b32 v28, v20
    v_swap_b32 v29, v21
    v_swap_b32 v30, v22
    v_swap_b32 v31, v23
    s_mov_b64 exec, -1
    buffer_store_dwordx4 v[28:31], v6, s[64:67], s7 offen sc1
    buffer_store_dwordx4 v[20:23], v6, s[64:67], s6 offen sc1
    s_branch ZD_48
WS_35:
W_49:
    ds_read_b32 v18, v14 offset:76
    s_sub_u32 s39, s39, 1
    s_cbranch_scc1 KS_ABORT
    s_waitcnt lgkmcnt(0)
    v_cmp_ne_u32 vcc, s84, v18
    s_cbranch_vccnz W_49
    s_branch WB_36
WS_38:
W_50:
    ds_read_b32 v18, v14 offset:76
    s_sub_u32 s39, s39, 1
    s_cbranch_scc1 KS_ABORT
    s_waitcnt lgkmcnt(0)
    v_cmp_ne_u32 vcc, s84, v18
    s_cbranch_vccnz W_50
    s_branch WB_39
WS_41:
W_51:
    ds_read_b32 v18, v14 offset:76
    s_sub_u32 s39, s39, 1
    s_cbranch_scc1 KS_ABORT
    s_waitcnt lgkmcnt(0)
    v_cmp_ne_u32 vcc, s84, v18
    s_cbranch_vccnz W_51
    s_branch WB_42
ZS_45:
    v_mov_b32 v19, s86
ZW_52:
    ds_read_u8 v18, v19 offset:160
    s_sub_u32 s39, s39, 1
    s_cbranch_scc1 KS_ABORT
    s_waitcnt lgkmcnt(0)
    v_cmp_ne_u32 vcc, 1, v18
    s_cbranch_vccnz ZW_52
    v_lshl_add_u32 v19, v19, 10, v12
    ds_read_b128 v[20:23], v19 offset:46592
    s_waitcnt lgkmcnt(0)
    s_branch ZB_46
ZA_43:
    s_cmp_lg_u32 s87, 0
    s_cbranch_scc1 ZC_44
    v_mov_b32 v19, s86
    v_lshl_add_u32 v18, v19, 10, v12
    ds_write_b128 v18, v[28:31] offset:46592
    ds_write_b8 v19, v5 offset:160
    s_branch ZD_48
ZC_44:
    buffer_store_dwordx4 v[28:31], v6, s[64:67], s6 offen sc1
ZD_48:
    s_lshl_b32 s92, s87, 2
    s_add_u32 s92, s92, s86
    v_mov_b32 v8, s92
    s_waitcnt vmcnt(0)
    ds_write_b8 v8, v5 offset:48
    s_cmp_lg_u32 s38, 4
    s_cbranch_scc1 KS_K1
    s_setprio 0
    s_add_u32 s76, s36, 0x840000
    s_addc_u32 s77, s37, 0
    s_mov_b32 s78, 0x3000
    s_mov_b32 s79, 0x20000
    v_and_b32 v6, 1, v1
    v_lshlrev_b32 v6, 4, v6
    s_lshl_b32 s92, s90, 5
W_53:
    s_sleep 1
    ds_read_b32 v8, v4 offset:20
    s_sub_u32 s39, s39, 1
    s_cbranch_scc1 KS_ABORT
    s_waitcnt lgkmcnt(0)
    v_cmp_ne_u32 vcc, s84, v8
    s_cbranch_vccnz W_53
    s_mov_b64 exec, 3
    s_setprio 1
KS_K0:
    ds_read_b128 v[8:11], v6 offset:800
    s_sub_u32 s39, s39, 1
    s_cbranch_scc1 KS_ABORT
    s_waitcnt lgkmcnt(0)
    v_min3_u32 v12, v8, v9, v10
    v_min_u32 v12, v12, v11
    v_cmp_eq_u32 vcc, 0, v12
    s_cbranch_vccnz KS_K0
    buffer_store_dwordx4 v[8:11], v6, s[76:79], s92 offen sc1
    s_mov_b64 exec, -1
    s_waitcnt vmcnt(0)
    ds_write_b32 v4, v5 offset:24
KS_K1:
    s_cmp_lt_u32 s41, 18
    s_cbranch_scc1 KS_T
    s_waitcnt lgkmcnt(0)
    s_endpgm
KS_X:
    s_cmp_lt_u32 s41, 24
    s_cbranch_scc1 KS_X2
    s_setprio 2
KS_XC:
    s_mov_b32 s87, 2
    s_add_u32 s86, s38, 3
    s_and_b32 s86, s86, 3
    s_lshl_b32 s88, s40, 3
    s_and_b32 s92, s41, 7
    s_add_u32 s88, s88, s92
    s_add_u32 s88, s88, 512
    s_lshl_b32 s92, s86, 11
    s_add_u32 s92, s92, 146048
    v_lshl_add_u32 v28, v1, 3, s92
    s_branch KS_GRP
KS_X2:
    s_cmp_lt_u32 s41, 8
    s_cbranch_scc1 KS_X3
    s_sub_u32 s97, s38, 8
    s_branch KS_LN1
KS_X3:
    s_lshl_b32 s92, s2, 4
    s_add_u32 s92, s92, s38
    s_cmp_lg_u32 s92, 44
    s_cbranch_scc1 KS_X3B
    s_setprio 3
    s_memrealtime s[92:93]
    v_and_b32 v6, 3, v1
    v_lshlrev_b32 v7, 2, v6
    v_min_u32 v6, 2, v6
    v_lshlrev_b32 v6, 2, v6
    v_cmp_eq_u32 vcc, 3, v1
    s_waitcnt lgkmcnt(0)
    v_mov_b32 v8, s92
    v_mov_b32 v9, s93
    v_alignbit_b32 v8, v8, v8, v6
    v_cndmask_b32 v9, v4, v9, vcc
    v_xor_b32 v8, v8, v9
    v_and_b32 v9, 0xf0000fff, v8
    v_and_b32 v10, 0xfff000, v8
    v_lshl_or_b32 v9, v10, 4, v9
    v_lshrrev_b32 v10, 12, v8
    v_and_b32 v10, 0xf000, v10
    v_or3_b32 v9, v9, v10, v9
    v_or_b32 v9, 0x80000000, v9
    s_mov_b64 exec, 15
    global_store_dword v7, v9, s[34:35] sc1
    s_mov_b64 exec, -1
    s_setprio 0
KS_X3B:
    s_setprio 3
    s_branch KS_XC
    s_waitcnt lgkmcnt(0)
    s_barrier
    s_branch KS_G
KS_X4:
    s_cmp_lt_u32 s41, 18
    s_cbranch_scc1 KS_G
    s_waitcnt vmcnt(0) lgkmcnt(0)
    s_endpgm
KS_L:
    v_lshlrev_b32 v6, 2, v0
    ds_write_b32 v6, v4
    v_mov_b32 v8, 0
    v_mov_b32 v9, 0
    s_min_u32 s92, s38, 2
    s_mul_i32 s92, s92, 4672
    v_min_u32 v6, 59, v1
    v_lshl_add_u32 v6, v6, 3, s92
    ds_write_b64 v6, v[8:9] offset:3072
    s_mov_b32 s97, s38
    s_sub_u32 s92, s41, 8
    s_cmp_lt_u32 s92, 16
    s_cbranch_scc0 KS_L0
KS_LN1:
    s_setprio 3
    s_sub_u32 s92, s41, 8
    s_and_b32 s88, s92, 7
    s_lshr_b32 s92, s92, 3
    s_lshl_b32 s92, s92, 4
    s_add_u32 s88, s88, s92
    s_and_b32 s92, s40, 1
    s_lshl_b32 s92, s92, 3
    s_add_u32 s88, s88, s92
    s_lshr_b32 s92, s40, 1
    s_lshl_b32 s92, s92, 5
    s_add_u32 s88, s88, s92
    v_lshrrev_b32 v36, 5, v1
    v_and_b32 v37, 31, v1
    v_mul_u32_u24 v38, 1152, v36
    v_lshl_add_u32 v39, v37, 2, v38
    v_lshl_add_u32 v38, v37, 4, v38
    s_mul_i32 s93, s88, 18432
    s_mul_i32 s94, s97, 2304
    s_add_u32 s93, s93, s94
    s_waitcnt lgkmcnt(0)
    s_mov_b32 s64, s4
    s_mov_b32 s65, s5
    s_mov_b32 s66, 0x240000
    s_mov_b32 s67, 0x20000
    buffer_load_dwordx4 v[26:29], v38, s[64:67], s93 offen
    buffer_load_dwordx4 v[30:33], v38, s[64:67], s93 offen offset:512
    buffer_load_dword v34, v39, s[64:67], s93 offen offset:1024
    s_barrier
    s_lshr_b32 s93, s97, 2
    s_lshl_b32 s93, s93, 6
    s_add_u32 s94, s94, s93
    s_add_u32 s94, s94, 17088
    v_lshl_add_u32 v35, v37, 1, v36
    s_mov_b32 s98, 0x05040100
    s_mov_b32 s99, 0x07060302
    s_cmp_lt_u32 s97, 4
    s_cbranch_scc1 LN1A_54
    s_cmp_ge_u32 s41, 18
    s_cbranch_scc1 LN1A_54
    s_mov_b32 s68, s30
    s_mov_b32 s69, s31
    s_mov_b32 s70, 0x510000
    s_mov_b32 s71, 0x20000
    v_lshlrev_b32 v46, 4, v1
    s_mul_i32 s92, s89, 36864
    s_mul_i32 s93, s97, 9216
    s_add_u32 s92, s92, s93
    s_sub_u32 s92, s92, 36864
    s_add_u32 s93, s93, 72320
    s_add_u32 m0, s93, 0
    s_nop 0
    buffer_load_dwordx4 v46, s[68:71], s92 offen offset:0 nt lds
    buffer_load_dwordx4 v46, s[68:71], s92 offen offset:1024 nt lds
    buffer_load_dwordx4 v46, s[68:71], s92 offen offset:2048 nt lds
    buffer_load_dwordx4 v46, s[68:71], s92 offen offset:3072 nt lds
    s_add_u32 m0, s93, 4096
    s_add_u32 s92, s92, 4096
    buffer_load_dwordx4 v46, s[68:71], s92 offen offset:0 nt lds
    buffer_load_dwordx4 v46, s[68:71], s92 offen offset:1024 nt lds
    buffer_load_dwordx4 v46, s[68:71], s92 offen offset:2048 nt lds
    buffer_load_dwordx4 v46, s[68:71], s92 offen offset:3072 nt lds
    s_add_u32 m0, s93, 8192
    s_add_u32 s92, s92, 4096
    buffer_load_dwordx4 v46, s[68:71], s92 offen offset:0 nt lds
    s_waitcnt vmcnt(11)
    v_lshlrev_b32 v8, 16, v26
    v_and_b32 v9, 0xffff0000, v26
    v_lshlrev_b32 v10, 16, v27
    v_and_b32 v11, 0xffff0000, v27
    v_lshlrev_b32 v12, 16, v28
    v_and_b32 v13, 0xffff0000, v28
    v_lshlrev_b32 v14, 16, v29
    v_and_b32 v15, 0xffff0000, v29
    s_waitcnt vmcnt(10)
    v_lshlrev_b32 v16, 16, v30
    v_and_b32 v17, 0xffff0000, v30
    v_lshlrev_b32 v18, 16, v31
    v_and_b32 v19, 0xffff0000, v31
    v_lshlrev_b32 v20, 16, v32
    v_and_b32 v21, 0xffff0000, v32
    v_lshlrev_b32 v22, 16, v33
    v_and_b32 v23, 0xffff0000, v33
    s_waitcnt vmcnt(9)
    v_lshlrev_b32 v24, 16, v34
    v_and_b32 v25, 0xffff0000, v34
    s_branch LN1B_55
LN1A_54:
    s_waitcnt vmcnt(2)
    v_lshlrev_b32 v8, 16, v26
    v_and_b32 v9, 0xffff0000, v26
    v_lshlrev_b32 v10, 16, v27
    v_and_b32 v11, 0xffff0000, v27
    v_lshlrev_b32 v12, 16, v28
    v_and_b32 v13, 0xffff0000, v28
    v_lshlrev_b32 v14, 16, v29
    v_and_b32 v15, 0xffff0000, v29
    s_waitcnt vmcnt(1)
    v_lshlrev_b32 v16, 16, v30
    v_and_b32 v17, 0xffff0000, v30
    v_lshlrev_b32 v18, 16, v31
    v_and_b32 v19, 0xffff0000, v31
    v_lshlrev_b32 v20, 16, v32
    v_and_b32 v21, 0xffff0000, v32
    v_lshlrev_b32 v22, 16, v33
    v_and_b32 v23, 0xffff0000, v33
    s_waitcnt vmcnt(0)
    v_lshlrev_b32 v24, 16, v34
    v_and_b32 v25, 0xffff0000, v34
    s_nop 1
LN1B_55:
    v_lshl_add_u32 v6, v35, 4, s94
    v_lshl_add_u32 v7, v35, 2, s94
    v_mul_u32_u24 v35, 0x20202, v36
    v_lshl_add_u32 v35, v36, 25, v35
    v_add_u32 v35, 0x05040100, v35
    v_pk_add_f32 v[40:41], v[8:9], v[10:11]
    v_pk_add_f32 v[42:43], v[12:13], v[14:15]
    v_pk_add_f32 v[40:41], v[40:41], v[16:17]
    v_pk_add_f32 v[42:43], v[42:43], v[18:19]
    v_pk_add_f32 v[40:41], v[40:41], v[20:21]
    v_pk_add_f32 v[42:43], v[42:43], v[22:23]
    v_pk_add_f32 v[40:41], v[40:41], v[24:25]
    v_pk_add_f32 v[40:41], v[40:41], v[42:43]
    v_add_f32 v40, v40, v41
    s_nop 1
    v_add_f32_dpp v40, v40, v40 row_ror:8 row_mask:0xf bank_mask:0xf
    s_nop 1
    v_add_f32_dpp v40, v40, v40 row_ror:4 row_mask:0xf bank_mask:0xf
    s_nop 1
    v_add_f32_dpp v40, v40, v40 row_ror:2 row_mask:0xf bank_mask:0xf
    s_nop 1
    v_add_f32_dpp v40, v40, v40 row_ror:1 row_mask:0xf bank_mask:0xf
    v_mov_b32 v42, v40
    s_nop 1
    v_permlane16_swap_b32 v40, v42
    v_add_f32 v40, v40, v42
    v_mul_f32 v44, 0x3ae38e39, v40
    v_mov_b32 v45, v44
    v_cvt_pk_bf16_f32 v36, 0, v44
    v_cvt_pk_bf16_f32 v37, 0, v44
    v_pk_add_f32 v[38:39], v[8:9], v[44:45] neg_lo:[0,1] neg_hi:[0,1]
    v_pk_mul_f32 v[40:41], v[38:39], v[38:39]
    v_pk_add_f32 v[38:39], v[10:11], v[44:45] neg_lo:[0,1] neg_hi:[0,1]
    v_pk_mul_f32 v[42:43], v[38:39], v[38:39]
    v_pk_add_f32 v[38:39], v[12:13], v[44:45] neg_lo:[0,1] neg_hi:[0,1]
    v_pk_fma_f32 v[40:41], v[38:39], v[38:39], v[40:41]
    v_pk_add_f32 v[38:39], v[14:15], v[44:45] neg_lo:[0,1] neg_hi:[0,1]
    v_pk_fma_f32 v[42:43], v[38:39], v[38:39], v[42:43]
    v_pk_add_f32 v[38:39], v[16:17], v[44:45] neg_lo:[0,1] neg_hi:[0,1]
    v_pk_fma_f32 v[40:41], v[38:39], v[38:39], v[40:41]
    v_pk_add_f32 v[38:39], v[18:19], v[44:45] neg_lo:[0,1] neg_hi:[0,1]
    v_pk_fma_f32 v[42:43], v[38:39], v[38:39], v[42:43]
    v_pk_add_f32 v[38:39], v[20:21], v[44:45] neg_lo:[0,1] neg_hi:[0,1]
    v_pk_fma_f32 v[40:41], v[38:39], v[38:39], v[40:41]
    v_pk_add_f32 v[38:39], v[22:23], v[44:45] neg_lo:[0,1] neg_hi:[0,1]
    v_pk_fma_f32 v[42:43], v[38:39], v[38:39], v[42:43]
    v_pk_add_f32 v[38:39], v[24:25], v[44:45] neg_lo:[0,1] neg_hi:[0,1]
    v_pk_fma_f32 v[40:41], v[38:39], v[38:39], v[40:41]
    v_pk_add_f32 v[40:41], v[40:41], v[42:43]
    v_add_f32 v40, v40, v41
    s_nop 1
    v_add_f32_dpp v40, v40, v40 row_ror:8 row_mask:0xf bank_mask:0xf
    s_nop 1
    v_add_f32_dpp v40, v40, v40 row_ror:4 row_mask:0xf bank_mask:0xf
    s_nop 1
    v_add_f32_dpp v40, v40, v40 row_ror:2 row_mask:0xf bank_mask:0xf
    s_nop 1
    v_add_f32_dpp v40, v40, v40 row_ror:1 row_mask:0xf bank_mask:0xf
    v_mov_b32 v42, v40
    s_nop 1
    v_permlane16_swap_b32 v40, v42
    v_add_f32 v40, v40, v42
    v_mul_f32 v40, 0x3ae38e39, v40
    v_cvt_pk_bf16_f32 v40, 0, v40
    v_add_f32 v40, 0x3727c5ac, v40
    v_cvt_pk_bf16_f32 v40, 0, v40
    v_sqrt_f32 v40, v40
    s_nop 0
    v_cvt_pk_bf16_f32 v40, 0, v40
    v_rcp_f32 v38, v40
    s_nop 0
    v_mov_b32 v39, v38
    v_pk_add_f32 v[40:41], v[8:9], v[36:37] neg_lo:[0,1] neg_hi:[0,1]
    v_cvt_pk_bf16_f32 v40, 0, v40
    v_cvt_pk_bf16_f32 v41, 0, v41
    v_pk_mul_f32 v[40:41], v[40:41], v[38:39]
    v_cvt_pk_bf16_f32 v40, 0, v40
    v_cvt_pk_bf16_f32 v41, 0, v41
    v_cvt_pk_f16_f32 v26, v40, v41
    v_pk_add_f32 v[40:41], v[10:11], v[36:37] neg_lo:[0,1] neg_hi:[0,1]
    v_cvt_pk_bf16_f32 v40, 0, v40
    v_cvt_pk_bf16_f32 v41, 0, v41
    v_pk_mul_f32 v[40:41], v[40:41], v[38:39]
    v_cvt_pk_bf16_f32 v40, 0, v40
    v_cvt_pk_bf16_f32 v41, 0, v41
    v_cvt_pk_f16_f32 v27, v40, v41
    v_pk_add_f32 v[40:41], v[12:13], v[36:37] neg_lo:[0,1] neg_hi:[0,1]
    v_cvt_pk_bf16_f32 v40, 0, v40
    v_cvt_pk_bf16_f32 v41, 0, v41
    v_pk_mul_f32 v[40:41], v[40:41], v[38:39]
    v_cvt_pk_bf16_f32 v40, 0, v40
    v_cvt_pk_bf16_f32 v41, 0, v41
    v_cvt_pk_f16_f32 v28, v40, v41
    v_and_b32 v59, 3, v1
    v_lshlrev_b32 v59, 2, v59
    global_load_dword v58, v59, s[34:35] sc1
    v_pk_add_f32 v[40:41], v[14:15], v[36:37] neg_lo:[0,1] neg_hi:[0,1]
    v_cvt_pk_bf16_f32 v40, 0, v40
    v_cvt_pk_bf16_f32 v41, 0, v41
    v_pk_mul_f32 v[40:41], v[40:41], v[38:39]
    v_cvt_pk_bf16_f32 v40, 0, v40
    v_cvt_pk_bf16_f32 v41, 0, v41
    v_cvt_pk_f16_f32 v29, v40, v41
    v_permlane32_swap_b32 v26, v28
    s_nop 0
    v_permlane32_swap_b32 v27, v29
    v_perm_b32 v8, v28, v26, s98
    v_perm_b32 v9, v28, v26, s99
    v_perm_b32 v10, v29, v27, s98
    v_perm_b32 v11, v29, v27, s99
    ds_write_b128 v6, v[8:11] offset:0
    v_pk_add_f32 v[40:41], v[16:17], v[36:37] neg_lo:[0,1] neg_hi:[0,1]
    v_cvt_pk_bf16_f32 v40, 0, v40
    v_cvt_pk_bf16_f32 v41, 0, v41
    v_pk_mul_f32 v[40:41], v[40:41], v[38:39]
    v_cvt_pk_bf16_f32 v40, 0, v40
    v_cvt_pk_bf16_f32 v41, 0, v41
    v_cvt_pk_f16_f32 v30, v40, v41
    v_pk_add_f32 v[40:41], v[18:19], v[36:37] neg_lo:[0,1] neg_hi:[0,1]
    v_cvt_pk_bf16_f32 v40, 0, v40
    v_cvt_pk_bf16_f32 v41, 0, v41
    v_pk_mul_f32 v[40:41], v[40:41], v[38:39]
    v_cvt_pk_bf16_f32 v40, 0, v40
    v_cvt_pk_bf16_f32 v41, 0, v41
    v_cvt_pk_f16_f32 v31, v40, v41
    v_pk_add_f32 v[40:41], v[20:21], v[36:37] neg_lo:[0,1] neg_hi:[0,1]
    v_cvt_pk_bf16_f32 v40, 0, v40
    v_cvt_pk_bf16_f32 v41, 0, v41
    v_pk_mul_f32 v[40:41], v[40:41], v[38:39]
    v_cvt_pk_bf16_f32 v40, 0, v40
    v_cvt_pk_bf16_f32 v41, 0, v41
    v_cvt_pk_f16_f32 v32, v40, v41
    v_pk_add_f32 v[40:41], v[22:23], v[36:37] neg_lo:[0,1] neg_hi:[0,1]
    v_cvt_pk_bf16_f32 v40, 0, v40
    v_cvt_pk_bf16_f32 v41, 0, v41
    v_pk_mul_f32 v[40:41], v[40:41], v[38:39]
    v_cvt_pk_bf16_f32 v40, 0, v40
    v_cvt_pk_bf16_f32 v41, 0, v41
    v_cvt_pk_f16_f32 v33, v40, v41
    v_permlane32_swap_b32 v30, v32
    s_nop 0
    v_permlane32_swap_b32 v31, v33
    v_perm_b32 v16, v32, v30, s98
    v_perm_b32 v17, v32, v30, s99
    v_perm_b32 v18, v33, v31, s98
    v_perm_b32 v19, v33, v31, s99
    ds_write_b128 v6, v[16:19] offset:1024
    v_pk_add_f32 v[40:41], v[24:25], v[36:37] neg_lo:[0,1] neg_hi:[0,1]
    v_cvt_pk_bf16_f32 v40, 0, v40
    v_cvt_pk_bf16_f32 v41, 0, v41
    v_pk_mul_f32 v[40:41], v[40:41], v[38:39]
    v_cvt_pk_bf16_f32 v40, 0, v40
    v_cvt_pk_bf16_f32 v41, 0, v41
    v_cvt_pk_f16_f32 v34, v40, v41
    v_mov_b32 v40, v34
    s_nop 1
    v_permlane32_swap_b32 v34, v40
    v_perm_b32 v40, v40, v34, v35
    ds_write_b32 v7, v40 offset:2048
    v_mov_b32 v6, s97
    ds_write_b8 v6, v5 offset:0
    s_setprio 0
    s_cmp_ge_u32 s97, 4
    s_cbranch_scc1 KS_X4
    s_setprio 3
    s_mov_b32 s72, s36
    s_mov_b32 s73, s37
    s_mov_b32 s74, 0x240000
    s_mov_b32 s75, 0x20000
    v_and_b32 v6, 1, v0
    v_mul_u32_u24 v6, 9280, v6
    v_lshrrev_b32 v7, 1, v0
    v_lshl_add_u32 v6, v7, 2, v6
    v_add_u32 v6, 17088, v6
    v_lshrrev_b32 v7, 2, v0
    v_mul_u32_u24 v7, 0x2080, v7
    v_and_b32 v8, 3, v0
    v_lshl_add_u32 v7, v8, 4, v7
    s_lshl_b32 s92, s88, 6
    v_xor_b32 v7, s92, v7
    s_mov_b32 s92, 0
    s_add_u32 s93, s92, 524288
    s_add_u32 s94, s92, 1048576
    s_add_u32 s95, s92, 1572864
    s_add_u32 s96, s92, 2097152
    s_waitcnt vmcnt(0)
DBP_56:
    v_cmp_eq_u32 vcc, 0, v58
    s_cbranch_vccz DBG_57
    s_sleep 1
    global_load_dword v58, v59, s[34:35] sc1
    s_sub_u32 s39, s39, 1
    s_cbranch_scc1 KS_ABORT
    s_waitcnt vmcnt(0)
    s_branch DBP_56
DBG_57:
    ds_write_b32 v59, v58 offset:224
    s_mov_b32 s98, 0x70007
    v_lshrrev_b32 v57, 3, v58
    v_lshrrev_b32 v56, 6, v58
    v_lshrrev_b32 v55, 9, v58
W_58:
    ds_read_b64 v[20:21], v4 offset:0
    s_sub_u32 s39, s39, 1
    s_cbranch_scc1 KS_ABORT
    s_waitcnt lgkmcnt(0)
    v_and_b32 v20, v20, v21
    v_cmp_ne_u32 vcc, s84, v20
    s_cbranch_vccnz W_58
    ds_read2st64_b32 v[20:21], v6 offset0:0 offset1:9
    ds_read2st64_b32 v[22:23], v6 offset0:18 offset1:27
    ds_read2st64_b32 v[24:25], v6 offset0:2 offset1:11
    ds_read2st64_b32 v[26:27], v6 offset0:20 offset1:29
    ds_read2st64_b32 v[28:29], v6 offset0:4 offset1:13
    ds_read2st64_b32 v[30:31], v6 offset0:22 offset1:31
    ds_read2st64_b32 v[32:33], v6 offset0:6 offset1:15
    ds_read2st64_b32 v[34:35], v6 offset0:24 offset1:33
    ds_read2st64_b32 v[36:37], v6 offset0:8 offset1:17
    ds_read2st64_b32 v[38:39], v6 offset0:26 offset1:35
    s_waitcnt lgkmcnt(8)
    v_bfi_b32 v20, s98, v58, v20
    v_bfi_b32 v21, s98, v57, v21
    v_bfi_b32 v22, s98, v56, v22
    v_bfi_b32 v23, s98, v55, v23
    buffer_store_dwordx4 v[20:23], v7, s[72:75], s92 offen sc1
    s_waitcnt lgkmcnt(6)
    v_bfi_b32 v24, s98, v58, v24
    v_bfi_b32 v25, s98, v57, v25
    v_bfi_b32 v26, s98, v56, v26
    v_bfi_b32 v27, s98, v55, v27
    buffer_store_dwordx4 v[24:27], v7, s[72:75], s93 offen sc1
    s_waitcnt lgkmcnt(4)
    v_bfi_b32 v28, s98, v58, v28
    v_bfi_b32 v29, s98, v57, v29
    v_bfi_b32 v30, s98, v56, v30
    v_bfi_b32 v31, s98, v55, v31
    buffer_store_dwordx4 v[28:31], v7, s[72:75], s94 offen sc1
    s_waitcnt lgkmcnt(2)
    v_bfi_b32 v32, s98, v58, v32
    v_bfi_b32 v33, s98, v57, v33
    v_bfi_b32 v34, s98, v56, v34
    v_bfi_b32 v35, s98, v55, v35
    buffer_store_dwordx4 v[32:35], v7, s[72:75], s95 offen sc1
    s_waitcnt lgkmcnt(0)
    v_bfi_b32 v36, s98, v58, v36
    v_bfi_b32 v37, s98, v57, v37
    v_bfi_b32 v38, s98, v56, v38
    v_bfi_b32 v39, s98, v55, v39
    buffer_store_dwordx4 v[36:39], v7, s[72:75], s96 offen sc1
    v_mov_b32 v6, s97
    ds_write_b8 v6, v5 offset:200
    v_mul_u32_u24 v46, 57, v1
    v_lshrrev_b32 v46, 9, v46
    v_mul_u32_u24 v47, 9, v46
    v_sub_u32 v47, v1, v47
    v_mul_u32_u24 v46, 9216, v46
    v_lshl_add_u32 v46, v47, 7, v46
    s_cmp_ge_u32 s41, 18
    s_cbranch_scc1 KS_LL2
    s_branch KS_LLE
KS_LL2:
    s_mul_i32 s94, s38, 6
    s_add_u32 s94, s94, s41
    s_sub_u32 s94, s94, 18
    s_bitcmp1_b32 s94, 0
    s_cselect_b32 s72, s28, s26
    s_cselect_b32 s73, s29, s27
    s_mov_b32 s74, 0x510000
    s_mov_b32 s75, 0x20000
    s_lshr_b32 s95, s94, 1
    s_mul_i32 s95, s95, 64512
    s_mul_i32 s96, s40, 1152
    s_add_u32 s95, s95, s96
    s_add_u32 s96, s95, 2644992
    buffer_load_dword v47, v46, s[72:75], s96 offen nt
    buffer_load_dword v47, v46, s[72:75], s96 offen sc1
KS_LLE:
    s_mov_b32 s87, 1
    s_branch KS_L2B
KS_L0:
    s_and_b32 s92, s41, 15
    s_lshl_b32 s93, s40, 4
    s_add_u32 s92, s92, s93
    v_and_b32 v59, 3, v1
    v_lshlrev_b32 v59, 2, v59
    s_lshl_b32 s96, s92, 6
    s_add_u32 s93, s96, 0xb00000
    v_add_u32 v7, s93, v59
    s_mul_i32 s93, s92, 18560
    s_add_u32 s93, s93, 0x600000
    v_lshlrev_b32 v6, 4, v0
    v_mov_b32 v12, -1
    v_mov_b32 v13, -1
    v_mov_b32 v14, -1
    v_mov_b32 v15, -1
    s_setprio 3
    v_mul_u32_u24 v16, 57, v1
    v_lshrrev_b32 v16, 9, v16
    v_mul_u32_u24 v17, 9, v16
    v_sub_u32 v17, v1, v17
    v_mul_u32_u24 v16, 9216, v16
    v_lshl_add_u32 v16, v17, 7, v16
    s_waitcnt lgkmcnt(0)
    s_add_u32 s68, s36, s93
    s_addc_u32 s69, s37, 0
    s_mov_b32 s70, 18560
    s_mov_b32 s71, 0x20000
    s_barrier
W_59:
    s_sleep 2
    ds_read_b32 v8, v4 offset:36
    s_sub_u32 s39, s39, 1
    s_cbranch_scc1 KS_ABORT
    s_waitcnt lgkmcnt(0)
    v_cmp_eq_u32 vcc, 0, v8
    s_cbranch_vccnz W_59
    s_mov_b32 s92, 0
    buffer_store_dwordx4 v[12:15], v6, s[68:71], s92 offen sc1
    s_mov_b32 s92, 4096
    buffer_store_dwordx4 v[12:15], v6, s[68:71], s92 offen sc1
    s_mov_b32 s92, 8192
    buffer_store_dwordx4 v[12:15], v6, s[68:71], s92 offen sc1
    s_mov_b32 s92, 12288
    buffer_store_dwordx4 v[12:15], v6, s[68:71], s92 offen sc1
    s_mov_b32 s92, 16384
    buffer_store_dwordx4 v[12:15], v6, s[68:71], s92 offen sc1
    global_load_dword v58, v59, s[34:35] sc1
    s_waitcnt vmcnt(0)
DBP_60:
    v_cmp_eq_u32 vcc, 0, v58
    s_cbranch_vccz DBG_61
    s_sleep 1
    global_load_dword v58, v59, s[34:35] sc1
    s_sub_u32 s39, s39, 1
    s_cbranch_scc1 KS_ABORT
    s_waitcnt vmcnt(0)
    s_branch DBP_60
DBG_61:
    ds_write_b32 v59, v58 offset:224
    s_mov_b64 exec, 1
    ds_add_rtn_u32 v8, v4, v5 offset:8
    s_mov_b64 exec, -1
    v_lshrrev_b32 v57, 3, v58
    v_lshrrev_b32 v56, 6, v58
    v_lshrrev_b32 v55, 9, v58
    s_waitcnt lgkmcnt(0)
    v_readfirstlane_b32 s92, v8
    s_cmp_lg_u32 s92, 3
    s_cbranch_scc1 KS_L2
    s_mov_b64 exec, 15
    global_store_dword v7, v58, s[36:37] sc1
    s_mov_b64 exec, -1
    s_and_b32 s94, s41, 7
    s_cmp_ge_u32 s41, 8
    s_cbranch_scc1 KS_L1C
    s_branch KS_L2
KS_L1C:
    s_bitcmp1_b32 s94, 0
    s_cselect_b32 s72, s28, s26
    s_cselect_b32 s73, s29, s27
    s_mov_b32 s74, 0x510000
    s_mov_b32 s75, 0x20000
    s_lshr_b32 s95, s94, 1
    s_mul_i32 s95, s95, 64512
    s_mul_i32 s96, s40, 1152
    s_add_u32 s95, s95, s96
    s_add_u32 s96, s95, 3419136
    buffer_load_dword v18, v16, s[72:75], s96 offen nt
    buffer_load_dword v18, v16, s[72:75], s96 offen sc1
    s_add_u32 s96, s95, 3677184
    buffer_load_dword v18, v16, s[72:75], s96 offen nt
    buffer_load_dword v18, v16, s[72:75], s96 offen sc1
    s_add_u32 s96, s95, 3935232
    buffer_load_dword v18, v16, s[72:75], s96 offen nt
    buffer_load_dword v18, v16, s[72:75], s96 offen sc1
    s_add_u32 s96, s95, 4193280
    buffer_load_dword v18, v16, s[72:75], s96 offen nt
    buffer_load_dword v18, v16, s[72:75], s96 offen sc1
KS_L2:
    s_mov_b32 s87, 0
KS_L2B:
    s_mov_b32 s64, s36
    s_mov_b32 s65, s37
    s_mov_b32 s66, 0x240000
    s_mov_b32 s67, 0x20000
    v_lshrrev_b32 v7, 1, v1
    v_lshlrev_b32 v7, 6, v7
    v_and_b32 v10, 1, v1
    v_lshl_add_u32 v7, v10, 4, v7
    v_lshlrev_b32 v9, 4, v1
    s_lshl_b32 s92, s38, 11
    s_lshl_b32 s93, s90, 13
    s_add_u32 s93, s93, s92
    s_lshl_b32 s94, s90, 7
    s_and_b32 s95, s94, 0x380
    v_xor_b32 v13, s95, v9
    s_and_b32 s94, s94, 0x1c00
    s_xor_b32 s93, s93, s94
    s_xor_b32 s97, s93, 0x400
    s_lshl_b32 s95, s40, 3
    s_add_u32 s95, s95, s41
    s_add_u32 s95, s95, 488
    s_lshr_b32 s96, s95, 1
    s_lshl_b32 s96, s96, 13
    s_and_b32 s95, s95, 1
    s_lshl_b32 s95, s95, 5
    s_add_u32 s95, s95, s96
    s_add_u32 s95, s95, s92
    s_lshr_b32 s96, s96, 6
    s_and_b32 s94, s96, 0x780
    v_xor_b32 v7, s94, v7
    s_and_b32 s96, s96, 0x1800
    s_xor_b32 s95, s95, s96
    s_cmp_lt_u32 s41, 24
    s_cselect_b32 s95, 2359296, s95
    s_cselect_b32 s94, 0, 0x70007
    v_mov_b32_dpp v64, v58 quad_perm:[0,1,0,1] row_mask:0xf bank_mask:0xf
    v_mov_b32_dpp v65, v58 quad_perm:[2,3,2,3] row_mask:0xf bank_mask:0xf
    s_bitcmp1_b32 s41, 0
    s_cselect_b64 vcc, -1, 0
    v_cndmask_b32 v64, v64, v65, vcc
    v_and_b32 v60, 0x70007, v58
    v_and_b32 v61, 0x70007, v57
    v_and_b32 v62, 0x70007, v56
    v_and_b32 v63, 0x70007, v55
    v_lshrrev_b32 v67, 9, v64
    v_lshrrev_b32 v66, 6, v64
    v_lshrrev_b32 v65, 3, v64
    v_and_b32 v64, s94, v64
    v_and_b32 v65, s94, v65
    v_and_b32 v66, s94, v66
    v_and_b32 v67, s94, v67
    s_lshl_b32 s96, s38, 10
    s_add_u32 s96, s96, 3552
    v_bfe_u32 v11, v1, 1, 1
    v_mul_u32_u24 v11, 4672, v11
    v_lshl_add_u32 v11, v10, 4, v11
    v_lshrrev_b32 v10, 2, v1
    v_lshl_add_u32 v11, v10, 5, v11
    v_add_u32 v11, s96, v11
    v_add_u32 v10, s96, v9
    v_mov_b32 v116, s38
    s_add_u32 s92, s92, 0xb00000
    v_lshrrev_b32 v12, 2, v1
    v_lshl_add_u32 v12, v12, 6, v59
    v_add_u32 v12, s92, v12
    s_cmp_lt_u32 s41, 8
    s_cselect_b32 s94, 20, 4
    s_cmp_ge_u32 s41, 24
    s_cselect_b32 s94, 24, s94
    v_mov_b32 v14, s94
    s_setprio 0
    s_waitcnt vmcnt(0)
    ds_write_b8 v116, v5 offset:204
W_62:
    s_sleep 2
    ds_read_b32 v8, v14 offset:64
    s_sub_u32 s39, s39, 1
    s_cbranch_scc1 KS_ABORT
    s_waitcnt lgkmcnt(0)
    v_cmp_ne_u32 vcc, s84, v8
    s_cbranch_vccnz W_62
    s_setprio 3
    s_branch UPE_64
UP_63:
    s_sleep 2
UPE_64:
    global_load_dword v32, v12, s[36:37] sc1
    global_load_dword v33, v12, s[36:37] offset:1024 sc1
    buffer_load_dwordx4 v[20:23], v13, s[64:67], s93 offen sc1
    buffer_load_dwordx4 v[24:27], v13, s[64:67], s97 offen sc1
    buffer_load_dwordx4 v[28:31], v7, s[64:67], s95 offen sc1
    s_sub_u32 s39, s39, 1
    s_cbranch_scc1 KS_ABORT
    s_waitcnt vmcnt(2)
    v_xor_b32 v32, v58, v32
    v_xor_b32 v33, v58, v33
    v_xor_b32 v20, v60, v20
    v_xor_b32 v21, v61, v21
    v_xor_b32 v22, v62, v22
    v_xor_b32 v23, v63, v23
    v_or3_b32 v44, v20, v21, v21
    v_or3_b32 v44, v22, v23, v44
    s_waitcnt vmcnt(1)
    v_xor_b32 v24, v60, v24
    v_xor_b32 v25, v61, v25
    v_xor_b32 v26, v62, v26
    v_xor_b32 v27, v63, v27
    v_or3_b32 v44, v24, v25, v44
    v_or3_b32 v44, v26, v27, v44
    s_waitcnt vmcnt(0)
    v_xor_b32 v28, v64, v28
    v_xor_b32 v29, v65, v29
    v_xor_b32 v30, v66, v30
    v_xor_b32 v31, v67, v31
    v_or3_b32 v44, v28, v29, v44
    v_or3_b32 v44, v30, v31, v44
    v_and_b32 v44, 0x70007, v44
    v_or3_b32 v44, v44, v32, v33
    v_cmp_ne_u32 vcc, 0, v44
    s_cbranch_vccnz UP_63
    ds_write_b128 v11, v[20:23]
    ds_write_b128 v11, v[24:27] offset:512
    ds_write_b128 v10, v[28:31] offset:9344
    ds_write_b8 v116, v5 offset:16
    s_cmp_eq_u32 s38, 2
    s_cbranch_scc1 WJ2_67
    s_add_u32 s92, s38, 1
    s_lshr_b32 s92, s92, 2
    s_cmp_eq_u32 s38, 1
    s_cselect_b32 s92, 2, s92
    s_lshl_b32 s92, s92, 10
    v_lshl_add_u32 v10, v1, 4, s92
    v_add_u32 v11, 35840, v10
W_68:
    ds_read_b32 v12, v4 offset:16
    s_sub_u32 s39, s39, 1
    s_cbranch_scc1 KS_ABORT
    s_waitcnt lgkmcnt(0)
    v_cmp_ne_u32 vcc, s84, v12
    s_cbranch_vccnz W_68
    s_setprio 3
    ds_read_b128 v[20:23], v10 offset:3520
    ds_read_b128 v[24:27], v10 offset:3536
    ds_read_b64 v[28:29], v10 offset:3552
    ds_read_b128 v[32:35], v10 offset:8192
    ds_read_b128 v[36:39], v10 offset:8208
    ds_read_b64 v[40:41], v10 offset:8224
    ds_read_b128 v[44:47], v10 offset:12864
    ds_read_b128 v[48:51], v10 offset:12880
    ds_read_b64 v[52:53], v10 offset:12896
    s_cmp_eq_u32 s38, 1
    s_cbranch_scc1 WJ1_66
    ds_read_b32 v12, v4 offset:68
    s_waitcnt lgkmcnt(7)
    v_alignbit_b32 v57, v22, v21, 16
    v_alignbit_b32 v58, v23, v22, 16
    v_alignbit_b32 v59, v24, v23, 16
    v_alignbit_b32 v60, v25, v24, 16
    v_alignbit_b32 v61, v26, v25, 16
    v_alignbit_b32 v62, v27, v26, 16
    v_alignbit_b32 v63, v28, v27, 16
    v_alignbit_b32 v64, v29, v28, 16
    v_pk_add_f16 v66, v57, v22
    v_pk_add_f16 v67, v58, v23
    v_pk_add_f16 v68, v59, v24
    v_pk_add_f16 v69, v60, v25
    v_pk_add_f16 v70, v61, v26
    v_pk_add_f16 v71, v62, v27
    v_pk_add_f16 v72, v63, v28
    v_pk_add_f16 v73, v64, v29
    v_pk_add_f16 v80, v66, v58
    v_pk_add_f16 v81, v67, v59
    v_pk_add_f16 v82, v68, v60
    v_pk_add_f16 v83, v69, v61
    v_pk_add_f16 v74, v67, v68
    v_pk_add_f16 v75, v68, v69
    v_pk_add_f16 v76, v69, v70
    v_pk_add_f16 v77, v70, v71
    v_pk_add_f16 v78, v71, v72
    v_pk_add_f16 v79, v72, v73
    s_waitcnt lgkmcnt(0)
    v_cmp_eq_u32 vcc, s84, v12
    s_cbranch_vccnz WJK_69
W_70:
    s_sleep 1
    ds_read_b32 v12, v4 offset:68
    s_sub_u32 s39, s39, 1
    s_cbranch_scc1 KS_ABORT
    s_waitcnt lgkmcnt(0)
    v_cmp_ne_u32 vcc, s84, v12
    s_cbranch_vccnz W_70
WJK_69:
    ds_write_b128 v11, v[80:83] offset:0
    v_pk_add_f16 v87, v22, v74
    v_pk_add_f16 v88, v23, v75
    v_pk_add_f16 v89, v24, v76
    v_pk_add_f16 v90, v25, v77
    v_pk_add_f16 v91, v26, v78
    ds_write_b128 v11, v[88:91] offset:3104
    v_pk_add_f16 v84, v70, v62
    v_pk_add_f16 v85, v71, v63
    v_pk_add_f16 v86, v72, v64
    v_pk_add_f16 v92, v74, v83
    v_pk_add_f16 v93, v75, v84
    v_pk_add_f16 v94, v76, v85
    v_pk_add_f16 v95, v77, v86
    ds_write_b128 v11, v[92:95] offset:6176
    v_pk_add_f16 v96, v87, v76
    v_pk_add_f16 v97, v88, v77
    v_pk_add_f16 v98, v89, v78
    v_pk_add_f16 v99, v90, v79
    ds_write_b128 v11, v[96:99] offset:8240
    ds_write_b8 v116, v5 offset:76
    ds_read_b32 v12, v4 offset:84
    v_alignbit_b32 v57, v34, v33, 16
    v_alignbit_b32 v58, v35, v34, 16
    v_alignbit_b32 v59, v36, v35, 16
    v_alignbit_b32 v60, v37, v36, 16
    v_alignbit_b32 v61, v38, v37, 16
    v_alignbit_b32 v62, v39, v38, 16
    v_alignbit_b32 v63, v40, v39, 16
    v_alignbit_b32 v64, v41, v40, 16
    v_pk_add_f16 v66, v57, v34
    v_pk_add_f16 v67, v58, v35
    v_pk_add_f16 v68, v59, v36
    v_pk_add_f16 v69, v60, v37
    v_pk_add_f16 v70, v61, v38
    v_pk_add_f16 v71, v62, v39
    v_pk_add_f16 v72, v63, v40
    v_pk_add_f16 v73, v64, v41
    v_pk_add_f16 v80, v66, v58
    v_pk_add_f16 v81, v67, v59
    v_pk_add_f16 v82, v68, v60
    v_pk_add_f16 v83, v69, v61
    v_pk_add_f16 v74, v67, v68
    v_pk_add_f16 v75, v68, v69
    v_pk_add_f16 v76, v69, v70
    v_pk_add_f16 v77, v70, v71
    v_pk_add_f16 v78, v71, v72
    v_pk_add_f16 v79, v72, v73
    s_waitcnt lgkmcnt(0)
    v_cmp_eq_u32 vcc, s84, v12
    s_cbranch_vccnz WJK_71
W_72:
    s_sleep 1
    ds_read_b32 v12, v4 offset:84
    s_sub_u32 s39, s39, 1
    s_cbranch_scc1 KS_ABORT
    s_waitcnt lgkmcnt(0)
    v_cmp_ne_u32 vcc, s84, v12
    s_cbranch_vccnz W_72
WJK_71:
    ds_write_b128 v11, v[80:83] offset:36672
    v_pk_add_f16 v87, v34, v74
    v_pk_add_f16 v88, v35, v75
    v_pk_add_f16 v89, v36, v76
    v_pk_add_f16 v90, v37, v77
    v_pk_add_f16 v91, v38, v78
    ds_write_b128 v11, v[88:91] offset:39776
    v_pk_add_f16 v84, v70, v62
    v_pk_add_f16 v85, v71, v63
    v_pk_add_f16 v86, v72, v64
    v_pk_add_f16 v92, v74, v83
    v_pk_add_f16 v93, v75, v84
    v_pk_add_f16 v94, v76, v85
    v_pk_add_f16 v95, v77, v86
    ds_write_b128 v11, v[92:95] offset:42848
    v_pk_add_f16 v96, v87, v76
    v_pk_add_f16 v97, v88, v77
    v_pk_add_f16 v98, v89, v78
    v_pk_add_f16 v99, v90, v79
    ds_write_b128 v11, v[96:99] offset:44912
    ds_write_b8 v116, v5 offset:92
    s_cmp_lt_u32 s41, 24
    s_cbranch_scc1 WJE_65
    ds_read_b32 v12, v4 offset:100
    v_alignbit_b32 v57, v46, v45, 16
    v_alignbit_b32 v58, v47, v46, 16
    v_alignbit_b32 v59, v48, v47, 16
    v_alignbit_b32 v60, v49, v48, 16
    v_alignbit_b32 v61, v50, v49, 16
    v_alignbit_b32 v62, v51, v50, 16
    v_alignbit_b32 v63, v52, v51, 16
    v_alignbit_b32 v64, v53, v52, 16
    v_pk_add_f16 v66, v57, v46
    v_pk_add_f16 v67, v58, v47
    v_pk_add_f16 v68, v59, v48
    v_pk_add_f16 v69, v60, v49
    v_pk_add_f16 v70, v61, v50
    v_pk_add_f16 v71, v62, v51
    v_pk_add_f16 v72, v63, v52
    v_pk_add_f16 v73, v64, v53
    v_pk_add_f16 v80, v66, v58
    v_pk_add_f16 v81, v67, v59
    v_pk_add_f16 v82, v68, v60
    v_pk_add_f16 v83, v69, v61
    v_pk_add_f16 v74, v67, v68
    v_pk_add_f16 v75, v68, v69
    v_pk_add_f16 v76, v69, v70
    v_pk_add_f16 v77, v70, v71
    v_pk_add_f16 v78, v71, v72
    v_pk_add_f16 v79, v72, v73
    s_waitcnt lgkmcnt(0)
    v_cmp_eq_u32 vcc, s84, v12
    s_cbranch_vccnz WJK_73
W_74:
    s_sleep 1
    ds_read_b32 v12, v4 offset:100
    s_sub_u32 s39, s39, 1
    s_cbranch_scc1 KS_ABORT
    s_waitcnt lgkmcnt(0)
    v_cmp_ne_u32 vcc, s84, v12
    s_cbranch_vccnz W_74
WJK_73:
    v_add_u32 v11, 73344, v11
    ds_write_b128 v11, v[80:83] offset:0
    v_pk_add_f16 v87, v46, v74
    v_pk_add_f16 v88, v47, v75
    v_pk_add_f16 v89, v48, v76
    v_pk_add_f16 v90, v49, v77
    v_pk_add_f16 v91, v50, v78
    ds_write_b128 v11, v[88:91] offset:3104
    v_pk_add_f16 v84, v70, v62
    v_pk_add_f16 v85, v71, v63
    v_pk_add_f16 v86, v72, v64
    v_pk_add_f16 v92, v74, v83
    v_pk_add_f16 v93, v75, v84
    v_pk_add_f16 v94, v76, v85
    v_pk_add_f16 v95, v77, v86
    ds_write_b128 v11, v[92:95] offset:6176
    v_pk_add_f16 v96, v87, v76
    v_pk_add_f16 v97, v88, v77
    v_pk_add_f16 v98, v89, v78
    v_pk_add_f16 v99, v90, v79
    ds_write_b128 v11, v[96:99] offset:8240
    ds_write_b8 v116, v5 offset:108
    s_branch WJE_65
WJ1_66:
    ds_read_b32 v12, v4 offset:68
    s_waitcnt lgkmcnt(7)
    v_alignbit_b32 v57, v22, v21, 16
    v_alignbit_b32 v58, v23, v22, 16
    v_alignbit_b32 v59, v24, v23, 16
    v_alignbit_b32 v60, v25, v24, 16
    v_alignbit_b32 v61, v26, v25, 16
    v_alignbit_b32 v62, v27, v26, 16
    v_alignbit_b32 v63, v28, v27, 16
    v_pk_add_f16 v66, v57, v22
    v_pk_add_f16 v67, v58, v23
    v_pk_add_f16 v68, v59, v24
    v_pk_add_f16 v69, v60, v25
    v_pk_add_f16 v70, v61, v26
    v_pk_add_f16 v71, v62, v27
    v_pk_add_f16 v72, v63, v28
    v_pk_add_f16 v80, v66, v58
    v_pk_add_f16 v81, v67, v59
    v_pk_add_f16 v82, v68, v60
    v_pk_add_f16 v83, v69, v61
    v_pk_add_f16 v75, v68, v69
    v_pk_add_f16 v76, v69, v70
    v_pk_add_f16 v77, v70, v71
    v_pk_add_f16 v78, v71, v72
    s_waitcnt lgkmcnt(0)
    v_cmp_eq_u32 vcc, s84, v12
    s_cbranch_vccnz WJK_75
W_76:
    s_sleep 1
    ds_read_b32 v12, v4 offset:68
    s_sub_u32 s39, s39, 1
    s_cbranch_scc1 KS_ABORT
    s_waitcnt lgkmcnt(0)
    v_cmp_ne_u32 vcc, s84, v12
    s_cbranch_vccnz W_76
WJK_75:
    ds_write_b128 v11, v[80:83] offset:0
    v_pk_add_f16 v88, v23, v75
    v_pk_add_f16 v89, v24, v76
    v_pk_add_f16 v90, v25, v77
    v_pk_add_f16 v91, v26, v78
    ds_write_b128 v11, v[88:91] offset:3104
    ds_write_b8 v116, v5 offset:76
    ds_read_b32 v12, v4 offset:84
    v_alignbit_b32 v57, v34, v33, 16
    v_alignbit_b32 v58, v35, v34, 16
    v_alignbit_b32 v59, v36, v35, 16
    v_alignbit_b32 v60, v37, v36, 16
    v_alignbit_b32 v61, v38, v37, 16
    v_alignbit_b32 v62, v39, v38, 16
    v_alignbit_b32 v63, v40, v39, 16
    v_pk_add_f16 v66, v57, v34
    v_pk_add_f16 v67, v58, v35
    v_pk_add_f16 v68, v59, v36
    v_pk_add_f16 v69, v60, v37
    v_pk_add_f16 v70, v61, v38
    v_pk_add_f16 v71, v62, v39
    v_pk_add_f16 v72, v63, v40
    v_pk_add_f16 v80, v66, v58
    v_pk_add_f16 v81, v67, v59
    v_pk_add_f16 v82, v68, v60
    v_pk_add_f16 v83, v69, v61
    v_pk_add_f16 v75, v68, v69
    v_pk_add_f16 v76, v69, v70
    v_pk_add_f16 v77, v70, v71
    v_pk_add_f16 v78, v71, v72
    s_waitcnt lgkmcnt(0)
    v_cmp_eq_u32 vcc, s84, v12
    s_cbranch_vccnz WJK_77
W_78:
    s_sleep 1
    ds_read_b32 v12, v4 offset:84
    s_sub_u32 s39, s39, 1
    s_cbranch_scc1 KS_ABORT
    s_waitcnt lgkmcnt(0)
    v_cmp_ne_u32 vcc, s84, v12
    s_cbranch_vccnz W_78
WJK_77:
    ds_write_b128 v11, v[80:83] offset:36672
    v_pk_add_f16 v88, v35, v75
    v_pk_add_f16 v89, v36, v76
    v_pk_add_f16 v90, v37, v77
    v_pk_add_f16 v91, v38, v78
    ds_write_b128 v11, v[88:91] offset:39776
    ds_write_b8 v116, v5 offset:92
    s_cmp_lt_u32 s41, 24
    s_cbranch_scc1 WJE_65
    ds_read_b32 v12, v4 offset:100
    v_alignbit_b32 v57, v46, v45, 16
    v_alignbit_b32 v58, v47, v46, 16
    v_alignbit_b32 v59, v48, v47, 16
    v_alignbit_b32 v60, v49, v48, 16
    v_alignbit_b32 v61, v50, v49, 16
    v_alignbit_b32 v62, v51, v50, 16
    v_alignbit_b32 v63, v52, v51, 16
    v_pk_add_f16 v66, v57, v46
    v_pk_add_f16 v67, v58, v47
    v_pk_add_f16 v68, v59, v48
    v_pk_add_f16 v69, v60, v49
    v_pk_add_f16 v70, v61, v50
    v_pk_add_f16 v71, v62, v51
    v_pk_add_f16 v72, v63, v52
    v_pk_add_f16 v80, v66, v58
    v_pk_add_f16 v81, v67, v59
    v_pk_add_f16 v82, v68, v60
    v_pk_add_f16 v83, v69, v61
    v_pk_add_f16 v75, v68, v69
    v_pk_add_f16 v76, v69, v70
    v_pk_add_f16 v77, v70, v71
    v_pk_add_f16 v78, v71, v72
    s_waitcnt lgkmcnt(0)
    v_cmp_eq_u32 vcc, s84, v12
    s_cbranch_vccnz WJK_79
W_80:
    s_sleep 1
    ds_read_b32 v12, v4 offset:100
    s_sub_u32 s39, s39, 1
    s_cbranch_scc1 KS_ABORT
    s_waitcnt lgkmcnt(0)
    v_cmp_ne_u32 vcc, s84, v12
    s_cbranch_vccnz W_80
WJK_79:
    v_add_u32 v11, 73344, v11
    ds_write_b128 v11, v[80:83] offset:0
    v_pk_add_f16 v88, v47, v75
    v_pk_add_f16 v89, v48, v76
    v_pk_add_f16 v90, v49, v77
    v_pk_add_f16 v91, v50, v78
    ds_write_b128 v11, v[88:91] offset:3104
    ds_write_b8 v116, v5 offset:108
    s_branch WJE_65
WJ2_67:
    ds_write_b8 v116, v5 offset:76
    ds_write_b8 v116, v5 offset:92
    ds_write_b8 v116, v5 offset:108
    s_sub_u32 s94, s41, 18
    s_and_b32 s94, s94, 31
    s_cmp_ge_u32 s94, 14
    s_cbranch_scc1 WJE_65
    v_mul_u32_u24 v100, 57, v1
    v_lshrrev_b32 v100, 9, v100
    v_mul_u32_u24 v101, 9, v100
    v_sub_u32 v101, v1, v101
    v_mul_u32_u24 v100, 9216, v100
    v_lshl_add_u32 v100, v101, 7, v100
W_81:
    s_sleep 1
    ds_read_b32 v12, v4 offset:16
    s_sub_u32 s39, s39, 1
    s_cbranch_scc1 KS_ABORT
    s_waitcnt lgkmcnt(0)
    v_cmp_ne_u32 vcc, s84, v12
    s_cbranch_vccnz W_81
    s_bitcmp1_b32 s94, 0
    s_cselect_b32 s72, s28, s26
    s_cselect_b32 s73, s29, s27
    s_mov_b32 s74, 0x510000
    s_mov_b32 s75, 0x20000
    s_lshr_b32 s95, s94, 1
    s_mul_i32 s95, s95, 64512
    s_mul_i32 s96, s40, 1152
    s_add_u32 s95, s95, s96
    s_add_u32 s96, s95, 4451328
    buffer_load_dword v102, v100, s[72:75], s96 offen nt
    buffer_load_dword v102, v100, s[72:75], s96 offen sc1
    s_add_u32 s96, s95, 4902912
    buffer_load_dword v102, v100, s[72:75], s96 offen nt
    buffer_load_dword v102, v100, s[72:75], s96 offen sc1
KS_PF2D:
WJE_65:
    s_setprio 0
    s_lshr_b32 s92, s90, 6
    s_lshl_b32 s92, s92, 9
    s_bfe_u32 s93, s90, 0x20004
    s_lshl_b32 s93, s93, 6
    s_add_u32 s92, s92, s93
    s_and_b32 s93, s90, 3
    s_lshl_b32 s93, s93, 4
    s_add_u32 s92, s92, s93
    s_and_b32 s93, s90, 12
    s_add_u32 s92, s92, s93
    s_lshr_b32 s93, s38, 1
    s_lshl_b32 s93, s93, 8
    s_add_u32 s92, s92, s93
    s_and_b32 s93, s38, 1
    s_lshl_b32 s93, s93, 1
    s_add_u32 s92, s92, s93
    v_lshrrev_b32 v113, 5, v1
    v_and_b32 v114, 31, v1
    v_add_u32 v112, s92, v113
    v_mul_u32_u24 v115, 1152, v112
    v_lshl_add_u32 v8, v114, 2, v115
    v_lshl_add_u32 v115, v114, 4, v115
    v_lshlrev_b32 v7, 2, v114
    v_lshlrev_b32 v6, 4, v114
    v_bfe_u32 v111, v1, 3, 1
    v_add_u32 v111, s92, v111
    v_mul_u32_u24 v111, 1152, v111
    v_and_b32 v9, 7, v1
    v_lshl_add_u32 v111, v9, 4, v111
    s_mov_b32 s64, s4
    s_mov_b32 s65, s5
    s_mov_b32 s66, 0x240000
    s_mov_b32 s67, 0x20000
    s_mov_b32 s68, s24
    s_mov_b32 s69, s25
    s_mov_b32 s70, 0x480
    s_mov_b32 s71, 0x20000
    buffer_load_dwordx4 v[10:13], v115, s[64:67], 0 offen
    buffer_load_dwordx4 v[14:17], v115, s[64:67], 0 offen offset:512
    buffer_load_dword v18, v8, s[64:67], 0 offen offset:1024
    buffer_load_dwordx4 v[50:53], v6, s[68:71], 0 offen
    buffer_load_dwordx4 v[54:57], v6, s[68:71], 0 offen offset:512
    buffer_load_dword v58, v7, s[68:71], 0 offen offset:1024
KS_L4:
    s_add_u32 s64, s36, 0x600000
    s_addc_u32 s65, s37, 0
    s_mov_b32 s66, 0x240000
    s_mov_b32 s67, 0x20000
    s_mov_b32 s68, s32
    s_mov_b32 s69, s33
    s_mov_b32 s70, 0x240000
    s_mov_b32 s71, 0x20000
    s_mov_b32 s72, s36
    s_mov_b32 s73, s37
    s_mov_b32 s74, 0x240000
    s_mov_b32 s75, 0x20000
    s_add_u32 s76, s36, 0x840000
    s_addc_u32 s77, s37, 0
    s_mov_b32 s78, 0x3000
    s_mov_b32 s79, 0x20000
    s_not_b32 s93, s90
    v_xor_b32 v8, s93, v0
    v_lshrrev_b32 v6, 1, v0
    v_lshlrev_b32 v6, 6, v6
    v_and_b32 v8, 1, v8
    v_lshl_add_u32 v6, v8, 4, v6
    s_lshr_b32 s92, s90, 2
    s_lshl_b32 s92, s92, 15
    s_and_b32 s93, s90, 1
    s_lshl_b32 s93, s93, 14
    s_add_u32 s92, s92, s93
    s_and_b32 s93, s90, 2
    s_lshl_b32 s93, s93, 4
    s_add_u32 s92, s92, s93
    s_lshr_b32 s94, s90, 2
    s_lshl_b32 s94, s94, 12
    s_and_b32 s93, s90, 3
    s_lshl_b32 s93, s93, 4
    s_add_u32 s94, s94, s93
    s_lshl_b32 s93, s38, 10
    s_add_u32 s94, s94, s93
    s_add_u32 s94, s94, 0x200000
    v_lshlrev_b32 v9, 6, v2
    s_lshl_b32 s93, s90, 5
    s_and_b32 s95, s93, 0x1f80
    v_xor_b32 v6, s95, v6
    s_and_b32 s95, s93, 0x380
    v_xor_b32 v9, s95, v9
    s_and_b32 s95, s93, 0xc00
    s_xor_b32 s94, s94, s95
    s_and_b32 s93, s90, 1
    s_lshl_b32 s93, s93, 13
    s_xor_b32 s92, s92, s93
    s_xor_b32 s93, s92, 0x2000
    s_mul_i32 s95, s38, 2304
    s_add_u32 s95, s95, 17088
    v_lshl_add_u32 v117, v114, 5, s95
    v_lshl_add_u32 v110, v114, 3, s95
    s_lshl_b32 s95, s38, 9
    s_add_u32 s95, s95, 35840
    v_lshl_add_u32 v108, v1, 2, s95
    v_lshl_add_u32 v109, v1, 4, s95
    s_mov_b32 s95, 0x02020000
    v_mul_lo_u32 v118, v113, s95
    v_add_u32 v118, 0x01000c0c, v118
    v_lshlrev_b32 v8, 2, v0
    v_add_u32 v8, 17088, v8
    s_lshl_b32 s95, s38, 6
    s_add_u32 s95, s95, 19136
    v_lshl_add_u32 v119, v2, 2, s95
    s_waitcnt vmcnt(0)
    v_lshlrev_b32 v20, 16, v10
    v_and_b32 v21, 0xffff0000, v10
    v_lshlrev_b32 v22, 16, v11
    v_and_b32 v23, 0xffff0000, v11
    v_lshlrev_b32 v24, 16, v12
    v_and_b32 v25, 0xffff0000, v12
    v_lshlrev_b32 v26, 16, v13
    v_and_b32 v27, 0xffff0000, v13
    v_lshlrev_b32 v28, 16, v14
    v_and_b32 v29, 0xffff0000, v14
    v_lshlrev_b32 v30, 16, v15
    v_and_b32 v31, 0xffff0000, v15
    v_lshlrev_b32 v32, 16, v16
    v_and_b32 v33, 0xffff0000, v16
    v_lshlrev_b32 v34, 16, v17
    v_and_b32 v35, 0xffff0000, v17
    v_lshlrev_b32 v36, 16, v18
    v_and_b32 v37, 0xffff0000, v18
    v_lshlrev_b32 v80, 16, v50
    v_and_b32 v81, 0xffff0000, v50
    v_lshlrev_b32 v82, 16, v51
    v_and_b32 v83, 0xffff0000, v51
    v_lshlrev_b32 v84, 16, v52
    v_and_b32 v85, 0xffff0000, v52
    v_lshlrev_b32 v86, 16, v53
    v_and_b32 v87, 0xffff0000, v53
    v_lshlrev_b32 v88, 16, v54
    v_and_b32 v89, 0xffff0000, v54
    v_lshlrev_b32 v90, 16, v55
    v_and_b32 v91, 0xffff0000, v55
    v_lshlrev_b32 v92, 16, v56
    v_and_b32 v93, 0xffff0000, v56
    v_lshlrev_b32 v94, 16, v57
    v_and_b32 v95, 0xffff0000, v57
    v_lshlrev_b32 v96, 16, v58
    v_and_b32 v97, 0xffff0000, v58
    v_pk_add_f32 v[78:79], v[80:81], v[82:83]
    v_pk_add_f32 v[78:79], v[78:79], v[84:85]
    v_pk_add_f32 v[78:79], v[78:79], v[86:87]
    v_pk_add_f32 v[78:79], v[78:79], v[88:89]
    v_pk_add_f32 v[78:79], v[78:79], v[90:91]
    v_pk_add_f32 v[78:79], v[78:79], v[92:93]
    v_pk_add_f32 v[78:79], v[78:79], v[94:95]
    v_pk_add_f32 v[78:79], v[78:79], v[96:97]
    v_add_f32 v78, v78, v79
    s_nop 1
    v_add_f32_dpp v78, v78, v78 row_ror:8 row_mask:0xf bank_mask:0xf
    s_nop 1
    v_add_f32_dpp v78, v78, v78 row_ror:4 row_mask:0xf bank_mask:0xf
    s_nop 1
    v_add_f32_dpp v78, v78, v78 row_ror:2 row_mask:0xf bank_mask:0xf
    s_nop 1
    v_add_f32_dpp v78, v78, v78 row_ror:1 row_mask:0xf bank_mask:0xf
    v_mov_b32 v79, v78
    s_nop 1
    v_permlane16_swap_b32 v78, v79
    v_add_f32 v78, v78, v79
    v_sub_u32 v98, 0x87ff, v112
    v_lshl_add_u32 v99, v116, 1, v113
    v_lshlrev_b32 v99, 2, v99
W_82:
    s_sleep 1
    ds_read_b32 v60, v4 offset:52
    s_sub_u32 s39, s39, 1
    s_cbranch_scc1 KS_ABORT
    s_waitcnt lgkmcnt(0)
    v_cmp_ne_u32 vcc, s84, v60
    s_cbranch_vccnz W_82
    s_setprio 3
    s_branch ZPE_84
ZP_83:
    s_sleep 1
ZPE_84:
    buffer_load_dwordx4 v[68:71], v4, s[64:67], s94 offen sc1
    s_sub_u32 s39, s39, 1
    s_cbranch_scc1 KS_ABORT
    s_waitcnt vmcnt(0)
    v_max3_u32 v44, v68, v69, v70
    v_max_u32 v44, v44, v71
    v_cmp_eq_u32 vcc, -1, v44
    s_cbranch_vccnz ZP_83
    s_branch ZPE_86
ZP_85:
    s_sleep 1
ZPE_86:
    buffer_load_dwordx4 v[60:63], v6, s[64:67], s92 offen sc1
    buffer_load_dwordx4 v[64:67], v6, s[64:67], s93 offen sc1
    buffer_load_dwordx4 v[68:71], v9, s[64:67], s94 offen sc1
    s_sub_u32 s39, s39, 1
    s_cbranch_scc1 KS_ABORT
    s_waitcnt vmcnt(2)
    ds_write2st64_b32 v8, v60, v61 offset0:0 offset1:9
    ds_write2st64_b32 v8, v62, v63 offset0:18 offset1:27
    v_max3_u32 v44, v60, v61, v61
    v_max3_u32 v44, v62, v63, v44
    s_waitcnt vmcnt(1)
    ds_write2st64_b32 v8, v64, v65 offset0:4 offset1:13
    ds_write2st64_b32 v8, v66, v67 offset0:22 offset1:31
    v_max3_u32 v44, v64, v65, v44
    v_max3_u32 v44, v66, v67, v44
    s_waitcnt vmcnt(0)
    ds_write2st64_b32 v119, v68, v69 offset0:0 offset1:9
    ds_write2st64_b32 v119, v70, v71 offset0:18 offset1:27
    v_max3_u32 v44, v68, v69, v44
    v_max3_u32 v44, v70, v71, v44
    v_cmp_eq_u32 vcc, -1, v44
    s_cbranch_vccnz ZP_85
    ds_write_b8 v116, v5 offset:20
ZW_87:
    ds_read_b32 v44, v4 offset:20
    ds_read_b128 v[60:63], v117 offset:0
    ds_read_b128 v[64:67], v117 offset:16
    ds_read_b128 v[68:71], v117 offset:1024
    ds_read_b128 v[72:75], v117 offset:1040
    ds_read_b64 v[76:77], v110 offset:2048
    s_sub_u32 s39, s39, 1
    s_cbranch_scc1 KS_ABORT
    s_waitcnt lgkmcnt(5)
    v_cmp_ne_u32 vcc, s84, v44
    s_cbranch_vccnz ZW_87
    s_waitcnt lgkmcnt(4)
    v_perm_b32 v60, v60, v60, v118
    v_perm_b32 v61, v61, v61, v118
    v_pk_add_f32 v[20:21], v[60:61], v[20:21]
    v_pk_mul_f32 v[42:43], v[20:21], v[20:21]
    v_pk_mul_f32 v[44:45], v[20:21], v[80:81]
    v_perm_b32 v62, v62, v62, v118
    v_perm_b32 v63, v63, v63, v118
    v_pk_add_f32 v[22:23], v[62:63], v[22:23]
    v_pk_fma_f32 v[42:43], v[22:23], v[22:23], v[42:43]
    v_pk_fma_f32 v[44:45], v[22:23], v[82:83], v[44:45]
    v_pk_add_f32 v[40:41], v[22:23], v[20:21]
    s_waitcnt lgkmcnt(3)
    v_perm_b32 v64, v64, v64, v118
    v_perm_b32 v65, v65, v65, v118
    v_pk_add_f32 v[24:25], v[64:65], v[24:25]
    v_pk_fma_f32 v[42:43], v[24:25], v[24:25], v[42:43]
    v_pk_fma_f32 v[44:45], v[24:25], v[84:85], v[44:45]
    v_pk_add_f32 v[40:41], v[24:25], v[40:41]
    v_perm_b32 v66, v66, v66, v118
    v_perm_b32 v67, v67, v67, v118
    v_pk_add_f32 v[26:27], v[66:67], v[26:27]
    v_pk_fma_f32 v[42:43], v[26:27], v[26:27], v[42:43]
    v_pk_fma_f32 v[44:45], v[26:27], v[86:87], v[44:45]
    v_pk_add_f32 v[40:41], v[26:27], v[40:41]
    s_waitcnt lgkmcnt(2)
    v_perm_b32 v68, v68, v68, v118
    v_perm_b32 v69, v69, v69, v118
    v_pk_add_f32 v[28:29], v[68:69], v[28:29]
    v_pk_fma_f32 v[42:43], v[28:29], v[28:29], v[42:43]
    v_pk_fma_f32 v[44:45], v[28:29], v[88:89], v[44:45]
    v_pk_add_f32 v[40:41], v[28:29], v[40:41]
    v_perm_b32 v70, v70, v70, v118
    v_perm_b32 v71, v71, v71, v118
    v_pk_add_f32 v[30:31], v[70:71], v[30:31]
    v_pk_fma_f32 v[42:43], v[30:31], v[30:31], v[42:43]
    v_pk_fma_f32 v[44:45], v[30:31], v[90:91], v[44:45]
    v_pk_add_f32 v[40:41], v[30:31], v[40:41]
    s_waitcnt lgkmcnt(1)
    v_perm_b32 v72, v72, v72, v118
    v_perm_b32 v73, v73, v73, v118
    v_pk_add_f32 v[32:33], v[72:73], v[32:33]
    v_pk_fma_f32 v[42:43], v[32:33], v[32:33], v[42:43]
    v_pk_fma_f32 v[44:45], v[32:33], v[92:93], v[44:45]
    v_pk_add_f32 v[40:41], v[32:33], v[40:41]
    v_perm_b32 v74, v74, v74, v118
    v_perm_b32 v75, v75, v75, v118
    v_pk_add_f32 v[34:35], v[74:75], v[34:35]
    v_pk_fma_f32 v[42:43], v[34:35], v[34:35], v[42:43]
    v_pk_fma_f32 v[44:45], v[34:35], v[94:95], v[44:45]
    v_pk_add_f32 v[40:41], v[34:35], v[40:41]
    s_waitcnt lgkmcnt(0)
    v_perm_b32 v76, v76, v76, v118
    v_perm_b32 v77, v77, v77, v118
    v_pk_add_f32 v[36:37], v[76:77], v[36:37]
    v_pk_fma_f32 v[42:43], v[36:37], v[36:37], v[42:43]
    v_pk_fma_f32 v[44:45], v[36:37], v[96:97], v[44:45]
    v_pk_add_f32 v[40:41], v[36:37], v[40:41]
    v_add_f32 v42, v42, v43
    v_add_f32 v44, v44, v45
    v_add_f32 v40, v40, v41
    v_mov_b32 v41, v40
    v_permlane16_swap_b32 v42, v44
    s_nop 0
    v_permlane16_swap_b32 v40, v41
    v_add_f32 v42, v42, v44
    v_add_f32 v40, v40, v41
    s_nop 0
    v_add_f32_dpp v42, v42, v42 row_ror:8 row_mask:0xf bank_mask:0xf
    v_add_f32_dpp v40, v40, v40 row_ror:8 row_mask:0xf bank_mask:0xf
    s_nop 0
    v_add_f32_dpp v42, v42, v42 row_ror:4 row_mask:0xf bank_mask:0xf
    v_add_f32_dpp v40, v40, v40 row_ror:4 row_mask:0xf bank_mask:0xf
    s_nop 0
    v_add_f32_dpp v42, v42, v42 row_ror:2 row_mask:0xf bank_mask:0xf
    v_add_f32_dpp v40, v40, v40 row_ror:2 row_mask:0xf bank_mask:0xf
    s_nop 0
    v_add_f32_dpp v42, v42, v42 row_ror:1 row_mask:0xf bank_mask:0xf
    v_add_f32_dpp v40, v40, v40 row_ror:1 row_mask:0xf bank_mask:0xf
    v_mul_f32 v40, 0x3ae38e39, v40
    v_mov_b32 v44, v42
    v_cvt_pk_bf16_f32 v41, 0, v40
    v_mul_f32 v40, v40, v40
    v_permlane16_swap_b32 v42, v44
    v_mov_b32 v43, 0x3ae38e39
    v_fma_f32 v42, v42, v43, -v40
    v_fma_f32 v44, -v41, v78, v44
    v_max_f32 v42, 0, v42
    v_cvt_pk_bf16_f32 v42, 0, v42
    v_add_f32 v42, 0x3727c5ac, v42
    v_cvt_pk_bf16_f32 v42, 0, v42
    v_sqrt_f32 v42, v42
    s_nop 0
    v_cvt_pk_bf16_f32 v42, 0, v42
    v_rcp_f32 v42, v42
    s_nop 0
    v_mul_f32 v60, v44, v42
    v_cvt_pk_bf16_f32 v60, v60, v60
    v_ashrrev_i32 v61, 31, v60
    v_or_b32 v61, 0x80000000, v61
    s_mov_b32 s95, 0xffff0000
    v_xor_b32 v60, v60, v61
    v_and_or_b32 v60, v60, s95, v98
    s_mov_b32 exec_lo, 1
    s_mov_b32 exec_hi, 1
    ds_write_b32 v99, v60 offset:800
    s_mov_b64 exec, -1
    s_setprio 2
    v_cvt_pk_bf16_f32 v20, 0, v20
    v_cvt_pk_bf16_f32 v21, 0, v21
    v_cvt_pk_bf16_f32 v22, 0, v22
    v_cvt_pk_bf16_f32 v23, 0, v23
    v_cvt_pk_bf16_f32 v24, 0, v24
    v_cvt_pk_bf16_f32 v25, 0, v25
    v_cvt_pk_bf16_f32 v26, 0, v26
    v_cvt_pk_bf16_f32 v27, 0, v27
    v_cvt_pk_bf16_f32 v28, 0, v28
    v_cvt_pk_bf16_f32 v29, 0, v29
    v_cvt_pk_bf16_f32 v30, 0, v30
    v_cvt_pk_bf16_f32 v31, 0, v31
    v_cvt_pk_bf16_f32 v32, 0, v32
    v_cvt_pk_bf16_f32 v33, 0, v33
    v_cvt_pk_bf16_f32 v34, 0, v34
    v_cvt_pk_bf16_f32 v35, 0, v35
    v_cvt_pk_bf16_f32 v36, 0, v36
    v_cvt_pk_bf16_f32 v37, 0, v37
    v_pk_add_f32 v[44:45], v[20:21], v[22:23]
    v_pk_add_f32 v[46:47], v[24:25], v[26:27]
    v_pk_add_f32 v[44:45], v[44:45], v[28:29]
    v_pk_add_f32 v[46:47], v[46:47], v[30:31]
    v_pk_add_f32 v[44:45], v[44:45], v[32:33]
    v_pk_add_f32 v[46:47], v[46:47], v[34:35]
    v_pk_add_f32 v[44:45], v[44:45], v[36:37]
    v_pk_add_f32 v[44:45], v[44:45], v[46:47]
    v_add_f32 v44, v44, v45
    s_nop 1
    v_add_f32_dpp v44, v44, v44 row_ror:8 row_mask:0xf bank_mask:0xf
    s_nop 1
    v_add_f32_dpp v44, v44, v44 row_ror:4 row_mask:0xf bank_mask:0xf
    s_nop 1
    v_add_f32_dpp v44, v44, v44 row_ror:2 row_mask:0xf bank_mask:0xf
    s_nop 1
    v_add_f32_dpp v44, v44, v44 row_ror:1 row_mask:0xf bank_mask:0xf
    v_mov_b32 v46, v44
    s_nop 1
    v_permlane16_swap_b32 v44, v46
    v_add_f32 v44, v44, v46
    v_mul_f32 v48, 0x3ae38e39, v44
    v_mov_b32 v49, v48
    v_cvt_pk_bf16_f32 v40, 0, v48
    v_cvt_pk_bf16_f32 v41, 0, v48
    v_pk_add_f32 v[42:43], v[20:21], v[48:49] neg_lo:[0,1] neg_hi:[0,1]
    v_pk_mul_f32 v[44:45], v[42:43], v[42:43]
    v_pk_add_f32 v[42:43], v[22:23], v[48:49] neg_lo:[0,1] neg_hi:[0,1]
    v_pk_mul_f32 v[46:47], v[42:43], v[42:43]
    v_pk_add_f32 v[42:43], v[24:25], v[48:49] neg_lo:[0,1] neg_hi:[0,1]
    v_pk_fma_f32 v[44:45], v[42:43], v[42:43], v[44:45]
    v_pk_add_f32 v[42:43], v[26:27], v[48:49] neg_lo:[0,1] neg_hi:[0,1]
    v_pk_fma_f32 v[46:47], v[42:43], v[42:43], v[46:47]
    v_pk_add_f32 v[42:43], v[28:29], v[48:49] neg_lo:[0,1] neg_hi:[0,1]
    v_pk_fma_f32 v[44:45], v[42:43], v[42:43], v[44:45]
    v_pk_add_f32 v[42:43], v[30:31], v[48:49] neg_lo:[0,1] neg_hi:[0,1]
    v_pk_fma_f32 v[46:47], v[42:43], v[42:43], v[46:47]
    v_pk_add_f32 v[42:43], v[32:33], v[48:49] neg_lo:[0,1] neg_hi:[0,1]
    v_pk_fma_f32 v[44:45], v[42:43], v[42:43], v[44:45]
    v_pk_add_f32 v[42:43], v[34:35], v[48:49] neg_lo:[0,1] neg_hi:[0,1]
    v_pk_fma_f32 v[46:47], v[42:43], v[42:43], v[46:47]
    v_pk_add_f32 v[42:43], v[36:37], v[48:49] neg_lo:[0,1] neg_hi:[0,1]
    v_pk_fma_f32 v[44:45], v[42:43], v[42:43], v[44:45]
    v_pk_add_f32 v[44:45], v[44:45], v[46:47]
    v_add_f32 v44, v44, v45
    s_nop 1
    v_add_f32_dpp v44, v44, v44 row_ror:8 row_mask:0xf bank_mask:0xf
    s_nop 1
    v_add_f32_dpp v44, v44, v44 row_ror:4 row_mask:0xf bank_mask:0xf
    s_nop 1
    v_add_f32_dpp v44, v44, v44 row_ror:2 row_mask:0xf bank_mask:0xf
    s_nop 1
    v_add_f32_dpp v44, v44, v44 row_ror:1 row_mask:0xf bank_mask:0xf
    v_mov_b32 v46, v44
    s_nop 1
    v_permlane16_swap_b32 v44, v46
    v_add_f32 v44, v44, v46
    v_mul_f32 v44, 0x3ae38e39, v44
    v_cvt_pk_bf16_f32 v44, 0, v44
    v_add_f32 v44, 0x3727c5ac, v44
    v_cvt_pk_bf16_f32 v44, 0, v44
    v_sqrt_f32 v44, v44
    s_nop 0
    v_cvt_pk_bf16_f32 v44, 0, v44
    v_rcp_f32 v42, v44
    s_nop 0
    v_mov_b32 v43, v42
    v_pk_add_f32 v[44:45], v[20:21], v[40:41] neg_lo:[0,1] neg_hi:[0,1]
    v_cvt_pk_bf16_f32 v44, 0, v44
    v_cvt_pk_bf16_f32 v45, 0, v45
    v_pk_mul_f32 v[44:45], v[44:45], v[42:43]
    v_cvt_pk_bf16_f32 v10, v44, v45
    v_cvt_pk_bf16_f32 v44, 0, v44
    v_cvt_pk_bf16_f32 v45, 0, v45
    v_pk_add_f32 v[20:21], v[44:45], v[20:21]
    v_pk_add_f32 v[44:45], v[22:23], v[40:41] neg_lo:[0,1] neg_hi:[0,1]
    v_cvt_pk_bf16_f32 v44, 0, v44
    v_cvt_pk_bf16_f32 v45, 0, v45
    v_pk_mul_f32 v[44:45], v[44:45], v[42:43]
    v_cvt_pk_bf16_f32 v11, v44, v45
    v_cvt_pk_bf16_f32 v44, 0, v44
    v_cvt_pk_bf16_f32 v45, 0, v45
    v_pk_add_f32 v[22:23], v[44:45], v[22:23]
    v_pk_add_f32 v[44:45], v[24:25], v[40:41] neg_lo:[0,1] neg_hi:[0,1]
    v_cvt_pk_bf16_f32 v44, 0, v44
    v_cvt_pk_bf16_f32 v45, 0, v45
    v_pk_mul_f32 v[44:45], v[44:45], v[42:43]
    v_cvt_pk_bf16_f32 v12, v44, v45
    v_cvt_pk_bf16_f32 v44, 0, v44
    v_cvt_pk_bf16_f32 v45, 0, v45
    v_pk_add_f32 v[24:25], v[44:45], v[24:25]
    v_pk_add_f32 v[44:45], v[26:27], v[40:41] neg_lo:[0,1] neg_hi:[0,1]
    v_cvt_pk_bf16_f32 v44, 0, v44
    v_cvt_pk_bf16_f32 v45, 0, v45
    v_pk_mul_f32 v[44:45], v[44:45], v[42:43]
    v_cvt_pk_bf16_f32 v13, v44, v45
    v_cvt_pk_bf16_f32 v44, 0, v44
    v_cvt_pk_bf16_f32 v45, 0, v45
    v_pk_add_f32 v[26:27], v[44:45], v[26:27]
    v_pk_add_f32 v[44:45], v[28:29], v[40:41] neg_lo:[0,1] neg_hi:[0,1]
    v_cvt_pk_bf16_f32 v44, 0, v44
    v_cvt_pk_bf16_f32 v45, 0, v45
    v_pk_mul_f32 v[44:45], v[44:45], v[42:43]
    v_cvt_pk_bf16_f32 v14, v44, v45
    v_cvt_pk_bf16_f32 v44, 0, v44
    v_cvt_pk_bf16_f32 v45, 0, v45
    v_pk_add_f32 v[28:29], v[44:45], v[28:29]
    v_pk_add_f32 v[44:45], v[30:31], v[40:41] neg_lo:[0,1] neg_hi:[0,1]
    v_cvt_pk_bf16_f32 v44, 0, v44
    v_cvt_pk_bf16_f32 v45, 0, v45
    v_pk_mul_f32 v[44:45], v[44:45], v[42:43]
    v_cvt_pk_bf16_f32 v15, v44, v45
    v_cvt_pk_bf16_f32 v44, 0, v44
    v_cvt_pk_bf16_f32 v45, 0, v45
    v_pk_add_f32 v[30:31], v[44:45], v[30:31]
    v_pk_add_f32 v[44:45], v[32:33], v[40:41] neg_lo:[0,1] neg_hi:[0,1]
    v_cvt_pk_bf16_f32 v44, 0, v44
    v_cvt_pk_bf16_f32 v45, 0, v45
    v_pk_mul_f32 v[44:45], v[44:45], v[42:43]
    v_cvt_pk_bf16_f32 v16, v44, v45
    v_cvt_pk_bf16_f32 v44, 0, v44
    v_cvt_pk_bf16_f32 v45, 0, v45
    v_pk_add_f32 v[32:33], v[44:45], v[32:33]
    v_pk_add_f32 v[44:45], v[34:35], v[40:41] neg_lo:[0,1] neg_hi:[0,1]
    v_cvt_pk_bf16_f32 v44, 0, v44
    v_cvt_pk_bf16_f32 v45, 0, v45
    v_pk_mul_f32 v[44:45], v[44:45], v[42:43]
    v_cvt_pk_bf16_f32 v17, v44, v45
    v_cvt_pk_bf16_f32 v44, 0, v44
    v_cvt_pk_bf16_f32 v45, 0, v45
    v_pk_add_f32 v[34:35], v[44:45], v[34:35]
    v_pk_add_f32 v[44:45], v[36:37], v[40:41] neg_lo:[0,1] neg_hi:[0,1]
    v_cvt_pk_bf16_f32 v44, 0, v44
    v_cvt_pk_bf16_f32 v45, 0, v45
    v_pk_mul_f32 v[44:45], v[44:45], v[42:43]
    v_cvt_pk_bf16_f32 v18, v44, v45
    v_cvt_pk_bf16_f32 v44, 0, v44
    v_cvt_pk_bf16_f32 v45, 0, v45
    v_pk_add_f32 v[36:37], v[44:45], v[36:37]
    v_cvt_pk_bf16_f32 v58, v36, v37
    ds_write_b32 v108, v18
    ds_write_b32 v108, v58 offset:256
    ds_read_b128 v[64:67], v109
    buffer_store_dwordx4 v[10:13], v115, s[72:75], 0 offen sc1
    buffer_store_dwordx4 v[14:17], v115, s[72:75], 0 offen offset:512 sc1
    v_cvt_pk_bf16_f32 v50, v20, v21
    v_cvt_pk_bf16_f32 v51, v22, v23
    v_cvt_pk_bf16_f32 v52, v24, v25
    v_cvt_pk_bf16_f32 v53, v26, v27
    v_cvt_pk_bf16_f32 v54, v28, v29
    v_cvt_pk_bf16_f32 v55, v30, v31
    v_cvt_pk_bf16_f32 v56, v32, v33
    v_cvt_pk_bf16_f32 v57, v34, v35
    s_mov_b64 exec, 0xffff
    s_waitcnt lgkmcnt(0)
    buffer_store_dwordx4 v[64:67], v111, s[72:75], 0 offen offset:1024 sc1
    s_mov_b64 exec, 0xffff0000
    buffer_store_dwordx4 v[64:67], v111, s[68:71], 0 offen offset:1024 sc1
    s_mov_b64 exec, -1
    buffer_store_dwordx4 v[50:53], v115, s[68:71], 0 offen sc1
    buffer_store_dwordx4 v[54:57], v115, s[68:71], 0 offen offset:512 sc1
    s_waitcnt vmcnt(0)
    s_mov_b64 exec, 1
    ds_add_rtn_u32 v62, v4, v5 offset:176
    s_waitcnt lgkmcnt(0)
    v_cmp_eq_u32 vcc, 3, v62
    s_and_b64 exec, exec, vcc
    s_cbranch_execz KS_NOF2
    s_lshl_b32 s92, s2, 4
    s_add_u32 s92, s92, 8192
    buffer_store_dword v5, v4, s[76:79], s92 offen sc1
KS_NOF2:
    s_mov_b64 exec, -1
    s_setprio 0
    s_cmp_lt_u32 s41, 18
    s_cbranch_scc1 KS_B
    s_waitcnt lgkmcnt(0)
    s_endpgm
KS_T:
    s_setprio 0
    s_cmp_ge_u32 s38, 10
    s_cbranch_scc1 KS_P
    v_and_b32 v6, 1, v1
    v_subrev_u32 v6, 1, v6
    v_and_b32 v7, 7, v1
    v_lshlrev_b32 v7, 2, v7
    s_add_u32 s76, s36, 0x840000
    s_addc_u32 s77, s37, 0
    s_mov_b32 s78, 0x3000
    s_mov_b32 s79, 0x20000
    s_cmp_eq_u32 s38, 9
    s_cbranch_scc1 KS_W9
    s_cmp_eq_u32 s38, 8
    s_cbranch_scc1 KS_L2W
    s_sub_u32 s93, s38, 4
    s_lshl_b32 s92, s93, 10
    v_lshl_add_u32 v33, v1, 4, s92
    s_movk_i32 s92, 4096
    s_lshl_b32 s93, s93, 7
    v_lshlrev_b32 v32, 4, v2
    v_lshl_add_u32 v32, v3, 5, v32
    v_add_u32 v32, s93, v32
W_88:
    s_sleep 1
    ds_read_b32 v8, v4 offset:24
    s_sub_u32 s39, s39, 1
    s_cbranch_scc1 KS_ABORT
    s_waitcnt lgkmcnt(0)
    v_cmp_eq_u32 vcc, 0, v8
    s_cbranch_vccnz W_88
    s_setprio 2
    s_sleep 12
    s_branch ZPE_90
ZP_89:
    s_sleep 4
ZPE_90:
    buffer_load_dwordx4 v[8:11], v33, s[76:79], 0 offen sc1
    buffer_load_dwordx4 v[12:15], v33, s[76:79], s92 offen sc1
    s_sub_u32 s39, s39, 1
    s_cbranch_scc1 KS_ABORT
    s_waitcnt vmcnt(0)
    v_max3_u32 v44, v8, v9, v10
    v_max3_u32 v44, v44, v11, v12
    v_max3_u32 v44, v44, v13, v14
    v_max_u32 v44, v44, v15
    v_cmp_eq_u32 vcc, -1, v44
    s_cbranch_vccnz ZP_89
    ds_write_b32 v4, v5 offset:196
    v_max_u32 v16, v8, v9
    v_min_u32 v9, v8, v9
    v_max_u32 v17, v12, v13
    v_min_u32 v13, v12, v13
    v_max_u32 v18, v10, v11
    v_min_u32 v11, v10, v11
    v_max_u32 v19, v14, v15
    v_min_u32 v15, v14, v15
    v_max_u32 v20, v16, v18
    v_min_u32 v18, v16, v18
    v_max_u32 v21, v17, v19
    v_min_u32 v19, v17, v19
    v_max_u32 v22, v9, v11
    v_min_u32 v11, v9, v11
    v_max_u32 v23, v13, v15
    v_min_u32 v15, v13, v15
    v_max_u32 v24, v22, v18
    v_min_u32 v18, v22, v18
    v_max_u32 v25, v23, v19
    v_min_u32 v19, v23, v19
    v_mov_b32_dpp v26, v11 quad_perm:[1,0,3,2] row_mask:0xf bank_mask:0xf
    v_mov_b32_dpp v27, v18 quad_perm:[1,0,3,2] row_mask:0xf bank_mask:0xf
    v_mov_b32_dpp v8, v24 quad_perm:[1,0,3,2] row_mask:0xf bank_mask:0xf
    v_mov_b32_dpp v12, v20 quad_perm:[1,0,3,2] row_mask:0xf bank_mask:0xf
    v_med3_u32 v26, v20, v26, v6
    v_med3_u32 v27, v24, v27, v6
    v_med3_u32 v8, v18, v8, v6
    v_med3_u32 v12, v11, v12, v6
    v_max_u32 v10, v26, v8
    v_min_u32 v8, v26, v8
    v_max_u32 v14, v27, v12
    v_min_u32 v12, v27, v12
    v_max_u32 v16, v10, v14
    v_min_u32 v14, v10, v14
    v_max_u32 v17, v8, v12
    v_min_u32 v12, v8, v12
    v_mov_b32_dpp v9, v15 quad_perm:[1,0,3,2] row_mask:0xf bank_mask:0xf
    v_mov_b32_dpp v13, v19 quad_perm:[1,0,3,2] row_mask:0xf bank_mask:0xf
    v_mov_b32_dpp v22, v25 quad_perm:[1,0,3,2] row_mask:0xf bank_mask:0xf
    v_mov_b32_dpp v23, v21 quad_perm:[1,0,3,2] row_mask:0xf bank_mask:0xf
    v_med3_u32 v9, v21, v9, v6
    v_med3_u32 v13, v25, v13, v6
    v_med3_u32 v22, v19, v22, v6
    v_med3_u32 v23, v15, v23, v6
    v_max_u32 v20, v9, v22
    v_min_u32 v22, v9, v22
    v_max_u32 v24, v13, v23
    v_min_u32 v23, v13, v23
    v_max_u32 v18, v20, v24
    v_min_u32 v24, v20, v24
    v_max_u32 v11, v22, v23
    v_min_u32 v23, v22, v23
    s_nop 1
    v_max_u32_dpp v16, v23, v16 quad_perm:[1,0,3,2] row_mask:0xf bank_mask:0xf
    v_max_u32_dpp v14, v11, v14 quad_perm:[1,0,3,2] row_mask:0xf bank_mask:0xf
    v_max_u32_dpp v17, v24, v17 quad_perm:[1,0,3,2] row_mask:0xf bank_mask:0xf
    v_max_u32_dpp v12, v18, v12 quad_perm:[1,0,3,2] row_mask:0xf bank_mask:0xf
    v_mov_b32_dpp v26, v16 quad_perm:[1,0,3,2] row_mask:0xf bank_mask:0xf
    v_mov_b32_dpp v27, v14 quad_perm:[1,0,3,2] row_mask:0xf bank_mask:0xf
    v_mov_b32_dpp v10, v17 quad_perm:[1,0,3,2] row_mask:0xf bank_mask:0xf
    v_mov_b32_dpp v8, v12 quad_perm:[1,0,3,2] row_mask:0xf bank_mask:0xf
    v_med3_u32 v26, v16, v26, v6
    v_med3_u32 v27, v14, v27, v6
    v_med3_u32 v10, v17, v10, v6
    v_med3_u32 v8, v12, v8, v6
    v_max_u32 v21, v26, v10
    v_min_u32 v10, v26, v10
    v_max_u32 v25, v27, v8
    v_min_u32 v8, v27, v8
    v_max_u32 v19, v21, v25
    v_min_u32 v25, v21, v25
    v_max_u32 v15, v10, v8
    v_min_u32 v8, v10, v8
    s_nop 1
    v_max_u32_dpp v9, v8, v19 quad_perm:[3,2,1,0] row_mask:0xf bank_mask:0xf
    v_max_u32_dpp v13, v15, v25 quad_perm:[3,2,1,0] row_mask:0xf bank_mask:0xf
    v_max_u32_dpp v20, v25, v15 quad_perm:[3,2,1,0] row_mask:0xf bank_mask:0xf
    v_max_u32_dpp v22, v19, v8 quad_perm:[3,2,1,0] row_mask:0xf bank_mask:0xf
    v_mov_b32_dpp v18, v9 quad_perm:[1,0,3,2] row_mask:0xf bank_mask:0xf
    v_mov_b32_dpp v24, v13 quad_perm:[1,0,3,2] row_mask:0xf bank_mask:0xf
    v_mov_b32_dpp v11, v20 quad_perm:[1,0,3,2] row_mask:0xf bank_mask:0xf
    v_mov_b32_dpp v23, v22 quad_perm:[1,0,3,2] row_mask:0xf bank_mask:0xf
    v_med3_u32 v18, v9, v18, v6
    v_med3_u32 v24, v13, v24, v6
    v_med3_u32 v11, v20, v11, v6
    v_med3_u32 v23, v22, v23, v6
    v_max_u32 v16, v18, v11
    v_min_u32 v11, v18, v11
    v_max_u32 v14, v24, v23
    v_min_u32 v23, v24, v23
    v_max_u32 v17, v16, v14
    v_min_u32 v14, v16, v14
    v_max_u32 v12, v11, v23
    v_min_u32 v23, v11, v23
    s_nop 1
    v_max_u32_dpp v26, v23, v17 row_half_mirror row_mask:0xf bank_mask:0xf
    v_max_u32_dpp v27, v12, v14 row_half_mirror row_mask:0xf bank_mask:0xf
    v_max_u32_dpp v21, v14, v12 row_half_mirror row_mask:0xf bank_mask:0xf
    v_max_u32_dpp v10, v17, v23 row_half_mirror row_mask:0xf bank_mask:0xf
    v_mov_b32_dpp v19, v26 quad_perm:[1,0,3,2] row_mask:0xf bank_mask:0xf
    v_mov_b32_dpp v25, v27 quad_perm:[1,0,3,2] row_mask:0xf bank_mask:0xf
    v_mov_b32_dpp v15, v21 quad_perm:[1,0,3,2] row_mask:0xf bank_mask:0xf
    v_mov_b32_dpp v8, v10 quad_perm:[1,0,3,2] row_mask:0xf bank_mask:0xf
    v_med3_u32 v19, v26, v19, v6
    v_med3_u32 v25, v27, v25, v6
    v_med3_u32 v15, v21, v15, v6
    v_med3_u32 v8, v10, v8, v6
    v_max_u32 v9, v19, v15
    v_min_u32 v15, v19, v15
    v_max_u32 v13, v25, v8
    v_min_u32 v8, v25, v8
    v_max_u32 v20, v9, v13
    v_min_u32 v13, v9, v13
    v_max_u32 v22, v15, v8
    v_min_u32 v8, v15, v8
    s_nop 1
    v_max_u32_dpp v18, v8, v20 row_mirror row_mask:0xf bank_mask:0xf
    v_max_u32_dpp v24, v22, v13 row_mirror row_mask:0xf bank_mask:0xf
    v_max_u32_dpp v16, v13, v22 row_mirror row_mask:0xf bank_mask:0xf
    v_max_u32_dpp v11, v20, v8 row_mirror row_mask:0xf bank_mask:0xf
    v_mov_b32_dpp v17, v18 quad_perm:[1,0,3,2] row_mask:0xf bank_mask:0xf
    v_mov_b32_dpp v14, v24 quad_perm:[1,0,3,2] row_mask:0xf bank_mask:0xf
    v_mov_b32_dpp v12, v16 quad_perm:[1,0,3,2] row_mask:0xf bank_mask:0xf
    v_mov_b32_dpp v23, v11 quad_perm:[1,0,3,2] row_mask:0xf bank_mask:0xf
    v_med3_u32 v17, v18, v17, v6
    v_med3_u32 v14, v24, v14, v6
    v_med3_u32 v12, v16, v12, v6
    v_med3_u32 v23, v11, v23, v6
    v_max_u32 v26, v17, v12
    v_min_u32 v12, v17, v12
    v_max_u32 v27, v14, v23
    v_min_u32 v23, v14, v23
    v_max_u32 v21, v26, v27
    v_min_u32 v27, v26, v27
    v_max_u32 v10, v12, v23
    v_min_u32 v23, v12, v23
    v_mov_b32 v28, v21
    v_mov_b32 v29, v27
    v_mov_b32 v30, v10
    v_mov_b32 v31, v23
    s_mov_b32 exec_lo, 0x00030003
    s_mov_b32 exec_hi, 0x00030003
    ds_write_b128 v32, v[28:31] offset:256
    s_mov_b64 exec, -1
    s_setprio 0
    s_branch KS_B
KS_L2W:
    s_mov_b32 s72, s36
    s_mov_b32 s73, s37
    s_mov_b32 s74, 0x240000
    s_mov_b32 s75, 0x20000
    s_mov_b32 s92, 0xcccccccc
    s_mov_b32 s93, 0xcccccccc
    s_mov_b32 s94, 0xf0f0f0f0
    s_mov_b32 s95, 0xf0f0f0f0
    s_movk_i32 s96, 1152
    v_lshrrev_b32 v34, 3, v1
    v_lshlrev_b32 v34, 4, v34
    v_lshlrev_b32 v33, 4, v2
W_91:
    s_sleep 1
    ds_read_b32 v8, v4 offset:24
    s_sub_u32 s39, s39, 1
    s_cbranch_scc1 KS_ABORT
    s_waitcnt lgkmcnt(0)
    v_cmp_eq_u32 vcc, 0, v8
    s_cbranch_vccnz W_91
    s_setprio 2
KS_L2POLL:
    ds_read_b128 v[8:11], v33 offset:256
    ds_read_b128 v[12:15], v33 offset:512
    s_sub_u32 s39, s39, 1
    s_cbranch_scc1 KS_ABORT
    s_waitcnt lgkmcnt(0)
    v_min3_u32 v16, v8, v9, v10
    v_min3_u32 v17, v11, v12, v13
    v_min3_u32 v16, v16, v14, v15
    v_min_u32 v16, v16, v17
    v_cmp_eq_u32 vcc, 0, v16
    s_cbranch_vccnz KS_L2POLL
    v_max_u32_dpp v8, v15, v8 quad_perm:[1,0,3,2] row_mask:0xf bank_mask:0xf
    v_max_u32_dpp v9, v14, v9 quad_perm:[1,0,3,2] row_mask:0xf bank_mask:0xf
    v_max_u32_dpp v10, v13, v10 quad_perm:[1,0,3,2] row_mask:0xf bank_mask:0xf
    v_max_u32_dpp v11, v12, v11 quad_perm:[1,0,3,2] row_mask:0xf bank_mask:0xf
    v_mov_b32_dpp v16, v8 quad_perm:[1,0,3,2] row_mask:0xf bank_mask:0xf
    v_mov_b32_dpp v17, v9 quad_perm:[1,0,3,2] row_mask:0xf bank_mask:0xf
    v_mov_b32_dpp v18, v10 quad_perm:[1,0,3,2] row_mask:0xf bank_mask:0xf
    v_mov_b32_dpp v19, v11 quad_perm:[1,0,3,2] row_mask:0xf bank_mask:0xf
    v_med3_u32 v16, v8, v16, v6
    v_med3_u32 v17, v9, v17, v6
    v_med3_u32 v18, v10, v18, v6
    v_med3_u32 v19, v11, v19, v6
    v_max_u32 v20, v16, v18
    v_min_u32 v18, v16, v18
    v_max_u32 v21, v17, v19
    v_min_u32 v19, v17, v19
    v_max_u32 v22, v20, v21
    v_min_u32 v21, v20, v21
    v_max_u32 v23, v18, v19
    v_min_u32 v19, v18, v19
    s_nop 1
    v_max_u32_dpp v24, v19, v22 quad_perm:[3,2,1,0] row_mask:0xf bank_mask:0xf
    v_max_u32_dpp v25, v23, v21 quad_perm:[3,2,1,0] row_mask:0xf bank_mask:0xf
    v_max_u32_dpp v26, v21, v23 quad_perm:[3,2,1,0] row_mask:0xf bank_mask:0xf
    v_max_u32_dpp v27, v22, v19 quad_perm:[3,2,1,0] row_mask:0xf bank_mask:0xf
    v_mov_b32_dpp v12, v24 quad_perm:[1,0,3,2] row_mask:0xf bank_mask:0xf
    v_mov_b32_dpp v13, v25 quad_perm:[1,0,3,2] row_mask:0xf bank_mask:0xf
    v_mov_b32_dpp v14, v26 quad_perm:[1,0,3,2] row_mask:0xf bank_mask:0xf
    v_mov_b32_dpp v15, v27 quad_perm:[1,0,3,2] row_mask:0xf bank_mask:0xf
    v_med3_u32 v12, v24, v12, v6
    v_med3_u32 v13, v25, v13, v6
    v_med3_u32 v14, v26, v14, v6
    v_med3_u32 v15, v27, v15, v6
    v_max_u32 v8, v12, v14
    v_min_u32 v14, v12, v14
    v_max_u32 v9, v13, v15
    v_min_u32 v15, v13, v15
    v_max_u32 v10, v8, v9
    v_min_u32 v9, v8, v9
    v_max_u32 v11, v14, v15
    v_min_u32 v15, v14, v15
    s_nop 1
    v_max_u32_dpp v16, v15, v10 row_half_mirror row_mask:0xf bank_mask:0xf
    v_max_u32_dpp v17, v11, v9 row_half_mirror row_mask:0xf bank_mask:0xf
    v_max_u32_dpp v20, v9, v11 row_half_mirror row_mask:0xf bank_mask:0xf
    v_max_u32_dpp v18, v10, v15 row_half_mirror row_mask:0xf bank_mask:0xf
    v_mov_b32_dpp v22, v16 quad_perm:[1,0,3,2] row_mask:0xf bank_mask:0xf
    v_mov_b32_dpp v21, v17 quad_perm:[1,0,3,2] row_mask:0xf bank_mask:0xf
    v_mov_b32_dpp v23, v20 quad_perm:[1,0,3,2] row_mask:0xf bank_mask:0xf
    v_mov_b32_dpp v19, v18 quad_perm:[1,0,3,2] row_mask:0xf bank_mask:0xf
    v_med3_u32 v22, v16, v22, v6
    v_med3_u32 v21, v17, v21, v6
    v_med3_u32 v23, v20, v23, v6
    v_med3_u32 v19, v18, v19, v6
    v_max_u32 v24, v22, v23
    v_min_u32 v23, v22, v23
    v_max_u32 v25, v21, v19
    v_min_u32 v19, v21, v19
    v_max_u32 v26, v24, v25
    v_min_u32 v25, v24, v25
    v_max_u32 v27, v23, v19
    v_min_u32 v19, v23, v19
    s_nop 1
    v_max_u32_dpp v12, v19, v26 row_mirror row_mask:0xf bank_mask:0xf
    v_max_u32_dpp v13, v27, v25 row_mirror row_mask:0xf bank_mask:0xf
    v_max_u32_dpp v8, v25, v27 row_mirror row_mask:0xf bank_mask:0xf
    v_max_u32_dpp v14, v26, v19 row_mirror row_mask:0xf bank_mask:0xf
    v_cndmask_b32 v30, v12, v13, s[92:93]
    v_cndmask_b32 v31, v8, v14, s[92:93]
    v_cndmask_b32 v30, v30, v31, s[94:95]
    s_nop 1
    v_mov_b32_dpp v30, v30 row_shr:8 row_mask:0xf bank_mask:0xc
    v_and_b32 v31, 0x7ff, v30
    v_sub_u32 v31, 2047, v31
    v_mad_u32_u24 v31, v31, s96, v34
    s_mov_b32 m0, 17088
    s_nop 0
    buffer_load_dwordx4 v31, s[72:75], 0 offen offset:0 sc1 lds
    s_mov_b32 m0, 17984
    s_nop 0
    buffer_load_dwordx4 v31, s[72:75], 0 offen offset:128 sc1 lds
    s_mov_b32 m0, 18880
    s_nop 0
    buffer_load_dwordx4 v31, s[72:75], 0 offen offset:256 sc1 lds
    s_mov_b32 m0, 19776
    s_nop 0
    buffer_load_dwordx4 v31, s[72:75], 0 offen offset:384 sc1 lds
    s_mov_b32 m0, 20672
    s_nop 0
    buffer_load_dwordx4 v31, s[72:75], 0 offen offset:512 sc1 lds
    s_mov_b32 m0, 21568
    s_nop 0
    buffer_load_dwordx4 v31, s[72:75], 0 offen offset:640 sc1 lds
    s_mov_b32 m0, 22464
    s_nop 0
    buffer_load_dwordx4 v31, s[72:75], 0 offen offset:768 sc1 lds
    s_mov_b32 m0, 23360
    s_nop 0
    buffer_load_dwordx4 v31, s[72:75], 0 offen offset:896 sc1 lds
    s_mov_b32 m0, 24256
    s_nop 0
    buffer_load_dwordx4 v31, s[72:75], 0 offen offset:1024 sc1 lds
    ds_write_b32 v7, v30 offset:768
    s_waitcnt vmcnt(0)
    ds_write_b32 v4, v5 offset:32
    s_setprio 0
    s_branch KS_B
KS_W9:
    v_lshlrev_b32 v33, 4, v1
    s_movk_i32 s92, 0x2000
    s_mov_b32 s72, s36
    s_mov_b32 s73, s37
    s_mov_b32 s74, 0x240000
    s_mov_b32 s75, 0x20000
    s_add_u32 s64, s36, 0x600000
    s_addc_u32 s65, s37, 0
    s_mov_b32 s66, 0x240000
    s_mov_b32 s67, 0x20000
    s_mov_b32 s68, s4
    s_mov_b32 s69, s5
    s_mov_b32 s70, 0x240000
    s_mov_b32 s71, 0x20000
    v_bfe_u32 v43, v1, 2, 3
    s_lshl_b32 s93, s89, 3
    v_add_u32 v43, s93, v43
    v_bfe_u32 v40, v43, 4, 1
    v_and_b32 v41, 3, v1
    v_lshl_add_u32 v40, v40, 2, v41
    v_lshlrev_b32 v40, 2, v40
    v_lshrrev_b32 v41, 5, v43
    v_lshlrev_b32 v41, 4, v41
    v_and_b32 v42, 15, v43
    v_add_u32 v41, v41, v42
W_92:
    s_sleep 1
    ds_read_b32 v12, v7 offset:768
    s_sub_u32 s39, s39, 1
    s_cbranch_scc1 KS_ABORT
    s_waitcnt lgkmcnt(0)
    v_cmp_eq_u32 vcc, 0, v12
    s_cbranch_vccnz W_92
    ds_read_b32 v19, v40 offset:768
    s_waitcnt lgkmcnt(0)
    v_and_b32 v14, 0x7ff, v19
    v_sub_u32 v14, 2047, v14
    v_mul_u32_u24 v23, 1152, v14
    v_lshl_add_u32 v23, v41, 1, v23
    buffer_load_ushort v17, v23, s[68:71], 0 offen
    v_lshrrev_b32 v15, 9, v14
    v_bfe_u32 v16, v14, 6, 2
    v_lshl_add_u32 v15, v15, 2, v16
    v_bfe_u32 v16, v14, 2, 2
    v_lshl_add_u32 v15, v15, 2, v16
    v_bfe_u32 v16, v14, 4, 1
    v_bfe_u32 v24, v14, 8, 1
    v_and_b32 v25, 3, v14
    v_lshl_add_u32 v24, v24, 2, v25
    v_lshlrev_b32 v24, 1, v24
    v_bfe_u32 v25, v14, 5, 1
    v_lshl_add_u32 v24, v25, 5, v24
    v_lshl_add_u32 v25, v15, 1, v16
    v_lshl_add_u32 v25, v25, 14, v24
    v_lshrrev_b32 v26, 1, v41
    v_lshl_add_u32 v25, v26, 6, v25
    v_xor_b32 v26, v41, v16
    v_not_b32 v26, v26
    v_and_b32 v26, 1, v26
    v_lshl_add_u32 v25, v26, 4, v25
    v_lshl_add_u32 v26, v15, 12, v24
    v_lshl_add_u32 v26, v16, 4, v26
    v_lshl_add_u32 v26, v41, 6, v26
    v_add_u32 v26, 2064384, v26
    v_lshl_add_u32 v27, v16, 6, v15
    v_lshlrev_b32 v27, 7, v27
    v_xor_b32 v25, v27, v25
    v_and_b32 v27, 0xf80, v27
    v_xor_b32 v26, v27, v26
    v_cmp_gt_u32 vcc, 0x200, v41
    s_nop 1
    v_cndmask_b32 v25, v26, v25, vcc
    buffer_load_ushort v18, v25, s[64:67], 0 offen sc1
    v_ashrrev_i32 v22, 31, v19
    v_not_b32 v22, v22
    v_or_b32 v22, 0x80000000, v22
    v_xor_b32 v22, v19, v22
    v_and_b32 v22, 0xffff0000, v22
    v_mul_f32 v22, 0xbfb8aa3b, v22
    v_exp_f32 v22, v22
    s_nop 0
    v_add_f32 v22, 1.0, v22
    v_rcp_f32 v22, v22
    s_nop 0
    v_cvt_pk_bf16_f32 v22, 0, v22
    v_and_b32 v14, 31, v1
    v_lshlrev_b32 v14, 4, v14
    s_barrier
    buffer_load_dword v8, v33, s[76:79], s92 offen offset:0 sc1
    buffer_load_dword v9, v33, s[76:79], s92 offen offset:1024 sc1
    buffer_load_dword v10, v33, s[76:79], s92 offen offset:2048 sc1
    buffer_load_dword v11, v33, s[76:79], s92 offen offset:3072 sc1
    s_barrier
    s_branch ZPE_94
ZP_93:
    s_sleep 4
    buffer_load_dword v8, v33, s[76:79], s92 offen offset:0 sc1
    buffer_load_dword v9, v33, s[76:79], s92 offen offset:1024 sc1
    buffer_load_dword v10, v33, s[76:79], s92 offen offset:2048 sc1
    buffer_load_dword v11, v33, s[76:79], s92 offen offset:3072 sc1
ZPE_94:
    s_sub_u32 s39, s39, 1
    s_cbranch_scc1 KS_ABORT
    s_waitcnt vmcnt(0)
    v_max3_u32 v44, v8, v9, v10
    v_max_u32 v44, v44, v11
    v_cmp_eq_u32 vcc, -1, v44
    s_cbranch_vccnz ZP_93
    buffer_load_ushort v20, v23, s[72:75], 0 offen sc1
    s_barrier
    s_add_u32 s72, s36, 0xb10000
    s_addc_u32 s73, s37, 0
    s_mov_b32 s74, 0x40
    s_mov_b32 s75, 0x20000
    s_waitcnt vmcnt(0)
    v_lshlrev_b32 v17, 16, v17
    v_lshlrev_b32 v18, 16, v18
    v_add_f32 v17, v17, v18
    v_cvt_pk_bf16_f32 v17, v17, v17
    v_and_b32 v21, 0xffff0000, v17
    v_lshlrev_b32 v20, 16, v20
    ds_write_b128 v14, v[20:23] offset:1536
    s_cmp_lg_u32 s2, 0
    s_cbranch_scc1 KS_W9E
    buffer_store_dword v12, v7, s[72:75], 0 offen
KS_W9E:
    s_waitcnt lgkmcnt(0)
    s_endpgm
KS_B:
    s_add_u32 s64, s36, 0x850000
    s_addc_u32 s65, s37, 0
    s_mov_b32 s66, 0x28c800
    s_mov_b32 s67, 0x20000
    v_bfe_u32 v16, v1, 2, 2
    v_lshl_add_u32 v16, v3, 3, v16
    v_mul_u32_u24 v16, 1152, v16
    v_and_b32 v17, 3, v1
    v_lshl_add_u32 v16, v17, 3, v16
    s_lshl_b32 s92, s38, 7
    s_add_u32 s92, s92, 109184
    v_add_u32 v16, s92, v16
    v_lshlrev_b32 v18, 2, v17
    ds_read_b32 v24, v18 offset:224
    s_movk_i32 s94, 0xff
W_95:
    ds_read_b32 v17, v4 offset:40
    s_sub_u32 s39, s39, 1
    s_cbranch_scc1 KS_ABORT
    s_waitcnt lgkmcnt(0)
    v_cmp_ne_u32 vcc, s84, v17
    s_cbranch_vccnz W_95
    v_lshrrev_b32 v25, 8, v24
    v_lshrrev_b32 v26, 16, v24
    v_lshrrev_b32 v27, 24, v24
    ds_read_b64_tr_b16 v[48:49], v16 offset:0
    ds_read_b64_tr_b16 v[50:51], v16 offset:4608
    ds_read_b64_tr_b16 v[52:53], v16 offset:32
    ds_read_b64_tr_b16 v[54:55], v16 offset:4640
    ds_read_b64_tr_b16 v[56:57], v16 offset:64
    ds_read_b64_tr_b16 v[58:59], v16 offset:4672
    ds_read_b64_tr_b16 v[60:61], v16 offset:96
    ds_read_b64_tr_b16 v[62:63], v16 offset:4704
    v_and_b32 v16, 7, v2
    v_lshlrev_b32 v16, 6, v16
    v_lshl_add_u32 v16, v3, 4, v16
    s_mul_i32 s92, s89, 18560
    s_lshl_b32 s93, s38, 11
    s_add_u32 s92, s92, s93
    v_lshlrev_b32 v17, 4, v1
    s_waitcnt lgkmcnt(0)
    s_barrier
    s_barrier
    ds_read_b128 v[20:23], v16 offset:1024
    s_waitcnt lgkmcnt(0)
    v_mfma_f32_16x16x32_bf16 v[32:35], v[20:23], v[48:51], 0
    v_mfma_f32_16x16x32_bf16 v[36:39], v[20:23], v[52:55], 0
    v_mfma_f32_16x16x32_bf16 v[40:43], v[20:23], v[56:59], 0
    v_mfma_f32_16x16x32_bf16 v[44:47], v[20:23], v[60:63], 0
    s_nop 5
    v_permlane32_swap_b32 v32, v36
    v_permlane32_swap_b32 v33, v37
    v_permlane32_swap_b32 v34, v38
    v_permlane32_swap_b32 v35, v39
    v_bfi_b32 v32, s94, v24, v32
    v_bfi_b32 v33, s94, v25, v33
    v_bfi_b32 v34, s94, v26, v34
    v_bfi_b32 v35, s94, v27, v35
    buffer_store_dwordx4 v[32:35], v17, s[64:67], s92 offen offset:0 sc1
    v_permlane32_swap_b32 v40, v44
    v_permlane32_swap_b32 v41, v45
    v_permlane32_swap_b32 v42, v46
    v_permlane32_swap_b32 v43, v47
    v_bfi_b32 v40, s94, v24, v40
    v_bfi_b32 v41, s94, v25, v41
    v_bfi_b32 v42, s94, v26, v42
    v_bfi_b32 v43, s94, v27, v43
    buffer_store_dwordx4 v[40:43], v17, s[64:67], s92 offen offset:1024 sc1
    s_waitcnt vmcnt(0)
    s_barrier
    s_endpgm
KS_G0:
    ds_write_b8 v15, v5 offset:68
    s_setprio 0
KS_G:
    s_mov_b32 s98, 0x05040100
    s_mov_b32 s99, 0x07060302
    s_waitcnt vmcnt(0)
    s_sub_u32 s87, s38, 12
    s_mul_i32 s92, s87, 9
    s_add_u32 s92, s92, 1
    s_lshr_b32 s86, s92, 1
    s_lshl_b32 s92, s86, 5
    v_lshl_add_u32 v7, v3, 3, s92
    v_mul_u32_u24 v7, 9216, v7
    v_and_b32 v6, 7, v2
    v_lshl_add_u32 v7, v6, 3, v7
    s_lshl_b32 s92, s89, 6
    v_add_u32 v7, s92, v7
    v_cmp_gt_u32 vcc, 8, v2
    s_mov_b32 s76, 9216
    s_mov_b32 s77, 0
    s_mov_b32 s78, 230400
    s_mov_b32 s79, 0
    v_mov_b32 v46, s26
    v_mov_b32 v47, s27
    v_mov_b32 v6, s28
    v_cndmask_b32 v46, v6, v46, vcc
    v_mov_b32 v6, s29
    v_cndmask_b32 v47, v6, v47, vcc
    v_add_co_u32 v46, vcc, v46, v7
    s_nop 1
    v_addc_co_u32 v47, vcc, 0, v47, vcc
    s_mov_b32 s68, s30
    s_mov_b32 s69, s31
    s_mov_b32 s70, 0x510000
    s_mov_b32 s71, 0x20000
    v_lshlrev_b32 v8, 4, v1
    s_mul_i32 s92, s89, 36864
    s_mul_i32 s93, s87, 9216
    s_add_u32 s92, s92, s93
    s_add_u32 s93, s93, 109184
    s_cmp_lt_u32 s41, 8
    s_cselect_b32 s94, 0, 100
    v_mov_b32 v9, s94
W_96:
    s_sleep 2
    ds_read_b32 v10, v9 offset:100
    s_sub_u32 s39, s39, 1
    s_cbranch_scc1 KS_ABORT
    s_waitcnt lgkmcnt(0)
    v_cmp_ne_u32 vcc, s84, v10
    s_cbranch_vccnz W_96
    s_cmp_ge_u32 s41, 8
    s_cbranch_scc1 KS_GD1
    s_add_u32 m0, s93, 0
    s_nop 0
    buffer_load_dwordx4 v8, s[68:71], s92 offen offset:0 nt lds
    buffer_load_dwordx4 v8, s[68:71], s92 offen offset:1024 nt lds
    buffer_load_dwordx4 v8, s[68:71], s92 offen offset:2048 nt lds
    buffer_load_dwordx4 v8, s[68:71], s92 offen offset:3072 nt lds
    s_add_u32 m0, s93, 4096
    s_add_u32 s92, s92, 4096
    buffer_load_dwordx4 v8, s[68:71], s92 offen offset:0 nt lds
    buffer_load_dwordx4 v8, s[68:71], s92 offen offset:1024 nt lds
    buffer_load_dwordx4 v8, s[68:71], s92 offen offset:2048 nt lds
    buffer_load_dwordx4 v8, s[68:71], s92 offen offset:3072 nt lds
    s_add_u32 m0, s93, 8192
    s_add_u32 s92, s92, 4096
    buffer_load_dwordx4 v8, s[68:71], s92 offen offset:0 nt lds
KS_GD1:
    s_lshr_b32 s92, 12, s87
    s_bitcmp1_b32 s92, 0
    s_cbranch_scc0 GT_97
W_98:
    s_sleep 2
    ds_read_b32 v10, v4 offset:52
    s_sub_u32 s39, s39, 1
    s_cbranch_scc1 KS_ABORT
    s_waitcnt lgkmcnt(0)
    v_cmp_ne_u32 vcc, s84, v10
    s_cbranch_vccnz W_98
    s_setprio 1
GT_97:
    s_lshr_b32 s92, 3, s87
    s_bitcmp1_b32 s92, 0
    s_cbranch_scc0 KS_GN0
    global_load_dwordx2 v[48:49], v[46:47], off nt
    v_lshl_add_u64 v[46:47], v[46:47], 0, s[76:77]
    global_load_dwordx2 v[50:51], v[46:47], off nt
    v_lshl_add_u64 v[46:47], v[46:47], 0, s[76:77]
    global_load_dwordx2 v[52:53], v[46:47], off nt
    v_lshl_add_u64 v[46:47], v[46:47], 0, s[76:77]
    global_load_dwordx2 v[54:55], v[46:47], off nt
    v_lshl_add_u64 v[46:47], v[46:47], 0, s[76:77]
    global_load_dwordx2 v[56:57], v[46:47], off nt
    v_lshl_add_u64 v[46:47], v[46:47], 0, s[76:77]
    global_load_dwordx2 v[58:59], v[46:47], off nt
    v_lshl_add_u64 v[46:47], v[46:47], 0, s[76:77]
    global_load_dwordx2 v[60:61], v[46:47], off nt
    v_lshl_add_u64 v[46:47], v[46:47], 0, s[76:77]
    global_load_dwordx2 v[62:63], v[46:47], off nt
    v_lshl_add_u64 v[46:47], v[46:47], 0, s[78:79]
    global_load_dwordx2 v[64:65], v[46:47], off nt
    v_lshl_add_u64 v[46:47], v[46:47], 0, s[76:77]
    global_load_dwordx2 v[66:67], v[46:47], off nt
    v_lshl_add_u64 v[46:47], v[46:47], 0, s[76:77]
    global_load_dwordx2 v[68:69], v[46:47], off nt
    v_lshl_add_u64 v[46:47], v[46:47], 0, s[76:77]
    global_load_dwordx2 v[70:71], v[46:47], off nt
    v_lshl_add_u64 v[46:47], v[46:47], 0, s[76:77]
    global_load_dwordx2 v[72:73], v[46:47], off nt
    v_lshl_add_u64 v[46:47], v[46:47], 0, s[76:77]
    global_load_dwordx2 v[74:75], v[46:47], off nt
    v_lshl_add_u64 v[46:47], v[46:47], 0, s[76:77]
    global_load_dwordx2 v[76:77], v[46:47], off nt
    v_lshl_add_u64 v[46:47], v[46:47], 0, s[76:77]
    global_load_dwordx2 v[78:79], v[46:47], off nt
    v_lshl_add_u64 v[46:47], v[46:47], 0, s[78:79]
    global_load_dwordx2 v[80:81], v[46:47], off nt
    v_lshl_add_u64 v[46:47], v[46:47], 0, s[76:77]
    global_load_dwordx2 v[82:83], v[46:47], off nt
    v_lshl_add_u64 v[46:47], v[46:47], 0, s[76:77]
    global_load_dwordx2 v[84:85], v[46:47], off nt
    v_lshl_add_u64 v[46:47], v[46:47], 0, s[76:77]
    global_load_dwordx2 v[86:87], v[46:47], off nt
    v_lshl_add_u64 v[46:47], v[46:47], 0, s[76:77]
    global_load_dwordx2 v[88:89], v[46:47], off nt
    v_lshl_add_u64 v[46:47], v[46:47], 0, s[76:77]
    global_load_dwordx2 v[90:91], v[46:47], off nt
    v_lshl_add_u64 v[46:47], v[46:47], 0, s[76:77]
    global_load_dwordx2 v[92:93], v[46:47], off nt
    v_lshl_add_u64 v[46:47], v[46:47], 0, s[76:77]
    global_load_dwordx2 v[94:95], v[46:47], off nt
    v_lshl_add_u64 v[46:47], v[46:47], 0, s[78:79]
    global_load_dwordx2 v[96:97], v[46:47], off nt
    v_lshl_add_u64 v[46:47], v[46:47], 0, s[76:77]
    global_load_dwordx2 v[98:99], v[46:47], off nt
    v_lshl_add_u64 v[46:47], v[46:47], 0, s[76:77]
    global_load_dwordx2 v[100:101], v[46:47], off nt
    v_lshl_add_u64 v[46:47], v[46:47], 0, s[76:77]
    global_load_dwordx2 v[102:103], v[46:47], off nt
    v_lshl_add_u64 v[46:47], v[46:47], 0, s[76:77]
    global_load_dwordx2 v[104:105], v[46:47], off nt
    v_lshl_add_u64 v[46:47], v[46:47], 0, s[76:77]
    global_load_dwordx2 v[106:107], v[46:47], off nt
    v_lshl_add_u64 v[46:47], v[46:47], 0, s[76:77]
    global_load_dwordx2 v[108:109], v[46:47], off nt
    v_lshl_add_u64 v[46:47], v[46:47], 0, s[76:77]
    global_load_dwordx2 v[110:111], v[46:47], off nt
    v_lshl_add_u64 v[46:47], v[46:47], 0, s[78:79]
    s_bitcmp1_b32 s87, 0
    s_cbranch_scc1 KS_G4
    global_load_dwordx2 v[112:113], v[46:47], off nt
    v_lshl_add_u64 v[46:47], v[46:47], 0, s[76:77]
    global_load_dwordx2 v[114:115], v[46:47], off nt
    v_lshl_add_u64 v[46:47], v[46:47], 0, s[76:77]
    global_load_dwordx2 v[116:117], v[46:47], off nt
    v_lshl_add_u64 v[46:47], v[46:47], 0, s[76:77]
    global_load_dwordx2 v[118:119], v[46:47], off nt
    v_lshl_add_u64 v[46:47], v[46:47], 0, s[76:77]
    global_load_dwordx2 v[120:121], v[46:47], off nt
    v_lshl_add_u64 v[46:47], v[46:47], 0, s[76:77]
    global_load_dwordx2 v[122:123], v[46:47], off nt
    v_lshl_add_u64 v[46:47], v[46:47], 0, s[76:77]
    global_load_dwordx2 v[124:125], v[46:47], off nt
    v_lshl_add_u64 v[46:47], v[46:47], 0, s[76:77]
    global_load_dwordx2 v[126:127], v[46:47], off nt
    s_branch KS_G4
KS_GN0:
    global_load_dwordx2 v[48:49], v[46:47], off
    v_lshl_add_u64 v[46:47], v[46:47], 0, s[76:77]
    global_load_dwordx2 v[50:51], v[46:47], off
    v_lshl_add_u64 v[46:47], v[46:47], 0, s[76:77]
    global_load_dwordx2 v[52:53], v[46:47], off
    v_lshl_add_u64 v[46:47], v[46:47], 0, s[76:77]
    global_load_dwordx2 v[54:55], v[46:47], off
    v_lshl_add_u64 v[46:47], v[46:47], 0, s[76:77]
    global_load_dwordx2 v[56:57], v[46:47], off
    v_lshl_add_u64 v[46:47], v[46:47], 0, s[76:77]
    global_load_dwordx2 v[58:59], v[46:47], off
    v_lshl_add_u64 v[46:47], v[46:47], 0, s[76:77]
    global_load_dwordx2 v[60:61], v[46:47], off
    v_lshl_add_u64 v[46:47], v[46:47], 0, s[76:77]
    global_load_dwordx2 v[62:63], v[46:47], off
    v_lshl_add_u64 v[46:47], v[46:47], 0, s[78:79]
    global_load_dwordx2 v[64:65], v[46:47], off
    v_lshl_add_u64 v[46:47], v[46:47], 0, s[76:77]
    global_load_dwordx2 v[66:67], v[46:47], off
    v_lshl_add_u64 v[46:47], v[46:47], 0, s[76:77]
    global_load_dwordx2 v[68:69], v[46:47], off
    v_lshl_add_u64 v[46:47], v[46:47], 0, s[76:77]
    global_load_dwordx2 v[70:71], v[46:47], off
    v_lshl_add_u64 v[46:47], v[46:47], 0, s[76:77]
    global_load_dwordx2 v[72:73], v[46:47], off
    v_lshl_add_u64 v[46:47], v[46:47], 0, s[76:77]
    global_load_dwordx2 v[74:75], v[46:47], off
    v_lshl_add_u64 v[46:47], v[46:47], 0, s[76:77]
    global_load_dwordx2 v[76:77], v[46:47], off
    v_lshl_add_u64 v[46:47], v[46:47], 0, s[76:77]
    global_load_dwordx2 v[78:79], v[46:47], off
    v_lshl_add_u64 v[46:47], v[46:47], 0, s[78:79]
    global_load_dwordx2 v[80:81], v[46:47], off
    v_lshl_add_u64 v[46:47], v[46:47], 0, s[76:77]
    global_load_dwordx2 v[82:83], v[46:47], off
    v_lshl_add_u64 v[46:47], v[46:47], 0, s[76:77]
    global_load_dwordx2 v[84:85], v[46:47], off
    v_lshl_add_u64 v[46:47], v[46:47], 0, s[76:77]
    global_load_dwordx2 v[86:87], v[46:47], off
    v_lshl_add_u64 v[46:47], v[46:47], 0, s[76:77]
    global_load_dwordx2 v[88:89], v[46:47], off
    v_lshl_add_u64 v[46:47], v[46:47], 0, s[76:77]
    global_load_dwordx2 v[90:91], v[46:47], off
    v_lshl_add_u64 v[46:47], v[46:47], 0, s[76:77]
    global_load_dwordx2 v[92:93], v[46:47], off
    v_lshl_add_u64 v[46:47], v[46:47], 0, s[76:77]
    global_load_dwordx2 v[94:95], v[46:47], off
    v_lshl_add_u64 v[46:47], v[46:47], 0, s[78:79]
    global_load_dwordx2 v[96:97], v[46:47], off
    v_lshl_add_u64 v[46:47], v[46:47], 0, s[76:77]
    global_load_dwordx2 v[98:99], v[46:47], off
    v_lshl_add_u64 v[46:47], v[46:47], 0, s[76:77]
    global_load_dwordx2 v[100:101], v[46:47], off
    v_lshl_add_u64 v[46:47], v[46:47], 0, s[76:77]
    global_load_dwordx2 v[102:103], v[46:47], off
    v_lshl_add_u64 v[46:47], v[46:47], 0, s[76:77]
    global_load_dwordx2 v[104:105], v[46:47], off
    v_lshl_add_u64 v[46:47], v[46:47], 0, s[76:77]
    global_load_dwordx2 v[106:107], v[46:47], off
    v_lshl_add_u64 v[46:47], v[46:47], 0, s[76:77]
    global_load_dwordx2 v[108:109], v[46:47], off
    v_lshl_add_u64 v[46:47], v[46:47], 0, s[76:77]
    global_load_dwordx2 v[110:111], v[46:47], off
    v_lshl_add_u64 v[46:47], v[46:47], 0, s[78:79]
    s_bitcmp1_b32 s87, 0
    s_cbranch_scc1 KS_G4
    global_load_dwordx2 v[112:113], v[46:47], off
    v_lshl_add_u64 v[46:47], v[46:47], 0, s[76:77]
    global_load_dwordx2 v[114:115], v[46:47], off
    v_lshl_add_u64 v[46:47], v[46:47], 0, s[76:77]
    global_load_dwordx2 v[116:117], v[46:47], off
    v_lshl_add_u64 v[46:47], v[46:47], 0, s[76:77]
    global_load_dwordx2 v[118:119], v[46:47], off
    v_lshl_add_u64 v[46:47], v[46:47], 0, s[76:77]
    global_load_dwordx2 v[120:121], v[46:47], off
    v_lshl_add_u64 v[46:47], v[46:47], 0, s[76:77]
    global_load_dwordx2 v[122:123], v[46:47], off
    v_lshl_add_u64 v[46:47], v[46:47], 0, s[76:77]
    global_load_dwordx2 v[124:125], v[46:47], off
    v_lshl_add_u64 v[46:47], v[46:47], 0, s[76:77]
    global_load_dwordx2 v[126:127], v[46:47], off
KS_G4:
    v_mov_b32 v6, s87
    ds_write_b8 v6, v5 offset:192
    s_waitcnt vmcnt(0)
    ds_write_b8 v6, v5 offset:40
    v_perm_b32 v32, v50, v48, s98
    v_perm_b32 v33, v54, v52, s98
    v_perm_b32 v34, v58, v56, s98
    v_perm_b32 v35, v62, v60, s98
    v_perm_b32 v36, v50, v48, s99
    v_perm_b32 v37, v54, v52, s99
    v_perm_b32 v38, v58, v56, s99
    v_perm_b32 v39, v62, v60, s99
    v_perm_b32 v40, v51, v49, s98
    v_perm_b32 v41, v55, v53, s98
    v_perm_b32 v42, v59, v57, s98
    v_perm_b32 v43, v63, v61, s98
    v_perm_b32 v44, v51, v49, s99
    v_perm_b32 v45, v55, v53, s99
    v_perm_b32 v46, v59, v57, s99
    v_perm_b32 v47, v63, v61, s99
    v_perm_b32 v48, v66, v64, s98
    v_perm_b32 v49, v70, v68, s98
    v_perm_b32 v50, v74, v72, s98
    v_perm_b32 v51, v78, v76, s98
    v_perm_b32 v52, v66, v64, s99
    v_perm_b32 v53, v70, v68, s99
    v_perm_b32 v54, v74, v72, s99
    v_perm_b32 v55, v78, v76, s99
    v_perm_b32 v56, v67, v65, s98
    v_perm_b32 v57, v71, v69, s98
    v_perm_b32 v58, v75, v73, s98
    v_perm_b32 v59, v79, v77, s98
    v_perm_b32 v60, v67, v65, s99
    v_perm_b32 v61, v71, v69, s99
    v_perm_b32 v62, v75, v73, s99
    v_perm_b32 v63, v79, v77, s99
    v_perm_b32 v64, v82, v80, s98
    v_perm_b32 v65, v86, v84, s98
    v_perm_b32 v66, v90, v88, s98
    v_perm_b32 v67, v94, v92, s98
    v_perm_b32 v68, v82, v80, s99
    v_perm_b32 v69, v86, v84, s99
    v_perm_b32 v70, v90, v88, s99
    v_perm_b32 v71, v94, v92, s99
    v_perm_b32 v72, v83, v81, s98
    v_perm_b32 v73, v87, v85, s98
    v_perm_b32 v74, v91, v89, s98
    v_perm_b32 v75, v95, v93, s98
    v_perm_b32 v76, v83, v81, s99
    v_perm_b32 v77, v87, v85, s99
    v_perm_b32 v78, v91, v89, s99
    v_perm_b32 v79, v95, v93, s99
    v_perm_b32 v80, v98, v96, s98
    v_perm_b32 v81, v102, v100, s98
    v_perm_b32 v82, v106, v104, s98
    v_perm_b32 v83, v110, v108, s98
    v_perm_b32 v84, v98, v96, s99
    v_perm_b32 v85, v102, v100, s99
    v_perm_b32 v86, v106, v104, s99
    v_perm_b32 v87, v110, v108, s99
    v_perm_b32 v88, v99, v97, s98
    v_perm_b32 v89, v103, v101, s98
    v_perm_b32 v90, v107, v105, s98
    v_perm_b32 v91, v111, v109, s98
    v_perm_b32 v92, v99, v97, s99
    v_perm_b32 v93, v103, v101, s99
    v_perm_b32 v94, v107, v105, s99
    v_perm_b32 v95, v111, v109, s99
    v_perm_b32 v96, v114, v112, s98
    v_perm_b32 v97, v118, v116, s98
    v_perm_b32 v98, v122, v120, s98
    v_perm_b32 v99, v126, v124, s98
    v_perm_b32 v100, v114, v112, s99
    v_perm_b32 v101, v118, v116, s99
    v_perm_b32 v102, v122, v120, s99
    v_perm_b32 v103, v126, v124, s99
    v_perm_b32 v104, v115, v113, s98
    v_perm_b32 v105, v119, v117, s98
    v_perm_b32 v106, v123, v121, s98
    v_perm_b32 v107, v127, v125, s98
    v_perm_b32 v108, v115, v113, s99
    v_perm_b32 v109, v119, v117, s99
    v_perm_b32 v110, v123, v121, s99
    v_perm_b32 v111, v127, v125, s99
    s_mov_b32 s72, s36
    s_mov_b32 s73, s37
    s_mov_b32 s74, 0x240000
    s_mov_b32 s75, 0x20000
    s_lshl_b32 s92, s86, 6
    s_add_u32 s92, s92, 2358144
    v_and_b32 v6, 7, v2
    v_lshlrev_b32 v6, 2, v6
    v_lshl_add_u32 v7, v3, 4, s92
    s_movk_i32 s93, -1152
    s_and_b32 s94, s87, 1
    s_lshl_b32 s94, s94, 6
    s_sub_u32 s94, 256, s94
    s_lshl_b32 s92, s87, 6
    v_add_u32 v11, s92, v1
    v_lshrrev_b32 v8, 5, v11
    v_and_b32 v9, 31, v11
    v_and_b32 v10, 3, v9
    v_lshlrev_b32 v10, 9, v10
    v_lshrrev_b32 v9, 2, v9
    v_lshl_add_u32 v10, v9, 4, v10
    v_lshrrev_b32 v9, 2, v8
    v_lshl_add_u32 v10, v9, 8, v10
    v_and_b32 v9, 3, v8
    v_lshl_add_u32 v10, v9, 2, v10
    v_lshlrev_b32 v11, 1, v11
    s_lshl_b32 s92, s87, 11
    v_lshl_add_u32 v9, v1, 4, s92
    s_lshl_b32 s92, s86, 9
    s_add_u32 s92, s92, 17088
    v_lshl_add_u32 v28, v6, 2, s92
    v_lshl_add_u32 v28, v3, 7, v28
    s_lshl_b32 s92, s94, 3
    v_add_u32 v31, s92, v28
    v_lshlrev_b32 v0, 2, v3
    ds_read_b32 v0, v0 offset:224
W_99:
    s_sleep 2
    ds_read_b32 v12, v6 offset:768
    s_sub_u32 s39, s39, 1
    s_cbranch_scc1 KS_ABORT
    s_waitcnt lgkmcnt(0)
    v_cmp_eq_u32 vcc, 0, v12
    s_cbranch_vccnz W_99
    s_setprio 2
    v_and_b32 v12, 0x7ff, v12
    v_mad_i32_i24 v7, v12, s93, v7
    v_lshrrev_b32 v2, 3, v0
    v_lshrrev_b32 v5, 6, v0
    v_lshrrev_b32 v6, 9, v0
W_100:
    ds_read_b32 v12, v4 offset:32
    s_sub_u32 s39, s39, 1
    s_cbranch_scc1 KS_ABORT
    s_waitcnt lgkmcnt(0)
    v_cmp_eq_u32 vcc, 0, v12
    s_cbranch_vccnz W_100
    ds_read_b128 v[12:15], v28 offset:0
    ds_read_b128 v[16:19], v28 offset:512
    ds_read_b128 v[20:23], v28 offset:1024
    ds_read_b128 v[24:27], v28 offset:1536
    ds_read_b128 v[28:31], v31
    s_waitcnt lgkmcnt(4)
    v_mfma_f32_16x16x32_bf16 v[112:115], v[12:15], v[32:35], 0
    v_xor_b32 v4, v0, v12
    v_bitop3_b32 v4, v4, v2, v13 bitop3:0xf6
    v_mfma_f32_16x16x32_bf16 v[116:119], v[12:15], v[36:39], 0
    v_bitop3_b32 v4, v4, v5, v14 bitop3:0xf6
    v_bitop3_b32 v4, v4, v6, v15 bitop3:0xf6
    v_mfma_f32_16x16x32_bf16 v[120:123], v[12:15], v[40:43], 0
    v_and_b32 v8, 0x70007, v4
    v_mfma_f32_16x16x32_bf16 v[124:127], v[12:15], v[44:47], 0
    s_waitcnt lgkmcnt(3)
    v_mfma_f32_16x16x32_bf16 v[112:115], v[16:19], v[48:51], v[112:115]
    v_xor_b32 v4, v0, v16
    v_bitop3_b32 v4, v4, v2, v17 bitop3:0xf6
    v_mfma_f32_16x16x32_bf16 v[116:119], v[16:19], v[52:55], v[116:119]
    v_bitop3_b32 v4, v4, v5, v18 bitop3:0xf6
    v_bitop3_b32 v4, v4, v6, v19 bitop3:0xf6
    v_mfma_f32_16x16x32_bf16 v[120:123], v[16:19], v[56:59], v[120:123]
    v_and_b32 v4, 0x70007, v4
    v_min_u32 v8, v8, v4
    v_mfma_f32_16x16x32_bf16 v[124:127], v[16:19], v[60:63], v[124:127]
    s_waitcnt lgkmcnt(2)
    v_mfma_f32_16x16x32_bf16 v[112:115], v[20:23], v[64:67], v[112:115]
    v_xor_b32 v4, v0, v20
    v_bitop3_b32 v4, v4, v2, v21 bitop3:0xf6
    v_mfma_f32_16x16x32_bf16 v[116:119], v[20:23], v[68:71], v[116:119]
    v_bitop3_b32 v4, v4, v5, v22 bitop3:0xf6
    v_bitop3_b32 v4, v4, v6, v23 bitop3:0xf6
    v_mfma_f32_16x16x32_bf16 v[120:123], v[20:23], v[72:75], v[120:123]
    v_and_b32 v4, 0x70007, v4
    v_min_u32 v8, v8, v4
    v_mfma_f32_16x16x32_bf16 v[124:127], v[20:23], v[76:79], v[124:127]
    s_waitcnt lgkmcnt(1)
    v_mfma_f32_16x16x32_bf16 v[112:115], v[24:27], v[80:83], v[112:115]
    v_xor_b32 v4, v0, v24
    v_bitop3_b32 v4, v4, v2, v25 bitop3:0xf6
    v_mfma_f32_16x16x32_bf16 v[116:119], v[24:27], v[84:87], v[116:119]
    v_bitop3_b32 v4, v4, v5, v26 bitop3:0xf6
    v_bitop3_b32 v4, v4, v6, v27 bitop3:0xf6
    v_mfma_f32_16x16x32_bf16 v[120:123], v[24:27], v[88:91], v[120:123]
    v_and_b32 v4, 0x70007, v4
    v_min_u32 v8, v8, v4
    v_mfma_f32_16x16x32_bf16 v[124:127], v[24:27], v[92:95], v[124:127]
    s_waitcnt lgkmcnt(0)
    v_xor_b32 v4, v0, v28
    v_bitop3_b32 v4, v4, v2, v29 bitop3:0xf6
    v_bitop3_b32 v4, v4, v5, v30 bitop3:0xf6
    v_bitop3_b32 v4, v4, v6, v31 bitop3:0xf6
    v_and_b32 v4, 0x70007, v4
    v_min_u32 v8, v8, v4
    v_cmp_eq_u32 vcc, 0, v8
    s_cbranch_vccnz KS_GR
    s_bitcmp1_b32 s87, 0
    s_cbranch_scc1 KS_G5
    v_mfma_f32_16x16x32_bf16 v[112:115], v[28:31], v[96:99], v[112:115]
    v_mfma_f32_16x16x32_bf16 v[116:119], v[28:31], v[100:103], v[116:119]
    v_mfma_f32_16x16x32_bf16 v[120:123], v[28:31], v[104:107], v[120:123]
    v_mfma_f32_16x16x32_bf16 v[124:127], v[28:31], v[108:111], v[124:127]
    s_branch KS_G5
KS_GR:
    s_add_u32 s76, s36, 0x840000
    s_addc_u32 s77, s37, 0
    s_mov_b32 s78, 0x3000
    s_mov_b32 s79, 0x20000
    v_lshlrev_b32 v4, 4, v1
    s_movk_i32 s92, 0x2000
    s_nop 3
KS_GR2:
    s_sleep 2
    buffer_load_dword v12, v4, s[76:79], s92 offen offset:0 sc1
    buffer_load_dword v13, v4, s[76:79], s92 offen offset:1024 sc1
    buffer_load_dword v14, v4, s[76:79], s92 offen offset:2048 sc1
    buffer_load_dword v15, v4, s[76:79], s92 offen offset:3072 sc1
    s_sub_u32 s39, s39, 1
    s_cbranch_scc1 KS_ABORT
    s_waitcnt vmcnt(0)
    v_max3_u32 v12, v12, v13, v14
    v_max_u32 v12, v12, v15
    v_cmp_eq_u32 vcc, -1, v12
    s_cbranch_vccnz KS_GR2
    buffer_load_dwordx4 v[12:15], v7, s[72:75], 0 offen offset:0 sc1
    buffer_load_dwordx4 v[16:19], v7, s[72:75], 0 offen offset:64 sc1
    buffer_load_dwordx4 v[20:23], v7, s[72:75], 0 offen offset:128 sc1
    buffer_load_dwordx4 v[24:27], v7, s[72:75], 0 offen offset:192 sc1
    buffer_load_dwordx4 v[28:31], v7, s[72:75], s94 offen sc1
    s_sub_u32 s39, s39, 1
    s_cbranch_scc1 KS_ABORT
    s_waitcnt vmcnt(4)
    v_mfma_f32_16x16x32_bf16 v[112:115], v[12:15], v[32:35], 0
    v_mfma_f32_16x16x32_bf16 v[116:119], v[12:15], v[36:39], 0
    v_mfma_f32_16x16x32_bf16 v[120:123], v[12:15], v[40:43], 0
    v_mfma_f32_16x16x32_bf16 v[124:127], v[12:15], v[44:47], 0
    s_waitcnt vmcnt(3)
    v_mfma_f32_16x16x32_bf16 v[112:115], v[16:19], v[48:51], v[112:115]
    v_mfma_f32_16x16x32_bf16 v[116:119], v[16:19], v[52:55], v[116:119]
    v_mfma_f32_16x16x32_bf16 v[120:123], v[16:19], v[56:59], v[120:123]
    v_mfma_f32_16x16x32_bf16 v[124:127], v[16:19], v[60:63], v[124:127]
    s_waitcnt vmcnt(2)
    v_mfma_f32_16x16x32_bf16 v[112:115], v[20:23], v[64:67], v[112:115]
    v_mfma_f32_16x16x32_bf16 v[116:119], v[20:23], v[68:71], v[116:119]
    v_mfma_f32_16x16x32_bf16 v[120:123], v[20:23], v[72:75], v[120:123]
    v_mfma_f32_16x16x32_bf16 v[124:127], v[20:23], v[76:79], v[124:127]
    s_waitcnt vmcnt(1)
    v_mfma_f32_16x16x32_bf16 v[112:115], v[24:27], v[80:83], v[112:115]
    v_mfma_f32_16x16x32_bf16 v[116:119], v[24:27], v[84:87], v[116:119]
    v_mfma_f32_16x16x32_bf16 v[120:123], v[24:27], v[88:91], v[120:123]
    v_mfma_f32_16x16x32_bf16 v[124:127], v[24:27], v[92:95], v[124:127]
    s_waitcnt vmcnt(0)
    s_bitcmp1_b32 s87, 0
    s_cbranch_scc1 KS_G5
    v_mfma_f32_16x16x32_bf16 v[112:115], v[28:31], v[96:99], v[112:115]
    v_mfma_f32_16x16x32_bf16 v[116:119], v[28:31], v[100:103], v[116:119]
    v_mfma_f32_16x16x32_bf16 v[120:123], v[28:31], v[104:107], v[120:123]
    v_mfma_f32_16x16x32_bf16 v[124:127], v[28:31], v[108:111], v[124:127]
KS_G5:
    s_mov_b32 exec_lo, -1
    s_mov_b32 exec_hi, 0
    s_nop 5
    ds_write_b128 v9, v[112:115] offset:26368
    ds_write_b128 v9, v[116:119] offset:26880
    ds_write_b128 v9, v[120:123] offset:27392
    ds_write_b128 v9, v[124:127] offset:27904
    s_mov_b64 exec, -1
    s_waitcnt lgkmcnt(0)
    s_barrier
    ds_read_b32 v32, v10 offset:26368
    ds_read_b32 v33, v10 offset:26496
    ds_read_b32 v34, v10 offset:28416
    ds_read_b32 v35, v10 offset:28544
    ds_read_b32 v36, v10 offset:30464
    ds_read_b32 v37, v10 offset:30592
    ds_read_b32 v38, v10 offset:32512
    ds_read_b32 v39, v10 offset:32640
    s_waitcnt lgkmcnt(4)
    v_pk_add_f32 v[32:33], v[32:33], v[34:35]
    s_waitcnt lgkmcnt(0)
    v_pk_add_f32 v[36:37], v[36:37], v[38:39]
    v_pk_add_f32 v[32:33], v[32:33], v[36:37]
    v_cvt_pk_bf16_f32 v32, 0, v32
    v_cvt_pk_bf16_f32 v33, 0, v33
    v_mul_f32 v34, 0xbfb8aa3b, v32
    v_exp_f32 v34, v34
    s_nop 0
    v_add_f32 v34, 1.0, v34
    v_rcp_f32 v34, v34
    s_nop 0
    v_mul_f32 v34, v32, v34
    v_cvt_pk_bf16_f32 v34, 0, v34
    v_mul_f32 v34, v34, v33
    v_cvt_pk_bf16_f32 v34, v34, v34
    ds_write_b16 v11, v34 offset:1024
    s_waitcnt lgkmcnt(0)
    s_barrier
    s_branch KS_P2
KS_P:
    s_branch KS_P1
    s_mov_b32 s68, s30
    s_mov_b32 s69, s31
    s_mov_b32 s70, 0x510000
    s_mov_b32 s71, 0x20000
    s_sub_u32 s94, s38, 10
    v_lshlrev_b32 v6, 4, v1
    s_mul_i32 s92, s89, 36864
    s_mul_i32 s93, s94, 18432
    s_add_u32 s92, s92, s93
    s_add_u32 s93, s93, 109184
    s_lshl_b32 s94, s94, 1
    v_mov_b32 v7, s94
    v_mov_b32 v8, s84
W_101:
    s_sleep 2
    ds_read_b32 v10, v4 offset:20
    s_sub_u32 s39, s39, 1
    s_cbranch_scc1 KS_ABORT
    s_waitcnt lgkmcnt(0)
    v_cmp_ne_u32 vcc, s84, v10
    s_cbranch_vccnz W_101
    s_setprio 1
    s_add_u32 m0, s93, 0
    s_nop 0
    buffer_load_dwordx4 v6, s[68:71], s92 offen offset:0 nt lds
    buffer_load_dwordx4 v6, s[68:71], s92 offen offset:1024 nt lds
    buffer_load_dwordx4 v6, s[68:71], s92 offen offset:2048 nt lds
    buffer_load_dwordx4 v6, s[68:71], s92 offen offset:3072 nt lds
    s_add_u32 m0, s93, 4096
    s_add_u32 s92, s92, 4096
    buffer_load_dwordx4 v6, s[68:71], s92 offen offset:0 nt lds
    buffer_load_dwordx4 v6, s[68:71], s92 offen offset:1024 nt lds
    buffer_load_dwordx4 v6, s[68:71], s92 offen offset:2048 nt lds
    buffer_load_dwordx4 v6, s[68:71], s92 offen offset:3072 nt lds
    s_add_u32 m0, s93, 8192
    s_add_u32 s92, s92, 4096
    buffer_load_dwordx4 v6, s[68:71], s92 offen offset:0 nt lds
    buffer_load_dwordx4 v6, s[68:71], s92 offen offset:1024 nt lds
    buffer_load_dwordx4 v6, s[68:71], s92 offen offset:2048 nt lds
    buffer_load_dwordx4 v6, s[68:71], s92 offen offset:3072 nt lds
    s_add_u32 m0, s93, 12288
    s_add_u32 s92, s92, 4096
    buffer_load_dwordx4 v6, s[68:71], s92 offen offset:0 nt lds
    buffer_load_dwordx4 v6, s[68:71], s92 offen offset:1024 nt lds
    buffer_load_dwordx4 v6, s[68:71], s92 offen offset:2048 nt lds
    buffer_load_dwordx4 v6, s[68:71], s92 offen offset:3072 nt lds
    s_add_u32 m0, s93, 16384
    s_add_u32 s92, s92, 4096
    buffer_load_dwordx4 v6, s[68:71], s92 offen offset:0 nt lds
    buffer_load_dwordx4 v6, s[68:71], s92 offen offset:1024 nt lds
    s_waitcnt vmcnt(0)
    ds_write_b16 v7, v8 offset:40
KS_P1:
    s_setprio 0
    s_waitcnt lgkmcnt(0)
    s_barrier
    s_barrier
    s_setprio 2
KS_P2:
    s_sub_u32 s87, s38, 10
    s_add_u32 s64, s36, 0x850000
    s_addc_u32 s65, s37, 0
    s_mov_b32 s66, 0x28c800
    s_mov_b32 s67, 0x20000
    s_mov_b32 s68, s32
    s_mov_b32 s69, s33
    s_mov_b32 s70, 0x240000
    s_mov_b32 s71, 0x20000
    v_lshrrev_b32 v8, 3, v1
    v_mul_u32_u24 v8, 18560, v8
    v_and_b32 v9, 7, v1
    v_lshl_add_u32 v8, v9, 4, v8
    s_mul_i32 s92, s87, 445440
    s_lshl_b32 s93, s89, 7
    s_add_u32 s92, s92, s93
    s_add_u32 s93, s92, 148480
    s_add_u32 s94, s92, 296960
    s_lshl_b32 s95, s87, 7
    v_lshl_add_u32 v6, v9, 4, s95
    v_lshl_add_u32 v6, v3, 2, v6
    v_lshlrev_b32 v12, 2, v1
    v_add_u32 v12, 2048, v12
    v_lshlrev_b32 v13, 4, v1
    v_and_b32 v14, 12, v12
    ds_read_b32 v24, v14 offset:224
    s_waitcnt lgkmcnt(0)
    v_lshrrev_b32 v25, 8, v24
    v_lshrrev_b32 v26, 16, v24
    v_lshrrev_b32 v27, 24, v24
    s_barrier
    s_branch PPE_103
PP_102:
    s_sleep 1
PPE_103:
    buffer_load_dwordx4 v[32:35], v8, s[64:67], s92 offen sc1
    buffer_load_dwordx4 v[36:39], v8, s[64:67], s93 offen sc1
    buffer_load_dwordx4 v[40:43], v8, s[64:67], s94 offen sc1
    s_sub_u32 s39, s39, 1
    s_cbranch_scc1 KS_ABORT
    s_waitcnt vmcnt(2)
    v_xor_b32 v44, v24, v32
    v_xor_b32 v45, v25, v33
    v_bitop3_b32 v44, v44, v26, v34 bitop3:0xf6
    v_bitop3_b32 v45, v45, v27, v35 bitop3:0xf6
    s_waitcnt vmcnt(1)
    v_bitop3_b32 v44, v44, v24, v36 bitop3:0xf6
    v_bitop3_b32 v45, v45, v25, v37 bitop3:0xf6
    v_bitop3_b32 v44, v44, v26, v38 bitop3:0xf6
    v_bitop3_b32 v45, v45, v27, v39 bitop3:0xf6
    s_waitcnt vmcnt(0)
    v_bitop3_b32 v44, v44, v24, v40 bitop3:0xf6
    v_bitop3_b32 v45, v45, v25, v41 bitop3:0xf6
    v_bitop3_b32 v44, v44, v26, v42 bitop3:0xf6
    v_bitop3_b32 v45, v45, v27, v43 bitop3:0xf6
    v_or_b32 v44, v44, v45
    v_and_b32 v44, 0xff, v44
    v_cmp_ne_u32 vcc, 0, v44
    s_cbranch_vccnz PP_102
    v_pk_add_f32 v[32:33], v[32:33], v[36:37]
    v_pk_add_f32 v[34:35], v[34:35], v[38:39]
    v_pk_add_f32 v[32:33], v[32:33], v[40:41]
    v_pk_add_f32 v[34:35], v[34:35], v[42:43]
    s_nop 0
    v_add_f32_dpp v32, v32, v32 row_ror:8 row_mask:0xf bank_mask:0xf
    v_add_f32_dpp v33, v33, v33 row_ror:8 row_mask:0xf bank_mask:0xf
    v_add_f32_dpp v34, v34, v34 row_ror:8 row_mask:0xf bank_mask:0xf
    v_add_f32_dpp v35, v35, v35 row_ror:8 row_mask:0xf bank_mask:0xf
    v_permlane16_swap_b32 v32, v33
    s_nop 0
    v_permlane16_swap_b32 v34, v35
    v_add_f32 v32, v32, v33
    v_add_f32 v34, v34, v35
    s_nop 1
    v_permlane32_swap_b32 v32, v34
    v_add_f32 v32, v32, v34
    ds_write_b32 v6, v32 offset:2048
    s_waitcnt lgkmcnt(0)
    s_barrier
    s_cmp_lg_u32 s87, 0
    s_cbranch_scc1 KS_PEND
    s_mov_b32 exec_lo, -1
    s_mov_b32 exec_hi, 0
    ds_read2_b32 v[32:33], v12 offset0:0 offset1:32
    ds_read2_b32 v[34:35], v12 offset0:64 offset1:96
    ds_read2_b32 v[36:37], v12 offset0:128 offset1:160
    ds_read_b128 v[40:43], v13 offset:1536
    s_waitcnt lgkmcnt(0)
    v_pk_add_f32 v[32:33], v[32:33], v[34:35]
    v_pk_add_f32 v[32:33], v[32:33], v[36:37]
    v_add_f32 v8, v32, v33
    v_cvt_pk_bf16_f32 v8, 0, v8
    v_mul_f32 v8, v8, v42
    v_cvt_pk_bf16_f32 v8, 0, v8
    v_add_f32 v8, v8, v40
    v_cvt_pk_bf16_f32 v8, 0, v8
    v_add_f32 v8, v8, v41
    v_cvt_pk_bf16_f32 v8, v8, v8
    buffer_store_short v8, v43, s[68:71], 0 offen
KS_PEND:
KS_ABORT:
KS_END:
    s_endpgm
.section .rodata,"a"
.p2align 6
.amdhsa_kernel sequential_preLN__ssm_conv_s4__moe_arch_mod__prompt_kernel
  .amdhsa_next_free_vgpr 128
  .amdhsa_next_free_sgpr 100
  .amdhsa_accum_offset 128
  .amdhsa_group_segment_fixed_size 0
  .amdhsa_kernarg_size 136
  .amdhsa_user_sgpr_count 2
  .amdhsa_user_sgpr_kernarg_segment_ptr 1
  .amdhsa_system_sgpr_workgroup_id_x 1
  .amdhsa_float_denorm_mode_32 3
.end_amdhsa_kernel
```

```asm
; @launch grid=(256,1,1) block=(1024,1,1) lds=154240
.amdgcn_target "amdgcn-amd-amdhsa--gfx950"
.text
.globl sequential_preLN__ssm_conv_s4__moe_arch_mod__prompt_kernel
.p2align 8
.type sequential_preLN__ssm_conv_s4__moe_arch_mod__prompt_kernel,@function
sequential_preLN__ssm_conv_s4__moe_arch_mod__prompt_kernel:
    s_cmp_ge_u32 s2, 256
    s_cbranch_scc1 KS_END
    s_load_dwordx16 s[4:19], s[0:1], 0
    s_load_dwordx16 s[20:35], s[0:1], 64
    s_load_dwordx2 s[36:37], s[0:1], 128
    v_readfirstlane_b32 s38, v0
    s_lshr_b32 s38, s38, 6
    s_and_b32 s40, s2, 7
    s_lshr_b32 s41, s2, 3
    s_cmp_lg_u32 s38, 0
    s_cbranch_scc1 KS_CPE
    s_getpc_b64 s[42:43]
KS_PC:
    s_and_b32 s92, s41, 7
    s_mul_i32 s92, s92, 4608
    v_and_b32 v126, 63, v0
    v_lshl_add_u32 v126, v126, 7, s92
    v_min_u32 v126, KS_END-KS_PC, v126
    global_load_dword v127, v126, s[42:43]
KS_CPE:
    s_add_u32 s92, s38, 8
    s_sub_u32 s93, s38, 4
    s_cmp_lt_u32 s38, 8
    s_cselect_b32 s92, s92, s93
    s_cmp_lt_u32 s38, 4
    s_cselect_b32 s38, s38, s92
    v_and_b32 v1, 63, v0
    v_and_b32 v2, 15, v1
    v_lshrrev_b32 v3, 4, v1
    v_mov_b32 v4, 0
    v_mov_b32 v5, 1
    s_mov_b32 s39, 524288
    s_mov_b32 s84, 0x01010101
    s_lshl_b32 s90, s40, 5
    s_add_u32 s90, s90, s41
    s_mul_i32 s89, s40, 18
    s_add_u32 s89, s89, s41
    s_cmp_lt_u32 s38, 4
    s_cbranch_scc1 KS_L
    s_cmp_ge_u32 s38, 12
    s_cbranch_scc1 KS_X
    s_setprio 2
    s_lshr_b32 s87, s38, 2
    s_sub_u32 s87, s87, 1
    s_mul_i32 s86, s87, 3
    s_xor_b32 s86, s86, s38
    s_and_b32 s86, s86, 3
    s_lshl_b32 s88, s90, 1
    s_add_u32 s88, s88, s87
    s_lshl_b32 s92, s86, 11
    s_add_u32 s92, s92, 146048
    v_lshl_add_u32 v28, v1, 3, s92
    s_cmp_eq_u32 s86, 3
    s_cbranch_scc1 PX_1
    v_lshlrev_b32 v26, 3, v2
    v_mov_b32 v21, 0x80
    s_cmp_eq_u32 s86, 1
    s_cbranch_scc1 PX_2
    s_cmp_eq_u32 s86, 2
    s_cbranch_scc1 PX_3
    v_lshl_add_u32 v26, v3, 1, v26
    v_mov_b32 v22, 1
    s_branch PX_4
PX_2:
    v_cmp_gt_u32 vcc, 2, v3
    v_lshl_add_u32 v20, v3, 2, v26
    v_add_u32 v20, 256, v20
    v_lshl_add_u32 v26, v3, 8, v26
    v_cndmask_b32 v26, v26, v20, vcc
    v_cndmask_b32 v22, v21, 2, vcc
    v_cndmask_b32 v21, 4, v21, vcc
    s_branch PX_4
PX_3:
    v_lshl_add_u32 v26, v3, 9, v26
    v_add_u32 v26, 0x400, v26
    v_mov_b32 v22, 0x100
PX_4:
    v_mad_u32_u24 v26, v22, s87, v26
    v_add_u32 v27, v26, v21
    s_movk_i32 s96, 31232
    s_movk_i32 s97, -19072
    s_lshl_b32 s95, s87, 9
    v_cvt_f32_u32 v20, v26
    v_max_u32 v22, 0x800, v26
    v_cvt_f32_u32 v21, v27
    v_max_u32 v23, 0x800, v27
    v_cmp_gt_u32 vcc, 0x80, v26
    v_lshrrev_b32 v24, 16, v20
    v_add3_u32 v24, v24, v22, s97
    v_cndmask_b32 v24, v24, v26, vcc
    v_cmp_gt_u32 vcc, 0x80, v27
    v_lshrrev_b32 v25, 16, v21
    v_add3_u32 v25, v25, v23, s97
    v_cndmask_b32 v25, v25, v27, vcc
    v_min_u32 v24, 642, v24
    v_lshl_add_u32 v24, v24, 1, s96
    v_min_u32 v25, 642, v25
    v_lshl_add_u32 v25, v25, 1, s96
    v_add_u32 v29, s95, v28
    v_lshl_or_b32 v24, v25, 16, v24
    v_lshl_or_b32 v25, v27, 16, v26
    ds_write_b64 v29, v[24:25]
PX_1:
KS_GRP:
    s_lshl_b32 s92, s88, 8
    v_lshl_add_u32 v20, v1, 2, s92
    s_lshl_b32 s92, s88, 1
    v_mov_b32 v21, s92
    s_mul_i32 s85, s87, 36672
    s_add_u32 s85, s85, 35840
    s_waitcnt lgkmcnt(0)
    global_load_ushort v46, v21, s[18:19]
    global_load_dword v40, v20, s[6:7]
    global_load_dword v41, v20, s[8:9]
    global_load_dword v42, v20, s[10:11]
    global_load_dword v43, v20, s[12:13]
    global_load_dword v44, v20, s[14:15]
    global_load_dword v45, v20, s[16:17]
    global_load_ushort v107, v21, s[20:21]
    s_barrier
    s_movk_i32 s96, 31232
    s_cmp_eq_u32 s87, 2
    s_cbranch_scc1 PREE_7
    v_mov_b32 v32, 641
    s_cmp_eq_u32 s87, 1
    s_cbranch_scc1 PREB_5
    v_mov_b32 v33, 32514
    s_cmp_eq_u32 s86, 1
    s_cbranch_scc1 PRE_9
    s_cmp_eq_u32 s86, 2
    s_cbranch_scc1 PRE_10
    s_cmp_eq_u32 s86, 3
    s_cbranch_scc1 PRE_11
    v_lshlrev_b32 v23, 1, v1
    v_sub_u32 v30, 93, v23
    v_cmp_lt_u32 vcc, 61, v30
    v_lshlrev_b32 v31, 2, v30
    v_add_u32 v31, 32010, v31
    v_cndmask_b32 v24, v31, v33, vcc
    v_sub_u32 v30, 92, v23
    v_cmp_lt_u32 vcc, 61, v30
    v_lshlrev_b32 v31, 2, v30
    v_add_u32 v31, 32010, v31
    v_cndmask_b32 v25, v31, v33, vcc
    v_sub_u32 v30, 94, v23
    v_cmp_lt_u32 vcc, 62, v30
    v_lshlrev_b32 v31, 2, v30
    v_add_u32 v31, 32008, v31
    v_cndmask_b32 v26, v31, v33, vcc
    v_sub_u32 v30, 93, v23
    v_cmp_lt_u32 vcc, 62, v30
    v_lshlrev_b32 v31, 2, v30
    v_add_u32 v31, 32008, v31
    v_cndmask_b32 v27, v31, v33, vcc
    s_branch PREW_6
PRE_9:
    v_min_u32 v23, 47, v1
    v_lshlrev_b32 v23, 1, v23
    v_sub_u32 v30, 64, v23
    v_cmp_lt_u32 vcc, 63, v30
    v_lshlrev_b32 v31, 2, v30
    v_add_u32 v31, 32258, v31
    v_cndmask_b32 v24, v31, v33, vcc
    v_sub_u32 v30, 63, v23
    v_cmp_lt_u32 vcc, 63, v30
    v_lshlrev_b32 v31, 2, v30
    v_add_u32 v31, 32258, v31
    v_cndmask_b32 v25, v31, v33, vcc
    v_sub_u32 v30, 62, v23
    v_cmp_lt_u32 vcc, 63, v30
    v_lshlrev_b32 v31, 2, v30
    v_add_u32 v31, 32258, v31
    v_cndmask_b32 v27, v31, v33, vcc
    v_mov_b32 v26, v25
    s_branch PREW_6
PRE_10:
    v_min_u32 v23, 47, v1
    v_lshlrev_b32 v23, 1, v23
    v_sub_u32 v30, 64, v23
    v_cmp_lt_u32 vcc, 63, v30
    v_lshlrev_b32 v31, 2, v30
    v_add_u32 v31, 32260, v31
    v_cndmask_b32 v24, v31, v33, vcc
    v_sub_u32 v30, 63, v23
    v_cmp_lt_u32 vcc, 63, v30
    v_lshlrev_b32 v31, 2, v30
    v_add_u32 v31, 32260, v31
    v_cndmask_b32 v25, v31, v33, vcc
    v_sub_u32 v30, 62, v23
    v_cmp_lt_u32 vcc, 63, v30
    v_lshlrev_b32 v31, 2, v30
    v_add_u32 v31, 32260, v31
    v_cndmask_b32 v27, v31, v33, vcc
    v_mov_b32 v26, v25
    s_branch PREW_6
PRE_11:
    v_cmp_gt_u32 vcc, 9, v1
    v_add_u32 v23, 0x100, v1
    v_mov_b32 v33, 0x200
    v_cndmask_b32 v23, v23, v1, vcc
    v_lshlrev_b32 v23, 1, v23
    v_sub_u32 v30, 544, v23
    v_cvt_f32_i32 v31, v30
    v_cmp_gt_u32 vcc, 0x100, v30
    v_cvt_pk_bf16_f32 v31, v31, v31
    v_and_b32 v31, 0xffff, v31
    v_subrev_u32 v31, 0x4280, v31
    v_cndmask_b32 v31, v31, v30, vcc
    v_cmp_lt_u32 vcc, 0x20d, v30
    v_or_b32 v30, 1, v23
    s_nop 0
    v_cndmask_b32 v31, v31, v32, vcc
    v_cmp_eq_u32 vcc, 0x25d, v30
    s_nop 1
    v_cndmask_b32 v31, v31, v33, vcc
    v_lshl_add_u32 v24, v31, 1, s96
    v_add_u32 v23, 1, v23
    v_sub_u32 v30, 544, v23
    v_cvt_f32_i32 v31, v30
    v_cmp_gt_u32 vcc, 0x100, v30
    v_cvt_pk_bf16_f32 v31, v31, v31
    v_and_b32 v31, 0xffff, v31
    v_subrev_u32 v31, 0x4280, v31
    v_cndmask_b32 v31, v31, v30, vcc
    v_cmp_lt_u32 vcc, 0x20d, v30
    v_or_b32 v30, 1, v23
    s_nop 0
    v_cndmask_b32 v31, v31, v32, vcc
    v_cmp_eq_u32 vcc, 0x25d, v30
    s_nop 1
    v_cndmask_b32 v31, v31, v33, vcc
    v_lshl_add_u32 v25, v31, 1, s96
    v_add_u32 v23, 1, v23
    v_sub_u32 v30, 544, v23
    v_cvt_f32_i32 v31, v30
    v_cmp_gt_u32 vcc, 0x100, v30
    v_cvt_pk_bf16_f32 v31, v31, v31
    v_and_b32 v31, 0xffff, v31
    v_subrev_u32 v31, 0x4280, v31
    v_cndmask_b32 v31, v31, v30, vcc
    v_cmp_lt_u32 vcc, 0x20d, v30
    v_or_b32 v30, 1, v23
    s_nop 0
    v_cndmask_b32 v31, v31, v32, vcc
    v_cmp_eq_u32 vcc, 0x25d, v30
    s_nop 1
    v_cndmask_b32 v31, v31, v33, vcc
    v_lshl_add_u32 v27, v31, 1, s96
    v_mov_b32 v26, v25
    s_branch PREW_6
PREB_5:
    s_lshl_b32 s93, s86, 7
    s_add_u32 s93, s93, 18
    v_lshl_add_u32 v23, v1, 1, s93
    v_sub_u32 v30, 544, v23
    v_cvt_f32_i32 v31, v30
    v_cmp_gt_u32 vcc, 0x100, v30
    v_cvt_pk_bf16_f32 v31, v31, v31
    v_and_b32 v31, 0xffff, v31
    v_subrev_u32 v31, 0x4280, v31
    v_cndmask_b32 v31, v31, v30, vcc
    v_cmp_lt_u32 vcc, 0x20d, v30
    s_nop 1
    v_cndmask_b32 v31, v31, v32, vcc
    v_lshl_add_u32 v24, v31, 1, s96
    v_add_u32 v23, 1, v23
    v_sub_u32 v30, 544, v23
    v_cvt_f32_i32 v31, v30
    v_cmp_gt_u32 vcc, 0x100, v30
    v_cvt_pk_bf16_f32 v31, v31, v31
    v_and_b32 v31, 0xffff, v31
    v_subrev_u32 v31, 0x4280, v31
    v_cndmask_b32 v31, v31, v30, vcc
    v_cmp_lt_u32 vcc, 0x20d, v30
    s_nop 1
    v_cndmask_b32 v31, v31, v32, vcc
    v_lshl_add_u32 v25, v31, 1, s96
    v_add_u32 v23, 1, v23
    v_sub_u32 v30, 544, v23
    v_cvt_f32_i32 v31, v30
    v_cmp_gt_u32 vcc, 0x100, v30
    v_cvt_pk_bf16_f32 v31, v31, v31
    v_and_b32 v31, 0xffff, v31
    v_subrev_u32 v31, 0x4280, v31
    v_cndmask_b32 v31, v31, v30, vcc
    v_cmp_lt_u32 vcc, 0x20d, v30
    s_nop 1
    v_cndmask_b32 v31, v31, v32, vcc
    v_lshl_add_u32 v26, v31, 1, s96
    s_sub_u32 s93, s86, 1
    s_cmp_lt_u32 s93, 2
    s_cselect_b32 s94, 47, 63
    s_mul_i32 s93, s93, 384
    s_add_u32 s93, s93, 35664
    s_cmp_eq_u32 s86, 0
    s_cselect_b32 s93, 35152, s93
    s_cmp_eq_u32 s86, 3
    s_cselect_b32 s93, 32528, s93
    s_cselect_b32 s95, 0x100, 0
    v_cmp_gt_u32 vcc, 9, v1
    v_min_u32 v23, s94, v1
    v_add_u32 v30, s95, v23
    v_cndmask_b32 v23, v30, v23, vcc
    v_lshl_add_u32 v27, v23, 2, s93
    v_lshl_or_b32 v24, v25, 16, v24
    v_lshl_or_b32 v25, v27, 16, v26
    ds_write_b64 v28, v[24:25] offset:1024
    v_mov_b32 v24, s86
    ds_write_b8 v24, v5 offset:212
    s_branch PREE_7
PREW_6:
    v_lshl_or_b32 v24, v25, 16, v24
    v_lshl_or_b32 v25, v27, 16, v26
    ds_write_b64 v28, v[24:25] offset:1536
    v_mov_b32 v24, s86
    ds_write_b8 v24, v5 offset:208
PREE_7:
    s_mul_i32 s93, s86, 8704
    s_min_u32 s94, s93, 22304
    s_add_u32 s94, s94, s85
    s_lshl_b32 s92, s87, 4
    v_mov_b32 v14, s92
    v_add_u32 v15, s86, v14
    v_lshl_add_u32 v72, v1, 3, s94
    v_add_u32 v73, 2176, v72
    v_add_u32 v74, 4352, v72
    v_add_u32 v75, 6528, v72
    v_mul_u32_u24 v126, 544, v2
    v_lshl_add_u32 v126, v3, 4, v126
    v_add_u32 v126, s85, v126
    v_add_u32 v127, s93, v126
    v_lshlrev_b32 v20, 3, v3
    v_sub_u32 v20, v20, v2
    v_add_u32 v21, 16, v20
    v_lshrrev_b32 v21, 1, v21
    v_and_b32 v22, 1, v2
    s_add_u32 s92, s85, 32528
    v_lshl_add_u32 v21, v21, 2, s92
    s_movk_i32 s92, 1344
    s_movk_i32 s94, 192
    v_mad_u32_u24 v6, v22, s92, v21
    v_add_u32 v7, 640, v6
    v_mad_u32_u24 v23, v22, s94, v21
    v_add_u32 v13, 3136, v23
    v_lshlrev_b32 v23, 2, v3
    v_sub_u32 v23, v23, v2
    s_add_u32 s92, s85, 35212
    v_lshl_add_u32 v11, v23, 2, s92
    s_mul_i32 s94, s87, 4672
    s_add_u32 s94, s94, 3072
    v_lshl_add_u32 v23, v2, 5, s94
    v_lshl_add_u32 v8, v3, 4, v23
    v_bfe_u32 v20, v1, 2, 2
    v_and_b32 v21, 3, v1
    v_lshl_add_u32 v20, v3, 3, v20
    v_lshlrev_b32 v105, 2, v21
    v_lshl_add_u32 v21, v21, 3, s85
    v_lshl_add_u32 v9, v20, 4, v21
    v_lshl_add_u32 v10, v20, 5, v21
    v_lshlrev_b32 v12, 4, v1
    s_add_u32 s64, s36, 0x600000
    s_addc_u32 s65, s37, 0
    s_mov_b32 s66, 0x240000
    s_mov_b32 s67, 0x20000
    s_mov_b32 s10, 0x8080
    s_lshl_b32 s92, s86, 19
    s_lshl_b32 s93, s90, 6
    s_add_u32 s92, s92, s93
    s_lshl_b32 s93, s86, 16
    s_lshl_b32 s95, s88, 6
    s_add_u32 s93, s93, s95
    s_add_u32 s93, s93, 2064384
    s_cmp_eq_u32 s87, 2
    s_cselect_b32 s6, s93, s92
    s_cselect_b32 s8, 0x1080, s10
    s_cselect_b32 s92, 1, 3
    s_and_b32 s92, s92, s86
    s_lshl_b32 s92, s92, 11
    s_xor_b32 s6, s6, s92
    s_and_b32 s10, s6, 0x7c0
    s_xor_b32 s6, s6, s10
    s_xor_b32 s7, s6, 0x6000
    s_and_b32 s9, s87, 1
    s_lshl_b32 s9, s9, 4
    s_mov_b32 s12, 0x55555555
    s_mov_b32 s13, 0x55555555
    s_lshl_b32 s92, s86, 8
    s_add_u32 s92, s92, s85
    s_add_u32 s92, s92, 36
    v_lshl_add_u32 v124, v1, 2, s92
    s_movk_i32 s92, 192
    s_cmp_eq_u32 s86, 0
    s_cselect_b32 s92, 256, s92
    s_cmp_eq_u32 s86, 3
    s_cselect_b32 s92, 1344, s92
    v_mov_b32 v20, s85
    ds_write_b16 v20, v4 offset:32514
    s_mov_b32 s18, s92
    v_mov_b32 v125, v28
W_12:
    ds_read_b64 v[18:19], v4 offset:208
    s_sub_u32 s39, s39, 1
    s_cbranch_scc1 KS_ABORT
    s_waitcnt lgkmcnt(0)
    v_and_b32 v18, v18, v19
    v_cmp_ne_u32 vcc, s84, v18
    s_cbranch_vccnz W_12
    ds_read2st64_b64 v[28:31], v125 offset0:0 offset1:1
    ds_read2st64_b64 v[32:35], v125 offset0:2 offset1:3
    s_waitcnt lgkmcnt(0)
    v_add_u32_sdwa v108, s85, v28 dst_sel:DWORD dst_unused:UNUSED_PAD src0_sel:DWORD src1_sel:WORD_0
    v_add_u32_sdwa v109, s85, v28 dst_sel:DWORD dst_unused:UNUSED_PAD src0_sel:DWORD src1_sel:WORD_1
    v_cvt_f32_u32_sdwa v110, v29 dst_sel:DWORD dst_unused:UNUSED_PAD src0_sel:WORD_0
    v_cvt_f32_u32_sdwa v111, v29 dst_sel:DWORD dst_unused:UNUSED_PAD src0_sel:WORD_1
    v_add_u32_sdwa v112, s85, v30 dst_sel:DWORD dst_unused:UNUSED_PAD src0_sel:DWORD src1_sel:WORD_0
    v_add_u32_sdwa v113, s85, v30 dst_sel:DWORD dst_unused:UNUSED_PAD src0_sel:DWORD src1_sel:WORD_1
    v_cvt_f32_u32_sdwa v114, v31 dst_sel:DWORD dst_unused:UNUSED_PAD src0_sel:WORD_0
    v_cvt_f32_u32_sdwa v115, v31 dst_sel:DWORD dst_unused:UNUSED_PAD src0_sel:WORD_1
    v_add_u32_sdwa v116, s85, v32 dst_sel:DWORD dst_unused:UNUSED_PAD src0_sel:DWORD src1_sel:WORD_0
    v_add_u32_sdwa v117, s85, v32 dst_sel:DWORD dst_unused:UNUSED_PAD src0_sel:DWORD src1_sel:WORD_1
    v_add_u32_sdwa v118, s85, v33 dst_sel:DWORD dst_unused:UNUSED_PAD src0_sel:DWORD src1_sel:WORD_0
    v_add_u32_sdwa v119, s85, v33 dst_sel:DWORD dst_unused:UNUSED_PAD src0_sel:DWORD src1_sel:WORD_1
    v_add_u32_sdwa v120, s85, v34 dst_sel:DWORD dst_unused:UNUSED_PAD src0_sel:DWORD src1_sel:WORD_0
    v_add_u32_sdwa v121, s85, v34 dst_sel:DWORD dst_unused:UNUSED_PAD src0_sel:DWORD src1_sel:WORD_1
    v_add_u32_sdwa v122, s85, v35 dst_sel:DWORD dst_unused:UNUSED_PAD src0_sel:DWORD src1_sel:WORD_0
    v_add_u32_sdwa v123, s85, v35 dst_sel:DWORD dst_unused:UNUSED_PAD src0_sel:DWORD src1_sel:WORD_1
    v_add_u32 v125, s18, v119
    s_lshl_b32 s92, s87, 5
    s_add_u32 s92, s92, s41
    s_cmp_ge_u32 s92, 88
    s_cbranch_scc1 KC_RECV
    s_mov_b32 s92, 0x3fb8aa3b
    s_mov_b32 s93, 0x32a57060
    s_mov_b32 s94, 0x3e22f983
    s_mov_b32 s95, 0x31dc9c88
    s_waitcnt vmcnt(7)
    v_lshlrev_b32 v16, 16, v46
    v_mul_f32 v17, s92, v16
    v_fma_f32 v19, v16, s92, -v17
    v_fmac_f32 v19, s93, v16
    v_exp_f32 v17, v17
    v_mul_f32 v19, 0x3f317218, v19
    v_fmac_f32 v17, v17, v19
    v_cvt_pk_bf16_f32 v16, 0, v17
    s_waitcnt vmcnt(5)
    ds_write_b32 v4, v5 offset:36
    v_lshlrev_b32 v20, 16, v40
    v_and_b32 v21, 0xffff0000, v40
    v_lshlrev_b32 v22, 16, v41
    v_and_b32 v23, 0xffff0000, v41
    v_pk_mul_f32 v[20:21], v[20:21], v[16:17] op_sel_hi:[1,0]
    v_pk_mul_f32 v[22:23], v[22:23], v[16:17] op_sel_hi:[1,0]
    v_max_f32 v36, v20, v21
    v_pk_mul_f32 v[68:69], v[22:23], s[94:95] op_sel_hi:[1,0]
    v_pk_fma_f32 v[70:71], v[22:23], s[94:95], v[68:69] op_sel_hi:[1,0,1] neg_lo:[0,0,1] neg_hi:[0,0,1]
    v_pk_fma_f32 v[70:71], v[22:23], s[94:95], v[70:71] op_sel:[0,1,0]
    s_cmp_eq_u32 s86, 3
    s_cbranch_scc1 SK_14
    s_waitcnt vmcnt(1)
    v_lshlrev_b32 v24, 16, v42
    v_and_b32 v25, 0xffff0000, v42
    v_lshlrev_b32 v26, 16, v43
    v_and_b32 v27, 0xffff0000, v43
    v_lshlrev_b32 v28, 16, v44
    v_and_b32 v29, 0xffff0000, v44
    v_lshlrev_b32 v30, 16, v45
    v_and_b32 v31, 0xffff0000, v45
    v_pk_mul_f32 v[24:25], v[24:25], v[16:17] op_sel_hi:[1,0]
    v_pk_mul_f32 v[26:27], v[26:27], v[16:17] op_sel_hi:[1,0]
    v_pk_mul_f32 v[90:91], v[30:31], v[26:27]
    v_pk_mul_f32 v[92:93], v[30:31], v[24:25]
    v_pk_fma_f32 v[34:35], v[28:29], v[26:27], v[92:93]
    v_pk_fma_f32 v[32:33], v[28:29], v[24:25], v[90:91] neg_lo:[0,0,1] neg_hi:[0,0,1]
    v_max3_f32 v37, abs(v34), abs(v35), abs(v32)
    v_max_f32 v37, v37, abs(v33)
SK_14:
    s_waitcnt vmcnt(0)
    s_nop 0
    v_permlane32_swap_b32 v36, v37
    v_max_f32 v36, v36, v37
    s_nop 1
    v_max_f32_dpp v36, v36, v36 row_ror:8 row_mask:0xf bank_mask:0xf
    s_nop 1
    v_max_f32_dpp v36, v36, v36 row_ror:4 row_mask:0xf bank_mask:0xf
    s_nop 1
    v_max_f32_dpp v36, v36, v36 row_ror:2 row_mask:0xf bank_mask:0xf
    s_nop 1
    v_max_f32_dpp v36, v36, v36 row_ror:1 row_mask:0xf bank_mask:0xf
    v_mov_b32 v38, v36
    s_nop 1
    v_permlane16_swap_b32 v36, v38
    v_max_f32 v36, v36, v38
    s_nop 0
    v_readlane_b32 s14, v36, 0
    v_readlane_b32 s15, v36, 32
    s_add_u32 s15, s15, 0x7fffff
    s_lshr_b32 s15, s15, 23
    s_max_u32 s15, s15, 24
    s_sub_u32 s16, 269, s15
    s_lshl_b32 s16, s16, 23
    v_subrev_f32 v20, s14, v20
    v_subrev_f32 v21, s14, v21
    v_mul_f32 v20, 0x3fb8aa3b, v20
    v_mul_f32 v21, 0x3fb8aa3b, v21
    s_cmp_eq_u32 s86, 3
    s_cbranch_scc1 JOB_18
    s_cmp_eq_u32 s86, 1
    s_cbranch_scc1 JOB_16
    s_cmp_eq_u32 s86, 2
    s_cbranch_scc1 JOB_17
    v_mul_f32 v91, 0x43000000, v68
    v_mul_f32 v90, 0x43000000, v20
    v_mul_f32 v95, 0x43000000, v69
    v_mul_f32 v94, 0x43000000, v21
    v_fract_f32 v91, v91
    v_fract_f32 v95, v95
    v_fmac_f32 v91, 0x43000000, v70
    v_fmac_f32 v95, 0x43000000, v71
    v_exp_f32 v90, v90
    v_cos_f32 v92, v91
    v_sin_f32 v91, v91
    v_exp_f32 v94, v94
    v_cos_f32 v96, v95
    v_sin_f32 v95, v95
    v_mul_f32 v44, v90, v92
    v_mul_f32 v46, v90, v91
    v_mul_f32 v45, v94, v96
    v_mul_f32 v47, v94, v95
    v_pk_mul_f32 v[32:33], v[32:33], s[16:17] op_sel_hi:[1,0]
    v_pk_mul_f32 v[34:35], v[34:35], s[16:17] op_sel_hi:[1,0]
    v_fract_f32 v91, v68
    v_fract_f32 v95, v69
    v_fmac_f32 v91, 1.0, v70
    v_fmac_f32 v95, 1.0, v71
    v_exp_f32 v90, v20
    v_cos_f32 v92, v91
    v_sin_f32 v91, v91
    v_exp_f32 v94, v21
    v_cos_f32 v96, v95
    v_sin_f32 v95, v95
    v_mul_f32 v40, v90, v92
    v_mul_f32 v42, v90, v91
    v_mul_f32 v41, v94, v96
    v_mul_f32 v43, v94, v95
    v_pk_mul_f32 v[90:91], v[34:35], v[46:47]
    v_pk_mul_f32 v[94:95], v[34:35], v[42:43]
    v_pk_mul_f32 v[92:93], v[34:35], v[44:45]
    v_pk_mul_f32 v[96:97], v[34:35], v[40:41]
    v_pk_fma_f32 v[62:63], v[32:33], v[46:47], v[92:93]
    v_pk_fma_f32 v[54:55], v[32:33], v[42:43], v[96:97]
    v_pk_fma_f32 v[60:61], v[32:33], v[44:45], v[90:91] neg_lo:[0,0,1] neg_hi:[0,0,1]
    v_pk_fma_f32 v[52:53], v[32:33], v[40:41], v[94:95] neg_lo:[0,0,1] neg_hi:[0,0,1]
    v_cvt_pk_f16_f32 v98, v32, v34
    v_cvt_pk_f16_f32 v99, v33, v35
    v_cvt_pk_f16_f32 v100, v60, v62
    v_cvt_pk_f16_f32 v101, v61, v63
    ds_write2_b64 v72, v[98:99], v[100:101] offset0:0 offset1:68
    v_pk_mul_f32 v[90:91], v[54:55], v[46:47]
    v_pk_mul_f32 v[94:95], v[54:55], v[42:43]
    v_pk_mul_f32 v[92:93], v[54:55], v[44:45]
    v_pk_mul_f32 v[96:97], v[54:55], v[40:41]
    v_pk_fma_f32 v[62:63], v[52:53], v[46:47], v[92:93]
    v_pk_fma_f32 v[58:59], v[52:53], v[42:43], v[96:97]
    v_pk_fma_f32 v[60:61], v[52:53], v[44:45], v[90:91] neg_lo:[0,0,1] neg_hi:[0,0,1]
    v_pk_fma_f32 v[56:57], v[52:53], v[40:41], v[94:95] neg_lo:[0,0,1] neg_hi:[0,0,1]
    v_cvt_pk_f16_f32 v76, v52, v54
    v_cvt_pk_f16_f32 v77, v53, v55
    v_cvt_pk_f16_f32 v78, v60, v62
    v_cvt_pk_f16_f32 v79, v61, v63
    ds_write2_b64 v72, v[76:77], v[78:79] offset0:136 offset1:204
    v_pk_mul_f32 v[90:91], v[58:59], v[46:47]
    v_pk_mul_f32 v[94:95], v[58:59], v[42:43]
    v_pk_mul_f32 v[92:93], v[58:59], v[44:45]
    v_pk_mul_f32 v[96:97], v[58:59], v[40:41]
    v_pk_fma_f32 v[62:63], v[56:57], v[46:47], v[92:93]
    v_pk_fma_f32 v[54:55], v[56:57], v[42:43], v[96:97]
    v_pk_fma_f32 v[60:61], v[56:57], v[44:45], v[90:91] neg_lo:[0,0,1] neg_hi:[0,0,1]
    v_pk_fma_f32 v[52:53], v[56:57], v[40:41], v[94:95] neg_lo:[0,0,1] neg_hi:[0,0,1]
    v_cvt_pk_f16_f32 v98, v56, v58
    v_cvt_pk_f16_f32 v99, v57, v59
    v_cvt_pk_f16_f32 v100, v60, v62
    v_cvt_pk_f16_f32 v101, v61, v63
    ds_write2_b64 v73, v[98:99], v[100:101] offset0:0 offset1:68
    v_pk_mul_f32 v[90:91], v[54:55], v[46:47]
    v_pk_mul_f32 v[94:95], v[54:55], v[42:43]
    v_pk_mul_f32 v[92:93], v[54:55], v[44:45]
    v_pk_mul_f32 v[96:97], v[54:55], v[40:41]
    v_pk_fma_f32 v[62:63], v[52:53], v[46:47], v[92:93]
    v_pk_fma_f32 v[58:59], v[52:53], v[42:43], v[96:97]
    v_pk_fma_f32 v[60:61], v[52:53], v[44:45], v[90:91] neg_lo:[0,0,1] neg_hi:[0,0,1]
    v_pk_fma_f32 v[56:57], v[52:53], v[40:41], v[94:95] neg_lo:[0,0,1] neg_hi:[0,0,1]
    v_cvt_pk_f16_f32 v76, v52, v54
    v_cvt_pk_f16_f32 v77, v53, v55
    v_cvt_pk_f16_f32 v78, v60, v62
    v_cvt_pk_f16_f32 v79, v61, v63
    ds_write2_b64 v73, v[76:77], v[78:79] offset0:136 offset1:204
    v_pk_mul_f32 v[90:91], v[58:59], v[46:47]
    v_pk_mul_f32 v[94:95], v[58:59], v[42:43]
    v_pk_mul_f32 v[92:93], v[58:59], v[44:45]
    v_pk_mul_f32 v[96:97], v[58:59], v[40:41]
    v_pk_fma_f32 v[62:63], v[56:57], v[46:47], v[92:93]
    v_pk_fma_f32 v[54:55], v[56:57], v[42:43], v[96:97]
    v_pk_fma_f32 v[60:61], v[56:57], v[44:45], v[90:91] neg_lo:[0,0,1] neg_hi:[0,0,1]
    v_pk_fma_f32 v[52:53], v[56:57], v[40:41], v[94:95] neg_lo:[0,0,1] neg_hi:[0,0,1]
    v_cvt_pk_f16_f32 v98, v56, v58
    v_cvt_pk_f16_f32 v99, v57, v59
    v_cvt_pk_f16_f32 v100, v60, v62
    v_cvt_pk_f16_f32 v101, v61, v63
    ds_write2_b64 v74, v[98:99], v[100:101] offset0:0 offset1:68
    v_pk_mul_f32 v[90:91], v[54:55], v[46:47]
    v_pk_mul_f32 v[94:95], v[54:55], v[42:43]
    v_pk_mul_f32 v[92:93], v[54:55], v[44:45]
    v_pk_mul_f32 v[96:97], v[54:55], v[40:41]
    v_pk_fma_f32 v[62:63], v[52:53], v[46:47], v[92:93]
    v_pk_fma_f32 v[58:59], v[52:53], v[42:43], v[96:97]
    v_pk_fma_f32 v[60:61], v[52:53], v[44:45], v[90:91] neg_lo:[0,0,1] neg_hi:[0,0,1]
    v_pk_fma_f32 v[56:57], v[52:53], v[40:41], v[94:95] neg_lo:[0,0,1] neg_hi:[0,0,1]
    v_cvt_pk_f16_f32 v76, v52, v54
    v_cvt_pk_f16_f32 v77, v53, v55
    v_cvt_pk_f16_f32 v78, v60, v62
    v_cvt_pk_f16_f32 v79, v61, v63
    ds_write2_b64 v74, v[76:77], v[78:79] offset0:136 offset1:204
    v_pk_mul_f32 v[90:91], v[58:59], v[46:47]
    v_pk_mul_f32 v[94:95], v[58:59], v[42:43]
    v_pk_mul_f32 v[92:93], v[58:59], v[44:45]
    v_pk_mul_f32 v[96:97], v[58:59], v[40:41]
    v_pk_fma_f32 v[62:63], v[56:57], v[46:47], v[92:93]
    v_pk_fma_f32 v[54:55], v[56:57], v[42:43], v[96:97]
    v_pk_fma_f32 v[60:61], v[56:57], v[44:45], v[90:91] neg_lo:[0,0,1] neg_hi:[0,0,1]
    v_pk_fma_f32 v[52:53], v[56:57], v[40:41], v[94:95] neg_lo:[0,0,1] neg_hi:[0,0,1]
    v_cvt_pk_f16_f32 v98, v56, v58
    v_cvt_pk_f16_f32 v99, v57, v59
    v_cvt_pk_f16_f32 v100, v60, v62
    v_cvt_pk_f16_f32 v101, v61, v63
    ds_write2_b64 v75, v[98:99], v[100:101] offset0:0 offset1:68
    v_pk_mul_f32 v[90:91], v[54:55], v[46:47]
    v_pk_mul_f32 v[92:93], v[54:55], v[44:45]
    v_pk_fma_f32 v[62:63], v[52:53], v[46:47], v[92:93]
    v_pk_fma_f32 v[60:61], v[52:53], v[44:45], v[90:91] neg_lo:[0,0,1] neg_hi:[0,0,1]
    v_cvt_pk_f16_f32 v76, v52, v54
    v_cvt_pk_f16_f32 v77, v53, v55
    v_cvt_pk_f16_f32 v78, v60, v62
    v_cvt_pk_f16_f32 v79, v61, v63
    ds_write2_b64 v75, v[76:77], v[78:79] offset0:136 offset1:204
    s_branch JOBJ_19
JOB_16:
    v_mul_f32 v91, 0x43000000, v68
    v_mul_f32 v90, 0x43000000, v20
    v_mul_f32 v95, 0x43000000, v69
    v_mul_f32 v94, 0x43000000, v21
    v_fract_f32 v91, v91
    v_fract_f32 v95, v95
    v_fmac_f32 v91, 0x43000000, v70
    v_fmac_f32 v95, 0x43000000, v71
    v_exp_f32 v90, v90
    v_cos_f32 v92, v91
    v_sin_f32 v91, v91
    v_exp_f32 v94, v94
    v_cos_f32 v96, v95
    v_sin_f32 v95, v95
    v_mul_f32 v44, v90, v92
    v_mul_f32 v46, v90, v91
    v_mul_f32 v45, v94, v96
    v_mul_f32 v47, v94, v95
    v_pk_mul_f32 v[32:33], v[32:33], s[16:17] op_sel_hi:[1,0]
    v_pk_mul_f32 v[34:35], v[34:35], s[16:17] op_sel_hi:[1,0]
    v_pk_mul_f32 v[90:91], v[46:47], v[46:47]
    v_pk_mul_f32 v[92:93], v[44:45], v[46:47]
    v_pk_fma_f32 v[48:49], v[44:45], v[44:45], v[90:91] neg_lo:[0,0,1] neg_hi:[0,0,1]
    v_pk_add_f32 v[50:51], v[92:93], v[92:93]
    v_mul_f32 v91, 2.0, v68
    v_mul_f32 v90, 2.0, v20
    v_mul_f32 v95, 2.0, v69
    v_mul_f32 v94, 2.0, v21
    v_fract_f32 v91, v91
    v_fract_f32 v95, v95
    v_fmac_f32 v91, 2.0, v70
    v_fmac_f32 v95, 2.0, v71
    v_exp_f32 v90, v90
    v_cos_f32 v92, v91
    v_sin_f32 v91, v91
    v_exp_f32 v94, v94
    v_cos_f32 v96, v95
    v_sin_f32 v95, v95
    v_mul_f32 v40, v90, v92
    v_mul_f32 v42, v90, v91
    v_mul_f32 v41, v94, v96
    v_mul_f32 v43, v94, v95
    v_pk_mul_f32 v[90:91], v[34:35], v[50:51]
    v_pk_mul_f32 v[92:93], v[34:35], v[48:49]
    v_pk_fma_f32 v[54:55], v[32:33], v[50:51], v[92:93]
    v_pk_fma_f32 v[52:53], v[32:33], v[48:49], v[90:91] neg_lo:[0,0,1] neg_hi:[0,0,1]
    v_pk_mul_f32 v[90:91], v[54:55], v[50:51]
    v_pk_mul_f32 v[92:93], v[54:55], v[48:49]
    v_pk_fma_f32 v[66:67], v[52:53], v[50:51], v[92:93]
    v_pk_fma_f32 v[64:65], v[52:53], v[48:49], v[90:91] neg_lo:[0,0,1] neg_hi:[0,0,1]
    v_pk_mul_f32 v[90:91], v[54:55], v[46:47]
    v_pk_mul_f32 v[94:95], v[54:55], v[42:43]
    v_pk_mul_f32 v[92:93], v[54:55], v[44:45]
    v_pk_mul_f32 v[96:97], v[54:55], v[40:41]
    v_pk_fma_f32 v[62:63], v[52:53], v[46:47], v[92:93]
    v_pk_fma_f32 v[58:59], v[52:53], v[42:43], v[96:97]
    v_pk_fma_f32 v[60:61], v[52:53], v[44:45], v[90:91] neg_lo:[0,0,1] neg_hi:[0,0,1]
    v_pk_fma_f32 v[56:57], v[52:53], v[40:41], v[94:95] neg_lo:[0,0,1] neg_hi:[0,0,1]
    v_cvt_pk_f16_f32 v98, v52, v54
    v_cvt_pk_f16_f32 v99, v53, v55
    v_cvt_pk_f16_f32 v100, v60, v62
    v_cvt_pk_f16_f32 v101, v61, v63
    ds_write2_b64 v72, v[98:99], v[100:101] offset0:0 offset1:68
    v_pk_mul_f32 v[90:91], v[58:59], v[46:47]
    v_pk_mul_f32 v[94:95], v[58:59], v[42:43]
    v_pk_mul_f32 v[92:93], v[58:59], v[44:45]
    v_pk_mul_f32 v[96:97], v[58:59], v[40:41]
    v_pk_fma_f32 v[62:63], v[56:57], v[46:47], v[92:93]
    v_pk_fma_f32 v[54:55], v[56:57], v[42:43], v[96:97]
    v_pk_fma_f32 v[60:61], v[56:57], v[44:45], v[90:91] neg_lo:[0,0,1] neg_hi:[0,0,1]
    v_pk_fma_f32 v[52:53], v[56:57], v[40:41], v[94:95] neg_lo:[0,0,1] neg_hi:[0,0,1]
    v_cvt_pk_f16_f32 v76, v56, v58
    v_cvt_pk_f16_f32 v77, v57, v59
    v_cvt_pk_f16_f32 v78, v60, v62
    v_cvt_pk_f16_f32 v79, v61, v63
    ds_write2_b64 v72, v[76:77], v[78:79] offset0:136 offset1:204
    v_pk_mul_f32 v[90:91], v[54:55], v[46:47]
    v_pk_mul_f32 v[94:95], v[54:55], v[42:43]
    v_pk_mul_f32 v[92:93], v[54:55], v[44:45]
    v_pk_mul_f32 v[96:97], v[54:55], v[40:41]
    v_pk_fma_f32 v[62:63], v[52:53], v[46:47], v[92:93]
    v_pk_fma_f32 v[58:59], v[52:53], v[42:43], v[96:97]
    v_pk_fma_f32 v[60:61], v[52:53], v[44:45], v[90:91] neg_lo:[0,0,1] neg_hi:[0,0,1]
    v_pk_fma_f32 v[56:57], v[52:53], v[40:41], v[94:95] neg_lo:[0,0,1] neg_hi:[0,0,1]
    v_cvt_pk_f16_f32 v98, v52, v54
    v_cvt_pk_f16_f32 v99, v53, v55
    v_cvt_pk_f16_f32 v100, v60, v62
    v_cvt_pk_f16_f32 v101, v61, v63
    ds_write2_b64 v73, v[98:99], v[100:101] offset0:0 offset1:68
    v_pk_mul_f32 v[90:91], v[58:59], v[46:47]
    v_pk_mul_f32 v[94:95], v[42:43], v[42:43]
    v_pk_mul_f32 v[92:93], v[58:59], v[44:45]
    v_pk_mul_f32 v[96:97], v[40:41], v[42:43]
    v_pk_fma_f32 v[62:63], v[56:57], v[46:47], v[92:93]
    v_pk_fma_f32 v[48:49], v[40:41], v[40:41], v[94:95] neg_lo:[0,0,1] neg_hi:[0,0,1]
    v_pk_fma_f32 v[60:61], v[56:57], v[44:45], v[90:91] neg_lo:[0,0,1] neg_hi:[0,0,1]
    v_pk_add_f32 v[50:51], v[96:97], v[96:97]
    v_cvt_pk_f16_f32 v76, v56, v58
    v_cvt_pk_f16_f32 v77, v57, v59
    v_cvt_pk_f16_f32 v78, v60, v62
    v_cvt_pk_f16_f32 v79, v61, v63
    ds_write2_b64 v73, v[76:77], v[78:79] offset0:136 offset1:204
    v_pk_mul_f32 v[90:91], v[66:67], v[50:51]
    v_pk_mul_f32 v[94:95], v[66:67], v[46:47]
    v_pk_mul_f32 v[92:93], v[66:67], v[48:49]
    v_pk_mul_f32 v[96:97], v[66:67], v[44:45]
    v_pk_fma_f32 v[62:63], v[64:65], v[50:51], v[92:93]
    v_pk_fma_f32 v[54:55], v[64:65], v[46:47], v[96:97]
    v_pk_fma_f32 v[60:61], v[64:65], v[48:49], v[90:91] neg_lo:[0,0,1] neg_hi:[0,0,1]
    v_pk_fma_f32 v[52:53], v[64:65], v[44:45], v[94:95] neg_lo:[0,0,1] neg_hi:[0,0,1]
    v_cvt_pk_f16_f32 v98, v64, v66
    v_cvt_pk_f16_f32 v99, v65, v67
    v_cvt_pk_f16_f32 v100, v60, v62
    v_cvt_pk_f16_f32 v101, v61, v63
    ds_write2_b64 v74, v[98:99], v[100:101] offset0:0 offset1:68
    v_pk_mul_f32 v[90:91], v[54:55], v[50:51]
    v_pk_mul_f32 v[94:95], v[54:55], v[46:47]
    v_pk_mul_f32 v[92:93], v[54:55], v[48:49]
    v_pk_mul_f32 v[96:97], v[54:55], v[44:45]
    v_pk_fma_f32 v[62:63], v[52:53], v[50:51], v[92:93]
    v_pk_fma_f32 v[58:59], v[52:53], v[46:47], v[96:97]
    v_pk_fma_f32 v[60:61], v[52:53], v[48:49], v[90:91] neg_lo:[0,0,1] neg_hi:[0,0,1]
    v_pk_fma_f32 v[56:57], v[52:53], v[44:45], v[94:95] neg_lo:[0,0,1] neg_hi:[0,0,1]
    v_cvt_pk_f16_f32 v76, v52, v54
    v_cvt_pk_f16_f32 v77, v53, v55
    v_cvt_pk_f16_f32 v78, v60, v62
    v_cvt_pk_f16_f32 v79, v61, v63
    ds_write2_b64 v74, v[76:77], v[78:79] offset0:136 offset1:204
    v_pk_mul_f32 v[90:91], v[58:59], v[50:51]
    v_pk_mul_f32 v[94:95], v[58:59], v[46:47]
    v_pk_mul_f32 v[92:93], v[58:59], v[48:49]
    v_pk_mul_f32 v[96:97], v[58:59], v[44:45]
    v_pk_fma_f32 v[62:63], v[56:57], v[50:51], v[92:93]
    v_pk_fma_f32 v[54:55], v[56:57], v[46:47], v[96:97]
    v_pk_fma_f32 v[60:61], v[56:57], v[48:49], v[90:91] neg_lo:[0,0,1] neg_hi:[0,0,1]
    v_pk_fma_f32 v[52:53], v[56:57], v[44:45], v[94:95] neg_lo:[0,0,1] neg_hi:[0,0,1]
    v_cvt_pk_f16_f32 v98, v56, v58
    v_cvt_pk_f16_f32 v99, v57, v59
    v_cvt_pk_f16_f32 v100, v60, v62
    v_cvt_pk_f16_f32 v101, v61, v63
    ds_write2_b64 v75, v[98:99], v[100:101] offset0:0 offset1:68
    v_pk_mul_f32 v[90:91], v[54:55], v[50:51]
    v_pk_mul_f32 v[92:93], v[54:55], v[48:49]
    v_pk_fma_f32 v[62:63], v[52:53], v[50:51], v[92:93]
    v_pk_fma_f32 v[60:61], v[52:53], v[48:49], v[90:91] neg_lo:[0,0,1] neg_hi:[0,0,1]
    v_cvt_pk_f16_f32 v76, v52, v54
    v_cvt_pk_f16_f32 v77, v53, v55
    v_cvt_pk_f16_f32 v78, v60, v62
    v_cvt_pk_f16_f32 v79, v61, v63
    ds_write2_b64 v75, v[76:77], v[78:79] offset0:136 offset1:204
    s_branch JOBJ_19
JOB_18:
    v_mul_f32 v91, 0x41000000, v68
    v_mul_f32 v90, 0x41000000, v20
    v_mul_f32 v95, 0x41000000, v69
    v_mul_f32 v94, 0x41000000, v21
    v_fract_f32 v91, v91
    v_fract_f32 v95, v95
    v_fmac_f32 v91, 0x41000000, v70
    v_fmac_f32 v95, 0x41000000, v71
    v_exp_f32 v90, v90
    v_cos_f32 v92, v91
    v_sin_f32 v91, v91
    v_exp_f32 v94, v94
    v_cos_f32 v96, v95
    v_sin_f32 v95, v95
    v_mul_f32 v40, v90, v92
    v_mul_f32 v42, v90, -v91
    v_mul_f32 v41, v94, v96
    v_mul_f32 v43, v94, -v95
    v_mov_b32 v52, 0x47000000
    v_mov_b32 v53, 0x47000000
    v_mov_b32 v54, 0
    v_mov_b32 v55, 0
    v_pk_mul_f32 v[90:91], v[42:43], v[42:43]
    v_pk_mul_f32 v[60:61], v[40:41], v[52:53]
    v_pk_mul_f32 v[92:93], v[40:41], v[42:43]
    v_pk_mul_f32 v[62:63], v[42:43], v[52:53]
    v_pk_fma_f32 v[44:45], v[40:41], v[40:41], v[90:91] neg_lo:[0,0,1] neg_hi:[0,0,1]
    v_pk_add_f32 v[46:47], v[92:93], v[92:93]
    v_pk_mul_f32 v[56:57], v[44:45], v[52:53]
    v_pk_mul_f32 v[94:95], v[62:63], v[46:47]
    v_pk_mul_f32 v[58:59], v[46:47], v[52:53]
    v_pk_mul_f32 v[96:97], v[62:63], v[44:45]
    v_pk_fma_f32 v[66:67], v[60:61], v[46:47], v[96:97]
    v_pk_fma_f32 v[64:65], v[60:61], v[44:45], v[94:95] neg_lo:[0,0,1] neg_hi:[0,0,1]
    v_cvt_pk_f16_f32 v98, v52, v54
    v_cvt_pk_f16_f32 v99, v53, v55
    v_cvt_pk_f16_f32 v100, v60, v62
    v_cvt_pk_f16_f32 v101, v61, v63
    ds_write2_b64 v72, v[98:99], v[100:101] offset0:0 offset1:68
    v_pk_mul_f32 v[90:91], v[58:59], v[46:47]
    v_pk_mul_f32 v[94:95], v[66:67], v[46:47]
    v_pk_mul_f32 v[92:93], v[58:59], v[44:45]
    v_pk_mul_f32 v[96:97], v[66:67], v[44:45]
    v_pk_fma_f32 v[54:55], v[56:57], v[46:47], v[92:93]
    v_pk_fma_f32 v[62:63], v[64:65], v[46:47], v[96:97]
    v_pk_fma_f32 v[52:53], v[56:57], v[44:45], v[90:91] neg_lo:[0,0,1] neg_hi:[0,0,1]
    v_pk_fma_f32 v[60:61], v[64:65], v[44:45], v[94:95] neg_lo:[0,0,1] neg_hi:[0,0,1]
    v_cvt_pk_f16_f32 v76, v56, v58
    v_cvt_pk_f16_f32 v77, v57, v59
    v_cvt_pk_f16_f32 v78, v64, v66
    v_cvt_pk_f16_f32 v79, v65, v67
    ds_write2_b64 v72, v[76:77], v[78:79] offset0:136 offset1:204
    v_pk_mul_f32 v[90:91], v[54:55], v[46:47]
    v_pk_mul_f32 v[94:95], v[62:63], v[46:47]
    v_pk_mul_f32 v[92:93], v[54:55], v[44:45]
    v_pk_mul_f32 v[96:97], v[62:63], v[44:45]
    v_pk_fma_f32 v[58:59], v[52:53], v[46:47], v[92:93]
    v_pk_fma_f32 v[66:67], v[60:61], v[46:47], v[96:97]
    v_pk_fma_f32 v[56:57], v[52:53], v[44:45], v[90:91] neg_lo:[0,0,1] neg_hi:[0,0,1]
    v_pk_fma_f32 v[64:65], v[60:61], v[44:45], v[94:95] neg_lo:[0,0,1] neg_hi:[0,0,1]
    v_cvt_pk_f16_f32 v98, v52, v54
    v_cvt_pk_f16_f32 v99, v53, v55
    v_cvt_pk_f16_f32 v100, v60, v62
    v_cvt_pk_f16_f32 v101, v61, v63
    ds_write2_b64 v73, v[98:99], v[100:101] offset0:0 offset1:68
    v_pk_mul_f32 v[90:91], v[58:59], v[46:47]
    v_pk_mul_f32 v[94:95], v[66:67], v[46:47]
    v_pk_mul_f32 v[92:93], v[58:59], v[44:45]
    v_pk_mul_f32 v[96:97], v[66:67], v[44:45]
    v_pk_fma_f32 v[54:55], v[56:57], v[46:47], v[92:93]
    v_pk_fma_f32 v[62:63], v[64:65], v[46:47], v[96:97]
    v_pk_fma_f32 v[52:53], v[56:57], v[44:45], v[90:91] neg_lo:[0,0,1] neg_hi:[0,0,1]
    v_pk_fma_f32 v[60:61], v[64:65], v[44:45], v[94:95] neg_lo:[0,0,1] neg_hi:[0,0,1]
    v_cvt_pk_f16_f32 v76, v56, v58
    v_cvt_pk_f16_f32 v77, v57, v59
    v_cvt_pk_f16_f32 v78, v64, v66
    v_cvt_pk_f16_f32 v79, v65, v67
    ds_write2_b64 v73, v[76:77], v[78:79] offset0:136 offset1:204
    v_pk_mul_f32 v[90:91], v[54:55], v[46:47]
    v_pk_mul_f32 v[94:95], v[62:63], v[46:47]
    v_pk_mul_f32 v[92:93], v[54:55], v[44:45]
    v_pk_mul_f32 v[96:97], v[62:63], v[44:45]
    v_pk_fma_f32 v[58:59], v[52:53], v[46:47], v[92:93]
    v_pk_fma_f32 v[66:67], v[60:61], v[46:47], v[96:97]
    v_pk_fma_f32 v[56:57], v[52:53], v[44:45], v[90:91] neg_lo:[0,0,1] neg_hi:[0,0,1]
    v_pk_fma_f32 v[64:65], v[60:61], v[44:45], v[94:95] neg_lo:[0,0,1] neg_hi:[0,0,1]
    v_cvt_pk_f16_f32 v98, v52, v54
    v_cvt_pk_f16_f32 v99, v53, v55
    v_cvt_pk_f16_f32 v100, v60, v62
    v_cvt_pk_f16_f32 v101, v61, v63
    ds_write2_b64 v74, v[98:99], v[100:101] offset0:0 offset1:68
    v_pk_mul_f32 v[90:91], v[58:59], v[46:47]
    v_pk_mul_f32 v[94:95], v[66:67], v[46:47]
    v_pk_mul_f32 v[92:93], v[58:59], v[44:45]
    v_pk_mul_f32 v[96:97], v[66:67], v[44:45]
    v_pk_fma_f32 v[54:55], v[56:57], v[46:47], v[92:93]
    v_pk_fma_f32 v[62:63], v[64:65], v[46:47], v[96:97]
    v_pk_fma_f32 v[52:53], v[56:57], v[44:45], v[90:91] neg_lo:[0,0,1] neg_hi:[0,0,1]
    v_pk_fma_f32 v[60:61], v[64:65], v[44:45], v[94:95] neg_lo:[0,0,1] neg_hi:[0,0,1]
    v_cvt_pk_f16_f32 v76, v56, v58
    v_cvt_pk_f16_f32 v77, v57, v59
    v_cvt_pk_f16_f32 v78, v64, v66
    v_cvt_pk_f16_f32 v79, v65, v67
    ds_write2_b64 v74, v[76:77], v[78:79] offset0:136 offset1:204
    v_pk_mul_f32 v[90:91], v[54:55], v[46:47]
    v_pk_mul_f32 v[94:95], v[62:63], v[46:47]
    v_pk_mul_f32 v[92:93], v[54:55], v[44:45]
    v_pk_mul_f32 v[96:97], v[62:63], v[44:45]
    v_pk_fma_f32 v[58:59], v[52:53], v[46:47], v[92:93]
    v_pk_fma_f32 v[66:67], v[60:61], v[46:47], v[96:97]
    v_pk_fma_f32 v[56:57], v[52:53], v[44:45], v[90:91] neg_lo:[0,0,1] neg_hi:[0,0,1]
    v_pk_fma_f32 v[64:65], v[60:61], v[44:45], v[94:95] neg_lo:[0,0,1] neg_hi:[0,0,1]
    v_cvt_pk_f16_f32 v98, v52, v54
    v_cvt_pk_f16_f32 v99, v53, v55
    v_cvt_pk_f16_f32 v100, v60, v62
    v_cvt_pk_f16_f32 v101, v61, v63
    ds_write2_b64 v75, v[98:99], v[100:101] offset0:0 offset1:68
    v_cvt_pk_f16_f32 v76, v56, v58
    v_cvt_pk_f16_f32 v77, v57, v59
    v_cvt_pk_f16_f32 v78, v64, v66
    v_cvt_pk_f16_f32 v79, v65, v67
    ds_write2_b64 v75, v[76:77], v[78:79] offset0:136 offset1:204
    ds_write_b8 v15, v5 offset:64
    s_cmp_eq_u32 s87, 2
    s_cbranch_scc1 KS_G0
    s_branch EXP_13
KC_SEND:
W_20:
    ds_read_b32 v104, v105 offset:224
    s_sub_u32 s39, s39, 1
    s_cbranch_scc1 KS_ABORT
    s_waitcnt lgkmcnt(0)
    v_cmp_eq_u32 vcc, 0, v104
    s_cbranch_vccnz W_20
    s_lshl_b32 s92, s88, 12
    s_lshl_b32 s93, s86, 10
    s_add_u32 s92, s92, s93
    s_add_u32 s92, s92, 0x920000
    v_add_u32 v24, s92, v12
    s_mov_b32 s93, 0xffff
    v_lshlrev_b32 v25, 16, v104
    v_cvt_f16_f32 v20, v20
    v_cvt_f16_f32 v21, v21
    v_cvt_f16_f32 v22, v22
    v_cvt_f16_f32 v23, v23
    s_cmp_lg_u32 s86, 2
    s_cbranch_scc1 KC_S2
    s_mov_b32 exec_lo, 0
    s_mov_b32 exec_hi, 0xffff0000
    v_mov_b32 v20, v106
    v_lshrrev_b32 v21, 16, v106
    s_mov_b64 exec, -1
KC_S2:
    v_bfi_b32 v20, s93, v20, v104
    v_bfi_b32 v21, s93, v21, v25
    v_bfi_b32 v22, s93, v22, v104
    v_bfi_b32 v23, s93, v23, v25
    global_store_dwordx4 v24, v[20:23], s[36:37] sc1
    s_branch KS_G0
KC_RECV:
    s_cmp_eq_u32 s86, 3
    s_cbranch_scc1 EXP_13
    s_lshl_b32 s92, s88, 12
    s_lshl_b32 s93, s86, 10
    s_add_u32 s92, s92, s93
    s_add_u32 s92, s92, 0x920000
    v_add_u32 v24, s92, v12
W_21:
    s_sleep 2
    ds_read_b32 v104, v105 offset:224
    s_sub_u32 s39, s39, 1
    s_cbranch_scc1 KS_ABORT
    s_waitcnt lgkmcnt(0)
    v_cmp_eq_u32 vcc, 0, v104
    s_cbranch_vccnz W_21
    v_lshlrev_b32 v25, 16, v104
W_22:
    s_sleep 2
    ds_read_b32 v17, v4 offset:68
    s_sub_u32 s39, s39, 1
    s_cbranch_scc1 KS_ABORT
    s_waitcnt lgkmcnt(0)
    v_cmp_ne_u32 vcc, s84, v17
    s_cbranch_vccnz W_22
    s_branch KPE_24
KP_23:
    s_sleep 2
KPE_24:
    global_load_dwordx4 v[20:23], v24, s[36:37] sc1
    s_sub_u32 s39, s39, 1
    s_cbranch_scc1 KS_ABORT
    s_waitcnt vmcnt(0)
    v_xor_b32 v20, v104, v20
    v_xor_b32 v21, v25, v21
    v_xor_b32 v22, v104, v22
    v_xor_b32 v23, v25, v23
    v_or3_b32 v26, v20, v21, v22
    v_or_b32 v26, v26, v23
    v_cmp_lt_u32 vcc, 0xffff, v26
    s_cbranch_vccnz KP_23
    v_xor_b32 v20, v104, v20
    v_xor_b32 v22, v104, v22
    ds_write_b16 v108, v20
    ds_write_b16 v109, v21
    ds_write_b16 v112, v22
    ds_write_b16 v113, v23
    s_cmp_lg_u32 s86, 2
    s_cbranch_scc1 EXP_13
    v_and_b32 v20, 0xffff, v20
    v_lshl_or_b32 v20, v21, 16, v20
    v_lshlrev_b32 v21, 16, v107
    s_mov_b32 exec_lo, 0
    s_mov_b32 exec_hi, 0x10000
    ds_write_b64 v14, v[20:21] offset:832
    s_mov_b64 exec, -1
    s_branch EXP_13
JOB_17:
    v_mul_f32 v91, 0x43000000, v68
    v_mul_f32 v90, 0x43000000, v20
    v_mul_f32 v95, 0x43000000, v69
    v_mul_f32 v94, 0x43000000, v21
    v_fract_f32 v91, v91
    v_fract_f32 v95, v95
    v_fmac_f32 v91, 0x43000000, v70
    v_fmac_f32 v95, 0x43000000, v71
    v_exp_f32 v90, v90
    v_cos_f32 v92, v91
    v_sin_f32 v91, v91
    v_exp_f32 v94, v94
    v_cos_f32 v96, v95
    v_sin_f32 v95, v95
    v_mul_f32 v44, v90, v92
    v_mul_f32 v46, v90, v91
    v_mul_f32 v45, v94, v96
    v_mul_f32 v47, v94, v95
    v_pk_mul_f32 v[32:33], v[32:33], s[16:17] op_sel_hi:[1,0]
    v_pk_mul_f32 v[34:35], v[34:35], s[16:17] op_sel_hi:[1,0]
    v_pk_mul_f32 v[90:91], v[46:47], v[46:47]
    v_pk_mul_f32 v[94:95], v[34:35], v[46:47]
    v_pk_mul_f32 v[92:93], v[44:45], v[46:47]
    v_pk_mul_f32 v[96:97], v[34:35], v[44:45]
    v_pk_fma_f32 v[40:41], v[44:45], v[44:45], v[90:91] neg_lo:[0,0,1] neg_hi:[0,0,1]
    v_pk_fma_f32 v[66:67], v[32:33], v[46:47], v[96:97]
    v_pk_add_f32 v[42:43], v[92:93], v[92:93]
    v_pk_fma_f32 v[64:65], v[32:33], v[44:45], v[94:95] neg_lo:[0,0,1] neg_hi:[0,0,1]
    v_pk_mul_f32 v[90:91], v[42:43], v[42:43]
    v_pk_mul_f32 v[92:93], v[40:41], v[42:43]
    v_pk_fma_f32 v[48:49], v[40:41], v[40:41], v[90:91] neg_lo:[0,0,1] neg_hi:[0,0,1]
    v_pk_add_f32 v[50:51], v[92:93], v[92:93]
    v_pk_mul_f32 v[90:91], v[50:51], v[50:51]
    v_pk_mul_f32 v[92:93], v[48:49], v[50:51]
    v_pk_fma_f32 v[48:49], v[48:49], v[48:49], v[90:91] neg_lo:[0,0,1] neg_hi:[0,0,1]
    v_pk_add_f32 v[50:51], v[92:93], v[92:93]
    v_pk_mul_f32 v[90:91], v[34:35], v[50:51]
    v_pk_mul_f32 v[94:95], v[66:67], v[50:51]
    v_pk_mul_f32 v[92:93], v[34:35], v[48:49]
    v_pk_mul_f32 v[96:97], v[66:67], v[48:49]
    v_pk_fma_f32 v[54:55], v[32:33], v[50:51], v[92:93]
    v_pk_fma_f32 v[62:63], v[64:65], v[50:51], v[96:97]
    v_pk_fma_f32 v[52:53], v[32:33], v[48:49], v[90:91] neg_lo:[0,0,1] neg_hi:[0,0,1]
    v_pk_fma_f32 v[60:61], v[64:65], v[48:49], v[94:95] neg_lo:[0,0,1] neg_hi:[0,0,1]
    v_pk_mul_f32 v[90:91], v[54:55], v[42:43]
    v_pk_mul_f32 v[94:95], v[62:63], v[42:43]
    v_pk_mul_f32 v[92:93], v[54:55], v[40:41]
    v_pk_mul_f32 v[96:97], v[62:63], v[40:41]
    v_pk_fma_f32 v[58:59], v[52:53], v[42:43], v[92:93]
    v_pk_fma_f32 v[66:67], v[60:61], v[42:43], v[96:97]
    v_pk_fma_f32 v[56:57], v[52:53], v[40:41], v[90:91] neg_lo:[0,0,1] neg_hi:[0,0,1]
    v_pk_fma_f32 v[64:65], v[60:61], v[40:41], v[94:95] neg_lo:[0,0,1] neg_hi:[0,0,1]
    v_cvt_pk_f16_f32 v98, v52, v54
    v_cvt_pk_f16_f32 v99, v53, v55
    v_cvt_pk_f16_f32 v100, v60, v62
    v_cvt_pk_f16_f32 v101, v61, v63
    ds_write2_b64 v72, v[98:99], v[100:101] offset0:0 offset1:68
    v_pk_mul_f32 v[90:91], v[58:59], v[42:43]
    v_pk_mul_f32 v[94:95], v[66:67], v[42:43]
    v_pk_mul_f32 v[92:93], v[58:59], v[40:41]
    v_pk_mul_f32 v[96:97], v[66:67], v[40:41]
    v_pk_fma_f32 v[54:55], v[56:57], v[42:43], v[92:93]
    v_pk_fma_f32 v[62:63], v[64:65], v[42:43], v[96:97]
    v_pk_fma_f32 v[52:53], v[56:57], v[40:41], v[90:91] neg_lo:[0,0,1] neg_hi:[0,0,1]
    v_pk_fma_f32 v[60:61], v[64:65], v[40:41], v[94:95] neg_lo:[0,0,1] neg_hi:[0,0,1]
    v_cvt_pk_f16_f32 v76, v56, v58
    v_cvt_pk_f16_f32 v77, v57, v59
    v_cvt_pk_f16_f32 v78, v64, v66
    v_cvt_pk_f16_f32 v79, v65, v67
    ds_write2_b64 v72, v[76:77], v[78:79] offset0:136 offset1:204
    v_pk_mul_f32 v[90:91], v[54:55], v[42:43]
    v_pk_mul_f32 v[94:95], v[62:63], v[42:43]
    v_pk_mul_f32 v[92:93], v[54:55], v[40:41]
    v_pk_mul_f32 v[96:97], v[62:63], v[40:41]
    v_pk_fma_f32 v[58:59], v[52:53], v[42:43], v[92:93]
    v_pk_fma_f32 v[66:67], v[60:61], v[42:43], v[96:97]
    v_pk_fma_f32 v[56:57], v[52:53], v[40:41], v[90:91] neg_lo:[0,0,1] neg_hi:[0,0,1]
    v_pk_fma_f32 v[64:65], v[60:61], v[40:41], v[94:95] neg_lo:[0,0,1] neg_hi:[0,0,1]
    v_cvt_pk_f16_f32 v98, v52, v54
    v_cvt_pk_f16_f32 v99, v53, v55
    v_cvt_pk_f16_f32 v100, v60, v62
    v_cvt_pk_f16_f32 v101, v61, v63
    ds_write2_b64 v73, v[98:99], v[100:101] offset0:0 offset1:68
    v_pk_mul_f32 v[90:91], v[58:59], v[42:43]
    v_pk_mul_f32 v[92:93], v[58:59], v[40:41]
    v_pk_fma_f32 v[54:55], v[56:57], v[42:43], v[92:93]
    v_pk_fma_f32 v[52:53], v[56:57], v[40:41], v[90:91] neg_lo:[0,0,1] neg_hi:[0,0,1]
    v_cvt_pk_f16_f32 v76, v56, v58
    v_cvt_pk_f16_f32 v77, v57, v59
    v_cvt_pk_f16_f32 v78, v64, v66
    v_cvt_pk_f16_f32 v79, v65, v67
    ds_write2_b64 v73, v[76:77], v[78:79] offset0:136 offset1:204
    v_cvt_pk_f16_f32 v98, v52, v54
    v_cvt_pk_f16_f32 v99, v53, v55
    v_mov_b32 v36, 0x4538aa3b
    v_mul_f32 v24, s14, v36
    v_max_f32 v24, 0, v24
    v_exp_f32 v24, v24
    ds_write_b64 v74, v[98:99] offset:0
    s_sub_u32 s11, s15, 7
    s_lshl_b32 s11, s11, 23
    v_lshlrev_b32 v25, 16, v107
    v_mul_f32 v24, s11, v24
    v_mov_b32 v106, v24
    ds_write_b64 v14, v[24:25] offset:832
JOBJ_19:
    ds_write_b8 v15, v5 offset:64
    ds_read_b128 v[40:43], v127 offset:0
    ds_read_b128 v[44:47], v127 offset:64
    ds_read_b128 v[48:51], v127 offset:128
    ds_read_b128 v[52:55], v127 offset:192
    ds_read_b128 v[56:59], v127 offset:256
    ds_read_b128 v[60:63], v127 offset:320
    ds_read_b128 v[64:67], v127 offset:384
    ds_read_b128 v[68:71], v127 offset:448
    v_mov_b32 v36, 0x3fb8aa3b
    v_mul_f32 v36, s14, v36
    v_mul_f32 v37, 0x45000000, v36
    v_max_f32 v37, 0, v37
    v_add_f32 v37, 0x41b80000, v37
    v_fma_f32 v110, v110, v36, -v37
    v_fma_f32 v111, v111, v36, -v37
    v_fma_f32 v114, v114, v36, -v37
    v_fma_f32 v115, v115, v36, -v37
    v_exp_f32 v110, v110
    v_exp_f32 v111, v111
    v_exp_f32 v114, v114
    v_exp_f32 v115, v115
W_25:
    ds_read_u8 v17, v14 offset:67
    s_sub_u32 s39, s39, 1
    s_cbranch_scc1 KS_ABORT
    s_waitcnt lgkmcnt(0)
    v_cmp_eq_u32 vcc, 0, v17
    s_cbranch_vccnz W_25
    ds_read_b128 v[72:75], v126 offset:22304
    ds_read_b128 v[76:79], v126 offset:22368
    ds_read_b128 v[80:83], v126 offset:22432
    ds_read_b128 v[84:87], v126 offset:22496
    ds_read_b128 v[88:91], v126 offset:22560
    ds_read_b128 v[92:95], v126 offset:22624
    ds_read_b128 v[96:99], v126 offset:22688
    ds_read_b128 v[100:103], v126 offset:22752
    s_waitcnt lgkmcnt(7)
    v_mfma_f32_16x16x32_f16 v[20:23], v[40:43], v[72:75], 0
    s_waitcnt lgkmcnt(6)
    v_mfma_f32_16x16x32_f16 v[24:27], v[44:47], v[76:79], 0
    s_waitcnt lgkmcnt(5)
    v_mfma_f32_16x16x32_f16 v[20:23], v[48:51], v[80:83], v[20:23]
    s_waitcnt lgkmcnt(4)
    v_mfma_f32_16x16x32_f16 v[24:27], v[52:55], v[84:87], v[24:27]
    s_waitcnt lgkmcnt(3)
    v_mfma_f32_16x16x32_f16 v[20:23], v[56:59], v[88:91], v[20:23]
    s_waitcnt lgkmcnt(2)
    v_mfma_f32_16x16x32_f16 v[24:27], v[60:63], v[92:95], v[24:27]
    s_waitcnt lgkmcnt(1)
    v_mfma_f32_16x16x32_f16 v[20:23], v[64:67], v[96:99], v[20:23]
    s_waitcnt lgkmcnt(0)
    v_mfma_f32_16x16x32_f16 v[24:27], v[68:71], v[100:103], v[24:27]
    s_nop 7
    v_add_f32 v20, v20, v24
    v_add_f32 v21, v21, v25
    v_add_f32 v22, v22, v26
    v_add_f32 v23, v23, v27
    v_mul_f32 v20, v20, v110
    v_mul_f32 v21, v21, v111
    v_mul_f32 v22, v22, v114
    v_mul_f32 v23, v23, v115
    s_cmp_eq_u32 s87, 2
    s_cbranch_scc1 KC_SEND
    v_cvt_f16_f32 v20, v20
    ds_write_b16 v108, v20
    v_cvt_f16_f32 v21, v21
    ds_write_b16 v109, v21
    v_cvt_f16_f32 v22, v22
    ds_write_b16 v112, v22
    v_cvt_f16_f32 v23, v23
    ds_write_b16 v113, v23
EXP_13:
    ds_write_b8 v15, v5 offset:68
    v_mov_b32 v28, 0
    v_mov_b32 v29, 0
    v_mov_b32 v30, 0
    v_mov_b32 v31, 0
    v_mov_b32 v32, s85
    s_waitcnt vmcnt(0)
W_26:
    ds_read_b32 v20, v14 offset:68
    s_sub_u32 s39, s39, 1
    s_cbranch_scc1 KS_ABORT
    s_waitcnt lgkmcnt(0)
    v_cmp_ne_u32 vcc, s84, v20
    s_cbranch_vccnz W_26
    ds_read_u16 v20, v116
    ds_read_u16 v21, v117
    ds_read_u16 v22, v118
    ds_read_u16 v23, v120
    ds_read_u16 v24, v121
    ds_read_u16 v25, v122
    ds_read_u16 v26, v123
    s_mov_b64 exec, 1
    ds_write_b128 v32, v[28:31] offset:3088
    ds_write_b128 v32, v[28:31] offset:8224
    ds_write_b128 v32, v[28:31] offset:3072
    s_mov_b64 exec, -1
    s_waitcnt lgkmcnt(7)
    v_lshl_or_b32 v28, v21, 16, v20
    v_lshl_or_b32 v29, v22, 16, v21
    ds_write_b32 v124, v28 offset:32528
    ds_write_b32 v124, v29 offset:33872
    s_waitcnt lgkmcnt(5)
    v_lshl_or_b32 v30, v24, 16, v23
    v_lshl_or_b32 v31, v26, 16, v25
    ds_write_b32 v119, v30
    ds_write_b32 v125, v31
    ds_write_b8 v15, v5 offset:72
W_27:
    ds_read_b32 v20, v14 offset:72
    s_sub_u32 s39, s39, 1
    s_cbranch_scc1 KS_ABORT
    s_waitcnt lgkmcnt(0)
    v_cmp_ne_u32 vcc, s84, v20
    s_cbranch_vccnz W_27
    ds_read_b64 v[16:17], v14 offset:832
    s_cmp_eq_u32 s86, 1
    s_cbranch_scc1 CV_29
    s_cmp_eq_u32 s86, 2
    s_cbranch_scc1 CV_30
    s_cmp_eq_u32 s86, 3
    s_cbranch_scc1 CV_31
    ds_read2_b32 v[32:33], v6 offset0:144 offset1:145
    ds_read2_b32 v[34:35], v6 offset0:146 offset1:147
    ds_read2_b32 v[36:37], v6 offset0:16 offset1:17
    ds_read2_b32 v[38:39], v6 offset0:18 offset1:19
    ds_read2_b32 v[40:41], v6 offset0:160 offset1:161
    ds_read2_b32 v[42:43], v6 offset0:162 offset1:163
    ds_read2_b32 v[44:45], v6 offset0:32 offset1:33
    ds_read2_b32 v[46:47], v6 offset0:34 offset1:35
    ds_read2_b32 v[48:49], v6 offset0:176 offset1:177
    ds_read2_b32 v[50:51], v6 offset0:178 offset1:179
    ds_read2_b32 v[52:53], v6 offset0:48 offset1:49
    ds_read2_b32 v[54:55], v6 offset0:50 offset1:51
    ds_read2_b32 v[56:57], v6 offset0:192 offset1:193
    ds_read2_b32 v[58:59], v6 offset0:194 offset1:195
    ds_read2_b32 v[60:61], v6 offset0:64 offset1:65
    ds_read2_b32 v[62:63], v6 offset0:66 offset1:67
    ds_read2_b32 v[64:65], v6 offset0:208 offset1:209
    ds_read2_b32 v[66:67], v6 offset0:210 offset1:211
    ds_read2_b32 v[68:69], v6 offset0:80 offset1:81
    ds_read2_b32 v[70:71], v6 offset0:82 offset1:83
    ds_read2_b32 v[72:73], v6 offset0:224 offset1:225
    ds_read2_b32 v[74:75], v6 offset0:226 offset1:227
    ds_read2_b32 v[76:77], v6 offset0:96 offset1:97
    ds_read2_b32 v[78:79], v6 offset0:98 offset1:99
    ds_read2_b32 v[80:81], v6 offset0:240 offset1:241
    ds_read2_b32 v[82:83], v6 offset0:242 offset1:243
    ds_read2_b32 v[84:85], v6 offset0:112 offset1:113
    ds_read2_b32 v[86:87], v6 offset0:114 offset1:115
    ds_read2_b32 v[88:89], v7 offset0:96 offset1:97
    ds_read2_b32 v[90:91], v7 offset0:98 offset1:99
    ds_read2_b32 v[92:93], v6 offset0:128 offset1:129
    ds_read2_b32 v[94:95], v6 offset0:130 offset1:131
    v_lshlrev_b32 v18, 3, v3
    v_sub_u32 v18, v8, v18
    v_lshrrev_b32 v19, 2, v2
    v_lshl_add_u32 v19, v19, 2, v3
    v_and_b32 v28, 3, v2
    v_lshlrev_b32 v28, 4, v28
    v_mul_u32_u24 v19, s8, v19
    v_xor_b32 v19, s10, v19
    s_waitcnt lgkmcnt(0)
    v_mov_b32 v7, v18
    v_add_u32 v6, v19, v28
    v_xor_b32 v12, s9, v12
W_33:
    ds_read_b32 v18, v4 offset:16
    s_sub_u32 s39, s39, 1
    s_cbranch_scc1 KS_ABORT
    s_waitcnt lgkmcnt(0)
    v_cmp_ne_u32 vcc, s84, v18
    s_cbranch_vccnz W_33
    s_setprio 1
    ds_read_b128 v[96:99], v8 offset:0
    ds_read_b128 v[100:103], v8 offset:64
    ds_read_b128 v[104:107], v8 offset:128
    ds_read_b128 v[108:111], v8 offset:192
    s_waitcnt lgkmcnt(3)
    v_mfma_f32_16x16x32_f16 v[20:23], v[32:35], v[96:99], 0
    v_mfma_f32_16x16x32_f16 v[24:27], v[36:39], v[96:99], 0
    ds_read_b128 v[112:115], v8 offset:256
    s_waitcnt lgkmcnt(3)
    v_mfma_f32_16x16x32_f16 v[20:23], v[40:43], v[100:103], v[20:23]
    ds_read_b64 v[28:29], v7 offset:480
    ds_read_b64 v[30:31], v7 offset:992
    v_mfma_f32_16x16x32_f16 v[24:27], v[44:47], v[100:103], v[24:27]
    ds_read_b128 v[116:119], v8 offset:320
    s_waitcnt lgkmcnt(5)
    v_mfma_f32_16x16x32_f16 v[20:23], v[48:51], v[104:107], v[20:23]
    v_mfma_f32_16x16x32_f16 v[24:27], v[52:55], v[104:107], v[24:27]
    ds_read_b128 v[120:123], v8 offset:384
    s_waitcnt lgkmcnt(2)
    v_fma_mix_f32 v104, v28, v17, 0 op_sel_hi:[1,0,0]
    v_fma_mix_f32 v105, v28, v17, 0 op_sel:[1,0,0] op_sel_hi:[1,0,0]
    v_mfma_f32_16x16x32_f16 v[20:23], v[56:59], v[108:111], v[20:23]
    v_fma_mix_f32 v106, v29, v17, 0 op_sel_hi:[1,0,0]
    v_fma_mix_f32 v107, v29, v17, 0 op_sel:[1,0,0] op_sel_hi:[1,0,0]
    v_mfma_f32_16x16x32_f16 v[24:27], v[60:63], v[108:111], v[24:27]
    ds_read_b128 v[124:127], v8 offset:448
    v_cvt_pk_bf16_f32 v104, 0, v104
    v_cvt_pk_bf16_f32 v105, 0, v105
    v_mfma_f32_16x16x32_f16 v[20:23], v[64:67], v[112:115], v[20:23]
    v_cvt_pk_bf16_f32 v106, 0, v106
    v_cvt_pk_bf16_f32 v107, 0, v107
    v_mfma_f32_16x16x32_f16 v[24:27], v[68:71], v[112:115], v[24:27]
    ds_read_b128 v[36:39], v8 offset:512
    v_fma_mix_f32 v112, v30, v17, 0 op_sel_hi:[1,0,0]
    v_fma_mix_f32 v113, v30, v17, 0 op_sel:[1,0,0] op_sel_hi:[1,0,0]
    s_waitcnt lgkmcnt(3)
    v_mfma_f32_16x16x32_f16 v[20:23], v[72:75], v[116:119], v[20:23]
    ds_read_b128 v[96:99], v8 offset:576
    v_fma_mix_f32 v114, v31, v17, 0 op_sel_hi:[1,0,0]
    v_fma_mix_f32 v115, v31, v17, 0 op_sel:[1,0,0] op_sel_hi:[1,0,0]
    v_mfma_f32_16x16x32_f16 v[24:27], v[76:79], v[116:119], v[24:27]
    ds_read_b128 v[44:47], v8 offset:640
    v_cvt_pk_bf16_f32 v112, 0, v112
    v_cvt_pk_bf16_f32 v113, 0, v113
    s_waitcnt lgkmcnt(4)
    v_mfma_f32_16x16x32_f16 v[20:23], v[80:83], v[120:123], v[20:23]
    ds_read_b128 v[100:103], v8 offset:704
    v_cvt_pk_bf16_f32 v114, 0, v114
    v_cvt_pk_bf16_f32 v115, 0, v115
    v_mfma_f32_16x16x32_f16 v[24:27], v[84:87], v[120:123], v[24:27]
    ds_read_b128 v[52:55], v8 offset:768
    s_waitcnt lgkmcnt(5)
    v_mfma_f32_16x16x32_f16 v[20:23], v[88:91], v[124:127], v[20:23]
    ds_read_b128 v[60:63], v8 offset:832
    v_mfma_f32_16x16x32_f16 v[24:27], v[92:95], v[124:127], v[24:27]
    ds_read_b128 v[108:111], v8 offset:896
    s_waitcnt lgkmcnt(6)
    v_mfma_f32_16x16x32_f16 v[24:27], v[32:35], v[36:39], v[24:27]
    ds_read_b128 v[68:71], v8 offset:960
    s_nop 1
    v_mul_f32 v20, v20, v16
    v_mul_f32 v21, v21, v16
    s_waitcnt lgkmcnt(6)
    v_mfma_f32_16x16x32_f16 v[24:27], v[40:43], v[96:99], v[24:27]
    v_mul_f32 v22, v22, v16
    v_mul_f32 v23, v23, v16
    s_waitcnt lgkmcnt(5)
    v_mfma_f32_16x16x32_f16 v[24:27], v[48:51], v[44:47], v[24:27]
    v_cvt_pk_bf16_f32 v20, 0, v20
    v_cvt_pk_bf16_f32 v21, 0, v21
    s_waitcnt lgkmcnt(4)
    v_mfma_f32_16x16x32_f16 v[24:27], v[56:59], v[100:103], v[24:27]
    v_cvt_pk_bf16_f32 v22, 0, v22
    v_cvt_pk_bf16_f32 v23, 0, v23
    s_waitcnt lgkmcnt(3)
    v_mfma_f32_16x16x32_f16 v[24:27], v[64:67], v[52:55], v[24:27]
    v_add_f32 v20, v20, v104
    v_add_f32 v21, v21, v105
    s_waitcnt lgkmcnt(2)
    v_mfma_f32_16x16x32_f16 v[24:27], v[72:75], v[60:63], v[24:27]
    v_add_f32 v22, v22, v106
    v_add_f32 v23, v23, v107
    s_waitcnt lgkmcnt(1)
    v_mfma_f32_16x16x32_f16 v[24:27], v[80:83], v[108:111], v[24:27]
    v_cvt_pk_bf16_f32 v28, v20, v21
    v_cvt_pk_bf16_f32 v29, v22, v23
    s_waitcnt lgkmcnt(0)
    v_mfma_f32_16x16x32_f16 v[24:27], v[88:91], v[68:71], v[24:27]
    v_min_u32 v28, -2, v28
    v_min_u32 v29, -2, v29
    ds_read_u8 v18, v4 offset:160
    ds_read_b128 v[20:23], v12 offset:46592
    s_nop 3
    v_mul_f32 v24, v24, v16
    v_mul_f32 v25, v25, v16
    v_mul_f32 v26, v26, v16
    v_mul_f32 v27, v27, v16
    v_cvt_pk_bf16_f32 v24, 0, v24
    v_cvt_pk_bf16_f32 v25, 0, v25
    v_cvt_pk_bf16_f32 v26, 0, v26
    v_cvt_pk_bf16_f32 v27, 0, v27
    v_add_f32 v24, v24, v112
    v_add_f32 v25, v25, v113
    v_add_f32 v26, v26, v114
    v_add_f32 v27, v27, v115
    v_cvt_pk_bf16_f32 v30, v24, v25
    v_cvt_pk_bf16_f32 v31, v26, v27
    v_min_u32 v30, -2, v30
    v_min_u32 v31, -2, v31
    s_branch CVE_32
CV_29:
    ds_read2_b32 v[32:33], v6 offset0:0 offset1:1
    ds_read2_b32 v[34:35], v6 offset0:2 offset1:3
    ds_read2_b32 v[36:37], v6 offset0:16 offset1:17
    ds_read2_b32 v[38:39], v6 offset0:18 offset1:19
    ds_read2_b32 v[40:41], v6 offset0:32 offset1:33
    ds_read2_b32 v[42:43], v6 offset0:34 offset1:35
    ds_read2_b32 v[44:45], v6 offset0:48 offset1:49
    ds_read2_b32 v[46:47], v6 offset0:50 offset1:51
    ds_read2_b32 v[48:49], v6 offset0:64 offset1:65
    ds_read2_b32 v[50:51], v6 offset0:66 offset1:67
    ds_read2_b32 v[52:53], v6 offset0:80 offset1:81
    ds_read2_b32 v[54:55], v6 offset0:82 offset1:83
    ds_read2_b32 v[56:57], v6 offset0:96 offset1:97
    ds_read2_b32 v[58:59], v6 offset0:98 offset1:99
    ds_read2_b32 v[60:61], v6 offset0:112 offset1:113
    ds_read2_b32 v[62:63], v6 offset0:114 offset1:115
    ds_read2_b32 v[64:65], v6 offset0:128 offset1:129
    ds_read2_b32 v[66:67], v6 offset0:130 offset1:131
    ds_read2_b32 v[68:69], v6 offset0:144 offset1:145
    ds_read2_b32 v[70:71], v6 offset0:146 offset1:147
    ds_read2_b32 v[72:73], v6 offset0:160 offset1:161
    ds_read2_b32 v[74:75], v6 offset0:162 offset1:163
    ds_read2_b32 v[76:77], v6 offset0:176 offset1:177
    ds_read2_b32 v[78:79], v6 offset0:178 offset1:179
    ds_read2_b32 v[80:81], v6 offset0:192 offset1:193
    ds_read2_b32 v[82:83], v6 offset0:194 offset1:195
    ds_read2_b32 v[84:85], v6 offset0:208 offset1:209
    ds_read2_b32 v[86:87], v6 offset0:210 offset1:211
    ds_read2_b32 v[88:89], v6 offset0:224 offset1:225
    ds_read2_b32 v[90:91], v6 offset0:226 offset1:227
    ds_read2_b32 v[92:93], v6 offset0:240 offset1:241
    ds_read2_b32 v[94:95], v6 offset0:242 offset1:243
    ds_read2_b32 v[96:97], v7 offset0:96 offset1:97
    ds_read2_b32 v[98:99], v7 offset0:98 offset1:99
    ds_read2_b32 v[100:101], v11 offset0:32 offset1:33
    ds_read2_b32 v[102:103], v11 offset0:34 offset1:35
    ds_read2_b32 v[104:105], v11 offset0:96 offset1:97
    ds_read2_b32 v[106:107], v11 offset0:98 offset1:99
    v_lshlrev_b32 v18, 3, v3
    v_sub_u32 v18, v8, v18
    v_lshrrev_b32 v19, 2, v2
    v_lshl_add_u32 v19, v19, 2, v3
    v_and_b32 v28, 3, v2
    v_lshlrev_b32 v28, 4, v28
    v_mul_u32_u24 v19, s8, v19
    v_xor_b32 v19, s10, v19
    s_waitcnt lgkmcnt(0)
    v_mov_b32 v7, v18
    v_add_u32 v6, v19, v28
    v_xor_b32 v12, s9, v12
W_34:
    ds_read_b32 v18, v4 offset:16
    s_sub_u32 s39, s39, 1
    s_cbranch_scc1 KS_ABORT
    s_waitcnt lgkmcnt(0)
    v_cmp_ne_u32 vcc, s84, v18
    s_cbranch_vccnz W_34
    s_setprio 1
    ds_read_b128 v[108:111], v8 offset:448
    ds_read_b128 v[112:115], v8 offset:512
    ds_read_b128 v[116:119], v8 offset:576
    ds_read_b128 v[120:123], v8 offset:640
    ds_read_b128 v[124:127], v8 offset:704
    s_waitcnt lgkmcnt(4)
    v_mfma_f32_16x16x32_f16 v[20:23], v[32:35], v[108:111], 0
    ds_read_b128 v[108:111], v8 offset:768
    s_waitcnt lgkmcnt(4)
    v_mfma_f32_16x16x32_f16 v[20:23], v[36:39], v[112:115], v[20:23]
    ds_read_b128 v[112:115], v8 offset:832
    s_waitcnt lgkmcnt(4)
    v_mfma_f32_16x16x32_f16 v[20:23], v[40:43], v[116:119], v[20:23]
    ds_read_b128 v[116:119], v8 offset:896
    ds_read_b64 v[28:29], v7 offset:1504
    ds_read_b64 v[30:31], v7 offset:2016
    s_waitcnt lgkmcnt(6)
    v_mfma_f32_16x16x32_f16 v[20:23], v[44:47], v[120:123], v[20:23]
    ds_read_b128 v[120:123], v8 offset:960
    s_waitcnt lgkmcnt(6)
    v_mfma_f32_16x16x32_f16 v[20:23], v[48:51], v[124:127], v[20:23]
    ds_read_b128 v[124:127], v8 offset:1024
    s_waitcnt lgkmcnt(6)
    v_mfma_f32_16x16x32_f16 v[20:23], v[52:55], v[108:111], v[20:23]
    ds_read_b128 v[108:111], v8 offset:1088
    s_waitcnt lgkmcnt(6)
    v_mfma_f32_16x16x32_f16 v[20:23], v[56:59], v[112:115], v[20:23]
    s_waitcnt lgkmcnt(5)
    v_mfma_f32_16x16x32_f16 v[20:23], v[60:63], v[116:119], v[20:23]
    ds_read_b128 v[112:115], v8 offset:1152
    s_waitcnt lgkmcnt(3)
    v_mfma_f32_16x16x32_f16 v[20:23], v[64:67], v[120:123], v[20:23]
    v_mfma_f32_16x16x32_f16 v[24:27], v[32:35], v[120:123], 0
    ds_read_b128 v[116:119], v8 offset:1216
    v_fma_mix_f32 v120, v28, v17, 0 op_sel_hi:[1,0,0]
    v_fma_mix_f32 v121, v28, v17, 0 op_sel:[1,0,0] op_sel_hi:[1,0,0]
    s_waitcnt lgkmcnt(3)
    v_mfma_f32_16x16x32_f16 v[20:23], v[68:71], v[124:127], v[20:23]
    v_fma_mix_f32 v122, v29, v17, 0 op_sel_hi:[1,0,0]
    v_fma_mix_f32 v123, v29, v17, 0 op_sel:[1,0,0] op_sel_hi:[1,0,0]
    v_mfma_f32_16x16x32_f16 v[24:27], v[36:39], v[124:127], v[24:27]
    ds_read_b128 v[32:35], v8 offset:1280
    v_cvt_pk_bf16_f32 v120, 0, v120
    v_cvt_pk_bf16_f32 v121, 0, v121
    s_waitcnt lgkmcnt(3)
    v_mfma_f32_16x16x32_f16 v[20:23], v[72:75], v[108:111], v[20:23]
    v_cvt_pk_bf16_f32 v122, 0, v122
    v_cvt_pk_bf16_f32 v123, 0, v123
    v_mfma_f32_16x16x32_f16 v[24:27], v[40:43], v[108:111], v[24:27]
    ds_read_b128 v[36:39], v8 offset:1344
    v_fma_mix_f32 v108, v30, v17, 0 op_sel_hi:[1,0,0]
    v_fma_mix_f32 v109, v30, v17, 0 op_sel:[1,0,0] op_sel_hi:[1,0,0]
    s_waitcnt lgkmcnt(3)
    v_mfma_f32_16x16x32_f16 v[20:23], v[76:79], v[112:115], v[20:23]
    v_fma_mix_f32 v110, v31, v17, 0 op_sel_hi:[1,0,0]
    v_fma_mix_f32 v111, v31, v17, 0 op_sel:[1,0,0] op_sel_hi:[1,0,0]
    v_mfma_f32_16x16x32_f16 v[24:27], v[44:47], v[112:115], v[24:27]
    ds_read_b128 v[124:127], v8 offset:1408
    v_cvt_pk_bf16_f32 v108, 0, v108
    v_cvt_pk_bf16_f32 v109, 0, v109
    s_waitcnt lgkmcnt(3)
    v_mfma_f32_16x16x32_f16 v[20:23], v[80:83], v[116:119], v[20:23]
    v_cvt_pk_bf16_f32 v110, 0, v110
    v_cvt_pk_bf16_f32 v111, 0, v111
    v_mfma_f32_16x16x32_f16 v[24:27], v[48:51], v[116:119], v[24:27]
    ds_read_b128 v[40:43], v8 offset:1472
    s_waitcnt lgkmcnt(3)
    v_mfma_f32_16x16x32_f16 v[20:23], v[84:87], v[32:35], v[20:23]
    v_mfma_f32_16x16x32_f16 v[24:27], v[52:55], v[32:35], v[24:27]
    ds_read_b128 v[44:47], v8 offset:1536
    s_waitcnt lgkmcnt(3)
    v_mfma_f32_16x16x32_f16 v[20:23], v[88:91], v[36:39], v[20:23]
    ds_read_b128 v[112:115], v8 offset:1600
    v_mfma_f32_16x16x32_f16 v[24:27], v[56:59], v[36:39], v[24:27]
    ds_read_b128 v[48:51], v8 offset:1664
    s_waitcnt lgkmcnt(4)
    v_mfma_f32_16x16x32_f16 v[20:23], v[92:95], v[124:127], v[20:23]
    ds_read_b128 v[116:119], v8 offset:1728
    v_mfma_f32_16x16x32_f16 v[24:27], v[60:63], v[124:127], v[24:27]
    ds_read_b128 v[52:55], v8 offset:1792
    s_waitcnt lgkmcnt(5)
    v_mfma_f32_16x16x32_f16 v[20:23], v[96:99], v[40:43], v[20:23]
    ds_read_b128 v[32:35], v8 offset:1856
    v_mfma_f32_16x16x32_f16 v[24:27], v[64:67], v[40:43], v[24:27]
    ds_read_b32 v18, v14 offset:76
    ds_read_b128 v[56:59], v8 offset:1920
    s_waitcnt lgkmcnt(7)
    v_mfma_f32_16x16x32_f16 v[24:27], v[68:71], v[44:47], v[24:27]
    ds_read_b128 v[36:39], v8 offset:1984
    s_waitcnt lgkmcnt(7)
    v_mfma_f32_16x16x32_f16 v[24:27], v[72:75], v[112:115], v[24:27]
    ds_read2_b32 v[60:61], v11 offset0:16 offset1:17
    ds_read2_b32 v[62:63], v11 offset0:18 offset1:19
    s_waitcnt lgkmcnt(8)
    v_mfma_f32_16x16x32_f16 v[24:27], v[76:79], v[48:51], v[24:27]
    s_waitcnt lgkmcnt(4)
    v_cmp_ne_u32 vcc, s84, v18
    s_cbranch_vccnz WS_35
WB_36:
    ds_read_b64_tr_b16 v[124:125], v9 offset:0
    ds_read_b64_tr_b16 v[126:127], v9 offset:64
    ds_read_b64_tr_b16 v[64:65], v9 offset:3088
    ds_read_b64_tr_b16 v[66:67], v9 offset:3152
    v_mfma_f32_16x16x32_f16 v[24:27], v[80:83], v[116:119], v[24:27]
    v_mfma_f32_16x16x32_f16 v[24:27], v[84:87], v[52:55], v[24:27]
    ds_read_b64_tr_b16 v[40:41], v9 offset:512
    ds_read_b64_tr_b16 v[42:43], v9 offset:576
    ds_read2_b32 v[68:69], v11 offset0:80 offset1:81
    ds_read2_b32 v[70:71], v11 offset0:82 offset1:83
    v_mfma_f32_16x16x32_f16 v[24:27], v[88:91], v[32:35], v[24:27]
    s_waitcnt lgkmcnt(11)
    v_mfma_f32_16x16x32_f16 v[24:27], v[92:95], v[56:59], v[24:27]
    ds_read_b64_tr_b16 v[44:45], v9 offset:3600
    ds_read_b64_tr_b16 v[46:47], v9 offset:3664
    s_waitcnt lgkmcnt(12)
    v_mfma_f32_16x16x32_f16 v[24:27], v[96:99], v[36:39], v[24:27]
    s_waitcnt lgkmcnt(8)
    v_mfma_f32_16x16x32_f16 v[20:23], v[124:127], v[100:103], v[20:23]
    s_waitcnt lgkmcnt(6)
    v_mfma_f32_16x16x32_f16 v[20:23], v[64:67], v[104:107], v[20:23]
    v_mfma_f32_16x16x32_f16 v[24:27], v[124:127], v[60:63], v[24:27]
    s_waitcnt lgkmcnt(4)
    v_mfma_f32_16x16x32_f16 v[24:27], v[40:43], v[100:103], v[24:27]
    s_nop 4
    v_mul_f32 v20, v20, v16
    v_mul_f32 v21, v21, v16
    s_waitcnt lgkmcnt(2)
    v_mfma_f32_16x16x32_f16 v[24:27], v[64:67], v[68:71], v[24:27]
    v_mul_f32 v22, v22, v16
    v_mul_f32 v23, v23, v16
    s_waitcnt lgkmcnt(0)
    v_mfma_f32_16x16x32_f16 v[24:27], v[44:47], v[104:107], v[24:27]
    v_cvt_pk_bf16_f32 v20, 0, v20
    v_cvt_pk_bf16_f32 v21, 0, v21
    v_cvt_pk_bf16_f32 v22, 0, v22
    v_cvt_pk_bf16_f32 v23, 0, v23
    v_add_f32 v20, v20, v120
    v_add_f32 v21, v21, v121
    v_add_f32 v22, v22, v122
    v_add_f32 v23, v23, v123
    v_cvt_pk_bf16_f32 v28, v20, v21
    v_cvt_pk_bf16_f32 v29, v22, v23
    v_min_u32 v28, -2, v28
    v_min_u32 v29, -2, v29
    ds_read_u8 v18, v4 offset:161
    ds_read_b128 v[20:23], v12 offset:47616
    v_mul_f32 v24, v24, v16
    v_mul_f32 v25, v25, v16
    v_mul_f32 v26, v26, v16
    v_mul_f32 v27, v27, v16
    v_cvt_pk_bf16_f32 v24, 0, v24
    v_cvt_pk_bf16_f32 v25, 0, v25
    v_cvt_pk_bf16_f32 v26, 0, v26
    v_cvt_pk_bf16_f32 v27, 0, v27
    v_add_f32 v24, v24, v108
    v_add_f32 v25, v25, v109
    v_add_f32 v26, v26, v110
    v_add_f32 v27, v27, v111
    v_cvt_pk_bf16_f32 v30, v24, v25
    v_cvt_pk_bf16_f32 v31, v26, v27
    v_min_u32 v30, -2, v30
    v_min_u32 v31, -2, v31
    s_branch CVE_32
CV_30:
    ds_read2_b32 v[32:33], v7 offset0:128 offset1:129
    ds_read2_b32 v[34:35], v7 offset0:130 offset1:131
    ds_read2_b32 v[36:37], v6 offset0:0 offset1:1
    ds_read2_b32 v[38:39], v6 offset0:2 offset1:3
    ds_read2_b32 v[40:41], v6 offset0:16 offset1:17
    ds_read2_b32 v[42:43], v6 offset0:18 offset1:19
    ds_read2_b32 v[44:45], v6 offset0:32 offset1:33
    ds_read2_b32 v[46:47], v6 offset0:34 offset1:35
    ds_read2_b32 v[48:49], v6 offset0:48 offset1:49
    ds_read2_b32 v[50:51], v6 offset0:50 offset1:51
    ds_read2_b32 v[52:53], v6 offset0:64 offset1:65
    ds_read2_b32 v[54:55], v6 offset0:66 offset1:67
    ds_read2_b32 v[56:57], v6 offset0:80 offset1:81
    ds_read2_b32 v[58:59], v6 offset0:82 offset1:83
    ds_read2_b32 v[60:61], v6 offset0:96 offset1:97
    ds_read2_b32 v[62:63], v6 offset0:98 offset1:99
    ds_read2_b32 v[64:65], v6 offset0:112 offset1:113
    ds_read2_b32 v[66:67], v6 offset0:114 offset1:115
    ds_read2_b32 v[68:69], v6 offset0:128 offset1:129
    ds_read2_b32 v[70:71], v6 offset0:130 offset1:131
    ds_read2_b32 v[72:73], v6 offset0:144 offset1:145
    ds_read2_b32 v[74:75], v6 offset0:146 offset1:147
    ds_read2_b32 v[76:77], v6 offset0:160 offset1:161
    ds_read2_b32 v[78:79], v6 offset0:162 offset1:163
    ds_read2_b32 v[80:81], v6 offset0:176 offset1:177
    ds_read2_b32 v[82:83], v6 offset0:178 offset1:179
    ds_read2_b32 v[84:85], v6 offset0:192 offset1:193
    ds_read2_b32 v[86:87], v6 offset0:194 offset1:195
    ds_read2_b32 v[88:89], v6 offset0:208 offset1:209
    ds_read2_b32 v[90:91], v6 offset0:210 offset1:211
    ds_read2_b32 v[92:93], v6 offset0:224 offset1:225
    ds_read2_b32 v[94:95], v6 offset0:226 offset1:227
    ds_read2_b32 v[96:97], v6 offset0:240 offset1:241
    ds_read2_b32 v[98:99], v6 offset0:242 offset1:243
    ds_read2_b32 v[100:101], v7 offset0:96 offset1:97
    ds_read2_b32 v[102:103], v7 offset0:98 offset1:99
    ds_read2_b32 v[104:105], v11 offset0:0 offset1:1
    ds_read2_b32 v[106:107], v11 offset0:2 offset1:3
    v_lshlrev_b32 v18, 3, v3
    v_sub_u32 v18, v8, v18
    v_lshrrev_b32 v19, 2, v2
    v_lshl_add_u32 v19, v19, 2, v3
    v_and_b32 v28, 3, v2
    v_lshlrev_b32 v28, 4, v28
    v_mul_u32_u24 v19, s8, v19
    v_xor_b32 v19, s10, v19
    s_waitcnt lgkmcnt(0)
    v_mov_b32 v7, v18
    v_add_u32 v6, v19, v28
    v_xor_b32 v12, s9, v12
W_37:
    ds_read_b32 v18, v4 offset:16
    s_sub_u32 s39, s39, 1
    s_cbranch_scc1 KS_ABORT
    s_waitcnt lgkmcnt(0)
    v_cmp_ne_u32 vcc, s84, v18
    s_cbranch_vccnz W_37
    s_setprio 1
    ds_read_b128 v[108:111], v8 offset:448
    ds_read_b128 v[112:115], v8 offset:960
    ds_read_b128 v[116:119], v8 offset:1472
    ds_read_b128 v[120:123], v8 offset:1536
    ds_read_b128 v[124:127], v8 offset:1600
    s_waitcnt lgkmcnt(4)
    v_mfma_f32_16x16x32_f16 v[20:23], v[32:35], v[108:111], 0
    ds_read_b128 v[108:111], v8 offset:1664
    s_waitcnt lgkmcnt(4)
    v_mfma_f32_16x16x32_f16 v[24:27], v[32:35], v[112:115], 0
    ds_read_b128 v[32:35], v8 offset:1728
    ds_read_b128 v[112:115], v8 offset:1792
    s_waitcnt lgkmcnt(5)
    v_mfma_f32_16x16x32_f16 v[20:23], v[36:39], v[116:119], v[20:23]
    ds_read_b128 v[116:119], v8 offset:1856
    ds_read_b64 v[28:29], v7 offset:2528
    ds_read_b64 v[30:31], v7 offset:3040
    s_waitcnt lgkmcnt(7)
    v_mfma_f32_16x16x32_f16 v[20:23], v[40:43], v[120:123], v[20:23]
    ds_read_b128 v[120:123], v8 offset:1920
    s_waitcnt lgkmcnt(7)
    v_mfma_f32_16x16x32_f16 v[20:23], v[44:47], v[124:127], v[20:23]
    ds_read_b128 v[124:127], v8 offset:1984
    s_waitcnt lgkmcnt(7)
    v_mfma_f32_16x16x32_f16 v[20:23], v[48:51], v[108:111], v[20:23]
    ds_read_b128 v[108:111], v8 offset:2048
    s_waitcnt lgkmcnt(7)
    v_mfma_f32_16x16x32_f16 v[20:23], v[52:55], v[32:35], v[20:23]
    s_waitcnt lgkmcnt(6)
    v_mfma_f32_16x16x32_f16 v[20:23], v[56:59], v[112:115], v[20:23]
    ds_read_b128 v[32:35], v8 offset:2112
    s_waitcnt lgkmcnt(6)
    v_mfma_f32_16x16x32_f16 v[20:23], v[60:63], v[116:119], v[20:23]
    s_waitcnt lgkmcnt(4)
    v_fma_mix_f32 v116, v28, v17, 0 op_sel_hi:[1,0,0]
    v_fma_mix_f32 v117, v28, v17, 0 op_sel:[1,0,0] op_sel_hi:[1,0,0]
    s_waitcnt lgkmcnt(3)
    v_mfma_f32_16x16x32_f16 v[20:23], v[64:67], v[120:123], v[20:23]
    ds_read_b128 v[112:115], v8 offset:2176
    v_fma_mix_f32 v118, v29, v17, 0 op_sel_hi:[1,0,0]
    v_fma_mix_f32 v119, v29, v17, 0 op_sel:[1,0,0] op_sel_hi:[1,0,0]
    s_waitcnt lgkmcnt(3)
    v_mfma_f32_16x16x32_f16 v[20:23], v[68:71], v[124:127], v[20:23]
    v_cvt_pk_bf16_f32 v116, 0, v116
    v_cvt_pk_bf16_f32 v117, 0, v117
    v_mfma_f32_16x16x32_f16 v[24:27], v[36:39], v[124:127], v[24:27]
    ds_read_b128 v[120:123], v8 offset:2240
    v_cvt_pk_bf16_f32 v118, 0, v118
    v_cvt_pk_bf16_f32 v119, 0, v119
    s_waitcnt lgkmcnt(3)
    v_mfma_f32_16x16x32_f16 v[20:23], v[72:75], v[108:111], v[20:23]
    v_fma_mix_f32 v124, v30, v17, 0 op_sel_hi:[1,0,0]
    v_fma_mix_f32 v125, v30, v17, 0 op_sel:[1,0,0] op_sel_hi:[1,0,0]
    v_mfma_f32_16x16x32_f16 v[24:27], v[40:43], v[108:111], v[24:27]
    ds_read_b128 v[36:39], v8 offset:2304
    v_fma_mix_f32 v126, v31, v17, 0 op_sel_hi:[1,0,0]
    v_fma_mix_f32 v127, v31, v17, 0 op_sel:[1,0,0] op_sel_hi:[1,0,0]
    s_waitcnt lgkmcnt(3)
    v_mfma_f32_16x16x32_f16 v[20:23], v[76:79], v[32:35], v[20:23]
    v_cvt_pk_bf16_f32 v124, 0, v124
    v_cvt_pk_bf16_f32 v125, 0, v125
    v_mfma_f32_16x16x32_f16 v[24:27], v[44:47], v[32:35], v[24:27]
    ds_read_b128 v[40:43], v8 offset:2368
    v_cvt_pk_bf16_f32 v126, 0, v126
    v_cvt_pk_bf16_f32 v127, 0, v127
    s_waitcnt lgkmcnt(3)
    v_mfma_f32_16x16x32_f16 v[20:23], v[80:83], v[112:115], v[20:23]
    v_mfma_f32_16x16x32_f16 v[24:27], v[48:51], v[112:115], v[24:27]
    ds_read_b128 v[108:111], v8 offset:2432
    s_waitcnt lgkmcnt(3)
    v_mfma_f32_16x16x32_f16 v[20:23], v[84:87], v[120:123], v[20:23]
    v_mfma_f32_16x16x32_f16 v[24:27], v[52:55], v[120:123], v[24:27]
    ds_read_b128 v[44:47], v8 offset:2496
    s_waitcnt lgkmcnt(3)
    v_mfma_f32_16x16x32_f16 v[20:23], v[88:91], v[36:39], v[20:23]
    v_mfma_f32_16x16x32_f16 v[24:27], v[56:59], v[36:39], v[24:27]
    ds_read_b128 v[32:35], v8 offset:2560
    s_waitcnt lgkmcnt(3)
    v_mfma_f32_16x16x32_f16 v[20:23], v[92:95], v[40:43], v[20:23]
    ds_read_b128 v[48:51], v8 offset:2624
    v_mfma_f32_16x16x32_f16 v[24:27], v[60:63], v[40:43], v[24:27]
    ds_read_b128 v[112:115], v8 offset:2688
    s_waitcnt lgkmcnt(4)
    v_mfma_f32_16x16x32_f16 v[20:23], v[96:99], v[108:111], v[20:23]
    ds_read_b128 v[52:55], v8 offset:2752
    v_mfma_f32_16x16x32_f16 v[24:27], v[64:67], v[108:111], v[24:27]
    ds_read_b128 v[120:123], v8 offset:2816
    s_waitcnt lgkmcnt(5)
    v_mfma_f32_16x16x32_f16 v[20:23], v[100:103], v[44:47], v[20:23]
    ds_read_b128 v[56:59], v8 offset:2880
    v_mfma_f32_16x16x32_f16 v[24:27], v[68:71], v[44:47], v[24:27]
    ds_read_b32 v18, v14 offset:76
    ds_read_b128 v[36:39], v8 offset:2944
    s_waitcnt lgkmcnt(7)
    v_mfma_f32_16x16x32_f16 v[24:27], v[72:75], v[32:35], v[24:27]
    ds_read_b128 v[60:63], v8 offset:3008
    s_waitcnt lgkmcnt(7)
    v_mfma_f32_16x16x32_f16 v[24:27], v[76:79], v[48:51], v[24:27]
    ds_read2_b32 v[40:41], v11 offset0:16 offset1:17
    ds_read2_b32 v[42:43], v11 offset0:18 offset1:19
    ds_read2_b32 v[64:65], v11 offset0:32 offset1:33
    ds_read2_b32 v[66:67], v11 offset0:34 offset1:35
    s_waitcnt lgkmcnt(10)
    v_mfma_f32_16x16x32_f16 v[24:27], v[80:83], v[112:115], v[24:27]
    s_waitcnt lgkmcnt(6)
    v_cmp_ne_u32 vcc, s84, v18
    s_cbranch_vccnz WS_38
WB_39:
    ds_read_b64_tr_b16 v[108:109], v9 offset:0
    ds_read_b64_tr_b16 v[110:111], v9 offset:64
    ds_read_b64_tr_b16 v[68:69], v9 offset:512
    ds_read_b64_tr_b16 v[70:71], v9 offset:576
    v_mfma_f32_16x16x32_f16 v[24:27], v[84:87], v[52:55], v[24:27]
    ds_read_b64_tr_b16 v[44:45], v9 offset:1024
    ds_read_b64_tr_b16 v[46:47], v9 offset:1088
    v_mfma_f32_16x16x32_f16 v[24:27], v[88:91], v[120:123], v[24:27]
    ds_read_b64_tr_b16 v[72:73], v9 offset:3088
    ds_read_b64_tr_b16 v[74:75], v9 offset:3152
    ds_read2_b32 v[32:33], v11 offset0:64 offset1:65
    ds_read2_b32 v[34:35], v11 offset0:66 offset1:67
    v_mfma_f32_16x16x32_f16 v[24:27], v[92:95], v[56:59], v[24:27]
    ds_read_b64_tr_b16 v[76:77], v9 offset:3600
    ds_read_b64_tr_b16 v[78:79], v9 offset:3664
    ds_read2_b32 v[48:49], v11 offset0:80 offset1:81
    ds_read2_b32 v[50:51], v11 offset0:82 offset1:83
    v_mfma_f32_16x16x32_f16 v[24:27], v[96:99], v[36:39], v[24:27]
    ds_read_b64_tr_b16 v[80:81], v9 offset:4112
    ds_read_b64_tr_b16 v[82:83], v9 offset:4176
    ds_read2_b32 v[112:113], v11 offset0:96 offset1:97
    ds_read2_b32 v[114:115], v11 offset0:98 offset1:99
    v_mfma_f32_16x16x32_f16 v[24:27], v[100:103], v[60:63], v[24:27]
    ds_read_b64_tr_b16 v[84:85], v10 offset:6176
    ds_read_b64_tr_b16 v[86:87], v10 offset:6304
    ds_read2_b32 v[52:53], v13 offset0:24 offset1:25
    ds_read2_b32 v[54:55], v13 offset0:26 offset1:27
    v_mfma_f32_16x16x32_f16 v[20:23], v[108:111], v[104:107], v[20:23]
    ds_read_b64_tr_b16 v[88:89], v10 offset:8224
    ds_read_b64_tr_b16 v[90:91], v10 offset:8352
    ds_read2_b32 v[120:121], v13 offset0:120 offset1:121
    ds_read2_b32 v[122:123], v13 offset0:122 offset1:123
    v_mfma_f32_16x16x32_f16 v[20:23], v[68:71], v[40:43], v[20:23]
    v_mfma_f32_16x16x32_f16 v[20:23], v[44:47], v[64:67], v[20:23]
    v_mfma_f32_16x16x32_f16 v[20:23], v[72:75], v[32:35], v[20:23]
    ds_read_b64_tr_b16 v[92:93], v9 offset:1536
    ds_read_b64_tr_b16 v[94:95], v9 offset:1600
    s_waitcnt lgkmcnt(14)
    v_mfma_f32_16x16x32_f16 v[20:23], v[76:79], v[48:51], v[20:23]
    s_waitcnt lgkmcnt(10)
    v_mfma_f32_16x16x32_f16 v[20:23], v[80:83], v[112:115], v[20:23]
    s_waitcnt lgkmcnt(6)
    v_mfma_f32_16x16x32_f16 v[20:23], v[84:87], v[52:55], v[20:23]
    ds_read_b64_tr_b16 v[56:57], v9 offset:4624
    ds_read_b64_tr_b16 v[58:59], v9 offset:4688
    ds_read2_b32 v[96:97], v13 offset0:16 offset1:17
    ds_read2_b32 v[98:99], v13 offset0:18 offset1:19
    s_waitcnt lgkmcnt(6)
    v_mfma_f32_16x16x32_f16 v[20:23], v[88:91], v[120:123], v[20:23]
    ds_read2_b32 v[36:37], v13 offset0:112 offset1:113
    ds_read2_b32 v[38:39], v13 offset0:114 offset1:115
    v_mfma_f32_16x16x32_f16 v[24:27], v[68:71], v[104:107], v[24:27]
    v_mfma_f32_16x16x32_f16 v[24:27], v[44:47], v[40:43], v[24:27]
    s_nop 3
    v_mul_f32 v20, v20, v16
    v_mul_f32 v21, v21, v16
    s_waitcnt lgkmcnt(6)
    v_mfma_f32_16x16x32_f16 v[24:27], v[92:95], v[64:67], v[24:27]
    v_mul_f32 v22, v22, v16
    v_mul_f32 v23, v23, v16
    v_mfma_f32_16x16x32_f16 v[24:27], v[76:79], v[32:35], v[24:27]
    v_cvt_pk_bf16_f32 v20, 0, v20
    v_cvt_pk_bf16_f32 v21, 0, v21
    v_mfma_f32_16x16x32_f16 v[24:27], v[80:83], v[48:51], v[24:27]
    v_cvt_pk_bf16_f32 v22, 0, v22
    v_cvt_pk_bf16_f32 v23, 0, v23
    s_waitcnt lgkmcnt(4)
    v_mfma_f32_16x16x32_f16 v[24:27], v[56:59], v[112:115], v[24:27]
    v_add_f32 v20, v20, v116
    v_add_f32 v21, v21, v117
    s_waitcnt lgkmcnt(2)
    v_mfma_f32_16x16x32_f16 v[24:27], v[84:87], v[96:99], v[24:27]
    v_add_f32 v22, v22, v118
    v_add_f32 v23, v23, v119
    s_waitcnt lgkmcnt(0)
    v_mfma_f32_16x16x32_f16 v[24:27], v[88:91], v[36:39], v[24:27]
    v_cvt_pk_bf16_f32 v28, v20, v21
    v_cvt_pk_bf16_f32 v29, v22, v23
    v_min_u32 v28, -2, v28
    v_min_u32 v29, -2, v29
    ds_read_u8 v18, v4 offset:162
    ds_read_b128 v[20:23], v12 offset:48640
    s_nop 1
    v_mul_f32 v24, v24, v16
    v_mul_f32 v25, v25, v16
    v_mul_f32 v26, v26, v16
    v_mul_f32 v27, v27, v16
    v_cvt_pk_bf16_f32 v24, 0, v24
    v_cvt_pk_bf16_f32 v25, 0, v25
    v_cvt_pk_bf16_f32 v26, 0, v26
    v_cvt_pk_bf16_f32 v27, 0, v27
    v_add_f32 v24, v24, v124
    v_add_f32 v25, v25, v125
    v_add_f32 v26, v26, v126
    v_add_f32 v27, v27, v127
    v_cvt_pk_bf16_f32 v30, v24, v25
    v_cvt_pk_bf16_f32 v31, v26, v27
    v_min_u32 v30, -2, v30
    v_min_u32 v31, -2, v31
    s_branch CVE_32
CV_31:
    ds_read2_b32 v[32:33], v7 offset0:128 offset1:129
    ds_read2_b32 v[34:35], v7 offset0:130 offset1:131
    ds_read2_b32 v[36:37], v6 offset0:0 offset1:1
    ds_read2_b32 v[38:39], v6 offset0:2 offset1:3
    ds_read2_b32 v[40:41], v6 offset0:16 offset1:17
    ds_read2_b32 v[42:43], v6 offset0:18 offset1:19
    ds_read2_b32 v[44:45], v6 offset0:32 offset1:33
    ds_read2_b32 v[46:47], v6 offset0:34 offset1:35
    ds_read2_b32 v[48:49], v6 offset0:48 offset1:49
    ds_read2_b32 v[50:51], v6 offset0:50 offset1:51
    ds_read2_b32 v[52:53], v6 offset0:64 offset1:65
    ds_read2_b32 v[54:55], v6 offset0:66 offset1:67
    ds_read2_b32 v[56:57], v6 offset0:80 offset1:81
    ds_read2_b32 v[58:59], v6 offset0:82 offset1:83
    ds_read2_b32 v[60:61], v6 offset0:96 offset1:97
    ds_read2_b32 v[62:63], v6 offset0:98 offset1:99
    ds_read2_b32 v[64:65], v6 offset0:112 offset1:113
    ds_read2_b32 v[66:67], v6 offset0:114 offset1:115
    ds_read2_b32 v[68:69], v6 offset0:128 offset1:129
    ds_read2_b32 v[70:71], v6 offset0:130 offset1:131
    ds_read2_b32 v[72:73], v6 offset0:144 offset1:145
    ds_read2_b32 v[74:75], v6 offset0:146 offset1:147
    ds_read2_b32 v[76:77], v6 offset0:160 offset1:161
    ds_read2_b32 v[78:79], v6 offset0:162 offset1:163
    ds_read2_b32 v[80:81], v6 offset0:176 offset1:177
    ds_read2_b32 v[82:83], v6 offset0:178 offset1:179
    ds_read2_b32 v[84:85], v6 offset0:192 offset1:193
    ds_read2_b32 v[86:87], v6 offset0:194 offset1:195
    ds_read2_b32 v[88:89], v6 offset0:208 offset1:209
    ds_read2_b32 v[90:91], v6 offset0:210 offset1:211
    ds_read2_b32 v[92:93], v6 offset0:224 offset1:225
    ds_read2_b32 v[94:95], v6 offset0:226 offset1:227
    ds_read2_b32 v[96:97], v6 offset0:240 offset1:241
    ds_read2_b32 v[98:99], v6 offset0:242 offset1:243
    ds_read2_b32 v[100:101], v7 offset0:96 offset1:97
    ds_read2_b32 v[102:103], v7 offset0:98 offset1:99
    ds_read2_b32 v[104:105], v11 offset0:0 offset1:1
    ds_read2_b32 v[106:107], v11 offset0:2 offset1:3
    v_lshlrev_b32 v18, 3, v3
    v_sub_u32 v18, v8, v18
    v_lshrrev_b32 v19, 2, v2
    v_lshl_add_u32 v19, v19, 2, v3
    v_and_b32 v28, 3, v2
    v_lshlrev_b32 v28, 4, v28
    v_mul_u32_u24 v19, s8, v19
    v_xor_b32 v19, s10, v19
    s_waitcnt lgkmcnt(0)
    v_mov_b32 v7, v18
    v_add_u32 v6, v19, v28
    v_xor_b32 v12, s9, v12
W_40:
    ds_read_b32 v18, v4 offset:16
    s_sub_u32 s39, s39, 1
    s_cbranch_scc1 KS_ABORT
    s_waitcnt lgkmcnt(0)
    v_cmp_ne_u32 vcc, s84, v18
    s_cbranch_vccnz W_40
    s_setprio 1
    ds_read_b128 v[108:111], v8 offset:1472
    ds_read_b128 v[112:115], v8 offset:1984
    ds_read_b128 v[116:119], v8 offset:2496
    ds_read_b128 v[120:123], v8 offset:2560
    ds_read_b128 v[124:127], v8 offset:2624
    s_waitcnt lgkmcnt(4)
    v_mfma_f32_16x16x32_f16 v[20:23], v[32:35], v[108:111], 0
    ds_read_b128 v[108:111], v8 offset:2688
    s_waitcnt lgkmcnt(4)
    v_mfma_f32_16x16x32_f16 v[24:27], v[32:35], v[112:115], 0
    ds_read_b128 v[32:35], v8 offset:2752
    ds_read_b128 v[112:115], v8 offset:2816
    s_waitcnt lgkmcnt(5)
    v_mfma_f32_16x16x32_f16 v[20:23], v[36:39], v[116:119], v[20:23]
    ds_read_b128 v[116:119], v8 offset:2880
    ds_read_b64 v[28:29], v7 offset:3552
    ds_read_b64 v[30:31], v7 offset:4064
    s_waitcnt lgkmcnt(7)
    v_mfma_f32_16x16x32_f16 v[20:23], v[40:43], v[120:123], v[20:23]
    ds_read_b128 v[120:123], v8 offset:2944
    s_waitcnt lgkmcnt(7)
    v_mfma_f32_16x16x32_f16 v[20:23], v[44:47], v[124:127], v[20:23]
    ds_read_b128 v[124:127], v8 offset:3008
    s_waitcnt lgkmcnt(7)
    v_mfma_f32_16x16x32_f16 v[20:23], v[48:51], v[108:111], v[20:23]
    ds_read_b128 v[108:111], v8 offset:3072
    s_waitcnt lgkmcnt(7)
    v_mfma_f32_16x16x32_f16 v[20:23], v[52:55], v[32:35], v[20:23]
    s_waitcnt lgkmcnt(6)
    v_mfma_f32_16x16x32_f16 v[20:23], v[56:59], v[112:115], v[20:23]
    ds_read_b128 v[32:35], v8 offset:3136
    s_waitcnt lgkmcnt(6)
    v_mfma_f32_16x16x32_f16 v[20:23], v[60:63], v[116:119], v[20:23]
    s_waitcnt lgkmcnt(4)
    v_fma_mix_f32 v116, v28, v17, 0 op_sel_hi:[1,0,0]
    v_fma_mix_f32 v117, v28, v17, 0 op_sel:[1,0,0] op_sel_hi:[1,0,0]
    s_waitcnt lgkmcnt(3)
    v_mfma_f32_16x16x32_f16 v[20:23], v[64:67], v[120:123], v[20:23]
    ds_read_b128 v[112:115], v8 offset:3200
    v_fma_mix_f32 v118, v29, v17, 0 op_sel_hi:[1,0,0]
    v_fma_mix_f32 v119, v29, v17, 0 op_sel:[1,0,0] op_sel_hi:[1,0,0]
    s_waitcnt lgkmcnt(3)
    v_mfma_f32_16x16x32_f16 v[20:23], v[68:71], v[124:127], v[20:23]
    v_cvt_pk_bf16_f32 v116, 0, v116
    v_cvt_pk_bf16_f32 v117, 0, v117
    v_mfma_f32_16x16x32_f16 v[24:27], v[36:39], v[124:127], v[24:27]
    ds_read_b128 v[120:123], v8 offset:3264
    v_cvt_pk_bf16_f32 v118, 0, v118
    v_cvt_pk_bf16_f32 v119, 0, v119
    s_waitcnt lgkmcnt(3)
    v_mfma_f32_16x16x32_f16 v[20:23], v[72:75], v[108:111], v[20:23]
    v_fma_mix_f32 v124, v30, v17, 0 op_sel_hi:[1,0,0]
    v_fma_mix_f32 v125, v30, v17, 0 op_sel:[1,0,0] op_sel_hi:[1,0,0]
    v_mfma_f32_16x16x32_f16 v[24:27], v[40:43], v[108:111], v[24:27]
    ds_read_b128 v[36:39], v8 offset:3328
    v_fma_mix_f32 v126, v31, v17, 0 op_sel_hi:[1,0,0]
    v_fma_mix_f32 v127, v31, v17, 0 op_sel:[1,0,0] op_sel_hi:[1,0,0]
    s_waitcnt lgkmcnt(3)
    v_mfma_f32_16x16x32_f16 v[20:23], v[76:79], v[32:35], v[20:23]
    v_cvt_pk_bf16_f32 v124, 0, v124
    v_cvt_pk_bf16_f32 v125, 0, v125
    v_mfma_f32_16x16x32_f16 v[24:27], v[44:47], v[32:35], v[24:27]
    ds_read_b128 v[40:43], v8 offset:3392
    v_cvt_pk_bf16_f32 v126, 0, v126
    v_cvt_pk_bf16_f32 v127, 0, v127
    s_waitcnt lgkmcnt(3)
    v_mfma_f32_16x16x32_f16 v[20:23], v[80:83], v[112:115], v[20:23]
    v_mfma_f32_16x16x32_f16 v[24:27], v[48:51], v[112:115], v[24:27]
    ds_read_b128 v[108:111], v8 offset:3456
    s_waitcnt lgkmcnt(3)
    v_mfma_f32_16x16x32_f16 v[20:23], v[84:87], v[120:123], v[20:23]
    v_mfma_f32_16x16x32_f16 v[24:27], v[52:55], v[120:123], v[24:27]
    ds_read_b128 v[44:47], v8 offset:3520
    s_waitcnt lgkmcnt(3)
    v_mfma_f32_16x16x32_f16 v[20:23], v[88:91], v[36:39], v[20:23]
    v_mfma_f32_16x16x32_f16 v[24:27], v[56:59], v[36:39], v[24:27]
    ds_read_b128 v[32:35], v8 offset:3584
    s_waitcnt lgkmcnt(3)
    v_mfma_f32_16x16x32_f16 v[20:23], v[92:95], v[40:43], v[20:23]
    ds_read_b128 v[48:51], v8 offset:3648
    v_mfma_f32_16x16x32_f16 v[24:27], v[60:63], v[40:43], v[24:27]
    ds_read_b128 v[112:115], v8 offset:3712
    s_waitcnt lgkmcnt(4)
    v_mfma_f32_16x16x32_f16 v[20:23], v[96:99], v[108:111], v[20:23]
    ds_read_b128 v[52:55], v8 offset:3776
    v_mfma_f32_16x16x32_f16 v[24:27], v[64:67], v[108:111], v[24:27]
    ds_read_b128 v[120:123], v8 offset:3840
    s_waitcnt lgkmcnt(5)
    v_mfma_f32_16x16x32_f16 v[20:23], v[100:103], v[44:47], v[20:23]
    ds_read_b128 v[56:59], v8 offset:3904
    v_mfma_f32_16x16x32_f16 v[24:27], v[68:71], v[44:47], v[24:27]
    ds_read_b32 v18, v14 offset:76
    ds_read_b128 v[36:39], v8 offset:3968
    s_waitcnt lgkmcnt(7)
    v_mfma_f32_16x16x32_f16 v[24:27], v[72:75], v[32:35], v[24:27]
    ds_read_b128 v[60:63], v8 offset:4032
    s_waitcnt lgkmcnt(7)
    v_mfma_f32_16x16x32_f16 v[24:27], v[76:79], v[48:51], v[24:27]
    ds_read2_b32 v[40:41], v11 offset0:16 offset1:17
    ds_read2_b32 v[42:43], v11 offset0:18 offset1:19
    ds_read2_b32 v[64:65], v11 offset0:32 offset1:33
    ds_read2_b32 v[66:67], v11 offset0:34 offset1:35
    s_waitcnt lgkmcnt(10)
    v_mfma_f32_16x16x32_f16 v[24:27], v[80:83], v[112:115], v[24:27]
    s_waitcnt lgkmcnt(6)
    v_cmp_ne_u32 vcc, s84, v18
    s_cbranch_vccnz WS_41
WB_42:
    ds_read_b64_tr_b16 v[108:109], v9 offset:1024
    ds_read_b64_tr_b16 v[110:111], v9 offset:1088
    ds_read_b64_tr_b16 v[68:69], v9 offset:1536
    ds_read_b64_tr_b16 v[70:71], v9 offset:1600
    v_mfma_f32_16x16x32_f16 v[24:27], v[84:87], v[52:55], v[24:27]
    ds_read_b64_tr_b16 v[44:45], v9 offset:2048
    ds_read_b64_tr_b16 v[46:47], v9 offset:2112
    v_mfma_f32_16x16x32_f16 v[24:27], v[88:91], v[120:123], v[24:27]
    ds_read_b64_tr_b16 v[72:73], v9 offset:4112
    ds_read_b64_tr_b16 v[74:75], v9 offset:4176
    ds_read2_b32 v[32:33], v11 offset0:64 offset1:65
    ds_read2_b32 v[34:35], v11 offset0:66 offset1:67
    v_mfma_f32_16x16x32_f16 v[24:27], v[92:95], v[56:59], v[24:27]
    ds_read_b64_tr_b16 v[76:77], v9 offset:4624
    ds_read_b64_tr_b16 v[78:79], v9 offset:4688
    ds_read2_b32 v[48:49], v11 offset0:80 offset1:81
    ds_read2_b32 v[50:51], v11 offset0:82 offset1:83
    v_mfma_f32_16x16x32_f16 v[24:27], v[96:99], v[36:39], v[24:27]
    ds_read_b64_tr_b16 v[80:81], v9 offset:5136
    ds_read_b64_tr_b16 v[82:83], v9 offset:5200
    ds_read2_b32 v[112:113], v11 offset0:96 offset1:97
    ds_read2_b32 v[114:115], v11 offset0:98 offset1:99
    v_mfma_f32_16x16x32_f16 v[24:27], v[100:103], v[60:63], v[24:27]
    ds_read_b64_tr_b16 v[84:85], v10 offset:6176
    ds_read_b64_tr_b16 v[86:87], v10 offset:6304
    ds_read2_b32 v[52:53], v13 offset0:8 offset1:9
    ds_read2_b32 v[54:55], v13 offset0:10 offset1:11
    v_mfma_f32_16x16x32_f16 v[20:23], v[108:111], v[104:107], v[20:23]
    ds_read_b64_tr_b16 v[88:89], v10 offset:7200
    ds_read_b64_tr_b16 v[90:91], v10 offset:7328
    ds_read2_b32 v[120:121], v13 offset0:24 offset1:25
    ds_read2_b32 v[122:123], v13 offset0:26 offset1:27
    v_mfma_f32_16x16x32_f16 v[20:23], v[68:71], v[40:43], v[20:23]
    ds_read_b64_tr_b16 v[92:93], v10 offset:8224
    ds_read_b64_tr_b16 v[94:95], v10 offset:8352
    ds_read2_b32 v[56:57], v13 offset0:104 offset1:105
    ds_read2_b32 v[58:59], v13 offset0:106 offset1:107
    v_mfma_f32_16x16x32_f16 v[20:23], v[44:47], v[64:67], v[20:23]
    ds_read_b64_tr_b16 v[96:97], v10 offset:9248
    ds_read_b64_tr_b16 v[98:99], v10 offset:9376
    ds_read2_b32 v[36:37], v13 offset0:120 offset1:121
    ds_read2_b32 v[38:39], v13 offset0:122 offset1:123
    v_mfma_f32_16x16x32_f16 v[20:23], v[72:75], v[32:35], v[20:23]
    v_mfma_f32_16x16x32_f16 v[20:23], v[76:79], v[48:51], v[20:23]
    v_mfma_f32_16x16x32_f16 v[20:23], v[80:83], v[112:115], v[20:23]
    ds_read_b64_tr_b16 v[100:101], v9 offset:2560
    ds_read_b64_tr_b16 v[102:103], v9 offset:2624
    s_waitcnt lgkmcnt(14)
    v_mfma_f32_16x16x32_f16 v[20:23], v[84:87], v[52:55], v[20:23]
    s_waitcnt lgkmcnt(10)
    v_mfma_f32_16x16x32_f16 v[20:23], v[88:91], v[120:123], v[20:23]
    s_waitcnt lgkmcnt(6)
    v_mfma_f32_16x16x32_f16 v[20:23], v[92:95], v[56:59], v[20:23]
    ds_read_b64_tr_b16 v[60:61], v9 offset:5648
    ds_read_b64_tr_b16 v[62:63], v9 offset:5712
    ds_read2_b32 v[108:109], v13 offset0:0 offset1:1
    ds_read2_b32 v[110:111], v13 offset0:2 offset1:3
    s_waitcnt lgkmcnt(6)
    v_mfma_f32_16x16x32_f16 v[20:23], v[96:99], v[36:39], v[20:23]
    ds_read2_b32 v[72:73], v13 offset0:16 offset1:17
    ds_read2_b32 v[74:75], v13 offset0:18 offset1:19
    ds_read2_b32 v[52:53], v13 offset0:96 offset1:97
    ds_read2_b32 v[54:55], v13 offset0:98 offset1:99
    v_mfma_f32_16x16x32_f16 v[24:27], v[68:71], v[104:107], v[24:27]
    ds_read2_b32 v[120:121], v13 offset0:112 offset1:113
    ds_read2_b32 v[122:123], v13 offset0:114 offset1:115
    v_mfma_f32_16x16x32_f16 v[24:27], v[44:47], v[40:43], v[24:27]
    v_mul_f32 v20, v20, v16
    v_mul_f32 v21, v21, v16
    s_waitcnt lgkmcnt(10)
    v_mfma_f32_16x16x32_f16 v[24:27], v[100:103], v[64:67], v[24:27]
    v_mul_f32 v22, v22, v16
    v_mul_f32 v23, v23, v16
    v_mfma_f32_16x16x32_f16 v[24:27], v[76:79], v[32:35], v[24:27]
    v_cvt_pk_bf16_f32 v20, 0, v20
    v_cvt_pk_bf16_f32 v21, 0, v21
    v_mfma_f32_16x16x32_f16 v[24:27], v[80:83], v[48:51], v[24:27]
    v_cvt_pk_bf16_f32 v22, 0, v22
    v_cvt_pk_bf16_f32 v23, 0, v23
    s_waitcnt lgkmcnt(8)
    v_mfma_f32_16x16x32_f16 v[24:27], v[60:63], v[112:115], v[24:27]
    v_add_f32 v20, v20, v116
    v_add_f32 v21, v21, v117
    s_waitcnt lgkmcnt(6)
    v_mfma_f32_16x16x32_f16 v[24:27], v[84:87], v[108:111], v[24:27]
    v_add_f32 v22, v22, v118
    v_add_f32 v23, v23, v119
    s_waitcnt lgkmcnt(4)
    v_mfma_f32_16x16x32_f16 v[24:27], v[88:91], v[72:75], v[24:27]
    v_cvt_pk_bf16_f32 v28, v20, v21
    v_cvt_pk_bf16_f32 v29, v22, v23
    s_waitcnt lgkmcnt(2)
    v_mfma_f32_16x16x32_f16 v[24:27], v[92:95], v[52:55], v[24:27]
    v_min_u32 v28, -2, v28
    v_min_u32 v29, -2, v29
    s_waitcnt lgkmcnt(0)
    v_mfma_f32_16x16x32_f16 v[24:27], v[96:99], v[120:123], v[24:27]
    ds_read_u8 v18, v4 offset:163
    ds_read_b128 v[20:23], v12 offset:49664
    s_nop 5
    v_mul_f32 v24, v24, v16
    v_mul_f32 v25, v25, v16
    v_mul_f32 v26, v26, v16
    v_mul_f32 v27, v27, v16
    v_cvt_pk_bf16_f32 v24, 0, v24
    v_cvt_pk_bf16_f32 v25, 0, v25
    v_cvt_pk_bf16_f32 v26, 0, v26
    v_cvt_pk_bf16_f32 v27, 0, v27
    v_add_f32 v24, v24, v124
    v_add_f32 v25, v25, v125
    v_add_f32 v26, v26, v126
    v_add_f32 v27, v27, v127
    v_cvt_pk_bf16_f32 v30, v24, v25
    v_cvt_pk_bf16_f32 v31, v26, v27
    v_min_u32 v30, -2, v30
    v_min_u32 v31, -2, v31
CVE_32:
    s_waitcnt lgkmcnt(0)
    s_cmp_lg_u32 s87, 1
    s_cbranch_scc1 ZA_43
    v_cmp_ne_u32 vcc, 1, v18
    s_cbranch_vccnz ZS_45
ZB_46:
    s_mov_b64 exec, s[12:13]
    v_swap_b32 v28, v20
    v_swap_b32 v29, v21
    v_swap_b32 v30, v22
    v_swap_b32 v31, v23
    s_mov_b64 exec, -1
    buffer_store_dwordx4 v[28:31], v6, s[64:67], s7 offen sc1
    buffer_store_dwordx4 v[20:23], v6, s[64:67], s6 offen sc1
    s_branch ZD_48
WS_35:
W_49:
    ds_read_b32 v18, v14 offset:76
    s_sub_u32 s39, s39, 1
    s_cbranch_scc1 KS_ABORT
    s_waitcnt lgkmcnt(0)
    v_cmp_ne_u32 vcc, s84, v18
    s_cbranch_vccnz W_49
    s_branch WB_36
WS_38:
W_50:
    ds_read_b32 v18, v14 offset:76
    s_sub_u32 s39, s39, 1
    s_cbranch_scc1 KS_ABORT
    s_waitcnt lgkmcnt(0)
    v_cmp_ne_u32 vcc, s84, v18
    s_cbranch_vccnz W_50
    s_branch WB_39
WS_41:
W_51:
    ds_read_b32 v18, v14 offset:76
    s_sub_u32 s39, s39, 1
    s_cbranch_scc1 KS_ABORT
    s_waitcnt lgkmcnt(0)
    v_cmp_ne_u32 vcc, s84, v18
    s_cbranch_vccnz W_51
    s_branch WB_42
ZS_45:
    v_mov_b32 v19, s86
ZW_52:
    ds_read_u8 v18, v19 offset:160
    s_sub_u32 s39, s39, 1
    s_cbranch_scc1 KS_ABORT
    s_waitcnt lgkmcnt(0)
    v_cmp_ne_u32 vcc, 1, v18
    s_cbranch_vccnz ZW_52
    v_lshl_add_u32 v19, v19, 10, v12
    ds_read_b128 v[20:23], v19 offset:46592
    s_waitcnt lgkmcnt(0)
    s_branch ZB_46
ZA_43:
    s_cmp_lg_u32 s87, 0
    s_cbranch_scc1 ZC_44
    v_mov_b32 v19, s86
    v_lshl_add_u32 v18, v19, 10, v12
    ds_write_b128 v18, v[28:31] offset:46592
    ds_write_b8 v19, v5 offset:160
    s_branch ZD_48
ZC_44:
    buffer_store_dwordx4 v[28:31], v6, s[64:67], s6 offen sc1
ZD_48:
    s_lshl_b32 s92, s87, 2
    s_add_u32 s92, s92, s86
    v_mov_b32 v8, s92
    s_waitcnt vmcnt(0)
    ds_write_b8 v8, v5 offset:48
    s_branch KS_K1
    s_cmp_lg_u32 s38, 4
    s_cbranch_scc1 KS_K1
    s_setprio 0
    s_add_u32 s76, s36, 0x840000
    s_addc_u32 s77, s37, 0
    s_mov_b32 s78, 0x3000
    s_mov_b32 s79, 0x20000
    v_and_b32 v6, 1, v1
    v_lshlrev_b32 v6, 4, v6
    s_lshl_b32 s92, s90, 5
W_53:
    s_sleep 1
    ds_read_b32 v8, v4 offset:20
    s_sub_u32 s39, s39, 1
    s_cbranch_scc1 KS_ABORT
    s_waitcnt lgkmcnt(0)
    v_cmp_ne_u32 vcc, s84, v8
    s_cbranch_vccnz W_53
    s_mov_b64 exec, 3
    s_setprio 1
KS_K0:
    ds_read_b128 v[8:11], v6 offset:800
    s_sub_u32 s39, s39, 1
    s_cbranch_scc1 KS_ABORT
    s_waitcnt lgkmcnt(0)
    v_min3_u32 v12, v8, v9, v10
    v_min_u32 v12, v12, v11
    v_cmp_eq_u32 vcc, 0, v12
    s_cbranch_vccnz KS_K0
    buffer_store_dwordx4 v[8:11], v6, s[76:79], s92 offen sc1
    s_mov_b64 exec, -1
    s_waitcnt vmcnt(0)
    ds_write_b32 v4, v5 offset:24
KS_K1:
    s_cmp_lt_u32 s41, 18
    s_cbranch_scc1 KS_T
    s_waitcnt lgkmcnt(0)
    s_endpgm
KS_X:
    s_cmp_lt_u32 s41, 24
    s_cbranch_scc1 KS_X2
    s_setprio 2
KS_XC:
    s_mov_b32 s87, 2
    s_add_u32 s86, s38, 3
    s_and_b32 s86, s86, 3
    s_lshl_b32 s88, s40, 3
    s_and_b32 s92, s41, 7
    s_add_u32 s88, s88, s92
    s_add_u32 s88, s88, 512
    s_lshl_b32 s92, s86, 11
    s_add_u32 s92, s92, 146048
    v_lshl_add_u32 v28, v1, 3, s92
    s_branch KS_GRP
KS_X2:
    s_cmp_lt_u32 s41, 8
    s_cbranch_scc1 KS_X3
    s_sub_u32 s97, s38, 8
    s_branch KS_LN1
KS_X3:
    s_lshl_b32 s92, s2, 4
    s_add_u32 s92, s92, s38
    s_cmp_lg_u32 s92, 44
    s_cbranch_scc1 KS_X3B
    s_setprio 3
    s_memrealtime s[92:93]
    v_and_b32 v6, 3, v1
    v_lshlrev_b32 v7, 2, v6
    v_min_u32 v6, 2, v6
    v_lshlrev_b32 v6, 2, v6
    v_cmp_eq_u32 vcc, 3, v1
    s_waitcnt lgkmcnt(0)
    v_mov_b32 v8, s92
    v_mov_b32 v9, s93
    v_alignbit_b32 v8, v8, v8, v6
    v_cndmask_b32 v9, v4, v9, vcc
    v_xor_b32 v8, v8, v9
    v_and_b32 v9, 0xf0000fff, v8
    v_and_b32 v10, 0xfff000, v8
    v_lshl_or_b32 v9, v10, 4, v9
    v_lshrrev_b32 v10, 12, v8
    v_and_b32 v10, 0xf000, v10
    v_or3_b32 v9, v9, v10, v9
    v_or_b32 v9, 0x80000000, v9
    s_mov_b64 exec, 15
    global_store_dword v7, v9, s[34:35] sc1
    s_mov_b64 exec, -1
    s_setprio 0
KS_X3B:
    s_setprio 3
    s_branch KS_XC
    s_waitcnt lgkmcnt(0)
    s_barrier
    s_branch KS_G
KS_X4:
    s_cmp_lt_u32 s41, 18
    s_cbranch_scc1 KS_G
    s_waitcnt vmcnt(0) lgkmcnt(0)
    s_endpgm
KS_L:
    v_lshlrev_b32 v6, 2, v0
    ds_write_b32 v6, v4
    v_mov_b32 v8, 0
    v_mov_b32 v9, 0
    s_min_u32 s92, s38, 2
    s_mul_i32 s92, s92, 4672
    v_min_u32 v6, 59, v1
    v_lshl_add_u32 v6, v6, 3, s92
    ds_write_b64 v6, v[8:9] offset:3072
    s_mov_b32 s97, s38
    s_sub_u32 s92, s41, 8
    s_cmp_lt_u32 s92, 16
    s_cbranch_scc0 KS_L0
KS_LN1:
    s_setprio 3
    s_sub_u32 s92, s41, 8
    s_and_b32 s88, s92, 7
    s_lshr_b32 s92, s92, 3
    s_lshl_b32 s92, s92, 4
    s_add_u32 s88, s88, s92
    s_and_b32 s92, s40, 1
    s_lshl_b32 s92, s92, 3
    s_add_u32 s88, s88, s92
    s_lshr_b32 s92, s40, 1
    s_lshl_b32 s92, s92, 5
    s_add_u32 s88, s88, s92
    v_lshrrev_b32 v36, 5, v1
    v_and_b32 v37, 31, v1
    v_mul_u32_u24 v38, 1152, v36
    v_lshl_add_u32 v39, v37, 2, v38
    v_lshl_add_u32 v38, v37, 4, v38
    s_mul_i32 s93, s88, 18432
    s_mul_i32 s94, s97, 2304
    s_add_u32 s93, s93, s94
    s_waitcnt lgkmcnt(0)
    s_mov_b32 s64, s4
    s_mov_b32 s65, s5
    s_mov_b32 s66, 0x240000
    s_mov_b32 s67, 0x20000
    buffer_load_dwordx4 v[26:29], v38, s[64:67], s93 offen
    buffer_load_dwordx4 v[30:33], v38, s[64:67], s93 offen offset:512
    buffer_load_dword v34, v39, s[64:67], s93 offen offset:1024
    s_barrier
    s_lshr_b32 s93, s97, 2
    s_lshl_b32 s93, s93, 6
    s_add_u32 s94, s94, s93
    s_add_u32 s94, s94, 17088
    v_lshl_add_u32 v35, v37, 1, v36
    s_mov_b32 s98, 0x05040100
    s_mov_b32 s99, 0x07060302
    s_cmp_lt_u32 s97, 4
    s_cbranch_scc1 LN1A_54
    s_cmp_ge_u32 s41, 18
    s_cbranch_scc1 LN1A_54
    s_mov_b32 s68, s30
    s_mov_b32 s69, s31
    s_mov_b32 s70, 0x510000
    s_mov_b32 s71, 0x20000
    v_lshlrev_b32 v46, 4, v1
    s_mul_i32 s92, s89, 36864
    s_mul_i32 s93, s97, 9216
    s_add_u32 s92, s92, s93
    s_sub_u32 s92, s92, 36864
    s_add_u32 s93, s93, 72320
    s_add_u32 m0, s93, 0
    s_nop 0
    buffer_load_dwordx4 v46, s[68:71], s92 offen offset:0 nt lds
    buffer_load_dwordx4 v46, s[68:71], s92 offen offset:1024 nt lds
    buffer_load_dwordx4 v46, s[68:71], s92 offen offset:2048 nt lds
    buffer_load_dwordx4 v46, s[68:71], s92 offen offset:3072 nt lds
    s_add_u32 m0, s93, 4096
    s_add_u32 s92, s92, 4096
    buffer_load_dwordx4 v46, s[68:71], s92 offen offset:0 nt lds
    buffer_load_dwordx4 v46, s[68:71], s92 offen offset:1024 nt lds
    buffer_load_dwordx4 v46, s[68:71], s92 offen offset:2048 nt lds
    buffer_load_dwordx4 v46, s[68:71], s92 offen offset:3072 nt lds
    s_add_u32 m0, s93, 8192
    s_add_u32 s92, s92, 4096
    buffer_load_dwordx4 v46, s[68:71], s92 offen offset:0 nt lds
    s_waitcnt vmcnt(11)
    v_lshlrev_b32 v8, 16, v26
    v_and_b32 v9, 0xffff0000, v26
    v_lshlrev_b32 v10, 16, v27
    v_and_b32 v11, 0xffff0000, v27
    v_lshlrev_b32 v12, 16, v28
    v_and_b32 v13, 0xffff0000, v28
    v_lshlrev_b32 v14, 16, v29
    v_and_b32 v15, 0xffff0000, v29
    s_waitcnt vmcnt(10)
    v_lshlrev_b32 v16, 16, v30
    v_and_b32 v17, 0xffff0000, v30
    v_lshlrev_b32 v18, 16, v31
    v_and_b32 v19, 0xffff0000, v31
    v_lshlrev_b32 v20, 16, v32
    v_and_b32 v21, 0xffff0000, v32
    v_lshlrev_b32 v22, 16, v33
    v_and_b32 v23, 0xffff0000, v33
    s_waitcnt vmcnt(9)
    v_lshlrev_b32 v24, 16, v34
    v_and_b32 v25, 0xffff0000, v34
    s_branch LN1B_55
LN1A_54:
    s_waitcnt vmcnt(2)
    v_lshlrev_b32 v8, 16, v26
    v_and_b32 v9, 0xffff0000, v26
    v_lshlrev_b32 v10, 16, v27
    v_and_b32 v11, 0xffff0000, v27
    v_lshlrev_b32 v12, 16, v28
    v_and_b32 v13, 0xffff0000, v28
    v_lshlrev_b32 v14, 16, v29
    v_and_b32 v15, 0xffff0000, v29
    s_waitcnt vmcnt(1)
    v_lshlrev_b32 v16, 16, v30
    v_and_b32 v17, 0xffff0000, v30
    v_lshlrev_b32 v18, 16, v31
    v_and_b32 v19, 0xffff0000, v31
    v_lshlrev_b32 v20, 16, v32
    v_and_b32 v21, 0xffff0000, v32
    v_lshlrev_b32 v22, 16, v33
    v_and_b32 v23, 0xffff0000, v33
    s_waitcnt vmcnt(0)
    v_lshlrev_b32 v24, 16, v34
    v_and_b32 v25, 0xffff0000, v34
    s_nop 1
LN1B_55:
    v_lshl_add_u32 v6, v35, 4, s94
    v_lshl_add_u32 v7, v35, 2, s94
    v_mul_u32_u24 v35, 0x20202, v36
    v_lshl_add_u32 v35, v36, 25, v35
    v_add_u32 v35, 0x05040100, v35
    v_pk_add_f32 v[40:41], v[8:9], v[10:11]
    v_pk_add_f32 v[42:43], v[12:13], v[14:15]
    v_pk_add_f32 v[40:41], v[40:41], v[16:17]
    v_pk_add_f32 v[42:43], v[42:43], v[18:19]
    v_pk_add_f32 v[40:41], v[40:41], v[20:21]
    v_pk_add_f32 v[42:43], v[42:43], v[22:23]
    v_pk_add_f32 v[40:41], v[40:41], v[24:25]
    v_pk_add_f32 v[40:41], v[40:41], v[42:43]
    v_add_f32 v40, v40, v41
    s_nop 1
    v_add_f32_dpp v40, v40, v40 row_ror:8 row_mask:0xf bank_mask:0xf
    s_nop 1
    v_add_f32_dpp v40, v40, v40 row_ror:4 row_mask:0xf bank_mask:0xf
    s_nop 1
    v_add_f32_dpp v40, v40, v40 row_ror:2 row_mask:0xf bank_mask:0xf
    s_nop 1
    v_add_f32_dpp v40, v40, v40 row_ror:1 row_mask:0xf bank_mask:0xf
    v_mov_b32 v42, v40
    s_nop 1
    v_permlane16_swap_b32 v40, v42
    v_add_f32 v40, v40, v42
    v_mul_f32 v44, 0x3ae38e39, v40
    v_mov_b32 v45, v44
    v_cvt_pk_bf16_f32 v36, 0, v44
    v_cvt_pk_bf16_f32 v37, 0, v44
    v_pk_add_f32 v[38:39], v[8:9], v[44:45] neg_lo:[0,1] neg_hi:[0,1]
    v_pk_mul_f32 v[40:41], v[38:39], v[38:39]
    v_pk_add_f32 v[38:39], v[10:11], v[44:45] neg_lo:[0,1] neg_hi:[0,1]
    v_pk_mul_f32 v[42:43], v[38:39], v[38:39]
    v_pk_add_f32 v[38:39], v[12:13], v[44:45] neg_lo:[0,1] neg_hi:[0,1]
    v_pk_fma_f32 v[40:41], v[38:39], v[38:39], v[40:41]
    v_pk_add_f32 v[38:39], v[14:15], v[44:45] neg_lo:[0,1] neg_hi:[0,1]
    v_pk_fma_f32 v[42:43], v[38:39], v[38:39], v[42:43]
    v_pk_add_f32 v[38:39], v[16:17], v[44:45] neg_lo:[0,1] neg_hi:[0,1]
    v_pk_fma_f32 v[40:41], v[38:39], v[38:39], v[40:41]
    v_pk_add_f32 v[38:39], v[18:19], v[44:45] neg_lo:[0,1] neg_hi:[0,1]
    v_pk_fma_f32 v[42:43], v[38:39], v[38:39], v[42:43]
    v_pk_add_f32 v[38:39], v[20:21], v[44:45] neg_lo:[0,1] neg_hi:[0,1]
    v_pk_fma_f32 v[40:41], v[38:39], v[38:39], v[40:41]
    v_pk_add_f32 v[38:39], v[22:23], v[44:45] neg_lo:[0,1] neg_hi:[0,1]
    v_pk_fma_f32 v[42:43], v[38:39], v[38:39], v[42:43]
    v_pk_add_f32 v[38:39], v[24:25], v[44:45] neg_lo:[0,1] neg_hi:[0,1]
    v_pk_fma_f32 v[40:41], v[38:39], v[38:39], v[40:41]
    v_pk_add_f32 v[40:41], v[40:41], v[42:43]
    v_add_f32 v40, v40, v41
    s_nop 1
    v_add_f32_dpp v40, v40, v40 row_ror:8 row_mask:0xf bank_mask:0xf
    s_nop 1
    v_add_f32_dpp v40, v40, v40 row_ror:4 row_mask:0xf bank_mask:0xf
    s_nop 1
    v_add_f32_dpp v40, v40, v40 row_ror:2 row_mask:0xf bank_mask:0xf
    s_nop 1
    v_add_f32_dpp v40, v40, v40 row_ror:1 row_mask:0xf bank_mask:0xf
    v_mov_b32 v42, v40
    s_nop 1
    v_permlane16_swap_b32 v40, v42
    v_add_f32 v40, v40, v42
    v_mul_f32 v40, 0x3ae38e39, v40
    v_cvt_pk_bf16_f32 v40, 0, v40
    v_add_f32 v40, 0x3727c5ac, v40
    v_cvt_pk_bf16_f32 v40, 0, v40
    v_sqrt_f32 v40, v40
    s_nop 0
    v_cvt_pk_bf16_f32 v40, 0, v40
    v_rcp_f32 v38, v40
    s_nop 0
    v_mov_b32 v39, v38
    v_pk_add_f32 v[40:41], v[8:9], v[36:37] neg_lo:[0,1] neg_hi:[0,1]
    v_cvt_pk_bf16_f32 v40, 0, v40
    v_cvt_pk_bf16_f32 v41, 0, v41
    v_pk_mul_f32 v[40:41], v[40:41], v[38:39]
    v_cvt_pk_bf16_f32 v40, 0, v40
    v_cvt_pk_bf16_f32 v41, 0, v41
    v_cvt_pk_f16_f32 v26, v40, v41
    v_pk_add_f32 v[40:41], v[10:11], v[36:37] neg_lo:[0,1] neg_hi:[0,1]
    v_cvt_pk_bf16_f32 v40, 0, v40
    v_cvt_pk_bf16_f32 v41, 0, v41
    v_pk_mul_f32 v[40:41], v[40:41], v[38:39]
    v_cvt_pk_bf16_f32 v40, 0, v40
    v_cvt_pk_bf16_f32 v41, 0, v41
    v_cvt_pk_f16_f32 v27, v40, v41
    v_pk_add_f32 v[40:41], v[12:13], v[36:37] neg_lo:[0,1] neg_hi:[0,1]
    v_cvt_pk_bf16_f32 v40, 0, v40
    v_cvt_pk_bf16_f32 v41, 0, v41
    v_pk_mul_f32 v[40:41], v[40:41], v[38:39]
    v_cvt_pk_bf16_f32 v40, 0, v40
    v_cvt_pk_bf16_f32 v41, 0, v41
    v_cvt_pk_f16_f32 v28, v40, v41
    v_and_b32 v59, 3, v1
    v_lshlrev_b32 v59, 2, v59
    global_load_dword v58, v59, s[34:35] sc1
    v_pk_add_f32 v[40:41], v[14:15], v[36:37] neg_lo:[0,1] neg_hi:[0,1]
    v_cvt_pk_bf16_f32 v40, 0, v40
    v_cvt_pk_bf16_f32 v41, 0, v41
    v_pk_mul_f32 v[40:41], v[40:41], v[38:39]
    v_cvt_pk_bf16_f32 v40, 0, v40
    v_cvt_pk_bf16_f32 v41, 0, v41
    v_cvt_pk_f16_f32 v29, v40, v41
    v_permlane32_swap_b32 v26, v28
    s_nop 0
    v_permlane32_swap_b32 v27, v29
    v_perm_b32 v8, v28, v26, s98
    v_perm_b32 v9, v28, v26, s99
    v_perm_b32 v10, v29, v27, s98
    v_perm_b32 v11, v29, v27, s99
    ds_write_b128 v6, v[8:11] offset:0
    v_pk_add_f32 v[40:41], v[16:17], v[36:37] neg_lo:[0,1] neg_hi:[0,1]
    v_cvt_pk_bf16_f32 v40, 0, v40
    v_cvt_pk_bf16_f32 v41, 0, v41
    v_pk_mul_f32 v[40:41], v[40:41], v[38:39]
    v_cvt_pk_bf16_f32 v40, 0, v40
    v_cvt_pk_bf16_f32 v41, 0, v41
    v_cvt_pk_f16_f32 v30, v40, v41
    v_pk_add_f32 v[40:41], v[18:19], v[36:37] neg_lo:[0,1] neg_hi:[0,1]
    v_cvt_pk_bf16_f32 v40, 0, v40
    v_cvt_pk_bf16_f32 v41, 0, v41
    v_pk_mul_f32 v[40:41], v[40:41], v[38:39]
    v_cvt_pk_bf16_f32 v40, 0, v40
    v_cvt_pk_bf16_f32 v41, 0, v41
    v_cvt_pk_f16_f32 v31, v40, v41
    v_pk_add_f32 v[40:41], v[20:21], v[36:37] neg_lo:[0,1] neg_hi:[0,1]
    v_cvt_pk_bf16_f32 v40, 0, v40
    v_cvt_pk_bf16_f32 v41, 0, v41
    v_pk_mul_f32 v[40:41], v[40:41], v[38:39]
    v_cvt_pk_bf16_f32 v40, 0, v40
    v_cvt_pk_bf16_f32 v41, 0, v41
    v_cvt_pk_f16_f32 v32, v40, v41
    v_pk_add_f32 v[40:41], v[22:23], v[36:37] neg_lo:[0,1] neg_hi:[0,1]
    v_cvt_pk_bf16_f32 v40, 0, v40
    v_cvt_pk_bf16_f32 v41, 0, v41
    v_pk_mul_f32 v[40:41], v[40:41], v[38:39]
    v_cvt_pk_bf16_f32 v40, 0, v40
    v_cvt_pk_bf16_f32 v41, 0, v41
    v_cvt_pk_f16_f32 v33, v40, v41
    v_permlane32_swap_b32 v30, v32
    s_nop 0
    v_permlane32_swap_b32 v31, v33
    v_perm_b32 v16, v32, v30, s98
    v_perm_b32 v17, v32, v30, s99
    v_perm_b32 v18, v33, v31, s98
    v_perm_b32 v19, v33, v31, s99
    ds_write_b128 v6, v[16:19] offset:1024
    v_pk_add_f32 v[40:41], v[24:25], v[36:37] neg_lo:[0,1] neg_hi:[0,1]
    v_cvt_pk_bf16_f32 v40, 0, v40
    v_cvt_pk_bf16_f32 v41, 0, v41
    v_pk_mul_f32 v[40:41], v[40:41], v[38:39]
    v_cvt_pk_bf16_f32 v40, 0, v40
    v_cvt_pk_bf16_f32 v41, 0, v41
    v_cvt_pk_f16_f32 v34, v40, v41
    v_mov_b32 v40, v34
    s_nop 1
    v_permlane32_swap_b32 v34, v40
    v_perm_b32 v40, v40, v34, v35
    ds_write_b32 v7, v40 offset:2048
    v_mov_b32 v6, s97
    ds_write_b8 v6, v5 offset:0
    s_setprio 0
    s_cmp_ge_u32 s97, 4
    s_cbranch_scc1 KS_X4
    s_setprio 3
    s_mov_b32 s72, s36
    s_mov_b32 s73, s37
    s_mov_b32 s74, 0x240000
    s_mov_b32 s75, 0x20000
    v_and_b32 v6, 1, v0
    v_mul_u32_u24 v6, 9280, v6
    v_lshrrev_b32 v7, 1, v0
    v_lshl_add_u32 v6, v7, 2, v6
    v_add_u32 v6, 17088, v6
    v_lshrrev_b32 v7, 2, v0
    v_mul_u32_u24 v7, 0x2080, v7
    v_and_b32 v8, 3, v0
    v_lshl_add_u32 v7, v8, 4, v7
    s_lshl_b32 s92, s88, 6
    v_xor_b32 v7, s92, v7
    s_mov_b32 s92, 0
    s_add_u32 s93, s92, 524288
    s_add_u32 s94, s92, 1048576
    s_add_u32 s95, s92, 1572864
    s_add_u32 s96, s92, 2097152
    s_waitcnt vmcnt(0)
DBP_56:
    v_cmp_eq_u32 vcc, 0, v58
    s_cbranch_vccz DBG_57
    s_sleep 1
    global_load_dword v58, v59, s[34:35] sc1
    s_sub_u32 s39, s39, 1
    s_cbranch_scc1 KS_ABORT
    s_waitcnt vmcnt(0)
    s_branch DBP_56
DBG_57:
    ds_write_b32 v59, v58 offset:224
    s_mov_b32 s98, 0x70007
    v_lshrrev_b32 v57, 3, v58
    v_lshrrev_b32 v56, 6, v58
    v_lshrrev_b32 v55, 9, v58
W_58:
    ds_read_b64 v[20:21], v4 offset:0
    s_sub_u32 s39, s39, 1
    s_cbranch_scc1 KS_ABORT
    s_waitcnt lgkmcnt(0)
    v_and_b32 v20, v20, v21
    v_cmp_ne_u32 vcc, s84, v20
    s_cbranch_vccnz W_58
    ds_read2st64_b32 v[20:21], v6 offset0:0 offset1:9
    ds_read2st64_b32 v[22:23], v6 offset0:18 offset1:27
    ds_read2st64_b32 v[24:25], v6 offset0:2 offset1:11
    ds_read2st64_b32 v[26:27], v6 offset0:20 offset1:29
    ds_read2st64_b32 v[28:29], v6 offset0:4 offset1:13
    ds_read2st64_b32 v[30:31], v6 offset0:22 offset1:31
    ds_read2st64_b32 v[32:33], v6 offset0:6 offset1:15
    ds_read2st64_b32 v[34:35], v6 offset0:24 offset1:33
    ds_read2st64_b32 v[36:37], v6 offset0:8 offset1:17
    ds_read2st64_b32 v[38:39], v6 offset0:26 offset1:35
    s_waitcnt lgkmcnt(8)
    v_bfi_b32 v20, s98, v58, v20
    v_bfi_b32 v21, s98, v57, v21
    v_bfi_b32 v22, s98, v56, v22
    v_bfi_b32 v23, s98, v55, v23
    buffer_store_dwordx4 v[20:23], v7, s[72:75], s92 offen sc1
    s_waitcnt lgkmcnt(6)
    v_bfi_b32 v24, s98, v58, v24
    v_bfi_b32 v25, s98, v57, v25
    v_bfi_b32 v26, s98, v56, v26
    v_bfi_b32 v27, s98, v55, v27
    buffer_store_dwordx4 v[24:27], v7, s[72:75], s93 offen sc1
    s_waitcnt lgkmcnt(4)
    v_bfi_b32 v28, s98, v58, v28
    v_bfi_b32 v29, s98, v57, v29
    v_bfi_b32 v30, s98, v56, v30
    v_bfi_b32 v31, s98, v55, v31
    buffer_store_dwordx4 v[28:31], v7, s[72:75], s94 offen sc1
    s_waitcnt lgkmcnt(2)
    v_bfi_b32 v32, s98, v58, v32
    v_bfi_b32 v33, s98, v57, v33
    v_bfi_b32 v34, s98, v56, v34
    v_bfi_b32 v35, s98, v55, v35
    buffer_store_dwordx4 v[32:35], v7, s[72:75], s95 offen sc1
    s_waitcnt lgkmcnt(0)
    v_bfi_b32 v36, s98, v58, v36
    v_bfi_b32 v37, s98, v57, v37
    v_bfi_b32 v38, s98, v56, v38
    v_bfi_b32 v39, s98, v55, v39
    buffer_store_dwordx4 v[36:39], v7, s[72:75], s96 offen sc1
    v_mov_b32 v6, s97
    ds_write_b8 v6, v5 offset:200
    v_mul_u32_u24 v46, 57, v1
    v_lshrrev_b32 v46, 9, v46
    v_mul_u32_u24 v47, 9, v46
    v_sub_u32 v47, v1, v47
    v_mul_u32_u24 v46, 9216, v46
    v_lshl_add_u32 v46, v47, 7, v46
    s_cmp_ge_u32 s41, 18
    s_cbranch_scc1 KS_LL2
    s_branch KS_LLE
KS_LL2:
    s_mul_i32 s94, s38, 6
    s_add_u32 s94, s94, s41
    s_sub_u32 s94, s94, 18
    s_bitcmp1_b32 s94, 0
    s_cselect_b32 s72, s28, s26
    s_cselect_b32 s73, s29, s27
    s_mov_b32 s74, 0x510000
    s_mov_b32 s75, 0x20000
    s_lshr_b32 s95, s94, 1
    s_mul_i32 s95, s95, 64512
    s_mul_i32 s96, s40, 1152
    s_add_u32 s95, s95, s96
    s_add_u32 s96, s95, 2644992
    buffer_load_dword v47, v46, s[72:75], s96 offen nt
    buffer_load_dword v47, v46, s[72:75], s96 offen sc1
KS_LLE:
    s_mov_b32 s87, 1
    s_branch KS_L2B
KS_L0:
    s_and_b32 s92, s41, 15
    s_lshl_b32 s93, s40, 4
    s_add_u32 s92, s92, s93
    v_and_b32 v59, 3, v1
    v_lshlrev_b32 v59, 2, v59
    s_lshl_b32 s96, s92, 6
    s_add_u32 s93, s96, 0xb00000
    v_add_u32 v7, s93, v59
    s_mul_i32 s93, s92, 18560
    s_add_u32 s93, s93, 0x600000
    v_lshlrev_b32 v6, 4, v0
    v_mov_b32 v12, -1
    v_mov_b32 v13, -1
    v_mov_b32 v14, -1
    v_mov_b32 v15, -1
    s_setprio 3
    v_mul_u32_u24 v16, 57, v1
    v_lshrrev_b32 v16, 9, v16
    v_mul_u32_u24 v17, 9, v16
    v_sub_u32 v17, v1, v17
    v_mul_u32_u24 v16, 9216, v16
    v_lshl_add_u32 v16, v17, 7, v16
    s_waitcnt lgkmcnt(0)
    s_add_u32 s68, s36, s93
    s_addc_u32 s69, s37, 0
    s_mov_b32 s70, 18560
    s_mov_b32 s71, 0x20000
    s_barrier
W_59:
    s_sleep 2
    ds_read_b32 v8, v4 offset:36
    s_sub_u32 s39, s39, 1
    s_cbranch_scc1 KS_ABORT
    s_waitcnt lgkmcnt(0)
    v_cmp_eq_u32 vcc, 0, v8
    s_cbranch_vccnz W_59
    s_mov_b32 s92, 0
    buffer_store_dwordx4 v[12:15], v6, s[68:71], s92 offen sc1
    s_mov_b32 s92, 4096
    buffer_store_dwordx4 v[12:15], v6, s[68:71], s92 offen sc1
    s_mov_b32 s92, 8192
    buffer_store_dwordx4 v[12:15], v6, s[68:71], s92 offen sc1
    s_mov_b32 s92, 12288
    buffer_store_dwordx4 v[12:15], v6, s[68:71], s92 offen sc1
    s_mov_b32 s92, 16384
    buffer_store_dwordx4 v[12:15], v6, s[68:71], s92 offen sc1
    global_load_dword v58, v59, s[34:35] sc1
    s_waitcnt vmcnt(0)
DBP_60:
    v_cmp_eq_u32 vcc, 0, v58
    s_cbranch_vccz DBG_61
    s_sleep 1
    global_load_dword v58, v59, s[34:35] sc1
    s_sub_u32 s39, s39, 1
    s_cbranch_scc1 KS_ABORT
    s_waitcnt vmcnt(0)
    s_branch DBP_60
DBG_61:
    ds_write_b32 v59, v58 offset:224
    s_mov_b64 exec, 1
    ds_add_rtn_u32 v8, v4, v5 offset:8
    s_mov_b64 exec, -1
    v_lshrrev_b32 v57, 3, v58
    v_lshrrev_b32 v56, 6, v58
    v_lshrrev_b32 v55, 9, v58
    s_waitcnt lgkmcnt(0)
    v_readfirstlane_b32 s92, v8
    s_cmp_lg_u32 s92, 3
    s_cbranch_scc1 KS_L2
    s_mov_b64 exec, 15
    global_store_dword v7, v58, s[36:37] sc1
    s_mov_b64 exec, -1
    s_and_b32 s94, s41, 7
    s_cmp_ge_u32 s41, 8
    s_cbranch_scc1 KS_L1C
    s_branch KS_L2
KS_L1C:
    s_bitcmp1_b32 s94, 0
    s_cselect_b32 s72, s28, s26
    s_cselect_b32 s73, s29, s27
    s_mov_b32 s74, 0x510000
    s_mov_b32 s75, 0x20000
    s_lshr_b32 s95, s94, 1
    s_mul_i32 s95, s95, 64512
    s_mul_i32 s96, s40, 1152
    s_add_u32 s95, s95, s96
    s_add_u32 s96, s95, 3419136
    buffer_load_dword v18, v16, s[72:75], s96 offen nt
    buffer_load_dword v18, v16, s[72:75], s96 offen sc1
    s_add_u32 s96, s95, 3677184
    buffer_load_dword v18, v16, s[72:75], s96 offen nt
    buffer_load_dword v18, v16, s[72:75], s96 offen sc1
    s_add_u32 s96, s95, 3935232
    buffer_load_dword v18, v16, s[72:75], s96 offen nt
    buffer_load_dword v18, v16, s[72:75], s96 offen sc1
    s_add_u32 s96, s95, 4193280
    buffer_load_dword v18, v16, s[72:75], s96 offen nt
    buffer_load_dword v18, v16, s[72:75], s96 offen sc1
KS_L2:
    s_mov_b32 s87, 0
KS_L2B:
    s_mov_b32 s64, s36
    s_mov_b32 s65, s37
    s_mov_b32 s66, 0x240000
    s_mov_b32 s67, 0x20000
    v_lshrrev_b32 v7, 1, v1
    v_lshlrev_b32 v7, 6, v7
    v_and_b32 v10, 1, v1
    v_lshl_add_u32 v7, v10, 4, v7
    v_lshlrev_b32 v9, 4, v1
    s_lshl_b32 s92, s38, 11
    s_lshl_b32 s93, s90, 13
    s_add_u32 s93, s93, s92
    s_lshl_b32 s94, s90, 7
    s_and_b32 s95, s94, 0x380
    v_xor_b32 v13, s95, v9
    s_and_b32 s94, s94, 0x1c00
    s_xor_b32 s93, s93, s94
    s_xor_b32 s97, s93, 0x400
    s_lshl_b32 s95, s40, 3
    s_add_u32 s95, s95, s41
    s_add_u32 s95, s95, 488
    s_lshr_b32 s96, s95, 1
    s_lshl_b32 s96, s96, 13
    s_and_b32 s95, s95, 1
    s_lshl_b32 s95, s95, 5
    s_add_u32 s95, s95, s96
    s_add_u32 s95, s95, s92
    s_lshr_b32 s96, s96, 6
    s_and_b32 s94, s96, 0x780
    v_xor_b32 v7, s94, v7
    s_and_b32 s96, s96, 0x1800
    s_xor_b32 s95, s95, s96
    s_cmp_lt_u32 s41, 24
    s_cselect_b32 s95, 2359296, s95
    s_cselect_b32 s94, 0, 0x70007
    v_mov_b32_dpp v64, v58 quad_perm:[0,1,0,1] row_mask:0xf bank_mask:0xf
    v_mov_b32_dpp v65, v58 quad_perm:[2,3,2,3] row_mask:0xf bank_mask:0xf
    s_bitcmp1_b32 s41, 0
    s_cselect_b64 vcc, -1, 0
    v_cndmask_b32 v64, v64, v65, vcc
    v_and_b32 v60, 0x70007, v58
    v_and_b32 v61, 0x70007, v57
    v_and_b32 v62, 0x70007, v56
    v_and_b32 v63, 0x70007, v55
    v_lshrrev_b32 v67, 9, v64
    v_lshrrev_b32 v66, 6, v64
    v_lshrrev_b32 v65, 3, v64
    v_and_b32 v64, s94, v64
    v_and_b32 v65, s94, v65
    v_and_b32 v66, s94, v66
    v_and_b32 v67, s94, v67
    s_lshl_b32 s96, s38, 10
    s_add_u32 s96, s96, 3552
    v_bfe_u32 v11, v1, 1, 1
    v_mul_u32_u24 v11, 4672, v11
    v_lshl_add_u32 v11, v10, 4, v11
    v_lshrrev_b32 v10, 2, v1
    v_lshl_add_u32 v11, v10, 5, v11
    v_add_u32 v11, s96, v11
    v_add_u32 v10, s96, v9
    v_mov_b32 v116, s38
    s_add_u32 s92, s92, 0xb00000
    v_lshrrev_b32 v12, 2, v1
    v_lshl_add_u32 v12, v12, 6, v59
    v_add_u32 v12, s92, v12
    s_cmp_lt_u32 s41, 8
    s_cselect_b32 s94, 20, 4
    s_cmp_ge_u32 s41, 24
    s_cselect_b32 s94, 24, s94
    v_mov_b32 v14, s94
    s_setprio 0
    s_waitcnt vmcnt(0)
    ds_write_b8 v116, v5 offset:204
W_62:
    s_sleep 2
    ds_read_b32 v8, v14 offset:64
    s_sub_u32 s39, s39, 1
    s_cbranch_scc1 KS_ABORT
    s_waitcnt lgkmcnt(0)
    v_cmp_ne_u32 vcc, s84, v8
    s_cbranch_vccnz W_62
    s_setprio 3
    s_branch UPE_64
UP_63:
    s_sleep 2
UPE_64:
    global_load_dword v32, v12, s[36:37] sc1
    global_load_dword v33, v12, s[36:37] offset:1024 sc1
    buffer_load_dwordx4 v[20:23], v13, s[64:67], s93 offen sc1
    buffer_load_dwordx4 v[24:27], v13, s[64:67], s97 offen sc1
    buffer_load_dwordx4 v[28:31], v7, s[64:67], s95 offen sc1
    s_sub_u32 s39, s39, 1
    s_cbranch_scc1 KS_ABORT
    s_waitcnt vmcnt(2)
    v_xor_b32 v32, v58, v32
    v_xor_b32 v33, v58, v33
    v_xor_b32 v20, v60, v20
    v_xor_b32 v21, v61, v21
    v_xor_b32 v22, v62, v22
    v_xor_b32 v23, v63, v23
    v_or3_b32 v44, v20, v21, v21
    v_or3_b32 v44, v22, v23, v44
    s_waitcnt vmcnt(1)
    v_xor_b32 v24, v60, v24
    v_xor_b32 v25, v61, v25
    v_xor_b32 v26, v62, v26
    v_xor_b32 v27, v63, v27
    v_or3_b32 v44, v24, v25, v44
    v_or3_b32 v44, v26, v27, v44
    s_waitcnt vmcnt(0)
    v_xor_b32 v28, v64, v28
    v_xor_b32 v29, v65, v29
    v_xor_b32 v30, v66, v30
    v_xor_b32 v31, v67, v31
    v_or3_b32 v44, v28, v29, v44
    v_or3_b32 v44, v30, v31, v44
    v_and_b32 v44, 0x70007, v44
    v_or3_b32 v44, v44, v32, v33
    v_cmp_ne_u32 vcc, 0, v44
    s_cbranch_vccnz UP_63
    ds_write_b128 v11, v[20:23]
    ds_write_b128 v11, v[24:27] offset:512
    ds_write_b128 v10, v[28:31] offset:9344
    ds_write_b8 v116, v5 offset:16
    s_cmp_eq_u32 s38, 2
    s_cbranch_scc1 WJ2_67
    s_add_u32 s92, s38, 1
    s_lshr_b32 s92, s92, 2
    s_cmp_eq_u32 s38, 1
    s_cselect_b32 s92, 2, s92
    s_lshl_b32 s92, s92, 10
    v_lshl_add_u32 v10, v1, 4, s92
    v_add_u32 v11, 35840, v10
W_68:
    ds_read_b32 v12, v4 offset:16
    s_sub_u32 s39, s39, 1
    s_cbranch_scc1 KS_ABORT
    s_waitcnt lgkmcnt(0)
    v_cmp_ne_u32 vcc, s84, v12
    s_cbranch_vccnz W_68
    s_setprio 3
    ds_read_b128 v[20:23], v10 offset:3520
    ds_read_b128 v[24:27], v10 offset:3536
    ds_read_b64 v[28:29], v10 offset:3552
    ds_read_b128 v[32:35], v10 offset:8192
    ds_read_b128 v[36:39], v10 offset:8208
    ds_read_b64 v[40:41], v10 offset:8224
    ds_read_b128 v[44:47], v10 offset:12864
    ds_read_b128 v[48:51], v10 offset:12880
    ds_read_b64 v[52:53], v10 offset:12896
    s_cmp_eq_u32 s38, 1
    s_cbranch_scc1 WJ1_66
    ds_read_b32 v12, v4 offset:68
    s_waitcnt lgkmcnt(7)
    v_alignbit_b32 v57, v22, v21, 16
    v_alignbit_b32 v58, v23, v22, 16
    v_alignbit_b32 v59, v24, v23, 16
    v_alignbit_b32 v60, v25, v24, 16
    v_alignbit_b32 v61, v26, v25, 16
    v_alignbit_b32 v62, v27, v26, 16
    v_alignbit_b32 v63, v28, v27, 16
    v_alignbit_b32 v64, v29, v28, 16
    v_pk_add_f16 v66, v57, v22
    v_pk_add_f16 v67, v58, v23
    v_pk_add_f16 v68, v59, v24
    v_pk_add_f16 v69, v60, v25
    v_pk_add_f16 v70, v61, v26
    v_pk_add_f16 v71, v62, v27
    v_pk_add_f16 v72, v63, v28
    v_pk_add_f16 v73, v64, v29
    v_pk_add_f16 v80, v66, v58
    v_pk_add_f16 v81, v67, v59
    v_pk_add_f16 v82, v68, v60
    v_pk_add_f16 v83, v69, v61
    v_pk_add_f16 v74, v67, v68
    v_pk_add_f16 v75, v68, v69
    v_pk_add_f16 v76, v69, v70
    v_pk_add_f16 v77, v70, v71
    v_pk_add_f16 v78, v71, v72
    v_pk_add_f16 v79, v72, v73
    s_waitcnt lgkmcnt(0)
    v_cmp_eq_u32 vcc, s84, v12
    s_cbranch_vccnz WJK_69
W_70:
    s_sleep 1
    ds_read_b32 v12, v4 offset:68
    s_sub_u32 s39, s39, 1
    s_cbranch_scc1 KS_ABORT
    s_waitcnt lgkmcnt(0)
    v_cmp_ne_u32 vcc, s84, v12
    s_cbranch_vccnz W_70
WJK_69:
    ds_write_b128 v11, v[80:83] offset:0
    v_pk_add_f16 v87, v22, v74
    v_pk_add_f16 v88, v23, v75
    v_pk_add_f16 v89, v24, v76
    v_pk_add_f16 v90, v25, v77
    v_pk_add_f16 v91, v26, v78
    ds_write_b128 v11, v[88:91] offset:3104
    v_pk_add_f16 v84, v70, v62
    v_pk_add_f16 v85, v71, v63
    v_pk_add_f16 v86, v72, v64
    v_pk_add_f16 v92, v74, v83
    v_pk_add_f16 v93, v75, v84
    v_pk_add_f16 v94, v76, v85
    v_pk_add_f16 v95, v77, v86
    ds_write_b128 v11, v[92:95] offset:6176
    v_pk_add_f16 v96, v87, v76
    v_pk_add_f16 v97, v88, v77
    v_pk_add_f16 v98, v89, v78
    v_pk_add_f16 v99, v90, v79
    ds_write_b128 v11, v[96:99] offset:8240
    ds_write_b8 v116, v5 offset:76
    ds_read_b32 v12, v4 offset:84
    v_alignbit_b32 v57, v34, v33, 16
    v_alignbit_b32 v58, v35, v34, 16
    v_alignbit_b32 v59, v36, v35, 16
    v_alignbit_b32 v60, v37, v36, 16
    v_alignbit_b32 v61, v38, v37, 16
    v_alignbit_b32 v62, v39, v38, 16
    v_alignbit_b32 v63, v40, v39, 16
    v_alignbit_b32 v64, v41, v40, 16
    v_pk_add_f16 v66, v57, v34
    v_pk_add_f16 v67, v58, v35
    v_pk_add_f16 v68, v59, v36
    v_pk_add_f16 v69, v60, v37
    v_pk_add_f16 v70, v61, v38
    v_pk_add_f16 v71, v62, v39
    v_pk_add_f16 v72, v63, v40
    v_pk_add_f16 v73, v64, v41
    v_pk_add_f16 v80, v66, v58
    v_pk_add_f16 v81, v67, v59
    v_pk_add_f16 v82, v68, v60
    v_pk_add_f16 v83, v69, v61
    v_pk_add_f16 v74, v67, v68
    v_pk_add_f16 v75, v68, v69
    v_pk_add_f16 v76, v69, v70
    v_pk_add_f16 v77, v70, v71
    v_pk_add_f16 v78, v71, v72
    v_pk_add_f16 v79, v72, v73
    s_waitcnt lgkmcnt(0)
    v_cmp_eq_u32 vcc, s84, v12
    s_cbranch_vccnz WJK_71
W_72:
    s_sleep 1
    ds_read_b32 v12, v4 offset:84
    s_sub_u32 s39, s39, 1
    s_cbranch_scc1 KS_ABORT
    s_waitcnt lgkmcnt(0)
    v_cmp_ne_u32 vcc, s84, v12
    s_cbranch_vccnz W_72
WJK_71:
    ds_write_b128 v11, v[80:83] offset:36672
    v_pk_add_f16 v87, v34, v74
    v_pk_add_f16 v88, v35, v75
    v_pk_add_f16 v89, v36, v76
    v_pk_add_f16 v90, v37, v77
    v_pk_add_f16 v91, v38, v78
    ds_write_b128 v11, v[88:91] offset:39776
    v_pk_add_f16 v84, v70, v62
    v_pk_add_f16 v85, v71, v63
    v_pk_add_f16 v86, v72, v64
    v_pk_add_f16 v92, v74, v83
    v_pk_add_f16 v93, v75, v84
    v_pk_add_f16 v94, v76, v85
    v_pk_add_f16 v95, v77, v86
    ds_write_b128 v11, v[92:95] offset:42848
    v_pk_add_f16 v96, v87, v76
    v_pk_add_f16 v97, v88, v77
    v_pk_add_f16 v98, v89, v78
    v_pk_add_f16 v99, v90, v79
    ds_write_b128 v11, v[96:99] offset:44912
    ds_write_b8 v116, v5 offset:92
    s_cmp_lt_u32 s41, 24
    s_cbranch_scc1 WJE_65
    ds_read_b32 v12, v4 offset:100
    v_alignbit_b32 v57, v46, v45, 16
    v_alignbit_b32 v58, v47, v46, 16
    v_alignbit_b32 v59, v48, v47, 16
    v_alignbit_b32 v60, v49, v48, 16
    v_alignbit_b32 v61, v50, v49, 16
    v_alignbit_b32 v62, v51, v50, 16
    v_alignbit_b32 v63, v52, v51, 16
    v_alignbit_b32 v64, v53, v52, 16
    v_pk_add_f16 v66, v57, v46
    v_pk_add_f16 v67, v58, v47
    v_pk_add_f16 v68, v59, v48
    v_pk_add_f16 v69, v60, v49
    v_pk_add_f16 v70, v61, v50
    v_pk_add_f16 v71, v62, v51
    v_pk_add_f16 v72, v63, v52
    v_pk_add_f16 v73, v64, v53
    v_pk_add_f16 v80, v66, v58
    v_pk_add_f16 v81, v67, v59
    v_pk_add_f16 v82, v68, v60
    v_pk_add_f16 v83, v69, v61
    v_pk_add_f16 v74, v67, v68
    v_pk_add_f16 v75, v68, v69
    v_pk_add_f16 v76, v69, v70
    v_pk_add_f16 v77, v70, v71
    v_pk_add_f16 v78, v71, v72
    v_pk_add_f16 v79, v72, v73
    s_waitcnt lgkmcnt(0)
    v_cmp_eq_u32 vcc, s84, v12
    s_cbranch_vccnz WJK_73
W_74:
    s_sleep 1
    ds_read_b32 v12, v4 offset:100
    s_sub_u32 s39, s39, 1
    s_cbranch_scc1 KS_ABORT
    s_waitcnt lgkmcnt(0)
    v_cmp_ne_u32 vcc, s84, v12
    s_cbranch_vccnz W_74
WJK_73:
    v_add_u32 v11, 73344, v11
    ds_write_b128 v11, v[80:83] offset:0
    v_pk_add_f16 v87, v46, v74
    v_pk_add_f16 v88, v47, v75
    v_pk_add_f16 v89, v48, v76
    v_pk_add_f16 v90, v49, v77
    v_pk_add_f16 v91, v50, v78
    ds_write_b128 v11, v[88:91] offset:3104
    v_pk_add_f16 v84, v70, v62
    v_pk_add_f16 v85, v71, v63
    v_pk_add_f16 v86, v72, v64
    v_pk_add_f16 v92, v74, v83
    v_pk_add_f16 v93, v75, v84
    v_pk_add_f16 v94, v76, v85
    v_pk_add_f16 v95, v77, v86
    ds_write_b128 v11, v[92:95] offset:6176
    v_pk_add_f16 v96, v87, v76
    v_pk_add_f16 v97, v88, v77
    v_pk_add_f16 v98, v89, v78
    v_pk_add_f16 v99, v90, v79
    ds_write_b128 v11, v[96:99] offset:8240
    ds_write_b8 v116, v5 offset:108
    s_branch WJE_65
WJ1_66:
    ds_read_b32 v12, v4 offset:68
    s_waitcnt lgkmcnt(7)
    v_alignbit_b32 v57, v22, v21, 16
    v_alignbit_b32 v58, v23, v22, 16
    v_alignbit_b32 v59, v24, v23, 16
    v_alignbit_b32 v60, v25, v24, 16
    v_alignbit_b32 v61, v26, v25, 16
    v_alignbit_b32 v62, v27, v26, 16
    v_alignbit_b32 v63, v28, v27, 16
    v_pk_add_f16 v66, v57, v22
    v_pk_add_f16 v67, v58, v23
    v_pk_add_f16 v68, v59, v24
    v_pk_add_f16 v69, v60, v25
    v_pk_add_f16 v70, v61, v26
    v_pk_add_f16 v71, v62, v27
    v_pk_add_f16 v72, v63, v28
    v_pk_add_f16 v80, v66, v58
    v_pk_add_f16 v81, v67, v59
    v_pk_add_f16 v82, v68, v60
    v_pk_add_f16 v83, v69, v61
    v_pk_add_f16 v75, v68, v69
    v_pk_add_f16 v76, v69, v70
    v_pk_add_f16 v77, v70, v71
    v_pk_add_f16 v78, v71, v72
    s_waitcnt lgkmcnt(0)
    v_cmp_eq_u32 vcc, s84, v12
    s_cbranch_vccnz WJK_75
W_76:
    s_sleep 1
    ds_read_b32 v12, v4 offset:68
    s_sub_u32 s39, s39, 1
    s_cbranch_scc1 KS_ABORT
    s_waitcnt lgkmcnt(0)
    v_cmp_ne_u32 vcc, s84, v12
    s_cbranch_vccnz W_76
WJK_75:
    ds_write_b128 v11, v[80:83] offset:0
    v_pk_add_f16 v88, v23, v75
    v_pk_add_f16 v89, v24, v76
    v_pk_add_f16 v90, v25, v77
    v_pk_add_f16 v91, v26, v78
    ds_write_b128 v11, v[88:91] offset:3104
    ds_write_b8 v116, v5 offset:76
    ds_read_b32 v12, v4 offset:84
    v_alignbit_b32 v57, v34, v33, 16
    v_alignbit_b32 v58, v35, v34, 16
    v_alignbit_b32 v59, v36, v35, 16
    v_alignbit_b32 v60, v37, v36, 16
    v_alignbit_b32 v61, v38, v37, 16
    v_alignbit_b32 v62, v39, v38, 16
    v_alignbit_b32 v63, v40, v39, 16
    v_pk_add_f16 v66, v57, v34
    v_pk_add_f16 v67, v58, v35
    v_pk_add_f16 v68, v59, v36
    v_pk_add_f16 v69, v60, v37
    v_pk_add_f16 v70, v61, v38
    v_pk_add_f16 v71, v62, v39
    v_pk_add_f16 v72, v63, v40
    v_pk_add_f16 v80, v66, v58
    v_pk_add_f16 v81, v67, v59
    v_pk_add_f16 v82, v68, v60
    v_pk_add_f16 v83, v69, v61
    v_pk_add_f16 v75, v68, v69
    v_pk_add_f16 v76, v69, v70
    v_pk_add_f16 v77, v70, v71
    v_pk_add_f16 v78, v71, v72
    s_waitcnt lgkmcnt(0)
    v_cmp_eq_u32 vcc, s84, v12
    s_cbranch_vccnz WJK_77
W_78:
    s_sleep 1
    ds_read_b32 v12, v4 offset:84
    s_sub_u32 s39, s39, 1
    s_cbranch_scc1 KS_ABORT
    s_waitcnt lgkmcnt(0)
    v_cmp_ne_u32 vcc, s84, v12
    s_cbranch_vccnz W_78
WJK_77:
    ds_write_b128 v11, v[80:83] offset:36672
    v_pk_add_f16 v88, v35, v75
    v_pk_add_f16 v89, v36, v76
    v_pk_add_f16 v90, v37, v77
    v_pk_add_f16 v91, v38, v78
    ds_write_b128 v11, v[88:91] offset:39776
    ds_write_b8 v116, v5 offset:92
    s_cmp_lt_u32 s41, 24
    s_cbranch_scc1 WJE_65
    ds_read_b32 v12, v4 offset:100
    v_alignbit_b32 v57, v46, v45, 16
    v_alignbit_b32 v58, v47, v46, 16
    v_alignbit_b32 v59, v48, v47, 16
    v_alignbit_b32 v60, v49, v48, 16
    v_alignbit_b32 v61, v50, v49, 16
    v_alignbit_b32 v62, v51, v50, 16
    v_alignbit_b32 v63, v52, v51, 16
    v_pk_add_f16 v66, v57, v46
    v_pk_add_f16 v67, v58, v47
    v_pk_add_f16 v68, v59, v48
    v_pk_add_f16 v69, v60, v49
    v_pk_add_f16 v70, v61, v50
    v_pk_add_f16 v71, v62, v51
    v_pk_add_f16 v72, v63, v52
    v_pk_add_f16 v80, v66, v58
    v_pk_add_f16 v81, v67, v59
    v_pk_add_f16 v82, v68, v60
    v_pk_add_f16 v83, v69, v61
    v_pk_add_f16 v75, v68, v69
    v_pk_add_f16 v76, v69, v70
    v_pk_add_f16 v77, v70, v71
    v_pk_add_f16 v78, v71, v72
    s_waitcnt lgkmcnt(0)
    v_cmp_eq_u32 vcc, s84, v12
    s_cbranch_vccnz WJK_79
W_80:
    s_sleep 1
    ds_read_b32 v12, v4 offset:100
    s_sub_u32 s39, s39, 1
    s_cbranch_scc1 KS_ABORT
    s_waitcnt lgkmcnt(0)
    v_cmp_ne_u32 vcc, s84, v12
    s_cbranch_vccnz W_80
WJK_79:
    v_add_u32 v11, 73344, v11
    ds_write_b128 v11, v[80:83] offset:0
    v_pk_add_f16 v88, v47, v75
    v_pk_add_f16 v89, v48, v76
    v_pk_add_f16 v90, v49, v77
    v_pk_add_f16 v91, v50, v78
    ds_write_b128 v11, v[88:91] offset:3104
    ds_write_b8 v116, v5 offset:108
    s_branch WJE_65
WJ2_67:
    ds_write_b8 v116, v5 offset:76
    ds_write_b8 v116, v5 offset:92
    ds_write_b8 v116, v5 offset:108
    s_sub_u32 s94, s41, 18
    s_and_b32 s94, s94, 31
    s_cmp_ge_u32 s94, 14
    s_cbranch_scc1 WJE_65
    v_mul_u32_u24 v100, 57, v1
    v_lshrrev_b32 v100, 9, v100
    v_mul_u32_u24 v101, 9, v100
    v_sub_u32 v101, v1, v101
    v_mul_u32_u24 v100, 9216, v100
    v_lshl_add_u32 v100, v101, 7, v100
W_81:
    s_sleep 1
    ds_read_b32 v12, v4 offset:16
    s_sub_u32 s39, s39, 1
    s_cbranch_scc1 KS_ABORT
    s_waitcnt lgkmcnt(0)
    v_cmp_ne_u32 vcc, s84, v12
    s_cbranch_vccnz W_81
    s_bitcmp1_b32 s94, 0
    s_cselect_b32 s72, s28, s26
    s_cselect_b32 s73, s29, s27
    s_mov_b32 s74, 0x510000
    s_mov_b32 s75, 0x20000
    s_lshr_b32 s95, s94, 1
    s_mul_i32 s95, s95, 64512
    s_mul_i32 s96, s40, 1152
    s_add_u32 s95, s95, s96
    s_add_u32 s96, s95, 4451328
    buffer_load_dword v102, v100, s[72:75], s96 offen nt
    buffer_load_dword v102, v100, s[72:75], s96 offen sc1
    s_add_u32 s96, s95, 4902912
    buffer_load_dword v102, v100, s[72:75], s96 offen nt
    buffer_load_dword v102, v100, s[72:75], s96 offen sc1
KS_PF2D:
WJE_65:
    s_setprio 0
    s_lshr_b32 s92, s90, 6
    s_lshl_b32 s92, s92, 9
    s_bfe_u32 s93, s90, 0x20004
    s_lshl_b32 s93, s93, 6
    s_add_u32 s92, s92, s93
    s_and_b32 s93, s90, 3
    s_lshl_b32 s93, s93, 4
    s_add_u32 s92, s92, s93
    s_and_b32 s93, s90, 12
    s_add_u32 s92, s92, s93
    s_lshr_b32 s93, s38, 1
    s_lshl_b32 s93, s93, 8
    s_add_u32 s92, s92, s93
    s_and_b32 s93, s38, 1
    s_lshl_b32 s93, s93, 1
    s_add_u32 s92, s92, s93
    v_lshrrev_b32 v113, 5, v1
    v_and_b32 v114, 31, v1
    v_add_u32 v112, s92, v113
    v_mul_u32_u24 v115, 1152, v112
    v_lshl_add_u32 v8, v114, 2, v115
    v_lshl_add_u32 v115, v114, 4, v115
    v_lshlrev_b32 v7, 2, v114
    v_lshlrev_b32 v6, 4, v114
    v_bfe_u32 v111, v1, 3, 1
    v_add_u32 v111, s92, v111
    v_mul_u32_u24 v111, 1152, v111
    v_and_b32 v9, 7, v1
    v_lshl_add_u32 v111, v9, 4, v111
    s_mov_b32 s64, s4
    s_mov_b32 s65, s5
    s_mov_b32 s66, 0x240000
    s_mov_b32 s67, 0x20000
    s_mov_b32 s68, s24
    s_mov_b32 s69, s25
    s_mov_b32 s70, 0x480
    s_mov_b32 s71, 0x20000
    buffer_load_dwordx4 v[10:13], v115, s[64:67], 0 offen
    buffer_load_dwordx4 v[14:17], v115, s[64:67], 0 offen offset:512
    buffer_load_dword v18, v8, s[64:67], 0 offen offset:1024
    buffer_load_dwordx4 v[50:53], v6, s[68:71], 0 offen
    buffer_load_dwordx4 v[54:57], v6, s[68:71], 0 offen offset:512
    buffer_load_dword v58, v7, s[68:71], 0 offen offset:1024
KS_L4:
    s_add_u32 s64, s36, 0x600000
    s_addc_u32 s65, s37, 0
    s_mov_b32 s66, 0x240000
    s_mov_b32 s67, 0x20000
    s_mov_b32 s68, s32
    s_mov_b32 s69, s33
    s_mov_b32 s70, 0x240000
    s_mov_b32 s71, 0x20000
    s_mov_b32 s72, s36
    s_mov_b32 s73, s37
    s_mov_b32 s74, 0x240000
    s_mov_b32 s75, 0x20000
    s_add_u32 s76, s36, 0x840000
    s_addc_u32 s77, s37, 0
    s_mov_b32 s78, 0x3000
    s_mov_b32 s79, 0x20000
    s_not_b32 s93, s90
    v_xor_b32 v8, s93, v0
    v_lshrrev_b32 v6, 1, v0
    v_lshlrev_b32 v6, 6, v6
    v_and_b32 v8, 1, v8
    v_lshl_add_u32 v6, v8, 4, v6
    s_lshr_b32 s92, s90, 2
    s_lshl_b32 s92, s92, 15
    s_and_b32 s93, s90, 1
    s_lshl_b32 s93, s93, 14
    s_add_u32 s92, s92, s93
    s_and_b32 s93, s90, 2
    s_lshl_b32 s93, s93, 4
    s_add_u32 s92, s92, s93
    s_lshr_b32 s94, s90, 2
    s_lshl_b32 s94, s94, 12
    s_and_b32 s93, s90, 3
    s_lshl_b32 s93, s93, 4
    s_add_u32 s94, s94, s93
    s_lshl_b32 s93, s38, 10
    s_add_u32 s94, s94, s93
    s_add_u32 s94, s94, 0x200000
    v_lshlrev_b32 v9, 6, v2
    s_lshl_b32 s93, s90, 5
    s_and_b32 s95, s93, 0x1f80
    v_xor_b32 v6, s95, v6
    s_and_b32 s95, s93, 0x380
    v_xor_b32 v9, s95, v9
    s_and_b32 s95, s93, 0xc00
    s_xor_b32 s94, s94, s95
    s_and_b32 s93, s90, 1
    s_lshl_b32 s93, s93, 13
    s_xor_b32 s92, s92, s93
    s_xor_b32 s93, s92, 0x2000
    s_mul_i32 s95, s38, 2304
    s_add_u32 s95, s95, 17088
    v_lshl_add_u32 v117, v114, 5, s95
    v_lshl_add_u32 v110, v114, 3, s95
    s_lshl_b32 s95, s38, 9
    s_add_u32 s95, s95, 35840
    v_lshl_add_u32 v108, v1, 2, s95
    v_lshl_add_u32 v109, v1, 4, s95
    s_mov_b32 s95, 0x02020000
    v_mul_lo_u32 v118, v113, s95
    v_add_u32 v118, 0x01000c0c, v118
    v_lshlrev_b32 v8, 2, v0
    v_add_u32 v8, 17088, v8
    s_lshl_b32 s95, s38, 6
    s_add_u32 s95, s95, 19136
    v_lshl_add_u32 v119, v2, 2, s95
    s_waitcnt vmcnt(0)
    v_lshlrev_b32 v20, 16, v10
    v_and_b32 v21, 0xffff0000, v10
    v_lshlrev_b32 v22, 16, v11
    v_and_b32 v23, 0xffff0000, v11
    v_lshlrev_b32 v24, 16, v12
    v_and_b32 v25, 0xffff0000, v12
    v_lshlrev_b32 v26, 16, v13
    v_and_b32 v27, 0xffff0000, v13
    v_lshlrev_b32 v28, 16, v14
    v_and_b32 v29, 0xffff0000, v14
    v_lshlrev_b32 v30, 16, v15
    v_and_b32 v31, 0xffff0000, v15
    v_lshlrev_b32 v32, 16, v16
    v_and_b32 v33, 0xffff0000, v16
    v_lshlrev_b32 v34, 16, v17
    v_and_b32 v35, 0xffff0000, v17
    v_lshlrev_b32 v36, 16, v18
    v_and_b32 v37, 0xffff0000, v18
    v_lshlrev_b32 v80, 16, v50
    v_and_b32 v81, 0xffff0000, v50
    v_lshlrev_b32 v82, 16, v51
    v_and_b32 v83, 0xffff0000, v51
    v_lshlrev_b32 v84, 16, v52
    v_and_b32 v85, 0xffff0000, v52
    v_lshlrev_b32 v86, 16, v53
    v_and_b32 v87, 0xffff0000, v53
    v_lshlrev_b32 v88, 16, v54
    v_and_b32 v89, 0xffff0000, v54
    v_lshlrev_b32 v90, 16, v55
    v_and_b32 v91, 0xffff0000, v55
    v_lshlrev_b32 v92, 16, v56
    v_and_b32 v93, 0xffff0000, v56
    v_lshlrev_b32 v94, 16, v57
    v_and_b32 v95, 0xffff0000, v57
    v_lshlrev_b32 v96, 16, v58
    v_and_b32 v97, 0xffff0000, v58
    v_pk_add_f32 v[78:79], v[80:81], v[82:83]
    v_pk_add_f32 v[78:79], v[78:79], v[84:85]
    v_pk_add_f32 v[78:79], v[78:79], v[86:87]
    v_pk_add_f32 v[78:79], v[78:79], v[88:89]
    v_pk_add_f32 v[78:79], v[78:79], v[90:91]
    v_pk_add_f32 v[78:79], v[78:79], v[92:93]
    v_pk_add_f32 v[78:79], v[78:79], v[94:95]
    v_pk_add_f32 v[78:79], v[78:79], v[96:97]
    v_add_f32 v78, v78, v79
    s_nop 1
    v_add_f32_dpp v78, v78, v78 row_ror:8 row_mask:0xf bank_mask:0xf
    s_nop 1
    v_add_f32_dpp v78, v78, v78 row_ror:4 row_mask:0xf bank_mask:0xf
    s_nop 1
    v_add_f32_dpp v78, v78, v78 row_ror:2 row_mask:0xf bank_mask:0xf
    s_nop 1
    v_add_f32_dpp v78, v78, v78 row_ror:1 row_mask:0xf bank_mask:0xf
    v_mov_b32 v79, v78
    s_nop 1
    v_permlane16_swap_b32 v78, v79
    v_add_f32 v78, v78, v79
    v_sub_u32 v98, 0x87ff, v112
    v_lshl_add_u32 v99, v116, 1, v113
    v_lshlrev_b32 v99, 2, v99
    s_lshl_b32 s97, s90, 5
W_82:
    s_sleep 1
    ds_read_b32 v60, v4 offset:52
    s_sub_u32 s39, s39, 1
    s_cbranch_scc1 KS_ABORT
    s_waitcnt lgkmcnt(0)
    v_cmp_ne_u32 vcc, s84, v60
    s_cbranch_vccnz W_82
    s_setprio 3
    s_branch ZPE_84
ZP_83:
    s_sleep 1
ZPE_84:
    buffer_load_dwordx4 v[68:71], v4, s[64:67], s94 offen sc1
    s_sub_u32 s39, s39, 1
    s_cbranch_scc1 KS_ABORT
    s_waitcnt vmcnt(0)
    v_max3_u32 v44, v68, v69, v70
    v_max_u32 v44, v44, v71
    v_cmp_eq_u32 vcc, -1, v44
    s_cbranch_vccnz ZP_83
    s_branch ZPE_86
ZP_85:
    s_sleep 1
ZPE_86:
    buffer_load_dwordx4 v[60:63], v6, s[64:67], s92 offen sc1
    buffer_load_dwordx4 v[64:67], v6, s[64:67], s93 offen sc1
    buffer_load_dwordx4 v[68:71], v9, s[64:67], s94 offen sc1
    s_sub_u32 s39, s39, 1
    s_cbranch_scc1 KS_ABORT
    s_waitcnt vmcnt(2)
    ds_write2st64_b32 v8, v60, v61 offset0:0 offset1:9
    ds_write2st64_b32 v8, v62, v63 offset0:18 offset1:27
    v_max3_u32 v44, v60, v61, v61
    v_max3_u32 v44, v62, v63, v44
    s_waitcnt vmcnt(1)
    ds_write2st64_b32 v8, v64, v65 offset0:4 offset1:13
    ds_write2st64_b32 v8, v66, v67 offset0:22 offset1:31
    v_max3_u32 v44, v64, v65, v44
    v_max3_u32 v44, v66, v67, v44
    s_waitcnt vmcnt(0)
    ds_write2st64_b32 v119, v68, v69 offset0:0 offset1:9
    ds_write2st64_b32 v119, v70, v71 offset0:18 offset1:27
    v_max3_u32 v44, v68, v69, v44
    v_max3_u32 v44, v70, v71, v44
    v_cmp_eq_u32 vcc, -1, v44
    s_cbranch_vccnz ZP_85
    ds_write_b8 v116, v5 offset:20
ZW_87:
    ds_read_b32 v44, v4 offset:20
    ds_read_b128 v[60:63], v117 offset:0
    ds_read_b128 v[64:67], v117 offset:16
    ds_read_b128 v[68:71], v117 offset:1024
    ds_read_b128 v[72:75], v117 offset:1040
    ds_read_b64 v[76:77], v110 offset:2048
    s_sub_u32 s39, s39, 1
    s_cbranch_scc1 KS_ABORT
    s_waitcnt lgkmcnt(5)
    v_cmp_ne_u32 vcc, s84, v44
    s_cbranch_vccnz ZW_87
    s_waitcnt lgkmcnt(4)
    v_perm_b32 v60, v60, v60, v118
    v_perm_b32 v61, v61, v61, v118
    v_pk_add_f32 v[20:21], v[60:61], v[20:21]
    v_pk_mul_f32 v[42:43], v[20:21], v[20:21]
    v_pk_mul_f32 v[44:45], v[20:21], v[80:81]
    v_perm_b32 v62, v62, v62, v118
    v_perm_b32 v63, v63, v63, v118
    v_pk_add_f32 v[22:23], v[62:63], v[22:23]
    v_pk_fma_f32 v[42:43], v[22:23], v[22:23], v[42:43]
    v_pk_fma_f32 v[44:45], v[22:23], v[82:83], v[44:45]
    v_pk_add_f32 v[40:41], v[22:23], v[20:21]
    s_waitcnt lgkmcnt(3)
    v_perm_b32 v64, v64, v64, v118
    v_perm_b32 v65, v65, v65, v118
    v_pk_add_f32 v[24:25], v[64:65], v[24:25]
    v_pk_fma_f32 v[42:43], v[24:25], v[24:25], v[42:43]
    v_pk_fma_f32 v[44:45], v[24:25], v[84:85], v[44:45]
    v_pk_add_f32 v[40:41], v[24:25], v[40:41]
    v_perm_b32 v66, v66, v66, v118
    v_perm_b32 v67, v67, v67, v118
    v_pk_add_f32 v[26:27], v[66:67], v[26:27]
    v_pk_fma_f32 v[42:43], v[26:27], v[26:27], v[42:43]
    v_pk_fma_f32 v[44:45], v[26:27], v[86:87], v[44:45]
    v_pk_add_f32 v[40:41], v[26:27], v[40:41]
    s_waitcnt lgkmcnt(2)
    v_perm_b32 v68, v68, v68, v118
    v_perm_b32 v69, v69, v69, v118
    v_pk_add_f32 v[28:29], v[68:69], v[28:29]
    v_pk_fma_f32 v[42:43], v[28:29], v[28:29], v[42:43]
    v_pk_fma_f32 v[44:45], v[28:29], v[88:89], v[44:45]
    v_pk_add_f32 v[40:41], v[28:29], v[40:41]
    v_perm_b32 v70, v70, v70, v118
    v_perm_b32 v71, v71, v71, v118
    v_pk_add_f32 v[30:31], v[70:71], v[30:31]
    v_pk_fma_f32 v[42:43], v[30:31], v[30:31], v[42:43]
    v_pk_fma_f32 v[44:45], v[30:31], v[90:91], v[44:45]
    v_pk_add_f32 v[40:41], v[30:31], v[40:41]
    s_waitcnt lgkmcnt(1)
    v_perm_b32 v72, v72, v72, v118
    v_perm_b32 v73, v73, v73, v118
    v_pk_add_f32 v[32:33], v[72:73], v[32:33]
    v_pk_fma_f32 v[42:43], v[32:33], v[32:33], v[42:43]
    v_pk_fma_f32 v[44:45], v[32:33], v[92:93], v[44:45]
    v_pk_add_f32 v[40:41], v[32:33], v[40:41]
    v_perm_b32 v74, v74, v74, v118
    v_perm_b32 v75, v75, v75, v118
    v_pk_add_f32 v[34:35], v[74:75], v[34:35]
    v_pk_fma_f32 v[42:43], v[34:35], v[34:35], v[42:43]
    v_pk_fma_f32 v[44:45], v[34:35], v[94:95], v[44:45]
    v_pk_add_f32 v[40:41], v[34:35], v[40:41]
    s_waitcnt lgkmcnt(0)
    v_perm_b32 v76, v76, v76, v118
    v_perm_b32 v77, v77, v77, v118
    v_pk_add_f32 v[36:37], v[76:77], v[36:37]
    v_pk_fma_f32 v[42:43], v[36:37], v[36:37], v[42:43]
    v_pk_fma_f32 v[44:45], v[36:37], v[96:97], v[44:45]
    v_pk_add_f32 v[40:41], v[36:37], v[40:41]
    v_add_f32 v42, v42, v43
    v_add_f32 v44, v44, v45
    v_add_f32 v40, v40, v41
    v_mov_b32 v41, v40
    v_permlane16_swap_b32 v42, v44
    s_nop 0
    v_permlane16_swap_b32 v40, v41
    v_add_f32 v42, v42, v44
    v_add_f32 v40, v40, v41
    s_nop 0
    v_add_f32_dpp v42, v42, v42 row_ror:8 row_mask:0xf bank_mask:0xf
    v_add_f32_dpp v40, v40, v40 row_ror:8 row_mask:0xf bank_mask:0xf
    s_nop 0
    v_add_f32_dpp v42, v42, v42 row_ror:4 row_mask:0xf bank_mask:0xf
    v_add_f32_dpp v40, v40, v40 row_ror:4 row_mask:0xf bank_mask:0xf
    s_nop 0
    v_add_f32_dpp v42, v42, v42 row_ror:2 row_mask:0xf bank_mask:0xf
    v_add_f32_dpp v40, v40, v40 row_ror:2 row_mask:0xf bank_mask:0xf
    s_nop 0
    v_add_f32_dpp v42, v42, v42 row_ror:1 row_mask:0xf bank_mask:0xf
    v_add_f32_dpp v40, v40, v40 row_ror:1 row_mask:0xf bank_mask:0xf
    v_mul_f32 v40, 0x3ae38e39, v40
    v_mov_b32 v44, v42
    v_cvt_pk_bf16_f32 v41, 0, v40
    v_mul_f32 v40, v40, v40
    v_permlane16_swap_b32 v42, v44
    v_mov_b32 v43, 0x3ae38e39
    v_fma_f32 v42, v42, v43, -v40
    v_fma_f32 v44, -v41, v78, v44
    v_max_f32 v42, 0, v42
    v_cvt_pk_bf16_f32 v42, 0, v42
    v_add_f32 v42, 0x3727c5ac, v42
    v_cvt_pk_bf16_f32 v42, 0, v42
    v_sqrt_f32 v42, v42
    s_nop 0
    v_cvt_pk_bf16_f32 v42, 0, v42
    v_rcp_f32 v42, v42
    s_nop 0
    v_mul_f32 v60, v44, v42
    v_cvt_pk_bf16_f32 v60, v60, v60
    v_ashrrev_i32 v61, 31, v60
    v_or_b32 v61, 0x80000000, v61
    s_mov_b32 s95, 0xffff0000
    v_xor_b32 v60, v60, v61
    v_and_or_b32 v60, v60, s95, v98
    v_mov_b32 v61, v60
    s_nop 1
    v_permlane32_swap_b32 v60, v61
    s_mov_b64 exec, 1
    buffer_store_dwordx2 v[60:61], v99, s[76:79], s97 offen sc1
    ds_write_b8 v116, v5 offset:12
    s_mov_b64 exec, -1
    s_setprio 2
    v_cvt_pk_bf16_f32 v20, 0, v20
    v_cvt_pk_bf16_f32 v21, 0, v21
    v_cvt_pk_bf16_f32 v22, 0, v22
    v_cvt_pk_bf16_f32 v23, 0, v23
    v_cvt_pk_bf16_f32 v24, 0, v24
    v_cvt_pk_bf16_f32 v25, 0, v25
    v_cvt_pk_bf16_f32 v26, 0, v26
    v_cvt_pk_bf16_f32 v27, 0, v27
    v_cvt_pk_bf16_f32 v28, 0, v28
    v_cvt_pk_bf16_f32 v29, 0, v29
    v_cvt_pk_bf16_f32 v30, 0, v30
    v_cvt_pk_bf16_f32 v31, 0, v31
    v_cvt_pk_bf16_f32 v32, 0, v32
    v_cvt_pk_bf16_f32 v33, 0, v33
    v_cvt_pk_bf16_f32 v34, 0, v34
    v_cvt_pk_bf16_f32 v35, 0, v35
    v_cvt_pk_bf16_f32 v36, 0, v36
    v_cvt_pk_bf16_f32 v37, 0, v37
    v_pk_add_f32 v[44:45], v[20:21], v[22:23]
    v_pk_add_f32 v[46:47], v[24:25], v[26:27]
    v_pk_add_f32 v[44:45], v[44:45], v[28:29]
    v_pk_add_f32 v[46:47], v[46:47], v[30:31]
    v_pk_add_f32 v[44:45], v[44:45], v[32:33]
    v_pk_add_f32 v[46:47], v[46:47], v[34:35]
    v_pk_add_f32 v[44:45], v[44:45], v[36:37]
    v_pk_add_f32 v[44:45], v[44:45], v[46:47]
    v_add_f32 v44, v44, v45
    s_nop 1
    v_add_f32_dpp v44, v44, v44 row_ror:8 row_mask:0xf bank_mask:0xf
    s_nop 1
    v_add_f32_dpp v44, v44, v44 row_ror:4 row_mask:0xf bank_mask:0xf
    s_nop 1
    v_add_f32_dpp v44, v44, v44 row_ror:2 row_mask:0xf bank_mask:0xf
    s_nop 1
    v_add_f32_dpp v44, v44, v44 row_ror:1 row_mask:0xf bank_mask:0xf
    v_mov_b32 v46, v44
    s_nop 1
    v_permlane16_swap_b32 v44, v46
    v_add_f32 v44, v44, v46
    v_mul_f32 v48, 0x3ae38e39, v44
    v_mov_b32 v49, v48
    v_cvt_pk_bf16_f32 v40, 0, v48
    v_cvt_pk_bf16_f32 v41, 0, v48
    v_pk_add_f32 v[42:43], v[20:21], v[48:49] neg_lo:[0,1] neg_hi:[0,1]
    v_pk_mul_f32 v[44:45], v[42:43], v[42:43]
    v_pk_add_f32 v[42:43], v[22:23], v[48:49] neg_lo:[0,1] neg_hi:[0,1]
    v_pk_mul_f32 v[46:47], v[42:43], v[42:43]
    v_pk_add_f32 v[42:43], v[24:25], v[48:49] neg_lo:[0,1] neg_hi:[0,1]
    v_pk_fma_f32 v[44:45], v[42:43], v[42:43], v[44:45]
    v_pk_add_f32 v[42:43], v[26:27], v[48:49] neg_lo:[0,1] neg_hi:[0,1]
    v_pk_fma_f32 v[46:47], v[42:43], v[42:43], v[46:47]
    v_pk_add_f32 v[42:43], v[28:29], v[48:49] neg_lo:[0,1] neg_hi:[0,1]
    v_pk_fma_f32 v[44:45], v[42:43], v[42:43], v[44:45]
    v_pk_add_f32 v[42:43], v[30:31], v[48:49] neg_lo:[0,1] neg_hi:[0,1]
    v_pk_fma_f32 v[46:47], v[42:43], v[42:43], v[46:47]
    v_pk_add_f32 v[42:43], v[32:33], v[48:49] neg_lo:[0,1] neg_hi:[0,1]
    v_pk_fma_f32 v[44:45], v[42:43], v[42:43], v[44:45]
    v_pk_add_f32 v[42:43], v[34:35], v[48:49] neg_lo:[0,1] neg_hi:[0,1]
    v_pk_fma_f32 v[46:47], v[42:43], v[42:43], v[46:47]
    v_pk_add_f32 v[42:43], v[36:37], v[48:49] neg_lo:[0,1] neg_hi:[0,1]
    v_pk_fma_f32 v[44:45], v[42:43], v[42:43], v[44:45]
    v_pk_add_f32 v[44:45], v[44:45], v[46:47]
    v_add_f32 v44, v44, v45
    s_nop 1
    v_add_f32_dpp v44, v44, v44 row_ror:8 row_mask:0xf bank_mask:0xf
    s_nop 1
    v_add_f32_dpp v44, v44, v44 row_ror:4 row_mask:0xf bank_mask:0xf
    s_nop 1
    v_add_f32_dpp v44, v44, v44 row_ror:2 row_mask:0xf bank_mask:0xf
    s_nop 1
    v_add_f32_dpp v44, v44, v44 row_ror:1 row_mask:0xf bank_mask:0xf
    v_mov_b32 v46, v44
    s_nop 1
    v_permlane16_swap_b32 v44, v46
    v_add_f32 v44, v44, v46
    v_mul_f32 v44, 0x3ae38e39, v44
    v_cvt_pk_bf16_f32 v44, 0, v44
    v_add_f32 v44, 0x3727c5ac, v44
    v_cvt_pk_bf16_f32 v44, 0, v44
    v_sqrt_f32 v44, v44
    s_nop 0
    v_cvt_pk_bf16_f32 v44, 0, v44
    v_rcp_f32 v42, v44
    s_nop 0
    v_mov_b32 v43, v42
    v_pk_add_f32 v[44:45], v[20:21], v[40:41] neg_lo:[0,1] neg_hi:[0,1]
    v_cvt_pk_bf16_f32 v44, 0, v44
    v_cvt_pk_bf16_f32 v45, 0, v45
    v_pk_mul_f32 v[44:45], v[44:45], v[42:43]
    v_cvt_pk_bf16_f32 v10, v44, v45
    v_cvt_pk_bf16_f32 v44, 0, v44
    v_cvt_pk_bf16_f32 v45, 0, v45
    v_pk_add_f32 v[20:21], v[44:45], v[20:21]
    v_pk_add_f32 v[44:45], v[22:23], v[40:41] neg_lo:[0,1] neg_hi:[0,1]
    v_cvt_pk_bf16_f32 v44, 0, v44
    v_cvt_pk_bf16_f32 v45, 0, v45
    v_pk_mul_f32 v[44:45], v[44:45], v[42:43]
    v_cvt_pk_bf16_f32 v11, v44, v45
    v_cvt_pk_bf16_f32 v44, 0, v44
    v_cvt_pk_bf16_f32 v45, 0, v45
    v_pk_add_f32 v[22:23], v[44:45], v[22:23]
    v_pk_add_f32 v[44:45], v[24:25], v[40:41] neg_lo:[0,1] neg_hi:[0,1]
    v_cvt_pk_bf16_f32 v44, 0, v44
    v_cvt_pk_bf16_f32 v45, 0, v45
    v_pk_mul_f32 v[44:45], v[44:45], v[42:43]
    v_cvt_pk_bf16_f32 v12, v44, v45
    v_cvt_pk_bf16_f32 v44, 0, v44
    v_cvt_pk_bf16_f32 v45, 0, v45
    v_pk_add_f32 v[24:25], v[44:45], v[24:25]
    v_pk_add_f32 v[44:45], v[26:27], v[40:41] neg_lo:[0,1] neg_hi:[0,1]
    v_cvt_pk_bf16_f32 v44, 0, v44
    v_cvt_pk_bf16_f32 v45, 0, v45
    v_pk_mul_f32 v[44:45], v[44:45], v[42:43]
    v_cvt_pk_bf16_f32 v13, v44, v45
    v_cvt_pk_bf16_f32 v44, 0, v44
    v_cvt_pk_bf16_f32 v45, 0, v45
    v_pk_add_f32 v[26:27], v[44:45], v[26:27]
    v_pk_add_f32 v[44:45], v[28:29], v[40:41] neg_lo:[0,1] neg_hi:[0,1]
    v_cvt_pk_bf16_f32 v44, 0, v44
    v_cvt_pk_bf16_f32 v45, 0, v45
    v_pk_mul_f32 v[44:45], v[44:45], v[42:43]
    v_cvt_pk_bf16_f32 v14, v44, v45
    v_cvt_pk_bf16_f32 v44, 0, v44
    v_cvt_pk_bf16_f32 v45, 0, v45
    v_pk_add_f32 v[28:29], v[44:45], v[28:29]
    v_pk_add_f32 v[44:45], v[30:31], v[40:41] neg_lo:[0,1] neg_hi:[0,1]
    v_cvt_pk_bf16_f32 v44, 0, v44
    v_cvt_pk_bf16_f32 v45, 0, v45
    v_pk_mul_f32 v[44:45], v[44:45], v[42:43]
    v_cvt_pk_bf16_f32 v15, v44, v45
    v_cvt_pk_bf16_f32 v44, 0, v44
    v_cvt_pk_bf16_f32 v45, 0, v45
    v_pk_add_f32 v[30:31], v[44:45], v[30:31]
    v_pk_add_f32 v[44:45], v[32:33], v[40:41] neg_lo:[0,1] neg_hi:[0,1]
    v_cvt_pk_bf16_f32 v44, 0, v44
    v_cvt_pk_bf16_f32 v45, 0, v45
    v_pk_mul_f32 v[44:45], v[44:45], v[42:43]
    v_cvt_pk_bf16_f32 v16, v44, v45
    v_cvt_pk_bf16_f32 v44, 0, v44
    v_cvt_pk_bf16_f32 v45, 0, v45
    v_pk_add_f32 v[32:33], v[44:45], v[32:33]
    v_pk_add_f32 v[44:45], v[34:35], v[40:41] neg_lo:[0,1] neg_hi:[0,1]
    v_cvt_pk_bf16_f32 v44, 0, v44
    v_cvt_pk_bf16_f32 v45, 0, v45
    v_pk_mul_f32 v[44:45], v[44:45], v[42:43]
    v_cvt_pk_bf16_f32 v17, v44, v45
    v_cvt_pk_bf16_f32 v44, 0, v44
    v_cvt_pk_bf16_f32 v45, 0, v45
    v_pk_add_f32 v[34:35], v[44:45], v[34:35]
    v_pk_add_f32 v[44:45], v[36:37], v[40:41] neg_lo:[0,1] neg_hi:[0,1]
    v_cvt_pk_bf16_f32 v44, 0, v44
    v_cvt_pk_bf16_f32 v45, 0, v45
    v_pk_mul_f32 v[44:45], v[44:45], v[42:43]
    v_cvt_pk_bf16_f32 v18, v44, v45
    v_cvt_pk_bf16_f32 v44, 0, v44
    v_cvt_pk_bf16_f32 v45, 0, v45
    v_pk_add_f32 v[36:37], v[44:45], v[36:37]
    v_cvt_pk_bf16_f32 v58, v36, v37
    ds_write_b32 v108, v18
    ds_write_b32 v108, v58 offset:256
    ds_read_b128 v[64:67], v109
    buffer_store_dwordx4 v[10:13], v115, s[72:75], 0 offen sc1
    buffer_store_dwordx4 v[14:17], v115, s[72:75], 0 offen offset:512 sc1
    v_cvt_pk_bf16_f32 v50, v20, v21
    v_cvt_pk_bf16_f32 v51, v22, v23
    v_cvt_pk_bf16_f32 v52, v24, v25
    v_cvt_pk_bf16_f32 v53, v26, v27
    v_cvt_pk_bf16_f32 v54, v28, v29
    v_cvt_pk_bf16_f32 v55, v30, v31
    v_cvt_pk_bf16_f32 v56, v32, v33
    v_cvt_pk_bf16_f32 v57, v34, v35
    s_mov_b64 exec, 0xffff
    s_waitcnt lgkmcnt(0)
    buffer_store_dwordx4 v[64:67], v111, s[72:75], 0 offen offset:1024 sc1
    s_setprio 0
    s_sleep 30
    s_mov_b64 exec, 0xffff0000
    buffer_store_dwordx4 v[64:67], v111, s[68:71], 0 offen offset:1024 sc1
    s_mov_b64 exec, -1
    buffer_store_dwordx4 v[50:53], v115, s[68:71], 0 offen sc1
    buffer_store_dwordx4 v[54:57], v115, s[68:71], 0 offen offset:512 sc1
    s_mul_i32 s92, s89, 9344
    s_add_u32 s92, s92, 0x850000
    s_add_u32 s64, s36, s92
    s_addc_u32 s65, s37, 0
    s_cmp_lt_u32 s41, 18
    s_cselect_b32 s66, 9216, 0
    s_mov_b32 s67, 0x20000
    s_mul_i32 s92, s38, 3072
    v_lshlrev_b32 v8, 4, v1
    v_mov_b32 v60, -1
    v_mov_b32 v61, -1
    v_mov_b32 v62, -1
    v_mov_b32 v63, -1
    buffer_store_dwordx4 v[60:63], v8, s[64:67], s92 offen offset:0 sc1
    buffer_store_dwordx4 v[60:63], v8, s[64:67], s92 offen offset:1024 sc1
    buffer_store_dwordx4 v[60:63], v8, s[64:67], s92 offen offset:2048 sc1
    s_waitcnt vmcnt(0)
    s_mov_b64 exec, 1
    ds_add_rtn_u32 v62, v4, v5 offset:176
    s_waitcnt lgkmcnt(0)
    v_cmp_eq_u32 vcc, 3, v62
    s_and_b64 exec, exec, vcc
    s_cbranch_execz KS_NOF2
    s_lshl_b32 s92, s2, 4
    s_add_u32 s92, s92, 8192
    buffer_store_dword v5, v4, s[76:79], s92 offen sc1
KS_NOF2:
    s_mov_b64 exec, -1
    s_setprio 0
    s_cmp_lt_u32 s41, 18
    s_cbranch_scc1 KS_B
    s_waitcnt lgkmcnt(0)
    s_endpgm
KS_T:
    s_setprio 0
    s_cmp_ge_u32 s38, 10
    s_cbranch_scc1 KS_PEND
    v_and_b32 v6, 1, v1
    v_subrev_u32 v6, 1, v6
    v_and_b32 v7, 7, v1
    v_lshlrev_b32 v7, 2, v7
    s_add_u32 s76, s36, 0x840000
    s_addc_u32 s77, s37, 0
    s_mov_b32 s78, 0x3000
    s_mov_b32 s79, 0x20000
    s_cmp_eq_u32 s38, 9
    s_cbranch_scc1 KS_W9
    s_cmp_eq_u32 s38, 8
    s_cbranch_scc1 KS_L2W
    s_sub_u32 s93, s38, 4
    s_lshl_b32 s92, s93, 10
    v_lshl_add_u32 v33, v1, 4, s92
    s_movk_i32 s92, 4096
    s_lshl_b32 s93, s93, 7
    v_lshlrev_b32 v32, 4, v2
    v_lshl_add_u32 v32, v3, 5, v32
    v_add_u32 v32, s93, v32
W_88:
    s_sleep 1
    ds_read_b32 v8, v4 offset:12
    s_sub_u32 s39, s39, 1
    s_cbranch_scc1 KS_ABORT
    s_waitcnt lgkmcnt(0)
    v_cmp_ne_u32 vcc, s84, v8
    s_cbranch_vccnz W_88
    s_setprio 2
    s_sleep 27
    s_branch ZPE_90
ZP_89:
    s_sleep 4
ZPE_90:
    buffer_load_dwordx4 v[8:11], v33, s[76:79], 0 offen sc1
    buffer_load_dwordx4 v[12:15], v33, s[76:79], s92 offen sc1
    s_sub_u32 s39, s39, 1
    s_cbranch_scc1 KS_ABORT
    s_waitcnt vmcnt(0)
    v_max3_u32 v44, v8, v9, v10
    v_max3_u32 v44, v44, v11, v12
    v_max3_u32 v44, v44, v13, v14
    v_max_u32 v44, v44, v15
    v_cmp_eq_u32 vcc, -1, v44
    s_cbranch_vccnz ZP_89
    ds_write_b32 v4, v5 offset:196
    v_max_u32 v16, v8, v9
    v_min_u32 v9, v8, v9
    v_max_u32 v17, v12, v13
    v_min_u32 v13, v12, v13
    v_max_u32 v18, v10, v11
    v_min_u32 v11, v10, v11
    v_max_u32 v19, v14, v15
    v_min_u32 v15, v14, v15
    v_max_u32 v20, v16, v18
    v_min_u32 v18, v16, v18
    v_max_u32 v21, v17, v19
    v_min_u32 v19, v17, v19
    v_max_u32 v22, v9, v11
    v_min_u32 v11, v9, v11
    v_max_u32 v23, v13, v15
    v_min_u32 v15, v13, v15
    v_max_u32 v24, v22, v18
    v_min_u32 v18, v22, v18
    v_max_u32 v25, v23, v19
    v_min_u32 v19, v23, v19
    v_mov_b32_dpp v26, v11 quad_perm:[1,0,3,2] row_mask:0xf bank_mask:0xf
    v_mov_b32_dpp v27, v18 quad_perm:[1,0,3,2] row_mask:0xf bank_mask:0xf
    v_mov_b32_dpp v8, v24 quad_perm:[1,0,3,2] row_mask:0xf bank_mask:0xf
    v_mov_b32_dpp v12, v20 quad_perm:[1,0,3,2] row_mask:0xf bank_mask:0xf
    v_med3_u32 v26, v20, v26, v6
    v_med3_u32 v27, v24, v27, v6
    v_med3_u32 v8, v18, v8, v6
    v_med3_u32 v12, v11, v12, v6
    v_max_u32 v10, v26, v8
    v_min_u32 v8, v26, v8
    v_max_u32 v14, v27, v12
    v_min_u32 v12, v27, v12
    v_max_u32 v16, v10, v14
    v_min_u32 v14, v10, v14
    v_max_u32 v17, v8, v12
    v_min_u32 v12, v8, v12
    v_mov_b32_dpp v9, v15 quad_perm:[1,0,3,2] row_mask:0xf bank_mask:0xf
    v_mov_b32_dpp v13, v19 quad_perm:[1,0,3,2] row_mask:0xf bank_mask:0xf
    v_mov_b32_dpp v22, v25 quad_perm:[1,0,3,2] row_mask:0xf bank_mask:0xf
    v_mov_b32_dpp v23, v21 quad_perm:[1,0,3,2] row_mask:0xf bank_mask:0xf
    v_med3_u32 v9, v21, v9, v6
    v_med3_u32 v13, v25, v13, v6
    v_med3_u32 v22, v19, v22, v6
    v_med3_u32 v23, v15, v23, v6
    v_max_u32 v20, v9, v22
    v_min_u32 v22, v9, v22
    v_max_u32 v24, v13, v23
    v_min_u32 v23, v13, v23
    v_max_u32 v18, v20, v24
    v_min_u32 v24, v20, v24
    v_max_u32 v11, v22, v23
    v_min_u32 v23, v22, v23
    s_nop 1
    v_max_u32_dpp v16, v23, v16 quad_perm:[1,0,3,2] row_mask:0xf bank_mask:0xf
    v_max_u32_dpp v14, v11, v14 quad_perm:[1,0,3,2] row_mask:0xf bank_mask:0xf
    v_max_u32_dpp v17, v24, v17 quad_perm:[1,0,3,2] row_mask:0xf bank_mask:0xf
    v_max_u32_dpp v12, v18, v12 quad_perm:[1,0,3,2] row_mask:0xf bank_mask:0xf
    v_mov_b32_dpp v26, v16 quad_perm:[1,0,3,2] row_mask:0xf bank_mask:0xf
    v_mov_b32_dpp v27, v14 quad_perm:[1,0,3,2] row_mask:0xf bank_mask:0xf
    v_mov_b32_dpp v10, v17 quad_perm:[1,0,3,2] row_mask:0xf bank_mask:0xf
    v_mov_b32_dpp v8, v12 quad_perm:[1,0,3,2] row_mask:0xf bank_mask:0xf
    v_med3_u32 v26, v16, v26, v6
    v_med3_u32 v27, v14, v27, v6
    v_med3_u32 v10, v17, v10, v6
    v_med3_u32 v8, v12, v8, v6
    v_max_u32 v21, v26, v10
    v_min_u32 v10, v26, v10
    v_max_u32 v25, v27, v8
    v_min_u32 v8, v27, v8
    v_max_u32 v19, v21, v25
    v_min_u32 v25, v21, v25
    v_max_u32 v15, v10, v8
    v_min_u32 v8, v10, v8
    s_nop 1
    v_max_u32_dpp v9, v8, v19 quad_perm:[3,2,1,0] row_mask:0xf bank_mask:0xf
    v_max_u32_dpp v13, v15, v25 quad_perm:[3,2,1,0] row_mask:0xf bank_mask:0xf
    v_max_u32_dpp v20, v25, v15 quad_perm:[3,2,1,0] row_mask:0xf bank_mask:0xf
    v_max_u32_dpp v22, v19, v8 quad_perm:[3,2,1,0] row_mask:0xf bank_mask:0xf
    v_mov_b32_dpp v18, v9 quad_perm:[1,0,3,2] row_mask:0xf bank_mask:0xf
    v_mov_b32_dpp v24, v13 quad_perm:[1,0,3,2] row_mask:0xf bank_mask:0xf
    v_mov_b32_dpp v11, v20 quad_perm:[1,0,3,2] row_mask:0xf bank_mask:0xf
    v_mov_b32_dpp v23, v22 quad_perm:[1,0,3,2] row_mask:0xf bank_mask:0xf
    v_med3_u32 v18, v9, v18, v6
    v_med3_u32 v24, v13, v24, v6
    v_med3_u32 v11, v20, v11, v6
    v_med3_u32 v23, v22, v23, v6
    v_max_u32 v16, v18, v11
    v_min_u32 v11, v18, v11
    v_max_u32 v14, v24, v23
    v_min_u32 v23, v24, v23
    v_max_u32 v17, v16, v14
    v_min_u32 v14, v16, v14
    v_max_u32 v12, v11, v23
    v_min_u32 v23, v11, v23
    s_nop 1
    v_max_u32_dpp v26, v23, v17 row_half_mirror row_mask:0xf bank_mask:0xf
    v_max_u32_dpp v27, v12, v14 row_half_mirror row_mask:0xf bank_mask:0xf
    v_max_u32_dpp v21, v14, v12 row_half_mirror row_mask:0xf bank_mask:0xf
    v_max_u32_dpp v10, v17, v23 row_half_mirror row_mask:0xf bank_mask:0xf
    v_mov_b32_dpp v19, v26 quad_perm:[1,0,3,2] row_mask:0xf bank_mask:0xf
    v_mov_b32_dpp v25, v27 quad_perm:[1,0,3,2] row_mask:0xf bank_mask:0xf
    v_mov_b32_dpp v15, v21 quad_perm:[1,0,3,2] row_mask:0xf bank_mask:0xf
    v_mov_b32_dpp v8, v10 quad_perm:[1,0,3,2] row_mask:0xf bank_mask:0xf
    v_med3_u32 v19, v26, v19, v6
    v_med3_u32 v25, v27, v25, v6
    v_med3_u32 v15, v21, v15, v6
    v_med3_u32 v8, v10, v8, v6
    v_max_u32 v9, v19, v15
    v_min_u32 v15, v19, v15
    v_max_u32 v13, v25, v8
    v_min_u32 v8, v25, v8
    v_max_u32 v20, v9, v13
    v_min_u32 v13, v9, v13
    v_max_u32 v22, v15, v8
    v_min_u32 v8, v15, v8
    s_nop 1
    v_max_u32_dpp v18, v8, v20 row_mirror row_mask:0xf bank_mask:0xf
    v_max_u32_dpp v24, v22, v13 row_mirror row_mask:0xf bank_mask:0xf
    v_max_u32_dpp v16, v13, v22 row_mirror row_mask:0xf bank_mask:0xf
    v_max_u32_dpp v11, v20, v8 row_mirror row_mask:0xf bank_mask:0xf
    v_mov_b32_dpp v17, v18 quad_perm:[1,0,3,2] row_mask:0xf bank_mask:0xf
    v_mov_b32_dpp v14, v24 quad_perm:[1,0,3,2] row_mask:0xf bank_mask:0xf
    v_mov_b32_dpp v12, v16 quad_perm:[1,0,3,2] row_mask:0xf bank_mask:0xf
    v_mov_b32_dpp v23, v11 quad_perm:[1,0,3,2] row_mask:0xf bank_mask:0xf
    v_med3_u32 v17, v18, v17, v6
    v_med3_u32 v14, v24, v14, v6
    v_med3_u32 v12, v16, v12, v6
    v_med3_u32 v23, v11, v23, v6
    v_max_u32 v26, v17, v12
    v_min_u32 v12, v17, v12
    v_max_u32 v27, v14, v23
    v_min_u32 v23, v14, v23
    v_max_u32 v21, v26, v27
    v_min_u32 v27, v26, v27
    v_max_u32 v10, v12, v23
    v_min_u32 v23, v12, v23
    v_mov_b32 v28, v21
    v_mov_b32 v29, v27
    v_mov_b32 v30, v10
    v_mov_b32 v31, v23
    s_mov_b32 exec_lo, 0x00030003
    s_mov_b32 exec_hi, 0x00030003
    ds_write_b128 v32, v[28:31] offset:256
    s_mov_b64 exec, -1
    s_setprio 0
    s_branch KS_B
KS_L2W:
    s_mov_b32 s72, s36
    s_mov_b32 s73, s37
    s_mov_b32 s74, 0x240000
    s_mov_b32 s75, 0x20000
    s_mov_b32 s92, 0xcccccccc
    s_mov_b32 s93, 0xcccccccc
    s_mov_b32 s94, 0xf0f0f0f0
    s_mov_b32 s95, 0xf0f0f0f0
    s_movk_i32 s96, 1152
    v_lshrrev_b32 v34, 3, v1
    v_lshlrev_b32 v34, 4, v34
    v_lshlrev_b32 v33, 4, v2
W_91:
    s_sleep 1
    ds_read_b32 v8, v4 offset:12
    s_sub_u32 s39, s39, 1
    s_cbranch_scc1 KS_ABORT
    s_waitcnt lgkmcnt(0)
    v_cmp_ne_u32 vcc, s84, v8
    s_cbranch_vccnz W_91
    s_setprio 2
KS_L2POLL:
    ds_read_b128 v[8:11], v33 offset:256
    ds_read_b128 v[12:15], v33 offset:512
    s_sub_u32 s39, s39, 1
    s_cbranch_scc1 KS_ABORT
    s_waitcnt lgkmcnt(0)
    v_min3_u32 v16, v8, v9, v10
    v_min3_u32 v17, v11, v12, v13
    v_min3_u32 v16, v16, v14, v15
    v_min_u32 v16, v16, v17
    v_cmp_eq_u32 vcc, 0, v16
    s_cbranch_vccnz KS_L2POLL
    v_max_u32_dpp v8, v15, v8 quad_perm:[1,0,3,2] row_mask:0xf bank_mask:0xf
    v_max_u32_dpp v9, v14, v9 quad_perm:[1,0,3,2] row_mask:0xf bank_mask:0xf
    v_max_u32_dpp v10, v13, v10 quad_perm:[1,0,3,2] row_mask:0xf bank_mask:0xf
    v_max_u32_dpp v11, v12, v11 quad_perm:[1,0,3,2] row_mask:0xf bank_mask:0xf
    v_mov_b32_dpp v16, v8 quad_perm:[1,0,3,2] row_mask:0xf bank_mask:0xf
    v_mov_b32_dpp v17, v9 quad_perm:[1,0,3,2] row_mask:0xf bank_mask:0xf
    v_mov_b32_dpp v18, v10 quad_perm:[1,0,3,2] row_mask:0xf bank_mask:0xf
    v_mov_b32_dpp v19, v11 quad_perm:[1,0,3,2] row_mask:0xf bank_mask:0xf
    v_med3_u32 v16, v8, v16, v6
    v_med3_u32 v17, v9, v17, v6
    v_med3_u32 v18, v10, v18, v6
    v_med3_u32 v19, v11, v19, v6
    v_max_u32 v20, v16, v18
    v_min_u32 v18, v16, v18
    v_max_u32 v21, v17, v19
    v_min_u32 v19, v17, v19
    v_max_u32 v22, v20, v21
    v_min_u32 v21, v20, v21
    v_max_u32 v23, v18, v19
    v_min_u32 v19, v18, v19
    s_nop 1
    v_max_u32_dpp v24, v19, v22 quad_perm:[3,2,1,0] row_mask:0xf bank_mask:0xf
    v_max_u32_dpp v25, v23, v21 quad_perm:[3,2,1,0] row_mask:0xf bank_mask:0xf
    v_max_u32_dpp v26, v21, v23 quad_perm:[3,2,1,0] row_mask:0xf bank_mask:0xf
    v_max_u32_dpp v27, v22, v19 quad_perm:[3,2,1,0] row_mask:0xf bank_mask:0xf
    v_mov_b32_dpp v12, v24 quad_perm:[1,0,3,2] row_mask:0xf bank_mask:0xf
    v_mov_b32_dpp v13, v25 quad_perm:[1,0,3,2] row_mask:0xf bank_mask:0xf
    v_mov_b32_dpp v14, v26 quad_perm:[1,0,3,2] row_mask:0xf bank_mask:0xf
    v_mov_b32_dpp v15, v27 quad_perm:[1,0,3,2] row_mask:0xf bank_mask:0xf
    v_med3_u32 v12, v24, v12, v6
    v_med3_u32 v13, v25, v13, v6
    v_med3_u32 v14, v26, v14, v6
    v_med3_u32 v15, v27, v15, v6
    v_max_u32 v8, v12, v14
    v_min_u32 v14, v12, v14
    v_max_u32 v9, v13, v15
    v_min_u32 v15, v13, v15
    v_max_u32 v10, v8, v9
    v_min_u32 v9, v8, v9
    v_max_u32 v11, v14, v15
    v_min_u32 v15, v14, v15
    s_nop 1
    v_max_u32_dpp v16, v15, v10 row_half_mirror row_mask:0xf bank_mask:0xf
    v_max_u32_dpp v17, v11, v9 row_half_mirror row_mask:0xf bank_mask:0xf
    v_max_u32_dpp v20, v9, v11 row_half_mirror row_mask:0xf bank_mask:0xf
    v_max_u32_dpp v18, v10, v15 row_half_mirror row_mask:0xf bank_mask:0xf
    v_mov_b32_dpp v22, v16 quad_perm:[1,0,3,2] row_mask:0xf bank_mask:0xf
    v_mov_b32_dpp v21, v17 quad_perm:[1,0,3,2] row_mask:0xf bank_mask:0xf
    v_mov_b32_dpp v23, v20 quad_perm:[1,0,3,2] row_mask:0xf bank_mask:0xf
    v_mov_b32_dpp v19, v18 quad_perm:[1,0,3,2] row_mask:0xf bank_mask:0xf
    v_med3_u32 v22, v16, v22, v6
    v_med3_u32 v21, v17, v21, v6
    v_med3_u32 v23, v20, v23, v6
    v_med3_u32 v19, v18, v19, v6
    v_max_u32 v24, v22, v23
    v_min_u32 v23, v22, v23
    v_max_u32 v25, v21, v19
    v_min_u32 v19, v21, v19
    v_max_u32 v26, v24, v25
    v_min_u32 v25, v24, v25
    v_max_u32 v27, v23, v19
    v_min_u32 v19, v23, v19
    s_nop 1
    v_max_u32_dpp v12, v19, v26 row_mirror row_mask:0xf bank_mask:0xf
    v_max_u32_dpp v13, v27, v25 row_mirror row_mask:0xf bank_mask:0xf
    v_max_u32_dpp v8, v25, v27 row_mirror row_mask:0xf bank_mask:0xf
    v_max_u32_dpp v14, v26, v19 row_mirror row_mask:0xf bank_mask:0xf
    v_cndmask_b32 v30, v12, v13, s[92:93]
    v_cndmask_b32 v31, v8, v14, s[92:93]
    v_cndmask_b32 v30, v30, v31, s[94:95]
    s_nop 1
    v_mov_b32_dpp v30, v30 row_shr:8 row_mask:0xf bank_mask:0xc
    v_and_b32 v31, 0x7ff, v30
    v_sub_u32 v31, 2047, v31
    v_mad_u32_u24 v31, v31, s96, v34
    s_mov_b32 m0, 17088
    s_nop 0
    buffer_load_dwordx4 v31, s[72:75], 0 offen offset:0 sc1 lds
    s_mov_b32 m0, 17984
    s_nop 0
    buffer_load_dwordx4 v31, s[72:75], 0 offen offset:128 sc1 lds
    s_mov_b32 m0, 18880
    s_nop 0
    buffer_load_dwordx4 v31, s[72:75], 0 offen offset:256 sc1 lds
    s_mov_b32 m0, 19776
    s_nop 0
    buffer_load_dwordx4 v31, s[72:75], 0 offen offset:384 sc1 lds
    s_mov_b32 m0, 20672
    s_nop 0
    buffer_load_dwordx4 v31, s[72:75], 0 offen offset:512 sc1 lds
    s_mov_b32 m0, 21568
    s_nop 0
    buffer_load_dwordx4 v31, s[72:75], 0 offen offset:640 sc1 lds
    s_mov_b32 m0, 22464
    s_nop 0
    buffer_load_dwordx4 v31, s[72:75], 0 offen offset:768 sc1 lds
    s_mov_b32 m0, 23360
    s_nop 0
    buffer_load_dwordx4 v31, s[72:75], 0 offen offset:896 sc1 lds
    s_mov_b32 m0, 24256
    s_nop 0
    buffer_load_dwordx4 v31, s[72:75], 0 offen offset:1024 sc1 lds
    ds_write_b32 v7, v30 offset:768
    s_waitcnt vmcnt(0)
    ds_write_b32 v4, v5 offset:32
    s_setprio 0
    s_branch KS_B
KS_W9:
    v_lshlrev_b32 v33, 4, v1
    s_movk_i32 s92, 0x2000
    s_mov_b32 s72, s36
    s_mov_b32 s73, s37
    s_mov_b32 s74, 0x240000
    s_mov_b32 s75, 0x20000
    s_add_u32 s64, s36, 0x600000
    s_addc_u32 s65, s37, 0
    s_mov_b32 s66, 0x240000
    s_mov_b32 s67, 0x20000
    s_mov_b32 s68, s4
    s_mov_b32 s69, s5
    s_mov_b32 s70, 0x240000
    s_mov_b32 s71, 0x20000
    v_bfe_u32 v43, v1, 3, 2
    s_lshl_b32 s93, s89, 2
    v_add_u32 v43, s93, v43
    v_bfe_u32 v40, v43, 4, 1
    v_and_b32 v41, 3, v1
    v_lshl_add_u32 v40, v40, 2, v41
    v_lshlrev_b32 v40, 2, v40
    v_and_b32 v41, 0x3cf, v43
    v_bfe_u32 v42, v43, 5, 1
    v_lshl_add_u32 v41, v42, 4, v41
    v_bfe_u32 v42, v1, 2, 1
    v_lshl_add_u32 v41, v42, 5, v41
W_92:
    s_sleep 1
    ds_read_b32 v12, v7 offset:768
    s_sub_u32 s39, s39, 1
    s_cbranch_scc1 KS_ABORT
    s_waitcnt lgkmcnt(0)
    v_cmp_eq_u32 vcc, 0, v12
    s_cbranch_vccnz W_92
    ds_read_b32 v19, v40 offset:768
    s_waitcnt lgkmcnt(0)
    v_and_b32 v14, 0x7ff, v19
    v_sub_u32 v14, 2047, v14
    v_mul_u32_u24 v23, 1152, v14
    v_lshl_add_u32 v23, v41, 1, v23
    buffer_load_ushort v17, v23, s[68:71], 0 offen
    v_lshrrev_b32 v15, 9, v14
    v_bfe_u32 v16, v14, 6, 2
    v_lshl_add_u32 v15, v15, 2, v16
    v_bfe_u32 v16, v14, 2, 2
    v_lshl_add_u32 v15, v15, 2, v16
    v_bfe_u32 v16, v14, 4, 1
    v_bfe_u32 v24, v14, 8, 1
    v_and_b32 v25, 3, v14
    v_lshl_add_u32 v24, v24, 2, v25
    v_lshlrev_b32 v24, 1, v24
    v_bfe_u32 v25, v14, 5, 1
    v_lshl_add_u32 v24, v25, 5, v24
    v_lshl_add_u32 v25, v15, 1, v16
    v_lshl_add_u32 v25, v25, 14, v24
    v_lshrrev_b32 v26, 1, v41
    v_lshl_add_u32 v25, v26, 6, v25
    v_xor_b32 v26, v41, v16
    v_not_b32 v26, v26
    v_and_b32 v26, 1, v26
    v_lshl_add_u32 v25, v26, 4, v25
    v_lshl_add_u32 v26, v15, 12, v24
    v_lshl_add_u32 v26, v16, 4, v26
    v_lshl_add_u32 v26, v41, 6, v26
    v_add_u32 v26, 2064384, v26
    v_lshl_add_u32 v27, v16, 6, v15
    v_lshlrev_b32 v27, 7, v27
    v_xor_b32 v25, v27, v25
    v_and_b32 v27, 0xf80, v27
    v_xor_b32 v26, v27, v26
    v_cmp_gt_u32 vcc, 0x200, v41
    s_nop 1
    v_cndmask_b32 v25, v26, v25, vcc
    buffer_load_ushort v18, v25, s[64:67], 0 offen sc1
    v_ashrrev_i32 v22, 31, v19
    v_not_b32 v22, v22
    v_or_b32 v22, 0x80000000, v22
    v_xor_b32 v22, v19, v22
    v_and_b32 v22, 0xffff0000, v22
    v_mul_f32 v22, 0xbfb8aa3b, v22
    v_exp_f32 v22, v22
    s_nop 0
    v_add_f32 v22, 1.0, v22
    v_rcp_f32 v22, v22
    s_nop 0
    v_cvt_pk_bf16_f32 v22, 0, v22
    v_and_b32 v14, 31, v1
    v_lshlrev_b32 v14, 4, v14
    s_barrier
    buffer_load_dword v8, v33, s[76:79], s92 offen offset:0 sc1
    buffer_load_dword v9, v33, s[76:79], s92 offen offset:1024 sc1
    buffer_load_dword v10, v33, s[76:79], s92 offen offset:2048 sc1
    buffer_load_dword v11, v33, s[76:79], s92 offen offset:3072 sc1
    s_barrier
    s_branch ZPE_94
ZP_93:
    s_sleep 4
    buffer_load_dword v8, v33, s[76:79], s92 offen offset:0 sc1
    buffer_load_dword v9, v33, s[76:79], s92 offen offset:1024 sc1
    buffer_load_dword v10, v33, s[76:79], s92 offen offset:2048 sc1
    buffer_load_dword v11, v33, s[76:79], s92 offen offset:3072 sc1
ZPE_94:
    s_sub_u32 s39, s39, 1
    s_cbranch_scc1 KS_ABORT
    s_waitcnt vmcnt(0)
    v_max3_u32 v44, v8, v9, v10
    v_max_u32 v44, v44, v11
    v_cmp_eq_u32 vcc, -1, v44
    s_cbranch_vccnz ZP_93
    ds_write_b32 v4, v5 offset:28
    buffer_load_ushort v20, v23, s[72:75], 0 offen sc1
    s_add_u32 s72, s36, 0xb10000
    s_addc_u32 s73, s37, 0
    s_mov_b32 s74, 0x40
    s_mov_b32 s75, 0x20000
    s_waitcnt vmcnt(0)
    v_lshlrev_b32 v17, 16, v17
    v_lshlrev_b32 v18, 16, v18
    v_add_f32 v17, v17, v18
    v_cvt_pk_bf16_f32 v17, v17, v17
    v_and_b32 v21, 0xffff0000, v17
    v_lshlrev_b32 v20, 16, v20
    s_cmp_lg_u32 s2, 0
    s_cbranch_scc1 KS_W9E
    buffer_store_dword v12, v7, s[72:75], 0 offen
KS_W9E:
    s_mov_b32 s68, s32
    s_mov_b32 s69, s33
    s_mov_b32 s70, 0x240000
    s_mov_b32 s71, 0x20000
    v_lshlrev_b32 v14, 2, v1
    v_add_u32 v14, 1536, v14
    s_mov_b32 exec_lo, -1
    s_mov_b32 exec_hi, 0
    s_setprio 3
    s_barrier
    ds_read2_b32 v[32:33], v14 offset0:0 offset1:32
    ds_read2_b32 v[34:35], v14 offset0:64 offset1:96
    ds_read2_b32 v[36:37], v14 offset0:128 offset1:160
    ds_read2_b32 v[38:39], v14 offset0:192 offset1:224
    ds_read_b32 v40, v14 offset:1024
    s_waitcnt lgkmcnt(3)
    v_pk_add_f32 v[32:33], v[32:33], v[34:35]
    s_waitcnt lgkmcnt(1)
    v_pk_add_f32 v[36:37], v[36:37], v[38:39]
    v_add_f32 v32, v32, v33
    s_waitcnt lgkmcnt(0)
    v_add_f32 v36, v36, v37
    v_add_f32 v32, v32, v40
    v_add_f32 v8, v32, v36
    v_cvt_pk_bf16_f32 v8, 0, v8
    v_mul_f32 v8, v8, v22
    v_cvt_pk_bf16_f32 v8, 0, v8
    v_add_f32 v8, v8, v20
    v_cvt_pk_bf16_f32 v8, 0, v8
    v_add_f32 v8, v8, v21
    v_cvt_pk_bf16_f32 v8, v8, v8
    buffer_store_short v8, v23, s[68:71], 0 offen
    s_endpgm
KS_B:
    s_add_u32 s64, s36, 0x850000
    s_addc_u32 s65, s37, 0
    s_mov_b32 s66, 0x148800
    s_mov_b32 s67, 0x20000
    v_bfe_u32 v16, v1, 2, 2
    v_lshl_add_u32 v16, v3, 3, v16
    v_mul_u32_u24 v16, 1152, v16
    v_and_b32 v17, 3, v1
    v_lshl_add_u32 v16, v17, 3, v16
    s_lshl_b32 s92, s38, 7
    s_add_u32 s92, s92, 109184
    v_add_u32 v16, s92, v16
    v_lshrrev_b32 v18, 2, v1
    v_mul_u32_u24 v18, 9344, v18
    v_lshl_add_u32 v18, v17, 4, v18
    s_mul_i32 s94, s38, 149504
    s_lshl_b32 s95, s89, 6
    s_add_u32 s94, s94, s95
    s_lshl_b32 s95, s38, 7
    v_lshl_add_u32 v19, v17, 5, s95
    v_lshl_add_u32 v19, v3, 3, v19
    s_movk_i32 s95, 0x3f80
    s_mov_b32 s96, 0x3f800000
    v_mov_b32 v28, 0
    v_mov_b32 v29, 0
W_95:
    ds_read_b32 v17, v4 offset:40
    s_sub_u32 s39, s39, 1
    s_cbranch_scc1 KS_ABORT
    s_waitcnt lgkmcnt(0)
    v_cmp_ne_u32 vcc, s84, v17
    s_cbranch_vccnz W_95
    ds_read_b64_tr_b16 v[48:49], v16 offset:0
    ds_read_b64_tr_b16 v[50:51], v16 offset:4608
    ds_read_b64_tr_b16 v[52:53], v16 offset:32
    ds_read_b64_tr_b16 v[54:55], v16 offset:4640
    ds_read_b64_tr_b16 v[56:57], v16 offset:64
    ds_read_b64_tr_b16 v[58:59], v16 offset:4672
    ds_read_b64_tr_b16 v[60:61], v16 offset:96
    ds_read_b64_tr_b16 v[62:63], v16 offset:4704
    v_and_b32 v16, 7, v2
    v_lshlrev_b32 v16, 6, v16
    v_lshl_add_u32 v16, v3, 4, v16
    s_mul_i32 s92, s89, 9344
    s_lshl_b32 s93, s38, 10
    s_add_u32 s92, s92, s93
    v_lshlrev_b32 v17, 4, v1
    s_waitcnt lgkmcnt(0)
    s_barrier
    s_barrier
    ds_read_b128 v[20:23], v16 offset:1024
    s_waitcnt lgkmcnt(0)
    v_mfma_f32_16x16x32_bf16 v[32:35], v[20:23], v[48:51], 0
    v_mfma_f32_16x16x32_bf16 v[40:43], v[20:23], v[56:59], 0
    v_mfma_f32_16x16x32_bf16 v[36:39], v[20:23], v[52:55], 0
    v_mfma_f32_16x16x32_bf16 v[44:47], v[20:23], v[60:63], 0
    s_mov_b32 exec_lo, -1
    s_mov_b32 exec_hi, 0
    s_nop 2
    v_cvt_pk_bf16_f32 v24, v32, v33
    v_cvt_pk_bf16_f32 v25, v34, v35
    v_cvt_pk_bf16_f32 v26, v40, v41
    v_cvt_pk_bf16_f32 v27, v42, v43
    s_mov_b32 exec_lo, 0
    s_mov_b32 exec_hi, -1
    v_cvt_pk_bf16_f32 v24, v36, v37
    v_cvt_pk_bf16_f32 v25, v38, v39
    v_cvt_pk_bf16_f32 v26, v44, v45
    v_cvt_pk_bf16_f32 v27, v46, v47
    s_mov_b64 exec, -1
    v_min_u32 v24, -2, v24
    v_min_u32 v25, -2, v25
    v_min_u32 v26, -2, v26
    v_min_u32 v27, -2, v27
    buffer_store_dwordx4 v[24:27], v17, s[64:67], s92 offen sc1
    s_sleep 13
    s_setprio 2
W_96:
    ds_read_b32 v30, v4 offset:28
    s_sub_u32 s39, s39, 1
    s_cbranch_scc1 KS_ABORT
    s_waitcnt lgkmcnt(0)
    v_cmp_eq_u32 vcc, 0, v30
    s_cbranch_vccnz W_96
    s_branch ZPE_98
ZP_97:
    s_sleep 1
ZPE_98:
    buffer_load_dwordx4 v[32:35], v18, s[64:67], s94 offen sc1
    s_sub_u32 s39, s39, 1
    s_cbranch_scc1 KS_ABORT
    s_waitcnt vmcnt(0)
    v_max3_u32 v44, v32, v33, v34
    v_max_u32 v44, v44, v35
    v_cmp_eq_u32 vcc, -1, v44
    s_cbranch_vccnz ZP_97
    v_permlane32_swap_b32 v32, v34
    v_permlane32_swap_b32 v33, v35
    s_nop 1
    v_permlane16_swap_b32 v32, v33
    v_permlane16_swap_b32 v34, v35
    v_dot2c_f32_bf16 v28, s95, v32
    v_dot2c_f32_bf16 v29, s96, v32
    v_dot2c_f32_bf16 v28, s95, v33
    v_dot2c_f32_bf16 v29, s96, v33
    v_dot2c_f32_bf16 v28, s95, v34
    v_dot2c_f32_bf16 v29, s96, v34
    v_dot2c_f32_bf16 v28, s95, v35
    v_dot2c_f32_bf16 v29, s96, v35
    s_nop 1
    v_add_f32_dpp v28, v28, v28 row_ror:8 row_mask:0xf bank_mask:0xf
    v_add_f32_dpp v29, v29, v29 row_ror:8 row_mask:0xf bank_mask:0xf
    s_nop 0
    v_add_f32_dpp v28, v28, v28 row_ror:4 row_mask:0xf bank_mask:0xf
    v_add_f32_dpp v29, v29, v29 row_ror:4 row_mask:0xf bank_mask:0xf
    s_mov_b32 exec_lo, 0x000f000f
    s_mov_b32 exec_hi, 0x000f000f
    ds_write_b64 v19, v[28:29] offset:1536
    s_waitcnt lgkmcnt(0)
    s_barrier
    s_endpgm
KS_G0:
    ds_write_b8 v15, v5 offset:68
    s_setprio 0
KS_G:
    s_mov_b32 s98, 0x05040100
    s_mov_b32 s99, 0x07060302
    s_waitcnt vmcnt(0)
    s_sub_u32 s87, s38, 12
    s_mul_i32 s92, s87, 9
    s_add_u32 s92, s92, 1
    s_lshr_b32 s86, s92, 1
    s_lshl_b32 s92, s86, 5
    v_lshl_add_u32 v7, v3, 3, s92
    v_mul_u32_u24 v7, 9216, v7
    v_and_b32 v6, 7, v2
    v_lshl_add_u32 v7, v6, 3, v7
    s_lshl_b32 s92, s89, 6
    v_add_u32 v7, s92, v7
    v_cmp_gt_u32 vcc, 8, v2
    s_mov_b32 s76, 9216
    s_mov_b32 s77, 0
    s_mov_b32 s78, 230400
    s_mov_b32 s79, 0
    v_mov_b32 v46, s26
    v_mov_b32 v47, s27
    v_mov_b32 v6, s28
    v_cndmask_b32 v46, v6, v46, vcc
    v_mov_b32 v6, s29
    v_cndmask_b32 v47, v6, v47, vcc
    v_add_co_u32 v46, vcc, v46, v7
    s_nop 1
    v_addc_co_u32 v47, vcc, 0, v47, vcc
    s_mov_b32 s68, s30
    s_mov_b32 s69, s31
    s_mov_b32 s70, 0x510000
    s_mov_b32 s71, 0x20000
    v_lshlrev_b32 v8, 4, v1
    s_mul_i32 s92, s89, 36864
    s_mul_i32 s93, s87, 9216
    s_add_u32 s92, s92, s93
    s_add_u32 s93, s93, 109184
    s_cmp_lt_u32 s41, 8
    s_cselect_b32 s94, 0, 100
    v_mov_b32 v9, s94
W_99:
    s_sleep 2
    ds_read_b32 v10, v9 offset:100
    s_sub_u32 s39, s39, 1
    s_cbranch_scc1 KS_ABORT
    s_waitcnt lgkmcnt(0)
    v_cmp_ne_u32 vcc, s84, v10
    s_cbranch_vccnz W_99
    s_cmp_ge_u32 s41, 8
    s_cbranch_scc1 KS_GD1
    s_add_u32 m0, s93, 0
    s_nop 0
    buffer_load_dwordx4 v8, s[68:71], s92 offen offset:0 nt lds
    buffer_load_dwordx4 v8, s[68:71], s92 offen offset:1024 nt lds
    buffer_load_dwordx4 v8, s[68:71], s92 offen offset:2048 nt lds
    buffer_load_dwordx4 v8, s[68:71], s92 offen offset:3072 nt lds
    s_add_u32 m0, s93, 4096
    s_add_u32 s92, s92, 4096
    buffer_load_dwordx4 v8, s[68:71], s92 offen offset:0 nt lds
    buffer_load_dwordx4 v8, s[68:71], s92 offen offset:1024 nt lds
    buffer_load_dwordx4 v8, s[68:71], s92 offen offset:2048 nt lds
    buffer_load_dwordx4 v8, s[68:71], s92 offen offset:3072 nt lds
    s_add_u32 m0, s93, 8192
    s_add_u32 s92, s92, 4096
    buffer_load_dwordx4 v8, s[68:71], s92 offen offset:0 nt lds
KS_GD1:
    s_lshr_b32 s92, 12, s87
    s_bitcmp1_b32 s92, 0
    s_cbranch_scc0 GT_100
W_101:
    s_sleep 2
    ds_read_b32 v10, v4 offset:52
    s_sub_u32 s39, s39, 1
    s_cbranch_scc1 KS_ABORT
    s_waitcnt lgkmcnt(0)
    v_cmp_ne_u32 vcc, s84, v10
    s_cbranch_vccnz W_101
    s_setprio 1
GT_100:
    s_lshr_b32 s92, 3, s87
    s_bitcmp1_b32 s92, 0
    s_cbranch_scc0 KS_GN0
    global_load_dwordx2 v[48:49], v[46:47], off nt
    v_lshl_add_u64 v[46:47], v[46:47], 0, s[76:77]
    global_load_dwordx2 v[50:51], v[46:47], off nt
    v_lshl_add_u64 v[46:47], v[46:47], 0, s[76:77]
    global_load_dwordx2 v[52:53], v[46:47], off nt
    v_lshl_add_u64 v[46:47], v[46:47], 0, s[76:77]
    global_load_dwordx2 v[54:55], v[46:47], off nt
    v_lshl_add_u64 v[46:47], v[46:47], 0, s[76:77]
    global_load_dwordx2 v[56:57], v[46:47], off nt
    v_lshl_add_u64 v[46:47], v[46:47], 0, s[76:77]
    global_load_dwordx2 v[58:59], v[46:47], off nt
    v_lshl_add_u64 v[46:47], v[46:47], 0, s[76:77]
    global_load_dwordx2 v[60:61], v[46:47], off nt
    v_lshl_add_u64 v[46:47], v[46:47], 0, s[76:77]
    global_load_dwordx2 v[62:63], v[46:47], off nt
    v_lshl_add_u64 v[46:47], v[46:47], 0, s[78:79]
    global_load_dwordx2 v[64:65], v[46:47], off nt
    v_lshl_add_u64 v[46:47], v[46:47], 0, s[76:77]
    global_load_dwordx2 v[66:67], v[46:47], off nt
    v_lshl_add_u64 v[46:47], v[46:47], 0, s[76:77]
    global_load_dwordx2 v[68:69], v[46:47], off nt
    v_lshl_add_u64 v[46:47], v[46:47], 0, s[76:77]
    global_load_dwordx2 v[70:71], v[46:47], off nt
    v_lshl_add_u64 v[46:47], v[46:47], 0, s[76:77]
    global_load_dwordx2 v[72:73], v[46:47], off nt
    v_lshl_add_u64 v[46:47], v[46:47], 0, s[76:77]
    global_load_dwordx2 v[74:75], v[46:47], off nt
    v_lshl_add_u64 v[46:47], v[46:47], 0, s[76:77]
    global_load_dwordx2 v[76:77], v[46:47], off nt
    v_lshl_add_u64 v[46:47], v[46:47], 0, s[76:77]
    global_load_dwordx2 v[78:79], v[46:47], off nt
    v_lshl_add_u64 v[46:47], v[46:47], 0, s[78:79]
    global_load_dwordx2 v[80:81], v[46:47], off nt
    v_lshl_add_u64 v[46:47], v[46:47], 0, s[76:77]
    global_load_dwordx2 v[82:83], v[46:47], off nt
    v_lshl_add_u64 v[46:47], v[46:47], 0, s[76:77]
    global_load_dwordx2 v[84:85], v[46:47], off nt
    v_lshl_add_u64 v[46:47], v[46:47], 0, s[76:77]
    global_load_dwordx2 v[86:87], v[46:47], off nt
    v_lshl_add_u64 v[46:47], v[46:47], 0, s[76:77]
    global_load_dwordx2 v[88:89], v[46:47], off nt
    v_lshl_add_u64 v[46:47], v[46:47], 0, s[76:77]
    global_load_dwordx2 v[90:91], v[46:47], off nt
    v_lshl_add_u64 v[46:47], v[46:47], 0, s[76:77]
    global_load_dwordx2 v[92:93], v[46:47], off nt
    v_lshl_add_u64 v[46:47], v[46:47], 0, s[76:77]
    global_load_dwordx2 v[94:95], v[46:47], off nt
    v_lshl_add_u64 v[46:47], v[46:47], 0, s[78:79]
    global_load_dwordx2 v[96:97], v[46:47], off nt
    v_lshl_add_u64 v[46:47], v[46:47], 0, s[76:77]
    global_load_dwordx2 v[98:99], v[46:47], off nt
    v_lshl_add_u64 v[46:47], v[46:47], 0, s[76:77]
    global_load_dwordx2 v[100:101], v[46:47], off nt
    v_lshl_add_u64 v[46:47], v[46:47], 0, s[76:77]
    global_load_dwordx2 v[102:103], v[46:47], off nt
    v_lshl_add_u64 v[46:47], v[46:47], 0, s[76:77]
    global_load_dwordx2 v[104:105], v[46:47], off nt
    v_lshl_add_u64 v[46:47], v[46:47], 0, s[76:77]
    global_load_dwordx2 v[106:107], v[46:47], off nt
    v_lshl_add_u64 v[46:47], v[46:47], 0, s[76:77]
    global_load_dwordx2 v[108:109], v[46:47], off nt
    v_lshl_add_u64 v[46:47], v[46:47], 0, s[76:77]
    global_load_dwordx2 v[110:111], v[46:47], off nt
    v_lshl_add_u64 v[46:47], v[46:47], 0, s[78:79]
    s_bitcmp1_b32 s87, 0
    s_cbranch_scc1 KS_G4
    global_load_dwordx2 v[112:113], v[46:47], off nt
    v_lshl_add_u64 v[46:47], v[46:47], 0, s[76:77]
    global_load_dwordx2 v[114:115], v[46:47], off nt
    v_lshl_add_u64 v[46:47], v[46:47], 0, s[76:77]
    global_load_dwordx2 v[116:117], v[46:47], off nt
    v_lshl_add_u64 v[46:47], v[46:47], 0, s[76:77]
    global_load_dwordx2 v[118:119], v[46:47], off nt
    v_lshl_add_u64 v[46:47], v[46:47], 0, s[76:77]
    global_load_dwordx2 v[120:121], v[46:47], off nt
    v_lshl_add_u64 v[46:47], v[46:47], 0, s[76:77]
    global_load_dwordx2 v[122:123], v[46:47], off nt
    v_lshl_add_u64 v[46:47], v[46:47], 0, s[76:77]
    global_load_dwordx2 v[124:125], v[46:47], off nt
    v_lshl_add_u64 v[46:47], v[46:47], 0, s[76:77]
    global_load_dwordx2 v[126:127], v[46:47], off nt
    s_branch KS_G4
KS_GN0:
    global_load_dwordx2 v[48:49], v[46:47], off
    v_lshl_add_u64 v[46:47], v[46:47], 0, s[76:77]
    global_load_dwordx2 v[50:51], v[46:47], off
    v_lshl_add_u64 v[46:47], v[46:47], 0, s[76:77]
    global_load_dwordx2 v[52:53], v[46:47], off
    v_lshl_add_u64 v[46:47], v[46:47], 0, s[76:77]
    global_load_dwordx2 v[54:55], v[46:47], off
    v_lshl_add_u64 v[46:47], v[46:47], 0, s[76:77]
    global_load_dwordx2 v[56:57], v[46:47], off
    v_lshl_add_u64 v[46:47], v[46:47], 0, s[76:77]
    global_load_dwordx2 v[58:59], v[46:47], off
    v_lshl_add_u64 v[46:47], v[46:47], 0, s[76:77]
    global_load_dwordx2 v[60:61], v[46:47], off
    v_lshl_add_u64 v[46:47], v[46:47], 0, s[76:77]
    global_load_dwordx2 v[62:63], v[46:47], off
    v_lshl_add_u64 v[46:47], v[46:47], 0, s[78:79]
    global_load_dwordx2 v[64:65], v[46:47], off
    v_lshl_add_u64 v[46:47], v[46:47], 0, s[76:77]
    global_load_dwordx2 v[66:67], v[46:47], off
    v_lshl_add_u64 v[46:47], v[46:47], 0, s[76:77]
    global_load_dwordx2 v[68:69], v[46:47], off
    v_lshl_add_u64 v[46:47], v[46:47], 0, s[76:77]
    global_load_dwordx2 v[70:71], v[46:47], off
    v_lshl_add_u64 v[46:47], v[46:47], 0, s[76:77]
    global_load_dwordx2 v[72:73], v[46:47], off
    v_lshl_add_u64 v[46:47], v[46:47], 0, s[76:77]
    global_load_dwordx2 v[74:75], v[46:47], off
    v_lshl_add_u64 v[46:47], v[46:47], 0, s[76:77]
    global_load_dwordx2 v[76:77], v[46:47], off
    v_lshl_add_u64 v[46:47], v[46:47], 0, s[76:77]
    global_load_dwordx2 v[78:79], v[46:47], off
    v_lshl_add_u64 v[46:47], v[46:47], 0, s[78:79]
    global_load_dwordx2 v[80:81], v[46:47], off
    v_lshl_add_u64 v[46:47], v[46:47], 0, s[76:77]
    global_load_dwordx2 v[82:83], v[46:47], off
    v_lshl_add_u64 v[46:47], v[46:47], 0, s[76:77]
    global_load_dwordx2 v[84:85], v[46:47], off
    v_lshl_add_u64 v[46:47], v[46:47], 0, s[76:77]
    global_load_dwordx2 v[86:87], v[46:47], off
    v_lshl_add_u64 v[46:47], v[46:47], 0, s[76:77]
    global_load_dwordx2 v[88:89], v[46:47], off
    v_lshl_add_u64 v[46:47], v[46:47], 0, s[76:77]
    global_load_dwordx2 v[90:91], v[46:47], off
    v_lshl_add_u64 v[46:47], v[46:47], 0, s[76:77]
    global_load_dwordx2 v[92:93], v[46:47], off
    v_lshl_add_u64 v[46:47], v[46:47], 0, s[76:77]
    global_load_dwordx2 v[94:95], v[46:47], off
    v_lshl_add_u64 v[46:47], v[46:47], 0, s[78:79]
    global_load_dwordx2 v[96:97], v[46:47], off
    v_lshl_add_u64 v[46:47], v[46:47], 0, s[76:77]
    global_load_dwordx2 v[98:99], v[46:47], off
    v_lshl_add_u64 v[46:47], v[46:47], 0, s[76:77]
    global_load_dwordx2 v[100:101], v[46:47], off
    v_lshl_add_u64 v[46:47], v[46:47], 0, s[76:77]
    global_load_dwordx2 v[102:103], v[46:47], off
    v_lshl_add_u64 v[46:47], v[46:47], 0, s[76:77]
    global_load_dwordx2 v[104:105], v[46:47], off
    v_lshl_add_u64 v[46:47], v[46:47], 0, s[76:77]
    global_load_dwordx2 v[106:107], v[46:47], off
    v_lshl_add_u64 v[46:47], v[46:47], 0, s[76:77]
    global_load_dwordx2 v[108:109], v[46:47], off
    v_lshl_add_u64 v[46:47], v[46:47], 0, s[76:77]
    global_load_dwordx2 v[110:111], v[46:47], off
    v_lshl_add_u64 v[46:47], v[46:47], 0, s[78:79]
    s_bitcmp1_b32 s87, 0
    s_cbranch_scc1 KS_G4
    global_load_dwordx2 v[112:113], v[46:47], off
    v_lshl_add_u64 v[46:47], v[46:47], 0, s[76:77]
    global_load_dwordx2 v[114:115], v[46:47], off
    v_lshl_add_u64 v[46:47], v[46:47], 0, s[76:77]
    global_load_dwordx2 v[116:117], v[46:47], off
    v_lshl_add_u64 v[46:47], v[46:47], 0, s[76:77]
    global_load_dwordx2 v[118:119], v[46:47], off
    v_lshl_add_u64 v[46:47], v[46:47], 0, s[76:77]
    global_load_dwordx2 v[120:121], v[46:47], off
    v_lshl_add_u64 v[46:47], v[46:47], 0, s[76:77]
    global_load_dwordx2 v[122:123], v[46:47], off
    v_lshl_add_u64 v[46:47], v[46:47], 0, s[76:77]
    global_load_dwordx2 v[124:125], v[46:47], off
    v_lshl_add_u64 v[46:47], v[46:47], 0, s[76:77]
    global_load_dwordx2 v[126:127], v[46:47], off
KS_G4:
    v_mov_b32 v6, s87
    ds_write_b8 v6, v5 offset:192
    s_waitcnt vmcnt(0)
    ds_write_b8 v6, v5 offset:40
    v_perm_b32 v32, v50, v48, s98
    v_perm_b32 v33, v54, v52, s98
    v_perm_b32 v34, v58, v56, s98
    v_perm_b32 v35, v62, v60, s98
    v_perm_b32 v36, v50, v48, s99
    v_perm_b32 v37, v54, v52, s99
    v_perm_b32 v38, v58, v56, s99
    v_perm_b32 v39, v62, v60, s99
    v_perm_b32 v40, v51, v49, s98
    v_perm_b32 v41, v55, v53, s98
    v_perm_b32 v42, v59, v57, s98
    v_perm_b32 v43, v63, v61, s98
    v_perm_b32 v44, v51, v49, s99
    v_perm_b32 v45, v55, v53, s99
    v_perm_b32 v46, v59, v57, s99
    v_perm_b32 v47, v63, v61, s99
    v_perm_b32 v48, v66, v64, s98
    v_perm_b32 v49, v70, v68, s98
    v_perm_b32 v50, v74, v72, s98
    v_perm_b32 v51, v78, v76, s98
    v_perm_b32 v52, v66, v64, s99
    v_perm_b32 v53, v70, v68, s99
    v_perm_b32 v54, v74, v72, s99
    v_perm_b32 v55, v78, v76, s99
    v_perm_b32 v56, v67, v65, s98
    v_perm_b32 v57, v71, v69, s98
    v_perm_b32 v58, v75, v73, s98
    v_perm_b32 v59, v79, v77, s98
    v_perm_b32 v60, v67, v65, s99
    v_perm_b32 v61, v71, v69, s99
    v_perm_b32 v62, v75, v73, s99
    v_perm_b32 v63, v79, v77, s99
    v_perm_b32 v64, v82, v80, s98
    v_perm_b32 v65, v86, v84, s98
    v_perm_b32 v66, v90, v88, s98
    v_perm_b32 v67, v94, v92, s98
    v_perm_b32 v68, v82, v80, s99
    v_perm_b32 v69, v86, v84, s99
    v_perm_b32 v70, v90, v88, s99
    v_perm_b32 v71, v94, v92, s99
    v_perm_b32 v72, v83, v81, s98
    v_perm_b32 v73, v87, v85, s98
    v_perm_b32 v74, v91, v89, s98
    v_perm_b32 v75, v95, v93, s98
    v_perm_b32 v76, v83, v81, s99
    v_perm_b32 v77, v87, v85, s99
    v_perm_b32 v78, v91, v89, s99
    v_perm_b32 v79, v95, v93, s99
    v_perm_b32 v80, v98, v96, s98
    v_perm_b32 v81, v102, v100, s98
    v_perm_b32 v82, v106, v104, s98
    v_perm_b32 v83, v110, v108, s98
    v_perm_b32 v84, v98, v96, s99
    v_perm_b32 v85, v102, v100, s99
    v_perm_b32 v86, v106, v104, s99
    v_perm_b32 v87, v110, v108, s99
    v_perm_b32 v88, v99, v97, s98
    v_perm_b32 v89, v103, v101, s98
    v_perm_b32 v90, v107, v105, s98
    v_perm_b32 v91, v111, v109, s98
    v_perm_b32 v92, v99, v97, s99
    v_perm_b32 v93, v103, v101, s99
    v_perm_b32 v94, v107, v105, s99
    v_perm_b32 v95, v111, v109, s99
    v_perm_b32 v96, v114, v112, s98
    v_perm_b32 v97, v118, v116, s98
    v_perm_b32 v98, v122, v120, s98
    v_perm_b32 v99, v126, v124, s98
    v_perm_b32 v100, v114, v112, s99
    v_perm_b32 v101, v118, v116, s99
    v_perm_b32 v102, v122, v120, s99
    v_perm_b32 v103, v126, v124, s99
    v_perm_b32 v104, v115, v113, s98
    v_perm_b32 v105, v119, v117, s98
    v_perm_b32 v106, v123, v121, s98
    v_perm_b32 v107, v127, v125, s98
    v_perm_b32 v108, v115, v113, s99
    v_perm_b32 v109, v119, v117, s99
    v_perm_b32 v110, v123, v121, s99
    v_perm_b32 v111, v127, v125, s99
    s_mov_b32 s72, s36
    s_mov_b32 s73, s37
    s_mov_b32 s74, 0x240000
    s_mov_b32 s75, 0x20000
    s_lshl_b32 s92, s86, 6
    s_add_u32 s92, s92, 2358144
    v_and_b32 v6, 7, v2
    v_lshlrev_b32 v6, 2, v6
    v_lshl_add_u32 v7, v3, 4, s92
    s_movk_i32 s93, -1152
    s_and_b32 s94, s87, 1
    s_lshl_b32 s94, s94, 6
    s_sub_u32 s94, 256, s94
    s_lshl_b32 s92, s87, 6
    v_add_u32 v11, s92, v1
    v_lshrrev_b32 v8, 5, v11
    v_and_b32 v9, 31, v11
    v_and_b32 v10, 3, v9
    v_lshlrev_b32 v10, 9, v10
    v_lshrrev_b32 v9, 2, v9
    v_lshl_add_u32 v10, v9, 4, v10
    v_lshrrev_b32 v9, 2, v8
    v_lshl_add_u32 v10, v9, 8, v10
    v_and_b32 v9, 3, v8
    v_lshl_add_u32 v10, v9, 2, v10
    v_lshlrev_b32 v11, 1, v11
    s_lshl_b32 s92, s87, 11
    v_lshl_add_u32 v9, v1, 4, s92
    s_lshl_b32 s92, s86, 9
    s_add_u32 s92, s92, 17088
    v_lshl_add_u32 v28, v6, 2, s92
    v_lshl_add_u32 v28, v3, 7, v28
    s_lshl_b32 s92, s94, 3
    v_add_u32 v31, s92, v28
    v_lshlrev_b32 v0, 2, v3
    ds_read_b32 v0, v0 offset:224
W_102:
    s_sleep 2
    ds_read_b32 v12, v6 offset:768
    s_sub_u32 s39, s39, 1
    s_cbranch_scc1 KS_ABORT
    s_waitcnt lgkmcnt(0)
    v_cmp_eq_u32 vcc, 0, v12
    s_cbranch_vccnz W_102
    s_setprio 2
    v_and_b32 v12, 0x7ff, v12
    v_mad_i32_i24 v7, v12, s93, v7
    v_lshrrev_b32 v2, 3, v0
    v_lshrrev_b32 v5, 6, v0
    v_lshrrev_b32 v6, 9, v0
W_103:
    ds_read_b32 v12, v4 offset:32
    s_sub_u32 s39, s39, 1
    s_cbranch_scc1 KS_ABORT
    s_waitcnt lgkmcnt(0)
    v_cmp_eq_u32 vcc, 0, v12
    s_cbranch_vccnz W_103
    ds_read_b128 v[12:15], v28 offset:0
    ds_read_b128 v[16:19], v28 offset:512
    ds_read_b128 v[20:23], v28 offset:1024
    ds_read_b128 v[24:27], v28 offset:1536
    ds_read_b128 v[28:31], v31
    s_waitcnt lgkmcnt(4)
    v_mfma_f32_16x16x32_bf16 v[112:115], v[12:15], v[32:35], 0
    v_xor_b32 v4, v0, v12
    v_bitop3_b32 v4, v4, v2, v13 bitop3:0xf6
    v_mfma_f32_16x16x32_bf16 v[116:119], v[12:15], v[36:39], 0
    v_bitop3_b32 v4, v4, v5, v14 bitop3:0xf6
    v_bitop3_b32 v4, v4, v6, v15 bitop3:0xf6
    v_mfma_f32_16x16x32_bf16 v[120:123], v[12:15], v[40:43], 0
    v_and_b32 v8, 0x70007, v4
    v_mfma_f32_16x16x32_bf16 v[124:127], v[12:15], v[44:47], 0
    s_waitcnt lgkmcnt(3)
    v_mfma_f32_16x16x32_bf16 v[112:115], v[16:19], v[48:51], v[112:115]
    v_xor_b32 v4, v0, v16
    v_bitop3_b32 v4, v4, v2, v17 bitop3:0xf6
    v_mfma_f32_16x16x32_bf16 v[116:119], v[16:19], v[52:55], v[116:119]
    v_bitop3_b32 v4, v4, v5, v18 bitop3:0xf6
    v_bitop3_b32 v4, v4, v6, v19 bitop3:0xf6
    v_mfma_f32_16x16x32_bf16 v[120:123], v[16:19], v[56:59], v[120:123]
    v_and_b32 v4, 0x70007, v4
    v_min_u32 v8, v8, v4
    v_mfma_f32_16x16x32_bf16 v[124:127], v[16:19], v[60:63], v[124:127]
    s_waitcnt lgkmcnt(2)
    v_mfma_f32_16x16x32_bf16 v[112:115], v[20:23], v[64:67], v[112:115]
    v_xor_b32 v4, v0, v20
    v_bitop3_b32 v4, v4, v2, v21 bitop3:0xf6
    v_mfma_f32_16x16x32_bf16 v[116:119], v[20:23], v[68:71], v[116:119]
    v_bitop3_b32 v4, v4, v5, v22 bitop3:0xf6
    v_bitop3_b32 v4, v4, v6, v23 bitop3:0xf6
    v_mfma_f32_16x16x32_bf16 v[120:123], v[20:23], v[72:75], v[120:123]
    v_and_b32 v4, 0x70007, v4
    v_min_u32 v8, v8, v4
    v_mfma_f32_16x16x32_bf16 v[124:127], v[20:23], v[76:79], v[124:127]
    s_waitcnt lgkmcnt(1)
    v_mfma_f32_16x16x32_bf16 v[112:115], v[24:27], v[80:83], v[112:115]
    v_xor_b32 v4, v0, v24
    v_bitop3_b32 v4, v4, v2, v25 bitop3:0xf6
    v_mfma_f32_16x16x32_bf16 v[116:119], v[24:27], v[84:87], v[116:119]
    v_bitop3_b32 v4, v4, v5, v26 bitop3:0xf6
    v_bitop3_b32 v4, v4, v6, v27 bitop3:0xf6
    v_mfma_f32_16x16x32_bf16 v[120:123], v[24:27], v[88:91], v[120:123]
    v_and_b32 v4, 0x70007, v4
    v_min_u32 v8, v8, v4
    v_mfma_f32_16x16x32_bf16 v[124:127], v[24:27], v[92:95], v[124:127]
    s_waitcnt lgkmcnt(0)
    v_xor_b32 v4, v0, v28
    v_bitop3_b32 v4, v4, v2, v29 bitop3:0xf6
    v_bitop3_b32 v4, v4, v5, v30 bitop3:0xf6
    v_bitop3_b32 v4, v4, v6, v31 bitop3:0xf6
    v_and_b32 v4, 0x70007, v4
    v_min_u32 v8, v8, v4
    v_cmp_eq_u32 vcc, 0, v8
    s_cbranch_vccnz KS_GR
    s_bitcmp1_b32 s87, 0
    s_cbranch_scc1 KS_G5
    v_mfma_f32_16x16x32_bf16 v[112:115], v[28:31], v[96:99], v[112:115]
    v_mfma_f32_16x16x32_bf16 v[116:119], v[28:31], v[100:103], v[116:119]
    v_mfma_f32_16x16x32_bf16 v[120:123], v[28:31], v[104:107], v[120:123]
    v_mfma_f32_16x16x32_bf16 v[124:127], v[28:31], v[108:111], v[124:127]
    s_branch KS_G5
KS_GR:
    s_add_u32 s76, s36, 0x840000
    s_addc_u32 s77, s37, 0
    s_mov_b32 s78, 0x3000
    s_mov_b32 s79, 0x20000
    v_lshlrev_b32 v4, 4, v1
    s_movk_i32 s92, 0x2000
    s_nop 3
KS_GR2:
    s_sleep 2
    buffer_load_dword v12, v4, s[76:79], s92 offen offset:0 sc1
    buffer_load_dword v13, v4, s[76:79], s92 offen offset:1024 sc1
    buffer_load_dword v14, v4, s[76:79], s92 offen offset:2048 sc1
    buffer_load_dword v15, v4, s[76:79], s92 offen offset:3072 sc1
    s_sub_u32 s39, s39, 1
    s_cbranch_scc1 KS_ABORT
    s_waitcnt vmcnt(0)
    v_max3_u32 v12, v12, v13, v14
    v_max_u32 v12, v12, v15
    v_cmp_eq_u32 vcc, -1, v12
    s_cbranch_vccnz KS_GR2
    buffer_load_dwordx4 v[12:15], v7, s[72:75], 0 offen offset:0 sc1
    buffer_load_dwordx4 v[16:19], v7, s[72:75], 0 offen offset:64 sc1
    buffer_load_dwordx4 v[20:23], v7, s[72:75], 0 offen offset:128 sc1
    buffer_load_dwordx4 v[24:27], v7, s[72:75], 0 offen offset:192 sc1
    buffer_load_dwordx4 v[28:31], v7, s[72:75], s94 offen sc1
    s_sub_u32 s39, s39, 1
    s_cbranch_scc1 KS_ABORT
    s_waitcnt vmcnt(4)
    v_mfma_f32_16x16x32_bf16 v[112:115], v[12:15], v[32:35], 0
    v_mfma_f32_16x16x32_bf16 v[116:119], v[12:15], v[36:39], 0
    v_mfma_f32_16x16x32_bf16 v[120:123], v[12:15], v[40:43], 0
    v_mfma_f32_16x16x32_bf16 v[124:127], v[12:15], v[44:47], 0
    s_waitcnt vmcnt(3)
    v_mfma_f32_16x16x32_bf16 v[112:115], v[16:19], v[48:51], v[112:115]
    v_mfma_f32_16x16x32_bf16 v[116:119], v[16:19], v[52:55], v[116:119]
    v_mfma_f32_16x16x32_bf16 v[120:123], v[16:19], v[56:59], v[120:123]
    v_mfma_f32_16x16x32_bf16 v[124:127], v[16:19], v[60:63], v[124:127]
    s_waitcnt vmcnt(2)
    v_mfma_f32_16x16x32_bf16 v[112:115], v[20:23], v[64:67], v[112:115]
    v_mfma_f32_16x16x32_bf16 v[116:119], v[20:23], v[68:71], v[116:119]
    v_mfma_f32_16x16x32_bf16 v[120:123], v[20:23], v[72:75], v[120:123]
    v_mfma_f32_16x16x32_bf16 v[124:127], v[20:23], v[76:79], v[124:127]
    s_waitcnt vmcnt(1)
    v_mfma_f32_16x16x32_bf16 v[112:115], v[24:27], v[80:83], v[112:115]
    v_mfma_f32_16x16x32_bf16 v[116:119], v[24:27], v[84:87], v[116:119]
    v_mfma_f32_16x16x32_bf16 v[120:123], v[24:27], v[88:91], v[120:123]
    v_mfma_f32_16x16x32_bf16 v[124:127], v[24:27], v[92:95], v[124:127]
    s_waitcnt vmcnt(0)
    s_bitcmp1_b32 s87, 0
    s_cbranch_scc1 KS_G5
    v_mfma_f32_16x16x32_bf16 v[112:115], v[28:31], v[96:99], v[112:115]
    v_mfma_f32_16x16x32_bf16 v[116:119], v[28:31], v[100:103], v[116:119]
    v_mfma_f32_16x16x32_bf16 v[120:123], v[28:31], v[104:107], v[120:123]
    v_mfma_f32_16x16x32_bf16 v[124:127], v[28:31], v[108:111], v[124:127]
KS_G5:
    s_mov_b32 exec_lo, -1
    s_mov_b32 exec_hi, 0
    s_nop 5
    ds_write_b128 v9, v[112:115] offset:26368
    ds_write_b128 v9, v[116:119] offset:26880
    ds_write_b128 v9, v[120:123] offset:27392
    ds_write_b128 v9, v[124:127] offset:27904
    s_mov_b64 exec, -1
    s_waitcnt lgkmcnt(0)
    s_barrier
    ds_read_b32 v32, v10 offset:26368
    ds_read_b32 v33, v10 offset:26496
    ds_read_b32 v34, v10 offset:28416
    ds_read_b32 v35, v10 offset:28544
    ds_read_b32 v36, v10 offset:30464
    ds_read_b32 v37, v10 offset:30592
    ds_read_b32 v38, v10 offset:32512
    ds_read_b32 v39, v10 offset:32640
    s_waitcnt lgkmcnt(4)
    v_pk_add_f32 v[32:33], v[32:33], v[34:35]
    s_waitcnt lgkmcnt(0)
    v_pk_add_f32 v[36:37], v[36:37], v[38:39]
    v_pk_add_f32 v[32:33], v[32:33], v[36:37]
    v_cvt_pk_bf16_f32 v32, 0, v32
    v_cvt_pk_bf16_f32 v33, 0, v33
    v_mul_f32 v34, 0xbfb8aa3b, v32
    v_exp_f32 v34, v34
    s_nop 0
    v_add_f32 v34, 1.0, v34
    v_rcp_f32 v34, v34
    s_nop 0
    v_mul_f32 v34, v32, v34
    v_cvt_pk_bf16_f32 v34, 0, v34
    v_mul_f32 v34, v34, v33
    v_cvt_pk_bf16_f32 v34, v34, v34
    ds_write_b16 v11, v34 offset:1024
    s_waitcnt lgkmcnt(0)
    s_barrier
    s_branch KS_PEND
KS_PEND:
KS_ABORT:
KS_END:
    s_endpgm
.section .rodata,"a"
.p2align 6
.amdhsa_kernel sequential_preLN__ssm_conv_s4__moe_arch_mod__prompt_kernel
  .amdhsa_next_free_vgpr 128
  .amdhsa_next_free_sgpr 100
  .amdhsa_accum_offset 128
  .amdhsa_group_segment_fixed_size 0
  .amdhsa_kernarg_size 136
  .amdhsa_user_sgpr_count 2
  .amdhsa_user_sgpr_kernarg_segment_ptr 1
  .amdhsa_system_sgpr_workgroup_id_x 1
  .amdhsa_float_denorm_mode_32 3
.end_amdhsa_kernel
```

```asm
; @launch grid=(256,1,1) block=(1024,1,1) lds=154240
.amdgcn_target "amdgcn-amd-amdhsa--gfx950"
.text
.globl sequential_preLN__ssm_conv_s4__moe_arch_mod__prompt_kernel
.p2align 8
.type sequential_preLN__ssm_conv_s4__moe_arch_mod__prompt_kernel,@function
sequential_preLN__ssm_conv_s4__moe_arch_mod__prompt_kernel:
    s_cmp_ge_u32 s2, 256
    s_cbranch_scc1 KS_END
    s_load_dwordx16 s[4:19], s[0:1], 0
    s_load_dwordx16 s[20:35], s[0:1], 64
    s_load_dwordx2 s[36:37], s[0:1], 128
    v_readfirstlane_b32 s38, v0
    s_lshr_b32 s38, s38, 6
    s_and_b32 s40, s2, 7
    s_lshr_b32 s41, s2, 3
    s_cmp_lg_u32 s38, 0
    s_cbranch_scc1 KS_CPE
    s_getpc_b64 s[42:43]
KS_PC:
    s_and_b32 s92, s41, 7
    s_mul_i32 s92, s92, 4608
    v_and_b32 v126, 63, v0
    v_lshl_add_u32 v126, v126, 7, s92
    v_min_u32 v126, KS_END-KS_PC, v126
    global_load_dword v127, v126, s[42:43]
KS_CPE:
    s_add_u32 s92, s38, 8
    s_sub_u32 s93, s38, 4
    s_cmp_lt_u32 s38, 8
    s_cselect_b32 s92, s92, s93
    s_cmp_lt_u32 s38, 4
    s_cselect_b32 s38, s38, s92
    v_and_b32 v1, 63, v0
    v_and_b32 v2, 15, v1
    v_lshrrev_b32 v3, 4, v1
    v_mov_b32 v4, 0
    v_mov_b32 v5, 1
    s_mov_b32 s39, 524288
    s_mov_b32 s84, 0x01010101
    s_lshl_b32 s90, s40, 5
    s_add_u32 s90, s90, s41
    s_mul_i32 s89, s40, 18
    s_add_u32 s89, s89, s41
    s_cmp_lt_u32 s38, 4
    s_cbranch_scc1 KS_L
    s_cmp_ge_u32 s38, 12
    s_cbranch_scc1 KS_X
    s_setprio 2
    s_lshr_b32 s87, s38, 2
    s_sub_u32 s87, s87, 1
    s_mul_i32 s86, s87, 3
    s_xor_b32 s86, s86, s38
    s_and_b32 s86, s86, 3
    s_lshl_b32 s88, s90, 1
    s_add_u32 s88, s88, s87
    s_lshl_b32 s92, s86, 11
    s_add_u32 s92, s92, 146048
    v_lshl_add_u32 v28, v1, 3, s92
    s_cmp_eq_u32 s86, 3
    s_cbranch_scc1 PX_1
    v_lshlrev_b32 v26, 3, v2
    v_mov_b32 v21, 0x80
    s_cmp_eq_u32 s86, 1
    s_cbranch_scc1 PX_2
    s_cmp_eq_u32 s86, 2
    s_cbranch_scc1 PX_3
    v_lshl_add_u32 v26, v3, 1, v26
    v_mov_b32 v22, 1
    s_branch PX_4
PX_2:
    v_cmp_gt_u32 vcc, 2, v3
    v_lshl_add_u32 v20, v3, 2, v26
    v_add_u32 v20, 256, v20
    v_lshl_add_u32 v26, v3, 8, v26
    v_cndmask_b32 v26, v26, v20, vcc
    v_cndmask_b32 v22, v21, 2, vcc
    v_cndmask_b32 v21, 4, v21, vcc
    s_branch PX_4
PX_3:
    v_lshl_add_u32 v26, v3, 9, v26
    v_add_u32 v26, 0x400, v26
    v_mov_b32 v22, 0x100
PX_4:
    v_mad_u32_u24 v26, v22, s87, v26
    v_add_u32 v27, v26, v21
    s_movk_i32 s96, 31232
    s_movk_i32 s97, -19072
    s_lshl_b32 s95, s87, 9
    v_cvt_f32_u32 v20, v26
    v_max_u32 v22, 0x800, v26
    v_cvt_f32_u32 v21, v27
    v_max_u32 v23, 0x800, v27
    v_cmp_gt_u32 vcc, 0x80, v26
    v_lshrrev_b32 v24, 16, v20
    v_add3_u32 v24, v24, v22, s97
    v_cndmask_b32 v24, v24, v26, vcc
    v_cmp_gt_u32 vcc, 0x80, v27
    v_lshrrev_b32 v25, 16, v21
    v_add3_u32 v25, v25, v23, s97
    v_cndmask_b32 v25, v25, v27, vcc
    v_min_u32 v24, 642, v24
    v_lshl_add_u32 v24, v24, 1, s96
    v_min_u32 v25, 642, v25
    v_lshl_add_u32 v25, v25, 1, s96
    v_add_u32 v29, s95, v28
    v_lshl_or_b32 v24, v25, 16, v24
    v_lshl_or_b32 v25, v27, 16, v26
    ds_write_b64 v29, v[24:25]
PX_1:
KS_GRP:
    s_lshl_b32 s92, s88, 8
    v_lshl_add_u32 v20, v1, 2, s92
    s_lshl_b32 s92, s88, 1
    v_mov_b32 v21, s92
    s_mul_i32 s85, s87, 36672
    s_add_u32 s85, s85, 35840
    s_waitcnt lgkmcnt(0)
    global_load_ushort v46, v21, s[18:19]
    global_load_dword v40, v20, s[6:7]
    global_load_dword v41, v20, s[8:9]
    global_load_dword v42, v20, s[10:11]
    global_load_dword v43, v20, s[12:13]
    global_load_dword v44, v20, s[14:15]
    global_load_dword v45, v20, s[16:17]
    global_load_ushort v107, v21, s[20:21]
    s_barrier
    s_movk_i32 s96, 31232
    s_cmp_eq_u32 s87, 2
    s_cbranch_scc1 PREE_7
    v_mov_b32 v32, 641
    s_cmp_eq_u32 s87, 1
    s_cbranch_scc1 PREB_5
    v_mov_b32 v33, 32514
    s_cmp_eq_u32 s86, 1
    s_cbranch_scc1 PRE_9
    s_cmp_eq_u32 s86, 2
    s_cbranch_scc1 PRE_10
    s_cmp_eq_u32 s86, 3
    s_cbranch_scc1 PRE_11
    v_lshlrev_b32 v23, 1, v1
    v_sub_u32 v30, 93, v23
    v_cmp_lt_u32 vcc, 61, v30
    v_lshlrev_b32 v31, 2, v30
    v_add_u32 v31, 32010, v31
    v_cndmask_b32 v24, v31, v33, vcc
    v_sub_u32 v30, 92, v23
    v_cmp_lt_u32 vcc, 61, v30
    v_lshlrev_b32 v31, 2, v30
    v_add_u32 v31, 32010, v31
    v_cndmask_b32 v25, v31, v33, vcc
    v_sub_u32 v30, 94, v23
    v_cmp_lt_u32 vcc, 62, v30
    v_lshlrev_b32 v31, 2, v30
    v_add_u32 v31, 32008, v31
    v_cndmask_b32 v26, v31, v33, vcc
    v_sub_u32 v30, 93, v23
    v_cmp_lt_u32 vcc, 62, v30
    v_lshlrev_b32 v31, 2, v30
    v_add_u32 v31, 32008, v31
    v_cndmask_b32 v27, v31, v33, vcc
    s_branch PREW_6
PRE_9:
    v_min_u32 v23, 47, v1
    v_lshlrev_b32 v23, 1, v23
    v_sub_u32 v30, 64, v23
    v_cmp_lt_u32 vcc, 63, v30
    v_lshlrev_b32 v31, 2, v30
    v_add_u32 v31, 32258, v31
    v_cndmask_b32 v24, v31, v33, vcc
    v_sub_u32 v30, 63, v23
    v_cmp_lt_u32 vcc, 63, v30
    v_lshlrev_b32 v31, 2, v30
    v_add_u32 v31, 32258, v31
    v_cndmask_b32 v25, v31, v33, vcc
    v_sub_u32 v30, 62, v23
    v_cmp_lt_u32 vcc, 63, v30
    v_lshlrev_b32 v31, 2, v30
    v_add_u32 v31, 32258, v31
    v_cndmask_b32 v27, v31, v33, vcc
    v_mov_b32 v26, v25
    s_branch PREW_6
PRE_10:
    v_min_u32 v23, 47, v1
    v_lshlrev_b32 v23, 1, v23
    v_sub_u32 v30, 64, v23
    v_cmp_lt_u32 vcc, 63, v30
    v_lshlrev_b32 v31, 2, v30
    v_add_u32 v31, 32260, v31
    v_cndmask_b32 v24, v31, v33, vcc
    v_sub_u32 v30, 63, v23
    v_cmp_lt_u32 vcc, 63, v30
    v_lshlrev_b32 v31, 2, v30
    v_add_u32 v31, 32260, v31
    v_cndmask_b32 v25, v31, v33, vcc
    v_sub_u32 v30, 62, v23
    v_cmp_lt_u32 vcc, 63, v30
    v_lshlrev_b32 v31, 2, v30
    v_add_u32 v31, 32260, v31
    v_cndmask_b32 v27, v31, v33, vcc
    v_mov_b32 v26, v25
    s_branch PREW_6
PRE_11:
    v_cmp_gt_u32 vcc, 9, v1
    v_add_u32 v23, 0x100, v1
    v_mov_b32 v33, 0x200
    v_cndmask_b32 v23, v23, v1, vcc
    v_lshlrev_b32 v23, 1, v23
    v_sub_u32 v30, 544, v23
    v_cvt_f32_i32 v31, v30
    v_cmp_gt_u32 vcc, 0x100, v30
    v_cvt_pk_bf16_f32 v31, v31, v31
    v_and_b32 v31, 0xffff, v31
    v_subrev_u32 v31, 0x4280, v31
    v_cndmask_b32 v31, v31, v30, vcc
    v_cmp_lt_u32 vcc, 0x20d, v30
    v_or_b32 v30, 1, v23
    s_nop 0
    v_cndmask_b32 v31, v31, v32, vcc
    v_cmp_eq_u32 vcc, 0x25d, v30
    s_nop 1
    v_cndmask_b32 v31, v31, v33, vcc
    v_lshl_add_u32 v24, v31, 1, s96
    v_add_u32 v23, 1, v23
    v_sub_u32 v30, 544, v23
    v_cvt_f32_i32 v31, v30
    v_cmp_gt_u32 vcc, 0x100, v30
    v_cvt_pk_bf16_f32 v31, v31, v31
    v_and_b32 v31, 0xffff, v31
    v_subrev_u32 v31, 0x4280, v31
    v_cndmask_b32 v31, v31, v30, vcc
    v_cmp_lt_u32 vcc, 0x20d, v30
    v_or_b32 v30, 1, v23
    s_nop 0
    v_cndmask_b32 v31, v31, v32, vcc
    v_cmp_eq_u32 vcc, 0x25d, v30
    s_nop 1
    v_cndmask_b32 v31, v31, v33, vcc
    v_lshl_add_u32 v25, v31, 1, s96
    v_add_u32 v23, 1, v23
    v_sub_u32 v30, 544, v23
    v_cvt_f32_i32 v31, v30
    v_cmp_gt_u32 vcc, 0x100, v30
    v_cvt_pk_bf16_f32 v31, v31, v31
    v_and_b32 v31, 0xffff, v31
    v_subrev_u32 v31, 0x4280, v31
    v_cndmask_b32 v31, v31, v30, vcc
    v_cmp_lt_u32 vcc, 0x20d, v30
    v_or_b32 v30, 1, v23
    s_nop 0
    v_cndmask_b32 v31, v31, v32, vcc
    v_cmp_eq_u32 vcc, 0x25d, v30
    s_nop 1
    v_cndmask_b32 v31, v31, v33, vcc
    v_lshl_add_u32 v27, v31, 1, s96
    v_mov_b32 v26, v25
    s_branch PREW_6
PREB_5:
    s_lshl_b32 s93, s86, 7
    s_add_u32 s93, s93, 18
    v_lshl_add_u32 v23, v1, 1, s93
    v_sub_u32 v30, 544, v23
    v_cvt_f32_i32 v31, v30
    v_cmp_gt_u32 vcc, 0x100, v30
    v_cvt_pk_bf16_f32 v31, v31, v31
    v_and_b32 v31, 0xffff, v31
    v_subrev_u32 v31, 0x4280, v31
    v_cndmask_b32 v31, v31, v30, vcc
    v_cmp_lt_u32 vcc, 0x20d, v30
    s_nop 1
    v_cndmask_b32 v31, v31, v32, vcc
    v_lshl_add_u32 v24, v31, 1, s96
    v_add_u32 v23, 1, v23
    v_sub_u32 v30, 544, v23
    v_cvt_f32_i32 v31, v30
    v_cmp_gt_u32 vcc, 0x100, v30
    v_cvt_pk_bf16_f32 v31, v31, v31
    v_and_b32 v31, 0xffff, v31
    v_subrev_u32 v31, 0x4280, v31
    v_cndmask_b32 v31, v31, v30, vcc
    v_cmp_lt_u32 vcc, 0x20d, v30
    s_nop 1
    v_cndmask_b32 v31, v31, v32, vcc
    v_lshl_add_u32 v25, v31, 1, s96
    v_add_u32 v23, 1, v23
    v_sub_u32 v30, 544, v23
    v_cvt_f32_i32 v31, v30
    v_cmp_gt_u32 vcc, 0x100, v30
    v_cvt_pk_bf16_f32 v31, v31, v31
    v_and_b32 v31, 0xffff, v31
    v_subrev_u32 v31, 0x4280, v31
    v_cndmask_b32 v31, v31, v30, vcc
    v_cmp_lt_u32 vcc, 0x20d, v30
    s_nop 1
    v_cndmask_b32 v31, v31, v32, vcc
    v_lshl_add_u32 v26, v31, 1, s96
    s_sub_u32 s93, s86, 1
    s_cmp_lt_u32 s93, 2
    s_cselect_b32 s94, 47, 63
    s_mul_i32 s93, s93, 384
    s_add_u32 s93, s93, 35664
    s_cmp_eq_u32 s86, 0
    s_cselect_b32 s93, 35152, s93
    s_cmp_eq_u32 s86, 3
    s_cselect_b32 s93, 32528, s93
    s_cselect_b32 s95, 0x100, 0
    v_cmp_gt_u32 vcc, 9, v1
    v_min_u32 v23, s94, v1
    v_add_u32 v30, s95, v23
    v_cndmask_b32 v23, v30, v23, vcc
    v_lshl_add_u32 v27, v23, 2, s93
    v_lshl_or_b32 v24, v25, 16, v24
    v_lshl_or_b32 v25, v27, 16, v26
    ds_write_b64 v28, v[24:25] offset:1024
    v_mov_b32 v24, s86
    ds_write_b8 v24, v5 offset:212
    s_branch PREE_7
PREW_6:
    v_lshl_or_b32 v24, v25, 16, v24
    v_lshl_or_b32 v25, v27, 16, v26
    ds_write_b64 v28, v[24:25] offset:1536
    v_mov_b32 v24, s86
    ds_write_b8 v24, v5 offset:208
PREE_7:
    s_mul_i32 s93, s86, 8704
    s_min_u32 s94, s93, 22304
    s_add_u32 s94, s94, s85
    s_lshl_b32 s92, s87, 4
    v_mov_b32 v14, s92
    v_add_u32 v15, s86, v14
    v_lshl_add_u32 v72, v1, 3, s94
    v_add_u32 v73, 2176, v72
    v_add_u32 v74, 4352, v72
    v_add_u32 v75, 6528, v72
    v_mul_u32_u24 v126, 544, v2
    v_lshl_add_u32 v126, v3, 4, v126
    v_add_u32 v126, s85, v126
    v_add_u32 v127, s93, v126
    v_lshlrev_b32 v20, 3, v3
    v_sub_u32 v20, v20, v2
    v_add_u32 v21, 16, v20
    v_lshrrev_b32 v21, 1, v21
    v_and_b32 v22, 1, v2
    s_add_u32 s92, s85, 32528
    v_lshl_add_u32 v21, v21, 2, s92
    s_movk_i32 s92, 1344
    s_movk_i32 s94, 192
    v_mad_u32_u24 v6, v22, s92, v21
    v_add_u32 v7, 640, v6
    v_mad_u32_u24 v23, v22, s94, v21
    v_add_u32 v13, 3136, v23
    v_lshlrev_b32 v23, 2, v3
    v_sub_u32 v23, v23, v2
    s_add_u32 s92, s85, 35212
    v_lshl_add_u32 v11, v23, 2, s92
    s_mul_i32 s94, s87, 4672
    s_add_u32 s94, s94, 3072
    v_lshl_add_u32 v23, v2, 5, s94
    v_lshl_add_u32 v8, v3, 4, v23
    v_bfe_u32 v20, v1, 2, 2
    v_and_b32 v21, 3, v1
    v_lshl_add_u32 v20, v3, 3, v20
    v_lshlrev_b32 v105, 2, v21
    v_lshl_add_u32 v21, v21, 3, s85
    v_lshl_add_u32 v9, v20, 4, v21
    v_lshl_add_u32 v10, v20, 5, v21
    v_lshlrev_b32 v12, 4, v1
    s_add_u32 s64, s36, 0x600000
    s_addc_u32 s65, s37, 0
    s_mov_b32 s66, 0x240000
    s_mov_b32 s67, 0x20000
    s_mov_b32 s10, 0x8080
    s_lshl_b32 s92, s86, 19
    s_lshl_b32 s93, s90, 6
    s_add_u32 s92, s92, s93
    s_lshl_b32 s93, s86, 16
    s_lshl_b32 s95, s88, 6
    s_add_u32 s93, s93, s95
    s_add_u32 s93, s93, 2064384
    s_cmp_eq_u32 s87, 2
    s_cselect_b32 s6, s93, s92
    s_cselect_b32 s8, 0x1080, s10
    s_cselect_b32 s92, 1, 3
    s_and_b32 s92, s92, s86
    s_lshl_b32 s92, s92, 11
    s_xor_b32 s6, s6, s92
    s_and_b32 s10, s6, 0x7c0
    s_xor_b32 s6, s6, s10
    s_xor_b32 s7, s6, 0x6000
    s_and_b32 s9, s87, 1
    s_lshl_b32 s9, s9, 4
    s_mov_b32 s12, 0x55555555
    s_mov_b32 s13, 0x55555555
    s_lshl_b32 s92, s86, 8
    s_add_u32 s92, s92, s85
    s_add_u32 s92, s92, 36
    v_lshl_add_u32 v124, v1, 2, s92
    s_movk_i32 s92, 192
    s_cmp_eq_u32 s86, 0
    s_cselect_b32 s92, 256, s92
    s_cmp_eq_u32 s86, 3
    s_cselect_b32 s92, 1344, s92
    v_mov_b32 v20, s85
    ds_write_b16 v20, v4 offset:32514
    s_mov_b32 s18, s92
    v_mov_b32 v125, v28
W_12:
    ds_read_b64 v[18:19], v4 offset:208
    s_sub_u32 s39, s39, 1
    s_cbranch_scc1 KS_ABORT
    s_waitcnt lgkmcnt(0)
    v_and_b32 v18, v18, v19
    v_cmp_ne_u32 vcc, s84, v18
    s_cbranch_vccnz W_12
    ds_read2st64_b64 v[28:31], v125 offset0:0 offset1:1
    ds_read2st64_b64 v[32:35], v125 offset0:2 offset1:3
    s_waitcnt lgkmcnt(0)
    v_add_u32_sdwa v108, s85, v28 dst_sel:DWORD dst_unused:UNUSED_PAD src0_sel:DWORD src1_sel:WORD_0
    v_add_u32_sdwa v109, s85, v28 dst_sel:DWORD dst_unused:UNUSED_PAD src0_sel:DWORD src1_sel:WORD_1
    v_cvt_f32_u32_sdwa v110, v29 dst_sel:DWORD dst_unused:UNUSED_PAD src0_sel:WORD_0
    v_cvt_f32_u32_sdwa v111, v29 dst_sel:DWORD dst_unused:UNUSED_PAD src0_sel:WORD_1
    v_add_u32_sdwa v112, s85, v30 dst_sel:DWORD dst_unused:UNUSED_PAD src0_sel:DWORD src1_sel:WORD_0
    v_add_u32_sdwa v113, s85, v30 dst_sel:DWORD dst_unused:UNUSED_PAD src0_sel:DWORD src1_sel:WORD_1
    v_cvt_f32_u32_sdwa v114, v31 dst_sel:DWORD dst_unused:UNUSED_PAD src0_sel:WORD_0
    v_cvt_f32_u32_sdwa v115, v31 dst_sel:DWORD dst_unused:UNUSED_PAD src0_sel:WORD_1
    v_add_u32_sdwa v116, s85, v32 dst_sel:DWORD dst_unused:UNUSED_PAD src0_sel:DWORD src1_sel:WORD_0
    v_add_u32_sdwa v117, s85, v32 dst_sel:DWORD dst_unused:UNUSED_PAD src0_sel:DWORD src1_sel:WORD_1
    v_add_u32_sdwa v118, s85, v33 dst_sel:DWORD dst_unused:UNUSED_PAD src0_sel:DWORD src1_sel:WORD_0
    v_add_u32_sdwa v119, s85, v33 dst_sel:DWORD dst_unused:UNUSED_PAD src0_sel:DWORD src1_sel:WORD_1
    v_add_u32_sdwa v120, s85, v34 dst_sel:DWORD dst_unused:UNUSED_PAD src0_sel:DWORD src1_sel:WORD_0
    v_add_u32_sdwa v121, s85, v34 dst_sel:DWORD dst_unused:UNUSED_PAD src0_sel:DWORD src1_sel:WORD_1
    v_add_u32_sdwa v122, s85, v35 dst_sel:DWORD dst_unused:UNUSED_PAD src0_sel:DWORD src1_sel:WORD_0
    v_add_u32_sdwa v123, s85, v35 dst_sel:DWORD dst_unused:UNUSED_PAD src0_sel:DWORD src1_sel:WORD_1
    v_add_u32 v125, s18, v119
    s_lshl_b32 s92, s87, 5
    s_add_u32 s92, s92, s41
    s_cmp_ge_u32 s92, 88
    s_cbranch_scc1 KC_RECV
    s_mov_b32 s92, 0x3fb8aa3b
    s_mov_b32 s93, 0x32a57060
    s_mov_b32 s94, 0x3e22f983
    s_mov_b32 s95, 0x31dc9c88
    s_waitcnt vmcnt(7)
    v_lshlrev_b32 v16, 16, v46
    v_mul_f32 v17, s92, v16
    v_fma_f32 v19, v16, s92, -v17
    v_fmac_f32 v19, s93, v16
    v_exp_f32 v17, v17
    v_mul_f32 v19, 0x3f317218, v19
    v_fmac_f32 v17, v17, v19
    v_cvt_pk_bf16_f32 v16, 0, v17
    s_waitcnt vmcnt(5)
    ds_write_b32 v4, v5 offset:36
    v_lshlrev_b32 v20, 16, v40
    v_and_b32 v21, 0xffff0000, v40
    v_lshlrev_b32 v22, 16, v41
    v_and_b32 v23, 0xffff0000, v41
    v_pk_mul_f32 v[20:21], v[20:21], v[16:17] op_sel_hi:[1,0]
    v_pk_mul_f32 v[22:23], v[22:23], v[16:17] op_sel_hi:[1,0]
    v_max_f32 v36, v20, v21
    v_pk_mul_f32 v[68:69], v[22:23], s[94:95] op_sel_hi:[1,0]
    v_pk_fma_f32 v[70:71], v[22:23], s[94:95], v[68:69] op_sel_hi:[1,0,1] neg_lo:[0,0,1] neg_hi:[0,0,1]
    v_pk_fma_f32 v[70:71], v[22:23], s[94:95], v[70:71] op_sel:[0,1,0]
    s_cmp_eq_u32 s86, 3
    s_cbranch_scc1 SK_14
    s_waitcnt vmcnt(1)
    v_lshlrev_b32 v24, 16, v42
    v_and_b32 v25, 0xffff0000, v42
    v_lshlrev_b32 v26, 16, v43
    v_and_b32 v27, 0xffff0000, v43
    v_lshlrev_b32 v28, 16, v44
    v_and_b32 v29, 0xffff0000, v44
    v_lshlrev_b32 v30, 16, v45
    v_and_b32 v31, 0xffff0000, v45
    v_pk_mul_f32 v[24:25], v[24:25], v[16:17] op_sel_hi:[1,0]
    v_pk_mul_f32 v[26:27], v[26:27], v[16:17] op_sel_hi:[1,0]
    v_pk_mul_f32 v[90:91], v[30:31], v[26:27]
    v_pk_mul_f32 v[92:93], v[30:31], v[24:25]
    v_pk_fma_f32 v[34:35], v[28:29], v[26:27], v[92:93]
    v_pk_fma_f32 v[32:33], v[28:29], v[24:25], v[90:91] neg_lo:[0,0,1] neg_hi:[0,0,1]
    v_max3_f32 v37, abs(v34), abs(v35), abs(v32)
    v_max_f32 v37, v37, abs(v33)
SK_14:
    s_waitcnt vmcnt(0)
    s_nop 0
    v_permlane32_swap_b32 v36, v37
    v_max_f32 v36, v36, v37
    s_nop 1
    v_max_f32_dpp v36, v36, v36 row_ror:8 row_mask:0xf bank_mask:0xf
    s_nop 1
    v_max_f32_dpp v36, v36, v36 row_ror:4 row_mask:0xf bank_mask:0xf
    s_nop 1
    v_max_f32_dpp v36, v36, v36 row_ror:2 row_mask:0xf bank_mask:0xf
    s_nop 1
    v_max_f32_dpp v36, v36, v36 row_ror:1 row_mask:0xf bank_mask:0xf
    v_mov_b32 v38, v36
    s_nop 1
    v_permlane16_swap_b32 v36, v38
    v_max_f32 v36, v36, v38
    s_nop 0
    v_readlane_b32 s14, v36, 0
    v_readlane_b32 s15, v36, 32
    s_add_u32 s15, s15, 0x7fffff
    s_lshr_b32 s15, s15, 23
    s_max_u32 s15, s15, 24
    s_sub_u32 s16, 269, s15
    s_lshl_b32 s16, s16, 23
    v_subrev_f32 v20, s14, v20
    v_subrev_f32 v21, s14, v21
    v_mul_f32 v20, 0x3fb8aa3b, v20
    v_mul_f32 v21, 0x3fb8aa3b, v21
    s_cmp_eq_u32 s86, 3
    s_cbranch_scc1 JOB_18
    s_cmp_eq_u32 s86, 1
    s_cbranch_scc1 JOB_16
    s_cmp_eq_u32 s86, 2
    s_cbranch_scc1 JOB_17
    v_mul_f32 v91, 0x43000000, v68
    v_mul_f32 v90, 0x43000000, v20
    v_mul_f32 v95, 0x43000000, v69
    v_mul_f32 v94, 0x43000000, v21
    v_fract_f32 v91, v91
    v_fract_f32 v95, v95
    v_fmac_f32 v91, 0x43000000, v70
    v_fmac_f32 v95, 0x43000000, v71
    v_exp_f32 v90, v90
    v_cos_f32 v92, v91
    v_sin_f32 v91, v91
    v_exp_f32 v94, v94
    v_cos_f32 v96, v95
    v_sin_f32 v95, v95
    v_mul_f32 v44, v90, v92
    v_mul_f32 v46, v90, v91
    v_mul_f32 v45, v94, v96
    v_mul_f32 v47, v94, v95
    v_pk_mul_f32 v[32:33], v[32:33], s[16:17] op_sel_hi:[1,0]
    v_pk_mul_f32 v[34:35], v[34:35], s[16:17] op_sel_hi:[1,0]
    v_fract_f32 v91, v68
    v_fract_f32 v95, v69
    v_fmac_f32 v91, 1.0, v70
    v_fmac_f32 v95, 1.0, v71
    v_exp_f32 v90, v20
    v_cos_f32 v92, v91
    v_sin_f32 v91, v91
    v_exp_f32 v94, v21
    v_cos_f32 v96, v95
    v_sin_f32 v95, v95
    v_mul_f32 v40, v90, v92
    v_mul_f32 v42, v90, v91
    v_mul_f32 v41, v94, v96
    v_mul_f32 v43, v94, v95
    v_pk_mul_f32 v[90:91], v[34:35], v[46:47]
    v_pk_mul_f32 v[94:95], v[34:35], v[42:43]
    v_pk_mul_f32 v[92:93], v[34:35], v[44:45]
    v_pk_mul_f32 v[96:97], v[34:35], v[40:41]
    v_pk_fma_f32 v[62:63], v[32:33], v[46:47], v[92:93]
    v_pk_fma_f32 v[54:55], v[32:33], v[42:43], v[96:97]
    v_pk_fma_f32 v[60:61], v[32:33], v[44:45], v[90:91] neg_lo:[0,0,1] neg_hi:[0,0,1]
    v_pk_fma_f32 v[52:53], v[32:33], v[40:41], v[94:95] neg_lo:[0,0,1] neg_hi:[0,0,1]
    v_cvt_pk_f16_f32 v98, v32, v34
    v_cvt_pk_f16_f32 v99, v33, v35
    v_cvt_pk_f16_f32 v100, v60, v62
    v_cvt_pk_f16_f32 v101, v61, v63
    ds_write2_b64 v72, v[98:99], v[100:101] offset0:0 offset1:68
    v_pk_mul_f32 v[90:91], v[54:55], v[46:47]
    v_pk_mul_f32 v[94:95], v[54:55], v[42:43]
    v_pk_mul_f32 v[92:93], v[54:55], v[44:45]
    v_pk_mul_f32 v[96:97], v[54:55], v[40:41]
    v_pk_fma_f32 v[62:63], v[52:53], v[46:47], v[92:93]
    v_pk_fma_f32 v[58:59], v[52:53], v[42:43], v[96:97]
    v_pk_fma_f32 v[60:61], v[52:53], v[44:45], v[90:91] neg_lo:[0,0,1] neg_hi:[0,0,1]
    v_pk_fma_f32 v[56:57], v[52:53], v[40:41], v[94:95] neg_lo:[0,0,1] neg_hi:[0,0,1]
    v_cvt_pk_f16_f32 v76, v52, v54
    v_cvt_pk_f16_f32 v77, v53, v55
    v_cvt_pk_f16_f32 v78, v60, v62
    v_cvt_pk_f16_f32 v79, v61, v63
    ds_write2_b64 v72, v[76:77], v[78:79] offset0:136 offset1:204
    v_pk_mul_f32 v[90:91], v[58:59], v[46:47]
    v_pk_mul_f32 v[94:95], v[58:59], v[42:43]
    v_pk_mul_f32 v[92:93], v[58:59], v[44:45]
    v_pk_mul_f32 v[96:97], v[58:59], v[40:41]
    v_pk_fma_f32 v[62:63], v[56:57], v[46:47], v[92:93]
    v_pk_fma_f32 v[54:55], v[56:57], v[42:43], v[96:97]
    v_pk_fma_f32 v[60:61], v[56:57], v[44:45], v[90:91] neg_lo:[0,0,1] neg_hi:[0,0,1]
    v_pk_fma_f32 v[52:53], v[56:57], v[40:41], v[94:95] neg_lo:[0,0,1] neg_hi:[0,0,1]
    v_cvt_pk_f16_f32 v98, v56, v58
    v_cvt_pk_f16_f32 v99, v57, v59
    v_cvt_pk_f16_f32 v100, v60, v62
    v_cvt_pk_f16_f32 v101, v61, v63
    ds_write2_b64 v73, v[98:99], v[100:101] offset0:0 offset1:68
    v_pk_mul_f32 v[90:91], v[54:55], v[46:47]
    v_pk_mul_f32 v[94:95], v[54:55], v[42:43]
    v_pk_mul_f32 v[92:93], v[54:55], v[44:45]
    v_pk_mul_f32 v[96:97], v[54:55], v[40:41]
    v_pk_fma_f32 v[62:63], v[52:53], v[46:47], v[92:93]
    v_pk_fma_f32 v[58:59], v[52:53], v[42:43], v[96:97]
    v_pk_fma_f32 v[60:61], v[52:53], v[44:45], v[90:91] neg_lo:[0,0,1] neg_hi:[0,0,1]
    v_pk_fma_f32 v[56:57], v[52:53], v[40:41], v[94:95] neg_lo:[0,0,1] neg_hi:[0,0,1]
    v_cvt_pk_f16_f32 v76, v52, v54
    v_cvt_pk_f16_f32 v77, v53, v55
    v_cvt_pk_f16_f32 v78, v60, v62
    v_cvt_pk_f16_f32 v79, v61, v63
    ds_write2_b64 v73, v[76:77], v[78:79] offset0:136 offset1:204
    v_pk_mul_f32 v[90:91], v[58:59], v[46:47]
    v_pk_mul_f32 v[94:95], v[58:59], v[42:43]
    v_pk_mul_f32 v[92:93], v[58:59], v[44:45]
    v_pk_mul_f32 v[96:97], v[58:59], v[40:41]
    v_pk_fma_f32 v[62:63], v[56:57], v[46:47], v[92:93]
    v_pk_fma_f32 v[54:55], v[56:57], v[42:43], v[96:97]
    v_pk_fma_f32 v[60:61], v[56:57], v[44:45], v[90:91] neg_lo:[0,0,1] neg_hi:[0,0,1]
    v_pk_fma_f32 v[52:53], v[56:57], v[40:41], v[94:95] neg_lo:[0,0,1] neg_hi:[0,0,1]
    v_cvt_pk_f16_f32 v98, v56, v58
    v_cvt_pk_f16_f32 v99, v57, v59
    v_cvt_pk_f16_f32 v100, v60, v62
    v_cvt_pk_f16_f32 v101, v61, v63
    ds_write2_b64 v74, v[98:99], v[100:101] offset0:0 offset1:68
    v_pk_mul_f32 v[90:91], v[54:55], v[46:47]
    v_pk_mul_f32 v[94:95], v[54:55], v[42:43]
    v_pk_mul_f32 v[92:93], v[54:55], v[44:45]
    v_pk_mul_f32 v[96:97], v[54:55], v[40:41]
    v_pk_fma_f32 v[62:63], v[52:53], v[46:47], v[92:93]
    v_pk_fma_f32 v[58:59], v[52:53], v[42:43], v[96:97]
    v_pk_fma_f32 v[60:61], v[52:53], v[44:45], v[90:91] neg_lo:[0,0,1] neg_hi:[0,0,1]
    v_pk_fma_f32 v[56:57], v[52:53], v[40:41], v[94:95] neg_lo:[0,0,1] neg_hi:[0,0,1]
    v_cvt_pk_f16_f32 v76, v52, v54
    v_cvt_pk_f16_f32 v77, v53, v55
    v_cvt_pk_f16_f32 v78, v60, v62
    v_cvt_pk_f16_f32 v79, v61, v63
    ds_write2_b64 v74, v[76:77], v[78:79] offset0:136 offset1:204
    v_pk_mul_f32 v[90:91], v[58:59], v[46:47]
    v_pk_mul_f32 v[94:95], v[58:59], v[42:43]
    v_pk_mul_f32 v[92:93], v[58:59], v[44:45]
    v_pk_mul_f32 v[96:97], v[58:59], v[40:41]
    v_pk_fma_f32 v[62:63], v[56:57], v[46:47], v[92:93]
    v_pk_fma_f32 v[54:55], v[56:57], v[42:43], v[96:97]
    v_pk_fma_f32 v[60:61], v[56:57], v[44:45], v[90:91] neg_lo:[0,0,1] neg_hi:[0,0,1]
    v_pk_fma_f32 v[52:53], v[56:57], v[40:41], v[94:95] neg_lo:[0,0,1] neg_hi:[0,0,1]
    v_cvt_pk_f16_f32 v98, v56, v58
    v_cvt_pk_f16_f32 v99, v57, v59
    v_cvt_pk_f16_f32 v100, v60, v62
    v_cvt_pk_f16_f32 v101, v61, v63
    ds_write2_b64 v75, v[98:99], v[100:101] offset0:0 offset1:68
    v_pk_mul_f32 v[90:91], v[54:55], v[46:47]
    v_pk_mul_f32 v[92:93], v[54:55], v[44:45]
    v_pk_fma_f32 v[62:63], v[52:53], v[46:47], v[92:93]
    v_pk_fma_f32 v[60:61], v[52:53], v[44:45], v[90:91] neg_lo:[0,0,1] neg_hi:[0,0,1]
    v_cvt_pk_f16_f32 v76, v52, v54
    v_cvt_pk_f16_f32 v77, v53, v55
    v_cvt_pk_f16_f32 v78, v60, v62
    v_cvt_pk_f16_f32 v79, v61, v63
    ds_write2_b64 v75, v[76:77], v[78:79] offset0:136 offset1:204
    s_branch JOBJ_19
JOB_16:
    v_mul_f32 v91, 0x43000000, v68
    v_mul_f32 v90, 0x43000000, v20
    v_mul_f32 v95, 0x43000000, v69
    v_mul_f32 v94, 0x43000000, v21
    v_fract_f32 v91, v91
    v_fract_f32 v95, v95
    v_fmac_f32 v91, 0x43000000, v70
    v_fmac_f32 v95, 0x43000000, v71
    v_exp_f32 v90, v90
    v_cos_f32 v92, v91
    v_sin_f32 v91, v91
    v_exp_f32 v94, v94
    v_cos_f32 v96, v95
    v_sin_f32 v95, v95
    v_mul_f32 v44, v90, v92
    v_mul_f32 v46, v90, v91
    v_mul_f32 v45, v94, v96
    v_mul_f32 v47, v94, v95
    v_pk_mul_f32 v[32:33], v[32:33], s[16:17] op_sel_hi:[1,0]
    v_pk_mul_f32 v[34:35], v[34:35], s[16:17] op_sel_hi:[1,0]
    v_pk_mul_f32 v[90:91], v[46:47], v[46:47]
    v_pk_mul_f32 v[92:93], v[44:45], v[46:47]
    v_pk_fma_f32 v[48:49], v[44:45], v[44:45], v[90:91] neg_lo:[0,0,1] neg_hi:[0,0,1]
    v_pk_add_f32 v[50:51], v[92:93], v[92:93]
    v_mul_f32 v91, 2.0, v68
    v_mul_f32 v90, 2.0, v20
    v_mul_f32 v95, 2.0, v69
    v_mul_f32 v94, 2.0, v21
    v_fract_f32 v91, v91
    v_fract_f32 v95, v95
    v_fmac_f32 v91, 2.0, v70
    v_fmac_f32 v95, 2.0, v71
    v_exp_f32 v90, v90
    v_cos_f32 v92, v91
    v_sin_f32 v91, v91
    v_exp_f32 v94, v94
    v_cos_f32 v96, v95
    v_sin_f32 v95, v95
    v_mul_f32 v40, v90, v92
    v_mul_f32 v42, v90, v91
    v_mul_f32 v41, v94, v96
    v_mul_f32 v43, v94, v95
    v_pk_mul_f32 v[90:91], v[34:35], v[50:51]
    v_pk_mul_f32 v[92:93], v[34:35], v[48:49]
    v_pk_fma_f32 v[54:55], v[32:33], v[50:51], v[92:93]
    v_pk_fma_f32 v[52:53], v[32:33], v[48:49], v[90:91] neg_lo:[0,0,1] neg_hi:[0,0,1]
    v_pk_mul_f32 v[90:91], v[54:55], v[50:51]
    v_pk_mul_f32 v[92:93], v[54:55], v[48:49]
    v_pk_fma_f32 v[66:67], v[52:53], v[50:51], v[92:93]
    v_pk_fma_f32 v[64:65], v[52:53], v[48:49], v[90:91] neg_lo:[0,0,1] neg_hi:[0,0,1]
    v_pk_mul_f32 v[90:91], v[54:55], v[46:47]
    v_pk_mul_f32 v[94:95], v[54:55], v[42:43]
    v_pk_mul_f32 v[92:93], v[54:55], v[44:45]
    v_pk_mul_f32 v[96:97], v[54:55], v[40:41]
    v_pk_fma_f32 v[62:63], v[52:53], v[46:47], v[92:93]
    v_pk_fma_f32 v[58:59], v[52:53], v[42:43], v[96:97]
    v_pk_fma_f32 v[60:61], v[52:53], v[44:45], v[90:91] neg_lo:[0,0,1] neg_hi:[0,0,1]
    v_pk_fma_f32 v[56:57], v[52:53], v[40:41], v[94:95] neg_lo:[0,0,1] neg_hi:[0,0,1]
    v_cvt_pk_f16_f32 v98, v52, v54
    v_cvt_pk_f16_f32 v99, v53, v55
    v_cvt_pk_f16_f32 v100, v60, v62
    v_cvt_pk_f16_f32 v101, v61, v63
    ds_write2_b64 v72, v[98:99], v[100:101] offset0:0 offset1:68
    v_pk_mul_f32 v[90:91], v[58:59], v[46:47]
    v_pk_mul_f32 v[94:95], v[58:59], v[42:43]
    v_pk_mul_f32 v[92:93], v[58:59], v[44:45]
    v_pk_mul_f32 v[96:97], v[58:59], v[40:41]
    v_pk_fma_f32 v[62:63], v[56:57], v[46:47], v[92:93]
    v_pk_fma_f32 v[54:55], v[56:57], v[42:43], v[96:97]
    v_pk_fma_f32 v[60:61], v[56:57], v[44:45], v[90:91] neg_lo:[0,0,1] neg_hi:[0,0,1]
    v_pk_fma_f32 v[52:53], v[56:57], v[40:41], v[94:95] neg_lo:[0,0,1] neg_hi:[0,0,1]
    v_cvt_pk_f16_f32 v76, v56, v58
    v_cvt_pk_f16_f32 v77, v57, v59
    v_cvt_pk_f16_f32 v78, v60, v62
    v_cvt_pk_f16_f32 v79, v61, v63
    ds_write2_b64 v72, v[76:77], v[78:79] offset0:136 offset1:204
    v_pk_mul_f32 v[90:91], v[54:55], v[46:47]
    v_pk_mul_f32 v[94:95], v[54:55], v[42:43]
    v_pk_mul_f32 v[92:93], v[54:55], v[44:45]
    v_pk_mul_f32 v[96:97], v[54:55], v[40:41]
    v_pk_fma_f32 v[62:63], v[52:53], v[46:47], v[92:93]
    v_pk_fma_f32 v[58:59], v[52:53], v[42:43], v[96:97]
    v_pk_fma_f32 v[60:61], v[52:53], v[44:45], v[90:91] neg_lo:[0,0,1] neg_hi:[0,0,1]
    v_pk_fma_f32 v[56:57], v[52:53], v[40:41], v[94:95] neg_lo:[0,0,1] neg_hi:[0,0,1]
    v_cvt_pk_f16_f32 v98, v52, v54
    v_cvt_pk_f16_f32 v99, v53, v55
    v_cvt_pk_f16_f32 v100, v60, v62
    v_cvt_pk_f16_f32 v101, v61, v63
    ds_write2_b64 v73, v[98:99], v[100:101] offset0:0 offset1:68
    v_pk_mul_f32 v[90:91], v[58:59], v[46:47]
    v_pk_mul_f32 v[94:95], v[42:43], v[42:43]
    v_pk_mul_f32 v[92:93], v[58:59], v[44:45]
    v_pk_mul_f32 v[96:97], v[40:41], v[42:43]
    v_pk_fma_f32 v[62:63], v[56:57], v[46:47], v[92:93]
    v_pk_fma_f32 v[48:49], v[40:41], v[40:41], v[94:95] neg_lo:[0,0,1] neg_hi:[0,0,1]
    v_pk_fma_f32 v[60:61], v[56:57], v[44:45], v[90:91] neg_lo:[0,0,1] neg_hi:[0,0,1]
    v_pk_add_f32 v[50:51], v[96:97], v[96:97]
    v_cvt_pk_f16_f32 v76, v56, v58
    v_cvt_pk_f16_f32 v77, v57, v59
    v_cvt_pk_f16_f32 v78, v60, v62
    v_cvt_pk_f16_f32 v79, v61, v63
    ds_write2_b64 v73, v[76:77], v[78:79] offset0:136 offset1:204
    v_pk_mul_f32 v[90:91], v[66:67], v[50:51]
    v_pk_mul_f32 v[94:95], v[66:67], v[46:47]
    v_pk_mul_f32 v[92:93], v[66:67], v[48:49]
    v_pk_mul_f32 v[96:97], v[66:67], v[44:45]
    v_pk_fma_f32 v[62:63], v[64:65], v[50:51], v[92:93]
    v_pk_fma_f32 v[54:55], v[64:65], v[46:47], v[96:97]
    v_pk_fma_f32 v[60:61], v[64:65], v[48:49], v[90:91] neg_lo:[0,0,1] neg_hi:[0,0,1]
    v_pk_fma_f32 v[52:53], v[64:65], v[44:45], v[94:95] neg_lo:[0,0,1] neg_hi:[0,0,1]
    v_cvt_pk_f16_f32 v98, v64, v66
    v_cvt_pk_f16_f32 v99, v65, v67
    v_cvt_pk_f16_f32 v100, v60, v62
    v_cvt_pk_f16_f32 v101, v61, v63
    ds_write2_b64 v74, v[98:99], v[100:101] offset0:0 offset1:68
    v_pk_mul_f32 v[90:91], v[54:55], v[50:51]
    v_pk_mul_f32 v[94:95], v[54:55], v[46:47]
    v_pk_mul_f32 v[92:93], v[54:55], v[48:49]
    v_pk_mul_f32 v[96:97], v[54:55], v[44:45]
    v_pk_fma_f32 v[62:63], v[52:53], v[50:51], v[92:93]
    v_pk_fma_f32 v[58:59], v[52:53], v[46:47], v[96:97]
    v_pk_fma_f32 v[60:61], v[52:53], v[48:49], v[90:91] neg_lo:[0,0,1] neg_hi:[0,0,1]
    v_pk_fma_f32 v[56:57], v[52:53], v[44:45], v[94:95] neg_lo:[0,0,1] neg_hi:[0,0,1]
    v_cvt_pk_f16_f32 v76, v52, v54
    v_cvt_pk_f16_f32 v77, v53, v55
    v_cvt_pk_f16_f32 v78, v60, v62
    v_cvt_pk_f16_f32 v79, v61, v63
    ds_write2_b64 v74, v[76:77], v[78:79] offset0:136 offset1:204
    v_pk_mul_f32 v[90:91], v[58:59], v[50:51]
    v_pk_mul_f32 v[94:95], v[58:59], v[46:47]
    v_pk_mul_f32 v[92:93], v[58:59], v[48:49]
    v_pk_mul_f32 v[96:97], v[58:59], v[44:45]
    v_pk_fma_f32 v[62:63], v[56:57], v[50:51], v[92:93]
    v_pk_fma_f32 v[54:55], v[56:57], v[46:47], v[96:97]
    v_pk_fma_f32 v[60:61], v[56:57], v[48:49], v[90:91] neg_lo:[0,0,1] neg_hi:[0,0,1]
    v_pk_fma_f32 v[52:53], v[56:57], v[44:45], v[94:95] neg_lo:[0,0,1] neg_hi:[0,0,1]
    v_cvt_pk_f16_f32 v98, v56, v58
    v_cvt_pk_f16_f32 v99, v57, v59
    v_cvt_pk_f16_f32 v100, v60, v62
    v_cvt_pk_f16_f32 v101, v61, v63
    ds_write2_b64 v75, v[98:99], v[100:101] offset0:0 offset1:68
    v_pk_mul_f32 v[90:91], v[54:55], v[50:51]
    v_pk_mul_f32 v[92:93], v[54:55], v[48:49]
    v_pk_fma_f32 v[62:63], v[52:53], v[50:51], v[92:93]
    v_pk_fma_f32 v[60:61], v[52:53], v[48:49], v[90:91] neg_lo:[0,0,1] neg_hi:[0,0,1]
    v_cvt_pk_f16_f32 v76, v52, v54
    v_cvt_pk_f16_f32 v77, v53, v55
    v_cvt_pk_f16_f32 v78, v60, v62
    v_cvt_pk_f16_f32 v79, v61, v63
    ds_write2_b64 v75, v[76:77], v[78:79] offset0:136 offset1:204
    s_branch JOBJ_19
JOB_18:
    v_mul_f32 v91, 0x41000000, v68
    v_mul_f32 v90, 0x41000000, v20
    v_mul_f32 v95, 0x41000000, v69
    v_mul_f32 v94, 0x41000000, v21
    v_fract_f32 v91, v91
    v_fract_f32 v95, v95
    v_fmac_f32 v91, 0x41000000, v70
    v_fmac_f32 v95, 0x41000000, v71
    v_exp_f32 v90, v90
    v_cos_f32 v92, v91
    v_sin_f32 v91, v91
    v_exp_f32 v94, v94
    v_cos_f32 v96, v95
    v_sin_f32 v95, v95
    v_mul_f32 v40, v90, v92
    v_mul_f32 v42, v90, -v91
    v_mul_f32 v41, v94, v96
    v_mul_f32 v43, v94, -v95
    v_mov_b32 v52, 0x47000000
    v_mov_b32 v53, 0x47000000
    v_mov_b32 v54, 0
    v_mov_b32 v55, 0
    v_pk_mul_f32 v[90:91], v[42:43], v[42:43]
    v_pk_mul_f32 v[60:61], v[40:41], v[52:53]
    v_pk_mul_f32 v[92:93], v[40:41], v[42:43]
    v_pk_mul_f32 v[62:63], v[42:43], v[52:53]
    v_pk_fma_f32 v[44:45], v[40:41], v[40:41], v[90:91] neg_lo:[0,0,1] neg_hi:[0,0,1]
    v_pk_add_f32 v[46:47], v[92:93], v[92:93]
    v_pk_mul_f32 v[56:57], v[44:45], v[52:53]
    v_pk_mul_f32 v[94:95], v[62:63], v[46:47]
    v_pk_mul_f32 v[58:59], v[46:47], v[52:53]
    v_pk_mul_f32 v[96:97], v[62:63], v[44:45]
    v_pk_fma_f32 v[66:67], v[60:61], v[46:47], v[96:97]
    v_pk_fma_f32 v[64:65], v[60:61], v[44:45], v[94:95] neg_lo:[0,0,1] neg_hi:[0,0,1]
    v_cvt_pk_f16_f32 v98, v52, v54
    v_cvt_pk_f16_f32 v99, v53, v55
    v_cvt_pk_f16_f32 v100, v60, v62
    v_cvt_pk_f16_f32 v101, v61, v63
    ds_write2_b64 v72, v[98:99], v[100:101] offset0:0 offset1:68
    v_pk_mul_f32 v[90:91], v[58:59], v[46:47]
    v_pk_mul_f32 v[94:95], v[66:67], v[46:47]
    v_pk_mul_f32 v[92:93], v[58:59], v[44:45]
    v_pk_mul_f32 v[96:97], v[66:67], v[44:45]
    v_pk_fma_f32 v[54:55], v[56:57], v[46:47], v[92:93]
    v_pk_fma_f32 v[62:63], v[64:65], v[46:47], v[96:97]
    v_pk_fma_f32 v[52:53], v[56:57], v[44:45], v[90:91] neg_lo:[0,0,1] neg_hi:[0,0,1]
    v_pk_fma_f32 v[60:61], v[64:65], v[44:45], v[94:95] neg_lo:[0,0,1] neg_hi:[0,0,1]
    v_cvt_pk_f16_f32 v76, v56, v58
    v_cvt_pk_f16_f32 v77, v57, v59
    v_cvt_pk_f16_f32 v78, v64, v66
    v_cvt_pk_f16_f32 v79, v65, v67
    ds_write2_b64 v72, v[76:77], v[78:79] offset0:136 offset1:204
    v_pk_mul_f32 v[90:91], v[54:55], v[46:47]
    v_pk_mul_f32 v[94:95], v[62:63], v[46:47]
    v_pk_mul_f32 v[92:93], v[54:55], v[44:45]
    v_pk_mul_f32 v[96:97], v[62:63], v[44:45]
    v_pk_fma_f32 v[58:59], v[52:53], v[46:47], v[92:93]
    v_pk_fma_f32 v[66:67], v[60:61], v[46:47], v[96:97]
    v_pk_fma_f32 v[56:57], v[52:53], v[44:45], v[90:91] neg_lo:[0,0,1] neg_hi:[0,0,1]
    v_pk_fma_f32 v[64:65], v[60:61], v[44:45], v[94:95] neg_lo:[0,0,1] neg_hi:[0,0,1]
    v_cvt_pk_f16_f32 v98, v52, v54
    v_cvt_pk_f16_f32 v99, v53, v55
    v_cvt_pk_f16_f32 v100, v60, v62
    v_cvt_pk_f16_f32 v101, v61, v63
    ds_write2_b64 v73, v[98:99], v[100:101] offset0:0 offset1:68
    v_pk_mul_f32 v[90:91], v[58:59], v[46:47]
    v_pk_mul_f32 v[94:95], v[66:67], v[46:47]
    v_pk_mul_f32 v[92:93], v[58:59], v[44:45]
    v_pk_mul_f32 v[96:97], v[66:67], v[44:45]
    v_pk_fma_f32 v[54:55], v[56:57], v[46:47], v[92:93]
    v_pk_fma_f32 v[62:63], v[64:65], v[46:47], v[96:97]
    v_pk_fma_f32 v[52:53], v[56:57], v[44:45], v[90:91] neg_lo:[0,0,1] neg_hi:[0,0,1]
    v_pk_fma_f32 v[60:61], v[64:65], v[44:45], v[94:95] neg_lo:[0,0,1] neg_hi:[0,0,1]
    v_cvt_pk_f16_f32 v76, v56, v58
    v_cvt_pk_f16_f32 v77, v57, v59
    v_cvt_pk_f16_f32 v78, v64, v66
    v_cvt_pk_f16_f32 v79, v65, v67
    ds_write2_b64 v73, v[76:77], v[78:79] offset0:136 offset1:204
    v_pk_mul_f32 v[90:91], v[54:55], v[46:47]
    v_pk_mul_f32 v[94:95], v[62:63], v[46:47]
    v_pk_mul_f32 v[92:93], v[54:55], v[44:45]
    v_pk_mul_f32 v[96:97], v[62:63], v[44:45]
    v_pk_fma_f32 v[58:59], v[52:53], v[46:47], v[92:93]
    v_pk_fma_f32 v[66:67], v[60:61], v[46:47], v[96:97]
    v_pk_fma_f32 v[56:57], v[52:53], v[44:45], v[90:91] neg_lo:[0,0,1] neg_hi:[0,0,1]
    v_pk_fma_f32 v[64:65], v[60:61], v[44:45], v[94:95] neg_lo:[0,0,1] neg_hi:[0,0,1]
    v_cvt_pk_f16_f32 v98, v52, v54
    v_cvt_pk_f16_f32 v99, v53, v55
    v_cvt_pk_f16_f32 v100, v60, v62
    v_cvt_pk_f16_f32 v101, v61, v63
    ds_write2_b64 v74, v[98:99], v[100:101] offset0:0 offset1:68
    v_pk_mul_f32 v[90:91], v[58:59], v[46:47]
    v_pk_mul_f32 v[94:95], v[66:67], v[46:47]
    v_pk_mul_f32 v[92:93], v[58:59], v[44:45]
    v_pk_mul_f32 v[96:97], v[66:67], v[44:45]
    v_pk_fma_f32 v[54:55], v[56:57], v[46:47], v[92:93]
    v_pk_fma_f32 v[62:63], v[64:65], v[46:47], v[96:97]
    v_pk_fma_f32 v[52:53], v[56:57], v[44:45], v[90:91] neg_lo:[0,0,1] neg_hi:[0,0,1]
    v_pk_fma_f32 v[60:61], v[64:65], v[44:45], v[94:95] neg_lo:[0,0,1] neg_hi:[0,0,1]
    v_cvt_pk_f16_f32 v76, v56, v58
    v_cvt_pk_f16_f32 v77, v57, v59
    v_cvt_pk_f16_f32 v78, v64, v66
    v_cvt_pk_f16_f32 v79, v65, v67
    ds_write2_b64 v74, v[76:77], v[78:79] offset0:136 offset1:204
    v_pk_mul_f32 v[90:91], v[54:55], v[46:47]
    v_pk_mul_f32 v[94:95], v[62:63], v[46:47]
    v_pk_mul_f32 v[92:93], v[54:55], v[44:45]
    v_pk_mul_f32 v[96:97], v[62:63], v[44:45]
    v_pk_fma_f32 v[58:59], v[52:53], v[46:47], v[92:93]
    v_pk_fma_f32 v[66:67], v[60:61], v[46:47], v[96:97]
    v_pk_fma_f32 v[56:57], v[52:53], v[44:45], v[90:91] neg_lo:[0,0,1] neg_hi:[0,0,1]
    v_pk_fma_f32 v[64:65], v[60:61], v[44:45], v[94:95] neg_lo:[0,0,1] neg_hi:[0,0,1]
    v_cvt_pk_f16_f32 v98, v52, v54
    v_cvt_pk_f16_f32 v99, v53, v55
    v_cvt_pk_f16_f32 v100, v60, v62
    v_cvt_pk_f16_f32 v101, v61, v63
    ds_write2_b64 v75, v[98:99], v[100:101] offset0:0 offset1:68
    v_cvt_pk_f16_f32 v76, v56, v58
    v_cvt_pk_f16_f32 v77, v57, v59
    v_cvt_pk_f16_f32 v78, v64, v66
    v_cvt_pk_f16_f32 v79, v65, v67
    ds_write2_b64 v75, v[76:77], v[78:79] offset0:136 offset1:204
    ds_write_b8 v15, v5 offset:64
    s_cmp_eq_u32 s87, 2
    s_cbranch_scc1 KS_G0
    s_branch EXP_13
KC_SEND:
W_20:
    ds_read_b32 v104, v105 offset:224
    s_sub_u32 s39, s39, 1
    s_cbranch_scc1 KS_ABORT
    s_waitcnt lgkmcnt(0)
    v_cmp_eq_u32 vcc, 0, v104
    s_cbranch_vccnz W_20
    s_lshl_b32 s92, s88, 12
    s_lshl_b32 s93, s86, 10
    s_add_u32 s92, s92, s93
    s_add_u32 s92, s92, 0x920000
    v_add_u32 v24, s92, v12
    s_mov_b32 s93, 0xffff
    v_lshlrev_b32 v25, 16, v104
    v_cvt_f16_f32 v20, v20
    v_cvt_f16_f32 v21, v21
    v_cvt_f16_f32 v22, v22
    v_cvt_f16_f32 v23, v23
    s_cmp_lg_u32 s86, 2
    s_cbranch_scc1 KC_S2
    s_mov_b32 exec_lo, 0
    s_mov_b32 exec_hi, 0xffff0000
    v_mov_b32 v20, v106
    v_lshrrev_b32 v21, 16, v106
    s_mov_b64 exec, -1
KC_S2:
    v_bfi_b32 v20, s93, v20, v104
    v_bfi_b32 v21, s93, v21, v25
    v_bfi_b32 v22, s93, v22, v104
    v_bfi_b32 v23, s93, v23, v25
    global_store_dwordx4 v24, v[20:23], s[36:37] sc1
    s_branch KS_G0
KC_RECV:
    s_cmp_eq_u32 s86, 3
    s_cbranch_scc1 EXP_13
    s_lshl_b32 s92, s88, 12
    s_lshl_b32 s93, s86, 10
    s_add_u32 s92, s92, s93
    s_add_u32 s92, s92, 0x920000
    v_add_u32 v24, s92, v12
W_21:
    s_sleep 2
    ds_read_b32 v104, v105 offset:224
    s_sub_u32 s39, s39, 1
    s_cbranch_scc1 KS_ABORT
    s_waitcnt lgkmcnt(0)
    v_cmp_eq_u32 vcc, 0, v104
    s_cbranch_vccnz W_21
    v_lshlrev_b32 v25, 16, v104
W_22:
    s_sleep 2
    ds_read_b32 v17, v4 offset:68
    s_sub_u32 s39, s39, 1
    s_cbranch_scc1 KS_ABORT
    s_waitcnt lgkmcnt(0)
    v_cmp_ne_u32 vcc, s84, v17
    s_cbranch_vccnz W_22
    s_branch KPE_24
KP_23:
    s_sleep 2
KPE_24:
    global_load_dwordx4 v[20:23], v24, s[36:37] sc1
    s_sub_u32 s39, s39, 1
    s_cbranch_scc1 KS_ABORT
    s_waitcnt vmcnt(0)
    v_xor_b32 v20, v104, v20
    v_xor_b32 v21, v25, v21
    v_xor_b32 v22, v104, v22
    v_xor_b32 v23, v25, v23
    v_or3_b32 v26, v20, v21, v22
    v_or_b32 v26, v26, v23
    v_cmp_lt_u32 vcc, 0xffff, v26
    s_cbranch_vccnz KP_23
    v_xor_b32 v20, v104, v20
    v_xor_b32 v22, v104, v22
    ds_write_b16 v108, v20
    ds_write_b16 v109, v21
    ds_write_b16 v112, v22
    ds_write_b16 v113, v23
    s_cmp_lg_u32 s86, 2
    s_cbranch_scc1 EXP_13
    v_and_b32 v20, 0xffff, v20
    v_lshl_or_b32 v20, v21, 16, v20
    v_lshlrev_b32 v21, 16, v107
    s_mov_b32 exec_lo, 0
    s_mov_b32 exec_hi, 0x10000
    ds_write_b64 v14, v[20:21] offset:832
    s_mov_b64 exec, -1
    s_branch EXP_13
JOB_17:
    v_mul_f32 v91, 0x43000000, v68
    v_mul_f32 v90, 0x43000000, v20
    v_mul_f32 v95, 0x43000000, v69
    v_mul_f32 v94, 0x43000000, v21
    v_fract_f32 v91, v91
    v_fract_f32 v95, v95
    v_fmac_f32 v91, 0x43000000, v70
    v_fmac_f32 v95, 0x43000000, v71
    v_exp_f32 v90, v90
    v_cos_f32 v92, v91
    v_sin_f32 v91, v91
    v_exp_f32 v94, v94
    v_cos_f32 v96, v95
    v_sin_f32 v95, v95
    v_mul_f32 v44, v90, v92
    v_mul_f32 v46, v90, v91
    v_mul_f32 v45, v94, v96
    v_mul_f32 v47, v94, v95
    v_pk_mul_f32 v[32:33], v[32:33], s[16:17] op_sel_hi:[1,0]
    v_pk_mul_f32 v[34:35], v[34:35], s[16:17] op_sel_hi:[1,0]
    v_pk_mul_f32 v[90:91], v[46:47], v[46:47]
    v_pk_mul_f32 v[94:95], v[34:35], v[46:47]
    v_pk_mul_f32 v[92:93], v[44:45], v[46:47]
    v_pk_mul_f32 v[96:97], v[34:35], v[44:45]
    v_pk_fma_f32 v[40:41], v[44:45], v[44:45], v[90:91] neg_lo:[0,0,1] neg_hi:[0,0,1]
    v_pk_fma_f32 v[66:67], v[32:33], v[46:47], v[96:97]
    v_pk_add_f32 v[42:43], v[92:93], v[92:93]
    v_pk_fma_f32 v[64:65], v[32:33], v[44:45], v[94:95] neg_lo:[0,0,1] neg_hi:[0,0,1]
    v_pk_mul_f32 v[90:91], v[42:43], v[42:43]
    v_pk_mul_f32 v[92:93], v[40:41], v[42:43]
    v_pk_fma_f32 v[48:49], v[40:41], v[40:41], v[90:91] neg_lo:[0,0,1] neg_hi:[0,0,1]
    v_pk_add_f32 v[50:51], v[92:93], v[92:93]
    v_pk_mul_f32 v[90:91], v[50:51], v[50:51]
    v_pk_mul_f32 v[92:93], v[48:49], v[50:51]
    v_pk_fma_f32 v[48:49], v[48:49], v[48:49], v[90:91] neg_lo:[0,0,1] neg_hi:[0,0,1]
    v_pk_add_f32 v[50:51], v[92:93], v[92:93]
    v_pk_mul_f32 v[90:91], v[34:35], v[50:51]
    v_pk_mul_f32 v[94:95], v[66:67], v[50:51]
    v_pk_mul_f32 v[92:93], v[34:35], v[48:49]
    v_pk_mul_f32 v[96:97], v[66:67], v[48:49]
    v_pk_fma_f32 v[54:55], v[32:33], v[50:51], v[92:93]
    v_pk_fma_f32 v[62:63], v[64:65], v[50:51], v[96:97]
    v_pk_fma_f32 v[52:53], v[32:33], v[48:49], v[90:91] neg_lo:[0,0,1] neg_hi:[0,0,1]
    v_pk_fma_f32 v[60:61], v[64:65], v[48:49], v[94:95] neg_lo:[0,0,1] neg_hi:[0,0,1]
    v_pk_mul_f32 v[90:91], v[54:55], v[42:43]
    v_pk_mul_f32 v[94:95], v[62:63], v[42:43]
    v_pk_mul_f32 v[92:93], v[54:55], v[40:41]
    v_pk_mul_f32 v[96:97], v[62:63], v[40:41]
    v_pk_fma_f32 v[58:59], v[52:53], v[42:43], v[92:93]
    v_pk_fma_f32 v[66:67], v[60:61], v[42:43], v[96:97]
    v_pk_fma_f32 v[56:57], v[52:53], v[40:41], v[90:91] neg_lo:[0,0,1] neg_hi:[0,0,1]
    v_pk_fma_f32 v[64:65], v[60:61], v[40:41], v[94:95] neg_lo:[0,0,1] neg_hi:[0,0,1]
    v_cvt_pk_f16_f32 v98, v52, v54
    v_cvt_pk_f16_f32 v99, v53, v55
    v_cvt_pk_f16_f32 v100, v60, v62
    v_cvt_pk_f16_f32 v101, v61, v63
    ds_write2_b64 v72, v[98:99], v[100:101] offset0:0 offset1:68
    v_pk_mul_f32 v[90:91], v[58:59], v[42:43]
    v_pk_mul_f32 v[94:95], v[66:67], v[42:43]
    v_pk_mul_f32 v[92:93], v[58:59], v[40:41]
    v_pk_mul_f32 v[96:97], v[66:67], v[40:41]
    v_pk_fma_f32 v[54:55], v[56:57], v[42:43], v[92:93]
    v_pk_fma_f32 v[62:63], v[64:65], v[42:43], v[96:97]
    v_pk_fma_f32 v[52:53], v[56:57], v[40:41], v[90:91] neg_lo:[0,0,1] neg_hi:[0,0,1]
    v_pk_fma_f32 v[60:61], v[64:65], v[40:41], v[94:95] neg_lo:[0,0,1] neg_hi:[0,0,1]
    v_cvt_pk_f16_f32 v76, v56, v58
    v_cvt_pk_f16_f32 v77, v57, v59
    v_cvt_pk_f16_f32 v78, v64, v66
    v_cvt_pk_f16_f32 v79, v65, v67
    ds_write2_b64 v72, v[76:77], v[78:79] offset0:136 offset1:204
    v_pk_mul_f32 v[90:91], v[54:55], v[42:43]
    v_pk_mul_f32 v[94:95], v[62:63], v[42:43]
    v_pk_mul_f32 v[92:93], v[54:55], v[40:41]
    v_pk_mul_f32 v[96:97], v[62:63], v[40:41]
    v_pk_fma_f32 v[58:59], v[52:53], v[42:43], v[92:93]
    v_pk_fma_f32 v[66:67], v[60:61], v[42:43], v[96:97]
    v_pk_fma_f32 v[56:57], v[52:53], v[40:41], v[90:91] neg_lo:[0,0,1] neg_hi:[0,0,1]
    v_pk_fma_f32 v[64:65], v[60:61], v[40:41], v[94:95] neg_lo:[0,0,1] neg_hi:[0,0,1]
    v_cvt_pk_f16_f32 v98, v52, v54
    v_cvt_pk_f16_f32 v99, v53, v55
    v_cvt_pk_f16_f32 v100, v60, v62
    v_cvt_pk_f16_f32 v101, v61, v63
    ds_write2_b64 v73, v[98:99], v[100:101] offset0:0 offset1:68
    v_pk_mul_f32 v[90:91], v[58:59], v[42:43]
    v_pk_mul_f32 v[92:93], v[58:59], v[40:41]
    v_pk_fma_f32 v[54:55], v[56:57], v[42:43], v[92:93]
    v_pk_fma_f32 v[52:53], v[56:57], v[40:41], v[90:91] neg_lo:[0,0,1] neg_hi:[0,0,1]
    v_cvt_pk_f16_f32 v76, v56, v58
    v_cvt_pk_f16_f32 v77, v57, v59
    v_cvt_pk_f16_f32 v78, v64, v66
    v_cvt_pk_f16_f32 v79, v65, v67
    ds_write2_b64 v73, v[76:77], v[78:79] offset0:136 offset1:204
    v_cvt_pk_f16_f32 v98, v52, v54
    v_cvt_pk_f16_f32 v99, v53, v55
    v_mov_b32 v36, 0x4538aa3b
    v_mul_f32 v24, s14, v36
    v_max_f32 v24, 0, v24
    v_exp_f32 v24, v24
    ds_write_b64 v74, v[98:99] offset:0
    s_sub_u32 s11, s15, 7
    s_lshl_b32 s11, s11, 23
    v_lshlrev_b32 v25, 16, v107
    v_mul_f32 v24, s11, v24
    v_mov_b32 v106, v24
    ds_write_b64 v14, v[24:25] offset:832
JOBJ_19:
    ds_write_b8 v15, v5 offset:64
    ds_read_b128 v[40:43], v127 offset:0
    ds_read_b128 v[44:47], v127 offset:64
    ds_read_b128 v[48:51], v127 offset:128
    ds_read_b128 v[52:55], v127 offset:192
    ds_read_b128 v[56:59], v127 offset:256
    ds_read_b128 v[60:63], v127 offset:320
    ds_read_b128 v[64:67], v127 offset:384
    ds_read_b128 v[68:71], v127 offset:448
    v_mov_b32 v36, 0x3fb8aa3b
    v_mul_f32 v36, s14, v36
    v_mul_f32 v37, 0x45000000, v36
    v_max_f32 v37, 0, v37
    v_add_f32 v37, 0x41b80000, v37
    v_fma_f32 v110, v110, v36, -v37
    v_fma_f32 v111, v111, v36, -v37
    v_fma_f32 v114, v114, v36, -v37
    v_fma_f32 v115, v115, v36, -v37
    v_exp_f32 v110, v110
    v_exp_f32 v111, v111
    v_exp_f32 v114, v114
    v_exp_f32 v115, v115
W_25:
    ds_read_u8 v17, v14 offset:67
    s_sub_u32 s39, s39, 1
    s_cbranch_scc1 KS_ABORT
    s_waitcnt lgkmcnt(0)
    v_cmp_eq_u32 vcc, 0, v17
    s_cbranch_vccnz W_25
    ds_read_b128 v[72:75], v126 offset:22304
    ds_read_b128 v[76:79], v126 offset:22368
    ds_read_b128 v[80:83], v126 offset:22432
    ds_read_b128 v[84:87], v126 offset:22496
    ds_read_b128 v[88:91], v126 offset:22560
    ds_read_b128 v[92:95], v126 offset:22624
    ds_read_b128 v[96:99], v126 offset:22688
    ds_read_b128 v[100:103], v126 offset:22752
    s_waitcnt lgkmcnt(7)
    v_mfma_f32_16x16x32_f16 v[20:23], v[40:43], v[72:75], 0
    s_waitcnt lgkmcnt(6)
    v_mfma_f32_16x16x32_f16 v[24:27], v[44:47], v[76:79], 0
    s_waitcnt lgkmcnt(5)
    v_mfma_f32_16x16x32_f16 v[20:23], v[48:51], v[80:83], v[20:23]
    s_waitcnt lgkmcnt(4)
    v_mfma_f32_16x16x32_f16 v[24:27], v[52:55], v[84:87], v[24:27]
    s_waitcnt lgkmcnt(3)
    v_mfma_f32_16x16x32_f16 v[20:23], v[56:59], v[88:91], v[20:23]
    s_waitcnt lgkmcnt(2)
    v_mfma_f32_16x16x32_f16 v[24:27], v[60:63], v[92:95], v[24:27]
    s_waitcnt lgkmcnt(1)
    v_mfma_f32_16x16x32_f16 v[20:23], v[64:67], v[96:99], v[20:23]
    s_waitcnt lgkmcnt(0)
    v_mfma_f32_16x16x32_f16 v[24:27], v[68:71], v[100:103], v[24:27]
    s_nop 7
    v_add_f32 v20, v20, v24
    v_add_f32 v21, v21, v25
    v_add_f32 v22, v22, v26
    v_add_f32 v23, v23, v27
    v_mul_f32 v20, v20, v110
    v_mul_f32 v21, v21, v111
    v_mul_f32 v22, v22, v114
    v_mul_f32 v23, v23, v115
    s_cmp_eq_u32 s87, 2
    s_cbranch_scc1 KC_SEND
    v_cvt_f16_f32 v20, v20
    ds_write_b16 v108, v20
    v_cvt_f16_f32 v21, v21
    ds_write_b16 v109, v21
    v_cvt_f16_f32 v22, v22
    ds_write_b16 v112, v22
    v_cvt_f16_f32 v23, v23
    ds_write_b16 v113, v23
EXP_13:
    ds_write_b8 v15, v5 offset:68
    v_mov_b32 v28, 0
    v_mov_b32 v29, 0
    v_mov_b32 v30, 0
    v_mov_b32 v31, 0
    v_mov_b32 v32, s85
    s_waitcnt vmcnt(0)
W_26:
    ds_read_b32 v20, v14 offset:68
    s_sub_u32 s39, s39, 1
    s_cbranch_scc1 KS_ABORT
    s_waitcnt lgkmcnt(0)
    v_cmp_ne_u32 vcc, s84, v20
    s_cbranch_vccnz W_26
    ds_read_u16 v20, v116
    ds_read_u16 v21, v117
    ds_read_u16 v22, v118
    ds_read_u16 v23, v120
    ds_read_u16 v24, v121
    ds_read_u16 v25, v122
    ds_read_u16 v26, v123
    s_mov_b64 exec, 1
    ds_write_b128 v32, v[28:31] offset:3088
    ds_write_b128 v32, v[28:31] offset:8224
    ds_write_b128 v32, v[28:31] offset:3072
    s_mov_b64 exec, -1
    s_waitcnt lgkmcnt(7)
    v_lshl_or_b32 v28, v21, 16, v20
    v_lshl_or_b32 v29, v22, 16, v21
    ds_write_b32 v124, v28 offset:32528
    ds_write_b32 v124, v29 offset:33872
    s_waitcnt lgkmcnt(5)
    v_lshl_or_b32 v30, v24, 16, v23
    v_lshl_or_b32 v31, v26, 16, v25
    ds_write_b32 v119, v30
    ds_write_b32 v125, v31
    ds_write_b8 v15, v5 offset:72
W_27:
    ds_read_b32 v20, v14 offset:72
    s_sub_u32 s39, s39, 1
    s_cbranch_scc1 KS_ABORT
    s_waitcnt lgkmcnt(0)
    v_cmp_ne_u32 vcc, s84, v20
    s_cbranch_vccnz W_27
    ds_read_b64 v[16:17], v14 offset:832
    s_cmp_eq_u32 s86, 1
    s_cbranch_scc1 CV_29
    s_cmp_eq_u32 s86, 2
    s_cbranch_scc1 CV_30
    s_cmp_eq_u32 s86, 3
    s_cbranch_scc1 CV_31
    ds_read2_b32 v[32:33], v6 offset0:144 offset1:145
    ds_read2_b32 v[34:35], v6 offset0:146 offset1:147
    ds_read2_b32 v[36:37], v6 offset0:16 offset1:17
    ds_read2_b32 v[38:39], v6 offset0:18 offset1:19
    ds_read2_b32 v[40:41], v6 offset0:160 offset1:161
    ds_read2_b32 v[42:43], v6 offset0:162 offset1:163
    ds_read2_b32 v[44:45], v6 offset0:32 offset1:33
    ds_read2_b32 v[46:47], v6 offset0:34 offset1:35
    ds_read2_b32 v[48:49], v6 offset0:176 offset1:177
    ds_read2_b32 v[50:51], v6 offset0:178 offset1:179
    ds_read2_b32 v[52:53], v6 offset0:48 offset1:49
    ds_read2_b32 v[54:55], v6 offset0:50 offset1:51
    ds_read2_b32 v[56:57], v6 offset0:192 offset1:193
    ds_read2_b32 v[58:59], v6 offset0:194 offset1:195
    ds_read2_b32 v[60:61], v6 offset0:64 offset1:65
    ds_read2_b32 v[62:63], v6 offset0:66 offset1:67
    ds_read2_b32 v[64:65], v6 offset0:208 offset1:209
    ds_read2_b32 v[66:67], v6 offset0:210 offset1:211
    ds_read2_b32 v[68:69], v6 offset0:80 offset1:81
    ds_read2_b32 v[70:71], v6 offset0:82 offset1:83
    ds_read2_b32 v[72:73], v6 offset0:224 offset1:225
    ds_read2_b32 v[74:75], v6 offset0:226 offset1:227
    ds_read2_b32 v[76:77], v6 offset0:96 offset1:97
    ds_read2_b32 v[78:79], v6 offset0:98 offset1:99
    ds_read2_b32 v[80:81], v6 offset0:240 offset1:241
    ds_read2_b32 v[82:83], v6 offset0:242 offset1:243
    ds_read2_b32 v[84:85], v6 offset0:112 offset1:113
    ds_read2_b32 v[86:87], v6 offset0:114 offset1:115
    ds_read2_b32 v[88:89], v7 offset0:96 offset1:97
    ds_read2_b32 v[90:91], v7 offset0:98 offset1:99
    ds_read2_b32 v[92:93], v6 offset0:128 offset1:129
    ds_read2_b32 v[94:95], v6 offset0:130 offset1:131
    v_lshlrev_b32 v18, 3, v3
    v_sub_u32 v18, v8, v18
    v_lshrrev_b32 v19, 2, v2
    v_lshl_add_u32 v19, v19, 2, v3
    v_and_b32 v28, 3, v2
    v_lshlrev_b32 v28, 4, v28
    v_mul_u32_u24 v19, s8, v19
    v_xor_b32 v19, s10, v19
    s_waitcnt lgkmcnt(0)
    v_mov_b32 v7, v18
    v_add_u32 v6, v19, v28
    v_xor_b32 v12, s9, v12
W_33:
    ds_read_b32 v18, v4 offset:16
    s_sub_u32 s39, s39, 1
    s_cbranch_scc1 KS_ABORT
    s_waitcnt lgkmcnt(0)
    v_cmp_ne_u32 vcc, s84, v18
    s_cbranch_vccnz W_33
    s_setprio 1
    ds_read_b128 v[96:99], v8 offset:0
    ds_read_b128 v[100:103], v8 offset:64
    ds_read_b128 v[104:107], v8 offset:128
    ds_read_b128 v[108:111], v8 offset:192
    s_waitcnt lgkmcnt(3)
    v_mfma_f32_16x16x32_f16 v[20:23], v[32:35], v[96:99], 0
    v_mfma_f32_16x16x32_f16 v[24:27], v[36:39], v[96:99], 0
    ds_read_b128 v[112:115], v8 offset:256
    s_waitcnt lgkmcnt(3)
    v_mfma_f32_16x16x32_f16 v[20:23], v[40:43], v[100:103], v[20:23]
    ds_read_b64 v[28:29], v7 offset:480
    ds_read_b64 v[30:31], v7 offset:992
    v_mfma_f32_16x16x32_f16 v[24:27], v[44:47], v[100:103], v[24:27]
    ds_read_b128 v[116:119], v8 offset:320
    s_waitcnt lgkmcnt(5)
    v_mfma_f32_16x16x32_f16 v[20:23], v[48:51], v[104:107], v[20:23]
    v_mfma_f32_16x16x32_f16 v[24:27], v[52:55], v[104:107], v[24:27]
    ds_read_b128 v[120:123], v8 offset:384
    s_waitcnt lgkmcnt(2)
    v_fma_mix_f32 v104, v28, v17, 0 op_sel_hi:[1,0,0]
    v_fma_mix_f32 v105, v28, v17, 0 op_sel:[1,0,0] op_sel_hi:[1,0,0]
    v_mfma_f32_16x16x32_f16 v[20:23], v[56:59], v[108:111], v[20:23]
    v_fma_mix_f32 v106, v29, v17, 0 op_sel_hi:[1,0,0]
    v_fma_mix_f32 v107, v29, v17, 0 op_sel:[1,0,0] op_sel_hi:[1,0,0]
    v_mfma_f32_16x16x32_f16 v[24:27], v[60:63], v[108:111], v[24:27]
    ds_read_b128 v[124:127], v8 offset:448
    v_cvt_pk_bf16_f32 v104, 0, v104
    v_cvt_pk_bf16_f32 v105, 0, v105
    v_mfma_f32_16x16x32_f16 v[20:23], v[64:67], v[112:115], v[20:23]
    v_cvt_pk_bf16_f32 v106, 0, v106
    v_cvt_pk_bf16_f32 v107, 0, v107
    v_mfma_f32_16x16x32_f16 v[24:27], v[68:71], v[112:115], v[24:27]
    ds_read_b128 v[36:39], v8 offset:512
    v_fma_mix_f32 v112, v30, v17, 0 op_sel_hi:[1,0,0]
    v_fma_mix_f32 v113, v30, v17, 0 op_sel:[1,0,0] op_sel_hi:[1,0,0]
    s_waitcnt lgkmcnt(3)
    v_mfma_f32_16x16x32_f16 v[20:23], v[72:75], v[116:119], v[20:23]
    ds_read_b128 v[96:99], v8 offset:576
    v_fma_mix_f32 v114, v31, v17, 0 op_sel_hi:[1,0,0]
    v_fma_mix_f32 v115, v31, v17, 0 op_sel:[1,0,0] op_sel_hi:[1,0,0]
    v_mfma_f32_16x16x32_f16 v[24:27], v[76:79], v[116:119], v[24:27]
    ds_read_b128 v[44:47], v8 offset:640
    v_cvt_pk_bf16_f32 v112, 0, v112
    v_cvt_pk_bf16_f32 v113, 0, v113
    s_waitcnt lgkmcnt(4)
    v_mfma_f32_16x16x32_f16 v[20:23], v[80:83], v[120:123], v[20:23]
    ds_read_b128 v[100:103], v8 offset:704
    v_cvt_pk_bf16_f32 v114, 0, v114
    v_cvt_pk_bf16_f32 v115, 0, v115
    v_mfma_f32_16x16x32_f16 v[24:27], v[84:87], v[120:123], v[24:27]
    ds_read_b128 v[52:55], v8 offset:768
    s_waitcnt lgkmcnt(5)
    v_mfma_f32_16x16x32_f16 v[20:23], v[88:91], v[124:127], v[20:23]
    ds_read_b128 v[60:63], v8 offset:832
    v_mfma_f32_16x16x32_f16 v[24:27], v[92:95], v[124:127], v[24:27]
    ds_read_b128 v[108:111], v8 offset:896
    s_waitcnt lgkmcnt(6)
    v_mfma_f32_16x16x32_f16 v[24:27], v[32:35], v[36:39], v[24:27]
    ds_read_b128 v[68:71], v8 offset:960
    s_nop 1
    v_mul_f32 v20, v20, v16
    v_mul_f32 v21, v21, v16
    s_waitcnt lgkmcnt(6)
    v_mfma_f32_16x16x32_f16 v[24:27], v[40:43], v[96:99], v[24:27]
    v_mul_f32 v22, v22, v16
    v_mul_f32 v23, v23, v16
    s_waitcnt lgkmcnt(5)
    v_mfma_f32_16x16x32_f16 v[24:27], v[48:51], v[44:47], v[24:27]
    v_cvt_pk_bf16_f32 v20, 0, v20
    v_cvt_pk_bf16_f32 v21, 0, v21
    s_waitcnt lgkmcnt(4)
    v_mfma_f32_16x16x32_f16 v[24:27], v[56:59], v[100:103], v[24:27]
    v_cvt_pk_bf16_f32 v22, 0, v22
    v_cvt_pk_bf16_f32 v23, 0, v23
    s_waitcnt lgkmcnt(3)
    v_mfma_f32_16x16x32_f16 v[24:27], v[64:67], v[52:55], v[24:27]
    v_add_f32 v20, v20, v104
    v_add_f32 v21, v21, v105
    s_waitcnt lgkmcnt(2)
    v_mfma_f32_16x16x32_f16 v[24:27], v[72:75], v[60:63], v[24:27]
    v_add_f32 v22, v22, v106
    v_add_f32 v23, v23, v107
    s_waitcnt lgkmcnt(1)
    v_mfma_f32_16x16x32_f16 v[24:27], v[80:83], v[108:111], v[24:27]
    v_cvt_pk_bf16_f32 v28, v20, v21
    v_cvt_pk_bf16_f32 v29, v22, v23
    s_waitcnt lgkmcnt(0)
    v_mfma_f32_16x16x32_f16 v[24:27], v[88:91], v[68:71], v[24:27]
    v_min_u32 v28, -2, v28
    v_min_u32 v29, -2, v29
    ds_read_u8 v18, v4 offset:160
    ds_read_b128 v[20:23], v12 offset:46592
    s_nop 3
    v_mul_f32 v24, v24, v16
    v_mul_f32 v25, v25, v16
    v_mul_f32 v26, v26, v16
    v_mul_f32 v27, v27, v16
    v_cvt_pk_bf16_f32 v24, 0, v24
    v_cvt_pk_bf16_f32 v25, 0, v25
    v_cvt_pk_bf16_f32 v26, 0, v26
    v_cvt_pk_bf16_f32 v27, 0, v27
    v_add_f32 v24, v24, v112
    v_add_f32 v25, v25, v113
    v_add_f32 v26, v26, v114
    v_add_f32 v27, v27, v115
    v_cvt_pk_bf16_f32 v30, v24, v25
    v_cvt_pk_bf16_f32 v31, v26, v27
    v_min_u32 v30, -2, v30
    v_min_u32 v31, -2, v31
    s_branch CVE_32
CV_29:
    ds_read2_b32 v[32:33], v6 offset0:0 offset1:1
    ds_read2_b32 v[34:35], v6 offset0:2 offset1:3
    ds_read2_b32 v[36:37], v6 offset0:16 offset1:17
    ds_read2_b32 v[38:39], v6 offset0:18 offset1:19
    ds_read2_b32 v[40:41], v6 offset0:32 offset1:33
    ds_read2_b32 v[42:43], v6 offset0:34 offset1:35
    ds_read2_b32 v[44:45], v6 offset0:48 offset1:49
    ds_read2_b32 v[46:47], v6 offset0:50 offset1:51
    ds_read2_b32 v[48:49], v6 offset0:64 offset1:65
    ds_read2_b32 v[50:51], v6 offset0:66 offset1:67
    ds_read2_b32 v[52:53], v6 offset0:80 offset1:81
    ds_read2_b32 v[54:55], v6 offset0:82 offset1:83
    ds_read2_b32 v[56:57], v6 offset0:96 offset1:97
    ds_read2_b32 v[58:59], v6 offset0:98 offset1:99
    ds_read2_b32 v[60:61], v6 offset0:112 offset1:113
    ds_read2_b32 v[62:63], v6 offset0:114 offset1:115
    ds_read2_b32 v[64:65], v6 offset0:128 offset1:129
    ds_read2_b32 v[66:67], v6 offset0:130 offset1:131
    ds_read2_b32 v[68:69], v6 offset0:144 offset1:145
    ds_read2_b32 v[70:71], v6 offset0:146 offset1:147
    ds_read2_b32 v[72:73], v6 offset0:160 offset1:161
    ds_read2_b32 v[74:75], v6 offset0:162 offset1:163
    ds_read2_b32 v[76:77], v6 offset0:176 offset1:177
    ds_read2_b32 v[78:79], v6 offset0:178 offset1:179
    ds_read2_b32 v[80:81], v6 offset0:192 offset1:193
    ds_read2_b32 v[82:83], v6 offset0:194 offset1:195
    ds_read2_b32 v[84:85], v6 offset0:208 offset1:209
    ds_read2_b32 v[86:87], v6 offset0:210 offset1:211
    ds_read2_b32 v[88:89], v6 offset0:224 offset1:225
    ds_read2_b32 v[90:91], v6 offset0:226 offset1:227
    ds_read2_b32 v[92:93], v6 offset0:240 offset1:241
    ds_read2_b32 v[94:95], v6 offset0:242 offset1:243
    ds_read2_b32 v[96:97], v7 offset0:96 offset1:97
    ds_read2_b32 v[98:99], v7 offset0:98 offset1:99
    ds_read2_b32 v[100:101], v11 offset0:32 offset1:33
    ds_read2_b32 v[102:103], v11 offset0:34 offset1:35
    ds_read2_b32 v[104:105], v11 offset0:96 offset1:97
    ds_read2_b32 v[106:107], v11 offset0:98 offset1:99
    v_lshlrev_b32 v18, 3, v3
    v_sub_u32 v18, v8, v18
    v_lshrrev_b32 v19, 2, v2
    v_lshl_add_u32 v19, v19, 2, v3
    v_and_b32 v28, 3, v2
    v_lshlrev_b32 v28, 4, v28
    v_mul_u32_u24 v19, s8, v19
    v_xor_b32 v19, s10, v19
    s_waitcnt lgkmcnt(0)
    v_mov_b32 v7, v18
    v_add_u32 v6, v19, v28
    v_xor_b32 v12, s9, v12
W_34:
    ds_read_b32 v18, v4 offset:16
    s_sub_u32 s39, s39, 1
    s_cbranch_scc1 KS_ABORT
    s_waitcnt lgkmcnt(0)
    v_cmp_ne_u32 vcc, s84, v18
    s_cbranch_vccnz W_34
    s_setprio 1
    ds_read_b128 v[108:111], v8 offset:448
    ds_read_b128 v[112:115], v8 offset:512
    ds_read_b128 v[116:119], v8 offset:576
    ds_read_b128 v[120:123], v8 offset:640
    ds_read_b128 v[124:127], v8 offset:704
    s_waitcnt lgkmcnt(4)
    v_mfma_f32_16x16x32_f16 v[20:23], v[32:35], v[108:111], 0
    ds_read_b128 v[108:111], v8 offset:768
    s_waitcnt lgkmcnt(4)
    v_mfma_f32_16x16x32_f16 v[20:23], v[36:39], v[112:115], v[20:23]
    ds_read_b128 v[112:115], v8 offset:832
    s_waitcnt lgkmcnt(4)
    v_mfma_f32_16x16x32_f16 v[20:23], v[40:43], v[116:119], v[20:23]
    ds_read_b128 v[116:119], v8 offset:896
    ds_read_b64 v[28:29], v7 offset:1504
    ds_read_b64 v[30:31], v7 offset:2016
    s_waitcnt lgkmcnt(6)
    v_mfma_f32_16x16x32_f16 v[20:23], v[44:47], v[120:123], v[20:23]
    ds_read_b128 v[120:123], v8 offset:960
    s_waitcnt lgkmcnt(6)
    v_mfma_f32_16x16x32_f16 v[20:23], v[48:51], v[124:127], v[20:23]
    ds_read_b128 v[124:127], v8 offset:1024
    s_waitcnt lgkmcnt(6)
    v_mfma_f32_16x16x32_f16 v[20:23], v[52:55], v[108:111], v[20:23]
    ds_read_b128 v[108:111], v8 offset:1088
    s_waitcnt lgkmcnt(6)
    v_mfma_f32_16x16x32_f16 v[20:23], v[56:59], v[112:115], v[20:23]
    s_waitcnt lgkmcnt(5)
    v_mfma_f32_16x16x32_f16 v[20:23], v[60:63], v[116:119], v[20:23]
    ds_read_b128 v[112:115], v8 offset:1152
    s_waitcnt lgkmcnt(3)
    v_mfma_f32_16x16x32_f16 v[20:23], v[64:67], v[120:123], v[20:23]
    v_mfma_f32_16x16x32_f16 v[24:27], v[32:35], v[120:123], 0
    ds_read_b128 v[116:119], v8 offset:1216
    v_fma_mix_f32 v120, v28, v17, 0 op_sel_hi:[1,0,0]
    v_fma_mix_f32 v121, v28, v17, 0 op_sel:[1,0,0] op_sel_hi:[1,0,0]
    s_waitcnt lgkmcnt(3)
    v_mfma_f32_16x16x32_f16 v[20:23], v[68:71], v[124:127], v[20:23]
    v_fma_mix_f32 v122, v29, v17, 0 op_sel_hi:[1,0,0]
    v_fma_mix_f32 v123, v29, v17, 0 op_sel:[1,0,0] op_sel_hi:[1,0,0]
    v_mfma_f32_16x16x32_f16 v[24:27], v[36:39], v[124:127], v[24:27]
    ds_read_b128 v[32:35], v8 offset:1280
    v_cvt_pk_bf16_f32 v120, 0, v120
    v_cvt_pk_bf16_f32 v121, 0, v121
    s_waitcnt lgkmcnt(3)
    v_mfma_f32_16x16x32_f16 v[20:23], v[72:75], v[108:111], v[20:23]
    v_cvt_pk_bf16_f32 v122, 0, v122
    v_cvt_pk_bf16_f32 v123, 0, v123
    v_mfma_f32_16x16x32_f16 v[24:27], v[40:43], v[108:111], v[24:27]
    ds_read_b128 v[36:39], v8 offset:1344
    v_fma_mix_f32 v108, v30, v17, 0 op_sel_hi:[1,0,0]
    v_fma_mix_f32 v109, v30, v17, 0 op_sel:[1,0,0] op_sel_hi:[1,0,0]
    s_waitcnt lgkmcnt(3)
    v_mfma_f32_16x16x32_f16 v[20:23], v[76:79], v[112:115], v[20:23]
    v_fma_mix_f32 v110, v31, v17, 0 op_sel_hi:[1,0,0]
    v_fma_mix_f32 v111, v31, v17, 0 op_sel:[1,0,0] op_sel_hi:[1,0,0]
    v_mfma_f32_16x16x32_f16 v[24:27], v[44:47], v[112:115], v[24:27]
    ds_read_b128 v[124:127], v8 offset:1408
    v_cvt_pk_bf16_f32 v108, 0, v108
    v_cvt_pk_bf16_f32 v109, 0, v109
    s_waitcnt lgkmcnt(3)
    v_mfma_f32_16x16x32_f16 v[20:23], v[80:83], v[116:119], v[20:23]
    v_cvt_pk_bf16_f32 v110, 0, v110
    v_cvt_pk_bf16_f32 v111, 0, v111
    v_mfma_f32_16x16x32_f16 v[24:27], v[48:51], v[116:119], v[24:27]
    ds_read_b128 v[40:43], v8 offset:1472
    s_waitcnt lgkmcnt(3)
    v_mfma_f32_16x16x32_f16 v[20:23], v[84:87], v[32:35], v[20:23]
    v_mfma_f32_16x16x32_f16 v[24:27], v[52:55], v[32:35], v[24:27]
    ds_read_b128 v[44:47], v8 offset:1536
    s_waitcnt lgkmcnt(3)
    v_mfma_f32_16x16x32_f16 v[20:23], v[88:91], v[36:39], v[20:23]
    ds_read_b128 v[112:115], v8 offset:1600
    v_mfma_f32_16x16x32_f16 v[24:27], v[56:59], v[36:39], v[24:27]
    ds_read_b128 v[48:51], v8 offset:1664
    s_waitcnt lgkmcnt(4)
    v_mfma_f32_16x16x32_f16 v[20:23], v[92:95], v[124:127], v[20:23]
    ds_read_b128 v[116:119], v8 offset:1728
    v_mfma_f32_16x16x32_f16 v[24:27], v[60:63], v[124:127], v[24:27]
    ds_read_b128 v[52:55], v8 offset:1792
    s_waitcnt lgkmcnt(5)
    v_mfma_f32_16x16x32_f16 v[20:23], v[96:99], v[40:43], v[20:23]
    ds_read_b128 v[32:35], v8 offset:1856
    v_mfma_f32_16x16x32_f16 v[24:27], v[64:67], v[40:43], v[24:27]
    ds_read_b32 v18, v14 offset:76
    ds_read_b128 v[56:59], v8 offset:1920
    s_waitcnt lgkmcnt(7)
    v_mfma_f32_16x16x32_f16 v[24:27], v[68:71], v[44:47], v[24:27]
    ds_read_b128 v[36:39], v8 offset:1984
    s_waitcnt lgkmcnt(7)
    v_mfma_f32_16x16x32_f16 v[24:27], v[72:75], v[112:115], v[24:27]
    ds_read2_b32 v[60:61], v11 offset0:16 offset1:17
    ds_read2_b32 v[62:63], v11 offset0:18 offset1:19
    s_waitcnt lgkmcnt(8)
    v_mfma_f32_16x16x32_f16 v[24:27], v[76:79], v[48:51], v[24:27]
    s_waitcnt lgkmcnt(4)
    v_cmp_ne_u32 vcc, s84, v18
    s_cbranch_vccnz WS_35
WB_36:
    ds_read_b64_tr_b16 v[124:125], v9 offset:0
    ds_read_b64_tr_b16 v[126:127], v9 offset:64
    ds_read_b64_tr_b16 v[64:65], v9 offset:3088
    ds_read_b64_tr_b16 v[66:67], v9 offset:3152
    v_mfma_f32_16x16x32_f16 v[24:27], v[80:83], v[116:119], v[24:27]
    v_mfma_f32_16x16x32_f16 v[24:27], v[84:87], v[52:55], v[24:27]
    ds_read_b64_tr_b16 v[40:41], v9 offset:512
    ds_read_b64_tr_b16 v[42:43], v9 offset:576
    ds_read2_b32 v[68:69], v11 offset0:80 offset1:81
    ds_read2_b32 v[70:71], v11 offset0:82 offset1:83
    v_mfma_f32_16x16x32_f16 v[24:27], v[88:91], v[32:35], v[24:27]
    s_waitcnt lgkmcnt(11)
    v_mfma_f32_16x16x32_f16 v[24:27], v[92:95], v[56:59], v[24:27]
    ds_read_b64_tr_b16 v[44:45], v9 offset:3600
    ds_read_b64_tr_b16 v[46:47], v9 offset:3664
    s_waitcnt lgkmcnt(12)
    v_mfma_f32_16x16x32_f16 v[24:27], v[96:99], v[36:39], v[24:27]
    s_waitcnt lgkmcnt(8)
    v_mfma_f32_16x16x32_f16 v[20:23], v[124:127], v[100:103], v[20:23]
    s_waitcnt lgkmcnt(6)
    v_mfma_f32_16x16x32_f16 v[20:23], v[64:67], v[104:107], v[20:23]
    v_mfma_f32_16x16x32_f16 v[24:27], v[124:127], v[60:63], v[24:27]
    s_waitcnt lgkmcnt(4)
    v_mfma_f32_16x16x32_f16 v[24:27], v[40:43], v[100:103], v[24:27]
    s_nop 4
    v_mul_f32 v20, v20, v16
    v_mul_f32 v21, v21, v16
    s_waitcnt lgkmcnt(2)
    v_mfma_f32_16x16x32_f16 v[24:27], v[64:67], v[68:71], v[24:27]
    v_mul_f32 v22, v22, v16
    v_mul_f32 v23, v23, v16
    s_waitcnt lgkmcnt(0)
    v_mfma_f32_16x16x32_f16 v[24:27], v[44:47], v[104:107], v[24:27]
    v_cvt_pk_bf16_f32 v20, 0, v20
    v_cvt_pk_bf16_f32 v21, 0, v21
    v_cvt_pk_bf16_f32 v22, 0, v22
    v_cvt_pk_bf16_f32 v23, 0, v23
    v_add_f32 v20, v20, v120
    v_add_f32 v21, v21, v121
    v_add_f32 v22, v22, v122
    v_add_f32 v23, v23, v123
    v_cvt_pk_bf16_f32 v28, v20, v21
    v_cvt_pk_bf16_f32 v29, v22, v23
    v_min_u32 v28, -2, v28
    v_min_u32 v29, -2, v29
    ds_read_u8 v18, v4 offset:161
    ds_read_b128 v[20:23], v12 offset:47616
    v_mul_f32 v24, v24, v16
    v_mul_f32 v25, v25, v16
    v_mul_f32 v26, v26, v16
    v_mul_f32 v27, v27, v16
    v_cvt_pk_bf16_f32 v24, 0, v24
    v_cvt_pk_bf16_f32 v25, 0, v25
    v_cvt_pk_bf16_f32 v26, 0, v26
    v_cvt_pk_bf16_f32 v27, 0, v27
    v_add_f32 v24, v24, v108
    v_add_f32 v25, v25, v109
    v_add_f32 v26, v26, v110
    v_add_f32 v27, v27, v111
    v_cvt_pk_bf16_f32 v30, v24, v25
    v_cvt_pk_bf16_f32 v31, v26, v27
    v_min_u32 v30, -2, v30
    v_min_u32 v31, -2, v31
    s_branch CVE_32
CV_30:
    ds_read2_b32 v[32:33], v7 offset0:128 offset1:129
    ds_read2_b32 v[34:35], v7 offset0:130 offset1:131
    ds_read2_b32 v[36:37], v6 offset0:0 offset1:1
    ds_read2_b32 v[38:39], v6 offset0:2 offset1:3
    ds_read2_b32 v[40:41], v6 offset0:16 offset1:17
    ds_read2_b32 v[42:43], v6 offset0:18 offset1:19
    ds_read2_b32 v[44:45], v6 offset0:32 offset1:33
    ds_read2_b32 v[46:47], v6 offset0:34 offset1:35
    ds_read2_b32 v[48:49], v6 offset0:48 offset1:49
    ds_read2_b32 v[50:51], v6 offset0:50 offset1:51
    ds_read2_b32 v[52:53], v6 offset0:64 offset1:65
    ds_read2_b32 v[54:55], v6 offset0:66 offset1:67
    ds_read2_b32 v[56:57], v6 offset0:80 offset1:81
    ds_read2_b32 v[58:59], v6 offset0:82 offset1:83
    ds_read2_b32 v[60:61], v6 offset0:96 offset1:97
    ds_read2_b32 v[62:63], v6 offset0:98 offset1:99
    ds_read2_b32 v[64:65], v6 offset0:112 offset1:113
    ds_read2_b32 v[66:67], v6 offset0:114 offset1:115
    ds_read2_b32 v[68:69], v6 offset0:128 offset1:129
    ds_read2_b32 v[70:71], v6 offset0:130 offset1:131
    ds_read2_b32 v[72:73], v6 offset0:144 offset1:145
    ds_read2_b32 v[74:75], v6 offset0:146 offset1:147
    ds_read2_b32 v[76:77], v6 offset0:160 offset1:161
    ds_read2_b32 v[78:79], v6 offset0:162 offset1:163
    ds_read2_b32 v[80:81], v6 offset0:176 offset1:177
    ds_read2_b32 v[82:83], v6 offset0:178 offset1:179
    ds_read2_b32 v[84:85], v6 offset0:192 offset1:193
    ds_read2_b32 v[86:87], v6 offset0:194 offset1:195
    ds_read2_b32 v[88:89], v6 offset0:208 offset1:209
    ds_read2_b32 v[90:91], v6 offset0:210 offset1:211
    ds_read2_b32 v[92:93], v6 offset0:224 offset1:225
    ds_read2_b32 v[94:95], v6 offset0:226 offset1:227
    ds_read2_b32 v[96:97], v6 offset0:240 offset1:241
    ds_read2_b32 v[98:99], v6 offset0:242 offset1:243
    ds_read2_b32 v[100:101], v7 offset0:96 offset1:97
    ds_read2_b32 v[102:103], v7 offset0:98 offset1:99
    ds_read2_b32 v[104:105], v11 offset0:0 offset1:1
    ds_read2_b32 v[106:107], v11 offset0:2 offset1:3
    v_lshlrev_b32 v18, 3, v3
    v_sub_u32 v18, v8, v18
    v_lshrrev_b32 v19, 2, v2
    v_lshl_add_u32 v19, v19, 2, v3
    v_and_b32 v28, 3, v2
    v_lshlrev_b32 v28, 4, v28
    v_mul_u32_u24 v19, s8, v19
    v_xor_b32 v19, s10, v19
    s_waitcnt lgkmcnt(0)
    v_mov_b32 v7, v18
    v_add_u32 v6, v19, v28
    v_xor_b32 v12, s9, v12
W_37:
    ds_read_b32 v18, v4 offset:16
    s_sub_u32 s39, s39, 1
    s_cbranch_scc1 KS_ABORT
    s_waitcnt lgkmcnt(0)
    v_cmp_ne_u32 vcc, s84, v18
    s_cbranch_vccnz W_37
    s_setprio 1
    ds_read_b128 v[108:111], v8 offset:448
    ds_read_b128 v[112:115], v8 offset:960
    ds_read_b128 v[116:119], v8 offset:1472
    ds_read_b128 v[120:123], v8 offset:1536
    ds_read_b128 v[124:127], v8 offset:1600
    s_waitcnt lgkmcnt(4)
    v_mfma_f32_16x16x32_f16 v[20:23], v[32:35], v[108:111], 0
    ds_read_b128 v[108:111], v8 offset:1664
    s_waitcnt lgkmcnt(4)
    v_mfma_f32_16x16x32_f16 v[24:27], v[32:35], v[112:115], 0
    ds_read_b128 v[32:35], v8 offset:1728
    ds_read_b128 v[112:115], v8 offset:1792
    s_waitcnt lgkmcnt(5)
    v_mfma_f32_16x16x32_f16 v[20:23], v[36:39], v[116:119], v[20:23]
    ds_read_b128 v[116:119], v8 offset:1856
    ds_read_b64 v[28:29], v7 offset:2528
    ds_read_b64 v[30:31], v7 offset:3040
    s_waitcnt lgkmcnt(7)
    v_mfma_f32_16x16x32_f16 v[20:23], v[40:43], v[120:123], v[20:23]
    ds_read_b128 v[120:123], v8 offset:1920
    s_waitcnt lgkmcnt(7)
    v_mfma_f32_16x16x32_f16 v[20:23], v[44:47], v[124:127], v[20:23]
    ds_read_b128 v[124:127], v8 offset:1984
    s_waitcnt lgkmcnt(7)
    v_mfma_f32_16x16x32_f16 v[20:23], v[48:51], v[108:111], v[20:23]
    ds_read_b128 v[108:111], v8 offset:2048
    s_waitcnt lgkmcnt(7)
    v_mfma_f32_16x16x32_f16 v[20:23], v[52:55], v[32:35], v[20:23]
    s_waitcnt lgkmcnt(6)
    v_mfma_f32_16x16x32_f16 v[20:23], v[56:59], v[112:115], v[20:23]
    ds_read_b128 v[32:35], v8 offset:2112
    s_waitcnt lgkmcnt(6)
    v_mfma_f32_16x16x32_f16 v[20:23], v[60:63], v[116:119], v[20:23]
    s_waitcnt lgkmcnt(4)
    v_fma_mix_f32 v116, v28, v17, 0 op_sel_hi:[1,0,0]
    v_fma_mix_f32 v117, v28, v17, 0 op_sel:[1,0,0] op_sel_hi:[1,0,0]
    s_waitcnt lgkmcnt(3)
    v_mfma_f32_16x16x32_f16 v[20:23], v[64:67], v[120:123], v[20:23]
    ds_read_b128 v[112:115], v8 offset:2176
    v_fma_mix_f32 v118, v29, v17, 0 op_sel_hi:[1,0,0]
    v_fma_mix_f32 v119, v29, v17, 0 op_sel:[1,0,0] op_sel_hi:[1,0,0]
    s_waitcnt lgkmcnt(3)
    v_mfma_f32_16x16x32_f16 v[20:23], v[68:71], v[124:127], v[20:23]
    v_cvt_pk_bf16_f32 v116, 0, v116
    v_cvt_pk_bf16_f32 v117, 0, v117
    v_mfma_f32_16x16x32_f16 v[24:27], v[36:39], v[124:127], v[24:27]
    ds_read_b128 v[120:123], v8 offset:2240
    v_cvt_pk_bf16_f32 v118, 0, v118
    v_cvt_pk_bf16_f32 v119, 0, v119
    s_waitcnt lgkmcnt(3)
    v_mfma_f32_16x16x32_f16 v[20:23], v[72:75], v[108:111], v[20:23]
    v_fma_mix_f32 v124, v30, v17, 0 op_sel_hi:[1,0,0]
    v_fma_mix_f32 v125, v30, v17, 0 op_sel:[1,0,0] op_sel_hi:[1,0,0]
    v_mfma_f32_16x16x32_f16 v[24:27], v[40:43], v[108:111], v[24:27]
    ds_read_b128 v[36:39], v8 offset:2304
    v_fma_mix_f32 v126, v31, v17, 0 op_sel_hi:[1,0,0]
    v_fma_mix_f32 v127, v31, v17, 0 op_sel:[1,0,0] op_sel_hi:[1,0,0]
    s_waitcnt lgkmcnt(3)
    v_mfma_f32_16x16x32_f16 v[20:23], v[76:79], v[32:35], v[20:23]
    v_cvt_pk_bf16_f32 v124, 0, v124
    v_cvt_pk_bf16_f32 v125, 0, v125
    v_mfma_f32_16x16x32_f16 v[24:27], v[44:47], v[32:35], v[24:27]
    ds_read_b128 v[40:43], v8 offset:2368
    v_cvt_pk_bf16_f32 v126, 0, v126
    v_cvt_pk_bf16_f32 v127, 0, v127
    s_waitcnt lgkmcnt(3)
    v_mfma_f32_16x16x32_f16 v[20:23], v[80:83], v[112:115], v[20:23]
    v_mfma_f32_16x16x32_f16 v[24:27], v[48:51], v[112:115], v[24:27]
    ds_read_b128 v[108:111], v8 offset:2432
    s_waitcnt lgkmcnt(3)
    v_mfma_f32_16x16x32_f16 v[20:23], v[84:87], v[120:123], v[20:23]
    v_mfma_f32_16x16x32_f16 v[24:27], v[52:55], v[120:123], v[24:27]
    ds_read_b128 v[44:47], v8 offset:2496
    s_waitcnt lgkmcnt(3)
    v_mfma_f32_16x16x32_f16 v[20:23], v[88:91], v[36:39], v[20:23]
    v_mfma_f32_16x16x32_f16 v[24:27], v[56:59], v[36:39], v[24:27]
    ds_read_b128 v[32:35], v8 offset:2560
    s_waitcnt lgkmcnt(3)
    v_mfma_f32_16x16x32_f16 v[20:23], v[92:95], v[40:43], v[20:23]
    ds_read_b128 v[48:51], v8 offset:2624
    v_mfma_f32_16x16x32_f16 v[24:27], v[60:63], v[40:43], v[24:27]
    ds_read_b128 v[112:115], v8 offset:2688
    s_waitcnt lgkmcnt(4)
    v_mfma_f32_16x16x32_f16 v[20:23], v[96:99], v[108:111], v[20:23]
    ds_read_b128 v[52:55], v8 offset:2752
    v_mfma_f32_16x16x32_f16 v[24:27], v[64:67], v[108:111], v[24:27]
    ds_read_b128 v[120:123], v8 offset:2816
    s_waitcnt lgkmcnt(5)
    v_mfma_f32_16x16x32_f16 v[20:23], v[100:103], v[44:47], v[20:23]
    ds_read_b128 v[56:59], v8 offset:2880
    v_mfma_f32_16x16x32_f16 v[24:27], v[68:71], v[44:47], v[24:27]
    ds_read_b32 v18, v14 offset:76
    ds_read_b128 v[36:39], v8 offset:2944
    s_waitcnt lgkmcnt(7)
    v_mfma_f32_16x16x32_f16 v[24:27], v[72:75], v[32:35], v[24:27]
    ds_read_b128 v[60:63], v8 offset:3008
    s_waitcnt lgkmcnt(7)
    v_mfma_f32_16x16x32_f16 v[24:27], v[76:79], v[48:51], v[24:27]
    ds_read2_b32 v[40:41], v11 offset0:16 offset1:17
    ds_read2_b32 v[42:43], v11 offset0:18 offset1:19
    ds_read2_b32 v[64:65], v11 offset0:32 offset1:33
    ds_read2_b32 v[66:67], v11 offset0:34 offset1:35
    s_waitcnt lgkmcnt(10)
    v_mfma_f32_16x16x32_f16 v[24:27], v[80:83], v[112:115], v[24:27]
    s_waitcnt lgkmcnt(6)
    v_cmp_ne_u32 vcc, s84, v18
    s_cbranch_vccnz WS_38
WB_39:
    ds_read_b64_tr_b16 v[108:109], v9 offset:0
    ds_read_b64_tr_b16 v[110:111], v9 offset:64
    ds_read_b64_tr_b16 v[68:69], v9 offset:512
    ds_read_b64_tr_b16 v[70:71], v9 offset:576
    v_mfma_f32_16x16x32_f16 v[24:27], v[84:87], v[52:55], v[24:27]
    ds_read_b64_tr_b16 v[44:45], v9 offset:1024
    ds_read_b64_tr_b16 v[46:47], v9 offset:1088
    v_mfma_f32_16x16x32_f16 v[24:27], v[88:91], v[120:123], v[24:27]
    ds_read_b64_tr_b16 v[72:73], v9 offset:3088
    ds_read_b64_tr_b16 v[74:75], v9 offset:3152
    ds_read2_b32 v[32:33], v11 offset0:64 offset1:65
    ds_read2_b32 v[34:35], v11 offset0:66 offset1:67
    v_mfma_f32_16x16x32_f16 v[24:27], v[92:95], v[56:59], v[24:27]
    ds_read_b64_tr_b16 v[76:77], v9 offset:3600
    ds_read_b64_tr_b16 v[78:79], v9 offset:3664
    ds_read2_b32 v[48:49], v11 offset0:80 offset1:81
    ds_read2_b32 v[50:51], v11 offset0:82 offset1:83
    v_mfma_f32_16x16x32_f16 v[24:27], v[96:99], v[36:39], v[24:27]
    ds_read_b64_tr_b16 v[80:81], v9 offset:4112
    ds_read_b64_tr_b16 v[82:83], v9 offset:4176
    ds_read2_b32 v[112:113], v11 offset0:96 offset1:97
    ds_read2_b32 v[114:115], v11 offset0:98 offset1:99
    v_mfma_f32_16x16x32_f16 v[24:27], v[100:103], v[60:63], v[24:27]
    ds_read_b64_tr_b16 v[84:85], v10 offset:6176
    ds_read_b64_tr_b16 v[86:87], v10 offset:6304
    ds_read2_b32 v[52:53], v13 offset0:24 offset1:25
    ds_read2_b32 v[54:55], v13 offset0:26 offset1:27
    v_mfma_f32_16x16x32_f16 v[20:23], v[108:111], v[104:107], v[20:23]
    ds_read_b64_tr_b16 v[88:89], v10 offset:8224
    ds_read_b64_tr_b16 v[90:91], v10 offset:8352
    ds_read2_b32 v[120:121], v13 offset0:120 offset1:121
    ds_read2_b32 v[122:123], v13 offset0:122 offset1:123
    v_mfma_f32_16x16x32_f16 v[20:23], v[68:71], v[40:43], v[20:23]
    v_mfma_f32_16x16x32_f16 v[20:23], v[44:47], v[64:67], v[20:23]
    v_mfma_f32_16x16x32_f16 v[20:23], v[72:75], v[32:35], v[20:23]
    ds_read_b64_tr_b16 v[92:93], v9 offset:1536
    ds_read_b64_tr_b16 v[94:95], v9 offset:1600
    s_waitcnt lgkmcnt(14)
    v_mfma_f32_16x16x32_f16 v[20:23], v[76:79], v[48:51], v[20:23]
    s_waitcnt lgkmcnt(10)
    v_mfma_f32_16x16x32_f16 v[20:23], v[80:83], v[112:115], v[20:23]
    s_waitcnt lgkmcnt(6)
    v_mfma_f32_16x16x32_f16 v[20:23], v[84:87], v[52:55], v[20:23]
    ds_read_b64_tr_b16 v[56:57], v9 offset:4624
    ds_read_b64_tr_b16 v[58:59], v9 offset:4688
    ds_read2_b32 v[96:97], v13 offset0:16 offset1:17
    ds_read2_b32 v[98:99], v13 offset0:18 offset1:19
    s_waitcnt lgkmcnt(6)
    v_mfma_f32_16x16x32_f16 v[20:23], v[88:91], v[120:123], v[20:23]
    ds_read2_b32 v[36:37], v13 offset0:112 offset1:113
    ds_read2_b32 v[38:39], v13 offset0:114 offset1:115
    v_mfma_f32_16x16x32_f16 v[24:27], v[68:71], v[104:107], v[24:27]
    v_mfma_f32_16x16x32_f16 v[24:27], v[44:47], v[40:43], v[24:27]
    s_nop 3
    v_mul_f32 v20, v20, v16
    v_mul_f32 v21, v21, v16
    s_waitcnt lgkmcnt(6)
    v_mfma_f32_16x16x32_f16 v[24:27], v[92:95], v[64:67], v[24:27]
    v_mul_f32 v22, v22, v16
    v_mul_f32 v23, v23, v16
    v_mfma_f32_16x16x32_f16 v[24:27], v[76:79], v[32:35], v[24:27]
    v_cvt_pk_bf16_f32 v20, 0, v20
    v_cvt_pk_bf16_f32 v21, 0, v21
    v_mfma_f32_16x16x32_f16 v[24:27], v[80:83], v[48:51], v[24:27]
    v_cvt_pk_bf16_f32 v22, 0, v22
    v_cvt_pk_bf16_f32 v23, 0, v23
    s_waitcnt lgkmcnt(4)
    v_mfma_f32_16x16x32_f16 v[24:27], v[56:59], v[112:115], v[24:27]
    v_add_f32 v20, v20, v116
    v_add_f32 v21, v21, v117
    s_waitcnt lgkmcnt(2)
    v_mfma_f32_16x16x32_f16 v[24:27], v[84:87], v[96:99], v[24:27]
    v_add_f32 v22, v22, v118
    v_add_f32 v23, v23, v119
    s_waitcnt lgkmcnt(0)
    v_mfma_f32_16x16x32_f16 v[24:27], v[88:91], v[36:39], v[24:27]
    v_cvt_pk_bf16_f32 v28, v20, v21
    v_cvt_pk_bf16_f32 v29, v22, v23
    v_min_u32 v28, -2, v28
    v_min_u32 v29, -2, v29
    ds_read_u8 v18, v4 offset:162
    ds_read_b128 v[20:23], v12 offset:48640
    s_nop 1
    v_mul_f32 v24, v24, v16
    v_mul_f32 v25, v25, v16
    v_mul_f32 v26, v26, v16
    v_mul_f32 v27, v27, v16
    v_cvt_pk_bf16_f32 v24, 0, v24
    v_cvt_pk_bf16_f32 v25, 0, v25
    v_cvt_pk_bf16_f32 v26, 0, v26
    v_cvt_pk_bf16_f32 v27, 0, v27
    v_add_f32 v24, v24, v124
    v_add_f32 v25, v25, v125
    v_add_f32 v26, v26, v126
    v_add_f32 v27, v27, v127
    v_cvt_pk_bf16_f32 v30, v24, v25
    v_cvt_pk_bf16_f32 v31, v26, v27
    v_min_u32 v30, -2, v30
    v_min_u32 v31, -2, v31
    s_branch CVE_32
CV_31:
    ds_read2_b32 v[32:33], v7 offset0:128 offset1:129
    ds_read2_b32 v[34:35], v7 offset0:130 offset1:131
    ds_read2_b32 v[36:37], v6 offset0:0 offset1:1
    ds_read2_b32 v[38:39], v6 offset0:2 offset1:3
    ds_read2_b32 v[40:41], v6 offset0:16 offset1:17
    ds_read2_b32 v[42:43], v6 offset0:18 offset1:19
    ds_read2_b32 v[44:45], v6 offset0:32 offset1:33
    ds_read2_b32 v[46:47], v6 offset0:34 offset1:35
    ds_read2_b32 v[48:49], v6 offset0:48 offset1:49
    ds_read2_b32 v[50:51], v6 offset0:50 offset1:51
    ds_read2_b32 v[52:53], v6 offset0:64 offset1:65
    ds_read2_b32 v[54:55], v6 offset0:66 offset1:67
    ds_read2_b32 v[56:57], v6 offset0:80 offset1:81
    ds_read2_b32 v[58:59], v6 offset0:82 offset1:83
    ds_read2_b32 v[60:61], v6 offset0:96 offset1:97
    ds_read2_b32 v[62:63], v6 offset0:98 offset1:99
    ds_read2_b32 v[64:65], v6 offset0:112 offset1:113
    ds_read2_b32 v[66:67], v6 offset0:114 offset1:115
    ds_read2_b32 v[68:69], v6 offset0:128 offset1:129
    ds_read2_b32 v[70:71], v6 offset0:130 offset1:131
    ds_read2_b32 v[72:73], v6 offset0:144 offset1:145
    ds_read2_b32 v[74:75], v6 offset0:146 offset1:147
    ds_read2_b32 v[76:77], v6 offset0:160 offset1:161
    ds_read2_b32 v[78:79], v6 offset0:162 offset1:163
    ds_read2_b32 v[80:81], v6 offset0:176 offset1:177
    ds_read2_b32 v[82:83], v6 offset0:178 offset1:179
    ds_read2_b32 v[84:85], v6 offset0:192 offset1:193
    ds_read2_b32 v[86:87], v6 offset0:194 offset1:195
    ds_read2_b32 v[88:89], v6 offset0:208 offset1:209
    ds_read2_b32 v[90:91], v6 offset0:210 offset1:211
    ds_read2_b32 v[92:93], v6 offset0:224 offset1:225
    ds_read2_b32 v[94:95], v6 offset0:226 offset1:227
    ds_read2_b32 v[96:97], v6 offset0:240 offset1:241
    ds_read2_b32 v[98:99], v6 offset0:242 offset1:243
    ds_read2_b32 v[100:101], v7 offset0:96 offset1:97
    ds_read2_b32 v[102:103], v7 offset0:98 offset1:99
    ds_read2_b32 v[104:105], v11 offset0:0 offset1:1
    ds_read2_b32 v[106:107], v11 offset0:2 offset1:3
    v_lshlrev_b32 v18, 3, v3
    v_sub_u32 v18, v8, v18
    v_lshrrev_b32 v19, 2, v2
    v_lshl_add_u32 v19, v19, 2, v3
    v_and_b32 v28, 3, v2
    v_lshlrev_b32 v28, 4, v28
    v_mul_u32_u24 v19, s8, v19
    v_xor_b32 v19, s10, v19
    s_waitcnt lgkmcnt(0)
    v_mov_b32 v7, v18
    v_add_u32 v6, v19, v28
    v_xor_b32 v12, s9, v12
W_40:
    ds_read_b32 v18, v4 offset:16
    s_sub_u32 s39, s39, 1
    s_cbranch_scc1 KS_ABORT
    s_waitcnt lgkmcnt(0)
    v_cmp_ne_u32 vcc, s84, v18
    s_cbranch_vccnz W_40
    s_setprio 1
    ds_read_b128 v[108:111], v8 offset:1472
    ds_read_b128 v[112:115], v8 offset:1984
    ds_read_b128 v[116:119], v8 offset:2496
    ds_read_b128 v[120:123], v8 offset:2560
    ds_read_b128 v[124:127], v8 offset:2624
    s_waitcnt lgkmcnt(4)
    v_mfma_f32_16x16x32_f16 v[20:23], v[32:35], v[108:111], 0
    ds_read_b128 v[108:111], v8 offset:2688
    s_waitcnt lgkmcnt(4)
    v_mfma_f32_16x16x32_f16 v[24:27], v[32:35], v[112:115], 0
    ds_read_b128 v[32:35], v8 offset:2752
    ds_read_b128 v[112:115], v8 offset:2816
    s_waitcnt lgkmcnt(5)
    v_mfma_f32_16x16x32_f16 v[20:23], v[36:39], v[116:119], v[20:23]
    ds_read_b128 v[116:119], v8 offset:2880
    ds_read_b64 v[28:29], v7 offset:3552
    ds_read_b64 v[30:31], v7 offset:4064
    s_waitcnt lgkmcnt(7)
    v_mfma_f32_16x16x32_f16 v[20:23], v[40:43], v[120:123], v[20:23]
    ds_read_b128 v[120:123], v8 offset:2944
    s_waitcnt lgkmcnt(7)
    v_mfma_f32_16x16x32_f16 v[20:23], v[44:47], v[124:127], v[20:23]
    ds_read_b128 v[124:127], v8 offset:3008
    s_waitcnt lgkmcnt(7)
    v_mfma_f32_16x16x32_f16 v[20:23], v[48:51], v[108:111], v[20:23]
    ds_read_b128 v[108:111], v8 offset:3072
    s_waitcnt lgkmcnt(7)
    v_mfma_f32_16x16x32_f16 v[20:23], v[52:55], v[32:35], v[20:23]
    s_waitcnt lgkmcnt(6)
    v_mfma_f32_16x16x32_f16 v[20:23], v[56:59], v[112:115], v[20:23]
    ds_read_b128 v[32:35], v8 offset:3136
    s_waitcnt lgkmcnt(6)
    v_mfma_f32_16x16x32_f16 v[20:23], v[60:63], v[116:119], v[20:23]
    s_waitcnt lgkmcnt(4)
    v_fma_mix_f32 v116, v28, v17, 0 op_sel_hi:[1,0,0]
    v_fma_mix_f32 v117, v28, v17, 0 op_sel:[1,0,0] op_sel_hi:[1,0,0]
    s_waitcnt lgkmcnt(3)
    v_mfma_f32_16x16x32_f16 v[20:23], v[64:67], v[120:123], v[20:23]
    ds_read_b128 v[112:115], v8 offset:3200
    v_fma_mix_f32 v118, v29, v17, 0 op_sel_hi:[1,0,0]
    v_fma_mix_f32 v119, v29, v17, 0 op_sel:[1,0,0] op_sel_hi:[1,0,0]
    s_waitcnt lgkmcnt(3)
    v_mfma_f32_16x16x32_f16 v[20:23], v[68:71], v[124:127], v[20:23]
    v_cvt_pk_bf16_f32 v116, 0, v116
    v_cvt_pk_bf16_f32 v117, 0, v117
    v_mfma_f32_16x16x32_f16 v[24:27], v[36:39], v[124:127], v[24:27]
    ds_read_b128 v[120:123], v8 offset:3264
    v_cvt_pk_bf16_f32 v118, 0, v118
    v_cvt_pk_bf16_f32 v119, 0, v119
    s_waitcnt lgkmcnt(3)
    v_mfma_f32_16x16x32_f16 v[20:23], v[72:75], v[108:111], v[20:23]
    v_fma_mix_f32 v124, v30, v17, 0 op_sel_hi:[1,0,0]
    v_fma_mix_f32 v125, v30, v17, 0 op_sel:[1,0,0] op_sel_hi:[1,0,0]
    v_mfma_f32_16x16x32_f16 v[24:27], v[40:43], v[108:111], v[24:27]
    ds_read_b128 v[36:39], v8 offset:3328
    v_fma_mix_f32 v126, v31, v17, 0 op_sel_hi:[1,0,0]
    v_fma_mix_f32 v127, v31, v17, 0 op_sel:[1,0,0] op_sel_hi:[1,0,0]
    s_waitcnt lgkmcnt(3)
    v_mfma_f32_16x16x32_f16 v[20:23], v[76:79], v[32:35], v[20:23]
    v_cvt_pk_bf16_f32 v124, 0, v124
    v_cvt_pk_bf16_f32 v125, 0, v125
    v_mfma_f32_16x16x32_f16 v[24:27], v[44:47], v[32:35], v[24:27]
    ds_read_b128 v[40:43], v8 offset:3392
    v_cvt_pk_bf16_f32 v126, 0, v126
    v_cvt_pk_bf16_f32 v127, 0, v127
    s_waitcnt lgkmcnt(3)
    v_mfma_f32_16x16x32_f16 v[20:23], v[80:83], v[112:115], v[20:23]
    v_mfma_f32_16x16x32_f16 v[24:27], v[48:51], v[112:115], v[24:27]
    ds_read_b128 v[108:111], v8 offset:3456
    s_waitcnt lgkmcnt(3)
    v_mfma_f32_16x16x32_f16 v[20:23], v[84:87], v[120:123], v[20:23]
    v_mfma_f32_16x16x32_f16 v[24:27], v[52:55], v[120:123], v[24:27]
    ds_read_b128 v[44:47], v8 offset:3520
    s_waitcnt lgkmcnt(3)
    v_mfma_f32_16x16x32_f16 v[20:23], v[88:91], v[36:39], v[20:23]
    v_mfma_f32_16x16x32_f16 v[24:27], v[56:59], v[36:39], v[24:27]
    ds_read_b128 v[32:35], v8 offset:3584
    s_waitcnt lgkmcnt(3)
    v_mfma_f32_16x16x32_f16 v[20:23], v[92:95], v[40:43], v[20:23]
    ds_read_b128 v[48:51], v8 offset:3648
    v_mfma_f32_16x16x32_f16 v[24:27], v[60:63], v[40:43], v[24:27]
    ds_read_b128 v[112:115], v8 offset:3712
    s_waitcnt lgkmcnt(4)
    v_mfma_f32_16x16x32_f16 v[20:23], v[96:99], v[108:111], v[20:23]
    ds_read_b128 v[52:55], v8 offset:3776
    v_mfma_f32_16x16x32_f16 v[24:27], v[64:67], v[108:111], v[24:27]
    ds_read_b128 v[120:123], v8 offset:3840
    s_waitcnt lgkmcnt(5)
    v_mfma_f32_16x16x32_f16 v[20:23], v[100:103], v[44:47], v[20:23]
    ds_read_b128 v[56:59], v8 offset:3904
    v_mfma_f32_16x16x32_f16 v[24:27], v[68:71], v[44:47], v[24:27]
    ds_read_b32 v18, v14 offset:76
    ds_read_b128 v[36:39], v8 offset:3968
    s_waitcnt lgkmcnt(7)
    v_mfma_f32_16x16x32_f16 v[24:27], v[72:75], v[32:35], v[24:27]
    ds_read_b128 v[60:63], v8 offset:4032
    s_waitcnt lgkmcnt(7)
    v_mfma_f32_16x16x32_f16 v[24:27], v[76:79], v[48:51], v[24:27]
    ds_read2_b32 v[40:41], v11 offset0:16 offset1:17
    ds_read2_b32 v[42:43], v11 offset0:18 offset1:19
    ds_read2_b32 v[64:65], v11 offset0:32 offset1:33
    ds_read2_b32 v[66:67], v11 offset0:34 offset1:35
    s_waitcnt lgkmcnt(10)
    v_mfma_f32_16x16x32_f16 v[24:27], v[80:83], v[112:115], v[24:27]
    s_waitcnt lgkmcnt(6)
    v_cmp_ne_u32 vcc, s84, v18
    s_cbranch_vccnz WS_41
WB_42:
    ds_read_b64_tr_b16 v[108:109], v9 offset:1024
    ds_read_b64_tr_b16 v[110:111], v9 offset:1088
    ds_read_b64_tr_b16 v[68:69], v9 offset:1536
    ds_read_b64_tr_b16 v[70:71], v9 offset:1600
    v_mfma_f32_16x16x32_f16 v[24:27], v[84:87], v[52:55], v[24:27]
    ds_read_b64_tr_b16 v[44:45], v9 offset:2048
    ds_read_b64_tr_b16 v[46:47], v9 offset:2112
    v_mfma_f32_16x16x32_f16 v[24:27], v[88:91], v[120:123], v[24:27]
    ds_read_b64_tr_b16 v[72:73], v9 offset:4112
    ds_read_b64_tr_b16 v[74:75], v9 offset:4176
    ds_read2_b32 v[32:33], v11 offset0:64 offset1:65
    ds_read2_b32 v[34:35], v11 offset0:66 offset1:67
    v_mfma_f32_16x16x32_f16 v[24:27], v[92:95], v[56:59], v[24:27]
    ds_read_b64_tr_b16 v[76:77], v9 offset:4624
    ds_read_b64_tr_b16 v[78:79], v9 offset:4688
    ds_read2_b32 v[48:49], v11 offset0:80 offset1:81
    ds_read2_b32 v[50:51], v11 offset0:82 offset1:83
    v_mfma_f32_16x16x32_f16 v[24:27], v[96:99], v[36:39], v[24:27]
    ds_read_b64_tr_b16 v[80:81], v9 offset:5136
    ds_read_b64_tr_b16 v[82:83], v9 offset:5200
    ds_read2_b32 v[112:113], v11 offset0:96 offset1:97
    ds_read2_b32 v[114:115], v11 offset0:98 offset1:99
    v_mfma_f32_16x16x32_f16 v[24:27], v[100:103], v[60:63], v[24:27]
    ds_read_b64_tr_b16 v[84:85], v10 offset:6176
    ds_read_b64_tr_b16 v[86:87], v10 offset:6304
    ds_read2_b32 v[52:53], v13 offset0:8 offset1:9
    ds_read2_b32 v[54:55], v13 offset0:10 offset1:11
    v_mfma_f32_16x16x32_f16 v[20:23], v[108:111], v[104:107], v[20:23]
    ds_read_b64_tr_b16 v[88:89], v10 offset:7200
    ds_read_b64_tr_b16 v[90:91], v10 offset:7328
    ds_read2_b32 v[120:121], v13 offset0:24 offset1:25
    ds_read2_b32 v[122:123], v13 offset0:26 offset1:27
    v_mfma_f32_16x16x32_f16 v[20:23], v[68:71], v[40:43], v[20:23]
    ds_read_b64_tr_b16 v[92:93], v10 offset:8224
    ds_read_b64_tr_b16 v[94:95], v10 offset:8352
    ds_read2_b32 v[56:57], v13 offset0:104 offset1:105
    ds_read2_b32 v[58:59], v13 offset0:106 offset1:107
    v_mfma_f32_16x16x32_f16 v[20:23], v[44:47], v[64:67], v[20:23]
    ds_read_b64_tr_b16 v[96:97], v10 offset:9248
    ds_read_b64_tr_b16 v[98:99], v10 offset:9376
    ds_read2_b32 v[36:37], v13 offset0:120 offset1:121
    ds_read2_b32 v[38:39], v13 offset0:122 offset1:123
    v_mfma_f32_16x16x32_f16 v[20:23], v[72:75], v[32:35], v[20:23]
    v_mfma_f32_16x16x32_f16 v[20:23], v[76:79], v[48:51], v[20:23]
    v_mfma_f32_16x16x32_f16 v[20:23], v[80:83], v[112:115], v[20:23]
    ds_read_b64_tr_b16 v[100:101], v9 offset:2560
    ds_read_b64_tr_b16 v[102:103], v9 offset:2624
    s_waitcnt lgkmcnt(14)
    v_mfma_f32_16x16x32_f16 v[20:23], v[84:87], v[52:55], v[20:23]
    s_waitcnt lgkmcnt(10)
    v_mfma_f32_16x16x32_f16 v[20:23], v[88:91], v[120:123], v[20:23]
    s_waitcnt lgkmcnt(6)
    v_mfma_f32_16x16x32_f16 v[20:23], v[92:95], v[56:59], v[20:23]
    ds_read_b64_tr_b16 v[60:61], v9 offset:5648
    ds_read_b64_tr_b16 v[62:63], v9 offset:5712
    ds_read2_b32 v[108:109], v13 offset0:0 offset1:1
    ds_read2_b32 v[110:111], v13 offset0:2 offset1:3
    s_waitcnt lgkmcnt(6)
    v_mfma_f32_16x16x32_f16 v[20:23], v[96:99], v[36:39], v[20:23]
    ds_read2_b32 v[72:73], v13 offset0:16 offset1:17
    ds_read2_b32 v[74:75], v13 offset0:18 offset1:19
    ds_read2_b32 v[52:53], v13 offset0:96 offset1:97
    ds_read2_b32 v[54:55], v13 offset0:98 offset1:99
    v_mfma_f32_16x16x32_f16 v[24:27], v[68:71], v[104:107], v[24:27]
    ds_read2_b32 v[120:121], v13 offset0:112 offset1:113
    ds_read2_b32 v[122:123], v13 offset0:114 offset1:115
    v_mfma_f32_16x16x32_f16 v[24:27], v[44:47], v[40:43], v[24:27]
    v_mul_f32 v20, v20, v16
    v_mul_f32 v21, v21, v16
    s_waitcnt lgkmcnt(10)
    v_mfma_f32_16x16x32_f16 v[24:27], v[100:103], v[64:67], v[24:27]
    v_mul_f32 v22, v22, v16
    v_mul_f32 v23, v23, v16
    v_mfma_f32_16x16x32_f16 v[24:27], v[76:79], v[32:35], v[24:27]
    v_cvt_pk_bf16_f32 v20, 0, v20
    v_cvt_pk_bf16_f32 v21, 0, v21
    v_mfma_f32_16x16x32_f16 v[24:27], v[80:83], v[48:51], v[24:27]
    v_cvt_pk_bf16_f32 v22, 0, v22
    v_cvt_pk_bf16_f32 v23, 0, v23
    s_waitcnt lgkmcnt(8)
    v_mfma_f32_16x16x32_f16 v[24:27], v[60:63], v[112:115], v[24:27]
    v_add_f32 v20, v20, v116
    v_add_f32 v21, v21, v117
    s_waitcnt lgkmcnt(6)
    v_mfma_f32_16x16x32_f16 v[24:27], v[84:87], v[108:111], v[24:27]
    v_add_f32 v22, v22, v118
    v_add_f32 v23, v23, v119
    s_waitcnt lgkmcnt(4)
    v_mfma_f32_16x16x32_f16 v[24:27], v[88:91], v[72:75], v[24:27]
    v_cvt_pk_bf16_f32 v28, v20, v21
    v_cvt_pk_bf16_f32 v29, v22, v23
    s_waitcnt lgkmcnt(2)
    v_mfma_f32_16x16x32_f16 v[24:27], v[92:95], v[52:55], v[24:27]
    v_min_u32 v28, -2, v28
    v_min_u32 v29, -2, v29
    s_waitcnt lgkmcnt(0)
    v_mfma_f32_16x16x32_f16 v[24:27], v[96:99], v[120:123], v[24:27]
    ds_read_u8 v18, v4 offset:163
    ds_read_b128 v[20:23], v12 offset:49664
    s_nop 5
    v_mul_f32 v24, v24, v16
    v_mul_f32 v25, v25, v16
    v_mul_f32 v26, v26, v16
    v_mul_f32 v27, v27, v16
    v_cvt_pk_bf16_f32 v24, 0, v24
    v_cvt_pk_bf16_f32 v25, 0, v25
    v_cvt_pk_bf16_f32 v26, 0, v26
    v_cvt_pk_bf16_f32 v27, 0, v27
    v_add_f32 v24, v24, v124
    v_add_f32 v25, v25, v125
    v_add_f32 v26, v26, v126
    v_add_f32 v27, v27, v127
    v_cvt_pk_bf16_f32 v30, v24, v25
    v_cvt_pk_bf16_f32 v31, v26, v27
    v_min_u32 v30, -2, v30
    v_min_u32 v31, -2, v31
CVE_32:
    s_waitcnt lgkmcnt(0)
    s_cmp_lg_u32 s87, 1
    s_cbranch_scc1 ZA_43
    v_cmp_ne_u32 vcc, 1, v18
    s_cbranch_vccnz ZS_45
ZB_46:
    s_mov_b64 exec, s[12:13]
    v_swap_b32 v28, v20
    v_swap_b32 v29, v21
    v_swap_b32 v30, v22
    v_swap_b32 v31, v23
    s_mov_b64 exec, -1
    buffer_store_dwordx4 v[28:31], v6, s[64:67], s7 offen sc1
    buffer_store_dwordx4 v[20:23], v6, s[64:67], s6 offen sc1
    s_branch ZD_48
WS_35:
W_49:
    ds_read_b32 v18, v14 offset:76
    s_sub_u32 s39, s39, 1
    s_cbranch_scc1 KS_ABORT
    s_waitcnt lgkmcnt(0)
    v_cmp_ne_u32 vcc, s84, v18
    s_cbranch_vccnz W_49
    s_branch WB_36
WS_38:
W_50:
    ds_read_b32 v18, v14 offset:76
    s_sub_u32 s39, s39, 1
    s_cbranch_scc1 KS_ABORT
    s_waitcnt lgkmcnt(0)
    v_cmp_ne_u32 vcc, s84, v18
    s_cbranch_vccnz W_50
    s_branch WB_39
WS_41:
W_51:
    ds_read_b32 v18, v14 offset:76
    s_sub_u32 s39, s39, 1
    s_cbranch_scc1 KS_ABORT
    s_waitcnt lgkmcnt(0)
    v_cmp_ne_u32 vcc, s84, v18
    s_cbranch_vccnz W_51
    s_branch WB_42
ZS_45:
    v_mov_b32 v19, s86
ZW_52:
    ds_read_u8 v18, v19 offset:160
    s_sub_u32 s39, s39, 1
    s_cbranch_scc1 KS_ABORT
    s_waitcnt lgkmcnt(0)
    v_cmp_ne_u32 vcc, 1, v18
    s_cbranch_vccnz ZW_52
    v_lshl_add_u32 v19, v19, 10, v12
    ds_read_b128 v[20:23], v19 offset:46592
    s_waitcnt lgkmcnt(0)
    s_branch ZB_46
ZA_43:
    s_cmp_lg_u32 s87, 0
    s_cbranch_scc1 ZC_44
    v_mov_b32 v19, s86
    v_lshl_add_u32 v18, v19, 10, v12
    ds_write_b128 v18, v[28:31] offset:46592
    ds_write_b8 v19, v5 offset:160
    s_branch ZD_48
ZC_44:
    buffer_store_dwordx4 v[28:31], v6, s[64:67], s6 offen sc1
ZD_48:
    s_lshl_b32 s92, s87, 2
    s_add_u32 s92, s92, s86
    v_mov_b32 v8, s92
    s_waitcnt vmcnt(0)
    ds_write_b8 v8, v5 offset:48
    s_branch KS_K1
    s_cmp_lg_u32 s38, 4
    s_cbranch_scc1 KS_K1
    s_setprio 0
    s_add_u32 s76, s36, 0x840000
    s_addc_u32 s77, s37, 0
    s_mov_b32 s78, 0x3000
    s_mov_b32 s79, 0x20000
    v_and_b32 v6, 1, v1
    v_lshlrev_b32 v6, 4, v6
    s_lshl_b32 s92, s90, 5
W_53:
    s_sleep 1
    ds_read_b32 v8, v4 offset:20
    s_sub_u32 s39, s39, 1
    s_cbranch_scc1 KS_ABORT
    s_waitcnt lgkmcnt(0)
    v_cmp_ne_u32 vcc, s84, v8
    s_cbranch_vccnz W_53
    s_mov_b64 exec, 3
    s_setprio 1
KS_K0:
    ds_read_b128 v[8:11], v6 offset:800
    s_sub_u32 s39, s39, 1
    s_cbranch_scc1 KS_ABORT
    s_waitcnt lgkmcnt(0)
    v_min3_u32 v12, v8, v9, v10
    v_min_u32 v12, v12, v11
    v_cmp_eq_u32 vcc, 0, v12
    s_cbranch_vccnz KS_K0
    buffer_store_dwordx4 v[8:11], v6, s[76:79], s92 offen sc1
    s_mov_b64 exec, -1
    s_waitcnt vmcnt(0)
    ds_write_b32 v4, v5 offset:24
KS_K1:
    s_cmp_lt_u32 s41, 18
    s_cbranch_scc1 KS_T
    s_waitcnt lgkmcnt(0)
    s_endpgm
KS_X:
    s_cmp_lt_u32 s41, 24
    s_cbranch_scc1 KS_X2
    s_setprio 2
KS_XC:
    s_mov_b32 s87, 2
    s_add_u32 s86, s38, 3
    s_and_b32 s86, s86, 3
    s_lshl_b32 s88, s40, 3
    s_and_b32 s92, s41, 7
    s_add_u32 s88, s88, s92
    s_add_u32 s88, s88, 512
    s_lshl_b32 s92, s86, 11
    s_add_u32 s92, s92, 146048
    v_lshl_add_u32 v28, v1, 3, s92
    s_branch KS_GRP
KS_X2:
    s_cmp_lt_u32 s41, 8
    s_cbranch_scc1 KS_X3
    s_sub_u32 s97, s38, 8
    s_branch KS_LN1
KS_X3:
    s_lshl_b32 s92, s2, 4
    s_add_u32 s92, s92, s38
    s_cmp_lg_u32 s92, 44
    s_cbranch_scc1 KS_X3B
    s_setprio 3
    s_memrealtime s[92:93]
    v_and_b32 v6, 3, v1
    v_lshlrev_b32 v7, 2, v6
    v_min_u32 v6, 2, v6
    v_lshlrev_b32 v6, 2, v6
    v_cmp_eq_u32 vcc, 3, v1
    s_waitcnt lgkmcnt(0)
    v_mov_b32 v8, s92
    v_mov_b32 v9, s93
    v_alignbit_b32 v8, v8, v8, v6
    v_cndmask_b32 v9, v4, v9, vcc
    v_xor_b32 v8, v8, v9
    v_and_b32 v9, 0xf0000fff, v8
    v_and_b32 v10, 0xfff000, v8
    v_lshl_or_b32 v9, v10, 4, v9
    v_lshrrev_b32 v10, 12, v8
    v_and_b32 v10, 0xf000, v10
    v_or3_b32 v9, v9, v10, v9
    v_or_b32 v9, 0x80000000, v9
    s_mov_b64 exec, 15
    global_store_dword v7, v9, s[34:35] sc1
    s_mov_b64 exec, -1
    s_setprio 0
KS_X3B:
    s_setprio 3
    s_branch KS_XC
    s_waitcnt lgkmcnt(0)
    s_barrier
    s_branch KS_G
KS_X4:
    s_cmp_lt_u32 s41, 18
    s_cbranch_scc1 KS_G
    s_waitcnt vmcnt(0) lgkmcnt(0)
    s_endpgm
KS_L:
    v_lshlrev_b32 v6, 2, v0
    ds_write_b32 v6, v4
    v_mov_b32 v8, 0
    v_mov_b32 v9, 0
    s_min_u32 s92, s38, 2
    s_mul_i32 s92, s92, 4672
    v_min_u32 v6, 59, v1
    v_lshl_add_u32 v6, v6, 3, s92
    ds_write_b64 v6, v[8:9] offset:3072
    s_mov_b32 s97, s38
    s_sub_u32 s92, s41, 8
    s_cmp_lt_u32 s92, 16
    s_cbranch_scc0 KS_L0
KS_LN1:
    s_setprio 3
    s_sub_u32 s92, s41, 8
    s_and_b32 s88, s92, 7
    s_lshr_b32 s92, s92, 3
    s_lshl_b32 s92, s92, 4
    s_add_u32 s88, s88, s92
    s_and_b32 s92, s40, 1
    s_lshl_b32 s92, s92, 3
    s_add_u32 s88, s88, s92
    s_lshr_b32 s92, s40, 1
    s_lshl_b32 s92, s92, 5
    s_add_u32 s88, s88, s92
    v_lshrrev_b32 v36, 5, v1
    v_and_b32 v37, 31, v1
    v_mul_u32_u24 v38, 1152, v36
    v_lshl_add_u32 v39, v37, 2, v38
    v_lshl_add_u32 v38, v37, 4, v38
    s_mul_i32 s93, s88, 18432
    s_mul_i32 s94, s97, 2304
    s_add_u32 s93, s93, s94
    s_waitcnt lgkmcnt(0)
    s_mov_b32 s64, s4
    s_mov_b32 s65, s5
    s_mov_b32 s66, 0x240000
    s_mov_b32 s67, 0x20000
    buffer_load_dwordx4 v[26:29], v38, s[64:67], s93 offen
    buffer_load_dwordx4 v[30:33], v38, s[64:67], s93 offen offset:512
    buffer_load_dword v34, v39, s[64:67], s93 offen offset:1024
    s_barrier
    s_lshr_b32 s93, s97, 2
    s_lshl_b32 s93, s93, 6
    s_add_u32 s94, s94, s93
    s_add_u32 s94, s94, 17088
    v_lshl_add_u32 v35, v37, 1, v36
    s_mov_b32 s98, 0x05040100
    s_mov_b32 s99, 0x07060302
    s_cmp_lt_u32 s97, 4
    s_cbranch_scc1 LN1A_54
    s_cmp_ge_u32 s41, 18
    s_cbranch_scc1 LN1A_54
    s_mov_b32 s68, s30
    s_mov_b32 s69, s31
    s_mov_b32 s70, 0x510000
    s_mov_b32 s71, 0x20000
    v_lshlrev_b32 v46, 4, v1
    s_mul_i32 s92, s89, 36864
    s_mul_i32 s93, s97, 9216
    s_add_u32 s92, s92, s93
    s_sub_u32 s92, s92, 36864
    s_add_u32 s93, s93, 72320
    s_add_u32 m0, s93, 0
    s_nop 0
    buffer_load_dwordx4 v46, s[68:71], s92 offen offset:0 nt lds
    buffer_load_dwordx4 v46, s[68:71], s92 offen offset:1024 nt lds
    buffer_load_dwordx4 v46, s[68:71], s92 offen offset:2048 nt lds
    buffer_load_dwordx4 v46, s[68:71], s92 offen offset:3072 nt lds
    s_add_u32 m0, s93, 4096
    s_add_u32 s92, s92, 4096
    buffer_load_dwordx4 v46, s[68:71], s92 offen offset:0 nt lds
    buffer_load_dwordx4 v46, s[68:71], s92 offen offset:1024 nt lds
    buffer_load_dwordx4 v46, s[68:71], s92 offen offset:2048 nt lds
    buffer_load_dwordx4 v46, s[68:71], s92 offen offset:3072 nt lds
    s_add_u32 m0, s93, 8192
    s_add_u32 s92, s92, 4096
    buffer_load_dwordx4 v46, s[68:71], s92 offen offset:0 nt lds
    s_waitcnt vmcnt(11)
    v_lshlrev_b32 v8, 16, v26
    v_and_b32 v9, 0xffff0000, v26
    v_lshlrev_b32 v10, 16, v27
    v_and_b32 v11, 0xffff0000, v27
    v_lshlrev_b32 v12, 16, v28
    v_and_b32 v13, 0xffff0000, v28
    v_lshlrev_b32 v14, 16, v29
    v_and_b32 v15, 0xffff0000, v29
    s_waitcnt vmcnt(10)
    v_lshlrev_b32 v16, 16, v30
    v_and_b32 v17, 0xffff0000, v30
    v_lshlrev_b32 v18, 16, v31
    v_and_b32 v19, 0xffff0000, v31
    v_lshlrev_b32 v20, 16, v32
    v_and_b32 v21, 0xffff0000, v32
    v_lshlrev_b32 v22, 16, v33
    v_and_b32 v23, 0xffff0000, v33
    s_waitcnt vmcnt(9)
    v_lshlrev_b32 v24, 16, v34
    v_and_b32 v25, 0xffff0000, v34
    s_branch LN1B_55
LN1A_54:
    s_waitcnt vmcnt(2)
    v_lshlrev_b32 v8, 16, v26
    v_and_b32 v9, 0xffff0000, v26
    v_lshlrev_b32 v10, 16, v27
    v_and_b32 v11, 0xffff0000, v27
    v_lshlrev_b32 v12, 16, v28
    v_and_b32 v13, 0xffff0000, v28
    v_lshlrev_b32 v14, 16, v29
    v_and_b32 v15, 0xffff0000, v29
    s_waitcnt vmcnt(1)
    v_lshlrev_b32 v16, 16, v30
    v_and_b32 v17, 0xffff0000, v30
    v_lshlrev_b32 v18, 16, v31
    v_and_b32 v19, 0xffff0000, v31
    v_lshlrev_b32 v20, 16, v32
    v_and_b32 v21, 0xffff0000, v32
    v_lshlrev_b32 v22, 16, v33
    v_and_b32 v23, 0xffff0000, v33
    s_waitcnt vmcnt(0)
    v_lshlrev_b32 v24, 16, v34
    v_and_b32 v25, 0xffff0000, v34
    s_nop 1
LN1B_55:
    v_lshl_add_u32 v6, v35, 4, s94
    v_lshl_add_u32 v7, v35, 2, s94
    v_mul_u32_u24 v35, 0x20202, v36
    v_lshl_add_u32 v35, v36, 25, v35
    v_add_u32 v35, 0x05040100, v35
    v_pk_add_f32 v[40:41], v[8:9], v[10:11]
    v_pk_add_f32 v[42:43], v[12:13], v[14:15]
    v_pk_add_f32 v[40:41], v[40:41], v[16:17]
    v_pk_add_f32 v[42:43], v[42:43], v[18:19]
    v_pk_add_f32 v[40:41], v[40:41], v[20:21]
    v_pk_add_f32 v[42:43], v[42:43], v[22:23]
    v_pk_add_f32 v[40:41], v[40:41], v[24:25]
    v_pk_add_f32 v[40:41], v[40:41], v[42:43]
    v_add_f32 v40, v40, v41
    s_nop 1
    v_add_f32_dpp v40, v40, v40 row_ror:8 row_mask:0xf bank_mask:0xf
    s_nop 1
    v_add_f32_dpp v40, v40, v40 row_ror:4 row_mask:0xf bank_mask:0xf
    s_nop 1
    v_add_f32_dpp v40, v40, v40 row_ror:2 row_mask:0xf bank_mask:0xf
    s_nop 1
    v_add_f32_dpp v40, v40, v40 row_ror:1 row_mask:0xf bank_mask:0xf
    v_mov_b32 v42, v40
    s_nop 1
    v_permlane16_swap_b32 v40, v42
    v_add_f32 v40, v40, v42
    v_mul_f32 v44, 0x3ae38e39, v40
    v_mov_b32 v45, v44
    v_cvt_pk_bf16_f32 v36, 0, v44
    v_cvt_pk_bf16_f32 v37, 0, v44
    v_pk_add_f32 v[38:39], v[8:9], v[44:45] neg_lo:[0,1] neg_hi:[0,1]
    v_pk_mul_f32 v[40:41], v[38:39], v[38:39]
    v_pk_add_f32 v[38:39], v[10:11], v[44:45] neg_lo:[0,1] neg_hi:[0,1]
    v_pk_mul_f32 v[42:43], v[38:39], v[38:39]
    v_pk_add_f32 v[38:39], v[12:13], v[44:45] neg_lo:[0,1] neg_hi:[0,1]
    v_pk_fma_f32 v[40:41], v[38:39], v[38:39], v[40:41]
    v_pk_add_f32 v[38:39], v[14:15], v[44:45] neg_lo:[0,1] neg_hi:[0,1]
    v_pk_fma_f32 v[42:43], v[38:39], v[38:39], v[42:43]
    v_pk_add_f32 v[38:39], v[16:17], v[44:45] neg_lo:[0,1] neg_hi:[0,1]
    v_pk_fma_f32 v[40:41], v[38:39], v[38:39], v[40:41]
    v_pk_add_f32 v[38:39], v[18:19], v[44:45] neg_lo:[0,1] neg_hi:[0,1]
    v_pk_fma_f32 v[42:43], v[38:39], v[38:39], v[42:43]
    v_pk_add_f32 v[38:39], v[20:21], v[44:45] neg_lo:[0,1] neg_hi:[0,1]
    v_pk_fma_f32 v[40:41], v[38:39], v[38:39], v[40:41]
    v_pk_add_f32 v[38:39], v[22:23], v[44:45] neg_lo:[0,1] neg_hi:[0,1]
    v_pk_fma_f32 v[42:43], v[38:39], v[38:39], v[42:43]
    v_pk_add_f32 v[38:39], v[24:25], v[44:45] neg_lo:[0,1] neg_hi:[0,1]
    v_pk_fma_f32 v[40:41], v[38:39], v[38:39], v[40:41]
    v_pk_add_f32 v[40:41], v[40:41], v[42:43]
    v_add_f32 v40, v40, v41
    s_nop 1
    v_add_f32_dpp v40, v40, v40 row_ror:8 row_mask:0xf bank_mask:0xf
    s_nop 1
    v_add_f32_dpp v40, v40, v40 row_ror:4 row_mask:0xf bank_mask:0xf
    s_nop 1
    v_add_f32_dpp v40, v40, v40 row_ror:2 row_mask:0xf bank_mask:0xf
    s_nop 1
    v_add_f32_dpp v40, v40, v40 row_ror:1 row_mask:0xf bank_mask:0xf
    v_mov_b32 v42, v40
    s_nop 1
    v_permlane16_swap_b32 v40, v42
    v_add_f32 v40, v40, v42
    v_mul_f32 v40, 0x3ae38e39, v40
    v_cvt_pk_bf16_f32 v40, 0, v40
    v_add_f32 v40, 0x3727c5ac, v40
    v_cvt_pk_bf16_f32 v40, 0, v40
    v_sqrt_f32 v40, v40
    s_nop 0
    v_cvt_pk_bf16_f32 v40, 0, v40
    v_rcp_f32 v38, v40
    s_nop 0
    v_mov_b32 v39, v38
    v_pk_add_f32 v[40:41], v[8:9], v[36:37] neg_lo:[0,1] neg_hi:[0,1]
    v_cvt_pk_bf16_f32 v40, 0, v40
    v_cvt_pk_bf16_f32 v41, 0, v41
    v_pk_mul_f32 v[40:41], v[40:41], v[38:39]
    v_cvt_pk_bf16_f32 v40, 0, v40
    v_cvt_pk_bf16_f32 v41, 0, v41
    v_cvt_pk_f16_f32 v26, v40, v41
    v_pk_add_f32 v[40:41], v[10:11], v[36:37] neg_lo:[0,1] neg_hi:[0,1]
    v_cvt_pk_bf16_f32 v40, 0, v40
    v_cvt_pk_bf16_f32 v41, 0, v41
    v_pk_mul_f32 v[40:41], v[40:41], v[38:39]
    v_cvt_pk_bf16_f32 v40, 0, v40
    v_cvt_pk_bf16_f32 v41, 0, v41
    v_cvt_pk_f16_f32 v27, v40, v41
    v_pk_add_f32 v[40:41], v[12:13], v[36:37] neg_lo:[0,1] neg_hi:[0,1]
    v_cvt_pk_bf16_f32 v40, 0, v40
    v_cvt_pk_bf16_f32 v41, 0, v41
    v_pk_mul_f32 v[40:41], v[40:41], v[38:39]
    v_cvt_pk_bf16_f32 v40, 0, v40
    v_cvt_pk_bf16_f32 v41, 0, v41
    v_cvt_pk_f16_f32 v28, v40, v41
    v_and_b32 v59, 3, v1
    v_lshlrev_b32 v59, 2, v59
    global_load_dword v58, v59, s[34:35] sc1
    v_pk_add_f32 v[40:41], v[14:15], v[36:37] neg_lo:[0,1] neg_hi:[0,1]
    v_cvt_pk_bf16_f32 v40, 0, v40
    v_cvt_pk_bf16_f32 v41, 0, v41
    v_pk_mul_f32 v[40:41], v[40:41], v[38:39]
    v_cvt_pk_bf16_f32 v40, 0, v40
    v_cvt_pk_bf16_f32 v41, 0, v41
    v_cvt_pk_f16_f32 v29, v40, v41
    v_permlane32_swap_b32 v26, v28
    s_nop 0
    v_permlane32_swap_b32 v27, v29
    v_perm_b32 v8, v28, v26, s98
    v_perm_b32 v9, v28, v26, s99
    v_perm_b32 v10, v29, v27, s98
    v_perm_b32 v11, v29, v27, s99
    ds_write_b128 v6, v[8:11] offset:0
    v_pk_add_f32 v[40:41], v[16:17], v[36:37] neg_lo:[0,1] neg_hi:[0,1]
    v_cvt_pk_bf16_f32 v40, 0, v40
    v_cvt_pk_bf16_f32 v41, 0, v41
    v_pk_mul_f32 v[40:41], v[40:41], v[38:39]
    v_cvt_pk_bf16_f32 v40, 0, v40
    v_cvt_pk_bf16_f32 v41, 0, v41
    v_cvt_pk_f16_f32 v30, v40, v41
    v_pk_add_f32 v[40:41], v[18:19], v[36:37] neg_lo:[0,1] neg_hi:[0,1]
    v_cvt_pk_bf16_f32 v40, 0, v40
    v_cvt_pk_bf16_f32 v41, 0, v41
    v_pk_mul_f32 v[40:41], v[40:41], v[38:39]
    v_cvt_pk_bf16_f32 v40, 0, v40
    v_cvt_pk_bf16_f32 v41, 0, v41
    v_cvt_pk_f16_f32 v31, v40, v41
    v_pk_add_f32 v[40:41], v[20:21], v[36:37] neg_lo:[0,1] neg_hi:[0,1]
    v_cvt_pk_bf16_f32 v40, 0, v40
    v_cvt_pk_bf16_f32 v41, 0, v41
    v_pk_mul_f32 v[40:41], v[40:41], v[38:39]
    v_cvt_pk_bf16_f32 v40, 0, v40
    v_cvt_pk_bf16_f32 v41, 0, v41
    v_cvt_pk_f16_f32 v32, v40, v41
    v_pk_add_f32 v[40:41], v[22:23], v[36:37] neg_lo:[0,1] neg_hi:[0,1]
    v_cvt_pk_bf16_f32 v40, 0, v40
    v_cvt_pk_bf16_f32 v41, 0, v41
    v_pk_mul_f32 v[40:41], v[40:41], v[38:39]
    v_cvt_pk_bf16_f32 v40, 0, v40
    v_cvt_pk_bf16_f32 v41, 0, v41
    v_cvt_pk_f16_f32 v33, v40, v41
    v_permlane32_swap_b32 v30, v32
    s_nop 0
    v_permlane32_swap_b32 v31, v33
    v_perm_b32 v16, v32, v30, s98
    v_perm_b32 v17, v32, v30, s99
    v_perm_b32 v18, v33, v31, s98
    v_perm_b32 v19, v33, v31, s99
    ds_write_b128 v6, v[16:19] offset:1024
    v_pk_add_f32 v[40:41], v[24:25], v[36:37] neg_lo:[0,1] neg_hi:[0,1]
    v_cvt_pk_bf16_f32 v40, 0, v40
    v_cvt_pk_bf16_f32 v41, 0, v41
    v_pk_mul_f32 v[40:41], v[40:41], v[38:39]
    v_cvt_pk_bf16_f32 v40, 0, v40
    v_cvt_pk_bf16_f32 v41, 0, v41
    v_cvt_pk_f16_f32 v34, v40, v41
    v_mov_b32 v40, v34
    s_nop 1
    v_permlane32_swap_b32 v34, v40
    v_perm_b32 v40, v40, v34, v35
    ds_write_b32 v7, v40 offset:2048
    v_mov_b32 v6, s97
    ds_write_b8 v6, v5 offset:0
    s_setprio 0
    s_cmp_ge_u32 s97, 4
    s_cbranch_scc1 KS_X4
    s_setprio 3
    s_mov_b32 s72, s36
    s_mov_b32 s73, s37
    s_mov_b32 s74, 0x240000
    s_mov_b32 s75, 0x20000
    v_and_b32 v6, 1, v0
    v_mul_u32_u24 v6, 9280, v6
    v_lshrrev_b32 v7, 1, v0
    v_lshl_add_u32 v6, v7, 2, v6
    v_add_u32 v6, 17088, v6
    v_lshrrev_b32 v7, 2, v0
    v_mul_u32_u24 v7, 0x2080, v7
    v_and_b32 v8, 3, v0
    v_lshl_add_u32 v7, v8, 4, v7
    s_lshl_b32 s92, s88, 6
    v_xor_b32 v7, s92, v7
    s_mov_b32 s92, 0
    s_add_u32 s93, s92, 524288
    s_add_u32 s94, s92, 1048576
    s_add_u32 s95, s92, 1572864
    s_add_u32 s96, s92, 2097152
    s_waitcnt vmcnt(0)
DBP_56:
    v_cmp_eq_u32 vcc, 0, v58
    s_cbranch_vccz DBG_57
    s_sleep 1
    global_load_dword v58, v59, s[34:35] sc1
    s_sub_u32 s39, s39, 1
    s_cbranch_scc1 KS_ABORT
    s_waitcnt vmcnt(0)
    s_branch DBP_56
DBG_57:
    ds_write_b32 v59, v58 offset:224
    s_mov_b32 s98, 0x70007
    v_lshrrev_b32 v57, 3, v58
    v_lshrrev_b32 v56, 6, v58
    v_lshrrev_b32 v55, 9, v58
W_58:
    ds_read_b64 v[20:21], v4 offset:0
    s_sub_u32 s39, s39, 1
    s_cbranch_scc1 KS_ABORT
    s_waitcnt lgkmcnt(0)
    v_and_b32 v20, v20, v21
    v_cmp_ne_u32 vcc, s84, v20
    s_cbranch_vccnz W_58
    ds_read2st64_b32 v[20:21], v6 offset0:0 offset1:9
    ds_read2st64_b32 v[22:23], v6 offset0:18 offset1:27
    ds_read2st64_b32 v[24:25], v6 offset0:2 offset1:11
    ds_read2st64_b32 v[26:27], v6 offset0:20 offset1:29
    ds_read2st64_b32 v[28:29], v6 offset0:4 offset1:13
    ds_read2st64_b32 v[30:31], v6 offset0:22 offset1:31
    ds_read2st64_b32 v[32:33], v6 offset0:6 offset1:15
    ds_read2st64_b32 v[34:35], v6 offset0:24 offset1:33
    ds_read2st64_b32 v[36:37], v6 offset0:8 offset1:17
    ds_read2st64_b32 v[38:39], v6 offset0:26 offset1:35
    s_waitcnt lgkmcnt(8)
    v_bfi_b32 v20, s98, v58, v20
    v_bfi_b32 v21, s98, v57, v21
    v_bfi_b32 v22, s98, v56, v22
    v_bfi_b32 v23, s98, v55, v23
    buffer_store_dwordx4 v[20:23], v7, s[72:75], s92 offen sc1
    s_waitcnt lgkmcnt(6)
    v_bfi_b32 v24, s98, v58, v24
    v_bfi_b32 v25, s98, v57, v25
    v_bfi_b32 v26, s98, v56, v26
    v_bfi_b32 v27, s98, v55, v27
    buffer_store_dwordx4 v[24:27], v7, s[72:75], s93 offen sc1
    s_waitcnt lgkmcnt(4)
    v_bfi_b32 v28, s98, v58, v28
    v_bfi_b32 v29, s98, v57, v29
    v_bfi_b32 v30, s98, v56, v30
    v_bfi_b32 v31, s98, v55, v31
    buffer_store_dwordx4 v[28:31], v7, s[72:75], s94 offen sc1
    s_waitcnt lgkmcnt(2)
    v_bfi_b32 v32, s98, v58, v32
    v_bfi_b32 v33, s98, v57, v33
    v_bfi_b32 v34, s98, v56, v34
    v_bfi_b32 v35, s98, v55, v35
    buffer_store_dwordx4 v[32:35], v7, s[72:75], s95 offen sc1
    s_waitcnt lgkmcnt(0)
    v_bfi_b32 v36, s98, v58, v36
    v_bfi_b32 v37, s98, v57, v37
    v_bfi_b32 v38, s98, v56, v38
    v_bfi_b32 v39, s98, v55, v39
    buffer_store_dwordx4 v[36:39], v7, s[72:75], s96 offen sc1
    v_mov_b32 v6, s97
    ds_write_b8 v6, v5 offset:200
    v_mul_u32_u24 v46, 57, v1
    v_lshrrev_b32 v46, 9, v46
    v_mul_u32_u24 v47, 9, v46
    v_sub_u32 v47, v1, v47
    v_mul_u32_u24 v46, 9216, v46
    v_lshl_add_u32 v46, v47, 7, v46
    s_cmp_ge_u32 s41, 18
    s_cbranch_scc1 KS_LL2
    s_branch KS_LLE
KS_LL2:
    s_mul_i32 s94, s38, 6
    s_add_u32 s94, s94, s41
    s_sub_u32 s94, s94, 18
    s_bitcmp1_b32 s94, 0
    s_cselect_b32 s72, s28, s26
    s_cselect_b32 s73, s29, s27
    s_mov_b32 s74, 0x510000
    s_mov_b32 s75, 0x20000
    s_lshr_b32 s95, s94, 1
    s_mul_i32 s95, s95, 64512
    s_mul_i32 s96, s40, 1152
    s_add_u32 s95, s95, s96
    s_add_u32 s96, s95, 2644992
    buffer_load_dword v47, v46, s[72:75], s96 offen nt
    buffer_load_dword v47, v46, s[72:75], s96 offen sc1
KS_LLE:
    s_mov_b32 s87, 1
    s_branch KS_L2B
KS_L0:
    s_and_b32 s92, s41, 15
    s_lshl_b32 s93, s40, 4
    s_add_u32 s92, s92, s93
    v_and_b32 v59, 3, v1
    v_lshlrev_b32 v59, 2, v59
    s_lshl_b32 s96, s92, 6
    s_add_u32 s93, s96, 0xb00000
    v_add_u32 v7, s93, v59
    s_mul_i32 s93, s92, 18560
    s_add_u32 s93, s93, 0x600000
    v_lshlrev_b32 v6, 4, v0
    v_mov_b32 v12, -1
    v_mov_b32 v13, -1
    v_mov_b32 v14, -1
    v_mov_b32 v15, -1
    s_setprio 3
    v_mul_u32_u24 v16, 57, v1
    v_lshrrev_b32 v16, 9, v16
    v_mul_u32_u24 v17, 9, v16
    v_sub_u32 v17, v1, v17
    v_mul_u32_u24 v16, 9216, v16
    v_lshl_add_u32 v16, v17, 7, v16
    s_waitcnt lgkmcnt(0)
    s_add_u32 s68, s36, s93
    s_addc_u32 s69, s37, 0
    s_mov_b32 s70, 18560
    s_mov_b32 s71, 0x20000
    s_barrier
W_59:
    s_sleep 2
    ds_read_b32 v8, v4 offset:36
    s_sub_u32 s39, s39, 1
    s_cbranch_scc1 KS_ABORT
    s_waitcnt lgkmcnt(0)
    v_cmp_eq_u32 vcc, 0, v8
    s_cbranch_vccnz W_59
    s_mov_b32 s92, 0
    buffer_store_dwordx4 v[12:15], v6, s[68:71], s92 offen sc1
    s_mov_b32 s92, 4096
    buffer_store_dwordx4 v[12:15], v6, s[68:71], s92 offen sc1
    s_mov_b32 s92, 8192
    buffer_store_dwordx4 v[12:15], v6, s[68:71], s92 offen sc1
    s_mov_b32 s92, 12288
    buffer_store_dwordx4 v[12:15], v6, s[68:71], s92 offen sc1
    s_mov_b32 s92, 16384
    buffer_store_dwordx4 v[12:15], v6, s[68:71], s92 offen sc1
    global_load_dword v58, v59, s[34:35] sc1
    s_waitcnt vmcnt(0)
DBP_60:
    v_cmp_eq_u32 vcc, 0, v58
    s_cbranch_vccz DBG_61
    s_sleep 1
    global_load_dword v58, v59, s[34:35] sc1
    s_sub_u32 s39, s39, 1
    s_cbranch_scc1 KS_ABORT
    s_waitcnt vmcnt(0)
    s_branch DBP_60
DBG_61:
    ds_write_b32 v59, v58 offset:224
    s_mov_b64 exec, 1
    ds_add_rtn_u32 v8, v4, v5 offset:8
    s_mov_b64 exec, -1
    v_lshrrev_b32 v57, 3, v58
    v_lshrrev_b32 v56, 6, v58
    v_lshrrev_b32 v55, 9, v58
    s_waitcnt lgkmcnt(0)
    v_readfirstlane_b32 s92, v8
    s_cmp_lg_u32 s92, 3
    s_cbranch_scc1 KS_L2
    s_mov_b64 exec, 15
    global_store_dword v7, v58, s[36:37] sc1
    s_mov_b64 exec, -1
    s_and_b32 s94, s41, 7
    s_cmp_ge_u32 s41, 8
    s_cbranch_scc1 KS_L1C
    s_branch KS_L2
KS_L1C:
    s_bitcmp1_b32 s94, 0
    s_cselect_b32 s72, s28, s26
    s_cselect_b32 s73, s29, s27
    s_mov_b32 s74, 0x510000
    s_mov_b32 s75, 0x20000
    s_lshr_b32 s95, s94, 1
    s_mul_i32 s95, s95, 64512
    s_mul_i32 s96, s40, 1152
    s_add_u32 s95, s95, s96
    s_add_u32 s96, s95, 3419136
    buffer_load_dword v18, v16, s[72:75], s96 offen nt
    buffer_load_dword v18, v16, s[72:75], s96 offen sc1
    s_add_u32 s96, s95, 3677184
    buffer_load_dword v18, v16, s[72:75], s96 offen nt
    buffer_load_dword v18, v16, s[72:75], s96 offen sc1
    s_add_u32 s96, s95, 3935232
    buffer_load_dword v18, v16, s[72:75], s96 offen nt
    buffer_load_dword v18, v16, s[72:75], s96 offen sc1
    s_add_u32 s96, s95, 4193280
    buffer_load_dword v18, v16, s[72:75], s96 offen nt
    buffer_load_dword v18, v16, s[72:75], s96 offen sc1
KS_L2:
    s_mov_b32 s87, 0
KS_L2B:
    s_mov_b32 s64, s36
    s_mov_b32 s65, s37
    s_mov_b32 s66, 0x240000
    s_mov_b32 s67, 0x20000
    v_lshrrev_b32 v7, 1, v1
    v_lshlrev_b32 v7, 6, v7
    v_and_b32 v10, 1, v1
    v_lshl_add_u32 v7, v10, 4, v7
    v_lshlrev_b32 v9, 4, v1
    s_lshl_b32 s92, s38, 11
    s_lshl_b32 s93, s90, 13
    s_add_u32 s93, s93, s92
    s_lshl_b32 s94, s90, 7
    s_and_b32 s95, s94, 0x380
    v_xor_b32 v13, s95, v9
    s_and_b32 s94, s94, 0x1c00
    s_xor_b32 s93, s93, s94
    s_xor_b32 s97, s93, 0x400
    s_lshl_b32 s95, s40, 3
    s_add_u32 s95, s95, s41
    s_add_u32 s95, s95, 488
    s_lshr_b32 s96, s95, 1
    s_lshl_b32 s96, s96, 13
    s_and_b32 s95, s95, 1
    s_lshl_b32 s95, s95, 5
    s_add_u32 s95, s95, s96
    s_add_u32 s95, s95, s92
    s_lshr_b32 s96, s96, 6
    s_and_b32 s94, s96, 0x780
    v_xor_b32 v7, s94, v7
    s_and_b32 s96, s96, 0x1800
    s_xor_b32 s95, s95, s96
    s_cmp_lt_u32 s41, 24
    s_cselect_b32 s95, 2359296, s95
    s_cselect_b32 s94, 0, 0x70007
    v_mov_b32_dpp v64, v58 quad_perm:[0,1,0,1] row_mask:0xf bank_mask:0xf
    v_mov_b32_dpp v65, v58 quad_perm:[2,3,2,3] row_mask:0xf bank_mask:0xf
    s_bitcmp1_b32 s41, 0
    s_cselect_b64 vcc, -1, 0
    v_cndmask_b32 v64, v64, v65, vcc
    v_and_b32 v60, 0x70007, v58
    v_and_b32 v61, 0x70007, v57
    v_and_b32 v62, 0x70007, v56
    v_and_b32 v63, 0x70007, v55
    v_lshrrev_b32 v67, 9, v64
    v_lshrrev_b32 v66, 6, v64
    v_lshrrev_b32 v65, 3, v64
    v_and_b32 v64, s94, v64
    v_and_b32 v65, s94, v65
    v_and_b32 v66, s94, v66
    v_and_b32 v67, s94, v67
    s_lshl_b32 s96, s38, 10
    s_add_u32 s96, s96, 3552
    v_bfe_u32 v11, v1, 1, 1
    v_mul_u32_u24 v11, 4672, v11
    v_lshl_add_u32 v11, v10, 4, v11
    v_lshrrev_b32 v10, 2, v1
    v_lshl_add_u32 v11, v10, 5, v11
    v_add_u32 v11, s96, v11
    v_add_u32 v10, s96, v9
    v_mov_b32 v116, s38
    s_add_u32 s92, s92, 0xb00000
    v_lshrrev_b32 v12, 2, v1
    v_lshl_add_u32 v12, v12, 6, v59
    v_add_u32 v12, s92, v12
    s_cmp_lt_u32 s41, 8
    s_cselect_b32 s94, 20, 4
    s_cmp_ge_u32 s41, 24
    s_cselect_b32 s94, 24, s94
    v_mov_b32 v14, s94
    s_setprio 0
    s_waitcnt vmcnt(0)
    ds_write_b8 v116, v5 offset:204
W_62:
    s_sleep 2
    ds_read_b32 v8, v14 offset:64
    s_sub_u32 s39, s39, 1
    s_cbranch_scc1 KS_ABORT
    s_waitcnt lgkmcnt(0)
    v_cmp_ne_u32 vcc, s84, v8
    s_cbranch_vccnz W_62
    s_setprio 3
    s_branch UPE_64
UP_63:
    s_sleep 2
UPE_64:
    global_load_dword v32, v12, s[36:37] sc1
    global_load_dword v33, v12, s[36:37] offset:1024 sc1
    buffer_load_dwordx4 v[20:23], v13, s[64:67], s93 offen sc1
    buffer_load_dwordx4 v[24:27], v13, s[64:67], s97 offen sc1
    buffer_load_dwordx4 v[28:31], v7, s[64:67], s95 offen sc1
    s_sub_u32 s39, s39, 1
    s_cbranch_scc1 KS_ABORT
    s_waitcnt vmcnt(2)
    v_xor_b32 v32, v58, v32
    v_xor_b32 v33, v58, v33
    v_xor_b32 v20, v60, v20
    v_xor_b32 v21, v61, v21
    v_xor_b32 v22, v62, v22
    v_xor_b32 v23, v63, v23
    v_or3_b32 v44, v20, v21, v21
    v_or3_b32 v44, v22, v23, v44
    s_waitcnt vmcnt(1)
    v_xor_b32 v24, v60, v24
    v_xor_b32 v25, v61, v25
    v_xor_b32 v26, v62, v26
    v_xor_b32 v27, v63, v27
    v_or3_b32 v44, v24, v25, v44
    v_or3_b32 v44, v26, v27, v44
    s_waitcnt vmcnt(0)
    v_xor_b32 v28, v64, v28
    v_xor_b32 v29, v65, v29
    v_xor_b32 v30, v66, v30
    v_xor_b32 v31, v67, v31
    v_or3_b32 v44, v28, v29, v44
    v_or3_b32 v44, v30, v31, v44
    v_and_b32 v44, 0x70007, v44
    v_or3_b32 v44, v44, v32, v33
    v_cmp_ne_u32 vcc, 0, v44
    s_cbranch_vccnz UP_63
    ds_write_b128 v11, v[20:23]
    ds_write_b128 v11, v[24:27] offset:512
    ds_write_b128 v10, v[28:31] offset:9344
    ds_write_b8 v116, v5 offset:16
    s_cmp_eq_u32 s38, 2
    s_cbranch_scc1 WJ2_67
    s_add_u32 s92, s38, 1
    s_lshr_b32 s92, s92, 2
    s_cmp_eq_u32 s38, 1
    s_cselect_b32 s92, 2, s92
    s_lshl_b32 s92, s92, 10
    v_lshl_add_u32 v10, v1, 4, s92
    v_add_u32 v11, 35840, v10
W_68:
    ds_read_b32 v12, v4 offset:16
    s_sub_u32 s39, s39, 1
    s_cbranch_scc1 KS_ABORT
    s_waitcnt lgkmcnt(0)
    v_cmp_ne_u32 vcc, s84, v12
    s_cbranch_vccnz W_68
    s_setprio 3
    ds_read_b128 v[20:23], v10 offset:3520
    ds_read_b128 v[24:27], v10 offset:3536
    ds_read_b64 v[28:29], v10 offset:3552
    ds_read_b128 v[32:35], v10 offset:8192
    ds_read_b128 v[36:39], v10 offset:8208
    ds_read_b64 v[40:41], v10 offset:8224
    ds_read_b128 v[44:47], v10 offset:12864
    ds_read_b128 v[48:51], v10 offset:12880
    ds_read_b64 v[52:53], v10 offset:12896
    s_cmp_eq_u32 s38, 1
    s_cbranch_scc1 WJ1_66
    ds_read_b32 v12, v4 offset:68
    s_waitcnt lgkmcnt(7)
    v_alignbit_b32 v57, v22, v21, 16
    v_alignbit_b32 v58, v23, v22, 16
    v_alignbit_b32 v59, v24, v23, 16
    v_alignbit_b32 v60, v25, v24, 16
    v_alignbit_b32 v61, v26, v25, 16
    v_alignbit_b32 v62, v27, v26, 16
    v_alignbit_b32 v63, v28, v27, 16
    v_alignbit_b32 v64, v29, v28, 16
    v_pk_add_f16 v66, v57, v22
    v_pk_add_f16 v67, v58, v23
    v_pk_add_f16 v68, v59, v24
    v_pk_add_f16 v69, v60, v25
    v_pk_add_f16 v70, v61, v26
    v_pk_add_f16 v71, v62, v27
    v_pk_add_f16 v72, v63, v28
    v_pk_add_f16 v73, v64, v29
    v_pk_add_f16 v80, v66, v58
    v_pk_add_f16 v81, v67, v59
    v_pk_add_f16 v82, v68, v60
    v_pk_add_f16 v83, v69, v61
    v_pk_add_f16 v74, v67, v68
    v_pk_add_f16 v75, v68, v69
    v_pk_add_f16 v76, v69, v70
    v_pk_add_f16 v77, v70, v71
    v_pk_add_f16 v78, v71, v72
    v_pk_add_f16 v79, v72, v73
    s_waitcnt lgkmcnt(0)
    v_cmp_eq_u32 vcc, s84, v12
    s_cbranch_vccnz WJK_69
W_70:
    s_sleep 1
    ds_read_b32 v12, v4 offset:68
    s_sub_u32 s39, s39, 1
    s_cbranch_scc1 KS_ABORT
    s_waitcnt lgkmcnt(0)
    v_cmp_ne_u32 vcc, s84, v12
    s_cbranch_vccnz W_70
WJK_69:
    ds_write_b128 v11, v[80:83] offset:0
    v_pk_add_f16 v87, v22, v74
    v_pk_add_f16 v88, v23, v75
    v_pk_add_f16 v89, v24, v76
    v_pk_add_f16 v90, v25, v77
    v_pk_add_f16 v91, v26, v78
    ds_write_b128 v11, v[88:91] offset:3104
    v_pk_add_f16 v84, v70, v62
    v_pk_add_f16 v85, v71, v63
    v_pk_add_f16 v86, v72, v64
    v_pk_add_f16 v92, v74, v83
    v_pk_add_f16 v93, v75, v84
    v_pk_add_f16 v94, v76, v85
    v_pk_add_f16 v95, v77, v86
    ds_write_b128 v11, v[92:95] offset:6176
    v_pk_add_f16 v96, v87, v76
    v_pk_add_f16 v97, v88, v77
    v_pk_add_f16 v98, v89, v78
    v_pk_add_f16 v99, v90, v79
    ds_write_b128 v11, v[96:99] offset:8240
    ds_write_b8 v116, v5 offset:76
    ds_read_b32 v12, v4 offset:84
    v_alignbit_b32 v57, v34, v33, 16
    v_alignbit_b32 v58, v35, v34, 16
    v_alignbit_b32 v59, v36, v35, 16
    v_alignbit_b32 v60, v37, v36, 16
    v_alignbit_b32 v61, v38, v37, 16
    v_alignbit_b32 v62, v39, v38, 16
    v_alignbit_b32 v63, v40, v39, 16
    v_alignbit_b32 v64, v41, v40, 16
    v_pk_add_f16 v66, v57, v34
    v_pk_add_f16 v67, v58, v35
    v_pk_add_f16 v68, v59, v36
    v_pk_add_f16 v69, v60, v37
    v_pk_add_f16 v70, v61, v38
    v_pk_add_f16 v71, v62, v39
    v_pk_add_f16 v72, v63, v40
    v_pk_add_f16 v73, v64, v41
    v_pk_add_f16 v80, v66, v58
    v_pk_add_f16 v81, v67, v59
    v_pk_add_f16 v82, v68, v60
    v_pk_add_f16 v83, v69, v61
    v_pk_add_f16 v74, v67, v68
    v_pk_add_f16 v75, v68, v69
    v_pk_add_f16 v76, v69, v70
    v_pk_add_f16 v77, v70, v71
    v_pk_add_f16 v78, v71, v72
    v_pk_add_f16 v79, v72, v73
    s_waitcnt lgkmcnt(0)
    v_cmp_eq_u32 vcc, s84, v12
    s_cbranch_vccnz WJK_71
W_72:
    s_sleep 1
    ds_read_b32 v12, v4 offset:84
    s_sub_u32 s39, s39, 1
    s_cbranch_scc1 KS_ABORT
    s_waitcnt lgkmcnt(0)
    v_cmp_ne_u32 vcc, s84, v12
    s_cbranch_vccnz W_72
WJK_71:
    ds_write_b128 v11, v[80:83] offset:36672
    v_pk_add_f16 v87, v34, v74
    v_pk_add_f16 v88, v35, v75
    v_pk_add_f16 v89, v36, v76
    v_pk_add_f16 v90, v37, v77
    v_pk_add_f16 v91, v38, v78
    ds_write_b128 v11, v[88:91] offset:39776
    v_pk_add_f16 v84, v70, v62
    v_pk_add_f16 v85, v71, v63
    v_pk_add_f16 v86, v72, v64
    v_pk_add_f16 v92, v74, v83
    v_pk_add_f16 v93, v75, v84
    v_pk_add_f16 v94, v76, v85
    v_pk_add_f16 v95, v77, v86
    ds_write_b128 v11, v[92:95] offset:42848
    v_pk_add_f16 v96, v87, v76
    v_pk_add_f16 v97, v88, v77
    v_pk_add_f16 v98, v89, v78
    v_pk_add_f16 v99, v90, v79
    ds_write_b128 v11, v[96:99] offset:44912
    ds_write_b8 v116, v5 offset:92
    s_cmp_lt_u32 s41, 24
    s_cbranch_scc1 WJE_65
    ds_read_b32 v12, v4 offset:100
    v_alignbit_b32 v57, v46, v45, 16
    v_alignbit_b32 v58, v47, v46, 16
    v_alignbit_b32 v59, v48, v47, 16
    v_alignbit_b32 v60, v49, v48, 16
    v_alignbit_b32 v61, v50, v49, 16
    v_alignbit_b32 v62, v51, v50, 16
    v_alignbit_b32 v63, v52, v51, 16
    v_alignbit_b32 v64, v53, v52, 16
    v_pk_add_f16 v66, v57, v46
    v_pk_add_f16 v67, v58, v47
    v_pk_add_f16 v68, v59, v48
    v_pk_add_f16 v69, v60, v49
    v_pk_add_f16 v70, v61, v50
    v_pk_add_f16 v71, v62, v51
    v_pk_add_f16 v72, v63, v52
    v_pk_add_f16 v73, v64, v53
    v_pk_add_f16 v80, v66, v58
    v_pk_add_f16 v81, v67, v59
    v_pk_add_f16 v82, v68, v60
    v_pk_add_f16 v83, v69, v61
    v_pk_add_f16 v74, v67, v68
    v_pk_add_f16 v75, v68, v69
    v_pk_add_f16 v76, v69, v70
    v_pk_add_f16 v77, v70, v71
    v_pk_add_f16 v78, v71, v72
    v_pk_add_f16 v79, v72, v73
    s_waitcnt lgkmcnt(0)
    v_cmp_eq_u32 vcc, s84, v12
    s_cbranch_vccnz WJK_73
W_74:
    s_sleep 1
    ds_read_b32 v12, v4 offset:100
    s_sub_u32 s39, s39, 1
    s_cbranch_scc1 KS_ABORT
    s_waitcnt lgkmcnt(0)
    v_cmp_ne_u32 vcc, s84, v12
    s_cbranch_vccnz W_74
WJK_73:
    v_add_u32 v11, 73344, v11
    ds_write_b128 v11, v[80:83] offset:0
    v_pk_add_f16 v87, v46, v74
    v_pk_add_f16 v88, v47, v75
    v_pk_add_f16 v89, v48, v76
    v_pk_add_f16 v90, v49, v77
    v_pk_add_f16 v91, v50, v78
    ds_write_b128 v11, v[88:91] offset:3104
    v_pk_add_f16 v84, v70, v62
    v_pk_add_f16 v85, v71, v63
    v_pk_add_f16 v86, v72, v64
    v_pk_add_f16 v92, v74, v83
    v_pk_add_f16 v93, v75, v84
    v_pk_add_f16 v94, v76, v85
    v_pk_add_f16 v95, v77, v86
    ds_write_b128 v11, v[92:95] offset:6176
    v_pk_add_f16 v96, v87, v76
    v_pk_add_f16 v97, v88, v77
    v_pk_add_f16 v98, v89, v78
    v_pk_add_f16 v99, v90, v79
    ds_write_b128 v11, v[96:99] offset:8240
    ds_write_b8 v116, v5 offset:108
    s_branch WJE_65
WJ1_66:
    ds_read_b32 v12, v4 offset:68
    s_waitcnt lgkmcnt(7)
    v_alignbit_b32 v57, v22, v21, 16
    v_alignbit_b32 v58, v23, v22, 16
    v_alignbit_b32 v59, v24, v23, 16
    v_alignbit_b32 v60, v25, v24, 16
    v_alignbit_b32 v61, v26, v25, 16
    v_alignbit_b32 v62, v27, v26, 16
    v_alignbit_b32 v63, v28, v27, 16
    v_pk_add_f16 v66, v57, v22
    v_pk_add_f16 v67, v58, v23
    v_pk_add_f16 v68, v59, v24
    v_pk_add_f16 v69, v60, v25
    v_pk_add_f16 v70, v61, v26
    v_pk_add_f16 v71, v62, v27
    v_pk_add_f16 v72, v63, v28
    v_pk_add_f16 v80, v66, v58
    v_pk_add_f16 v81, v67, v59
    v_pk_add_f16 v82, v68, v60
    v_pk_add_f16 v83, v69, v61
    v_pk_add_f16 v75, v68, v69
    v_pk_add_f16 v76, v69, v70
    v_pk_add_f16 v77, v70, v71
    v_pk_add_f16 v78, v71, v72
    s_waitcnt lgkmcnt(0)
    v_cmp_eq_u32 vcc, s84, v12
    s_cbranch_vccnz WJK_75
W_76:
    s_sleep 1
    ds_read_b32 v12, v4 offset:68
    s_sub_u32 s39, s39, 1
    s_cbranch_scc1 KS_ABORT
    s_waitcnt lgkmcnt(0)
    v_cmp_ne_u32 vcc, s84, v12
    s_cbranch_vccnz W_76
WJK_75:
    ds_write_b128 v11, v[80:83] offset:0
    v_pk_add_f16 v88, v23, v75
    v_pk_add_f16 v89, v24, v76
    v_pk_add_f16 v90, v25, v77
    v_pk_add_f16 v91, v26, v78
    ds_write_b128 v11, v[88:91] offset:3104
    ds_write_b8 v116, v5 offset:76
    ds_read_b32 v12, v4 offset:84
    v_alignbit_b32 v57, v34, v33, 16
    v_alignbit_b32 v58, v35, v34, 16
    v_alignbit_b32 v59, v36, v35, 16
    v_alignbit_b32 v60, v37, v36, 16
    v_alignbit_b32 v61, v38, v37, 16
    v_alignbit_b32 v62, v39, v38, 16
    v_alignbit_b32 v63, v40, v39, 16
    v_pk_add_f16 v66, v57, v34
    v_pk_add_f16 v67, v58, v35
    v_pk_add_f16 v68, v59, v36
    v_pk_add_f16 v69, v60, v37
    v_pk_add_f16 v70, v61, v38
    v_pk_add_f16 v71, v62, v39
    v_pk_add_f16 v72, v63, v40
    v_pk_add_f16 v80, v66, v58
    v_pk_add_f16 v81, v67, v59
    v_pk_add_f16 v82, v68, v60
    v_pk_add_f16 v83, v69, v61
    v_pk_add_f16 v75, v68, v69
    v_pk_add_f16 v76, v69, v70
    v_pk_add_f16 v77, v70, v71
    v_pk_add_f16 v78, v71, v72
    s_waitcnt lgkmcnt(0)
    v_cmp_eq_u32 vcc, s84, v12
    s_cbranch_vccnz WJK_77
W_78:
    s_sleep 1
    ds_read_b32 v12, v4 offset:84
    s_sub_u32 s39, s39, 1
    s_cbranch_scc1 KS_ABORT
    s_waitcnt lgkmcnt(0)
    v_cmp_ne_u32 vcc, s84, v12
    s_cbranch_vccnz W_78
WJK_77:
    ds_write_b128 v11, v[80:83] offset:36672
    v_pk_add_f16 v88, v35, v75
    v_pk_add_f16 v89, v36, v76
    v_pk_add_f16 v90, v37, v77
    v_pk_add_f16 v91, v38, v78
    ds_write_b128 v11, v[88:91] offset:39776
    ds_write_b8 v116, v5 offset:92
    s_cmp_lt_u32 s41, 24
    s_cbranch_scc1 WJE_65
    ds_read_b32 v12, v4 offset:100
    v_alignbit_b32 v57, v46, v45, 16
    v_alignbit_b32 v58, v47, v46, 16
    v_alignbit_b32 v59, v48, v47, 16
    v_alignbit_b32 v60, v49, v48, 16
    v_alignbit_b32 v61, v50, v49, 16
    v_alignbit_b32 v62, v51, v50, 16
    v_alignbit_b32 v63, v52, v51, 16
    v_pk_add_f16 v66, v57, v46
    v_pk_add_f16 v67, v58, v47
    v_pk_add_f16 v68, v59, v48
    v_pk_add_f16 v69, v60, v49
    v_pk_add_f16 v70, v61, v50
    v_pk_add_f16 v71, v62, v51
    v_pk_add_f16 v72, v63, v52
    v_pk_add_f16 v80, v66, v58
    v_pk_add_f16 v81, v67, v59
    v_pk_add_f16 v82, v68, v60
    v_pk_add_f16 v83, v69, v61
    v_pk_add_f16 v75, v68, v69
    v_pk_add_f16 v76, v69, v70
    v_pk_add_f16 v77, v70, v71
    v_pk_add_f16 v78, v71, v72
    s_waitcnt lgkmcnt(0)
    v_cmp_eq_u32 vcc, s84, v12
    s_cbranch_vccnz WJK_79
W_80:
    s_sleep 1
    ds_read_b32 v12, v4 offset:100
    s_sub_u32 s39, s39, 1
    s_cbranch_scc1 KS_ABORT
    s_waitcnt lgkmcnt(0)
    v_cmp_ne_u32 vcc, s84, v12
    s_cbranch_vccnz W_80
WJK_79:
    v_add_u32 v11, 73344, v11
    ds_write_b128 v11, v[80:83] offset:0
    v_pk_add_f16 v88, v47, v75
    v_pk_add_f16 v89, v48, v76
    v_pk_add_f16 v90, v49, v77
    v_pk_add_f16 v91, v50, v78
    ds_write_b128 v11, v[88:91] offset:3104
    ds_write_b8 v116, v5 offset:108
    s_branch WJE_65
WJ2_67:
    ds_write_b8 v116, v5 offset:76
    ds_write_b8 v116, v5 offset:92
    ds_write_b8 v116, v5 offset:108
    s_sub_u32 s94, s41, 18
    s_and_b32 s94, s94, 31
    s_cmp_ge_u32 s94, 14
    s_cbranch_scc1 WJE_65
    v_mul_u32_u24 v100, 57, v1
    v_lshrrev_b32 v100, 9, v100
    v_mul_u32_u24 v101, 9, v100
    v_sub_u32 v101, v1, v101
    v_mul_u32_u24 v100, 9216, v100
    v_lshl_add_u32 v100, v101, 7, v100
W_81:
    s_sleep 1
    ds_read_b32 v12, v4 offset:16
    s_sub_u32 s39, s39, 1
    s_cbranch_scc1 KS_ABORT
    s_waitcnt lgkmcnt(0)
    v_cmp_ne_u32 vcc, s84, v12
    s_cbranch_vccnz W_81
    s_bitcmp1_b32 s94, 0
    s_cselect_b32 s72, s28, s26
    s_cselect_b32 s73, s29, s27
    s_mov_b32 s74, 0x510000
    s_mov_b32 s75, 0x20000
    s_lshr_b32 s95, s94, 1
    s_mul_i32 s95, s95, 64512
    s_mul_i32 s96, s40, 1152
    s_add_u32 s95, s95, s96
    s_add_u32 s96, s95, 4451328
    buffer_load_dword v102, v100, s[72:75], s96 offen nt
    buffer_load_dword v102, v100, s[72:75], s96 offen sc1
    s_add_u32 s96, s95, 4902912
    buffer_load_dword v102, v100, s[72:75], s96 offen nt
    buffer_load_dword v102, v100, s[72:75], s96 offen sc1
KS_PF2D:
WJE_65:
    s_setprio 0
    s_lshr_b32 s92, s90, 6
    s_lshl_b32 s92, s92, 9
    s_bfe_u32 s93, s90, 0x20004
    s_lshl_b32 s93, s93, 6
    s_add_u32 s92, s92, s93
    s_and_b32 s93, s90, 3
    s_lshl_b32 s93, s93, 4
    s_add_u32 s92, s92, s93
    s_and_b32 s93, s90, 12
    s_add_u32 s92, s92, s93
    s_lshr_b32 s93, s38, 1
    s_lshl_b32 s93, s93, 8
    s_add_u32 s92, s92, s93
    s_and_b32 s93, s38, 1
    s_lshl_b32 s93, s93, 1
    s_add_u32 s92, s92, s93
    v_lshrrev_b32 v113, 5, v1
    v_and_b32 v114, 31, v1
    v_add_u32 v112, s92, v113
    v_mul_u32_u24 v115, 1152, v112
    v_lshl_add_u32 v8, v114, 2, v115
    v_lshl_add_u32 v115, v114, 4, v115
    v_lshlrev_b32 v7, 2, v114
    v_lshlrev_b32 v6, 4, v114
    v_bfe_u32 v111, v1, 3, 1
    v_add_u32 v111, s92, v111
    v_mul_u32_u24 v111, 1152, v111
    v_and_b32 v9, 7, v1
    v_lshl_add_u32 v111, v9, 4, v111
    s_mov_b32 s64, s4
    s_mov_b32 s65, s5
    s_mov_b32 s66, 0x240000
    s_mov_b32 s67, 0x20000
    s_mov_b32 s68, s24
    s_mov_b32 s69, s25
    s_mov_b32 s70, 0x480
    s_mov_b32 s71, 0x20000
    buffer_load_dwordx4 v[10:13], v115, s[64:67], 0 offen
    buffer_load_dwordx4 v[14:17], v115, s[64:67], 0 offen offset:512
    buffer_load_dword v18, v8, s[64:67], 0 offen offset:1024
    buffer_load_dwordx4 v[50:53], v6, s[68:71], 0 offen
    buffer_load_dwordx4 v[54:57], v6, s[68:71], 0 offen offset:512
    buffer_load_dword v58, v7, s[68:71], 0 offen offset:1024
KS_L4:
    s_add_u32 s64, s36, 0x600000
    s_addc_u32 s65, s37, 0
    s_mov_b32 s66, 0x240000
    s_mov_b32 s67, 0x20000
    s_mov_b32 s68, s32
    s_mov_b32 s69, s33
    s_mov_b32 s70, 0x240000
    s_mov_b32 s71, 0x20000
    s_mov_b32 s72, s36
    s_mov_b32 s73, s37
    s_mov_b32 s74, 0x240000
    s_mov_b32 s75, 0x20000
    s_add_u32 s76, s36, 0x840000
    s_addc_u32 s77, s37, 0
    s_mov_b32 s78, 0x3000
    s_mov_b32 s79, 0x20000
    s_not_b32 s93, s90
    v_xor_b32 v8, s93, v0
    v_lshrrev_b32 v6, 1, v0
    v_lshlrev_b32 v6, 6, v6
    v_and_b32 v8, 1, v8
    v_lshl_add_u32 v6, v8, 4, v6
    s_lshr_b32 s92, s90, 2
    s_lshl_b32 s92, s92, 15
    s_and_b32 s93, s90, 1
    s_lshl_b32 s93, s93, 14
    s_add_u32 s92, s92, s93
    s_and_b32 s93, s90, 2
    s_lshl_b32 s93, s93, 4
    s_add_u32 s92, s92, s93
    s_lshr_b32 s94, s90, 2
    s_lshl_b32 s94, s94, 12
    s_and_b32 s93, s90, 3
    s_lshl_b32 s93, s93, 4
    s_add_u32 s94, s94, s93
    s_lshl_b32 s93, s38, 10
    s_add_u32 s94, s94, s93
    s_add_u32 s94, s94, 0x200000
    v_lshlrev_b32 v9, 6, v2
    s_lshl_b32 s93, s90, 5
    s_and_b32 s95, s93, 0x1f80
    v_xor_b32 v6, s95, v6
    s_and_b32 s95, s93, 0x380
    v_xor_b32 v9, s95, v9
    s_and_b32 s95, s93, 0xc00
    s_xor_b32 s94, s94, s95
    s_and_b32 s93, s90, 1
    s_lshl_b32 s93, s93, 13
    s_xor_b32 s92, s92, s93
    s_xor_b32 s93, s92, 0x2000
    s_mul_i32 s95, s38, 2304
    s_add_u32 s95, s95, 17088
    v_lshl_add_u32 v117, v114, 5, s95
    v_lshl_add_u32 v110, v114, 3, s95
    s_lshl_b32 s95, s38, 9
    s_add_u32 s95, s95, 35840
    v_lshl_add_u32 v108, v1, 2, s95
    v_lshl_add_u32 v109, v1, 4, s95
    s_mov_b32 s95, 0x02020000
    v_mul_lo_u32 v118, v113, s95
    v_add_u32 v118, 0x01000c0c, v118
    v_lshlrev_b32 v8, 2, v0
    v_add_u32 v8, 17088, v8
    s_lshl_b32 s95, s38, 6
    s_add_u32 s95, s95, 19136
    v_lshl_add_u32 v119, v2, 2, s95
    s_waitcnt vmcnt(0)
    v_lshlrev_b32 v20, 16, v10
    v_and_b32 v21, 0xffff0000, v10
    v_lshlrev_b32 v22, 16, v11
    v_and_b32 v23, 0xffff0000, v11
    v_lshlrev_b32 v24, 16, v12
    v_and_b32 v25, 0xffff0000, v12
    v_lshlrev_b32 v26, 16, v13
    v_and_b32 v27, 0xffff0000, v13
    v_lshlrev_b32 v28, 16, v14
    v_and_b32 v29, 0xffff0000, v14
    v_lshlrev_b32 v30, 16, v15
    v_and_b32 v31, 0xffff0000, v15
    v_lshlrev_b32 v32, 16, v16
    v_and_b32 v33, 0xffff0000, v16
    v_lshlrev_b32 v34, 16, v17
    v_and_b32 v35, 0xffff0000, v17
    v_lshlrev_b32 v36, 16, v18
    v_and_b32 v37, 0xffff0000, v18
    v_lshlrev_b32 v80, 16, v50
    v_and_b32 v81, 0xffff0000, v50
    v_lshlrev_b32 v82, 16, v51
    v_and_b32 v83, 0xffff0000, v51
    v_lshlrev_b32 v84, 16, v52
    v_and_b32 v85, 0xffff0000, v52
    v_lshlrev_b32 v86, 16, v53
    v_and_b32 v87, 0xffff0000, v53
    v_lshlrev_b32 v88, 16, v54
    v_and_b32 v89, 0xffff0000, v54
    v_lshlrev_b32 v90, 16, v55
    v_and_b32 v91, 0xffff0000, v55
    v_lshlrev_b32 v92, 16, v56
    v_and_b32 v93, 0xffff0000, v56
    v_lshlrev_b32 v94, 16, v57
    v_and_b32 v95, 0xffff0000, v57
    v_lshlrev_b32 v96, 16, v58
    v_and_b32 v97, 0xffff0000, v58
    v_pk_add_f32 v[78:79], v[80:81], v[82:83]
    v_pk_add_f32 v[78:79], v[78:79], v[84:85]
    v_pk_add_f32 v[78:79], v[78:79], v[86:87]
    v_pk_add_f32 v[78:79], v[78:79], v[88:89]
    v_pk_add_f32 v[78:79], v[78:79], v[90:91]
    v_pk_add_f32 v[78:79], v[78:79], v[92:93]
    v_pk_add_f32 v[78:79], v[78:79], v[94:95]
    v_pk_add_f32 v[78:79], v[78:79], v[96:97]
    v_add_f32 v78, v78, v79
    s_nop 1
    v_add_f32_dpp v78, v78, v78 row_ror:8 row_mask:0xf bank_mask:0xf
    s_nop 1
    v_add_f32_dpp v78, v78, v78 row_ror:4 row_mask:0xf bank_mask:0xf
    s_nop 1
    v_add_f32_dpp v78, v78, v78 row_ror:2 row_mask:0xf bank_mask:0xf
    s_nop 1
    v_add_f32_dpp v78, v78, v78 row_ror:1 row_mask:0xf bank_mask:0xf
    v_mov_b32 v79, v78
    s_nop 1
    v_permlane16_swap_b32 v78, v79
    v_add_f32 v78, v78, v79
    v_sub_u32 v98, 0x87ff, v112
    v_lshl_add_u32 v99, v116, 1, v113
    v_lshlrev_b32 v99, 2, v99
    s_lshl_b32 s97, s90, 5
W_82:
    s_sleep 1
    ds_read_b32 v60, v4 offset:52
    s_sub_u32 s39, s39, 1
    s_cbranch_scc1 KS_ABORT
    s_waitcnt lgkmcnt(0)
    v_cmp_ne_u32 vcc, s84, v60
    s_cbranch_vccnz W_82
    s_setprio 3
    s_branch ZPE_84
ZP_83:
    s_sleep 1
ZPE_84:
    buffer_load_dwordx4 v[68:71], v4, s[64:67], s94 offen sc1
    s_sub_u32 s39, s39, 1
    s_cbranch_scc1 KS_ABORT
    s_waitcnt vmcnt(0)
    v_max3_u32 v44, v68, v69, v70
    v_max_u32 v44, v44, v71
    v_cmp_eq_u32 vcc, -1, v44
    s_cbranch_vccnz ZP_83
    s_branch ZPE_86
ZP_85:
    s_sleep 1
ZPE_86:
    buffer_load_dwordx4 v[60:63], v6, s[64:67], s92 offen sc1
    buffer_load_dwordx4 v[64:67], v6, s[64:67], s93 offen sc1
    buffer_load_dwordx4 v[68:71], v9, s[64:67], s94 offen sc1
    s_sub_u32 s39, s39, 1
    s_cbranch_scc1 KS_ABORT
    s_waitcnt vmcnt(2)
    ds_write2st64_b32 v8, v60, v61 offset0:0 offset1:9
    ds_write2st64_b32 v8, v62, v63 offset0:18 offset1:27
    v_max3_u32 v44, v60, v61, v61
    v_max3_u32 v44, v62, v63, v44
    s_waitcnt vmcnt(1)
    ds_write2st64_b32 v8, v64, v65 offset0:4 offset1:13
    ds_write2st64_b32 v8, v66, v67 offset0:22 offset1:31
    v_max3_u32 v44, v64, v65, v44
    v_max3_u32 v44, v66, v67, v44
    s_waitcnt vmcnt(0)
    ds_write2st64_b32 v119, v68, v69 offset0:0 offset1:9
    ds_write2st64_b32 v119, v70, v71 offset0:18 offset1:27
    v_max3_u32 v44, v68, v69, v44
    v_max3_u32 v44, v70, v71, v44
    v_cmp_eq_u32 vcc, -1, v44
    s_cbranch_vccnz ZP_85
    ds_write_b8 v116, v5 offset:20
ZW_87:
    ds_read_b32 v44, v4 offset:20
    ds_read_b128 v[60:63], v117 offset:0
    ds_read_b128 v[64:67], v117 offset:16
    ds_read_b128 v[68:71], v117 offset:1024
    ds_read_b128 v[72:75], v117 offset:1040
    ds_read_b64 v[76:77], v110 offset:2048
    s_sub_u32 s39, s39, 1
    s_cbranch_scc1 KS_ABORT
    s_waitcnt lgkmcnt(5)
    v_cmp_ne_u32 vcc, s84, v44
    s_cbranch_vccnz ZW_87
    s_waitcnt lgkmcnt(4)
    v_perm_b32 v60, v60, v60, v118
    v_perm_b32 v61, v61, v61, v118
    v_pk_add_f32 v[20:21], v[60:61], v[20:21]
    v_pk_mul_f32 v[42:43], v[20:21], v[20:21]
    v_pk_mul_f32 v[44:45], v[20:21], v[80:81]
    v_perm_b32 v62, v62, v62, v118
    v_perm_b32 v63, v63, v63, v118
    v_pk_add_f32 v[22:23], v[62:63], v[22:23]
    v_pk_fma_f32 v[42:43], v[22:23], v[22:23], v[42:43]
    v_pk_fma_f32 v[44:45], v[22:23], v[82:83], v[44:45]
    v_pk_add_f32 v[40:41], v[22:23], v[20:21]
    s_waitcnt lgkmcnt(3)
    v_perm_b32 v64, v64, v64, v118
    v_perm_b32 v65, v65, v65, v118
    v_pk_add_f32 v[24:25], v[64:65], v[24:25]
    v_pk_fma_f32 v[42:43], v[24:25], v[24:25], v[42:43]
    v_pk_fma_f32 v[44:45], v[24:25], v[84:85], v[44:45]
    v_pk_add_f32 v[40:41], v[24:25], v[40:41]
    v_perm_b32 v66, v66, v66, v118
    v_perm_b32 v67, v67, v67, v118
    v_pk_add_f32 v[26:27], v[66:67], v[26:27]
    v_pk_fma_f32 v[42:43], v[26:27], v[26:27], v[42:43]
    v_pk_fma_f32 v[44:45], v[26:27], v[86:87], v[44:45]
    v_pk_add_f32 v[40:41], v[26:27], v[40:41]
    s_waitcnt lgkmcnt(2)
    v_perm_b32 v68, v68, v68, v118
    v_perm_b32 v69, v69, v69, v118
    v_pk_add_f32 v[28:29], v[68:69], v[28:29]
    v_pk_fma_f32 v[42:43], v[28:29], v[28:29], v[42:43]
    v_pk_fma_f32 v[44:45], v[28:29], v[88:89], v[44:45]
    v_pk_add_f32 v[40:41], v[28:29], v[40:41]
    v_perm_b32 v70, v70, v70, v118
    v_perm_b32 v71, v71, v71, v118
    v_pk_add_f32 v[30:31], v[70:71], v[30:31]
    v_pk_fma_f32 v[42:43], v[30:31], v[30:31], v[42:43]
    v_pk_fma_f32 v[44:45], v[30:31], v[90:91], v[44:45]
    v_pk_add_f32 v[40:41], v[30:31], v[40:41]
    s_waitcnt lgkmcnt(1)
    v_perm_b32 v72, v72, v72, v118
    v_perm_b32 v73, v73, v73, v118
    v_pk_add_f32 v[32:33], v[72:73], v[32:33]
    v_pk_fma_f32 v[42:43], v[32:33], v[32:33], v[42:43]
    v_pk_fma_f32 v[44:45], v[32:33], v[92:93], v[44:45]
    v_pk_add_f32 v[40:41], v[32:33], v[40:41]
    v_perm_b32 v74, v74, v74, v118
    v_perm_b32 v75, v75, v75, v118
    v_pk_add_f32 v[34:35], v[74:75], v[34:35]
    v_pk_fma_f32 v[42:43], v[34:35], v[34:35], v[42:43]
    v_pk_fma_f32 v[44:45], v[34:35], v[94:95], v[44:45]
    v_pk_add_f32 v[40:41], v[34:35], v[40:41]
    s_waitcnt lgkmcnt(0)
    v_perm_b32 v76, v76, v76, v118
    v_perm_b32 v77, v77, v77, v118
    v_pk_add_f32 v[36:37], v[76:77], v[36:37]
    v_pk_fma_f32 v[42:43], v[36:37], v[36:37], v[42:43]
    v_pk_fma_f32 v[44:45], v[36:37], v[96:97], v[44:45]
    v_pk_add_f32 v[40:41], v[36:37], v[40:41]
    v_add_f32 v42, v42, v43
    v_add_f32 v44, v44, v45
    v_add_f32 v40, v40, v41
    v_mov_b32 v41, v40
    v_permlane16_swap_b32 v42, v44
    s_nop 0
    v_permlane16_swap_b32 v40, v41
    v_add_f32 v42, v42, v44
    v_add_f32 v40, v40, v41
    s_nop 0
    v_add_f32_dpp v42, v42, v42 row_ror:8 row_mask:0xf bank_mask:0xf
    v_add_f32_dpp v40, v40, v40 row_ror:8 row_mask:0xf bank_mask:0xf
    s_nop 0
    v_add_f32_dpp v42, v42, v42 row_ror:4 row_mask:0xf bank_mask:0xf
    v_add_f32_dpp v40, v40, v40 row_ror:4 row_mask:0xf bank_mask:0xf
    s_nop 0
    v_add_f32_dpp v42, v42, v42 row_ror:2 row_mask:0xf bank_mask:0xf
    v_add_f32_dpp v40, v40, v40 row_ror:2 row_mask:0xf bank_mask:0xf
    s_nop 0
    v_add_f32_dpp v42, v42, v42 row_ror:1 row_mask:0xf bank_mask:0xf
    v_add_f32_dpp v40, v40, v40 row_ror:1 row_mask:0xf bank_mask:0xf
    v_mul_f32 v40, 0x3ae38e39, v40
    v_mov_b32 v44, v42
    v_cvt_pk_bf16_f32 v41, 0, v40
    v_mul_f32 v40, v40, v40
    v_permlane16_swap_b32 v42, v44
    v_mov_b32 v43, 0x3ae38e39
    v_fma_f32 v42, v42, v43, -v40
    v_fma_f32 v44, -v41, v78, v44
    v_max_f32 v42, 0, v42
    v_cvt_pk_bf16_f32 v42, 0, v42
    v_add_f32 v42, 0x3727c5ac, v42
    v_cvt_pk_bf16_f32 v42, 0, v42
    v_sqrt_f32 v42, v42
    s_nop 0
    v_cvt_pk_bf16_f32 v42, 0, v42
    v_rcp_f32 v42, v42
    s_nop 0
    v_mul_f32 v60, v44, v42
    v_cvt_pk_bf16_f32 v60, v60, v60
    v_ashrrev_i32 v61, 31, v60
    v_or_b32 v61, 0x80000000, v61
    s_mov_b32 s95, 0xffff0000
    v_xor_b32 v60, v60, v61
    v_and_or_b32 v60, v60, s95, v98
    v_mov_b32 v61, v60
    s_nop 1
    v_permlane32_swap_b32 v60, v61
    s_mov_b64 exec, 1
    buffer_store_dwordx2 v[60:61], v99, s[76:79], s97 offen sc1
    ds_write_b8 v116, v5 offset:12
    s_mov_b64 exec, -1
    s_setprio 2
    v_cvt_pk_bf16_f32 v20, 0, v20
    v_cvt_pk_bf16_f32 v21, 0, v21
    v_cvt_pk_bf16_f32 v22, 0, v22
    v_cvt_pk_bf16_f32 v23, 0, v23
    v_cvt_pk_bf16_f32 v24, 0, v24
    v_cvt_pk_bf16_f32 v25, 0, v25
    v_cvt_pk_bf16_f32 v26, 0, v26
    v_cvt_pk_bf16_f32 v27, 0, v27
    v_cvt_pk_bf16_f32 v28, 0, v28
    v_cvt_pk_bf16_f32 v29, 0, v29
    v_cvt_pk_bf16_f32 v30, 0, v30
    v_cvt_pk_bf16_f32 v31, 0, v31
    v_cvt_pk_bf16_f32 v32, 0, v32
    v_cvt_pk_bf16_f32 v33, 0, v33
    v_cvt_pk_bf16_f32 v34, 0, v34
    v_cvt_pk_bf16_f32 v35, 0, v35
    v_cvt_pk_bf16_f32 v36, 0, v36
    v_cvt_pk_bf16_f32 v37, 0, v37
    v_pk_add_f32 v[44:45], v[20:21], v[22:23]
    v_pk_add_f32 v[46:47], v[24:25], v[26:27]
    v_pk_add_f32 v[44:45], v[44:45], v[28:29]
    v_pk_add_f32 v[46:47], v[46:47], v[30:31]
    v_pk_add_f32 v[44:45], v[44:45], v[32:33]
    v_pk_add_f32 v[46:47], v[46:47], v[34:35]
    v_pk_add_f32 v[44:45], v[44:45], v[36:37]
    v_pk_add_f32 v[44:45], v[44:45], v[46:47]
    v_add_f32 v44, v44, v45
    s_nop 1
    v_add_f32_dpp v44, v44, v44 row_ror:8 row_mask:0xf bank_mask:0xf
    s_nop 1
    v_add_f32_dpp v44, v44, v44 row_ror:4 row_mask:0xf bank_mask:0xf
    s_nop 1
    v_add_f32_dpp v44, v44, v44 row_ror:2 row_mask:0xf bank_mask:0xf
    s_nop 1
    v_add_f32_dpp v44, v44, v44 row_ror:1 row_mask:0xf bank_mask:0xf
    v_mov_b32 v46, v44
    s_nop 1
    v_permlane16_swap_b32 v44, v46
    v_add_f32 v44, v44, v46
    v_mul_f32 v48, 0x3ae38e39, v44
    v_mov_b32 v49, v48
    v_cvt_pk_bf16_f32 v40, 0, v48
    v_cvt_pk_bf16_f32 v41, 0, v48
    v_pk_add_f32 v[42:43], v[20:21], v[48:49] neg_lo:[0,1] neg_hi:[0,1]
    v_pk_mul_f32 v[44:45], v[42:43], v[42:43]
    v_pk_add_f32 v[42:43], v[22:23], v[48:49] neg_lo:[0,1] neg_hi:[0,1]
    v_pk_mul_f32 v[46:47], v[42:43], v[42:43]
    v_pk_add_f32 v[42:43], v[24:25], v[48:49] neg_lo:[0,1] neg_hi:[0,1]
    v_pk_fma_f32 v[44:45], v[42:43], v[42:43], v[44:45]
    v_pk_add_f32 v[42:43], v[26:27], v[48:49] neg_lo:[0,1] neg_hi:[0,1]
    v_pk_fma_f32 v[46:47], v[42:43], v[42:43], v[46:47]
    v_pk_add_f32 v[42:43], v[28:29], v[48:49] neg_lo:[0,1] neg_hi:[0,1]
    v_pk_fma_f32 v[44:45], v[42:43], v[42:43], v[44:45]
    v_pk_add_f32 v[42:43], v[30:31], v[48:49] neg_lo:[0,1] neg_hi:[0,1]
    v_pk_fma_f32 v[46:47], v[42:43], v[42:43], v[46:47]
    v_pk_add_f32 v[42:43], v[32:33], v[48:49] neg_lo:[0,1] neg_hi:[0,1]
    v_pk_fma_f32 v[44:45], v[42:43], v[42:43], v[44:45]
    v_pk_add_f32 v[42:43], v[34:35], v[48:49] neg_lo:[0,1] neg_hi:[0,1]
    v_pk_fma_f32 v[46:47], v[42:43], v[42:43], v[46:47]
    v_pk_add_f32 v[42:43], v[36:37], v[48:49] neg_lo:[0,1] neg_hi:[0,1]
    v_pk_fma_f32 v[44:45], v[42:43], v[42:43], v[44:45]
    v_pk_add_f32 v[44:45], v[44:45], v[46:47]
    v_add_f32 v44, v44, v45
    s_nop 1
    v_add_f32_dpp v44, v44, v44 row_ror:8 row_mask:0xf bank_mask:0xf
    s_nop 1
    v_add_f32_dpp v44, v44, v44 row_ror:4 row_mask:0xf bank_mask:0xf
    s_nop 1
    v_add_f32_dpp v44, v44, v44 row_ror:2 row_mask:0xf bank_mask:0xf
    s_nop 1
    v_add_f32_dpp v44, v44, v44 row_ror:1 row_mask:0xf bank_mask:0xf
    v_mov_b32 v46, v44
    s_nop 1
    v_permlane16_swap_b32 v44, v46
    v_add_f32 v44, v44, v46
    v_mul_f32 v44, 0x3ae38e39, v44
    v_cvt_pk_bf16_f32 v44, 0, v44
    v_add_f32 v44, 0x3727c5ac, v44
    v_cvt_pk_bf16_f32 v44, 0, v44
    v_sqrt_f32 v44, v44
    s_nop 0
    v_cvt_pk_bf16_f32 v44, 0, v44
    v_rcp_f32 v42, v44
    s_nop 0
    v_mov_b32 v43, v42
    v_pk_add_f32 v[44:45], v[20:21], v[40:41] neg_lo:[0,1] neg_hi:[0,1]
    v_cvt_pk_bf16_f32 v44, 0, v44
    v_cvt_pk_bf16_f32 v45, 0, v45
    v_pk_mul_f32 v[44:45], v[44:45], v[42:43]
    v_cvt_pk_bf16_f32 v10, v44, v45
    v_cvt_pk_bf16_f32 v44, 0, v44
    v_cvt_pk_bf16_f32 v45, 0, v45
    v_pk_add_f32 v[20:21], v[44:45], v[20:21]
    v_pk_add_f32 v[44:45], v[22:23], v[40:41] neg_lo:[0,1] neg_hi:[0,1]
    v_cvt_pk_bf16_f32 v44, 0, v44
    v_cvt_pk_bf16_f32 v45, 0, v45
    v_pk_mul_f32 v[44:45], v[44:45], v[42:43]
    v_cvt_pk_bf16_f32 v11, v44, v45
    v_cvt_pk_bf16_f32 v44, 0, v44
    v_cvt_pk_bf16_f32 v45, 0, v45
    v_pk_add_f32 v[22:23], v[44:45], v[22:23]
    v_pk_add_f32 v[44:45], v[24:25], v[40:41] neg_lo:[0,1] neg_hi:[0,1]
    v_cvt_pk_bf16_f32 v44, 0, v44
    v_cvt_pk_bf16_f32 v45, 0, v45
    v_pk_mul_f32 v[44:45], v[44:45], v[42:43]
    v_cvt_pk_bf16_f32 v12, v44, v45
    v_cvt_pk_bf16_f32 v44, 0, v44
    v_cvt_pk_bf16_f32 v45, 0, v45
    v_pk_add_f32 v[24:25], v[44:45], v[24:25]
    v_pk_add_f32 v[44:45], v[26:27], v[40:41] neg_lo:[0,1] neg_hi:[0,1]
    v_cvt_pk_bf16_f32 v44, 0, v44
    v_cvt_pk_bf16_f32 v45, 0, v45
    v_pk_mul_f32 v[44:45], v[44:45], v[42:43]
    v_cvt_pk_bf16_f32 v13, v44, v45
    v_cvt_pk_bf16_f32 v44, 0, v44
    v_cvt_pk_bf16_f32 v45, 0, v45
    v_pk_add_f32 v[26:27], v[44:45], v[26:27]
    v_pk_add_f32 v[44:45], v[28:29], v[40:41] neg_lo:[0,1] neg_hi:[0,1]
    v_cvt_pk_bf16_f32 v44, 0, v44
    v_cvt_pk_bf16_f32 v45, 0, v45
    v_pk_mul_f32 v[44:45], v[44:45], v[42:43]
    v_cvt_pk_bf16_f32 v14, v44, v45
    v_cvt_pk_bf16_f32 v44, 0, v44
    v_cvt_pk_bf16_f32 v45, 0, v45
    v_pk_add_f32 v[28:29], v[44:45], v[28:29]
    v_pk_add_f32 v[44:45], v[30:31], v[40:41] neg_lo:[0,1] neg_hi:[0,1]
    v_cvt_pk_bf16_f32 v44, 0, v44
    v_cvt_pk_bf16_f32 v45, 0, v45
    v_pk_mul_f32 v[44:45], v[44:45], v[42:43]
    v_cvt_pk_bf16_f32 v15, v44, v45
    v_cvt_pk_bf16_f32 v44, 0, v44
    v_cvt_pk_bf16_f32 v45, 0, v45
    v_pk_add_f32 v[30:31], v[44:45], v[30:31]
    v_pk_add_f32 v[44:45], v[32:33], v[40:41] neg_lo:[0,1] neg_hi:[0,1]
    v_cvt_pk_bf16_f32 v44, 0, v44
    v_cvt_pk_bf16_f32 v45, 0, v45
    v_pk_mul_f32 v[44:45], v[44:45], v[42:43]
    v_cvt_pk_bf16_f32 v16, v44, v45
    v_cvt_pk_bf16_f32 v44, 0, v44
    v_cvt_pk_bf16_f32 v45, 0, v45
    v_pk_add_f32 v[32:33], v[44:45], v[32:33]
    v_pk_add_f32 v[44:45], v[34:35], v[40:41] neg_lo:[0,1] neg_hi:[0,1]
    v_cvt_pk_bf16_f32 v44, 0, v44
    v_cvt_pk_bf16_f32 v45, 0, v45
    v_pk_mul_f32 v[44:45], v[44:45], v[42:43]
    v_cvt_pk_bf16_f32 v17, v44, v45
    v_cvt_pk_bf16_f32 v44, 0, v44
    v_cvt_pk_bf16_f32 v45, 0, v45
    v_pk_add_f32 v[34:35], v[44:45], v[34:35]
    v_pk_add_f32 v[44:45], v[36:37], v[40:41] neg_lo:[0,1] neg_hi:[0,1]
    v_cvt_pk_bf16_f32 v44, 0, v44
    v_cvt_pk_bf16_f32 v45, 0, v45
    v_pk_mul_f32 v[44:45], v[44:45], v[42:43]
    v_cvt_pk_bf16_f32 v18, v44, v45
    v_cvt_pk_bf16_f32 v44, 0, v44
    v_cvt_pk_bf16_f32 v45, 0, v45
    v_pk_add_f32 v[36:37], v[44:45], v[36:37]
    v_cvt_pk_bf16_f32 v58, v36, v37
    ds_write_b32 v108, v18
    ds_write_b32 v108, v58 offset:256
    ds_read_b128 v[64:67], v109
    buffer_store_dwordx4 v[10:13], v115, s[72:75], 0 offen sc1
    buffer_store_dwordx4 v[14:17], v115, s[72:75], 0 offen offset:512 sc1
    v_cvt_pk_bf16_f32 v50, v20, v21
    v_cvt_pk_bf16_f32 v51, v22, v23
    v_cvt_pk_bf16_f32 v52, v24, v25
    v_cvt_pk_bf16_f32 v53, v26, v27
    v_cvt_pk_bf16_f32 v54, v28, v29
    v_cvt_pk_bf16_f32 v55, v30, v31
    v_cvt_pk_bf16_f32 v56, v32, v33
    v_cvt_pk_bf16_f32 v57, v34, v35
    s_mov_b64 exec, 0xffff
    s_waitcnt lgkmcnt(0)
    buffer_store_dwordx4 v[64:67], v111, s[72:75], 0 offen offset:1024 sc1
    s_setprio 0
    s_sleep 24
    s_mov_b64 exec, 0xffff0000
    buffer_store_dwordx4 v[64:67], v111, s[68:71], 0 offen offset:1024 sc1
    s_mov_b64 exec, -1
    buffer_store_dwordx4 v[50:53], v115, s[68:71], 0 offen sc1
    buffer_store_dwordx4 v[54:57], v115, s[68:71], 0 offen offset:512 sc1
    s_mul_i32 s92, s89, 9344
    s_add_u32 s92, s92, 0x850000
    s_add_u32 s64, s36, s92
    s_addc_u32 s65, s37, 0
    s_cmp_lt_u32 s41, 18
    s_cselect_b32 s66, 9216, 0
    s_mov_b32 s67, 0x20000
    s_mul_i32 s92, s38, 3072
    v_lshlrev_b32 v8, 4, v1
    v_mov_b32 v60, -1
    v_mov_b32 v61, -1
    v_mov_b32 v62, -1
    v_mov_b32 v63, -1
    buffer_store_dwordx4 v[60:63], v8, s[64:67], s92 offen offset:0 sc1
    buffer_store_dwordx4 v[60:63], v8, s[64:67], s92 offen offset:1024 sc1
    buffer_store_dwordx4 v[60:63], v8, s[64:67], s92 offen offset:2048 sc1
    s_waitcnt vmcnt(0)
    s_mov_b64 exec, 1
    ds_add_rtn_u32 v62, v4, v5 offset:176
    s_waitcnt lgkmcnt(0)
    v_cmp_eq_u32 vcc, 3, v62
    s_and_b64 exec, exec, vcc
    s_cbranch_execz KS_NOF2
    s_lshl_b32 s92, s2, 4
    s_add_u32 s92, s92, 8192
    buffer_store_dword v5, v4, s[76:79], s92 offen sc1
KS_NOF2:
    s_mov_b64 exec, -1
    s_setprio 0
    s_cmp_lt_u32 s41, 18
    s_cbranch_scc1 KS_B
    s_waitcnt lgkmcnt(0)
    s_endpgm
KS_T:
    s_setprio 0
    s_cmp_ge_u32 s38, 10
    s_cbranch_scc1 KS_PEND
    v_and_b32 v6, 1, v1
    v_subrev_u32 v6, 1, v6
    v_and_b32 v7, 7, v1
    v_lshlrev_b32 v7, 2, v7
    s_add_u32 s76, s36, 0x840000
    s_addc_u32 s77, s37, 0
    s_mov_b32 s78, 0x3000
    s_mov_b32 s79, 0x20000
    s_cmp_eq_u32 s38, 9
    s_cbranch_scc1 KS_W9
    s_cmp_eq_u32 s38, 8
    s_cbranch_scc1 KS_L2W
    s_branch KS_B
KS_L2W:
    s_mov_b32 s72, s36
    s_mov_b32 s73, s37
    s_mov_b32 s74, 0x240000
    s_mov_b32 s75, 0x20000
    v_lshlrev_b32 v40, 4, v1
    s_movk_i32 s92, 4096
    s_movk_i32 s96, -1152
    s_mov_b32 s93, 0
    v_mov_b32 v57, 0
    v_and_b32 v41, 1, v1
    v_lshl_add_u32 v41, v3, 1, v41
    v_lshlrev_b32 v41, 4, v41
    v_add_u32 v41, 2358144, v41
    v_lshlrev_b32 v7, 1, v1
    v_and_b32 v7, 28, v7
W_88:
    s_sleep 1
    ds_read_b32 v8, v4 offset:12
    s_sub_u32 s39, s39, 1
    s_cbranch_scc1 KS_ABORT
    s_waitcnt lgkmcnt(0)
    v_cmp_ne_u32 vcc, s84, v8
    s_cbranch_vccnz W_88
    s_setprio 3
    s_sleep 27
    s_branch KS_Q1
KS_Q0:
    s_sleep 1
KS_Q1:
    buffer_load_dwordx4 v[8:11], v40, s[76:79], 0 offen offset:0 sc1
    buffer_load_dwordx4 v[12:15], v40, s[76:79], 0 offen offset:1024 sc1
    buffer_load_dwordx4 v[16:19], v40, s[76:79], 0 offen offset:2048 sc1
    buffer_load_dwordx4 v[20:23], v40, s[76:79], 0 offen offset:3072 sc1
    buffer_load_dwordx4 v[24:27], v40, s[76:79], s92 offen offset:0 sc1
    buffer_load_dwordx4 v[28:31], v40, s[76:79], s92 offen offset:1024 sc1
    buffer_load_dwordx4 v[32:35], v40, s[76:79], s92 offen offset:2048 sc1
    buffer_load_dwordx4 v[36:39], v40, s[76:79], s92 offen offset:3072 sc1
    s_sub_u32 s39, s39, 1
    s_cbranch_scc1 KS_ABORT
    s_waitcnt vmcnt(7)
    v_max_u32 v42, v8, v9
    v_max_u32 v44, v10, v11
    v_min_u32 v43, v8, v9
    v_min_u32 v45, v10, v11
    s_waitcnt vmcnt(6)
    v_med3_u32 v46, v42, v12, v13
    v_med3_u32 v47, v44, v14, v15
    v_max3_u32 v42, v42, v12, v13
    v_max3_u32 v44, v44, v14, v15
    v_max_u32 v43, v43, v46
    v_max_u32 v45, v45, v47
    s_waitcnt vmcnt(5)
    v_med3_u32 v46, v42, v16, v17
    v_med3_u32 v47, v44, v18, v19
    v_max3_u32 v42, v42, v16, v17
    v_max3_u32 v44, v44, v18, v19
    v_max_u32 v43, v43, v46
    v_max_u32 v45, v45, v47
    s_waitcnt vmcnt(4)
    v_med3_u32 v46, v42, v20, v21
    v_med3_u32 v47, v44, v22, v23
    v_max3_u32 v42, v42, v20, v21
    v_max3_u32 v44, v44, v22, v23
    v_max_u32 v43, v43, v46
    v_max_u32 v45, v45, v47
    s_waitcnt vmcnt(3)
    v_med3_u32 v46, v42, v24, v25
    v_med3_u32 v47, v44, v26, v27
    v_max3_u32 v42, v42, v24, v25
    v_max3_u32 v44, v44, v26, v27
    v_max_u32 v43, v43, v46
    v_max_u32 v45, v45, v47
    s_waitcnt vmcnt(2)
    v_med3_u32 v46, v42, v28, v29
    v_med3_u32 v47, v44, v30, v31
    v_max3_u32 v42, v42, v28, v29
    v_max3_u32 v44, v44, v30, v31
    v_max_u32 v43, v43, v46
    v_max_u32 v45, v45, v47
    s_waitcnt vmcnt(1)
    v_med3_u32 v46, v42, v32, v33
    v_med3_u32 v47, v44, v34, v35
    v_max3_u32 v42, v42, v32, v33
    v_max3_u32 v44, v44, v34, v35
    v_max_u32 v43, v43, v46
    v_max_u32 v45, v45, v47
    v_max_u32 v43, v43, v45
    s_waitcnt vmcnt(0)
    v_med3_u32 v46, v42, v36, v37
    v_med3_u32 v47, v44, v38, v39
    v_max3_u32 v42, v42, v36, v37
    v_max3_u32 v44, v44, v38, v39
    v_max3_u32 v43, v43, v46, v47
    v_max_u32 v48, v42, v44
    v_med3_u32 v49, v42, v44, v43
    v_cmp_eq_u32 vcc, -1, v48
    v_mov_b32 v56, v49
KS_QN:
    v_max_u32_dpp v50, v49, v48 row_half_mirror row_mask:0xf bank_mask:0x5
    v_max_u32_dpp v51, v48, v49 row_half_mirror row_mask:0xf bank_mask:0x5
    v_min_u32_dpp v50, v49, v48 row_half_mirror row_mask:0xf bank_mask:0xa
    v_min_u32_dpp v51, v48, v49 row_half_mirror row_mask:0xf bank_mask:0xa
    s_cbranch_vccnz KS_Q0
    s_cmp_eq_u32 s93, 1
    v_min_u32 v53, v50, v51
    v_max_u32 v52, v50, v51
    s_nop 1
    v_max_u32_dpp v50, v53, v52 row_mirror row_mask:0xf bank_mask:0x3
    v_max_u32_dpp v51, v52, v53 row_mirror row_mask:0xf bank_mask:0x3
    v_min_u32_dpp v50, v53, v52 row_mirror row_mask:0xf bank_mask:0xc
    v_min_u32_dpp v51, v52, v53 row_mirror row_mask:0xf bank_mask:0xc
    s_nop 0
    v_max_u32_dpp v52, v50, v50 row_half_mirror row_mask:0xf bank_mask:0x5
    v_max_u32_dpp v53, v51, v51 row_half_mirror row_mask:0xf bank_mask:0x5
    v_min_u32_dpp v52, v50, v50 row_half_mirror row_mask:0xf bank_mask:0xa
    v_min_u32_dpp v53, v51, v51 row_half_mirror row_mask:0xf bank_mask:0xa
    v_max_u32 v48, v52, v53
    v_max_u32 v54, v52, v53
    v_min_u32 v49, v52, v53
    v_min_u32 v55, v52, v53
    v_permlane32_swap_b32 v48, v54
    s_nop 0
    v_permlane32_swap_b32 v49, v55
    s_nop 1
    v_max_u32_dpp v51, v54, v49 row_mirror row_mask:0xf bank_mask:0xf
    v_max_u32_dpp v50, v55, v48 row_mirror row_mask:0xf bank_mask:0xf
    s_nop 1
    v_max_u32_dpp v52, v50, v50 row_ror:8 row_mask:0xf bank_mask:0x3
    v_max_u32_dpp v53, v51, v51 row_ror:8 row_mask:0xf bank_mask:0x3
    v_min_u32_dpp v52, v50, v50 row_ror:8 row_mask:0xf bank_mask:0xc
    v_min_u32_dpp v53, v51, v51 row_ror:8 row_mask:0xf bank_mask:0xc
    s_nop 0
    v_max_u32_dpp v50, v52, v52 row_half_mirror row_mask:0xf bank_mask:0x5
    v_max_u32_dpp v51, v53, v53 row_half_mirror row_mask:0xf bank_mask:0x5
    v_min_u32_dpp v50, v52, v52 row_half_mirror row_mask:0xf bank_mask:0xa
    v_min_u32_dpp v51, v53, v53 row_half_mirror row_mask:0xf bank_mask:0xa
    v_max_u32 v48, v50, v51
    v_max_u32 v54, v50, v51
    v_min_u32 v49, v50, v51
    v_min_u32 v55, v50, v51
    v_permlane16_swap_b32 v48, v54
    s_nop 0
    v_permlane16_swap_b32 v49, v55
    s_nop 1
    v_max_u32_dpp v51, v54, v49 row_mirror row_mask:0xf bank_mask:0xf
    v_max_u32_dpp v50, v55, v48 row_mirror row_mask:0xf bank_mask:0xf
    s_nop 1
    v_max_u32_dpp v52, v50, v50 row_ror:8 row_mask:0xf bank_mask:0x3
    v_max_u32_dpp v53, v51, v51 row_ror:8 row_mask:0xf bank_mask:0x3
    v_min_u32_dpp v52, v50, v50 row_ror:8 row_mask:0xf bank_mask:0xc
    v_min_u32_dpp v53, v51, v51 row_ror:8 row_mask:0xf bank_mask:0xc
    s_nop 0
    v_max_u32_dpp v50, v52, v52 row_half_mirror row_mask:0xf bank_mask:0x5
    v_max_u32_dpp v51, v53, v53 row_half_mirror row_mask:0xf bank_mask:0x5
    v_min_u32_dpp v50, v52, v52 row_half_mirror row_mask:0xf bank_mask:0xa
    v_min_u32_dpp v51, v53, v53 row_half_mirror row_mask:0xf bank_mask:0xa
    v_min_u32 v49, v50, v51
    v_max_u32 v48, v50, v51
    s_nop 0
    v_mov_b32_dpp v55, v49 row_mirror row_mask:0xf bank_mask:0xf
    v_mov_b32_dpp v54, v48 row_mirror row_mask:0xf bank_mask:0xf
    s_nop 0
    v_max_u32_dpp v50, v55, v48 quad_perm:[1,0,3,2] row_mask:0xf bank_mask:0xf
    v_max_u32_dpp v51, v54, v49 quad_perm:[1,0,3,2] row_mask:0xf bank_mask:0xf
    s_nop 0
    v_max_u32_dpp v52, v50, v50 row_ror:8 row_mask:0xf bank_mask:0x3
    v_max_u32_dpp v53, v51, v51 row_ror:8 row_mask:0xf bank_mask:0x3
    v_min_u32_dpp v52, v50, v50 row_ror:8 row_mask:0xf bank_mask:0xc
    v_min_u32_dpp v53, v51, v51 row_ror:8 row_mask:0xf bank_mask:0xc
    s_nop 0
    v_max_u32_dpp v50, v52, v52 row_half_mirror row_mask:0xf bank_mask:0x5
    v_max_u32_dpp v51, v53, v53 row_half_mirror row_mask:0xf bank_mask:0x5
    v_min_u32_dpp v50, v52, v52 row_half_mirror row_mask:0xf bank_mask:0xa
    v_min_u32_dpp v51, v53, v53 row_half_mirror row_mask:0xf bank_mask:0xa
    v_min_u32 v49, v50, v51
    v_max_u32 v48, v50, v51
    s_nop 0
    v_mov_b32_dpp v55, v49 row_mirror row_mask:0xf bank_mask:0xf
    s_nop 1
    v_max_u32_dpp v59, v55, v48 quad_perm:[2,3,0,1] row_mask:0xf bank_mask:0xf
    s_cbranch_scc1 KS_QF2
    v_and_b32 v46, 0x7ff, v59
    v_mad_i32_i24 v46, v46, s96, v41
    s_mov_b32 m0, 17088
    s_nop 0
    buffer_load_dwordx4 v46, s[72:75], 0 offen offset:0 sc1 lds
    s_mov_b32 m0, 17984
    s_nop 0
    buffer_load_dwordx4 v46, s[72:75], 0 offen offset:128 sc1 lds
    s_mov_b32 m0, 18880
    s_nop 0
    buffer_load_dwordx4 v46, s[72:75], 0 offen offset:256 sc1 lds
    s_mov_b32 m0, 19776
    s_nop 0
    buffer_load_dwordx4 v46, s[72:75], 0 offen offset:384 sc1 lds
    s_mov_b32 m0, 20672
    s_nop 0
    buffer_load_dwordx4 v46, s[72:75], 0 offen offset:512 sc1 lds
    s_mov_b32 m0, 21568
    s_nop 0
    buffer_load_dwordx4 v46, s[72:75], 0 offen offset:640 sc1 lds
    s_mov_b32 m0, 22464
    s_nop 0
    buffer_load_dwordx4 v46, s[72:75], 0 offen offset:768 sc1 lds
    s_mov_b32 m0, 23360
    s_nop 0
    buffer_load_dwordx4 v46, s[72:75], 0 offen offset:896 sc1 lds
    s_mov_b32 m0, 24256
    s_nop 0
    buffer_load_dwordx4 v46, s[72:75], 0 offen offset:1024 sc1 lds
    v_sub_u32 v8, v8, v56
    v_min_u32_dpp v60, v59, v59 quad_perm:[2,3,0,1] row_mask:0xf bank_mask:0xf
    v_sub_u32 v9, v9, v56
    v_sub_u32 v10, v10, v56
    v_max3_u32 v47, v8, v9, v10
    v_sub_u32 v11, v11, v56
    v_sub_u32 v12, v12, v56
    v_min_u32_dpp v60, v60, v60 row_half_mirror row_mask:0xf bank_mask:0xf
    v_max3_u32 v47, v47, v11, v12
    v_sub_u32 v13, v13, v56
    v_sub_u32 v14, v14, v56
    v_max3_u32 v47, v47, v13, v14
    v_sub_u32 v15, v15, v56
    v_sub_u32 v16, v16, v56
    v_min_u32_dpp v60, v60, v60 row_ror:8 row_mask:0xf bank_mask:0xf
    v_max3_u32 v47, v47, v15, v16
    v_sub_u32 v17, v17, v56
    v_sub_u32 v18, v18, v56
    v_max3_u32 v47, v47, v17, v18
    v_sub_u32 v19, v19, v56
    v_sub_u32 v20, v20, v56
    v_max3_u32 v47, v47, v19, v20
    v_sub_u32 v21, v21, v56
    v_sub_u32 v22, v22, v56
    v_max3_u32 v47, v47, v21, v22
    v_sub_u32 v23, v23, v56
    v_sub_u32 v24, v24, v56
    v_max3_u32 v47, v47, v23, v24
    v_sub_u32 v25, v25, v56
    v_sub_u32 v26, v26, v56
    v_max3_u32 v47, v47, v25, v26
    v_sub_u32 v27, v27, v56
    v_sub_u32 v28, v28, v56
    v_max3_u32 v47, v47, v27, v28
    v_sub_u32 v29, v29, v56
    v_sub_u32 v30, v30, v56
    v_max3_u32 v47, v47, v29, v30
    v_sub_u32 v31, v31, v56
    v_sub_u32 v32, v32, v56
    v_max3_u32 v47, v47, v31, v32
    v_sub_u32 v33, v33, v56
    v_sub_u32 v34, v34, v56
    v_max3_u32 v47, v47, v33, v34
    v_sub_u32 v35, v35, v56
    v_sub_u32 v36, v36, v56
    v_max3_u32 v47, v47, v35, v36
    v_sub_u32 v37, v37, v56
    v_sub_u32 v38, v38, v56
    v_max3_u32 v47, v47, v37, v38
    v_sub_u32 v39, v39, v56
    v_add_u32 v57, v57, v56
    v_max_u32 v47, v47, v39
    v_add_u32 v47, v47, v57
    v_cmp_gt_u32 vcc, v47, v60
    s_cbranch_vccnz KS_QF1
    ds_write_b32 v7, v59 offset:768
    s_waitcnt vmcnt(0)
    ds_write_b32 v4, v5 offset:32
    s_setprio 0
    s_branch KS_B
KS_QF1:
    s_sub_u32 s39, s39, 1
    s_cbranch_scc1 KS_ABORT
    v_mov_b32 v58, v59
    v_max_u32 v42, v8, v9
    v_max_u32 v44, v10, v11
    v_min_u32 v43, v8, v9
    v_min_u32 v45, v10, v11
    v_med3_u32 v46, v42, v12, v13
    v_med3_u32 v47, v44, v14, v15
    v_max3_u32 v42, v42, v12, v13
    v_max3_u32 v44, v44, v14, v15
    v_max_u32 v43, v43, v46
    v_max_u32 v45, v45, v47
    v_med3_u32 v46, v42, v16, v17
    v_med3_u32 v47, v44, v18, v19
    v_max3_u32 v42, v42, v16, v17
    v_max3_u32 v44, v44, v18, v19
    v_max_u32 v43, v43, v46
    v_max_u32 v45, v45, v47
    v_med3_u32 v46, v42, v20, v21
    v_med3_u32 v47, v44, v22, v23
    v_max3_u32 v42, v42, v20, v21
    v_max3_u32 v44, v44, v22, v23
    v_max_u32 v43, v43, v46
    v_max_u32 v45, v45, v47
    v_med3_u32 v46, v42, v24, v25
    v_med3_u32 v47, v44, v26, v27
    v_max3_u32 v42, v42, v24, v25
    v_max3_u32 v44, v44, v26, v27
    v_max_u32 v43, v43, v46
    v_max_u32 v45, v45, v47
    v_med3_u32 v46, v42, v28, v29
    v_med3_u32 v47, v44, v30, v31
    v_max3_u32 v42, v42, v28, v29
    v_max3_u32 v44, v44, v30, v31
    v_max_u32 v43, v43, v46
    v_max_u32 v45, v45, v47
    v_med3_u32 v46, v42, v32, v33
    v_med3_u32 v47, v44, v34, v35
    v_max3_u32 v42, v42, v32, v33
    v_max3_u32 v44, v44, v34, v35
    v_max_u32 v43, v43, v46
    v_max_u32 v45, v45, v47
    v_max_u32 v43, v43, v45
    v_med3_u32 v46, v42, v36, v37
    v_med3_u32 v47, v44, v38, v39
    v_max3_u32 v42, v42, v36, v37
    v_max3_u32 v44, v44, v38, v39
    v_max3_u32 v43, v43, v46, v47
    v_max_u32 v48, v42, v44
    v_med3_u32 v56, v42, v44, v43
    v_add_u32 v48, v48, v57
    v_add_u32 v49, v56, v57
    s_mov_b32 s93, 1
    s_mov_b64 vcc, 0
    s_nop 2
    s_branch KS_QN
KS_QF2:
    v_mov_b32 v48, 0
    v_mov_b32 v49, 0
    s_mov_b64 exec, 0x5555
    v_max_u32 v48, v59, v58
    v_min_u32 v49, v59, v58
    s_mov_b64 exec, -1
    s_mov_b32 s93, 2
    s_mov_b64 vcc, 0
    s_waitcnt vmcnt(0)
    s_nop 5
    s_branch KS_QN
KS_W9:
    v_lshlrev_b32 v33, 4, v1
    s_movk_i32 s92, 0x2000
    s_mov_b32 s72, s36
    s_mov_b32 s73, s37
    s_mov_b32 s74, 0x240000
    s_mov_b32 s75, 0x20000
    s_add_u32 s64, s36, 0x600000
    s_addc_u32 s65, s37, 0
    s_mov_b32 s66, 0x240000
    s_mov_b32 s67, 0x20000
    s_mov_b32 s68, s4
    s_mov_b32 s69, s5
    s_mov_b32 s70, 0x240000
    s_mov_b32 s71, 0x20000
    v_bfe_u32 v43, v1, 3, 2
    s_lshl_b32 s93, s89, 2
    v_add_u32 v43, s93, v43
    v_bfe_u32 v40, v43, 4, 1
    v_and_b32 v41, 3, v1
    v_lshl_add_u32 v40, v40, 2, v41
    v_lshlrev_b32 v40, 2, v40
    v_and_b32 v41, 0x3cf, v43
    v_bfe_u32 v42, v43, 5, 1
    v_lshl_add_u32 v41, v42, 4, v41
    v_bfe_u32 v42, v1, 2, 1
    v_lshl_add_u32 v41, v42, 5, v41
W_89:
    s_sleep 1
    ds_read_b32 v12, v7 offset:768
    s_sub_u32 s39, s39, 1
    s_cbranch_scc1 KS_ABORT
    s_waitcnt lgkmcnt(0)
    v_cmp_eq_u32 vcc, 0, v12
    s_cbranch_vccnz W_89
    ds_read_b32 v19, v40 offset:768
    s_waitcnt lgkmcnt(0)
    v_and_b32 v14, 0x7ff, v19
    v_sub_u32 v14, 2047, v14
    v_mul_u32_u24 v23, 1152, v14
    v_lshl_add_u32 v23, v41, 1, v23
    buffer_load_ushort v17, v23, s[68:71], 0 offen
    v_lshrrev_b32 v15, 9, v14
    v_bfe_u32 v16, v14, 6, 2
    v_lshl_add_u32 v15, v15, 2, v16
    v_bfe_u32 v16, v14, 2, 2
    v_lshl_add_u32 v15, v15, 2, v16
    v_bfe_u32 v16, v14, 4, 1
    v_bfe_u32 v24, v14, 8, 1
    v_and_b32 v25, 3, v14
    v_lshl_add_u32 v24, v24, 2, v25
    v_lshlrev_b32 v24, 1, v24
    v_bfe_u32 v25, v14, 5, 1
    v_lshl_add_u32 v24, v25, 5, v24
    v_lshl_add_u32 v25, v15, 1, v16
    v_lshl_add_u32 v25, v25, 14, v24
    v_lshrrev_b32 v26, 1, v41
    v_lshl_add_u32 v25, v26, 6, v25
    v_xor_b32 v26, v41, v16
    v_not_b32 v26, v26
    v_and_b32 v26, 1, v26
    v_lshl_add_u32 v25, v26, 4, v25
    v_lshl_add_u32 v26, v15, 12, v24
    v_lshl_add_u32 v26, v16, 4, v26
    v_lshl_add_u32 v26, v41, 6, v26
    v_add_u32 v26, 2064384, v26
    v_lshl_add_u32 v27, v16, 6, v15
    v_lshlrev_b32 v27, 7, v27
    v_xor_b32 v25, v27, v25
    v_and_b32 v27, 0xf80, v27
    v_xor_b32 v26, v27, v26
    v_cmp_gt_u32 vcc, 0x200, v41
    s_nop 1
    v_cndmask_b32 v25, v26, v25, vcc
    buffer_load_ushort v18, v25, s[64:67], 0 offen sc1
    v_ashrrev_i32 v22, 31, v19
    v_not_b32 v22, v22
    v_or_b32 v22, 0x80000000, v22
    v_xor_b32 v22, v19, v22
    v_and_b32 v22, 0xffff0000, v22
    v_mul_f32 v22, 0xbfb8aa3b, v22
    v_exp_f32 v22, v22
    s_nop 0
    v_add_f32 v22, 1.0, v22
    v_rcp_f32 v22, v22
    s_nop 0
    v_cvt_pk_bf16_f32 v22, 0, v22
    v_and_b32 v14, 31, v1
    v_lshlrev_b32 v14, 4, v14
    s_barrier
    buffer_load_dword v8, v33, s[76:79], s92 offen offset:0 sc1
    buffer_load_dword v9, v33, s[76:79], s92 offen offset:1024 sc1
    buffer_load_dword v10, v33, s[76:79], s92 offen offset:2048 sc1
    buffer_load_dword v11, v33, s[76:79], s92 offen offset:3072 sc1
    s_barrier
    s_branch ZPE_91
ZP_90:
    s_sleep 4
    buffer_load_dword v8, v33, s[76:79], s92 offen offset:0 sc1
    buffer_load_dword v9, v33, s[76:79], s92 offen offset:1024 sc1
    buffer_load_dword v10, v33, s[76:79], s92 offen offset:2048 sc1
    buffer_load_dword v11, v33, s[76:79], s92 offen offset:3072 sc1
ZPE_91:
    s_sub_u32 s39, s39, 1
    s_cbranch_scc1 KS_ABORT
    s_waitcnt vmcnt(0)
    v_max3_u32 v44, v8, v9, v10
    v_max_u32 v44, v44, v11
    v_cmp_eq_u32 vcc, -1, v44
    s_cbranch_vccnz ZP_90
    ds_write_b32 v4, v5 offset:28
    buffer_load_ushort v20, v23, s[72:75], 0 offen sc1
    s_add_u32 s72, s36, 0xb10000
    s_addc_u32 s73, s37, 0
    s_mov_b32 s74, 0x40
    s_mov_b32 s75, 0x20000
    s_waitcnt vmcnt(0)
    v_lshlrev_b32 v17, 16, v17
    v_lshlrev_b32 v18, 16, v18
    v_add_f32 v17, v17, v18
    v_cvt_pk_bf16_f32 v17, v17, v17
    v_and_b32 v21, 0xffff0000, v17
    v_lshlrev_b32 v20, 16, v20
    s_cmp_lg_u32 s2, 0
    s_cbranch_scc1 KS_W9E
    buffer_store_dword v12, v7, s[72:75], 0 offen
KS_W9E:
    s_mov_b32 s68, s32
    s_mov_b32 s69, s33
    s_mov_b32 s70, 0x240000
    s_mov_b32 s71, 0x20000
    v_lshlrev_b32 v14, 2, v1
    v_add_u32 v14, 1536, v14
    s_mov_b32 exec_lo, -1
    s_mov_b32 exec_hi, 0
    s_setprio 3
    s_barrier
    ds_read2_b32 v[32:33], v14 offset0:0 offset1:32
    ds_read2_b32 v[34:35], v14 offset0:64 offset1:96
    ds_read2_b32 v[36:37], v14 offset0:128 offset1:160
    ds_read2_b32 v[38:39], v14 offset0:192 offset1:224
    ds_read_b32 v40, v14 offset:1024
    s_waitcnt lgkmcnt(3)
    v_pk_add_f32 v[32:33], v[32:33], v[34:35]
    s_waitcnt lgkmcnt(1)
    v_pk_add_f32 v[36:37], v[36:37], v[38:39]
    v_add_f32 v32, v32, v33
    s_waitcnt lgkmcnt(0)
    v_add_f32 v36, v36, v37
    v_add_f32 v32, v32, v40
    v_add_f32 v8, v32, v36
    v_cvt_pk_bf16_f32 v8, 0, v8
    v_mul_f32 v8, v8, v22
    v_cvt_pk_bf16_f32 v8, 0, v8
    v_add_f32 v8, v8, v20
    v_cvt_pk_bf16_f32 v8, 0, v8
    v_add_f32 v8, v8, v21
    v_cvt_pk_bf16_f32 v8, v8, v8
    buffer_store_short v8, v23, s[68:71], 0 offen
    s_endpgm
KS_B:
    s_add_u32 s64, s36, 0x850000
    s_addc_u32 s65, s37, 0
    s_mov_b32 s66, 0x148800
    s_mov_b32 s67, 0x20000
    v_bfe_u32 v16, v1, 2, 2
    v_lshl_add_u32 v16, v3, 3, v16
    v_mul_u32_u24 v16, 1152, v16
    v_and_b32 v17, 3, v1
    v_lshl_add_u32 v16, v17, 3, v16
    s_lshl_b32 s92, s38, 7
    s_add_u32 s92, s92, 109184
    v_add_u32 v16, s92, v16
    v_lshrrev_b32 v18, 2, v1
    v_mul_u32_u24 v18, 9344, v18
    v_lshl_add_u32 v18, v17, 4, v18
    s_mul_i32 s94, s38, 149504
    s_lshl_b32 s95, s89, 6
    s_add_u32 s94, s94, s95
    s_lshl_b32 s95, s38, 7
    v_lshl_add_u32 v19, v17, 5, s95
    v_lshl_add_u32 v19, v3, 3, v19
    s_movk_i32 s95, 0x3f80
    s_mov_b32 s96, 0x3f800000
    v_mov_b32 v28, 0
    v_mov_b32 v29, 0
W_92:
    ds_read_b32 v17, v4 offset:40
    s_sub_u32 s39, s39, 1
    s_cbranch_scc1 KS_ABORT
    s_waitcnt lgkmcnt(0)
    v_cmp_ne_u32 vcc, s84, v17
    s_cbranch_vccnz W_92
    ds_read_b64_tr_b16 v[48:49], v16 offset:0
    ds_read_b64_tr_b16 v[50:51], v16 offset:4608
    ds_read_b64_tr_b16 v[52:53], v16 offset:32
    ds_read_b64_tr_b16 v[54:55], v16 offset:4640
    ds_read_b64_tr_b16 v[56:57], v16 offset:64
    ds_read_b64_tr_b16 v[58:59], v16 offset:4672
    ds_read_b64_tr_b16 v[60:61], v16 offset:96
    ds_read_b64_tr_b16 v[62:63], v16 offset:4704
    v_and_b32 v16, 7, v2
    v_lshlrev_b32 v16, 6, v16
    v_lshl_add_u32 v16, v3, 4, v16
    s_mul_i32 s92, s89, 9344
    s_lshl_b32 s93, s38, 10
    s_add_u32 s92, s92, s93
    v_lshlrev_b32 v17, 4, v1
    s_waitcnt lgkmcnt(0)
    s_barrier
    s_barrier
    ds_read_b128 v[20:23], v16 offset:1024
    s_waitcnt lgkmcnt(0)
    v_mfma_f32_16x16x32_bf16 v[32:35], v[20:23], v[48:51], 0
    v_mfma_f32_16x16x32_bf16 v[40:43], v[20:23], v[56:59], 0
    v_mfma_f32_16x16x32_bf16 v[36:39], v[20:23], v[52:55], 0
    v_mfma_f32_16x16x32_bf16 v[44:47], v[20:23], v[60:63], 0
    s_mov_b32 exec_lo, -1
    s_mov_b32 exec_hi, 0
    s_nop 2
    v_cvt_pk_bf16_f32 v24, v32, v33
    v_cvt_pk_bf16_f32 v25, v34, v35
    v_cvt_pk_bf16_f32 v26, v40, v41
    v_cvt_pk_bf16_f32 v27, v42, v43
    s_mov_b32 exec_lo, 0
    s_mov_b32 exec_hi, -1
    v_cvt_pk_bf16_f32 v24, v36, v37
    v_cvt_pk_bf16_f32 v25, v38, v39
    v_cvt_pk_bf16_f32 v26, v44, v45
    v_cvt_pk_bf16_f32 v27, v46, v47
    s_mov_b64 exec, -1
    v_min_u32 v24, -2, v24
    v_min_u32 v25, -2, v25
    v_min_u32 v26, -2, v26
    v_min_u32 v27, -2, v27
    buffer_store_dwordx4 v[24:27], v17, s[64:67], s92 offen sc1
    s_sleep 13
    s_setprio 2
W_93:
    ds_read_b32 v30, v4 offset:28
    s_sub_u32 s39, s39, 1
    s_cbranch_scc1 KS_ABORT
    s_waitcnt lgkmcnt(0)
    v_cmp_eq_u32 vcc, 0, v30
    s_cbranch_vccnz W_93
    s_branch ZPE_95
ZP_94:
    s_sleep 1
ZPE_95:
    buffer_load_dwordx4 v[32:35], v18, s[64:67], s94 offen sc1
    s_sub_u32 s39, s39, 1
    s_cbranch_scc1 KS_ABORT
    s_waitcnt vmcnt(0)
    v_max3_u32 v44, v32, v33, v34
    v_max_u32 v44, v44, v35
    v_cmp_eq_u32 vcc, -1, v44
    s_cbranch_vccnz ZP_94
    v_permlane32_swap_b32 v32, v34
    v_permlane32_swap_b32 v33, v35
    s_nop 1
    v_permlane16_swap_b32 v32, v33
    v_permlane16_swap_b32 v34, v35
    v_dot2c_f32_bf16 v28, s95, v32
    v_dot2c_f32_bf16 v29, s96, v32
    v_dot2c_f32_bf16 v28, s95, v33
    v_dot2c_f32_bf16 v29, s96, v33
    v_dot2c_f32_bf16 v28, s95, v34
    v_dot2c_f32_bf16 v29, s96, v34
    v_dot2c_f32_bf16 v28, s95, v35
    v_dot2c_f32_bf16 v29, s96, v35
    s_nop 1
    v_add_f32_dpp v28, v28, v28 row_ror:8 row_mask:0xf bank_mask:0xf
    v_add_f32_dpp v29, v29, v29 row_ror:8 row_mask:0xf bank_mask:0xf
    s_nop 0
    v_add_f32_dpp v28, v28, v28 row_ror:4 row_mask:0xf bank_mask:0xf
    v_add_f32_dpp v29, v29, v29 row_ror:4 row_mask:0xf bank_mask:0xf
    s_mov_b32 exec_lo, 0x000f000f
    s_mov_b32 exec_hi, 0x000f000f
    ds_write_b64 v19, v[28:29] offset:1536
    s_waitcnt lgkmcnt(0)
    s_barrier
    s_endpgm
KS_G0:
    ds_write_b8 v15, v5 offset:68
    s_setprio 0
KS_G:
    s_mov_b32 s98, 0x05040100
    s_mov_b32 s99, 0x07060302
    s_waitcnt vmcnt(0)
    s_sub_u32 s87, s38, 12
    s_mul_i32 s92, s87, 9
    s_add_u32 s92, s92, 1
    s_lshr_b32 s86, s92, 1
    s_lshl_b32 s92, s86, 5
    v_lshl_add_u32 v7, v3, 3, s92
    v_mul_u32_u24 v7, 9216, v7
    v_and_b32 v6, 7, v2
    v_lshl_add_u32 v7, v6, 3, v7
    s_lshl_b32 s92, s89, 6
    v_add_u32 v7, s92, v7
    v_cmp_gt_u32 vcc, 8, v2
    s_mov_b32 s76, 9216
    s_mov_b32 s77, 0
    s_mov_b32 s78, 230400
    s_mov_b32 s79, 0
    v_mov_b32 v46, s26
    v_mov_b32 v47, s27
    v_mov_b32 v6, s28
    v_cndmask_b32 v46, v6, v46, vcc
    v_mov_b32 v6, s29
    v_cndmask_b32 v47, v6, v47, vcc
    v_add_co_u32 v46, vcc, v46, v7
    s_nop 1
    v_addc_co_u32 v47, vcc, 0, v47, vcc
    s_mov_b32 s68, s30
    s_mov_b32 s69, s31
    s_mov_b32 s70, 0x510000
    s_mov_b32 s71, 0x20000
    v_lshlrev_b32 v8, 4, v1
    s_mul_i32 s92, s89, 36864
    s_mul_i32 s93, s87, 9216
    s_add_u32 s92, s92, s93
    s_add_u32 s93, s93, 109184
    s_cmp_lt_u32 s41, 8
    s_cselect_b32 s94, 0, 100
    v_mov_b32 v9, s94
W_96:
    s_sleep 2
    ds_read_b32 v10, v9 offset:100
    s_sub_u32 s39, s39, 1
    s_cbranch_scc1 KS_ABORT
    s_waitcnt lgkmcnt(0)
    v_cmp_ne_u32 vcc, s84, v10
    s_cbranch_vccnz W_96
    s_cmp_ge_u32 s41, 8
    s_cbranch_scc1 KS_GD1
    s_add_u32 m0, s93, 0
    s_nop 0
    buffer_load_dwordx4 v8, s[68:71], s92 offen offset:0 nt lds
    buffer_load_dwordx4 v8, s[68:71], s92 offen offset:1024 nt lds
    buffer_load_dwordx4 v8, s[68:71], s92 offen offset:2048 nt lds
    buffer_load_dwordx4 v8, s[68:71], s92 offen offset:3072 nt lds
    s_add_u32 m0, s93, 4096
    s_add_u32 s92, s92, 4096
    buffer_load_dwordx4 v8, s[68:71], s92 offen offset:0 nt lds
    buffer_load_dwordx4 v8, s[68:71], s92 offen offset:1024 nt lds
    buffer_load_dwordx4 v8, s[68:71], s92 offen offset:2048 nt lds
    buffer_load_dwordx4 v8, s[68:71], s92 offen offset:3072 nt lds
    s_add_u32 m0, s93, 8192
    s_add_u32 s92, s92, 4096
    buffer_load_dwordx4 v8, s[68:71], s92 offen offset:0 nt lds
KS_GD1:
    s_lshr_b32 s92, 12, s87
    s_bitcmp1_b32 s92, 0
    s_cbranch_scc0 GT_97
W_98:
    s_sleep 2
    ds_read_b32 v10, v4 offset:52
    s_sub_u32 s39, s39, 1
    s_cbranch_scc1 KS_ABORT
    s_waitcnt lgkmcnt(0)
    v_cmp_ne_u32 vcc, s84, v10
    s_cbranch_vccnz W_98
    s_setprio 1
GT_97:
    s_lshr_b32 s92, 3, s87
    s_bitcmp1_b32 s92, 0
    s_cbranch_scc0 KS_GN0
    global_load_dwordx2 v[48:49], v[46:47], off nt
    v_lshl_add_u64 v[46:47], v[46:47], 0, s[76:77]
    global_load_dwordx2 v[50:51], v[46:47], off nt
    v_lshl_add_u64 v[46:47], v[46:47], 0, s[76:77]
    global_load_dwordx2 v[52:53], v[46:47], off nt
    v_lshl_add_u64 v[46:47], v[46:47], 0, s[76:77]
    global_load_dwordx2 v[54:55], v[46:47], off nt
    v_lshl_add_u64 v[46:47], v[46:47], 0, s[76:77]
    global_load_dwordx2 v[56:57], v[46:47], off nt
    v_lshl_add_u64 v[46:47], v[46:47], 0, s[76:77]
    global_load_dwordx2 v[58:59], v[46:47], off nt
    v_lshl_add_u64 v[46:47], v[46:47], 0, s[76:77]
    global_load_dwordx2 v[60:61], v[46:47], off nt
    v_lshl_add_u64 v[46:47], v[46:47], 0, s[76:77]
    global_load_dwordx2 v[62:63], v[46:47], off nt
    v_lshl_add_u64 v[46:47], v[46:47], 0, s[78:79]
    global_load_dwordx2 v[64:65], v[46:47], off nt
    v_lshl_add_u64 v[46:47], v[46:47], 0, s[76:77]
    global_load_dwordx2 v[66:67], v[46:47], off nt
    v_lshl_add_u64 v[46:47], v[46:47], 0, s[76:77]
    global_load_dwordx2 v[68:69], v[46:47], off nt
    v_lshl_add_u64 v[46:47], v[46:47], 0, s[76:77]
    global_load_dwordx2 v[70:71], v[46:47], off nt
    v_lshl_add_u64 v[46:47], v[46:47], 0, s[76:77]
    global_load_dwordx2 v[72:73], v[46:47], off nt
    v_lshl_add_u64 v[46:47], v[46:47], 0, s[76:77]
    global_load_dwordx2 v[74:75], v[46:47], off nt
    v_lshl_add_u64 v[46:47], v[46:47], 0, s[76:77]
    global_load_dwordx2 v[76:77], v[46:47], off nt
    v_lshl_add_u64 v[46:47], v[46:47], 0, s[76:77]
    global_load_dwordx2 v[78:79], v[46:47], off nt
    v_lshl_add_u64 v[46:47], v[46:47], 0, s[78:79]
    global_load_dwordx2 v[80:81], v[46:47], off nt
    v_lshl_add_u64 v[46:47], v[46:47], 0, s[76:77]
    global_load_dwordx2 v[82:83], v[46:47], off nt
    v_lshl_add_u64 v[46:47], v[46:47], 0, s[76:77]
    global_load_dwordx2 v[84:85], v[46:47], off nt
    v_lshl_add_u64 v[46:47], v[46:47], 0, s[76:77]
    global_load_dwordx2 v[86:87], v[46:47], off nt
    v_lshl_add_u64 v[46:47], v[46:47], 0, s[76:77]
    global_load_dwordx2 v[88:89], v[46:47], off nt
    v_lshl_add_u64 v[46:47], v[46:47], 0, s[76:77]
    global_load_dwordx2 v[90:91], v[46:47], off nt
    v_lshl_add_u64 v[46:47], v[46:47], 0, s[76:77]
    global_load_dwordx2 v[92:93], v[46:47], off nt
    v_lshl_add_u64 v[46:47], v[46:47], 0, s[76:77]
    global_load_dwordx2 v[94:95], v[46:47], off nt
    v_lshl_add_u64 v[46:47], v[46:47], 0, s[78:79]
    global_load_dwordx2 v[96:97], v[46:47], off nt
    v_lshl_add_u64 v[46:47], v[46:47], 0, s[76:77]
    global_load_dwordx2 v[98:99], v[46:47], off nt
    v_lshl_add_u64 v[46:47], v[46:47], 0, s[76:77]
    global_load_dwordx2 v[100:101], v[46:47], off nt
    v_lshl_add_u64 v[46:47], v[46:47], 0, s[76:77]
    global_load_dwordx2 v[102:103], v[46:47], off nt
    v_lshl_add_u64 v[46:47], v[46:47], 0, s[76:77]
    global_load_dwordx2 v[104:105], v[46:47], off nt
    v_lshl_add_u64 v[46:47], v[46:47], 0, s[76:77]
    global_load_dwordx2 v[106:107], v[46:47], off nt
    v_lshl_add_u64 v[46:47], v[46:47], 0, s[76:77]
    global_load_dwordx2 v[108:109], v[46:47], off nt
    v_lshl_add_u64 v[46:47], v[46:47], 0, s[76:77]
    global_load_dwordx2 v[110:111], v[46:47], off nt
    v_lshl_add_u64 v[46:47], v[46:47], 0, s[78:79]
    s_bitcmp1_b32 s87, 0
    s_cbranch_scc1 KS_G4
    global_load_dwordx2 v[112:113], v[46:47], off nt
    v_lshl_add_u64 v[46:47], v[46:47], 0, s[76:77]
    global_load_dwordx2 v[114:115], v[46:47], off nt
    v_lshl_add_u64 v[46:47], v[46:47], 0, s[76:77]
    global_load_dwordx2 v[116:117], v[46:47], off nt
    v_lshl_add_u64 v[46:47], v[46:47], 0, s[76:77]
    global_load_dwordx2 v[118:119], v[46:47], off nt
    v_lshl_add_u64 v[46:47], v[46:47], 0, s[76:77]
    global_load_dwordx2 v[120:121], v[46:47], off nt
    v_lshl_add_u64 v[46:47], v[46:47], 0, s[76:77]
    global_load_dwordx2 v[122:123], v[46:47], off nt
    v_lshl_add_u64 v[46:47], v[46:47], 0, s[76:77]
    global_load_dwordx2 v[124:125], v[46:47], off nt
    v_lshl_add_u64 v[46:47], v[46:47], 0, s[76:77]
    global_load_dwordx2 v[126:127], v[46:47], off nt
    s_branch KS_G4
KS_GN0:
    global_load_dwordx2 v[48:49], v[46:47], off
    v_lshl_add_u64 v[46:47], v[46:47], 0, s[76:77]
    global_load_dwordx2 v[50:51], v[46:47], off
    v_lshl_add_u64 v[46:47], v[46:47], 0, s[76:77]
    global_load_dwordx2 v[52:53], v[46:47], off
    v_lshl_add_u64 v[46:47], v[46:47], 0, s[76:77]
    global_load_dwordx2 v[54:55], v[46:47], off
    v_lshl_add_u64 v[46:47], v[46:47], 0, s[76:77]
    global_load_dwordx2 v[56:57], v[46:47], off
    v_lshl_add_u64 v[46:47], v[46:47], 0, s[76:77]
    global_load_dwordx2 v[58:59], v[46:47], off
    v_lshl_add_u64 v[46:47], v[46:47], 0, s[76:77]
    global_load_dwordx2 v[60:61], v[46:47], off
    v_lshl_add_u64 v[46:47], v[46:47], 0, s[76:77]
    global_load_dwordx2 v[62:63], v[46:47], off
    v_lshl_add_u64 v[46:47], v[46:47], 0, s[78:79]
    global_load_dwordx2 v[64:65], v[46:47], off
    v_lshl_add_u64 v[46:47], v[46:47], 0, s[76:77]
    global_load_dwordx2 v[66:67], v[46:47], off
    v_lshl_add_u64 v[46:47], v[46:47], 0, s[76:77]
    global_load_dwordx2 v[68:69], v[46:47], off
    v_lshl_add_u64 v[46:47], v[46:47], 0, s[76:77]
    global_load_dwordx2 v[70:71], v[46:47], off
    v_lshl_add_u64 v[46:47], v[46:47], 0, s[76:77]
    global_load_dwordx2 v[72:73], v[46:47], off
    v_lshl_add_u64 v[46:47], v[46:47], 0, s[76:77]
    global_load_dwordx2 v[74:75], v[46:47], off
    v_lshl_add_u64 v[46:47], v[46:47], 0, s[76:77]
    global_load_dwordx2 v[76:77], v[46:47], off
    v_lshl_add_u64 v[46:47], v[46:47], 0, s[76:77]
    global_load_dwordx2 v[78:79], v[46:47], off
    v_lshl_add_u64 v[46:47], v[46:47], 0, s[78:79]
    global_load_dwordx2 v[80:81], v[46:47], off
    v_lshl_add_u64 v[46:47], v[46:47], 0, s[76:77]
    global_load_dwordx2 v[82:83], v[46:47], off
    v_lshl_add_u64 v[46:47], v[46:47], 0, s[76:77]
    global_load_dwordx2 v[84:85], v[46:47], off
    v_lshl_add_u64 v[46:47], v[46:47], 0, s[76:77]
    global_load_dwordx2 v[86:87], v[46:47], off
    v_lshl_add_u64 v[46:47], v[46:47], 0, s[76:77]
    global_load_dwordx2 v[88:89], v[46:47], off
    v_lshl_add_u64 v[46:47], v[46:47], 0, s[76:77]
    global_load_dwordx2 v[90:91], v[46:47], off
    v_lshl_add_u64 v[46:47], v[46:47], 0, s[76:77]
    global_load_dwordx2 v[92:93], v[46:47], off
    v_lshl_add_u64 v[46:47], v[46:47], 0, s[76:77]
    global_load_dwordx2 v[94:95], v[46:47], off
    v_lshl_add_u64 v[46:47], v[46:47], 0, s[78:79]
    global_load_dwordx2 v[96:97], v[46:47], off
    v_lshl_add_u64 v[46:47], v[46:47], 0, s[76:77]
    global_load_dwordx2 v[98:99], v[46:47], off
    v_lshl_add_u64 v[46:47], v[46:47], 0, s[76:77]
    global_load_dwordx2 v[100:101], v[46:47], off
    v_lshl_add_u64 v[46:47], v[46:47], 0, s[76:77]
    global_load_dwordx2 v[102:103], v[46:47], off
    v_lshl_add_u64 v[46:47], v[46:47], 0, s[76:77]
    global_load_dwordx2 v[104:105], v[46:47], off
    v_lshl_add_u64 v[46:47], v[46:47], 0, s[76:77]
    global_load_dwordx2 v[106:107], v[46:47], off
    v_lshl_add_u64 v[46:47], v[46:47], 0, s[76:77]
    global_load_dwordx2 v[108:109], v[46:47], off
    v_lshl_add_u64 v[46:47], v[46:47], 0, s[76:77]
    global_load_dwordx2 v[110:111], v[46:47], off
    v_lshl_add_u64 v[46:47], v[46:47], 0, s[78:79]
    s_bitcmp1_b32 s87, 0
    s_cbranch_scc1 KS_G4
    global_load_dwordx2 v[112:113], v[46:47], off
    v_lshl_add_u64 v[46:47], v[46:47], 0, s[76:77]
    global_load_dwordx2 v[114:115], v[46:47], off
    v_lshl_add_u64 v[46:47], v[46:47], 0, s[76:77]
    global_load_dwordx2 v[116:117], v[46:47], off
    v_lshl_add_u64 v[46:47], v[46:47], 0, s[76:77]
    global_load_dwordx2 v[118:119], v[46:47], off
    v_lshl_add_u64 v[46:47], v[46:47], 0, s[76:77]
    global_load_dwordx2 v[120:121], v[46:47], off
    v_lshl_add_u64 v[46:47], v[46:47], 0, s[76:77]
    global_load_dwordx2 v[122:123], v[46:47], off
    v_lshl_add_u64 v[46:47], v[46:47], 0, s[76:77]
    global_load_dwordx2 v[124:125], v[46:47], off
    v_lshl_add_u64 v[46:47], v[46:47], 0, s[76:77]
    global_load_dwordx2 v[126:127], v[46:47], off
KS_G4:
    v_mov_b32 v6, s87
    ds_write_b8 v6, v5 offset:192
    s_waitcnt vmcnt(0)
    ds_write_b8 v6, v5 offset:40
    v_perm_b32 v32, v50, v48, s98
    v_perm_b32 v33, v54, v52, s98
    v_perm_b32 v34, v58, v56, s98
    v_perm_b32 v35, v62, v60, s98
    v_perm_b32 v36, v50, v48, s99
    v_perm_b32 v37, v54, v52, s99
    v_perm_b32 v38, v58, v56, s99
    v_perm_b32 v39, v62, v60, s99
    v_perm_b32 v40, v51, v49, s98
    v_perm_b32 v41, v55, v53, s98
    v_perm_b32 v42, v59, v57, s98
    v_perm_b32 v43, v63, v61, s98
    v_perm_b32 v44, v51, v49, s99
    v_perm_b32 v45, v55, v53, s99
    v_perm_b32 v46, v59, v57, s99
    v_perm_b32 v47, v63, v61, s99
    v_perm_b32 v48, v66, v64, s98
    v_perm_b32 v49, v70, v68, s98
    v_perm_b32 v50, v74, v72, s98
    v_perm_b32 v51, v78, v76, s98
    v_perm_b32 v52, v66, v64, s99
    v_perm_b32 v53, v70, v68, s99
    v_perm_b32 v54, v74, v72, s99
    v_perm_b32 v55, v78, v76, s99
    v_perm_b32 v56, v67, v65, s98
    v_perm_b32 v57, v71, v69, s98
    v_perm_b32 v58, v75, v73, s98
    v_perm_b32 v59, v79, v77, s98
    v_perm_b32 v60, v67, v65, s99
    v_perm_b32 v61, v71, v69, s99
    v_perm_b32 v62, v75, v73, s99
    v_perm_b32 v63, v79, v77, s99
    v_perm_b32 v64, v82, v80, s98
    v_perm_b32 v65, v86, v84, s98
    v_perm_b32 v66, v90, v88, s98
    v_perm_b32 v67, v94, v92, s98
    v_perm_b32 v68, v82, v80, s99
    v_perm_b32 v69, v86, v84, s99
    v_perm_b32 v70, v90, v88, s99
    v_perm_b32 v71, v94, v92, s99
    v_perm_b32 v72, v83, v81, s98
    v_perm_b32 v73, v87, v85, s98
    v_perm_b32 v74, v91, v89, s98
    v_perm_b32 v75, v95, v93, s98
    v_perm_b32 v76, v83, v81, s99
    v_perm_b32 v77, v87, v85, s99
    v_perm_b32 v78, v91, v89, s99
    v_perm_b32 v79, v95, v93, s99
    v_perm_b32 v80, v98, v96, s98
    v_perm_b32 v81, v102, v100, s98
    v_perm_b32 v82, v106, v104, s98
    v_perm_b32 v83, v110, v108, s98
    v_perm_b32 v84, v98, v96, s99
    v_perm_b32 v85, v102, v100, s99
    v_perm_b32 v86, v106, v104, s99
    v_perm_b32 v87, v110, v108, s99
    v_perm_b32 v88, v99, v97, s98
    v_perm_b32 v89, v103, v101, s98
    v_perm_b32 v90, v107, v105, s98
    v_perm_b32 v91, v111, v109, s98
    v_perm_b32 v92, v99, v97, s99
    v_perm_b32 v93, v103, v101, s99
    v_perm_b32 v94, v107, v105, s99
    v_perm_b32 v95, v111, v109, s99
    v_perm_b32 v96, v114, v112, s98
    v_perm_b32 v97, v118, v116, s98
    v_perm_b32 v98, v122, v120, s98
    v_perm_b32 v99, v126, v124, s98
    v_perm_b32 v100, v114, v112, s99
    v_perm_b32 v101, v118, v116, s99
    v_perm_b32 v102, v122, v120, s99
    v_perm_b32 v103, v126, v124, s99
    v_perm_b32 v104, v115, v113, s98
    v_perm_b32 v105, v119, v117, s98
    v_perm_b32 v106, v123, v121, s98
    v_perm_b32 v107, v127, v125, s98
    v_perm_b32 v108, v115, v113, s99
    v_perm_b32 v109, v119, v117, s99
    v_perm_b32 v110, v123, v121, s99
    v_perm_b32 v111, v127, v125, s99
    s_mov_b32 s72, s36
    s_mov_b32 s73, s37
    s_mov_b32 s74, 0x240000
    s_mov_b32 s75, 0x20000
    s_lshl_b32 s92, s86, 6
    s_add_u32 s92, s92, 2358144
    v_and_b32 v6, 7, v2
    v_lshlrev_b32 v6, 2, v6
    v_lshl_add_u32 v7, v3, 4, s92
    s_movk_i32 s93, -1152
    s_and_b32 s94, s87, 1
    s_lshl_b32 s94, s94, 6
    s_sub_u32 s94, 256, s94
    s_lshl_b32 s92, s87, 6
    v_add_u32 v11, s92, v1
    v_lshrrev_b32 v8, 5, v11
    v_and_b32 v9, 31, v11
    v_and_b32 v10, 3, v9
    v_lshlrev_b32 v10, 9, v10
    v_lshrrev_b32 v9, 2, v9
    v_lshl_add_u32 v10, v9, 4, v10
    v_lshrrev_b32 v9, 2, v8
    v_lshl_add_u32 v10, v9, 8, v10
    v_and_b32 v9, 3, v8
    v_lshl_add_u32 v10, v9, 2, v10
    v_lshlrev_b32 v11, 1, v11
    s_lshl_b32 s92, s87, 11
    v_lshl_add_u32 v9, v1, 4, s92
    s_lshl_b32 s92, s86, 9
    s_add_u32 s92, s92, 17088
    v_lshl_add_u32 v28, v6, 3, s92
    v_lshrrev_b32 v31, 1, v3
    v_lshl_add_u32 v28, v31, 8, v28
    v_and_b32 v31, 1, v3
    v_lshl_add_u32 v28, v31, 4, v28
    s_lshl_b32 s92, s94, 3
    v_add_u32 v31, s92, v28
    v_lshlrev_b32 v0, 2, v3
    ds_read_b32 v0, v0 offset:224
W_99:
    s_sleep 2
    ds_read_b32 v12, v6 offset:768
    s_sub_u32 s39, s39, 1
    s_cbranch_scc1 KS_ABORT
    s_waitcnt lgkmcnt(0)
    v_cmp_eq_u32 vcc, 0, v12
    s_cbranch_vccnz W_99
    s_setprio 2
    v_and_b32 v12, 0x7ff, v12
    v_mad_i32_i24 v7, v12, s93, v7
    v_lshrrev_b32 v2, 3, v0
    v_lshrrev_b32 v5, 6, v0
    v_lshrrev_b32 v6, 9, v0
W_100:
    ds_read_b32 v12, v4 offset:32
    s_sub_u32 s39, s39, 1
    s_cbranch_scc1 KS_ABORT
    s_waitcnt lgkmcnt(0)
    v_cmp_eq_u32 vcc, 0, v12
    s_cbranch_vccnz W_100
    ds_read_b128 v[12:15], v28 offset:0
    ds_read_b128 v[16:19], v28 offset:512
    ds_read_b128 v[20:23], v28 offset:1024
    ds_read_b128 v[24:27], v28 offset:1536
    ds_read_b128 v[28:31], v31
    s_waitcnt lgkmcnt(4)
    v_mfma_f32_16x16x32_bf16 v[112:115], v[12:15], v[32:35], 0
    v_xor_b32 v4, v0, v12
    v_bitop3_b32 v4, v4, v2, v13 bitop3:0xf6
    v_mfma_f32_16x16x32_bf16 v[116:119], v[12:15], v[36:39], 0
    v_bitop3_b32 v4, v4, v5, v14 bitop3:0xf6
    v_bitop3_b32 v4, v4, v6, v15 bitop3:0xf6
    v_mfma_f32_16x16x32_bf16 v[120:123], v[12:15], v[40:43], 0
    v_and_b32 v8, 0x70007, v4
    v_mfma_f32_16x16x32_bf16 v[124:127], v[12:15], v[44:47], 0
    s_waitcnt lgkmcnt(3)
    v_mfma_f32_16x16x32_bf16 v[112:115], v[16:19], v[48:51], v[112:115]
    v_xor_b32 v4, v0, v16
    v_bitop3_b32 v4, v4, v2, v17 bitop3:0xf6
    v_mfma_f32_16x16x32_bf16 v[116:119], v[16:19], v[52:55], v[116:119]
    v_bitop3_b32 v4, v4, v5, v18 bitop3:0xf6
    v_bitop3_b32 v4, v4, v6, v19 bitop3:0xf6
    v_mfma_f32_16x16x32_bf16 v[120:123], v[16:19], v[56:59], v[120:123]
    v_and_b32 v4, 0x70007, v4
    v_min_u32 v8, v8, v4
    v_mfma_f32_16x16x32_bf16 v[124:127], v[16:19], v[60:63], v[124:127]
    s_waitcnt lgkmcnt(2)
    v_mfma_f32_16x16x32_bf16 v[112:115], v[20:23], v[64:67], v[112:115]
    v_xor_b32 v4, v0, v20
    v_bitop3_b32 v4, v4, v2, v21 bitop3:0xf6
    v_mfma_f32_16x16x32_bf16 v[116:119], v[20:23], v[68:71], v[116:119]
    v_bitop3_b32 v4, v4, v5, v22 bitop3:0xf6
    v_bitop3_b32 v4, v4, v6, v23 bitop3:0xf6
    v_mfma_f32_16x16x32_bf16 v[120:123], v[20:23], v[72:75], v[120:123]
    v_and_b32 v4, 0x70007, v4
    v_min_u32 v8, v8, v4
    v_mfma_f32_16x16x32_bf16 v[124:127], v[20:23], v[76:79], v[124:127]
    s_waitcnt lgkmcnt(1)
    v_mfma_f32_16x16x32_bf16 v[112:115], v[24:27], v[80:83], v[112:115]
    v_xor_b32 v4, v0, v24
    v_bitop3_b32 v4, v4, v2, v25 bitop3:0xf6
    v_mfma_f32_16x16x32_bf16 v[116:119], v[24:27], v[84:87], v[116:119]
    v_bitop3_b32 v4, v4, v5, v26 bitop3:0xf6
    v_bitop3_b32 v4, v4, v6, v27 bitop3:0xf6
    v_mfma_f32_16x16x32_bf16 v[120:123], v[24:27], v[88:91], v[120:123]
    v_and_b32 v4, 0x70007, v4
    v_min_u32 v8, v8, v4
    v_mfma_f32_16x16x32_bf16 v[124:127], v[24:27], v[92:95], v[124:127]
    s_waitcnt lgkmcnt(0)
    v_xor_b32 v4, v0, v28
    v_bitop3_b32 v4, v4, v2, v29 bitop3:0xf6
    v_bitop3_b32 v4, v4, v5, v30 bitop3:0xf6
    v_bitop3_b32 v4, v4, v6, v31 bitop3:0xf6
    v_and_b32 v4, 0x70007, v4
    v_min_u32 v8, v8, v4
    v_cmp_eq_u32 vcc, 0, v8
    s_cbranch_vccnz KS_GR
    s_bitcmp1_b32 s87, 0
    s_cbranch_scc1 KS_G5
    v_mfma_f32_16x16x32_bf16 v[112:115], v[28:31], v[96:99], v[112:115]
    v_mfma_f32_16x16x32_bf16 v[116:119], v[28:31], v[100:103], v[116:119]
    v_mfma_f32_16x16x32_bf16 v[120:123], v[28:31], v[104:107], v[120:123]
    v_mfma_f32_16x16x32_bf16 v[124:127], v[28:31], v[108:111], v[124:127]
    s_branch KS_G5
KS_GR:
    s_add_u32 s76, s36, 0x840000
    s_addc_u32 s77, s37, 0
    s_mov_b32 s78, 0x3000
    s_mov_b32 s79, 0x20000
    v_lshlrev_b32 v4, 4, v1
    s_movk_i32 s92, 0x2000
    s_nop 3
KS_GR2:
    s_sleep 2
    buffer_load_dword v12, v4, s[76:79], s92 offen offset:0 sc1
    buffer_load_dword v13, v4, s[76:79], s92 offen offset:1024 sc1
    buffer_load_dword v14, v4, s[76:79], s92 offen offset:2048 sc1
    buffer_load_dword v15, v4, s[76:79], s92 offen offset:3072 sc1
    s_sub_u32 s39, s39, 1
    s_cbranch_scc1 KS_ABORT
    s_waitcnt vmcnt(0)
    v_max3_u32 v12, v12, v13, v14
    v_max_u32 v12, v12, v15
    v_cmp_eq_u32 vcc, -1, v12
    s_cbranch_vccnz KS_GR2
    buffer_load_dwordx4 v[12:15], v7, s[72:75], 0 offen offset:0 sc1
    buffer_load_dwordx4 v[16:19], v7, s[72:75], 0 offen offset:64 sc1
    buffer_load_dwordx4 v[20:23], v7, s[72:75], 0 offen offset:128 sc1
    buffer_load_dwordx4 v[24:27], v7, s[72:75], 0 offen offset:192 sc1
    buffer_load_dwordx4 v[28:31], v7, s[72:75], s94 offen sc1
    s_sub_u32 s39, s39, 1
    s_cbranch_scc1 KS_ABORT
    s_waitcnt vmcnt(4)
    v_mfma_f32_16x16x32_bf16 v[112:115], v[12:15], v[32:35], 0
    v_mfma_f32_16x16x32_bf16 v[116:119], v[12:15], v[36:39], 0
    v_mfma_f32_16x16x32_bf16 v[120:123], v[12:15], v[40:43], 0
    v_mfma_f32_16x16x32_bf16 v[124:127], v[12:15], v[44:47], 0
    s_waitcnt vmcnt(3)
    v_mfma_f32_16x16x32_bf16 v[112:115], v[16:19], v[48:51], v[112:115]
    v_mfma_f32_16x16x32_bf16 v[116:119], v[16:19], v[52:55], v[116:119]
    v_mfma_f32_16x16x32_bf16 v[120:123], v[16:19], v[56:59], v[120:123]
    v_mfma_f32_16x16x32_bf16 v[124:127], v[16:19], v[60:63], v[124:127]
    s_waitcnt vmcnt(2)
    v_mfma_f32_16x16x32_bf16 v[112:115], v[20:23], v[64:67], v[112:115]
    v_mfma_f32_16x16x32_bf16 v[116:119], v[20:23], v[68:71], v[116:119]
    v_mfma_f32_16x16x32_bf16 v[120:123], v[20:23], v[72:75], v[120:123]
    v_mfma_f32_16x16x32_bf16 v[124:127], v[20:23], v[76:79], v[124:127]
    s_waitcnt vmcnt(1)
    v_mfma_f32_16x16x32_bf16 v[112:115], v[24:27], v[80:83], v[112:115]
    v_mfma_f32_16x16x32_bf16 v[116:119], v[24:27], v[84:87], v[116:119]
    v_mfma_f32_16x16x32_bf16 v[120:123], v[24:27], v[88:91], v[120:123]
    v_mfma_f32_16x16x32_bf16 v[124:127], v[24:27], v[92:95], v[124:127]
    s_waitcnt vmcnt(0)
    s_bitcmp1_b32 s87, 0
    s_cbranch_scc1 KS_G5
    v_mfma_f32_16x16x32_bf16 v[112:115], v[28:31], v[96:99], v[112:115]
    v_mfma_f32_16x16x32_bf16 v[116:119], v[28:31], v[100:103], v[116:119]
    v_mfma_f32_16x16x32_bf16 v[120:123], v[28:31], v[104:107], v[120:123]
    v_mfma_f32_16x16x32_bf16 v[124:127], v[28:31], v[108:111], v[124:127]
KS_G5:
    s_mov_b32 exec_lo, -1
    s_mov_b32 exec_hi, 0
    s_nop 5
    ds_write_b128 v9, v[112:115] offset:26368
    ds_write_b128 v9, v[116:119] offset:26880
    ds_write_b128 v9, v[120:123] offset:27392
    ds_write_b128 v9, v[124:127] offset:27904
    s_mov_b64 exec, -1
    s_waitcnt lgkmcnt(0)
    s_barrier
    ds_read_b32 v32, v10 offset:26368
    ds_read_b32 v33, v10 offset:26496
    ds_read_b32 v34, v10 offset:28416
    ds_read_b32 v35, v10 offset:28544
    ds_read_b32 v36, v10 offset:30464
    ds_read_b32 v37, v10 offset:30592
    ds_read_b32 v38, v10 offset:32512
    ds_read_b32 v39, v10 offset:32640
    s_waitcnt lgkmcnt(4)
    v_pk_add_f32 v[32:33], v[32:33], v[34:35]
    s_waitcnt lgkmcnt(0)
    v_pk_add_f32 v[36:37], v[36:37], v[38:39]
    v_pk_add_f32 v[32:33], v[32:33], v[36:37]
    v_cvt_pk_bf16_f32 v32, 0, v32
    v_cvt_pk_bf16_f32 v33, 0, v33
    v_mul_f32 v34, 0xbfb8aa3b, v32
    v_exp_f32 v34, v34
    s_nop 0
    v_add_f32 v34, 1.0, v34
    v_rcp_f32 v34, v34
    s_nop 0
    v_mul_f32 v34, v32, v34
    v_cvt_pk_bf16_f32 v34, 0, v34
    v_mul_f32 v34, v34, v33
    v_cvt_pk_bf16_f32 v34, v34, v34
    ds_write_b16 v11, v34 offset:1024
    s_waitcnt lgkmcnt(0)
    s_barrier
    s_branch KS_PEND
KS_PEND:
KS_ABORT:
KS_END:
    s_endpgm
.section .rodata,"a"
.p2align 6
.amdhsa_kernel sequential_preLN__ssm_conv_s4__moe_arch_mod__prompt_kernel
  .amdhsa_next_free_vgpr 128
  .amdhsa_next_free_sgpr 100
  .amdhsa_accum_offset 128
  .amdhsa_group_segment_fixed_size 0
  .amdhsa_kernarg_size 136
  .amdhsa_user_sgpr_count 2
  .amdhsa_user_sgpr_kernarg_segment_ptr 1
  .amdhsa_system_sgpr_workgroup_id_x 1
  .amdhsa_float_denorm_mode_32 3
.end_amdhsa_kernel
```

```asm
; @launch grid=(256,1,1) block=(1024,1,1) lds=154240
.amdgcn_target "amdgcn-amd-amdhsa--gfx950"
.text
.globl sequential_preLN__ssm_conv_s4__moe_arch_mod__prompt_kernel
.p2align 8
.type sequential_preLN__ssm_conv_s4__moe_arch_mod__prompt_kernel,@function
sequential_preLN__ssm_conv_s4__moe_arch_mod__prompt_kernel:
    s_cmp_ge_u32 s2, 256
    s_cbranch_scc1 KS_END
    s_load_dwordx16 s[4:19], s[0:1], 0
    s_load_dwordx16 s[20:35], s[0:1], 64
    s_load_dwordx2 s[36:37], s[0:1], 128
    v_readfirstlane_b32 s38, v0
    s_lshr_b32 s38, s38, 6
    s_and_b32 s40, s2, 7
    s_lshr_b32 s41, s2, 3
    s_cmp_lg_u32 s38, 0
    s_cbranch_scc1 KS_CPE
    s_getpc_b64 s[42:43]
KS_PC:
    s_and_b32 s92, s41, 7
    s_mul_i32 s92, s92, 4608
    v_and_b32 v126, 63, v0
    v_lshl_add_u32 v126, v126, 7, s92
    v_min_u32 v126, KS_END-KS_PC, v126
    global_load_dword v127, v126, s[42:43]
KS_CPE:
    s_add_u32 s92, s38, 8
    s_sub_u32 s93, s38, 4
    s_cmp_lt_u32 s38, 8
    s_cselect_b32 s92, s92, s93
    s_cmp_lt_u32 s38, 4
    s_cselect_b32 s38, s38, s92
    v_and_b32 v1, 63, v0
    v_and_b32 v2, 15, v1
    v_lshrrev_b32 v3, 4, v1
    v_mov_b32 v4, 0
    v_mov_b32 v5, 1
    s_mov_b32 s39, 524288
    s_mov_b32 s84, 0x01010101
    s_lshl_b32 s90, s40, 5
    s_add_u32 s90, s90, s41
    s_mul_i32 s89, s40, 18
    s_add_u32 s89, s89, s41
    s_cmp_lt_u32 s38, 4
    s_cbranch_scc1 KS_L
    s_cmp_ge_u32 s38, 12
    s_cbranch_scc1 KS_X
    s_setprio 2
    s_lshr_b32 s87, s38, 2
    s_sub_u32 s87, s87, 1
    s_mul_i32 s86, s87, 3
    s_xor_b32 s86, s86, s38
    s_and_b32 s86, s86, 3
    s_lshl_b32 s88, s90, 1
    s_add_u32 s88, s88, s87
    s_lshl_b32 s92, s86, 11
    s_add_u32 s92, s92, 146048
    v_lshl_add_u32 v28, v1, 3, s92
    s_cmp_eq_u32 s86, 3
    s_cbranch_scc1 PX_1
    v_lshlrev_b32 v26, 3, v2
    v_mov_b32 v21, 0x80
    s_cmp_eq_u32 s86, 1
    s_cbranch_scc1 PX_2
    s_cmp_eq_u32 s86, 2
    s_cbranch_scc1 PX_3
    v_lshl_add_u32 v26, v3, 1, v26
    v_mov_b32 v22, 1
    s_branch PX_4
PX_2:
    v_cmp_gt_u32 vcc, 2, v3
    v_lshl_add_u32 v20, v3, 2, v26
    v_add_u32 v20, 256, v20
    v_lshl_add_u32 v26, v3, 8, v26
    v_cndmask_b32 v26, v26, v20, vcc
    v_cndmask_b32 v22, v21, 2, vcc
    v_cndmask_b32 v21, 4, v21, vcc
    s_branch PX_4
PX_3:
    v_lshl_add_u32 v26, v3, 9, v26
    v_add_u32 v26, 0x400, v26
    v_mov_b32 v22, 0x100
PX_4:
    v_mad_u32_u24 v26, v22, s87, v26
    v_add_u32 v27, v26, v21
    s_movk_i32 s96, 31232
    s_movk_i32 s97, -19072
    s_lshl_b32 s95, s87, 9
    v_cvt_f32_u32 v20, v26
    v_max_u32 v22, 0x800, v26
    v_cvt_f32_u32 v21, v27
    v_max_u32 v23, 0x800, v27
    v_cmp_gt_u32 vcc, 0x80, v26
    v_lshrrev_b32 v24, 16, v20
    v_add3_u32 v24, v24, v22, s97
    v_cndmask_b32 v24, v24, v26, vcc
    v_cmp_gt_u32 vcc, 0x80, v27
    v_lshrrev_b32 v25, 16, v21
    v_add3_u32 v25, v25, v23, s97
    v_cndmask_b32 v25, v25, v27, vcc
    v_min_u32 v24, 642, v24
    v_lshl_add_u32 v24, v24, 1, s96
    v_min_u32 v25, 642, v25
    v_lshl_add_u32 v25, v25, 1, s96
    v_add_u32 v29, s95, v28
    v_lshl_or_b32 v24, v25, 16, v24
    v_lshl_or_b32 v25, v27, 16, v26
    ds_write_b64 v29, v[24:25]
PX_1:
KS_GRP:
    s_lshl_b32 s92, s88, 8
    v_lshl_add_u32 v20, v1, 2, s92
    s_lshl_b32 s92, s88, 1
    v_mov_b32 v21, s92
    s_mul_i32 s85, s87, 36672
    s_add_u32 s85, s85, 35840
    s_waitcnt lgkmcnt(0)
    global_load_ushort v46, v21, s[18:19]
    global_load_dword v40, v20, s[6:7]
    global_load_dword v41, v20, s[8:9]
    global_load_dword v42, v20, s[10:11]
    global_load_dword v43, v20, s[12:13]
    global_load_dword v44, v20, s[14:15]
    global_load_dword v45, v20, s[16:17]
    global_load_ushort v107, v21, s[20:21]
    s_barrier
    s_movk_i32 s96, 31232
    s_cmp_eq_u32 s87, 2
    s_cbranch_scc1 PREE_7
    v_mov_b32 v32, 641
    s_cmp_eq_u32 s87, 1
    s_cbranch_scc1 PREB_5
    v_mov_b32 v33, 32514
    s_cmp_eq_u32 s86, 1
    s_cbranch_scc1 PRE_9
    s_cmp_eq_u32 s86, 2
    s_cbranch_scc1 PRE_10
    s_cmp_eq_u32 s86, 3
    s_cbranch_scc1 PRE_11
    v_lshlrev_b32 v23, 1, v1
    v_sub_u32 v30, 93, v23
    v_cmp_lt_u32 vcc, 61, v30
    v_lshlrev_b32 v31, 2, v30
    v_add_u32 v31, 32010, v31
    v_cndmask_b32 v24, v31, v33, vcc
    v_sub_u32 v30, 92, v23
    v_cmp_lt_u32 vcc, 61, v30
    v_lshlrev_b32 v31, 2, v30
    v_add_u32 v31, 32010, v31
    v_cndmask_b32 v25, v31, v33, vcc
    v_sub_u32 v30, 94, v23
    v_cmp_lt_u32 vcc, 62, v30
    v_lshlrev_b32 v31, 2, v30
    v_add_u32 v31, 32008, v31
    v_cndmask_b32 v26, v31, v33, vcc
    v_sub_u32 v30, 93, v23
    v_cmp_lt_u32 vcc, 62, v30
    v_lshlrev_b32 v31, 2, v30
    v_add_u32 v31, 32008, v31
    v_cndmask_b32 v27, v31, v33, vcc
    s_branch PREW_6
PRE_9:
    v_min_u32 v23, 47, v1
    v_lshlrev_b32 v23, 1, v23
    v_sub_u32 v30, 64, v23
    v_cmp_lt_u32 vcc, 63, v30
    v_lshlrev_b32 v31, 2, v30
    v_add_u32 v31, 32258, v31
    v_cndmask_b32 v24, v31, v33, vcc
    v_sub_u32 v30, 63, v23
    v_cmp_lt_u32 vcc, 63, v30
    v_lshlrev_b32 v31, 2, v30
    v_add_u32 v31, 32258, v31
    v_cndmask_b32 v25, v31, v33, vcc
    v_sub_u32 v30, 62, v23
    v_cmp_lt_u32 vcc, 63, v30
    v_lshlrev_b32 v31, 2, v30
    v_add_u32 v31, 32258, v31
    v_cndmask_b32 v27, v31, v33, vcc
    v_mov_b32 v26, v25
    s_branch PREW_6
PRE_10:
    v_min_u32 v23, 47, v1
    v_lshlrev_b32 v23, 1, v23
    v_sub_u32 v30, 64, v23
    v_cmp_lt_u32 vcc, 63, v30
    v_lshlrev_b32 v31, 2, v30
    v_add_u32 v31, 32260, v31
    v_cndmask_b32 v24, v31, v33, vcc
    v_sub_u32 v30, 63, v23
    v_cmp_lt_u32 vcc, 63, v30
    v_lshlrev_b32 v31, 2, v30
    v_add_u32 v31, 32260, v31
    v_cndmask_b32 v25, v31, v33, vcc
    v_sub_u32 v30, 62, v23
    v_cmp_lt_u32 vcc, 63, v30
    v_lshlrev_b32 v31, 2, v30
    v_add_u32 v31, 32260, v31
    v_cndmask_b32 v27, v31, v33, vcc
    v_mov_b32 v26, v25
    s_branch PREW_6
PRE_11:
    v_cmp_gt_u32 vcc, 9, v1
    v_add_u32 v23, 0x100, v1
    v_mov_b32 v33, 0x200
    v_cndmask_b32 v23, v23, v1, vcc
    v_lshlrev_b32 v23, 1, v23
    v_sub_u32 v30, 544, v23
    v_cvt_f32_i32 v31, v30
    v_cmp_gt_u32 vcc, 0x100, v30
    v_cvt_pk_bf16_f32 v31, v31, v31
    v_and_b32 v31, 0xffff, v31
    v_subrev_u32 v31, 0x4280, v31
    v_cndmask_b32 v31, v31, v30, vcc
    v_cmp_lt_u32 vcc, 0x20d, v30
    v_or_b32 v30, 1, v23
    s_nop 0
    v_cndmask_b32 v31, v31, v32, vcc
    v_cmp_eq_u32 vcc, 0x25d, v30
    s_nop 1
    v_cndmask_b32 v31, v31, v33, vcc
    v_lshl_add_u32 v24, v31, 1, s96
    v_add_u32 v23, 1, v23
    v_sub_u32 v30, 544, v23
    v_cvt_f32_i32 v31, v30
    v_cmp_gt_u32 vcc, 0x100, v30
    v_cvt_pk_bf16_f32 v31, v31, v31
    v_and_b32 v31, 0xffff, v31
    v_subrev_u32 v31, 0x4280, v31
    v_cndmask_b32 v31, v31, v30, vcc
    v_cmp_lt_u32 vcc, 0x20d, v30
    v_or_b32 v30, 1, v23
    s_nop 0
    v_cndmask_b32 v31, v31, v32, vcc
    v_cmp_eq_u32 vcc, 0x25d, v30
    s_nop 1
    v_cndmask_b32 v31, v31, v33, vcc
    v_lshl_add_u32 v25, v31, 1, s96
    v_add_u32 v23, 1, v23
    v_sub_u32 v30, 544, v23
    v_cvt_f32_i32 v31, v30
    v_cmp_gt_u32 vcc, 0x100, v30
    v_cvt_pk_bf16_f32 v31, v31, v31
    v_and_b32 v31, 0xffff, v31
    v_subrev_u32 v31, 0x4280, v31
    v_cndmask_b32 v31, v31, v30, vcc
    v_cmp_lt_u32 vcc, 0x20d, v30
    v_or_b32 v30, 1, v23
    s_nop 0
    v_cndmask_b32 v31, v31, v32, vcc
    v_cmp_eq_u32 vcc, 0x25d, v30
    s_nop 1
    v_cndmask_b32 v31, v31, v33, vcc
    v_lshl_add_u32 v27, v31, 1, s96
    v_mov_b32 v26, v25
    s_branch PREW_6
PREB_5:
    s_lshl_b32 s93, s86, 7
    s_add_u32 s93, s93, 18
    v_lshl_add_u32 v23, v1, 1, s93
    v_sub_u32 v30, 544, v23
    v_cvt_f32_i32 v31, v30
    v_cmp_gt_u32 vcc, 0x100, v30
    v_cvt_pk_bf16_f32 v31, v31, v31
    v_and_b32 v31, 0xffff, v31
    v_subrev_u32 v31, 0x4280, v31
    v_cndmask_b32 v31, v31, v30, vcc
    v_cmp_lt_u32 vcc, 0x20d, v30
    s_nop 1
    v_cndmask_b32 v31, v31, v32, vcc
    v_lshl_add_u32 v24, v31, 1, s96
    v_add_u32 v23, 1, v23
    v_sub_u32 v30, 544, v23
    v_cvt_f32_i32 v31, v30
    v_cmp_gt_u32 vcc, 0x100, v30
    v_cvt_pk_bf16_f32 v31, v31, v31
    v_and_b32 v31, 0xffff, v31
    v_subrev_u32 v31, 0x4280, v31
    v_cndmask_b32 v31, v31, v30, vcc
    v_cmp_lt_u32 vcc, 0x20d, v30
    s_nop 1
    v_cndmask_b32 v31, v31, v32, vcc
    v_lshl_add_u32 v25, v31, 1, s96
    v_add_u32 v23, 1, v23
    v_sub_u32 v30, 544, v23
    v_cvt_f32_i32 v31, v30
    v_cmp_gt_u32 vcc, 0x100, v30
    v_cvt_pk_bf16_f32 v31, v31, v31
    v_and_b32 v31, 0xffff, v31
    v_subrev_u32 v31, 0x4280, v31
    v_cndmask_b32 v31, v31, v30, vcc
    v_cmp_lt_u32 vcc, 0x20d, v30
    s_nop 1
    v_cndmask_b32 v31, v31, v32, vcc
    v_lshl_add_u32 v26, v31, 1, s96
    s_sub_u32 s93, s86, 1
    s_cmp_lt_u32 s93, 2
    s_cselect_b32 s94, 47, 63
    s_mul_i32 s93, s93, 384
    s_add_u32 s93, s93, 35664
    s_cmp_eq_u32 s86, 0
    s_cselect_b32 s93, 35152, s93
    s_cmp_eq_u32 s86, 3
    s_cselect_b32 s93, 32528, s93
    s_cselect_b32 s95, 0x100, 0
    v_cmp_gt_u32 vcc, 9, v1
    v_min_u32 v23, s94, v1
    v_add_u32 v30, s95, v23
    v_cndmask_b32 v23, v30, v23, vcc
    v_lshl_add_u32 v27, v23, 2, s93
    v_lshl_or_b32 v24, v25, 16, v24
    v_lshl_or_b32 v25, v27, 16, v26
    ds_write_b64 v28, v[24:25] offset:1024
    v_mov_b32 v24, s86
    ds_write_b8 v24, v5 offset:212
    s_branch PREE_7
PREW_6:
    v_lshl_or_b32 v24, v25, 16, v24
    v_lshl_or_b32 v25, v27, 16, v26
    ds_write_b64 v28, v[24:25] offset:1536
    v_mov_b32 v24, s86
    ds_write_b8 v24, v5 offset:208
PREE_7:
    s_mul_i32 s93, s86, 8704
    s_min_u32 s94, s93, 22304
    s_add_u32 s94, s94, s85
    s_lshl_b32 s92, s87, 4
    v_mov_b32 v14, s92
    v_add_u32 v15, s86, v14
    v_lshl_add_u32 v72, v1, 3, s94
    v_add_u32 v73, 2176, v72
    v_add_u32 v74, 4352, v72
    v_add_u32 v75, 6528, v72
    v_mul_u32_u24 v126, 544, v2
    v_lshl_add_u32 v126, v3, 4, v126
    v_add_u32 v126, s85, v126
    v_add_u32 v127, s93, v126
    v_lshlrev_b32 v20, 3, v3
    v_sub_u32 v20, v20, v2
    v_add_u32 v21, 16, v20
    v_lshrrev_b32 v21, 1, v21
    v_and_b32 v22, 1, v2
    s_add_u32 s92, s85, 32528
    v_lshl_add_u32 v21, v21, 2, s92
    s_movk_i32 s92, 1344
    s_movk_i32 s94, 192
    v_mad_u32_u24 v6, v22, s92, v21
    v_add_u32 v7, 640, v6
    v_mad_u32_u24 v23, v22, s94, v21
    v_add_u32 v13, 3136, v23
    v_lshlrev_b32 v23, 2, v3
    v_sub_u32 v23, v23, v2
    s_add_u32 s92, s85, 35212
    v_lshl_add_u32 v11, v23, 2, s92
    s_mul_i32 s94, s87, 4672
    s_add_u32 s94, s94, 3072
    v_lshl_add_u32 v23, v2, 5, s94
    v_lshl_add_u32 v8, v3, 4, v23
    v_bfe_u32 v20, v1, 2, 2
    v_and_b32 v21, 3, v1
    v_lshl_add_u32 v20, v3, 3, v20
    v_lshlrev_b32 v105, 2, v21
    v_lshl_add_u32 v21, v21, 3, s85
    v_lshl_add_u32 v9, v20, 4, v21
    v_lshl_add_u32 v10, v20, 5, v21
    v_lshlrev_b32 v12, 4, v1
    s_add_u32 s64, s36, 0x600000
    s_addc_u32 s65, s37, 0
    s_mov_b32 s66, 0x240000
    s_mov_b32 s67, 0x20000
    s_mov_b32 s10, 0x8080
    s_lshl_b32 s92, s86, 19
    s_lshl_b32 s93, s90, 6
    s_add_u32 s92, s92, s93
    s_lshl_b32 s93, s86, 16
    s_lshl_b32 s95, s88, 6
    s_add_u32 s93, s93, s95
    s_add_u32 s93, s93, 2064384
    s_cmp_eq_u32 s87, 2
    s_cselect_b32 s6, s93, s92
    s_cselect_b32 s8, 0x1080, s10
    s_cselect_b32 s92, 1, 3
    s_and_b32 s92, s92, s86
    s_lshl_b32 s92, s92, 11
    s_xor_b32 s6, s6, s92
    s_and_b32 s10, s6, 0x7c0
    s_xor_b32 s6, s6, s10
    s_xor_b32 s7, s6, 0x6000
    s_and_b32 s9, s87, 1
    s_lshl_b32 s9, s9, 4
    s_mov_b32 s12, 0x55555555
    s_mov_b32 s13, 0x55555555
    s_lshl_b32 s92, s86, 8
    s_add_u32 s92, s92, s85
    s_add_u32 s92, s92, 36
    v_lshl_add_u32 v124, v1, 2, s92
    s_movk_i32 s92, 192
    s_cmp_eq_u32 s86, 0
    s_cselect_b32 s92, 256, s92
    s_cmp_eq_u32 s86, 3
    s_cselect_b32 s92, 1344, s92
    v_mov_b32 v20, s85
    ds_write_b16 v20, v4 offset:32514
    s_mov_b32 s18, s92
    v_mov_b32 v125, v28
W_12:
    ds_read_b64 v[18:19], v4 offset:208
    s_sub_u32 s39, s39, 1
    s_cbranch_scc1 KS_ABORT
    s_waitcnt lgkmcnt(0)
    v_and_b32 v18, v18, v19
    v_cmp_ne_u32 vcc, s84, v18
    s_cbranch_vccnz W_12
    ds_read2st64_b64 v[28:31], v125 offset0:0 offset1:1
    ds_read2st64_b64 v[32:35], v125 offset0:2 offset1:3
    s_waitcnt lgkmcnt(0)
    v_add_u32_sdwa v108, s85, v28 dst_sel:DWORD dst_unused:UNUSED_PAD src0_sel:DWORD src1_sel:WORD_0
    v_add_u32_sdwa v109, s85, v28 dst_sel:DWORD dst_unused:UNUSED_PAD src0_sel:DWORD src1_sel:WORD_1
    v_cvt_f32_u32_sdwa v110, v29 dst_sel:DWORD dst_unused:UNUSED_PAD src0_sel:WORD_0
    v_cvt_f32_u32_sdwa v111, v29 dst_sel:DWORD dst_unused:UNUSED_PAD src0_sel:WORD_1
    v_add_u32_sdwa v112, s85, v30 dst_sel:DWORD dst_unused:UNUSED_PAD src0_sel:DWORD src1_sel:WORD_0
    v_add_u32_sdwa v113, s85, v30 dst_sel:DWORD dst_unused:UNUSED_PAD src0_sel:DWORD src1_sel:WORD_1
    v_cvt_f32_u32_sdwa v114, v31 dst_sel:DWORD dst_unused:UNUSED_PAD src0_sel:WORD_0
    v_cvt_f32_u32_sdwa v115, v31 dst_sel:DWORD dst_unused:UNUSED_PAD src0_sel:WORD_1
    v_add_u32_sdwa v116, s85, v32 dst_sel:DWORD dst_unused:UNUSED_PAD src0_sel:DWORD src1_sel:WORD_0
    v_add_u32_sdwa v117, s85, v32 dst_sel:DWORD dst_unused:UNUSED_PAD src0_sel:DWORD src1_sel:WORD_1
    v_add_u32_sdwa v118, s85, v33 dst_sel:DWORD dst_unused:UNUSED_PAD src0_sel:DWORD src1_sel:WORD_0
    v_add_u32_sdwa v119, s85, v33 dst_sel:DWORD dst_unused:UNUSED_PAD src0_sel:DWORD src1_sel:WORD_1
    v_add_u32_sdwa v120, s85, v34 dst_sel:DWORD dst_unused:UNUSED_PAD src0_sel:DWORD src1_sel:WORD_0
    v_add_u32_sdwa v121, s85, v34 dst_sel:DWORD dst_unused:UNUSED_PAD src0_sel:DWORD src1_sel:WORD_1
    v_add_u32_sdwa v122, s85, v35 dst_sel:DWORD dst_unused:UNUSED_PAD src0_sel:DWORD src1_sel:WORD_0
    v_add_u32_sdwa v123, s85, v35 dst_sel:DWORD dst_unused:UNUSED_PAD src0_sel:DWORD src1_sel:WORD_1
    v_add_u32 v125, s18, v119
    s_lshl_b32 s92, s87, 5
    s_add_u32 s92, s92, s41
    s_cmp_ge_u32 s92, 88
    s_cbranch_scc1 KC_RECV
    s_mov_b32 s92, 0x3fb8aa3b
    s_mov_b32 s93, 0x32a57060
    s_mov_b32 s94, 0x3e22f983
    s_mov_b32 s95, 0x31dc9c88
    s_waitcnt vmcnt(7)
    v_lshlrev_b32 v16, 16, v46
    v_mul_f32 v17, s92, v16
    v_fma_f32 v19, v16, s92, -v17
    v_fmac_f32 v19, s93, v16
    v_exp_f32 v17, v17
    v_mul_f32 v19, 0x3f317218, v19
    v_fmac_f32 v17, v17, v19
    v_cvt_pk_bf16_f32 v16, 0, v17
    s_waitcnt vmcnt(5)
    ds_write_b32 v4, v5 offset:36
    v_lshlrev_b32 v20, 16, v40
    v_and_b32 v21, 0xffff0000, v40
    v_lshlrev_b32 v22, 16, v41
    v_and_b32 v23, 0xffff0000, v41
    v_pk_mul_f32 v[20:21], v[20:21], v[16:17] op_sel_hi:[1,0]
    v_pk_mul_f32 v[22:23], v[22:23], v[16:17] op_sel_hi:[1,0]
    v_max_f32 v36, v20, v21
    v_pk_mul_f32 v[68:69], v[22:23], s[94:95] op_sel_hi:[1,0]
    v_pk_fma_f32 v[70:71], v[22:23], s[94:95], v[68:69] op_sel_hi:[1,0,1] neg_lo:[0,0,1] neg_hi:[0,0,1]
    v_pk_fma_f32 v[70:71], v[22:23], s[94:95], v[70:71] op_sel:[0,1,0]
    s_cmp_eq_u32 s86, 3
    s_cbranch_scc1 SK_14
    s_waitcnt vmcnt(1)
    v_lshlrev_b32 v24, 16, v42
    v_and_b32 v25, 0xffff0000, v42
    v_lshlrev_b32 v26, 16, v43
    v_and_b32 v27, 0xffff0000, v43
    v_lshlrev_b32 v28, 16, v44
    v_and_b32 v29, 0xffff0000, v44
    v_lshlrev_b32 v30, 16, v45
    v_and_b32 v31, 0xffff0000, v45
    v_pk_mul_f32 v[24:25], v[24:25], v[16:17] op_sel_hi:[1,0]
    v_pk_mul_f32 v[26:27], v[26:27], v[16:17] op_sel_hi:[1,0]
    v_pk_mul_f32 v[90:91], v[30:31], v[26:27]
    v_pk_mul_f32 v[92:93], v[30:31], v[24:25]
    v_pk_fma_f32 v[34:35], v[28:29], v[26:27], v[92:93]
    v_pk_fma_f32 v[32:33], v[28:29], v[24:25], v[90:91] neg_lo:[0,0,1] neg_hi:[0,0,1]
    v_max3_f32 v37, abs(v34), abs(v35), abs(v32)
    v_max_f32 v37, v37, abs(v33)
SK_14:
    s_waitcnt vmcnt(0)
    s_nop 0
    v_permlane32_swap_b32 v36, v37
    v_max_f32 v36, v36, v37
    s_nop 1
    v_max_f32_dpp v36, v36, v36 row_ror:8 row_mask:0xf bank_mask:0xf
    s_nop 1
    v_max_f32_dpp v36, v36, v36 row_ror:4 row_mask:0xf bank_mask:0xf
    s_nop 1
    v_max_f32_dpp v36, v36, v36 row_ror:2 row_mask:0xf bank_mask:0xf
    s_nop 1
    v_max_f32_dpp v36, v36, v36 row_ror:1 row_mask:0xf bank_mask:0xf
    v_mov_b32 v38, v36
    s_nop 1
    v_permlane16_swap_b32 v36, v38
    v_max_f32 v36, v36, v38
    s_nop 0
    v_readlane_b32 s14, v36, 0
    v_readlane_b32 s15, v36, 32
    s_add_u32 s15, s15, 0x7fffff
    s_lshr_b32 s15, s15, 23
    s_max_u32 s15, s15, 24
    s_sub_u32 s16, 269, s15
    s_lshl_b32 s16, s16, 23
    v_subrev_f32 v20, s14, v20
    v_subrev_f32 v21, s14, v21
    v_mul_f32 v20, 0x3fb8aa3b, v20
    v_mul_f32 v21, 0x3fb8aa3b, v21
    s_cmp_eq_u32 s86, 3
    s_cbranch_scc1 JOB_18
    s_cmp_eq_u32 s86, 1
    s_cbranch_scc1 JOB_16
    s_cmp_eq_u32 s86, 2
    s_cbranch_scc1 JOB_17
    v_mul_f32 v91, 0x43000000, v68
    v_mul_f32 v90, 0x43000000, v20
    v_mul_f32 v95, 0x43000000, v69
    v_mul_f32 v94, 0x43000000, v21
    v_fract_f32 v91, v91
    v_fract_f32 v95, v95
    v_fmac_f32 v91, 0x43000000, v70
    v_fmac_f32 v95, 0x43000000, v71
    v_exp_f32 v90, v90
    v_cos_f32 v92, v91
    v_sin_f32 v91, v91
    v_exp_f32 v94, v94
    v_cos_f32 v96, v95
    v_sin_f32 v95, v95
    v_mul_f32 v44, v90, v92
    v_mul_f32 v46, v90, v91
    v_mul_f32 v45, v94, v96
    v_mul_f32 v47, v94, v95
    v_pk_mul_f32 v[32:33], v[32:33], s[16:17] op_sel_hi:[1,0]
    v_pk_mul_f32 v[34:35], v[34:35], s[16:17] op_sel_hi:[1,0]
    v_fract_f32 v91, v68
    v_fract_f32 v95, v69
    v_fmac_f32 v91, 1.0, v70
    v_fmac_f32 v95, 1.0, v71
    v_exp_f32 v90, v20
    v_cos_f32 v92, v91
    v_sin_f32 v91, v91
    v_exp_f32 v94, v21
    v_cos_f32 v96, v95
    v_sin_f32 v95, v95
    v_mul_f32 v40, v90, v92
    v_mul_f32 v42, v90, v91
    v_mul_f32 v41, v94, v96
    v_mul_f32 v43, v94, v95
    v_pk_mul_f32 v[90:91], v[34:35], v[46:47]
    v_pk_mul_f32 v[94:95], v[34:35], v[42:43]
    v_pk_mul_f32 v[92:93], v[34:35], v[44:45]
    v_pk_mul_f32 v[96:97], v[34:35], v[40:41]
    v_pk_fma_f32 v[62:63], v[32:33], v[46:47], v[92:93]
    v_pk_fma_f32 v[54:55], v[32:33], v[42:43], v[96:97]
    v_pk_fma_f32 v[60:61], v[32:33], v[44:45], v[90:91] neg_lo:[0,0,1] neg_hi:[0,0,1]
    v_pk_fma_f32 v[52:53], v[32:33], v[40:41], v[94:95] neg_lo:[0,0,1] neg_hi:[0,0,1]
    v_cvt_pk_f16_f32 v98, v32, v34
    v_cvt_pk_f16_f32 v99, v33, v35
    v_cvt_pk_f16_f32 v100, v60, v62
    v_cvt_pk_f16_f32 v101, v61, v63
    ds_write2_b64 v72, v[98:99], v[100:101] offset0:0 offset1:68
    v_pk_mul_f32 v[90:91], v[54:55], v[46:47]
    v_pk_mul_f32 v[94:95], v[54:55], v[42:43]
    v_pk_mul_f32 v[92:93], v[54:55], v[44:45]
    v_pk_mul_f32 v[96:97], v[54:55], v[40:41]
    v_pk_fma_f32 v[62:63], v[52:53], v[46:47], v[92:93]
    v_pk_fma_f32 v[58:59], v[52:53], v[42:43], v[96:97]
    v_pk_fma_f32 v[60:61], v[52:53], v[44:45], v[90:91] neg_lo:[0,0,1] neg_hi:[0,0,1]
    v_pk_fma_f32 v[56:57], v[52:53], v[40:41], v[94:95] neg_lo:[0,0,1] neg_hi:[0,0,1]
    v_cvt_pk_f16_f32 v76, v52, v54
    v_cvt_pk_f16_f32 v77, v53, v55
    v_cvt_pk_f16_f32 v78, v60, v62
    v_cvt_pk_f16_f32 v79, v61, v63
    ds_write2_b64 v72, v[76:77], v[78:79] offset0:136 offset1:204
    v_pk_mul_f32 v[90:91], v[58:59], v[46:47]
    v_pk_mul_f32 v[94:95], v[58:59], v[42:43]
    v_pk_mul_f32 v[92:93], v[58:59], v[44:45]
    v_pk_mul_f32 v[96:97], v[58:59], v[40:41]
    v_pk_fma_f32 v[62:63], v[56:57], v[46:47], v[92:93]
    v_pk_fma_f32 v[54:55], v[56:57], v[42:43], v[96:97]
    v_pk_fma_f32 v[60:61], v[56:57], v[44:45], v[90:91] neg_lo:[0,0,1] neg_hi:[0,0,1]
    v_pk_fma_f32 v[52:53], v[56:57], v[40:41], v[94:95] neg_lo:[0,0,1] neg_hi:[0,0,1]
    v_cvt_pk_f16_f32 v98, v56, v58
    v_cvt_pk_f16_f32 v99, v57, v59
    v_cvt_pk_f16_f32 v100, v60, v62
    v_cvt_pk_f16_f32 v101, v61, v63
    ds_write2_b64 v73, v[98:99], v[100:101] offset0:0 offset1:68
    v_pk_mul_f32 v[90:91], v[54:55], v[46:47]
    v_pk_mul_f32 v[94:95], v[54:55], v[42:43]
    v_pk_mul_f32 v[92:93], v[54:55], v[44:45]
    v_pk_mul_f32 v[96:97], v[54:55], v[40:41]
    v_pk_fma_f32 v[62:63], v[52:53], v[46:47], v[92:93]
    v_pk_fma_f32 v[58:59], v[52:53], v[42:43], v[96:97]
    v_pk_fma_f32 v[60:61], v[52:53], v[44:45], v[90:91] neg_lo:[0,0,1] neg_hi:[0,0,1]
    v_pk_fma_f32 v[56:57], v[52:53], v[40:41], v[94:95] neg_lo:[0,0,1] neg_hi:[0,0,1]
    v_cvt_pk_f16_f32 v76, v52, v54
    v_cvt_pk_f16_f32 v77, v53, v55
    v_cvt_pk_f16_f32 v78, v60, v62
    v_cvt_pk_f16_f32 v79, v61, v63
    ds_write2_b64 v73, v[76:77], v[78:79] offset0:136 offset1:204
    v_pk_mul_f32 v[90:91], v[58:59], v[46:47]
    v_pk_mul_f32 v[94:95], v[58:59], v[42:43]
    v_pk_mul_f32 v[92:93], v[58:59], v[44:45]
    v_pk_mul_f32 v[96:97], v[58:59], v[40:41]
    v_pk_fma_f32 v[62:63], v[56:57], v[46:47], v[92:93]
    v_pk_fma_f32 v[54:55], v[56:57], v[42:43], v[96:97]
    v_pk_fma_f32 v[60:61], v[56:57], v[44:45], v[90:91] neg_lo:[0,0,1] neg_hi:[0,0,1]
    v_pk_fma_f32 v[52:53], v[56:57], v[40:41], v[94:95] neg_lo:[0,0,1] neg_hi:[0,0,1]
    v_cvt_pk_f16_f32 v98, v56, v58
    v_cvt_pk_f16_f32 v99, v57, v59
    v_cvt_pk_f16_f32 v100, v60, v62
    v_cvt_pk_f16_f32 v101, v61, v63
    ds_write2_b64 v74, v[98:99], v[100:101] offset0:0 offset1:68
    v_pk_mul_f32 v[90:91], v[54:55], v[46:47]
    v_pk_mul_f32 v[94:95], v[54:55], v[42:43]
    v_pk_mul_f32 v[92:93], v[54:55], v[44:45]
    v_pk_mul_f32 v[96:97], v[54:55], v[40:41]
    v_pk_fma_f32 v[62:63], v[52:53], v[46:47], v[92:93]
    v_pk_fma_f32 v[58:59], v[52:53], v[42:43], v[96:97]
    v_pk_fma_f32 v[60:61], v[52:53], v[44:45], v[90:91] neg_lo:[0,0,1] neg_hi:[0,0,1]
    v_pk_fma_f32 v[56:57], v[52:53], v[40:41], v[94:95] neg_lo:[0,0,1] neg_hi:[0,0,1]
    v_cvt_pk_f16_f32 v76, v52, v54
    v_cvt_pk_f16_f32 v77, v53, v55
    v_cvt_pk_f16_f32 v78, v60, v62
    v_cvt_pk_f16_f32 v79, v61, v63
    ds_write2_b64 v74, v[76:77], v[78:79] offset0:136 offset1:204
    v_pk_mul_f32 v[90:91], v[58:59], v[46:47]
    v_pk_mul_f32 v[94:95], v[58:59], v[42:43]
    v_pk_mul_f32 v[92:93], v[58:59], v[44:45]
    v_pk_mul_f32 v[96:97], v[58:59], v[40:41]
    v_pk_fma_f32 v[62:63], v[56:57], v[46:47], v[92:93]
    v_pk_fma_f32 v[54:55], v[56:57], v[42:43], v[96:97]
    v_pk_fma_f32 v[60:61], v[56:57], v[44:45], v[90:91] neg_lo:[0,0,1] neg_hi:[0,0,1]
    v_pk_fma_f32 v[52:53], v[56:57], v[40:41], v[94:95] neg_lo:[0,0,1] neg_hi:[0,0,1]
    v_cvt_pk_f16_f32 v98, v56, v58
    v_cvt_pk_f16_f32 v99, v57, v59
    v_cvt_pk_f16_f32 v100, v60, v62
    v_cvt_pk_f16_f32 v101, v61, v63
    ds_write2_b64 v75, v[98:99], v[100:101] offset0:0 offset1:68
    v_pk_mul_f32 v[90:91], v[54:55], v[46:47]
    v_pk_mul_f32 v[92:93], v[54:55], v[44:45]
    v_pk_fma_f32 v[62:63], v[52:53], v[46:47], v[92:93]
    v_pk_fma_f32 v[60:61], v[52:53], v[44:45], v[90:91] neg_lo:[0,0,1] neg_hi:[0,0,1]
    v_cvt_pk_f16_f32 v76, v52, v54
    v_cvt_pk_f16_f32 v77, v53, v55
    v_cvt_pk_f16_f32 v78, v60, v62
    v_cvt_pk_f16_f32 v79, v61, v63
    ds_write2_b64 v75, v[76:77], v[78:79] offset0:136 offset1:204
    s_branch JOBJ_19
JOB_16:
    v_mul_f32 v91, 0x43000000, v68
    v_mul_f32 v90, 0x43000000, v20
    v_mul_f32 v95, 0x43000000, v69
    v_mul_f32 v94, 0x43000000, v21
    v_fract_f32 v91, v91
    v_fract_f32 v95, v95
    v_fmac_f32 v91, 0x43000000, v70
    v_fmac_f32 v95, 0x43000000, v71
    v_exp_f32 v90, v90
    v_cos_f32 v92, v91
    v_sin_f32 v91, v91
    v_exp_f32 v94, v94
    v_cos_f32 v96, v95
    v_sin_f32 v95, v95
    v_mul_f32 v44, v90, v92
    v_mul_f32 v46, v90, v91
    v_mul_f32 v45, v94, v96
    v_mul_f32 v47, v94, v95
    v_pk_mul_f32 v[32:33], v[32:33], s[16:17] op_sel_hi:[1,0]
    v_pk_mul_f32 v[34:35], v[34:35], s[16:17] op_sel_hi:[1,0]
    v_pk_mul_f32 v[90:91], v[46:47], v[46:47]
    v_pk_mul_f32 v[92:93], v[44:45], v[46:47]
    v_pk_fma_f32 v[48:49], v[44:45], v[44:45], v[90:91] neg_lo:[0,0,1] neg_hi:[0,0,1]
    v_pk_add_f32 v[50:51], v[92:93], v[92:93]
    v_mul_f32 v91, 2.0, v68
    v_mul_f32 v90, 2.0, v20
    v_mul_f32 v95, 2.0, v69
    v_mul_f32 v94, 2.0, v21
    v_fract_f32 v91, v91
    v_fract_f32 v95, v95
    v_fmac_f32 v91, 2.0, v70
    v_fmac_f32 v95, 2.0, v71
    v_exp_f32 v90, v90
    v_cos_f32 v92, v91
    v_sin_f32 v91, v91
    v_exp_f32 v94, v94
    v_cos_f32 v96, v95
    v_sin_f32 v95, v95
    v_mul_f32 v40, v90, v92
    v_mul_f32 v42, v90, v91
    v_mul_f32 v41, v94, v96
    v_mul_f32 v43, v94, v95
    v_pk_mul_f32 v[90:91], v[34:35], v[50:51]
    v_pk_mul_f32 v[92:93], v[34:35], v[48:49]
    v_pk_fma_f32 v[54:55], v[32:33], v[50:51], v[92:93]
    v_pk_fma_f32 v[52:53], v[32:33], v[48:49], v[90:91] neg_lo:[0,0,1] neg_hi:[0,0,1]
    v_pk_mul_f32 v[90:91], v[54:55], v[50:51]
    v_pk_mul_f32 v[92:93], v[54:55], v[48:49]
    v_pk_fma_f32 v[66:67], v[52:53], v[50:51], v[92:93]
    v_pk_fma_f32 v[64:65], v[52:53], v[48:49], v[90:91] neg_lo:[0,0,1] neg_hi:[0,0,1]
    v_pk_mul_f32 v[90:91], v[54:55], v[46:47]
    v_pk_mul_f32 v[94:95], v[54:55], v[42:43]
    v_pk_mul_f32 v[92:93], v[54:55], v[44:45]
    v_pk_mul_f32 v[96:97], v[54:55], v[40:41]
    v_pk_fma_f32 v[62:63], v[52:53], v[46:47], v[92:93]
    v_pk_fma_f32 v[58:59], v[52:53], v[42:43], v[96:97]
    v_pk_fma_f32 v[60:61], v[52:53], v[44:45], v[90:91] neg_lo:[0,0,1] neg_hi:[0,0,1]
    v_pk_fma_f32 v[56:57], v[52:53], v[40:41], v[94:95] neg_lo:[0,0,1] neg_hi:[0,0,1]
    v_cvt_pk_f16_f32 v98, v52, v54
    v_cvt_pk_f16_f32 v99, v53, v55
    v_cvt_pk_f16_f32 v100, v60, v62
    v_cvt_pk_f16_f32 v101, v61, v63
    ds_write2_b64 v72, v[98:99], v[100:101] offset0:0 offset1:68
    v_pk_mul_f32 v[90:91], v[58:59], v[46:47]
    v_pk_mul_f32 v[94:95], v[58:59], v[42:43]
    v_pk_mul_f32 v[92:93], v[58:59], v[44:45]
    v_pk_mul_f32 v[96:97], v[58:59], v[40:41]
    v_pk_fma_f32 v[62:63], v[56:57], v[46:47], v[92:93]
    v_pk_fma_f32 v[54:55], v[56:57], v[42:43], v[96:97]
    v_pk_fma_f32 v[60:61], v[56:57], v[44:45], v[90:91] neg_lo:[0,0,1] neg_hi:[0,0,1]
    v_pk_fma_f32 v[52:53], v[56:57], v[40:41], v[94:95] neg_lo:[0,0,1] neg_hi:[0,0,1]
    v_cvt_pk_f16_f32 v76, v56, v58
    v_cvt_pk_f16_f32 v77, v57, v59
    v_cvt_pk_f16_f32 v78, v60, v62
    v_cvt_pk_f16_f32 v79, v61, v63
    ds_write2_b64 v72, v[76:77], v[78:79] offset0:136 offset1:204
    v_pk_mul_f32 v[90:91], v[54:55], v[46:47]
    v_pk_mul_f32 v[94:95], v[54:55], v[42:43]
    v_pk_mul_f32 v[92:93], v[54:55], v[44:45]
    v_pk_mul_f32 v[96:97], v[54:55], v[40:41]
    v_pk_fma_f32 v[62:63], v[52:53], v[46:47], v[92:93]
    v_pk_fma_f32 v[58:59], v[52:53], v[42:43], v[96:97]
    v_pk_fma_f32 v[60:61], v[52:53], v[44:45], v[90:91] neg_lo:[0,0,1] neg_hi:[0,0,1]
    v_pk_fma_f32 v[56:57], v[52:53], v[40:41], v[94:95] neg_lo:[0,0,1] neg_hi:[0,0,1]
    v_cvt_pk_f16_f32 v98, v52, v54
    v_cvt_pk_f16_f32 v99, v53, v55
    v_cvt_pk_f16_f32 v100, v60, v62
    v_cvt_pk_f16_f32 v101, v61, v63
    ds_write2_b64 v73, v[98:99], v[100:101] offset0:0 offset1:68
    v_pk_mul_f32 v[90:91], v[58:59], v[46:47]
    v_pk_mul_f32 v[94:95], v[42:43], v[42:43]
    v_pk_mul_f32 v[92:93], v[58:59], v[44:45]
    v_pk_mul_f32 v[96:97], v[40:41], v[42:43]
    v_pk_fma_f32 v[62:63], v[56:57], v[46:47], v[92:93]
    v_pk_fma_f32 v[48:49], v[40:41], v[40:41], v[94:95] neg_lo:[0,0,1] neg_hi:[0,0,1]
    v_pk_fma_f32 v[60:61], v[56:57], v[44:45], v[90:91] neg_lo:[0,0,1] neg_hi:[0,0,1]
    v_pk_add_f32 v[50:51], v[96:97], v[96:97]
    v_cvt_pk_f16_f32 v76, v56, v58
    v_cvt_pk_f16_f32 v77, v57, v59
    v_cvt_pk_f16_f32 v78, v60, v62
    v_cvt_pk_f16_f32 v79, v61, v63
    ds_write2_b64 v73, v[76:77], v[78:79] offset0:136 offset1:204
    v_pk_mul_f32 v[90:91], v[66:67], v[50:51]
    v_pk_mul_f32 v[94:95], v[66:67], v[46:47]
    v_pk_mul_f32 v[92:93], v[66:67], v[48:49]
    v_pk_mul_f32 v[96:97], v[66:67], v[44:45]
    v_pk_fma_f32 v[62:63], v[64:65], v[50:51], v[92:93]
    v_pk_fma_f32 v[54:55], v[64:65], v[46:47], v[96:97]
    v_pk_fma_f32 v[60:61], v[64:65], v[48:49], v[90:91] neg_lo:[0,0,1] neg_hi:[0,0,1]
    v_pk_fma_f32 v[52:53], v[64:65], v[44:45], v[94:95] neg_lo:[0,0,1] neg_hi:[0,0,1]
    v_cvt_pk_f16_f32 v98, v64, v66
    v_cvt_pk_f16_f32 v99, v65, v67
    v_cvt_pk_f16_f32 v100, v60, v62
    v_cvt_pk_f16_f32 v101, v61, v63
    ds_write2_b64 v74, v[98:99], v[100:101] offset0:0 offset1:68
    v_pk_mul_f32 v[90:91], v[54:55], v[50:51]
    v_pk_mul_f32 v[94:95], v[54:55], v[46:47]
    v_pk_mul_f32 v[92:93], v[54:55], v[48:49]
    v_pk_mul_f32 v[96:97], v[54:55], v[44:45]
    v_pk_fma_f32 v[62:63], v[52:53], v[50:51], v[92:93]
    v_pk_fma_f32 v[58:59], v[52:53], v[46:47], v[96:97]
    v_pk_fma_f32 v[60:61], v[52:53], v[48:49], v[90:91] neg_lo:[0,0,1] neg_hi:[0,0,1]
    v_pk_fma_f32 v[56:57], v[52:53], v[44:45], v[94:95] neg_lo:[0,0,1] neg_hi:[0,0,1]
    v_cvt_pk_f16_f32 v76, v52, v54
    v_cvt_pk_f16_f32 v77, v53, v55
    v_cvt_pk_f16_f32 v78, v60, v62
    v_cvt_pk_f16_f32 v79, v61, v63
    ds_write2_b64 v74, v[76:77], v[78:79] offset0:136 offset1:204
    v_pk_mul_f32 v[90:91], v[58:59], v[50:51]
    v_pk_mul_f32 v[94:95], v[58:59], v[46:47]
    v_pk_mul_f32 v[92:93], v[58:59], v[48:49]
    v_pk_mul_f32 v[96:97], v[58:59], v[44:45]
    v_pk_fma_f32 v[62:63], v[56:57], v[50:51], v[92:93]
    v_pk_fma_f32 v[54:55], v[56:57], v[46:47], v[96:97]
    v_pk_fma_f32 v[60:61], v[56:57], v[48:49], v[90:91] neg_lo:[0,0,1] neg_hi:[0,0,1]
    v_pk_fma_f32 v[52:53], v[56:57], v[44:45], v[94:95] neg_lo:[0,0,1] neg_hi:[0,0,1]
    v_cvt_pk_f16_f32 v98, v56, v58
    v_cvt_pk_f16_f32 v99, v57, v59
    v_cvt_pk_f16_f32 v100, v60, v62
    v_cvt_pk_f16_f32 v101, v61, v63
    ds_write2_b64 v75, v[98:99], v[100:101] offset0:0 offset1:68
    v_pk_mul_f32 v[90:91], v[54:55], v[50:51]
    v_pk_mul_f32 v[92:93], v[54:55], v[48:49]
    v_pk_fma_f32 v[62:63], v[52:53], v[50:51], v[92:93]
    v_pk_fma_f32 v[60:61], v[52:53], v[48:49], v[90:91] neg_lo:[0,0,1] neg_hi:[0,0,1]
    v_cvt_pk_f16_f32 v76, v52, v54
    v_cvt_pk_f16_f32 v77, v53, v55
    v_cvt_pk_f16_f32 v78, v60, v62
    v_cvt_pk_f16_f32 v79, v61, v63
    ds_write2_b64 v75, v[76:77], v[78:79] offset0:136 offset1:204
    s_branch JOBJ_19
JOB_18:
    v_mul_f32 v91, 0x41000000, v68
    v_mul_f32 v90, 0x41000000, v20
    v_mul_f32 v95, 0x41000000, v69
    v_mul_f32 v94, 0x41000000, v21
    v_fract_f32 v91, v91
    v_fract_f32 v95, v95
    v_fmac_f32 v91, 0x41000000, v70
    v_fmac_f32 v95, 0x41000000, v71
    v_exp_f32 v90, v90
    v_cos_f32 v92, v91
    v_sin_f32 v91, v91
    v_exp_f32 v94, v94
    v_cos_f32 v96, v95
    v_sin_f32 v95, v95
    v_mul_f32 v40, v90, v92
    v_mul_f32 v42, v90, -v91
    v_mul_f32 v41, v94, v96
    v_mul_f32 v43, v94, -v95
    v_mov_b32 v52, 0x47000000
    v_mov_b32 v53, 0x47000000
    v_mov_b32 v54, 0
    v_mov_b32 v55, 0
    v_pk_mul_f32 v[90:91], v[42:43], v[42:43]
    v_pk_mul_f32 v[60:61], v[40:41], v[52:53]
    v_pk_mul_f32 v[92:93], v[40:41], v[42:43]
    v_pk_mul_f32 v[62:63], v[42:43], v[52:53]
    v_pk_fma_f32 v[44:45], v[40:41], v[40:41], v[90:91] neg_lo:[0,0,1] neg_hi:[0,0,1]
    v_pk_add_f32 v[46:47], v[92:93], v[92:93]
    v_pk_mul_f32 v[56:57], v[44:45], v[52:53]
    v_pk_mul_f32 v[94:95], v[62:63], v[46:47]
    v_pk_mul_f32 v[58:59], v[46:47], v[52:53]
    v_pk_mul_f32 v[96:97], v[62:63], v[44:45]
    v_pk_fma_f32 v[66:67], v[60:61], v[46:47], v[96:97]
    v_pk_fma_f32 v[64:65], v[60:61], v[44:45], v[94:95] neg_lo:[0,0,1] neg_hi:[0,0,1]
    v_cvt_pk_f16_f32 v98, v52, v54
    v_cvt_pk_f16_f32 v99, v53, v55
    v_cvt_pk_f16_f32 v100, v60, v62
    v_cvt_pk_f16_f32 v101, v61, v63
    ds_write2_b64 v72, v[98:99], v[100:101] offset0:0 offset1:68
    v_pk_mul_f32 v[90:91], v[58:59], v[46:47]
    v_pk_mul_f32 v[94:95], v[66:67], v[46:47]
    v_pk_mul_f32 v[92:93], v[58:59], v[44:45]
    v_pk_mul_f32 v[96:97], v[66:67], v[44:45]
    v_pk_fma_f32 v[54:55], v[56:57], v[46:47], v[92:93]
    v_pk_fma_f32 v[62:63], v[64:65], v[46:47], v[96:97]
    v_pk_fma_f32 v[52:53], v[56:57], v[44:45], v[90:91] neg_lo:[0,0,1] neg_hi:[0,0,1]
    v_pk_fma_f32 v[60:61], v[64:65], v[44:45], v[94:95] neg_lo:[0,0,1] neg_hi:[0,0,1]
    v_cvt_pk_f16_f32 v76, v56, v58
    v_cvt_pk_f16_f32 v77, v57, v59
    v_cvt_pk_f16_f32 v78, v64, v66
    v_cvt_pk_f16_f32 v79, v65, v67
    ds_write2_b64 v72, v[76:77], v[78:79] offset0:136 offset1:204
    v_pk_mul_f32 v[90:91], v[54:55], v[46:47]
    v_pk_mul_f32 v[94:95], v[62:63], v[46:47]
    v_pk_mul_f32 v[92:93], v[54:55], v[44:45]
    v_pk_mul_f32 v[96:97], v[62:63], v[44:45]
    v_pk_fma_f32 v[58:59], v[52:53], v[46:47], v[92:93]
    v_pk_fma_f32 v[66:67], v[60:61], v[46:47], v[96:97]
    v_pk_fma_f32 v[56:57], v[52:53], v[44:45], v[90:91] neg_lo:[0,0,1] neg_hi:[0,0,1]
    v_pk_fma_f32 v[64:65], v[60:61], v[44:45], v[94:95] neg_lo:[0,0,1] neg_hi:[0,0,1]
    v_cvt_pk_f16_f32 v98, v52, v54
    v_cvt_pk_f16_f32 v99, v53, v55
    v_cvt_pk_f16_f32 v100, v60, v62
    v_cvt_pk_f16_f32 v101, v61, v63
    ds_write2_b64 v73, v[98:99], v[100:101] offset0:0 offset1:68
    v_pk_mul_f32 v[90:91], v[58:59], v[46:47]
    v_pk_mul_f32 v[94:95], v[66:67], v[46:47]
    v_pk_mul_f32 v[92:93], v[58:59], v[44:45]
    v_pk_mul_f32 v[96:97], v[66:67], v[44:45]
    v_pk_fma_f32 v[54:55], v[56:57], v[46:47], v[92:93]
    v_pk_fma_f32 v[62:63], v[64:65], v[46:47], v[96:97]
    v_pk_fma_f32 v[52:53], v[56:57], v[44:45], v[90:91] neg_lo:[0,0,1] neg_hi:[0,0,1]
    v_pk_fma_f32 v[60:61], v[64:65], v[44:45], v[94:95] neg_lo:[0,0,1] neg_hi:[0,0,1]
    v_cvt_pk_f16_f32 v76, v56, v58
    v_cvt_pk_f16_f32 v77, v57, v59
    v_cvt_pk_f16_f32 v78, v64, v66
    v_cvt_pk_f16_f32 v79, v65, v67
    ds_write2_b64 v73, v[76:77], v[78:79] offset0:136 offset1:204
    v_pk_mul_f32 v[90:91], v[54:55], v[46:47]
    v_pk_mul_f32 v[94:95], v[62:63], v[46:47]
    v_pk_mul_f32 v[92:93], v[54:55], v[44:45]
    v_pk_mul_f32 v[96:97], v[62:63], v[44:45]
    v_pk_fma_f32 v[58:59], v[52:53], v[46:47], v[92:93]
    v_pk_fma_f32 v[66:67], v[60:61], v[46:47], v[96:97]
    v_pk_fma_f32 v[56:57], v[52:53], v[44:45], v[90:91] neg_lo:[0,0,1] neg_hi:[0,0,1]
    v_pk_fma_f32 v[64:65], v[60:61], v[44:45], v[94:95] neg_lo:[0,0,1] neg_hi:[0,0,1]
    v_cvt_pk_f16_f32 v98, v52, v54
    v_cvt_pk_f16_f32 v99, v53, v55
    v_cvt_pk_f16_f32 v100, v60, v62
    v_cvt_pk_f16_f32 v101, v61, v63
    ds_write2_b64 v74, v[98:99], v[100:101] offset0:0 offset1:68
    v_pk_mul_f32 v[90:91], v[58:59], v[46:47]
    v_pk_mul_f32 v[94:95], v[66:67], v[46:47]
    v_pk_mul_f32 v[92:93], v[58:59], v[44:45]
    v_pk_mul_f32 v[96:97], v[66:67], v[44:45]
    v_pk_fma_f32 v[54:55], v[56:57], v[46:47], v[92:93]
    v_pk_fma_f32 v[62:63], v[64:65], v[46:47], v[96:97]
    v_pk_fma_f32 v[52:53], v[56:57], v[44:45], v[90:91] neg_lo:[0,0,1] neg_hi:[0,0,1]
    v_pk_fma_f32 v[60:61], v[64:65], v[44:45], v[94:95] neg_lo:[0,0,1] neg_hi:[0,0,1]
    v_cvt_pk_f16_f32 v76, v56, v58
    v_cvt_pk_f16_f32 v77, v57, v59
    v_cvt_pk_f16_f32 v78, v64, v66
    v_cvt_pk_f16_f32 v79, v65, v67
    ds_write2_b64 v74, v[76:77], v[78:79] offset0:136 offset1:204
    v_pk_mul_f32 v[90:91], v[54:55], v[46:47]
    v_pk_mul_f32 v[94:95], v[62:63], v[46:47]
    v_pk_mul_f32 v[92:93], v[54:55], v[44:45]
    v_pk_mul_f32 v[96:97], v[62:63], v[44:45]
    v_pk_fma_f32 v[58:59], v[52:53], v[46:47], v[92:93]
    v_pk_fma_f32 v[66:67], v[60:61], v[46:47], v[96:97]
    v_pk_fma_f32 v[56:57], v[52:53], v[44:45], v[90:91] neg_lo:[0,0,1] neg_hi:[0,0,1]
    v_pk_fma_f32 v[64:65], v[60:61], v[44:45], v[94:95] neg_lo:[0,0,1] neg_hi:[0,0,1]
    v_cvt_pk_f16_f32 v98, v52, v54
    v_cvt_pk_f16_f32 v99, v53, v55
    v_cvt_pk_f16_f32 v100, v60, v62
    v_cvt_pk_f16_f32 v101, v61, v63
    ds_write2_b64 v75, v[98:99], v[100:101] offset0:0 offset1:68
    v_cvt_pk_f16_f32 v76, v56, v58
    v_cvt_pk_f16_f32 v77, v57, v59
    v_cvt_pk_f16_f32 v78, v64, v66
    v_cvt_pk_f16_f32 v79, v65, v67
    ds_write2_b64 v75, v[76:77], v[78:79] offset0:136 offset1:204
    ds_write_b8 v15, v5 offset:64
    s_cmp_eq_u32 s87, 2
    s_cbranch_scc1 KS_G0
    s_branch EXP_13
KC_SEND:
W_20:
    ds_read_b32 v104, v105 offset:224
    s_sub_u32 s39, s39, 1
    s_cbranch_scc1 KS_ABORT
    s_waitcnt lgkmcnt(0)
    v_cmp_eq_u32 vcc, 0, v104
    s_cbranch_vccnz W_20
    s_lshl_b32 s92, s88, 12
    s_lshl_b32 s93, s86, 10
    s_add_u32 s92, s92, s93
    s_add_u32 s92, s92, 0x920000
    v_add_u32 v24, s92, v12
    s_mov_b32 s93, 0xffff
    v_lshlrev_b32 v25, 16, v104
    v_cvt_f16_f32 v20, v20
    v_cvt_f16_f32 v21, v21
    v_cvt_f16_f32 v22, v22
    v_cvt_f16_f32 v23, v23
    s_cmp_lg_u32 s86, 2
    s_cbranch_scc1 KC_S2
    s_mov_b32 exec_lo, 0
    s_mov_b32 exec_hi, 0xffff0000
    v_mov_b32 v20, v106
    v_lshrrev_b32 v21, 16, v106
    s_mov_b64 exec, -1
KC_S2:
    v_bfi_b32 v20, s93, v20, v104
    v_bfi_b32 v21, s93, v21, v25
    v_bfi_b32 v22, s93, v22, v104
    v_bfi_b32 v23, s93, v23, v25
    global_store_dwordx4 v24, v[20:23], s[36:37] sc1
    s_branch KS_G0
KC_RECV:
    s_cmp_eq_u32 s86, 3
    s_cbranch_scc1 EXP_13
    s_lshl_b32 s92, s88, 12
    s_lshl_b32 s93, s86, 10
    s_add_u32 s92, s92, s93
    s_add_u32 s92, s92, 0x920000
    v_add_u32 v24, s92, v12
W_21:
    s_sleep 2
    ds_read_b32 v104, v105 offset:224
    s_sub_u32 s39, s39, 1
    s_cbranch_scc1 KS_ABORT
    s_waitcnt lgkmcnt(0)
    v_cmp_eq_u32 vcc, 0, v104
    s_cbranch_vccnz W_21
    v_lshlrev_b32 v25, 16, v104
W_22:
    s_sleep 2
    ds_read_b32 v17, v4 offset:68
    s_sub_u32 s39, s39, 1
    s_cbranch_scc1 KS_ABORT
    s_waitcnt lgkmcnt(0)
    v_cmp_ne_u32 vcc, s84, v17
    s_cbranch_vccnz W_22
    s_branch KPE_24
KP_23:
    s_sleep 2
KPE_24:
    global_load_dwordx4 v[20:23], v24, s[36:37] sc1
    s_sub_u32 s39, s39, 1
    s_cbranch_scc1 KS_ABORT
    s_waitcnt vmcnt(0)
    v_xor_b32 v20, v104, v20
    v_xor_b32 v21, v25, v21
    v_xor_b32 v22, v104, v22
    v_xor_b32 v23, v25, v23
    v_or3_b32 v26, v20, v21, v22
    v_or_b32 v26, v26, v23
    v_cmp_lt_u32 vcc, 0xffff, v26
    s_cbranch_vccnz KP_23
    v_xor_b32 v20, v104, v20
    v_xor_b32 v22, v104, v22
    ds_write_b16 v108, v20
    ds_write_b16 v109, v21
    ds_write_b16 v112, v22
    ds_write_b16 v113, v23
    s_cmp_lg_u32 s86, 2
    s_cbranch_scc1 EXP_13
    v_and_b32 v20, 0xffff, v20
    v_lshl_or_b32 v20, v21, 16, v20
    v_lshlrev_b32 v21, 16, v107
    s_mov_b32 exec_lo, 0
    s_mov_b32 exec_hi, 0x10000
    ds_write_b64 v14, v[20:21] offset:832
    s_mov_b64 exec, -1
    s_branch EXP_13
JOB_17:
    v_mul_f32 v91, 0x43000000, v68
    v_mul_f32 v90, 0x43000000, v20
    v_mul_f32 v95, 0x43000000, v69
    v_mul_f32 v94, 0x43000000, v21
    v_fract_f32 v91, v91
    v_fract_f32 v95, v95
    v_fmac_f32 v91, 0x43000000, v70
    v_fmac_f32 v95, 0x43000000, v71
    v_exp_f32 v90, v90
    v_cos_f32 v92, v91
    v_sin_f32 v91, v91
    v_exp_f32 v94, v94
    v_cos_f32 v96, v95
    v_sin_f32 v95, v95
    v_mul_f32 v44, v90, v92
    v_mul_f32 v46, v90, v91
    v_mul_f32 v45, v94, v96
    v_mul_f32 v47, v94, v95
    v_pk_mul_f32 v[32:33], v[32:33], s[16:17] op_sel_hi:[1,0]
    v_pk_mul_f32 v[34:35], v[34:35], s[16:17] op_sel_hi:[1,0]
    v_pk_mul_f32 v[90:91], v[46:47], v[46:47]
    v_pk_mul_f32 v[94:95], v[34:35], v[46:47]
    v_pk_mul_f32 v[92:93], v[44:45], v[46:47]
    v_pk_mul_f32 v[96:97], v[34:35], v[44:45]
    v_pk_fma_f32 v[40:41], v[44:45], v[44:45], v[90:91] neg_lo:[0,0,1] neg_hi:[0,0,1]
    v_pk_fma_f32 v[66:67], v[32:33], v[46:47], v[96:97]
    v_pk_add_f32 v[42:43], v[92:93], v[92:93]
    v_pk_fma_f32 v[64:65], v[32:33], v[44:45], v[94:95] neg_lo:[0,0,1] neg_hi:[0,0,1]
    v_pk_mul_f32 v[90:91], v[42:43], v[42:43]
    v_pk_mul_f32 v[92:93], v[40:41], v[42:43]
    v_pk_fma_f32 v[48:49], v[40:41], v[40:41], v[90:91] neg_lo:[0,0,1] neg_hi:[0,0,1]
    v_pk_add_f32 v[50:51], v[92:93], v[92:93]
    v_pk_mul_f32 v[90:91], v[50:51], v[50:51]
    v_pk_mul_f32 v[92:93], v[48:49], v[50:51]
    v_pk_fma_f32 v[48:49], v[48:49], v[48:49], v[90:91] neg_lo:[0,0,1] neg_hi:[0,0,1]
    v_pk_add_f32 v[50:51], v[92:93], v[92:93]
    v_pk_mul_f32 v[90:91], v[34:35], v[50:51]
    v_pk_mul_f32 v[94:95], v[66:67], v[50:51]
    v_pk_mul_f32 v[92:93], v[34:35], v[48:49]
    v_pk_mul_f32 v[96:97], v[66:67], v[48:49]
    v_pk_fma_f32 v[54:55], v[32:33], v[50:51], v[92:93]
    v_pk_fma_f32 v[62:63], v[64:65], v[50:51], v[96:97]
    v_pk_fma_f32 v[52:53], v[32:33], v[48:49], v[90:91] neg_lo:[0,0,1] neg_hi:[0,0,1]
    v_pk_fma_f32 v[60:61], v[64:65], v[48:49], v[94:95] neg_lo:[0,0,1] neg_hi:[0,0,1]
    v_pk_mul_f32 v[90:91], v[54:55], v[42:43]
    v_pk_mul_f32 v[94:95], v[62:63], v[42:43]
    v_pk_mul_f32 v[92:93], v[54:55], v[40:41]
    v_pk_mul_f32 v[96:97], v[62:63], v[40:41]
    v_pk_fma_f32 v[58:59], v[52:53], v[42:43], v[92:93]
    v_pk_fma_f32 v[66:67], v[60:61], v[42:43], v[96:97]
    v_pk_fma_f32 v[56:57], v[52:53], v[40:41], v[90:91] neg_lo:[0,0,1] neg_hi:[0,0,1]
    v_pk_fma_f32 v[64:65], v[60:61], v[40:41], v[94:95] neg_lo:[0,0,1] neg_hi:[0,0,1]
    v_cvt_pk_f16_f32 v98, v52, v54
    v_cvt_pk_f16_f32 v99, v53, v55
    v_cvt_pk_f16_f32 v100, v60, v62
    v_cvt_pk_f16_f32 v101, v61, v63
    ds_write2_b64 v72, v[98:99], v[100:101] offset0:0 offset1:68
    v_pk_mul_f32 v[90:91], v[58:59], v[42:43]
    v_pk_mul_f32 v[94:95], v[66:67], v[42:43]
    v_pk_mul_f32 v[92:93], v[58:59], v[40:41]
    v_pk_mul_f32 v[96:97], v[66:67], v[40:41]
    v_pk_fma_f32 v[54:55], v[56:57], v[42:43], v[92:93]
    v_pk_fma_f32 v[62:63], v[64:65], v[42:43], v[96:97]
    v_pk_fma_f32 v[52:53], v[56:57], v[40:41], v[90:91] neg_lo:[0,0,1] neg_hi:[0,0,1]
    v_pk_fma_f32 v[60:61], v[64:65], v[40:41], v[94:95] neg_lo:[0,0,1] neg_hi:[0,0,1]
    v_cvt_pk_f16_f32 v76, v56, v58
    v_cvt_pk_f16_f32 v77, v57, v59
    v_cvt_pk_f16_f32 v78, v64, v66
    v_cvt_pk_f16_f32 v79, v65, v67
    ds_write2_b64 v72, v[76:77], v[78:79] offset0:136 offset1:204
    v_pk_mul_f32 v[90:91], v[54:55], v[42:43]
    v_pk_mul_f32 v[94:95], v[62:63], v[42:43]
    v_pk_mul_f32 v[92:93], v[54:55], v[40:41]
    v_pk_mul_f32 v[96:97], v[62:63], v[40:41]
    v_pk_fma_f32 v[58:59], v[52:53], v[42:43], v[92:93]
    v_pk_fma_f32 v[66:67], v[60:61], v[42:43], v[96:97]
    v_pk_fma_f32 v[56:57], v[52:53], v[40:41], v[90:91] neg_lo:[0,0,1] neg_hi:[0,0,1]
    v_pk_fma_f32 v[64:65], v[60:61], v[40:41], v[94:95] neg_lo:[0,0,1] neg_hi:[0,0,1]
    v_cvt_pk_f16_f32 v98, v52, v54
    v_cvt_pk_f16_f32 v99, v53, v55
    v_cvt_pk_f16_f32 v100, v60, v62
    v_cvt_pk_f16_f32 v101, v61, v63
    ds_write2_b64 v73, v[98:99], v[100:101] offset0:0 offset1:68
    v_pk_mul_f32 v[90:91], v[58:59], v[42:43]
    v_pk_mul_f32 v[92:93], v[58:59], v[40:41]
    v_pk_fma_f32 v[54:55], v[56:57], v[42:43], v[92:93]
    v_pk_fma_f32 v[52:53], v[56:57], v[40:41], v[90:91] neg_lo:[0,0,1] neg_hi:[0,0,1]
    v_cvt_pk_f16_f32 v76, v56, v58
    v_cvt_pk_f16_f32 v77, v57, v59
    v_cvt_pk_f16_f32 v78, v64, v66
    v_cvt_pk_f16_f32 v79, v65, v67
    ds_write2_b64 v73, v[76:77], v[78:79] offset0:136 offset1:204
    v_cvt_pk_f16_f32 v98, v52, v54
    v_cvt_pk_f16_f32 v99, v53, v55
    v_mov_b32 v36, 0x4538aa3b
    v_mul_f32 v24, s14, v36
    v_max_f32 v24, 0, v24
    v_exp_f32 v24, v24
    ds_write_b64 v74, v[98:99] offset:0
    s_sub_u32 s11, s15, 7
    s_lshl_b32 s11, s11, 23
    v_lshlrev_b32 v25, 16, v107
    v_mul_f32 v24, s11, v24
    v_mov_b32 v106, v24
    ds_write_b64 v14, v[24:25] offset:832
JOBJ_19:
    ds_write_b8 v15, v5 offset:64
    ds_read_b128 v[40:43], v127 offset:0
    ds_read_b128 v[44:47], v127 offset:64
    ds_read_b128 v[48:51], v127 offset:128
    ds_read_b128 v[52:55], v127 offset:192
    ds_read_b128 v[56:59], v127 offset:256
    ds_read_b128 v[60:63], v127 offset:320
    ds_read_b128 v[64:67], v127 offset:384
    ds_read_b128 v[68:71], v127 offset:448
    v_mov_b32 v36, 0x3fb8aa3b
    v_mul_f32 v36, s14, v36
    v_mul_f32 v37, 0x45000000, v36
    v_max_f32 v37, 0, v37
    v_add_f32 v37, 0x41b80000, v37
    v_fma_f32 v110, v110, v36, -v37
    v_fma_f32 v111, v111, v36, -v37
    v_fma_f32 v114, v114, v36, -v37
    v_fma_f32 v115, v115, v36, -v37
    v_exp_f32 v110, v110
    v_exp_f32 v111, v111
    v_exp_f32 v114, v114
    v_exp_f32 v115, v115
W_25:
    ds_read_u8 v17, v14 offset:67
    s_sub_u32 s39, s39, 1
    s_cbranch_scc1 KS_ABORT
    s_waitcnt lgkmcnt(0)
    v_cmp_eq_u32 vcc, 0, v17
    s_cbranch_vccnz W_25
    ds_read_b128 v[72:75], v126 offset:22304
    ds_read_b128 v[76:79], v126 offset:22368
    ds_read_b128 v[80:83], v126 offset:22432
    ds_read_b128 v[84:87], v126 offset:22496
    ds_read_b128 v[88:91], v126 offset:22560
    ds_read_b128 v[92:95], v126 offset:22624
    ds_read_b128 v[96:99], v126 offset:22688
    ds_read_b128 v[100:103], v126 offset:22752
    s_waitcnt lgkmcnt(7)
    v_mfma_f32_16x16x32_f16 v[20:23], v[40:43], v[72:75], 0
    s_waitcnt lgkmcnt(6)
    v_mfma_f32_16x16x32_f16 v[24:27], v[44:47], v[76:79], 0
    s_waitcnt lgkmcnt(5)
    v_mfma_f32_16x16x32_f16 v[20:23], v[48:51], v[80:83], v[20:23]
    s_waitcnt lgkmcnt(4)
    v_mfma_f32_16x16x32_f16 v[24:27], v[52:55], v[84:87], v[24:27]
    s_waitcnt lgkmcnt(3)
    v_mfma_f32_16x16x32_f16 v[20:23], v[56:59], v[88:91], v[20:23]
    s_waitcnt lgkmcnt(2)
    v_mfma_f32_16x16x32_f16 v[24:27], v[60:63], v[92:95], v[24:27]
    s_waitcnt lgkmcnt(1)
    v_mfma_f32_16x16x32_f16 v[20:23], v[64:67], v[96:99], v[20:23]
    s_waitcnt lgkmcnt(0)
    v_mfma_f32_16x16x32_f16 v[24:27], v[68:71], v[100:103], v[24:27]
    s_nop 7
    v_add_f32 v20, v20, v24
    v_add_f32 v21, v21, v25
    v_add_f32 v22, v22, v26
    v_add_f32 v23, v23, v27
    v_mul_f32 v20, v20, v110
    v_mul_f32 v21, v21, v111
    v_mul_f32 v22, v22, v114
    v_mul_f32 v23, v23, v115
    s_cmp_eq_u32 s87, 2
    s_cbranch_scc1 KC_SEND
    v_cvt_f16_f32 v20, v20
    ds_write_b16 v108, v20
    v_cvt_f16_f32 v21, v21
    ds_write_b16 v109, v21
    v_cvt_f16_f32 v22, v22
    ds_write_b16 v112, v22
    v_cvt_f16_f32 v23, v23
    ds_write_b16 v113, v23
EXP_13:
    ds_write_b8 v15, v5 offset:68
    v_mov_b32 v28, 0
    v_mov_b32 v29, 0
    v_mov_b32 v30, 0
    v_mov_b32 v31, 0
    v_mov_b32 v32, s85
    s_waitcnt vmcnt(0)
W_26:
    ds_read_b32 v20, v14 offset:68
    s_sub_u32 s39, s39, 1
    s_cbranch_scc1 KS_ABORT
    s_waitcnt lgkmcnt(0)
    v_cmp_ne_u32 vcc, s84, v20
    s_cbranch_vccnz W_26
    ds_read_u16 v20, v116
    ds_read_u16 v21, v117
    ds_read_u16 v22, v118
    ds_read_u16 v23, v120
    ds_read_u16 v24, v121
    ds_read_u16 v25, v122
    ds_read_u16 v26, v123
    s_mov_b64 exec, 1
    ds_write_b128 v32, v[28:31] offset:3088
    ds_write_b128 v32, v[28:31] offset:8224
    ds_write_b128 v32, v[28:31] offset:3072
    s_mov_b64 exec, -1
    s_waitcnt lgkmcnt(7)
    v_lshl_or_b32 v28, v21, 16, v20
    v_lshl_or_b32 v29, v22, 16, v21
    ds_write_b32 v124, v28 offset:32528
    ds_write_b32 v124, v29 offset:33872
    s_waitcnt lgkmcnt(5)
    v_lshl_or_b32 v30, v24, 16, v23
    v_lshl_or_b32 v31, v26, 16, v25
    ds_write_b32 v119, v30
    ds_write_b32 v125, v31
    ds_write_b8 v15, v5 offset:72
W_27:
    ds_read_b32 v20, v14 offset:72
    s_sub_u32 s39, s39, 1
    s_cbranch_scc1 KS_ABORT
    s_waitcnt lgkmcnt(0)
    v_cmp_ne_u32 vcc, s84, v20
    s_cbranch_vccnz W_27
    ds_read_b64 v[16:17], v14 offset:832
    s_cmp_eq_u32 s86, 1
    s_cbranch_scc1 CV_29
    s_cmp_eq_u32 s86, 2
    s_cbranch_scc1 CV_30
    s_cmp_eq_u32 s86, 3
    s_cbranch_scc1 CV_31
    ds_read2_b32 v[32:33], v6 offset0:144 offset1:145
    ds_read2_b32 v[34:35], v6 offset0:146 offset1:147
    ds_read2_b32 v[36:37], v6 offset0:16 offset1:17
    ds_read2_b32 v[38:39], v6 offset0:18 offset1:19
    ds_read2_b32 v[40:41], v6 offset0:160 offset1:161
    ds_read2_b32 v[42:43], v6 offset0:162 offset1:163
    ds_read2_b32 v[44:45], v6 offset0:32 offset1:33
    ds_read2_b32 v[46:47], v6 offset0:34 offset1:35
    ds_read2_b32 v[48:49], v6 offset0:176 offset1:177
    ds_read2_b32 v[50:51], v6 offset0:178 offset1:179
    ds_read2_b32 v[52:53], v6 offset0:48 offset1:49
    ds_read2_b32 v[54:55], v6 offset0:50 offset1:51
    ds_read2_b32 v[56:57], v6 offset0:192 offset1:193
    ds_read2_b32 v[58:59], v6 offset0:194 offset1:195
    ds_read2_b32 v[60:61], v6 offset0:64 offset1:65
    ds_read2_b32 v[62:63], v6 offset0:66 offset1:67
    ds_read2_b32 v[64:65], v6 offset0:208 offset1:209
    ds_read2_b32 v[66:67], v6 offset0:210 offset1:211
    ds_read2_b32 v[68:69], v6 offset0:80 offset1:81
    ds_read2_b32 v[70:71], v6 offset0:82 offset1:83
    ds_read2_b32 v[72:73], v6 offset0:224 offset1:225
    ds_read2_b32 v[74:75], v6 offset0:226 offset1:227
    ds_read2_b32 v[76:77], v6 offset0:96 offset1:97
    ds_read2_b32 v[78:79], v6 offset0:98 offset1:99
    ds_read2_b32 v[80:81], v6 offset0:240 offset1:241
    ds_read2_b32 v[82:83], v6 offset0:242 offset1:243
    ds_read2_b32 v[84:85], v6 offset0:112 offset1:113
    ds_read2_b32 v[86:87], v6 offset0:114 offset1:115
    ds_read2_b32 v[88:89], v7 offset0:96 offset1:97
    ds_read2_b32 v[90:91], v7 offset0:98 offset1:99
    ds_read2_b32 v[92:93], v6 offset0:128 offset1:129
    ds_read2_b32 v[94:95], v6 offset0:130 offset1:131
    v_lshlrev_b32 v18, 3, v3
    v_sub_u32 v18, v8, v18
    v_lshrrev_b32 v19, 2, v2
    v_lshl_add_u32 v19, v19, 2, v3
    v_and_b32 v28, 3, v2
    v_lshlrev_b32 v28, 4, v28
    v_mul_u32_u24 v19, s8, v19
    v_xor_b32 v19, s10, v19
    s_waitcnt lgkmcnt(0)
    v_mov_b32 v7, v18
    v_add_u32 v6, v19, v28
    v_xor_b32 v12, s9, v12
W_33:
    ds_read_b32 v18, v4 offset:16
    s_sub_u32 s39, s39, 1
    s_cbranch_scc1 KS_ABORT
    s_waitcnt lgkmcnt(0)
    v_cmp_ne_u32 vcc, s84, v18
    s_cbranch_vccnz W_33
    s_setprio 1
    ds_read_b128 v[96:99], v8 offset:0
    ds_read_b128 v[100:103], v8 offset:64
    ds_read_b128 v[104:107], v8 offset:128
    ds_read_b128 v[108:111], v8 offset:192
    s_waitcnt lgkmcnt(3)
    v_mfma_f32_16x16x32_f16 v[20:23], v[32:35], v[96:99], 0
    v_mfma_f32_16x16x32_f16 v[24:27], v[36:39], v[96:99], 0
    ds_read_b128 v[112:115], v8 offset:256
    s_waitcnt lgkmcnt(3)
    v_mfma_f32_16x16x32_f16 v[20:23], v[40:43], v[100:103], v[20:23]
    ds_read_b64 v[28:29], v7 offset:480
    ds_read_b64 v[30:31], v7 offset:992
    v_mfma_f32_16x16x32_f16 v[24:27], v[44:47], v[100:103], v[24:27]
    ds_read_b128 v[116:119], v8 offset:320
    s_waitcnt lgkmcnt(5)
    v_mfma_f32_16x16x32_f16 v[20:23], v[48:51], v[104:107], v[20:23]
    v_mfma_f32_16x16x32_f16 v[24:27], v[52:55], v[104:107], v[24:27]
    ds_read_b128 v[120:123], v8 offset:384
    s_waitcnt lgkmcnt(2)
    v_fma_mix_f32 v104, v28, v17, 0 op_sel_hi:[1,0,0]
    v_fma_mix_f32 v105, v28, v17, 0 op_sel:[1,0,0] op_sel_hi:[1,0,0]
    v_mfma_f32_16x16x32_f16 v[20:23], v[56:59], v[108:111], v[20:23]
    v_fma_mix_f32 v106, v29, v17, 0 op_sel_hi:[1,0,0]
    v_fma_mix_f32 v107, v29, v17, 0 op_sel:[1,0,0] op_sel_hi:[1,0,0]
    v_mfma_f32_16x16x32_f16 v[24:27], v[60:63], v[108:111], v[24:27]
    ds_read_b128 v[124:127], v8 offset:448
    v_cvt_pk_bf16_f32 v104, 0, v104
    v_cvt_pk_bf16_f32 v105, 0, v105
    v_mfma_f32_16x16x32_f16 v[20:23], v[64:67], v[112:115], v[20:23]
    v_cvt_pk_bf16_f32 v106, 0, v106
    v_cvt_pk_bf16_f32 v107, 0, v107
    v_mfma_f32_16x16x32_f16 v[24:27], v[68:71], v[112:115], v[24:27]
    ds_read_b128 v[36:39], v8 offset:512
    v_fma_mix_f32 v112, v30, v17, 0 op_sel_hi:[1,0,0]
    v_fma_mix_f32 v113, v30, v17, 0 op_sel:[1,0,0] op_sel_hi:[1,0,0]
    s_waitcnt lgkmcnt(3)
    v_mfma_f32_16x16x32_f16 v[20:23], v[72:75], v[116:119], v[20:23]
    ds_read_b128 v[96:99], v8 offset:576
    v_fma_mix_f32 v114, v31, v17, 0 op_sel_hi:[1,0,0]
    v_fma_mix_f32 v115, v31, v17, 0 op_sel:[1,0,0] op_sel_hi:[1,0,0]
    v_mfma_f32_16x16x32_f16 v[24:27], v[76:79], v[116:119], v[24:27]
    ds_read_b128 v[44:47], v8 offset:640
    v_cvt_pk_bf16_f32 v112, 0, v112
    v_cvt_pk_bf16_f32 v113, 0, v113
    s_waitcnt lgkmcnt(4)
    v_mfma_f32_16x16x32_f16 v[20:23], v[80:83], v[120:123], v[20:23]
    ds_read_b128 v[100:103], v8 offset:704
    v_cvt_pk_bf16_f32 v114, 0, v114
    v_cvt_pk_bf16_f32 v115, 0, v115
    v_mfma_f32_16x16x32_f16 v[24:27], v[84:87], v[120:123], v[24:27]
    ds_read_b128 v[52:55], v8 offset:768
    s_waitcnt lgkmcnt(5)
    v_mfma_f32_16x16x32_f16 v[20:23], v[88:91], v[124:127], v[20:23]
    ds_read_b128 v[60:63], v8 offset:832
    v_mfma_f32_16x16x32_f16 v[24:27], v[92:95], v[124:127], v[24:27]
    ds_read_b128 v[108:111], v8 offset:896
    s_waitcnt lgkmcnt(6)
    v_mfma_f32_16x16x32_f16 v[24:27], v[32:35], v[36:39], v[24:27]
    ds_read_b128 v[68:71], v8 offset:960
    s_nop 1
    v_mul_f32 v20, v20, v16
    v_mul_f32 v21, v21, v16
    s_waitcnt lgkmcnt(6)
    v_mfma_f32_16x16x32_f16 v[24:27], v[40:43], v[96:99], v[24:27]
    v_mul_f32 v22, v22, v16
    v_mul_f32 v23, v23, v16
    s_waitcnt lgkmcnt(5)
    v_mfma_f32_16x16x32_f16 v[24:27], v[48:51], v[44:47], v[24:27]
    v_cvt_pk_bf16_f32 v20, 0, v20
    v_cvt_pk_bf16_f32 v21, 0, v21
    s_waitcnt lgkmcnt(4)
    v_mfma_f32_16x16x32_f16 v[24:27], v[56:59], v[100:103], v[24:27]
    v_cvt_pk_bf16_f32 v22, 0, v22
    v_cvt_pk_bf16_f32 v23, 0, v23
    s_waitcnt lgkmcnt(3)
    v_mfma_f32_16x16x32_f16 v[24:27], v[64:67], v[52:55], v[24:27]
    v_add_f32 v20, v20, v104
    v_add_f32 v21, v21, v105
    s_waitcnt lgkmcnt(2)
    v_mfma_f32_16x16x32_f16 v[24:27], v[72:75], v[60:63], v[24:27]
    v_add_f32 v22, v22, v106
    v_add_f32 v23, v23, v107
    s_waitcnt lgkmcnt(1)
    v_mfma_f32_16x16x32_f16 v[24:27], v[80:83], v[108:111], v[24:27]
    v_cvt_pk_bf16_f32 v28, v20, v21
    v_cvt_pk_bf16_f32 v29, v22, v23
    s_waitcnt lgkmcnt(0)
    v_mfma_f32_16x16x32_f16 v[24:27], v[88:91], v[68:71], v[24:27]
    v_min_u32 v28, -2, v28
    v_min_u32 v29, -2, v29
    ds_read_u8 v18, v4 offset:160
    ds_read_b128 v[20:23], v12 offset:46592
    s_nop 3
    v_mul_f32 v24, v24, v16
    v_mul_f32 v25, v25, v16
    v_mul_f32 v26, v26, v16
    v_mul_f32 v27, v27, v16
    v_cvt_pk_bf16_f32 v24, 0, v24
    v_cvt_pk_bf16_f32 v25, 0, v25
    v_cvt_pk_bf16_f32 v26, 0, v26
    v_cvt_pk_bf16_f32 v27, 0, v27
    v_add_f32 v24, v24, v112
    v_add_f32 v25, v25, v113
    v_add_f32 v26, v26, v114
    v_add_f32 v27, v27, v115
    v_cvt_pk_bf16_f32 v30, v24, v25
    v_cvt_pk_bf16_f32 v31, v26, v27
    v_min_u32 v30, -2, v30
    v_min_u32 v31, -2, v31
    s_branch CVE_32
CV_29:
    ds_read2_b32 v[32:33], v6 offset0:0 offset1:1
    ds_read2_b32 v[34:35], v6 offset0:2 offset1:3
    ds_read2_b32 v[36:37], v6 offset0:16 offset1:17
    ds_read2_b32 v[38:39], v6 offset0:18 offset1:19
    ds_read2_b32 v[40:41], v6 offset0:32 offset1:33
    ds_read2_b32 v[42:43], v6 offset0:34 offset1:35
    ds_read2_b32 v[44:45], v6 offset0:48 offset1:49
    ds_read2_b32 v[46:47], v6 offset0:50 offset1:51
    ds_read2_b32 v[48:49], v6 offset0:64 offset1:65
    ds_read2_b32 v[50:51], v6 offset0:66 offset1:67
    ds_read2_b32 v[52:53], v6 offset0:80 offset1:81
    ds_read2_b32 v[54:55], v6 offset0:82 offset1:83
    ds_read2_b32 v[56:57], v6 offset0:96 offset1:97
    ds_read2_b32 v[58:59], v6 offset0:98 offset1:99
    ds_read2_b32 v[60:61], v6 offset0:112 offset1:113
    ds_read2_b32 v[62:63], v6 offset0:114 offset1:115
    ds_read2_b32 v[64:65], v6 offset0:128 offset1:129
    ds_read2_b32 v[66:67], v6 offset0:130 offset1:131
    ds_read2_b32 v[68:69], v6 offset0:144 offset1:145
    ds_read2_b32 v[70:71], v6 offset0:146 offset1:147
    ds_read2_b32 v[72:73], v6 offset0:160 offset1:161
    ds_read2_b32 v[74:75], v6 offset0:162 offset1:163
    ds_read2_b32 v[76:77], v6 offset0:176 offset1:177
    ds_read2_b32 v[78:79], v6 offset0:178 offset1:179
    ds_read2_b32 v[80:81], v6 offset0:192 offset1:193
    ds_read2_b32 v[82:83], v6 offset0:194 offset1:195
    ds_read2_b32 v[84:85], v6 offset0:208 offset1:209
    ds_read2_b32 v[86:87], v6 offset0:210 offset1:211
    ds_read2_b32 v[88:89], v6 offset0:224 offset1:225
    ds_read2_b32 v[90:91], v6 offset0:226 offset1:227
    ds_read2_b32 v[92:93], v6 offset0:240 offset1:241
    ds_read2_b32 v[94:95], v6 offset0:242 offset1:243
    ds_read2_b32 v[96:97], v7 offset0:96 offset1:97
    ds_read2_b32 v[98:99], v7 offset0:98 offset1:99
    ds_read2_b32 v[100:101], v11 offset0:32 offset1:33
    ds_read2_b32 v[102:103], v11 offset0:34 offset1:35
    ds_read2_b32 v[104:105], v11 offset0:96 offset1:97
    ds_read2_b32 v[106:107], v11 offset0:98 offset1:99
    v_lshlrev_b32 v18, 3, v3
    v_sub_u32 v18, v8, v18
    v_lshrrev_b32 v19, 2, v2
    v_lshl_add_u32 v19, v19, 2, v3
    v_and_b32 v28, 3, v2
    v_lshlrev_b32 v28, 4, v28
    v_mul_u32_u24 v19, s8, v19
    v_xor_b32 v19, s10, v19
    s_waitcnt lgkmcnt(0)
    v_mov_b32 v7, v18
    v_add_u32 v6, v19, v28
    v_xor_b32 v12, s9, v12
W_34:
    ds_read_b32 v18, v4 offset:16
    s_sub_u32 s39, s39, 1
    s_cbranch_scc1 KS_ABORT
    s_waitcnt lgkmcnt(0)
    v_cmp_ne_u32 vcc, s84, v18
    s_cbranch_vccnz W_34
    s_setprio 1
    ds_read_b128 v[108:111], v8 offset:448
    ds_read_b128 v[112:115], v8 offset:512
    ds_read_b128 v[116:119], v8 offset:576
    ds_read_b128 v[120:123], v8 offset:640
    ds_read_b128 v[124:127], v8 offset:704
    s_waitcnt lgkmcnt(4)
    v_mfma_f32_16x16x32_f16 v[20:23], v[32:35], v[108:111], 0
    ds_read_b128 v[108:111], v8 offset:768
    s_waitcnt lgkmcnt(4)
    v_mfma_f32_16x16x32_f16 v[20:23], v[36:39], v[112:115], v[20:23]
    ds_read_b128 v[112:115], v8 offset:832
    s_waitcnt lgkmcnt(4)
    v_mfma_f32_16x16x32_f16 v[20:23], v[40:43], v[116:119], v[20:23]
    ds_read_b128 v[116:119], v8 offset:896
    ds_read_b64 v[28:29], v7 offset:1504
    ds_read_b64 v[30:31], v7 offset:2016
    s_waitcnt lgkmcnt(6)
    v_mfma_f32_16x16x32_f16 v[20:23], v[44:47], v[120:123], v[20:23]
    ds_read_b128 v[120:123], v8 offset:960
    s_waitcnt lgkmcnt(6)
    v_mfma_f32_16x16x32_f16 v[20:23], v[48:51], v[124:127], v[20:23]
    ds_read_b128 v[124:127], v8 offset:1024
    s_waitcnt lgkmcnt(6)
    v_mfma_f32_16x16x32_f16 v[20:23], v[52:55], v[108:111], v[20:23]
    ds_read_b128 v[108:111], v8 offset:1088
    s_waitcnt lgkmcnt(6)
    v_mfma_f32_16x16x32_f16 v[20:23], v[56:59], v[112:115], v[20:23]
    s_waitcnt lgkmcnt(5)
    v_mfma_f32_16x16x32_f16 v[20:23], v[60:63], v[116:119], v[20:23]
    ds_read_b128 v[112:115], v8 offset:1152
    s_waitcnt lgkmcnt(3)
    v_mfma_f32_16x16x32_f16 v[20:23], v[64:67], v[120:123], v[20:23]
    v_mfma_f32_16x16x32_f16 v[24:27], v[32:35], v[120:123], 0
    ds_read_b128 v[116:119], v8 offset:1216
    v_fma_mix_f32 v120, v28, v17, 0 op_sel_hi:[1,0,0]
    v_fma_mix_f32 v121, v28, v17, 0 op_sel:[1,0,0] op_sel_hi:[1,0,0]
    s_waitcnt lgkmcnt(3)
    v_mfma_f32_16x16x32_f16 v[20:23], v[68:71], v[124:127], v[20:23]
    v_fma_mix_f32 v122, v29, v17, 0 op_sel_hi:[1,0,0]
    v_fma_mix_f32 v123, v29, v17, 0 op_sel:[1,0,0] op_sel_hi:[1,0,0]
    v_mfma_f32_16x16x32_f16 v[24:27], v[36:39], v[124:127], v[24:27]
    ds_read_b128 v[32:35], v8 offset:1280
    v_cvt_pk_bf16_f32 v120, 0, v120
    v_cvt_pk_bf16_f32 v121, 0, v121
    s_waitcnt lgkmcnt(3)
    v_mfma_f32_16x16x32_f16 v[20:23], v[72:75], v[108:111], v[20:23]
    v_cvt_pk_bf16_f32 v122, 0, v122
    v_cvt_pk_bf16_f32 v123, 0, v123
    v_mfma_f32_16x16x32_f16 v[24:27], v[40:43], v[108:111], v[24:27]
    ds_read_b128 v[36:39], v8 offset:1344
    v_fma_mix_f32 v108, v30, v17, 0 op_sel_hi:[1,0,0]
    v_fma_mix_f32 v109, v30, v17, 0 op_sel:[1,0,0] op_sel_hi:[1,0,0]
    s_waitcnt lgkmcnt(3)
    v_mfma_f32_16x16x32_f16 v[20:23], v[76:79], v[112:115], v[20:23]
    v_fma_mix_f32 v110, v31, v17, 0 op_sel_hi:[1,0,0]
    v_fma_mix_f32 v111, v31, v17, 0 op_sel:[1,0,0] op_sel_hi:[1,0,0]
    v_mfma_f32_16x16x32_f16 v[24:27], v[44:47], v[112:115], v[24:27]
    ds_read_b128 v[124:127], v8 offset:1408
    v_cvt_pk_bf16_f32 v108, 0, v108
    v_cvt_pk_bf16_f32 v109, 0, v109
    s_waitcnt lgkmcnt(3)
    v_mfma_f32_16x16x32_f16 v[20:23], v[80:83], v[116:119], v[20:23]
    v_cvt_pk_bf16_f32 v110, 0, v110
    v_cvt_pk_bf16_f32 v111, 0, v111
    v_mfma_f32_16x16x32_f16 v[24:27], v[48:51], v[116:119], v[24:27]
    ds_read_b128 v[40:43], v8 offset:1472
    s_waitcnt lgkmcnt(3)
    v_mfma_f32_16x16x32_f16 v[20:23], v[84:87], v[32:35], v[20:23]
    v_mfma_f32_16x16x32_f16 v[24:27], v[52:55], v[32:35], v[24:27]
    ds_read_b128 v[44:47], v8 offset:1536
    s_waitcnt lgkmcnt(3)
    v_mfma_f32_16x16x32_f16 v[20:23], v[88:91], v[36:39], v[20:23]
    ds_read_b128 v[112:115], v8 offset:1600
    v_mfma_f32_16x16x32_f16 v[24:27], v[56:59], v[36:39], v[24:27]
    ds_read_b128 v[48:51], v8 offset:1664
    s_waitcnt lgkmcnt(4)
    v_mfma_f32_16x16x32_f16 v[20:23], v[92:95], v[124:127], v[20:23]
    ds_read_b128 v[116:119], v8 offset:1728
    v_mfma_f32_16x16x32_f16 v[24:27], v[60:63], v[124:127], v[24:27]
    ds_read_b128 v[52:55], v8 offset:1792
    s_waitcnt lgkmcnt(5)
    v_mfma_f32_16x16x32_f16 v[20:23], v[96:99], v[40:43], v[20:23]
    ds_read_b128 v[32:35], v8 offset:1856
    v_mfma_f32_16x16x32_f16 v[24:27], v[64:67], v[40:43], v[24:27]
    ds_read_b32 v18, v14 offset:76
    ds_read_b128 v[56:59], v8 offset:1920
    s_waitcnt lgkmcnt(7)
    v_mfma_f32_16x16x32_f16 v[24:27], v[68:71], v[44:47], v[24:27]
    ds_read_b128 v[36:39], v8 offset:1984
    s_waitcnt lgkmcnt(7)
    v_mfma_f32_16x16x32_f16 v[24:27], v[72:75], v[112:115], v[24:27]
    ds_read2_b32 v[60:61], v11 offset0:16 offset1:17
    ds_read2_b32 v[62:63], v11 offset0:18 offset1:19
    s_waitcnt lgkmcnt(8)
    v_mfma_f32_16x16x32_f16 v[24:27], v[76:79], v[48:51], v[24:27]
    s_waitcnt lgkmcnt(4)
    v_cmp_ne_u32 vcc, s84, v18
    s_cbranch_vccnz WS_35
WB_36:
    ds_read_b64_tr_b16 v[124:125], v9 offset:0
    ds_read_b64_tr_b16 v[126:127], v9 offset:64
    ds_read_b64_tr_b16 v[64:65], v9 offset:3088
    ds_read_b64_tr_b16 v[66:67], v9 offset:3152
    v_mfma_f32_16x16x32_f16 v[24:27], v[80:83], v[116:119], v[24:27]
    v_mfma_f32_16x16x32_f16 v[24:27], v[84:87], v[52:55], v[24:27]
    ds_read_b64_tr_b16 v[40:41], v9 offset:512
    ds_read_b64_tr_b16 v[42:43], v9 offset:576
    ds_read2_b32 v[68:69], v11 offset0:80 offset1:81
    ds_read2_b32 v[70:71], v11 offset0:82 offset1:83
    v_mfma_f32_16x16x32_f16 v[24:27], v[88:91], v[32:35], v[24:27]
    s_waitcnt lgkmcnt(11)
    v_mfma_f32_16x16x32_f16 v[24:27], v[92:95], v[56:59], v[24:27]
    ds_read_b64_tr_b16 v[44:45], v9 offset:3600
    ds_read_b64_tr_b16 v[46:47], v9 offset:3664
    s_waitcnt lgkmcnt(12)
    v_mfma_f32_16x16x32_f16 v[24:27], v[96:99], v[36:39], v[24:27]
    s_waitcnt lgkmcnt(8)
    v_mfma_f32_16x16x32_f16 v[20:23], v[124:127], v[100:103], v[20:23]
    s_waitcnt lgkmcnt(6)
    v_mfma_f32_16x16x32_f16 v[20:23], v[64:67], v[104:107], v[20:23]
    v_mfma_f32_16x16x32_f16 v[24:27], v[124:127], v[60:63], v[24:27]
    s_waitcnt lgkmcnt(4)
    v_mfma_f32_16x16x32_f16 v[24:27], v[40:43], v[100:103], v[24:27]
    s_nop 4
    v_mul_f32 v20, v20, v16
    v_mul_f32 v21, v21, v16
    s_waitcnt lgkmcnt(2)
    v_mfma_f32_16x16x32_f16 v[24:27], v[64:67], v[68:71], v[24:27]
    v_mul_f32 v22, v22, v16
    v_mul_f32 v23, v23, v16
    s_waitcnt lgkmcnt(0)
    v_mfma_f32_16x16x32_f16 v[24:27], v[44:47], v[104:107], v[24:27]
    v_cvt_pk_bf16_f32 v20, 0, v20
    v_cvt_pk_bf16_f32 v21, 0, v21
    v_cvt_pk_bf16_f32 v22, 0, v22
    v_cvt_pk_bf16_f32 v23, 0, v23
    v_add_f32 v20, v20, v120
    v_add_f32 v21, v21, v121
    v_add_f32 v22, v22, v122
    v_add_f32 v23, v23, v123
    v_cvt_pk_bf16_f32 v28, v20, v21
    v_cvt_pk_bf16_f32 v29, v22, v23
    v_min_u32 v28, -2, v28
    v_min_u32 v29, -2, v29
    ds_read_u8 v18, v4 offset:161
    ds_read_b128 v[20:23], v12 offset:47616
    v_mul_f32 v24, v24, v16
    v_mul_f32 v25, v25, v16
    v_mul_f32 v26, v26, v16
    v_mul_f32 v27, v27, v16
    v_cvt_pk_bf16_f32 v24, 0, v24
    v_cvt_pk_bf16_f32 v25, 0, v25
    v_cvt_pk_bf16_f32 v26, 0, v26
    v_cvt_pk_bf16_f32 v27, 0, v27
    v_add_f32 v24, v24, v108
    v_add_f32 v25, v25, v109
    v_add_f32 v26, v26, v110
    v_add_f32 v27, v27, v111
    v_cvt_pk_bf16_f32 v30, v24, v25
    v_cvt_pk_bf16_f32 v31, v26, v27
    v_min_u32 v30, -2, v30
    v_min_u32 v31, -2, v31
    s_branch CVE_32
CV_30:
    ds_read2_b32 v[32:33], v7 offset0:128 offset1:129
    ds_read2_b32 v[34:35], v7 offset0:130 offset1:131
    ds_read2_b32 v[36:37], v6 offset0:0 offset1:1
    ds_read2_b32 v[38:39], v6 offset0:2 offset1:3
    ds_read2_b32 v[40:41], v6 offset0:16 offset1:17
    ds_read2_b32 v[42:43], v6 offset0:18 offset1:19
    ds_read2_b32 v[44:45], v6 offset0:32 offset1:33
    ds_read2_b32 v[46:47], v6 offset0:34 offset1:35
    ds_read2_b32 v[48:49], v6 offset0:48 offset1:49
    ds_read2_b32 v[50:51], v6 offset0:50 offset1:51
    ds_read2_b32 v[52:53], v6 offset0:64 offset1:65
    ds_read2_b32 v[54:55], v6 offset0:66 offset1:67
    ds_read2_b32 v[56:57], v6 offset0:80 offset1:81
    ds_read2_b32 v[58:59], v6 offset0:82 offset1:83
    ds_read2_b32 v[60:61], v6 offset0:96 offset1:97
    ds_read2_b32 v[62:63], v6 offset0:98 offset1:99
    ds_read2_b32 v[64:65], v6 offset0:112 offset1:113
    ds_read2_b32 v[66:67], v6 offset0:114 offset1:115
    ds_read2_b32 v[68:69], v6 offset0:128 offset1:129
    ds_read2_b32 v[70:71], v6 offset0:130 offset1:131
    ds_read2_b32 v[72:73], v6 offset0:144 offset1:145
    ds_read2_b32 v[74:75], v6 offset0:146 offset1:147
    ds_read2_b32 v[76:77], v6 offset0:160 offset1:161
    ds_read2_b32 v[78:79], v6 offset0:162 offset1:163
    ds_read2_b32 v[80:81], v6 offset0:176 offset1:177
    ds_read2_b32 v[82:83], v6 offset0:178 offset1:179
    ds_read2_b32 v[84:85], v6 offset0:192 offset1:193
    ds_read2_b32 v[86:87], v6 offset0:194 offset1:195
    ds_read2_b32 v[88:89], v6 offset0:208 offset1:209
    ds_read2_b32 v[90:91], v6 offset0:210 offset1:211
    ds_read2_b32 v[92:93], v6 offset0:224 offset1:225
    ds_read2_b32 v[94:95], v6 offset0:226 offset1:227
    ds_read2_b32 v[96:97], v6 offset0:240 offset1:241
    ds_read2_b32 v[98:99], v6 offset0:242 offset1:243
    ds_read2_b32 v[100:101], v7 offset0:96 offset1:97
    ds_read2_b32 v[102:103], v7 offset0:98 offset1:99
    ds_read2_b32 v[104:105], v11 offset0:0 offset1:1
    ds_read2_b32 v[106:107], v11 offset0:2 offset1:3
    v_lshlrev_b32 v18, 3, v3
    v_sub_u32 v18, v8, v18
    v_lshrrev_b32 v19, 2, v2
    v_lshl_add_u32 v19, v19, 2, v3
    v_and_b32 v28, 3, v2
    v_lshlrev_b32 v28, 4, v28
    v_mul_u32_u24 v19, s8, v19
    v_xor_b32 v19, s10, v19
    s_waitcnt lgkmcnt(0)
    v_mov_b32 v7, v18
    v_add_u32 v6, v19, v28
    v_xor_b32 v12, s9, v12
W_37:
    ds_read_b32 v18, v4 offset:16
    s_sub_u32 s39, s39, 1
    s_cbranch_scc1 KS_ABORT
    s_waitcnt lgkmcnt(0)
    v_cmp_ne_u32 vcc, s84, v18
    s_cbranch_vccnz W_37
    s_setprio 1
    ds_read_b128 v[108:111], v8 offset:448
    ds_read_b128 v[112:115], v8 offset:960
    ds_read_b128 v[116:119], v8 offset:1472
    ds_read_b128 v[120:123], v8 offset:1536
    ds_read_b128 v[124:127], v8 offset:1600
    s_waitcnt lgkmcnt(4)
    v_mfma_f32_16x16x32_f16 v[20:23], v[32:35], v[108:111], 0
    ds_read_b128 v[108:111], v8 offset:1664
    s_waitcnt lgkmcnt(4)
    v_mfma_f32_16x16x32_f16 v[24:27], v[32:35], v[112:115], 0
    ds_read_b128 v[32:35], v8 offset:1728
    ds_read_b128 v[112:115], v8 offset:1792
    s_waitcnt lgkmcnt(5)
    v_mfma_f32_16x16x32_f16 v[20:23], v[36:39], v[116:119], v[20:23]
    ds_read_b128 v[116:119], v8 offset:1856
    ds_read_b64 v[28:29], v7 offset:2528
    ds_read_b64 v[30:31], v7 offset:3040
    s_waitcnt lgkmcnt(7)
    v_mfma_f32_16x16x32_f16 v[20:23], v[40:43], v[120:123], v[20:23]
    ds_read_b128 v[120:123], v8 offset:1920
    s_waitcnt lgkmcnt(7)
    v_mfma_f32_16x16x32_f16 v[20:23], v[44:47], v[124:127], v[20:23]
    ds_read_b128 v[124:127], v8 offset:1984
    s_waitcnt lgkmcnt(7)
    v_mfma_f32_16x16x32_f16 v[20:23], v[48:51], v[108:111], v[20:23]
    ds_read_b128 v[108:111], v8 offset:2048
    s_waitcnt lgkmcnt(7)
    v_mfma_f32_16x16x32_f16 v[20:23], v[52:55], v[32:35], v[20:23]
    s_waitcnt lgkmcnt(6)
    v_mfma_f32_16x16x32_f16 v[20:23], v[56:59], v[112:115], v[20:23]
    ds_read_b128 v[32:35], v8 offset:2112
    s_waitcnt lgkmcnt(6)
    v_mfma_f32_16x16x32_f16 v[20:23], v[60:63], v[116:119], v[20:23]
    s_waitcnt lgkmcnt(4)
    v_fma_mix_f32 v116, v28, v17, 0 op_sel_hi:[1,0,0]
    v_fma_mix_f32 v117, v28, v17, 0 op_sel:[1,0,0] op_sel_hi:[1,0,0]
    s_waitcnt lgkmcnt(3)
    v_mfma_f32_16x16x32_f16 v[20:23], v[64:67], v[120:123], v[20:23]
    ds_read_b128 v[112:115], v8 offset:2176
    v_fma_mix_f32 v118, v29, v17, 0 op_sel_hi:[1,0,0]
    v_fma_mix_f32 v119, v29, v17, 0 op_sel:[1,0,0] op_sel_hi:[1,0,0]
    s_waitcnt lgkmcnt(3)
    v_mfma_f32_16x16x32_f16 v[20:23], v[68:71], v[124:127], v[20:23]
    v_cvt_pk_bf16_f32 v116, 0, v116
    v_cvt_pk_bf16_f32 v117, 0, v117
    v_mfma_f32_16x16x32_f16 v[24:27], v[36:39], v[124:127], v[24:27]
    ds_read_b128 v[120:123], v8 offset:2240
    v_cvt_pk_bf16_f32 v118, 0, v118
    v_cvt_pk_bf16_f32 v119, 0, v119
    s_waitcnt lgkmcnt(3)
    v_mfma_f32_16x16x32_f16 v[20:23], v[72:75], v[108:111], v[20:23]
    v_fma_mix_f32 v124, v30, v17, 0 op_sel_hi:[1,0,0]
    v_fma_mix_f32 v125, v30, v17, 0 op_sel:[1,0,0] op_sel_hi:[1,0,0]
    v_mfma_f32_16x16x32_f16 v[24:27], v[40:43], v[108:111], v[24:27]
    ds_read_b128 v[36:39], v8 offset:2304
    v_fma_mix_f32 v126, v31, v17, 0 op_sel_hi:[1,0,0]
    v_fma_mix_f32 v127, v31, v17, 0 op_sel:[1,0,0] op_sel_hi:[1,0,0]
    s_waitcnt lgkmcnt(3)
    v_mfma_f32_16x16x32_f16 v[20:23], v[76:79], v[32:35], v[20:23]
    v_cvt_pk_bf16_f32 v124, 0, v124
    v_cvt_pk_bf16_f32 v125, 0, v125
    v_mfma_f32_16x16x32_f16 v[24:27], v[44:47], v[32:35], v[24:27]
    ds_read_b128 v[40:43], v8 offset:2368
    v_cvt_pk_bf16_f32 v126, 0, v126
    v_cvt_pk_bf16_f32 v127, 0, v127
    s_waitcnt lgkmcnt(3)
    v_mfma_f32_16x16x32_f16 v[20:23], v[80:83], v[112:115], v[20:23]
    v_mfma_f32_16x16x32_f16 v[24:27], v[48:51], v[112:115], v[24:27]
    ds_read_b128 v[108:111], v8 offset:2432
    s_waitcnt lgkmcnt(3)
    v_mfma_f32_16x16x32_f16 v[20:23], v[84:87], v[120:123], v[20:23]
    v_mfma_f32_16x16x32_f16 v[24:27], v[52:55], v[120:123], v[24:27]
    ds_read_b128 v[44:47], v8 offset:2496
    s_waitcnt lgkmcnt(3)
    v_mfma_f32_16x16x32_f16 v[20:23], v[88:91], v[36:39], v[20:23]
    v_mfma_f32_16x16x32_f16 v[24:27], v[56:59], v[36:39], v[24:27]
    ds_read_b128 v[32:35], v8 offset:2560
    s_waitcnt lgkmcnt(3)
    v_mfma_f32_16x16x32_f16 v[20:23], v[92:95], v[40:43], v[20:23]
    ds_read_b128 v[48:51], v8 offset:2624
    v_mfma_f32_16x16x32_f16 v[24:27], v[60:63], v[40:43], v[24:27]
    ds_read_b128 v[112:115], v8 offset:2688
    s_waitcnt lgkmcnt(4)
    v_mfma_f32_16x16x32_f16 v[20:23], v[96:99], v[108:111], v[20:23]
    ds_read_b128 v[52:55], v8 offset:2752
    v_mfma_f32_16x16x32_f16 v[24:27], v[64:67], v[108:111], v[24:27]
    ds_read_b128 v[120:123], v8 offset:2816
    s_waitcnt lgkmcnt(5)
    v_mfma_f32_16x16x32_f16 v[20:23], v[100:103], v[44:47], v[20:23]
    ds_read_b128 v[56:59], v8 offset:2880
    v_mfma_f32_16x16x32_f16 v[24:27], v[68:71], v[44:47], v[24:27]
    ds_read_b32 v18, v14 offset:76
    ds_read_b128 v[36:39], v8 offset:2944
    s_waitcnt lgkmcnt(7)
    v_mfma_f32_16x16x32_f16 v[24:27], v[72:75], v[32:35], v[24:27]
    ds_read_b128 v[60:63], v8 offset:3008
    s_waitcnt lgkmcnt(7)
    v_mfma_f32_16x16x32_f16 v[24:27], v[76:79], v[48:51], v[24:27]
    ds_read2_b32 v[40:41], v11 offset0:16 offset1:17
    ds_read2_b32 v[42:43], v11 offset0:18 offset1:19
    ds_read2_b32 v[64:65], v11 offset0:32 offset1:33
    ds_read2_b32 v[66:67], v11 offset0:34 offset1:35
    s_waitcnt lgkmcnt(10)
    v_mfma_f32_16x16x32_f16 v[24:27], v[80:83], v[112:115], v[24:27]
    s_waitcnt lgkmcnt(6)
    v_cmp_ne_u32 vcc, s84, v18
    s_cbranch_vccnz WS_38
WB_39:
    ds_read_b64_tr_b16 v[108:109], v9 offset:0
    ds_read_b64_tr_b16 v[110:111], v9 offset:64
    ds_read_b64_tr_b16 v[68:69], v9 offset:512
    ds_read_b64_tr_b16 v[70:71], v9 offset:576
    v_mfma_f32_16x16x32_f16 v[24:27], v[84:87], v[52:55], v[24:27]
    ds_read_b64_tr_b16 v[44:45], v9 offset:1024
    ds_read_b64_tr_b16 v[46:47], v9 offset:1088
    v_mfma_f32_16x16x32_f16 v[24:27], v[88:91], v[120:123], v[24:27]
    ds_read_b64_tr_b16 v[72:73], v9 offset:3088
    ds_read_b64_tr_b16 v[74:75], v9 offset:3152
    ds_read2_b32 v[32:33], v11 offset0:64 offset1:65
    ds_read2_b32 v[34:35], v11 offset0:66 offset1:67
    v_mfma_f32_16x16x32_f16 v[24:27], v[92:95], v[56:59], v[24:27]
    ds_read_b64_tr_b16 v[76:77], v9 offset:3600
    ds_read_b64_tr_b16 v[78:79], v9 offset:3664
    ds_read2_b32 v[48:49], v11 offset0:80 offset1:81
    ds_read2_b32 v[50:51], v11 offset0:82 offset1:83
    v_mfma_f32_16x16x32_f16 v[24:27], v[96:99], v[36:39], v[24:27]
    ds_read_b64_tr_b16 v[80:81], v9 offset:4112
    ds_read_b64_tr_b16 v[82:83], v9 offset:4176
    ds_read2_b32 v[112:113], v11 offset0:96 offset1:97
    ds_read2_b32 v[114:115], v11 offset0:98 offset1:99
    v_mfma_f32_16x16x32_f16 v[24:27], v[100:103], v[60:63], v[24:27]
    ds_read_b64_tr_b16 v[84:85], v10 offset:6176
    ds_read_b64_tr_b16 v[86:87], v10 offset:6304
    ds_read2_b32 v[52:53], v13 offset0:24 offset1:25
    ds_read2_b32 v[54:55], v13 offset0:26 offset1:27
    v_mfma_f32_16x16x32_f16 v[20:23], v[108:111], v[104:107], v[20:23]
    ds_read_b64_tr_b16 v[88:89], v10 offset:8224
    ds_read_b64_tr_b16 v[90:91], v10 offset:8352
    ds_read2_b32 v[120:121], v13 offset0:120 offset1:121
    ds_read2_b32 v[122:123], v13 offset0:122 offset1:123
    v_mfma_f32_16x16x32_f16 v[20:23], v[68:71], v[40:43], v[20:23]
    v_mfma_f32_16x16x32_f16 v[20:23], v[44:47], v[64:67], v[20:23]
    v_mfma_f32_16x16x32_f16 v[20:23], v[72:75], v[32:35], v[20:23]
    ds_read_b64_tr_b16 v[92:93], v9 offset:1536
    ds_read_b64_tr_b16 v[94:95], v9 offset:1600
    s_waitcnt lgkmcnt(14)
    v_mfma_f32_16x16x32_f16 v[20:23], v[76:79], v[48:51], v[20:23]
    s_waitcnt lgkmcnt(10)
    v_mfma_f32_16x16x32_f16 v[20:23], v[80:83], v[112:115], v[20:23]
    s_waitcnt lgkmcnt(6)
    v_mfma_f32_16x16x32_f16 v[20:23], v[84:87], v[52:55], v[20:23]
    ds_read_b64_tr_b16 v[56:57], v9 offset:4624
    ds_read_b64_tr_b16 v[58:59], v9 offset:4688
    ds_read2_b32 v[96:97], v13 offset0:16 offset1:17
    ds_read2_b32 v[98:99], v13 offset0:18 offset1:19
    s_waitcnt lgkmcnt(6)
    v_mfma_f32_16x16x32_f16 v[20:23], v[88:91], v[120:123], v[20:23]
    ds_read2_b32 v[36:37], v13 offset0:112 offset1:113
    ds_read2_b32 v[38:39], v13 offset0:114 offset1:115
    v_mfma_f32_16x16x32_f16 v[24:27], v[68:71], v[104:107], v[24:27]
    v_mfma_f32_16x16x32_f16 v[24:27], v[44:47], v[40:43], v[24:27]
    s_nop 3
    v_mul_f32 v20, v20, v16
    v_mul_f32 v21, v21, v16
    s_waitcnt lgkmcnt(6)
    v_mfma_f32_16x16x32_f16 v[24:27], v[92:95], v[64:67], v[24:27]
    v_mul_f32 v22, v22, v16
    v_mul_f32 v23, v23, v16
    v_mfma_f32_16x16x32_f16 v[24:27], v[76:79], v[32:35], v[24:27]
    v_cvt_pk_bf16_f32 v20, 0, v20
    v_cvt_pk_bf16_f32 v21, 0, v21
    v_mfma_f32_16x16x32_f16 v[24:27], v[80:83], v[48:51], v[24:27]
    v_cvt_pk_bf16_f32 v22, 0, v22
    v_cvt_pk_bf16_f32 v23, 0, v23
    s_waitcnt lgkmcnt(4)
    v_mfma_f32_16x16x32_f16 v[24:27], v[56:59], v[112:115], v[24:27]
    v_add_f32 v20, v20, v116
    v_add_f32 v21, v21, v117
    s_waitcnt lgkmcnt(2)
    v_mfma_f32_16x16x32_f16 v[24:27], v[84:87], v[96:99], v[24:27]
    v_add_f32 v22, v22, v118
    v_add_f32 v23, v23, v119
    s_waitcnt lgkmcnt(0)
    v_mfma_f32_16x16x32_f16 v[24:27], v[88:91], v[36:39], v[24:27]
    v_cvt_pk_bf16_f32 v28, v20, v21
    v_cvt_pk_bf16_f32 v29, v22, v23
    v_min_u32 v28, -2, v28
    v_min_u32 v29, -2, v29
    ds_read_u8 v18, v4 offset:162
    ds_read_b128 v[20:23], v12 offset:48640
    s_nop 1
    v_mul_f32 v24, v24, v16
    v_mul_f32 v25, v25, v16
    v_mul_f32 v26, v26, v16
    v_mul_f32 v27, v27, v16
    v_cvt_pk_bf16_f32 v24, 0, v24
    v_cvt_pk_bf16_f32 v25, 0, v25
    v_cvt_pk_bf16_f32 v26, 0, v26
    v_cvt_pk_bf16_f32 v27, 0, v27
    v_add_f32 v24, v24, v124
    v_add_f32 v25, v25, v125
    v_add_f32 v26, v26, v126
    v_add_f32 v27, v27, v127
    v_cvt_pk_bf16_f32 v30, v24, v25
    v_cvt_pk_bf16_f32 v31, v26, v27
    v_min_u32 v30, -2, v30
    v_min_u32 v31, -2, v31
    s_branch CVE_32
CV_31:
    ds_read2_b32 v[32:33], v7 offset0:128 offset1:129
    ds_read2_b32 v[34:35], v7 offset0:130 offset1:131
    ds_read2_b32 v[36:37], v6 offset0:0 offset1:1
    ds_read2_b32 v[38:39], v6 offset0:2 offset1:3
    ds_read2_b32 v[40:41], v6 offset0:16 offset1:17
    ds_read2_b32 v[42:43], v6 offset0:18 offset1:19
    ds_read2_b32 v[44:45], v6 offset0:32 offset1:33
    ds_read2_b32 v[46:47], v6 offset0:34 offset1:35
    ds_read2_b32 v[48:49], v6 offset0:48 offset1:49
    ds_read2_b32 v[50:51], v6 offset0:50 offset1:51
    ds_read2_b32 v[52:53], v6 offset0:64 offset1:65
    ds_read2_b32 v[54:55], v6 offset0:66 offset1:67
    ds_read2_b32 v[56:57], v6 offset0:80 offset1:81
    ds_read2_b32 v[58:59], v6 offset0:82 offset1:83
    ds_read2_b32 v[60:61], v6 offset0:96 offset1:97
    ds_read2_b32 v[62:63], v6 offset0:98 offset1:99
    ds_read2_b32 v[64:65], v6 offset0:112 offset1:113
    ds_read2_b32 v[66:67], v6 offset0:114 offset1:115
    ds_read2_b32 v[68:69], v6 offset0:128 offset1:129
    ds_read2_b32 v[70:71], v6 offset0:130 offset1:131
    ds_read2_b32 v[72:73], v6 offset0:144 offset1:145
    ds_read2_b32 v[74:75], v6 offset0:146 offset1:147
    ds_read2_b32 v[76:77], v6 offset0:160 offset1:161
    ds_read2_b32 v[78:79], v6 offset0:162 offset1:163
    ds_read2_b32 v[80:81], v6 offset0:176 offset1:177
    ds_read2_b32 v[82:83], v6 offset0:178 offset1:179
    ds_read2_b32 v[84:85], v6 offset0:192 offset1:193
    ds_read2_b32 v[86:87], v6 offset0:194 offset1:195
    ds_read2_b32 v[88:89], v6 offset0:208 offset1:209
    ds_read2_b32 v[90:91], v6 offset0:210 offset1:211
    ds_read2_b32 v[92:93], v6 offset0:224 offset1:225
    ds_read2_b32 v[94:95], v6 offset0:226 offset1:227
    ds_read2_b32 v[96:97], v6 offset0:240 offset1:241
    ds_read2_b32 v[98:99], v6 offset0:242 offset1:243
    ds_read2_b32 v[100:101], v7 offset0:96 offset1:97
    ds_read2_b32 v[102:103], v7 offset0:98 offset1:99
    ds_read2_b32 v[104:105], v11 offset0:0 offset1:1
    ds_read2_b32 v[106:107], v11 offset0:2 offset1:3
    v_lshlrev_b32 v18, 3, v3
    v_sub_u32 v18, v8, v18
    v_lshrrev_b32 v19, 2, v2
    v_lshl_add_u32 v19, v19, 2, v3
    v_and_b32 v28, 3, v2
    v_lshlrev_b32 v28, 4, v28
    v_mul_u32_u24 v19, s8, v19
    v_xor_b32 v19, s10, v19
    s_waitcnt lgkmcnt(0)
    v_mov_b32 v7, v18
    v_add_u32 v6, v19, v28
    v_xor_b32 v12, s9, v12
W_40:
    ds_read_b32 v18, v4 offset:16
    s_sub_u32 s39, s39, 1
    s_cbranch_scc1 KS_ABORT
    s_waitcnt lgkmcnt(0)
    v_cmp_ne_u32 vcc, s84, v18
    s_cbranch_vccnz W_40
    s_setprio 1
    ds_read_b128 v[108:111], v8 offset:1472
    ds_read_b128 v[112:115], v8 offset:1984
    ds_read_b128 v[116:119], v8 offset:2496
    ds_read_b128 v[120:123], v8 offset:2560
    ds_read_b128 v[124:127], v8 offset:2624
    s_waitcnt lgkmcnt(4)
    v_mfma_f32_16x16x32_f16 v[20:23], v[32:35], v[108:111], 0
    ds_read_b128 v[108:111], v8 offset:2688
    s_waitcnt lgkmcnt(4)
    v_mfma_f32_16x16x32_f16 v[24:27], v[32:35], v[112:115], 0
    ds_read_b128 v[32:35], v8 offset:2752
    ds_read_b128 v[112:115], v8 offset:2816
    s_waitcnt lgkmcnt(5)
    v_mfma_f32_16x16x32_f16 v[20:23], v[36:39], v[116:119], v[20:23]
    ds_read_b128 v[116:119], v8 offset:2880
    ds_read_b64 v[28:29], v7 offset:3552
    ds_read_b64 v[30:31], v7 offset:4064
    s_waitcnt lgkmcnt(7)
    v_mfma_f32_16x16x32_f16 v[20:23], v[40:43], v[120:123], v[20:23]
    ds_read_b128 v[120:123], v8 offset:2944
    s_waitcnt lgkmcnt(7)
    v_mfma_f32_16x16x32_f16 v[20:23], v[44:47], v[124:127], v[20:23]
    ds_read_b128 v[124:127], v8 offset:3008
    s_waitcnt lgkmcnt(7)
    v_mfma_f32_16x16x32_f16 v[20:23], v[48:51], v[108:111], v[20:23]
    ds_read_b128 v[108:111], v8 offset:3072
    s_waitcnt lgkmcnt(7)
    v_mfma_f32_16x16x32_f16 v[20:23], v[52:55], v[32:35], v[20:23]
    s_waitcnt lgkmcnt(6)
    v_mfma_f32_16x16x32_f16 v[20:23], v[56:59], v[112:115], v[20:23]
    ds_read_b128 v[32:35], v8 offset:3136
    s_waitcnt lgkmcnt(6)
    v_mfma_f32_16x16x32_f16 v[20:23], v[60:63], v[116:119], v[20:23]
    s_waitcnt lgkmcnt(4)
    v_fma_mix_f32 v116, v28, v17, 0 op_sel_hi:[1,0,0]
    v_fma_mix_f32 v117, v28, v17, 0 op_sel:[1,0,0] op_sel_hi:[1,0,0]
    s_waitcnt lgkmcnt(3)
    v_mfma_f32_16x16x32_f16 v[20:23], v[64:67], v[120:123], v[20:23]
    ds_read_b128 v[112:115], v8 offset:3200
    v_fma_mix_f32 v118, v29, v17, 0 op_sel_hi:[1,0,0]
    v_fma_mix_f32 v119, v29, v17, 0 op_sel:[1,0,0] op_sel_hi:[1,0,0]
    s_waitcnt lgkmcnt(3)
    v_mfma_f32_16x16x32_f16 v[20:23], v[68:71], v[124:127], v[20:23]
    v_cvt_pk_bf16_f32 v116, 0, v116
    v_cvt_pk_bf16_f32 v117, 0, v117
    v_mfma_f32_16x16x32_f16 v[24:27], v[36:39], v[124:127], v[24:27]
    ds_read_b128 v[120:123], v8 offset:3264
    v_cvt_pk_bf16_f32 v118, 0, v118
    v_cvt_pk_bf16_f32 v119, 0, v119
    s_waitcnt lgkmcnt(3)
    v_mfma_f32_16x16x32_f16 v[20:23], v[72:75], v[108:111], v[20:23]
    v_fma_mix_f32 v124, v30, v17, 0 op_sel_hi:[1,0,0]
    v_fma_mix_f32 v125, v30, v17, 0 op_sel:[1,0,0] op_sel_hi:[1,0,0]
    v_mfma_f32_16x16x32_f16 v[24:27], v[40:43], v[108:111], v[24:27]
    ds_read_b128 v[36:39], v8 offset:3328
    v_fma_mix_f32 v126, v31, v17, 0 op_sel_hi:[1,0,0]
    v_fma_mix_f32 v127, v31, v17, 0 op_sel:[1,0,0] op_sel_hi:[1,0,0]
    s_waitcnt lgkmcnt(3)
    v_mfma_f32_16x16x32_f16 v[20:23], v[76:79], v[32:35], v[20:23]
    v_cvt_pk_bf16_f32 v124, 0, v124
    v_cvt_pk_bf16_f32 v125, 0, v125
    v_mfma_f32_16x16x32_f16 v[24:27], v[44:47], v[32:35], v[24:27]
    ds_read_b128 v[40:43], v8 offset:3392
    v_cvt_pk_bf16_f32 v126, 0, v126
    v_cvt_pk_bf16_f32 v127, 0, v127
    s_waitcnt lgkmcnt(3)
    v_mfma_f32_16x16x32_f16 v[20:23], v[80:83], v[112:115], v[20:23]
    v_mfma_f32_16x16x32_f16 v[24:27], v[48:51], v[112:115], v[24:27]
    ds_read_b128 v[108:111], v8 offset:3456
    s_waitcnt lgkmcnt(3)
    v_mfma_f32_16x16x32_f16 v[20:23], v[84:87], v[120:123], v[20:23]
    v_mfma_f32_16x16x32_f16 v[24:27], v[52:55], v[120:123], v[24:27]
    ds_read_b128 v[44:47], v8 offset:3520
    s_waitcnt lgkmcnt(3)
    v_mfma_f32_16x16x32_f16 v[20:23], v[88:91], v[36:39], v[20:23]
    v_mfma_f32_16x16x32_f16 v[24:27], v[56:59], v[36:39], v[24:27]
    ds_read_b128 v[32:35], v8 offset:3584
    s_waitcnt lgkmcnt(3)
    v_mfma_f32_16x16x32_f16 v[20:23], v[92:95], v[40:43], v[20:23]
    ds_read_b128 v[48:51], v8 offset:3648
    v_mfma_f32_16x16x32_f16 v[24:27], v[60:63], v[40:43], v[24:27]
    ds_read_b128 v[112:115], v8 offset:3712
    s_waitcnt lgkmcnt(4)
    v_mfma_f32_16x16x32_f16 v[20:23], v[96:99], v[108:111], v[20:23]
    ds_read_b128 v[52:55], v8 offset:3776
    v_mfma_f32_16x16x32_f16 v[24:27], v[64:67], v[108:111], v[24:27]
    ds_read_b128 v[120:123], v8 offset:3840
    s_waitcnt lgkmcnt(5)
    v_mfma_f32_16x16x32_f16 v[20:23], v[100:103], v[44:47], v[20:23]
    ds_read_b128 v[56:59], v8 offset:3904
    v_mfma_f32_16x16x32_f16 v[24:27], v[68:71], v[44:47], v[24:27]
    ds_read_b32 v18, v14 offset:76
    ds_read_b128 v[36:39], v8 offset:3968
    s_waitcnt lgkmcnt(7)
    v_mfma_f32_16x16x32_f16 v[24:27], v[72:75], v[32:35], v[24:27]
    ds_read_b128 v[60:63], v8 offset:4032
    s_waitcnt lgkmcnt(7)
    v_mfma_f32_16x16x32_f16 v[24:27], v[76:79], v[48:51], v[24:27]
    ds_read2_b32 v[40:41], v11 offset0:16 offset1:17
    ds_read2_b32 v[42:43], v11 offset0:18 offset1:19
    ds_read2_b32 v[64:65], v11 offset0:32 offset1:33
    ds_read2_b32 v[66:67], v11 offset0:34 offset1:35
    s_waitcnt lgkmcnt(10)
    v_mfma_f32_16x16x32_f16 v[24:27], v[80:83], v[112:115], v[24:27]
    s_waitcnt lgkmcnt(6)
    v_cmp_ne_u32 vcc, s84, v18
    s_cbranch_vccnz WS_41
WB_42:
    ds_read_b64_tr_b16 v[108:109], v9 offset:1024
    ds_read_b64_tr_b16 v[110:111], v9 offset:1088
    ds_read_b64_tr_b16 v[68:69], v9 offset:1536
    ds_read_b64_tr_b16 v[70:71], v9 offset:1600
    v_mfma_f32_16x16x32_f16 v[24:27], v[84:87], v[52:55], v[24:27]
    ds_read_b64_tr_b16 v[44:45], v9 offset:2048
    ds_read_b64_tr_b16 v[46:47], v9 offset:2112
    v_mfma_f32_16x16x32_f16 v[24:27], v[88:91], v[120:123], v[24:27]
    ds_read_b64_tr_b16 v[72:73], v9 offset:4112
    ds_read_b64_tr_b16 v[74:75], v9 offset:4176
    ds_read2_b32 v[32:33], v11 offset0:64 offset1:65
    ds_read2_b32 v[34:35], v11 offset0:66 offset1:67
    v_mfma_f32_16x16x32_f16 v[24:27], v[92:95], v[56:59], v[24:27]
    ds_read_b64_tr_b16 v[76:77], v9 offset:4624
    ds_read_b64_tr_b16 v[78:79], v9 offset:4688
    ds_read2_b32 v[48:49], v11 offset0:80 offset1:81
    ds_read2_b32 v[50:51], v11 offset0:82 offset1:83
    v_mfma_f32_16x16x32_f16 v[24:27], v[96:99], v[36:39], v[24:27]
    ds_read_b64_tr_b16 v[80:81], v9 offset:5136
    ds_read_b64_tr_b16 v[82:83], v9 offset:5200
    ds_read2_b32 v[112:113], v11 offset0:96 offset1:97
    ds_read2_b32 v[114:115], v11 offset0:98 offset1:99
    v_mfma_f32_16x16x32_f16 v[24:27], v[100:103], v[60:63], v[24:27]
    ds_read_b64_tr_b16 v[84:85], v10 offset:6176
    ds_read_b64_tr_b16 v[86:87], v10 offset:6304
    ds_read2_b32 v[52:53], v13 offset0:8 offset1:9
    ds_read2_b32 v[54:55], v13 offset0:10 offset1:11
    v_mfma_f32_16x16x32_f16 v[20:23], v[108:111], v[104:107], v[20:23]
    ds_read_b64_tr_b16 v[88:89], v10 offset:7200
    ds_read_b64_tr_b16 v[90:91], v10 offset:7328
    ds_read2_b32 v[120:121], v13 offset0:24 offset1:25
    ds_read2_b32 v[122:123], v13 offset0:26 offset1:27
    v_mfma_f32_16x16x32_f16 v[20:23], v[68:71], v[40:43], v[20:23]
    ds_read_b64_tr_b16 v[92:93], v10 offset:8224
    ds_read_b64_tr_b16 v[94:95], v10 offset:8352
    ds_read2_b32 v[56:57], v13 offset0:104 offset1:105
    ds_read2_b32 v[58:59], v13 offset0:106 offset1:107
    v_mfma_f32_16x16x32_f16 v[20:23], v[44:47], v[64:67], v[20:23]
    ds_read_b64_tr_b16 v[96:97], v10 offset:9248
    ds_read_b64_tr_b16 v[98:99], v10 offset:9376
    ds_read2_b32 v[36:37], v13 offset0:120 offset1:121
    ds_read2_b32 v[38:39], v13 offset0:122 offset1:123
    v_mfma_f32_16x16x32_f16 v[20:23], v[72:75], v[32:35], v[20:23]
    v_mfma_f32_16x16x32_f16 v[20:23], v[76:79], v[48:51], v[20:23]
    v_mfma_f32_16x16x32_f16 v[20:23], v[80:83], v[112:115], v[20:23]
    ds_read_b64_tr_b16 v[100:101], v9 offset:2560
    ds_read_b64_tr_b16 v[102:103], v9 offset:2624
    s_waitcnt lgkmcnt(14)
    v_mfma_f32_16x16x32_f16 v[20:23], v[84:87], v[52:55], v[20:23]
    s_waitcnt lgkmcnt(10)
    v_mfma_f32_16x16x32_f16 v[20:23], v[88:91], v[120:123], v[20:23]
    s_waitcnt lgkmcnt(6)
    v_mfma_f32_16x16x32_f16 v[20:23], v[92:95], v[56:59], v[20:23]
    ds_read_b64_tr_b16 v[60:61], v9 offset:5648
    ds_read_b64_tr_b16 v[62:63], v9 offset:5712
    ds_read2_b32 v[108:109], v13 offset0:0 offset1:1
    ds_read2_b32 v[110:111], v13 offset0:2 offset1:3
    s_waitcnt lgkmcnt(6)
    v_mfma_f32_16x16x32_f16 v[20:23], v[96:99], v[36:39], v[20:23]
    ds_read2_b32 v[72:73], v13 offset0:16 offset1:17
    ds_read2_b32 v[74:75], v13 offset0:18 offset1:19
    ds_read2_b32 v[52:53], v13 offset0:96 offset1:97
    ds_read2_b32 v[54:55], v13 offset0:98 offset1:99
    v_mfma_f32_16x16x32_f16 v[24:27], v[68:71], v[104:107], v[24:27]
    ds_read2_b32 v[120:121], v13 offset0:112 offset1:113
    ds_read2_b32 v[122:123], v13 offset0:114 offset1:115
    v_mfma_f32_16x16x32_f16 v[24:27], v[44:47], v[40:43], v[24:27]
    v_mul_f32 v20, v20, v16
    v_mul_f32 v21, v21, v16
    s_waitcnt lgkmcnt(10)
    v_mfma_f32_16x16x32_f16 v[24:27], v[100:103], v[64:67], v[24:27]
    v_mul_f32 v22, v22, v16
    v_mul_f32 v23, v23, v16
    v_mfma_f32_16x16x32_f16 v[24:27], v[76:79], v[32:35], v[24:27]
    v_cvt_pk_bf16_f32 v20, 0, v20
    v_cvt_pk_bf16_f32 v21, 0, v21
    v_mfma_f32_16x16x32_f16 v[24:27], v[80:83], v[48:51], v[24:27]
    v_cvt_pk_bf16_f32 v22, 0, v22
    v_cvt_pk_bf16_f32 v23, 0, v23
    s_waitcnt lgkmcnt(8)
    v_mfma_f32_16x16x32_f16 v[24:27], v[60:63], v[112:115], v[24:27]
    v_add_f32 v20, v20, v116
    v_add_f32 v21, v21, v117
    s_waitcnt lgkmcnt(6)
    v_mfma_f32_16x16x32_f16 v[24:27], v[84:87], v[108:111], v[24:27]
    v_add_f32 v22, v22, v118
    v_add_f32 v23, v23, v119
    s_waitcnt lgkmcnt(4)
    v_mfma_f32_16x16x32_f16 v[24:27], v[88:91], v[72:75], v[24:27]
    v_cvt_pk_bf16_f32 v28, v20, v21
    v_cvt_pk_bf16_f32 v29, v22, v23
    s_waitcnt lgkmcnt(2)
    v_mfma_f32_16x16x32_f16 v[24:27], v[92:95], v[52:55], v[24:27]
    v_min_u32 v28, -2, v28
    v_min_u32 v29, -2, v29
    s_waitcnt lgkmcnt(0)
    v_mfma_f32_16x16x32_f16 v[24:27], v[96:99], v[120:123], v[24:27]
    ds_read_u8 v18, v4 offset:163
    ds_read_b128 v[20:23], v12 offset:49664
    s_nop 5
    v_mul_f32 v24, v24, v16
    v_mul_f32 v25, v25, v16
    v_mul_f32 v26, v26, v16
    v_mul_f32 v27, v27, v16
    v_cvt_pk_bf16_f32 v24, 0, v24
    v_cvt_pk_bf16_f32 v25, 0, v25
    v_cvt_pk_bf16_f32 v26, 0, v26
    v_cvt_pk_bf16_f32 v27, 0, v27
    v_add_f32 v24, v24, v124
    v_add_f32 v25, v25, v125
    v_add_f32 v26, v26, v126
    v_add_f32 v27, v27, v127
    v_cvt_pk_bf16_f32 v30, v24, v25
    v_cvt_pk_bf16_f32 v31, v26, v27
    v_min_u32 v30, -2, v30
    v_min_u32 v31, -2, v31
CVE_32:
    s_waitcnt lgkmcnt(0)
    s_cmp_lg_u32 s87, 1
    s_cbranch_scc1 ZA_43
    v_cmp_ne_u32 vcc, 1, v18
    s_cbranch_vccnz ZS_45
ZB_46:
    s_mov_b64 exec, s[12:13]
    v_swap_b32 v28, v20
    v_swap_b32 v29, v21
    v_swap_b32 v30, v22
    v_swap_b32 v31, v23
    s_mov_b64 exec, -1
    buffer_store_dwordx4 v[28:31], v6, s[64:67], s7 offen sc1
    buffer_store_dwordx4 v[20:23], v6, s[64:67], s6 offen sc1
    s_branch ZD_48
WS_35:
W_49:
    ds_read_b32 v18, v14 offset:76
    s_sub_u32 s39, s39, 1
    s_cbranch_scc1 KS_ABORT
    s_waitcnt lgkmcnt(0)
    v_cmp_ne_u32 vcc, s84, v18
    s_cbranch_vccnz W_49
    s_branch WB_36
WS_38:
W_50:
    ds_read_b32 v18, v14 offset:76
    s_sub_u32 s39, s39, 1
    s_cbranch_scc1 KS_ABORT
    s_waitcnt lgkmcnt(0)
    v_cmp_ne_u32 vcc, s84, v18
    s_cbranch_vccnz W_50
    s_branch WB_39
WS_41:
W_51:
    ds_read_b32 v18, v14 offset:76
    s_sub_u32 s39, s39, 1
    s_cbranch_scc1 KS_ABORT
    s_waitcnt lgkmcnt(0)
    v_cmp_ne_u32 vcc, s84, v18
    s_cbranch_vccnz W_51
    s_branch WB_42
ZS_45:
    v_mov_b32 v19, s86
ZW_52:
    ds_read_u8 v18, v19 offset:160
    s_sub_u32 s39, s39, 1
    s_cbranch_scc1 KS_ABORT
    s_waitcnt lgkmcnt(0)
    v_cmp_ne_u32 vcc, 1, v18
    s_cbranch_vccnz ZW_52
    v_lshl_add_u32 v19, v19, 10, v12
    ds_read_b128 v[20:23], v19 offset:46592
    s_waitcnt lgkmcnt(0)
    s_branch ZB_46
ZA_43:
    s_cmp_lg_u32 s87, 0
    s_cbranch_scc1 ZC_44
    v_mov_b32 v19, s86
    v_lshl_add_u32 v18, v19, 10, v12
    ds_write_b128 v18, v[28:31] offset:46592
    ds_write_b8 v19, v5 offset:160
    s_branch ZD_48
ZC_44:
    buffer_store_dwordx4 v[28:31], v6, s[64:67], s6 offen sc1
ZD_48:
    s_lshl_b32 s92, s87, 2
    s_add_u32 s92, s92, s86
    v_mov_b32 v8, s92
    s_waitcnt vmcnt(0)
    ds_write_b8 v8, v5 offset:48
    s_branch KS_K1
    s_cmp_lg_u32 s38, 4
    s_cbranch_scc1 KS_K1
    s_setprio 0
    s_add_u32 s76, s36, 0x840000
    s_addc_u32 s77, s37, 0
    s_mov_b32 s78, 0x4000
    s_mov_b32 s79, 0x20000
    v_and_b32 v6, 1, v1
    v_lshlrev_b32 v6, 4, v6
    s_lshl_b32 s92, s90, 5
W_53:
    s_sleep 1
    ds_read_b32 v8, v4 offset:20
    s_sub_u32 s39, s39, 1
    s_cbranch_scc1 KS_ABORT
    s_waitcnt lgkmcnt(0)
    v_cmp_ne_u32 vcc, s84, v8
    s_cbranch_vccnz W_53
    s_mov_b64 exec, 3
    s_setprio 1
KS_K0:
    ds_read_b128 v[8:11], v6 offset:800
    s_sub_u32 s39, s39, 1
    s_cbranch_scc1 KS_ABORT
    s_waitcnt lgkmcnt(0)
    v_min3_u32 v12, v8, v9, v10
    v_min_u32 v12, v12, v11
    v_cmp_eq_u32 vcc, 0, v12
    s_cbranch_vccnz KS_K0
    buffer_store_dwordx4 v[8:11], v6, s[76:79], s92 offen sc1
    s_mov_b64 exec, -1
    s_waitcnt vmcnt(0)
    ds_write_b32 v4, v5 offset:24
KS_K1:
    s_cmp_lt_u32 s41, 18
    s_cbranch_scc1 KS_T
    s_waitcnt lgkmcnt(0)
    s_endpgm
KS_X:
    s_cmp_lt_u32 s41, 24
    s_cbranch_scc1 KS_X2
    s_setprio 2
KS_XC:
    s_mov_b32 s87, 2
    s_add_u32 s86, s38, 3
    s_and_b32 s86, s86, 3
    s_lshl_b32 s88, s40, 3
    s_and_b32 s92, s41, 7
    s_add_u32 s88, s88, s92
    s_add_u32 s88, s88, 512
    s_lshl_b32 s92, s86, 11
    s_add_u32 s92, s92, 146048
    v_lshl_add_u32 v28, v1, 3, s92
    s_branch KS_GRP
KS_X2:
    s_cmp_lt_u32 s41, 8
    s_cbranch_scc1 KS_X3
    s_sub_u32 s97, s38, 8
    s_branch KS_LN1
KS_X3:
    s_lshl_b32 s92, s2, 4
    s_add_u32 s92, s92, s38
    s_cmp_lg_u32 s92, 44
    s_cbranch_scc1 KS_X3B
    s_setprio 3
    s_memrealtime s[92:93]
    v_and_b32 v6, 3, v1
    v_lshlrev_b32 v7, 2, v6
    v_min_u32 v6, 2, v6
    v_lshlrev_b32 v6, 2, v6
    v_cmp_eq_u32 vcc, 3, v1
    s_waitcnt lgkmcnt(0)
    v_mov_b32 v8, s92
    v_mov_b32 v9, s93
    v_alignbit_b32 v8, v8, v8, v6
    v_cndmask_b32 v9, v4, v9, vcc
    v_xor_b32 v8, v8, v9
    v_and_b32 v9, 0xf0000fff, v8
    v_and_b32 v10, 0xfff000, v8
    v_lshl_or_b32 v9, v10, 4, v9
    v_lshrrev_b32 v10, 12, v8
    v_and_b32 v10, 0xf000, v10
    v_or3_b32 v9, v9, v10, v9
    v_or_b32 v9, 0x80000000, v9
    s_mov_b64 exec, 15
    global_store_dword v7, v9, s[34:35] sc1
    s_mov_b64 exec, -1
    s_setprio 0
KS_X3B:
    s_setprio 3
    s_branch KS_XC
    s_waitcnt lgkmcnt(0)
    s_barrier
    s_branch KS_G
KS_X4:
    s_cmp_lt_u32 s41, 18
    s_cbranch_scc1 KS_G
    v_mul_u32_u24 v46, 57, v1
    v_lshrrev_b32 v46, 9, v46
    v_mul_u32_u24 v47, 9, v46
    v_sub_u32 v47, v1, v47
    v_mul_u32_u24 v46, 9216, v46
    v_lshl_add_u32 v46, v47, 7, v46
    s_mul_i32 s94, s38, 6
    s_add_u32 s94, s94, s41
    s_sub_u32 s94, s94, 90
W_54:
    s_sleep 2
    ds_read_b32 v10, v4 offset:200
    s_sub_u32 s39, s39, 1
    s_cbranch_scc1 KS_ABORT
    s_waitcnt lgkmcnt(0)
    v_cmp_ne_u32 vcc, s84, v10
    s_cbranch_vccnz W_54
    s_bitcmp1_b32 s94, 0
    s_cselect_b32 s72, s28, s26
    s_cselect_b32 s73, s29, s27
    s_mov_b32 s74, 0x510000
    s_mov_b32 s75, 0x20000
    s_lshr_b32 s95, s94, 1
    s_mul_i32 s95, s95, 64512
    s_mul_i32 s96, s40, 1152
    s_add_u32 s95, s95, s96
    s_add_u32 s96, s95, 2644992
    buffer_load_dword v47, v46, s[72:75], s96 offen nt
    buffer_load_dword v47, v46, s[72:75], s96 offen sc1
KS_XPE:
    s_waitcnt vmcnt(0) lgkmcnt(0)
    s_endpgm
KS_L:
    v_lshlrev_b32 v6, 2, v0
    ds_write_b32 v6, v4
    v_mov_b32 v8, 0
    v_mov_b32 v9, 0
    s_min_u32 s92, s38, 2
    s_mul_i32 s92, s92, 4672
    v_min_u32 v6, 59, v1
    v_lshl_add_u32 v6, v6, 3, s92
    ds_write_b64 v6, v[8:9] offset:3072
    s_mov_b32 s97, s38
    s_sub_u32 s92, s41, 8
    s_cmp_lt_u32 s92, 16
    s_cbranch_scc0 KS_L0
KS_LN1:
    s_setprio 3
    s_sub_u32 s92, s41, 8
    s_and_b32 s88, s92, 7
    s_lshr_b32 s92, s92, 3
    s_lshl_b32 s92, s92, 4
    s_add_u32 s88, s88, s92
    s_and_b32 s92, s40, 1
    s_lshl_b32 s92, s92, 3
    s_add_u32 s88, s88, s92
    s_lshr_b32 s92, s40, 1
    s_lshl_b32 s92, s92, 5
    s_add_u32 s88, s88, s92
    v_lshrrev_b32 v36, 5, v1
    v_and_b32 v37, 31, v1
    v_mul_u32_u24 v38, 1152, v36
    v_lshl_add_u32 v39, v37, 2, v38
    v_lshl_add_u32 v38, v37, 4, v38
    s_mul_i32 s93, s88, 18432
    s_mul_i32 s94, s97, 2304
    s_add_u32 s93, s93, s94
    s_waitcnt lgkmcnt(0)
    s_mov_b32 s64, s4
    s_mov_b32 s65, s5
    s_mov_b32 s66, 0x240000
    s_mov_b32 s67, 0x20000
    buffer_load_dwordx4 v[26:29], v38, s[64:67], s93 offen
    buffer_load_dwordx4 v[30:33], v38, s[64:67], s93 offen offset:512
    buffer_load_dword v34, v39, s[64:67], s93 offen offset:1024
    s_barrier
    s_lshr_b32 s93, s97, 2
    s_lshl_b32 s93, s93, 6
    s_add_u32 s94, s94, s93
    s_add_u32 s94, s94, 17088
    v_lshl_add_u32 v35, v37, 1, v36
    s_mov_b32 s98, 0x05040100
    s_mov_b32 s99, 0x07060302
    s_cmp_lt_u32 s97, 4
    s_cbranch_scc1 LN1A_55
    s_cmp_ge_u32 s41, 18
    s_cbranch_scc1 LN1A_55
    s_mov_b32 s68, s30
    s_mov_b32 s69, s31
    s_mov_b32 s70, 0x510000
    s_mov_b32 s71, 0x20000
    v_lshlrev_b32 v46, 4, v1
    s_mul_i32 s92, s89, 36864
    s_mul_i32 s93, s97, 9216
    s_add_u32 s92, s92, s93
    s_sub_u32 s92, s92, 36864
    s_add_u32 s93, s93, 72320
    s_add_u32 m0, s93, 0
    s_nop 0
    buffer_load_dwordx4 v46, s[68:71], s92 offen offset:0 nt lds
    buffer_load_dwordx4 v46, s[68:71], s92 offen offset:1024 nt lds
    buffer_load_dwordx4 v46, s[68:71], s92 offen offset:2048 nt lds
    buffer_load_dwordx4 v46, s[68:71], s92 offen offset:3072 nt lds
    s_add_u32 m0, s93, 4096
    s_add_u32 s92, s92, 4096
    buffer_load_dwordx4 v46, s[68:71], s92 offen offset:0 nt lds
    buffer_load_dwordx4 v46, s[68:71], s92 offen offset:1024 nt lds
    buffer_load_dwordx4 v46, s[68:71], s92 offen offset:2048 nt lds
    buffer_load_dwordx4 v46, s[68:71], s92 offen offset:3072 nt lds
    s_add_u32 m0, s93, 8192
    s_add_u32 s92, s92, 4096
    buffer_load_dwordx4 v46, s[68:71], s92 offen offset:0 nt lds
    s_waitcnt vmcnt(11)
    v_lshlrev_b32 v8, 16, v26
    v_and_b32 v9, 0xffff0000, v26
    v_lshlrev_b32 v10, 16, v27
    v_and_b32 v11, 0xffff0000, v27
    v_lshlrev_b32 v12, 16, v28
    v_and_b32 v13, 0xffff0000, v28
    v_lshlrev_b32 v14, 16, v29
    v_and_b32 v15, 0xffff0000, v29
    s_waitcnt vmcnt(10)
    v_lshlrev_b32 v16, 16, v30
    v_and_b32 v17, 0xffff0000, v30
    v_lshlrev_b32 v18, 16, v31
    v_and_b32 v19, 0xffff0000, v31
    v_lshlrev_b32 v20, 16, v32
    v_and_b32 v21, 0xffff0000, v32
    v_lshlrev_b32 v22, 16, v33
    v_and_b32 v23, 0xffff0000, v33
    s_waitcnt vmcnt(9)
    v_lshlrev_b32 v24, 16, v34
    v_and_b32 v25, 0xffff0000, v34
    s_branch LN1B_56
LN1A_55:
    s_waitcnt vmcnt(2)
    v_lshlrev_b32 v8, 16, v26
    v_and_b32 v9, 0xffff0000, v26
    v_lshlrev_b32 v10, 16, v27
    v_and_b32 v11, 0xffff0000, v27
    v_lshlrev_b32 v12, 16, v28
    v_and_b32 v13, 0xffff0000, v28
    v_lshlrev_b32 v14, 16, v29
    v_and_b32 v15, 0xffff0000, v29
    s_waitcnt vmcnt(1)
    v_lshlrev_b32 v16, 16, v30
    v_and_b32 v17, 0xffff0000, v30
    v_lshlrev_b32 v18, 16, v31
    v_and_b32 v19, 0xffff0000, v31
    v_lshlrev_b32 v20, 16, v32
    v_and_b32 v21, 0xffff0000, v32
    v_lshlrev_b32 v22, 16, v33
    v_and_b32 v23, 0xffff0000, v33
    s_waitcnt vmcnt(0)
    v_lshlrev_b32 v24, 16, v34
    v_and_b32 v25, 0xffff0000, v34
    s_nop 1
LN1B_56:
    v_lshl_add_u32 v6, v35, 4, s94
    v_lshl_add_u32 v7, v35, 2, s94
    v_mul_u32_u24 v35, 0x20202, v36
    v_lshl_add_u32 v35, v36, 25, v35
    v_add_u32 v35, 0x05040100, v35
    v_pk_add_f32 v[40:41], v[8:9], v[10:11]
    v_pk_add_f32 v[42:43], v[12:13], v[14:15]
    v_pk_add_f32 v[40:41], v[40:41], v[16:17]
    v_pk_add_f32 v[42:43], v[42:43], v[18:19]
    v_pk_add_f32 v[40:41], v[40:41], v[20:21]
    v_pk_add_f32 v[42:43], v[42:43], v[22:23]
    v_pk_add_f32 v[40:41], v[40:41], v[24:25]
    v_pk_add_f32 v[40:41], v[40:41], v[42:43]
    v_add_f32 v40, v40, v41
    s_nop 1
    v_add_f32_dpp v40, v40, v40 row_ror:8 row_mask:0xf bank_mask:0xf
    s_nop 1
    v_add_f32_dpp v40, v40, v40 row_ror:4 row_mask:0xf bank_mask:0xf
    s_nop 1
    v_add_f32_dpp v40, v40, v40 row_ror:2 row_mask:0xf bank_mask:0xf
    s_nop 1
    v_add_f32_dpp v40, v40, v40 row_ror:1 row_mask:0xf bank_mask:0xf
    v_mov_b32 v42, v40
    s_nop 1
    v_permlane16_swap_b32 v40, v42
    v_add_f32 v40, v40, v42
    v_mul_f32 v44, 0x3ae38e39, v40
    v_mov_b32 v45, v44
    v_cvt_pk_bf16_f32 v36, 0, v44
    v_cvt_pk_bf16_f32 v37, 0, v44
    v_pk_add_f32 v[38:39], v[8:9], v[44:45] neg_lo:[0,1] neg_hi:[0,1]
    v_pk_mul_f32 v[40:41], v[38:39], v[38:39]
    v_pk_add_f32 v[38:39], v[10:11], v[44:45] neg_lo:[0,1] neg_hi:[0,1]
    v_pk_mul_f32 v[42:43], v[38:39], v[38:39]
    v_pk_add_f32 v[38:39], v[12:13], v[44:45] neg_lo:[0,1] neg_hi:[0,1]
    v_pk_fma_f32 v[40:41], v[38:39], v[38:39], v[40:41]
    v_pk_add_f32 v[38:39], v[14:15], v[44:45] neg_lo:[0,1] neg_hi:[0,1]
    v_pk_fma_f32 v[42:43], v[38:39], v[38:39], v[42:43]
    v_pk_add_f32 v[38:39], v[16:17], v[44:45] neg_lo:[0,1] neg_hi:[0,1]
    v_pk_fma_f32 v[40:41], v[38:39], v[38:39], v[40:41]
    v_pk_add_f32 v[38:39], v[18:19], v[44:45] neg_lo:[0,1] neg_hi:[0,1]
    v_pk_fma_f32 v[42:43], v[38:39], v[38:39], v[42:43]
    v_pk_add_f32 v[38:39], v[20:21], v[44:45] neg_lo:[0,1] neg_hi:[0,1]
    v_pk_fma_f32 v[40:41], v[38:39], v[38:39], v[40:41]
    v_pk_add_f32 v[38:39], v[22:23], v[44:45] neg_lo:[0,1] neg_hi:[0,1]
    v_pk_fma_f32 v[42:43], v[38:39], v[38:39], v[42:43]
    v_pk_add_f32 v[38:39], v[24:25], v[44:45] neg_lo:[0,1] neg_hi:[0,1]
    v_pk_fma_f32 v[40:41], v[38:39], v[38:39], v[40:41]
    v_pk_add_f32 v[40:41], v[40:41], v[42:43]
    v_add_f32 v40, v40, v41
    s_nop 1
    v_add_f32_dpp v40, v40, v40 row_ror:8 row_mask:0xf bank_mask:0xf
    s_nop 1
    v_add_f32_dpp v40, v40, v40 row_ror:4 row_mask:0xf bank_mask:0xf
    s_nop 1
    v_add_f32_dpp v40, v40, v40 row_ror:2 row_mask:0xf bank_mask:0xf
    s_nop 1
    v_add_f32_dpp v40, v40, v40 row_ror:1 row_mask:0xf bank_mask:0xf
    v_mov_b32 v42, v40
    s_nop 1
    v_permlane16_swap_b32 v40, v42
    v_add_f32 v40, v40, v42
    v_mul_f32 v40, 0x3ae38e39, v40
    v_cvt_pk_bf16_f32 v40, 0, v40
    v_add_f32 v40, 0x3727c5ac, v40
    v_cvt_pk_bf16_f32 v40, 0, v40
    v_sqrt_f32 v40, v40
    s_nop 0
    v_cvt_pk_bf16_f32 v40, 0, v40
    v_rcp_f32 v38, v40
    s_nop 0
    v_mov_b32 v39, v38
    v_pk_add_f32 v[40:41], v[8:9], v[36:37] neg_lo:[0,1] neg_hi:[0,1]
    v_cvt_pk_bf16_f32 v40, 0, v40
    v_cvt_pk_bf16_f32 v41, 0, v41
    v_pk_mul_f32 v[40:41], v[40:41], v[38:39]
    v_cvt_pk_bf16_f32 v40, 0, v40
    v_cvt_pk_bf16_f32 v41, 0, v41
    v_cvt_pk_f16_f32 v26, v40, v41
    v_pk_add_f32 v[40:41], v[10:11], v[36:37] neg_lo:[0,1] neg_hi:[0,1]
    v_cvt_pk_bf16_f32 v40, 0, v40
    v_cvt_pk_bf16_f32 v41, 0, v41
    v_pk_mul_f32 v[40:41], v[40:41], v[38:39]
    v_cvt_pk_bf16_f32 v40, 0, v40
    v_cvt_pk_bf16_f32 v41, 0, v41
    v_cvt_pk_f16_f32 v27, v40, v41
    v_pk_add_f32 v[40:41], v[12:13], v[36:37] neg_lo:[0,1] neg_hi:[0,1]
    v_cvt_pk_bf16_f32 v40, 0, v40
    v_cvt_pk_bf16_f32 v41, 0, v41
    v_pk_mul_f32 v[40:41], v[40:41], v[38:39]
    v_cvt_pk_bf16_f32 v40, 0, v40
    v_cvt_pk_bf16_f32 v41, 0, v41
    v_cvt_pk_f16_f32 v28, v40, v41
    v_and_b32 v59, 3, v1
    v_lshlrev_b32 v59, 2, v59
    global_load_dword v58, v59, s[34:35] sc1
    v_pk_add_f32 v[40:41], v[14:15], v[36:37] neg_lo:[0,1] neg_hi:[0,1]
    v_cvt_pk_bf16_f32 v40, 0, v40
    v_cvt_pk_bf16_f32 v41, 0, v41
    v_pk_mul_f32 v[40:41], v[40:41], v[38:39]
    v_cvt_pk_bf16_f32 v40, 0, v40
    v_cvt_pk_bf16_f32 v41, 0, v41
    v_cvt_pk_f16_f32 v29, v40, v41
    v_permlane32_swap_b32 v26, v28
    s_nop 0
    v_permlane32_swap_b32 v27, v29
    v_perm_b32 v8, v28, v26, s98
    v_perm_b32 v9, v28, v26, s99
    v_perm_b32 v10, v29, v27, s98
    v_perm_b32 v11, v29, v27, s99
    ds_write_b128 v6, v[8:11] offset:0
    v_pk_add_f32 v[40:41], v[16:17], v[36:37] neg_lo:[0,1] neg_hi:[0,1]
    v_cvt_pk_bf16_f32 v40, 0, v40
    v_cvt_pk_bf16_f32 v41, 0, v41
    v_pk_mul_f32 v[40:41], v[40:41], v[38:39]
    v_cvt_pk_bf16_f32 v40, 0, v40
    v_cvt_pk_bf16_f32 v41, 0, v41
    v_cvt_pk_f16_f32 v30, v40, v41
    v_pk_add_f32 v[40:41], v[18:19], v[36:37] neg_lo:[0,1] neg_hi:[0,1]
    v_cvt_pk_bf16_f32 v40, 0, v40
    v_cvt_pk_bf16_f32 v41, 0, v41
    v_pk_mul_f32 v[40:41], v[40:41], v[38:39]
    v_cvt_pk_bf16_f32 v40, 0, v40
    v_cvt_pk_bf16_f32 v41, 0, v41
    v_cvt_pk_f16_f32 v31, v40, v41
    v_pk_add_f32 v[40:41], v[20:21], v[36:37] neg_lo:[0,1] neg_hi:[0,1]
    v_cvt_pk_bf16_f32 v40, 0, v40
    v_cvt_pk_bf16_f32 v41, 0, v41
    v_pk_mul_f32 v[40:41], v[40:41], v[38:39]
    v_cvt_pk_bf16_f32 v40, 0, v40
    v_cvt_pk_bf16_f32 v41, 0, v41
    v_cvt_pk_f16_f32 v32, v40, v41
    v_pk_add_f32 v[40:41], v[22:23], v[36:37] neg_lo:[0,1] neg_hi:[0,1]
    v_cvt_pk_bf16_f32 v40, 0, v40
    v_cvt_pk_bf16_f32 v41, 0, v41
    v_pk_mul_f32 v[40:41], v[40:41], v[38:39]
    v_cvt_pk_bf16_f32 v40, 0, v40
    v_cvt_pk_bf16_f32 v41, 0, v41
    v_cvt_pk_f16_f32 v33, v40, v41
    v_permlane32_swap_b32 v30, v32
    s_nop 0
    v_permlane32_swap_b32 v31, v33
    v_perm_b32 v16, v32, v30, s98
    v_perm_b32 v17, v32, v30, s99
    v_perm_b32 v18, v33, v31, s98
    v_perm_b32 v19, v33, v31, s99
    ds_write_b128 v6, v[16:19] offset:1024
    v_pk_add_f32 v[40:41], v[24:25], v[36:37] neg_lo:[0,1] neg_hi:[0,1]
    v_cvt_pk_bf16_f32 v40, 0, v40
    v_cvt_pk_bf16_f32 v41, 0, v41
    v_pk_mul_f32 v[40:41], v[40:41], v[38:39]
    v_cvt_pk_bf16_f32 v40, 0, v40
    v_cvt_pk_bf16_f32 v41, 0, v41
    v_cvt_pk_f16_f32 v34, v40, v41
    v_mov_b32 v40, v34
    s_nop 1
    v_permlane32_swap_b32 v34, v40
    v_perm_b32 v40, v40, v34, v35
    ds_write_b32 v7, v40 offset:2048
    v_mov_b32 v6, s97
    ds_write_b8 v6, v5 offset:0
    s_setprio 0
    s_cmp_ge_u32 s97, 4
    s_cbranch_scc1 KS_X4
    s_setprio 3
    s_mov_b32 s72, s36
    s_mov_b32 s73, s37
    s_mov_b32 s74, 0x240000
    s_mov_b32 s75, 0x20000
    v_and_b32 v6, 1, v0
    v_mul_u32_u24 v6, 9280, v6
    v_lshrrev_b32 v7, 1, v0
    v_lshl_add_u32 v6, v7, 2, v6
    v_add_u32 v6, 17088, v6
    v_lshrrev_b32 v7, 2, v0
    v_mul_u32_u24 v7, 0x2080, v7
    v_and_b32 v8, 3, v0
    v_lshl_add_u32 v7, v8, 4, v7
    s_lshl_b32 s92, s88, 6
    v_xor_b32 v7, s92, v7
    s_mov_b32 s92, 0
    s_add_u32 s93, s92, 524288
    s_add_u32 s94, s92, 1048576
    s_add_u32 s95, s92, 1572864
    s_add_u32 s96, s92, 2097152
    s_waitcnt vmcnt(0)
DBP_57:
    v_cmp_eq_u32 vcc, 0, v58
    s_cbranch_vccz DBG_58
    s_sleep 1
    global_load_dword v58, v59, s[34:35] sc1
    s_sub_u32 s39, s39, 1
    s_cbranch_scc1 KS_ABORT
    s_waitcnt vmcnt(0)
    s_branch DBP_57
DBG_58:
    ds_write_b32 v59, v58 offset:224
    s_mov_b32 s98, 0x70007
    v_lshrrev_b32 v57, 3, v58
    v_lshrrev_b32 v56, 6, v58
    v_lshrrev_b32 v55, 9, v58
W_59:
    ds_read_b64 v[20:21], v4 offset:0
    s_sub_u32 s39, s39, 1
    s_cbranch_scc1 KS_ABORT
    s_waitcnt lgkmcnt(0)
    v_and_b32 v20, v20, v21
    v_cmp_ne_u32 vcc, s84, v20
    s_cbranch_vccnz W_59
    ds_read2st64_b32 v[20:21], v6 offset0:0 offset1:9
    ds_read2st64_b32 v[22:23], v6 offset0:18 offset1:27
    ds_read2st64_b32 v[24:25], v6 offset0:2 offset1:11
    ds_read2st64_b32 v[26:27], v6 offset0:20 offset1:29
    ds_read2st64_b32 v[28:29], v6 offset0:4 offset1:13
    ds_read2st64_b32 v[30:31], v6 offset0:22 offset1:31
    ds_read2st64_b32 v[32:33], v6 offset0:6 offset1:15
    ds_read2st64_b32 v[34:35], v6 offset0:24 offset1:33
    ds_read2st64_b32 v[36:37], v6 offset0:8 offset1:17
    ds_read2st64_b32 v[38:39], v6 offset0:26 offset1:35
    s_waitcnt lgkmcnt(8)
    v_bfi_b32 v20, s98, v58, v20
    v_bfi_b32 v21, s98, v57, v21
    v_bfi_b32 v22, s98, v56, v22
    v_bfi_b32 v23, s98, v55, v23
    buffer_store_dwordx4 v[20:23], v7, s[72:75], s92 offen sc1
    s_waitcnt lgkmcnt(6)
    v_bfi_b32 v24, s98, v58, v24
    v_bfi_b32 v25, s98, v57, v25
    v_bfi_b32 v26, s98, v56, v26
    v_bfi_b32 v27, s98, v55, v27
    buffer_store_dwordx4 v[24:27], v7, s[72:75], s93 offen sc1
    s_waitcnt lgkmcnt(4)
    v_bfi_b32 v28, s98, v58, v28
    v_bfi_b32 v29, s98, v57, v29
    v_bfi_b32 v30, s98, v56, v30
    v_bfi_b32 v31, s98, v55, v31
    buffer_store_dwordx4 v[28:31], v7, s[72:75], s94 offen sc1
    s_waitcnt lgkmcnt(2)
    v_bfi_b32 v32, s98, v58, v32
    v_bfi_b32 v33, s98, v57, v33
    v_bfi_b32 v34, s98, v56, v34
    v_bfi_b32 v35, s98, v55, v35
    buffer_store_dwordx4 v[32:35], v7, s[72:75], s95 offen sc1
    s_waitcnt lgkmcnt(0)
    v_bfi_b32 v36, s98, v58, v36
    v_bfi_b32 v37, s98, v57, v37
    v_bfi_b32 v38, s98, v56, v38
    v_bfi_b32 v39, s98, v55, v39
    buffer_store_dwordx4 v[36:39], v7, s[72:75], s96 offen sc1
    v_mov_b32 v6, s97
    ds_write_b8 v6, v5 offset:200
    s_mov_b32 s87, 1
    s_branch KS_L2B
KS_L0:
    s_and_b32 s92, s41, 15
    s_lshl_b32 s93, s40, 4
    s_add_u32 s92, s92, s93
    v_and_b32 v59, 3, v1
    v_lshlrev_b32 v59, 2, v59
    s_lshl_b32 s96, s92, 6
    s_add_u32 s93, s96, 0xb00000
    v_add_u32 v7, s93, v59
    s_mul_i32 s93, s92, 18560
    s_add_u32 s93, s93, 0x600000
    v_lshlrev_b32 v6, 4, v0
    v_mov_b32 v12, -1
    v_mov_b32 v13, -1
    v_mov_b32 v14, -1
    v_mov_b32 v15, -1
    s_setprio 3
    v_mul_u32_u24 v16, 57, v1
    v_lshrrev_b32 v16, 9, v16
    v_mul_u32_u24 v17, 9, v16
    v_sub_u32 v17, v1, v17
    v_mul_u32_u24 v16, 9216, v16
    v_lshl_add_u32 v16, v17, 7, v16
    s_waitcnt lgkmcnt(0)
    s_add_u32 s68, s36, s93
    s_addc_u32 s69, s37, 0
    s_mov_b32 s70, 18560
    s_mov_b32 s71, 0x20000
    s_barrier
W_60:
    s_sleep 2
    ds_read_b32 v8, v4 offset:36
    s_sub_u32 s39, s39, 1
    s_cbranch_scc1 KS_ABORT
    s_waitcnt lgkmcnt(0)
    v_cmp_eq_u32 vcc, 0, v8
    s_cbranch_vccnz W_60
    s_mov_b32 s92, 0
    buffer_store_dwordx4 v[12:15], v6, s[68:71], s92 offen sc1
    s_mov_b32 s92, 4096
    buffer_store_dwordx4 v[12:15], v6, s[68:71], s92 offen sc1
    s_mov_b32 s92, 8192
    buffer_store_dwordx4 v[12:15], v6, s[68:71], s92 offen sc1
    s_mov_b32 s92, 12288
    buffer_store_dwordx4 v[12:15], v6, s[68:71], s92 offen sc1
    s_mov_b32 s92, 16384
    buffer_store_dwordx4 v[12:15], v6, s[68:71], s92 offen sc1
    global_load_dword v58, v59, s[34:35] sc1
    s_waitcnt vmcnt(0)
DBP_61:
    v_cmp_eq_u32 vcc, 0, v58
    s_cbranch_vccz DBG_62
    s_sleep 1
    global_load_dword v58, v59, s[34:35] sc1
    s_sub_u32 s39, s39, 1
    s_cbranch_scc1 KS_ABORT
    s_waitcnt vmcnt(0)
    s_branch DBP_61
DBG_62:
    ds_write_b32 v59, v58 offset:224
    s_mov_b64 exec, 1
    ds_add_rtn_u32 v8, v4, v5 offset:8
    s_mov_b64 exec, -1
    v_lshrrev_b32 v57, 3, v58
    v_lshrrev_b32 v56, 6, v58
    v_lshrrev_b32 v55, 9, v58
    s_waitcnt lgkmcnt(0)
    v_readfirstlane_b32 s92, v8
    s_cmp_lg_u32 s92, 3
    s_cbranch_scc1 KS_L2
    s_mov_b64 exec, 15
    global_store_dword v7, v58, s[36:37] sc1
    s_mov_b64 exec, -1
    s_and_b32 s94, s41, 7
    s_cmp_ge_u32 s41, 8
    s_cbranch_scc1 KS_L1C
    s_branch KS_L2
KS_L1C:
    s_bitcmp1_b32 s94, 0
    s_cselect_b32 s72, s28, s26
    s_cselect_b32 s73, s29, s27
    s_mov_b32 s74, 0x510000
    s_mov_b32 s75, 0x20000
    s_lshr_b32 s95, s94, 1
    s_mul_i32 s95, s95, 64512
    s_mul_i32 s96, s40, 1152
    s_add_u32 s95, s95, s96
    s_add_u32 s96, s95, 3419136
    buffer_load_dword v18, v16, s[72:75], s96 offen nt
    buffer_load_dword v18, v16, s[72:75], s96 offen sc1
    s_add_u32 s96, s95, 3677184
    buffer_load_dword v18, v16, s[72:75], s96 offen nt
    buffer_load_dword v18, v16, s[72:75], s96 offen sc1
    s_add_u32 s96, s95, 3935232
    buffer_load_dword v18, v16, s[72:75], s96 offen nt
    buffer_load_dword v18, v16, s[72:75], s96 offen sc1
    s_add_u32 s96, s95, 4193280
    buffer_load_dword v18, v16, s[72:75], s96 offen nt
    buffer_load_dword v18, v16, s[72:75], s96 offen sc1
KS_L2:
    s_mov_b32 s87, 0
KS_L2B:
    s_mov_b32 s64, s36
    s_mov_b32 s65, s37
    s_mov_b32 s66, 0x240000
    s_mov_b32 s67, 0x20000
    v_lshrrev_b32 v7, 1, v1
    v_lshlrev_b32 v7, 6, v7
    v_and_b32 v10, 1, v1
    v_lshl_add_u32 v7, v10, 4, v7
    v_lshlrev_b32 v9, 4, v1
    s_lshl_b32 s92, s38, 11
    s_lshl_b32 s93, s90, 13
    s_add_u32 s93, s93, s92
    s_lshl_b32 s94, s90, 7
    s_and_b32 s95, s94, 0x380
    v_xor_b32 v13, s95, v9
    s_and_b32 s94, s94, 0x1c00
    s_xor_b32 s93, s93, s94
    s_xor_b32 s97, s93, 0x400
    s_lshl_b32 s95, s40, 3
    s_add_u32 s95, s95, s41
    s_add_u32 s95, s95, 488
    s_lshr_b32 s96, s95, 1
    s_lshl_b32 s96, s96, 13
    s_and_b32 s95, s95, 1
    s_lshl_b32 s95, s95, 5
    s_add_u32 s95, s95, s96
    s_add_u32 s95, s95, s92
    s_lshr_b32 s96, s96, 6
    s_and_b32 s94, s96, 0x780
    v_xor_b32 v7, s94, v7
    s_and_b32 s96, s96, 0x1800
    s_xor_b32 s95, s95, s96
    s_cmp_lt_u32 s41, 24
    s_cselect_b32 s95, 2359296, s95
    s_cselect_b32 s94, 0, 0x70007
    v_mov_b32_dpp v64, v58 quad_perm:[0,1,0,1] row_mask:0xf bank_mask:0xf
    v_mov_b32_dpp v65, v58 quad_perm:[2,3,2,3] row_mask:0xf bank_mask:0xf
    s_bitcmp1_b32 s41, 0
    s_cselect_b64 vcc, -1, 0
    v_cndmask_b32 v64, v64, v65, vcc
    v_and_b32 v60, 0x70007, v58
    v_and_b32 v61, 0x70007, v57
    v_and_b32 v62, 0x70007, v56
    v_and_b32 v63, 0x70007, v55
    v_lshrrev_b32 v67, 9, v64
    v_lshrrev_b32 v66, 6, v64
    v_lshrrev_b32 v65, 3, v64
    v_and_b32 v64, s94, v64
    v_and_b32 v65, s94, v65
    v_and_b32 v66, s94, v66
    v_and_b32 v67, s94, v67
    s_lshl_b32 s96, s38, 10
    s_add_u32 s96, s96, 3552
    v_bfe_u32 v11, v1, 1, 1
    v_mul_u32_u24 v11, 4672, v11
    v_lshl_add_u32 v11, v10, 4, v11
    v_lshrrev_b32 v10, 2, v1
    v_lshl_add_u32 v11, v10, 5, v11
    v_add_u32 v11, s96, v11
    v_add_u32 v10, s96, v9
    v_mov_b32 v116, s38
    s_add_u32 s92, s92, 0xb00000
    v_lshrrev_b32 v12, 2, v1
    v_lshl_add_u32 v12, v12, 6, v59
    v_add_u32 v12, s92, v12
    s_cmp_lt_u32 s41, 8
    s_cselect_b32 s94, 20, 20
    s_cmp_ge_u32 s41, 24
    s_cselect_b32 s94, 24, s94
    v_mov_b32 v14, s94
    s_setprio 0
    ds_write_b8 v116, v5 offset:204
W_63:
    s_sleep 2
    ds_read_b32 v8, v14 offset:64
    s_sub_u32 s39, s39, 1
    s_cbranch_scc1 KS_ABORT
    s_waitcnt lgkmcnt(0)
    v_cmp_ne_u32 vcc, s84, v8
    s_cbranch_vccnz W_63
    s_setprio 3
    s_branch UPE_65
UP_64:
    s_sleep 2
UPE_65:
    global_load_dword v32, v12, s[36:37] sc1
    global_load_dword v33, v12, s[36:37] offset:1024 sc1
    buffer_load_dwordx4 v[20:23], v13, s[64:67], s93 offen sc1
    buffer_load_dwordx4 v[24:27], v13, s[64:67], s97 offen sc1
    buffer_load_dwordx4 v[28:31], v7, s[64:67], s95 offen sc1
    s_sub_u32 s39, s39, 1
    s_cbranch_scc1 KS_ABORT
    s_waitcnt vmcnt(2)
    v_xor_b32 v32, v58, v32
    v_xor_b32 v33, v58, v33
    v_xor_b32 v20, v60, v20
    v_xor_b32 v21, v61, v21
    v_xor_b32 v22, v62, v22
    v_xor_b32 v23, v63, v23
    v_or3_b32 v44, v20, v21, v21
    v_or3_b32 v44, v22, v23, v44
    s_waitcnt vmcnt(1)
    v_xor_b32 v24, v60, v24
    v_xor_b32 v25, v61, v25
    v_xor_b32 v26, v62, v26
    v_xor_b32 v27, v63, v27
    v_or3_b32 v44, v24, v25, v44
    v_or3_b32 v44, v26, v27, v44
    s_waitcnt vmcnt(0)
    v_xor_b32 v28, v64, v28
    v_xor_b32 v29, v65, v29
    v_xor_b32 v30, v66, v30
    v_xor_b32 v31, v67, v31
    v_or3_b32 v44, v28, v29, v44
    v_or3_b32 v44, v30, v31, v44
    v_and_b32 v44, 0x70007, v44
    v_or3_b32 v44, v44, v32, v33
    v_cmp_ne_u32 vcc, 0, v44
    s_cbranch_vccnz UP_64
    ds_write_b128 v11, v[20:23]
    ds_write_b128 v11, v[24:27] offset:512
    ds_write_b128 v10, v[28:31] offset:9344
    ds_write_b8 v116, v5 offset:16
    s_cmp_eq_u32 s38, 2
    s_cbranch_scc1 WJ2_68
    s_add_u32 s92, s38, 1
    s_lshr_b32 s92, s92, 2
    s_cmp_eq_u32 s38, 1
    s_cselect_b32 s92, 2, s92
    s_lshl_b32 s92, s92, 10
    v_lshl_add_u32 v10, v1, 4, s92
    v_add_u32 v11, 35840, v10
W_69:
    ds_read_b32 v12, v4 offset:16
    s_sub_u32 s39, s39, 1
    s_cbranch_scc1 KS_ABORT
    s_waitcnt lgkmcnt(0)
    v_cmp_ne_u32 vcc, s84, v12
    s_cbranch_vccnz W_69
    s_setprio 3
    ds_read_b128 v[20:23], v10 offset:3520
    ds_read_b128 v[24:27], v10 offset:3536
    ds_read_b64 v[28:29], v10 offset:3552
    ds_read_b128 v[32:35], v10 offset:8192
    ds_read_b128 v[36:39], v10 offset:8208
    ds_read_b64 v[40:41], v10 offset:8224
    ds_read_b128 v[44:47], v10 offset:12864
    ds_read_b128 v[48:51], v10 offset:12880
    ds_read_b64 v[52:53], v10 offset:12896
    s_cmp_eq_u32 s38, 1
    s_cbranch_scc1 WJ1_67
    ds_read_b32 v12, v4 offset:68
    s_waitcnt lgkmcnt(7)
    v_alignbit_b32 v57, v22, v21, 16
    v_alignbit_b32 v58, v23, v22, 16
    v_alignbit_b32 v59, v24, v23, 16
    v_alignbit_b32 v60, v25, v24, 16
    v_alignbit_b32 v61, v26, v25, 16
    v_alignbit_b32 v62, v27, v26, 16
    v_alignbit_b32 v63, v28, v27, 16
    v_alignbit_b32 v64, v29, v28, 16
    v_pk_add_f16 v66, v57, v22
    v_pk_add_f16 v67, v58, v23
    v_pk_add_f16 v68, v59, v24
    v_pk_add_f16 v69, v60, v25
    v_pk_add_f16 v70, v61, v26
    v_pk_add_f16 v71, v62, v27
    v_pk_add_f16 v72, v63, v28
    v_pk_add_f16 v73, v64, v29
    v_pk_add_f16 v80, v66, v58
    v_pk_add_f16 v81, v67, v59
    v_pk_add_f16 v82, v68, v60
    v_pk_add_f16 v83, v69, v61
    v_pk_add_f16 v74, v67, v68
    v_pk_add_f16 v75, v68, v69
    v_pk_add_f16 v76, v69, v70
    v_pk_add_f16 v77, v70, v71
    v_pk_add_f16 v78, v71, v72
    v_pk_add_f16 v79, v72, v73
    s_waitcnt lgkmcnt(0)
    v_cmp_eq_u32 vcc, s84, v12
    s_cbranch_vccnz WJK_70
W_71:
    s_sleep 1
    ds_read_b32 v12, v4 offset:68
    s_sub_u32 s39, s39, 1
    s_cbranch_scc1 KS_ABORT
    s_waitcnt lgkmcnt(0)
    v_cmp_ne_u32 vcc, s84, v12
    s_cbranch_vccnz W_71
WJK_70:
    ds_write_b128 v11, v[80:83] offset:0
    v_pk_add_f16 v87, v22, v74
    v_pk_add_f16 v88, v23, v75
    v_pk_add_f16 v89, v24, v76
    v_pk_add_f16 v90, v25, v77
    v_pk_add_f16 v91, v26, v78
    ds_write_b128 v11, v[88:91] offset:3104
    v_pk_add_f16 v84, v70, v62
    v_pk_add_f16 v85, v71, v63
    v_pk_add_f16 v86, v72, v64
    v_pk_add_f16 v92, v74, v83
    v_pk_add_f16 v93, v75, v84
    v_pk_add_f16 v94, v76, v85
    v_pk_add_f16 v95, v77, v86
    ds_write_b128 v11, v[92:95] offset:6176
    v_pk_add_f16 v96, v87, v76
    v_pk_add_f16 v97, v88, v77
    v_pk_add_f16 v98, v89, v78
    v_pk_add_f16 v99, v90, v79
    ds_write_b128 v11, v[96:99] offset:8240
    ds_write_b8 v116, v5 offset:76
    ds_read_b32 v12, v4 offset:84
    v_alignbit_b32 v57, v34, v33, 16
    v_alignbit_b32 v58, v35, v34, 16
    v_alignbit_b32 v59, v36, v35, 16
    v_alignbit_b32 v60, v37, v36, 16
    v_alignbit_b32 v61, v38, v37, 16
    v_alignbit_b32 v62, v39, v38, 16
    v_alignbit_b32 v63, v40, v39, 16
    v_alignbit_b32 v64, v41, v40, 16
    v_pk_add_f16 v66, v57, v34
    v_pk_add_f16 v67, v58, v35
    v_pk_add_f16 v68, v59, v36
    v_pk_add_f16 v69, v60, v37
    v_pk_add_f16 v70, v61, v38
    v_pk_add_f16 v71, v62, v39
    v_pk_add_f16 v72, v63, v40
    v_pk_add_f16 v73, v64, v41
    v_pk_add_f16 v80, v66, v58
    v_pk_add_f16 v81, v67, v59
    v_pk_add_f16 v82, v68, v60
    v_pk_add_f16 v83, v69, v61
    v_pk_add_f16 v74, v67, v68
    v_pk_add_f16 v75, v68, v69
    v_pk_add_f16 v76, v69, v70
    v_pk_add_f16 v77, v70, v71
    v_pk_add_f16 v78, v71, v72
    v_pk_add_f16 v79, v72, v73
    s_waitcnt lgkmcnt(0)
    v_cmp_eq_u32 vcc, s84, v12
    s_cbranch_vccnz WJK_72
W_73:
    s_sleep 1
    ds_read_b32 v12, v4 offset:84
    s_sub_u32 s39, s39, 1
    s_cbranch_scc1 KS_ABORT
    s_waitcnt lgkmcnt(0)
    v_cmp_ne_u32 vcc, s84, v12
    s_cbranch_vccnz W_73
WJK_72:
    ds_write_b128 v11, v[80:83] offset:36672
    v_pk_add_f16 v87, v34, v74
    v_pk_add_f16 v88, v35, v75
    v_pk_add_f16 v89, v36, v76
    v_pk_add_f16 v90, v37, v77
    v_pk_add_f16 v91, v38, v78
    ds_write_b128 v11, v[88:91] offset:39776
    v_pk_add_f16 v84, v70, v62
    v_pk_add_f16 v85, v71, v63
    v_pk_add_f16 v86, v72, v64
    v_pk_add_f16 v92, v74, v83
    v_pk_add_f16 v93, v75, v84
    v_pk_add_f16 v94, v76, v85
    v_pk_add_f16 v95, v77, v86
    ds_write_b128 v11, v[92:95] offset:42848
    v_pk_add_f16 v96, v87, v76
    v_pk_add_f16 v97, v88, v77
    v_pk_add_f16 v98, v89, v78
    v_pk_add_f16 v99, v90, v79
    ds_write_b128 v11, v[96:99] offset:44912
    ds_write_b8 v116, v5 offset:92
    s_cmp_lt_u32 s41, 24
    s_cbranch_scc1 WJE_66
    ds_read_b32 v12, v4 offset:100
    v_alignbit_b32 v57, v46, v45, 16
    v_alignbit_b32 v58, v47, v46, 16
    v_alignbit_b32 v59, v48, v47, 16
    v_alignbit_b32 v60, v49, v48, 16
    v_alignbit_b32 v61, v50, v49, 16
    v_alignbit_b32 v62, v51, v50, 16
    v_alignbit_b32 v63, v52, v51, 16
    v_alignbit_b32 v64, v53, v52, 16
    v_pk_add_f16 v66, v57, v46
    v_pk_add_f16 v67, v58, v47
    v_pk_add_f16 v68, v59, v48
    v_pk_add_f16 v69, v60, v49
    v_pk_add_f16 v70, v61, v50
    v_pk_add_f16 v71, v62, v51
    v_pk_add_f16 v72, v63, v52
    v_pk_add_f16 v73, v64, v53
    v_pk_add_f16 v80, v66, v58
    v_pk_add_f16 v81, v67, v59
    v_pk_add_f16 v82, v68, v60
    v_pk_add_f16 v83, v69, v61
    v_pk_add_f16 v74, v67, v68
    v_pk_add_f16 v75, v68, v69
    v_pk_add_f16 v76, v69, v70
    v_pk_add_f16 v77, v70, v71
    v_pk_add_f16 v78, v71, v72
    v_pk_add_f16 v79, v72, v73
    s_waitcnt lgkmcnt(0)
    v_cmp_eq_u32 vcc, s84, v12
    s_cbranch_vccnz WJK_74
W_75:
    s_sleep 1
    ds_read_b32 v12, v4 offset:100
    s_sub_u32 s39, s39, 1
    s_cbranch_scc1 KS_ABORT
    s_waitcnt lgkmcnt(0)
    v_cmp_ne_u32 vcc, s84, v12
    s_cbranch_vccnz W_75
WJK_74:
    v_add_u32 v11, 73344, v11
    ds_write_b128 v11, v[80:83] offset:0
    v_pk_add_f16 v87, v46, v74
    v_pk_add_f16 v88, v47, v75
    v_pk_add_f16 v89, v48, v76
    v_pk_add_f16 v90, v49, v77
    v_pk_add_f16 v91, v50, v78
    ds_write_b128 v11, v[88:91] offset:3104
    v_pk_add_f16 v84, v70, v62
    v_pk_add_f16 v85, v71, v63
    v_pk_add_f16 v86, v72, v64
    v_pk_add_f16 v92, v74, v83
    v_pk_add_f16 v93, v75, v84
    v_pk_add_f16 v94, v76, v85
    v_pk_add_f16 v95, v77, v86
    ds_write_b128 v11, v[92:95] offset:6176
    v_pk_add_f16 v96, v87, v76
    v_pk_add_f16 v97, v88, v77
    v_pk_add_f16 v98, v89, v78
    v_pk_add_f16 v99, v90, v79
    ds_write_b128 v11, v[96:99] offset:8240
    ds_write_b8 v116, v5 offset:108
    s_branch WJE_66
WJ1_67:
    ds_read_b32 v12, v4 offset:68
    s_waitcnt lgkmcnt(7)
    v_alignbit_b32 v57, v22, v21, 16
    v_alignbit_b32 v58, v23, v22, 16
    v_alignbit_b32 v59, v24, v23, 16
    v_alignbit_b32 v60, v25, v24, 16
    v_alignbit_b32 v61, v26, v25, 16
    v_alignbit_b32 v62, v27, v26, 16
    v_alignbit_b32 v63, v28, v27, 16
    v_pk_add_f16 v66, v57, v22
    v_pk_add_f16 v67, v58, v23
    v_pk_add_f16 v68, v59, v24
    v_pk_add_f16 v69, v60, v25
    v_pk_add_f16 v70, v61, v26
    v_pk_add_f16 v71, v62, v27
    v_pk_add_f16 v72, v63, v28
    v_pk_add_f16 v80, v66, v58
    v_pk_add_f16 v81, v67, v59
    v_pk_add_f16 v82, v68, v60
    v_pk_add_f16 v83, v69, v61
    v_pk_add_f16 v75, v68, v69
    v_pk_add_f16 v76, v69, v70
    v_pk_add_f16 v77, v70, v71
    v_pk_add_f16 v78, v71, v72
    s_waitcnt lgkmcnt(0)
    v_cmp_eq_u32 vcc, s84, v12
    s_cbranch_vccnz WJK_76
W_77:
    s_sleep 1
    ds_read_b32 v12, v4 offset:68
    s_sub_u32 s39, s39, 1
    s_cbranch_scc1 KS_ABORT
    s_waitcnt lgkmcnt(0)
    v_cmp_ne_u32 vcc, s84, v12
    s_cbranch_vccnz W_77
WJK_76:
    ds_write_b128 v11, v[80:83] offset:0
    v_pk_add_f16 v88, v23, v75
    v_pk_add_f16 v89, v24, v76
    v_pk_add_f16 v90, v25, v77
    v_pk_add_f16 v91, v26, v78
    ds_write_b128 v11, v[88:91] offset:3104
    ds_write_b8 v116, v5 offset:76
    ds_read_b32 v12, v4 offset:84
    v_alignbit_b32 v57, v34, v33, 16
    v_alignbit_b32 v58, v35, v34, 16
    v_alignbit_b32 v59, v36, v35, 16
    v_alignbit_b32 v60, v37, v36, 16
    v_alignbit_b32 v61, v38, v37, 16
    v_alignbit_b32 v62, v39, v38, 16
    v_alignbit_b32 v63, v40, v39, 16
    v_pk_add_f16 v66, v57, v34
    v_pk_add_f16 v67, v58, v35
    v_pk_add_f16 v68, v59, v36
    v_pk_add_f16 v69, v60, v37
    v_pk_add_f16 v70, v61, v38
    v_pk_add_f16 v71, v62, v39
    v_pk_add_f16 v72, v63, v40
    v_pk_add_f16 v80, v66, v58
    v_pk_add_f16 v81, v67, v59
    v_pk_add_f16 v82, v68, v60
    v_pk_add_f16 v83, v69, v61
    v_pk_add_f16 v75, v68, v69
    v_pk_add_f16 v76, v69, v70
    v_pk_add_f16 v77, v70, v71
    v_pk_add_f16 v78, v71, v72
    s_waitcnt lgkmcnt(0)
    v_cmp_eq_u32 vcc, s84, v12
    s_cbranch_vccnz WJK_78
W_79:
    s_sleep 1
    ds_read_b32 v12, v4 offset:84
    s_sub_u32 s39, s39, 1
    s_cbranch_scc1 KS_ABORT
    s_waitcnt lgkmcnt(0)
    v_cmp_ne_u32 vcc, s84, v12
    s_cbranch_vccnz W_79
WJK_78:
    ds_write_b128 v11, v[80:83] offset:36672
    v_pk_add_f16 v88, v35, v75
    v_pk_add_f16 v89, v36, v76
    v_pk_add_f16 v90, v37, v77
    v_pk_add_f16 v91, v38, v78
    ds_write_b128 v11, v[88:91] offset:39776
    ds_write_b8 v116, v5 offset:92
    s_cmp_lt_u32 s41, 24
    s_cbranch_scc1 WJE_66
    ds_read_b32 v12, v4 offset:100
    v_alignbit_b32 v57, v46, v45, 16
    v_alignbit_b32 v58, v47, v46, 16
    v_alignbit_b32 v59, v48, v47, 16
    v_alignbit_b32 v60, v49, v48, 16
    v_alignbit_b32 v61, v50, v49, 16
    v_alignbit_b32 v62, v51, v50, 16
    v_alignbit_b32 v63, v52, v51, 16
    v_pk_add_f16 v66, v57, v46
    v_pk_add_f16 v67, v58, v47
    v_pk_add_f16 v68, v59, v48
    v_pk_add_f16 v69, v60, v49
    v_pk_add_f16 v70, v61, v50
    v_pk_add_f16 v71, v62, v51
    v_pk_add_f16 v72, v63, v52
    v_pk_add_f16 v80, v66, v58
    v_pk_add_f16 v81, v67, v59
    v_pk_add_f16 v82, v68, v60
    v_pk_add_f16 v83, v69, v61
    v_pk_add_f16 v75, v68, v69
    v_pk_add_f16 v76, v69, v70
    v_pk_add_f16 v77, v70, v71
    v_pk_add_f16 v78, v71, v72
    s_waitcnt lgkmcnt(0)
    v_cmp_eq_u32 vcc, s84, v12
    s_cbranch_vccnz WJK_80
W_81:
    s_sleep 1
    ds_read_b32 v12, v4 offset:100
    s_sub_u32 s39, s39, 1
    s_cbranch_scc1 KS_ABORT
    s_waitcnt lgkmcnt(0)
    v_cmp_ne_u32 vcc, s84, v12
    s_cbranch_vccnz W_81
WJK_80:
    v_add_u32 v11, 73344, v11
    ds_write_b128 v11, v[80:83] offset:0
    v_pk_add_f16 v88, v47, v75
    v_pk_add_f16 v89, v48, v76
    v_pk_add_f16 v90, v49, v77
    v_pk_add_f16 v91, v50, v78
    ds_write_b128 v11, v[88:91] offset:3104
    ds_write_b8 v116, v5 offset:108
    s_branch WJE_66
WJ2_68:
    ds_write_b8 v116, v5 offset:76
    ds_write_b8 v116, v5 offset:92
    ds_write_b8 v116, v5 offset:108
    s_sub_u32 s94, s41, 18
    s_and_b32 s94, s94, 31
    s_cmp_ge_u32 s94, 14
    s_cbranch_scc1 WJE_66
    v_mul_u32_u24 v100, 57, v1
    v_lshrrev_b32 v100, 9, v100
    v_mul_u32_u24 v101, 9, v100
    v_sub_u32 v101, v1, v101
    v_mul_u32_u24 v100, 9216, v100
    v_lshl_add_u32 v100, v101, 7, v100
W_82:
    s_sleep 1
    ds_read_b32 v12, v4 offset:16
    s_sub_u32 s39, s39, 1
    s_cbranch_scc1 KS_ABORT
    s_waitcnt lgkmcnt(0)
    v_cmp_ne_u32 vcc, s84, v12
    s_cbranch_vccnz W_82
    s_bitcmp1_b32 s94, 0
    s_cselect_b32 s72, s28, s26
    s_cselect_b32 s73, s29, s27
    s_mov_b32 s74, 0x510000
    s_mov_b32 s75, 0x20000
    s_lshr_b32 s95, s94, 1
    s_mul_i32 s95, s95, 64512
    s_mul_i32 s96, s40, 1152
    s_add_u32 s95, s95, s96
    s_add_u32 s96, s95, 4451328
    buffer_load_dword v102, v100, s[72:75], s96 offen nt
    buffer_load_dword v102, v100, s[72:75], s96 offen sc1
    s_add_u32 s96, s95, 4902912
    buffer_load_dword v102, v100, s[72:75], s96 offen nt
    buffer_load_dword v102, v100, s[72:75], s96 offen sc1
KS_PF2D:
WJE_66:
    s_setprio 0
    s_lshr_b32 s92, s90, 6
    s_lshl_b32 s92, s92, 9
    s_bfe_u32 s93, s90, 0x20004
    s_lshl_b32 s93, s93, 6
    s_add_u32 s92, s92, s93
    s_and_b32 s93, s90, 3
    s_lshl_b32 s93, s93, 4
    s_add_u32 s92, s92, s93
    s_and_b32 s93, s90, 12
    s_add_u32 s92, s92, s93
    s_lshr_b32 s93, s38, 1
    s_lshl_b32 s93, s93, 8
    s_add_u32 s92, s92, s93
    s_and_b32 s93, s38, 1
    s_lshl_b32 s93, s93, 1
    s_add_u32 s92, s92, s93
    v_lshrrev_b32 v113, 5, v1
    v_and_b32 v114, 31, v1
    v_add_u32 v112, s92, v113
    v_mul_u32_u24 v115, 1152, v112
    v_lshl_add_u32 v8, v114, 2, v115
    v_lshl_add_u32 v115, v114, 4, v115
    v_lshlrev_b32 v7, 2, v114
    v_lshlrev_b32 v6, 4, v114
    v_bfe_u32 v111, v1, 3, 1
    v_add_u32 v111, s92, v111
    v_mul_u32_u24 v111, 1152, v111
    v_and_b32 v9, 7, v1
    v_lshl_add_u32 v111, v9, 4, v111
    s_mov_b32 s64, s4
    s_mov_b32 s65, s5
    s_mov_b32 s66, 0x240000
    s_mov_b32 s67, 0x20000
    s_mov_b32 s68, s24
    s_mov_b32 s69, s25
    s_mov_b32 s70, 0x480
    s_mov_b32 s71, 0x20000
    buffer_load_dwordx4 v[10:13], v115, s[64:67], 0 offen
    buffer_load_dwordx4 v[14:17], v115, s[64:67], 0 offen offset:512
    buffer_load_dword v18, v8, s[64:67], 0 offen offset:1024
    buffer_load_dwordx4 v[50:53], v6, s[68:71], 0 offen
    buffer_load_dwordx4 v[54:57], v6, s[68:71], 0 offen offset:512
    buffer_load_dword v58, v7, s[68:71], 0 offen offset:1024
KS_L4:
    s_add_u32 s64, s36, 0x600000
    s_addc_u32 s65, s37, 0
    s_mov_b32 s66, 0x240000
    s_mov_b32 s67, 0x20000
    s_mov_b32 s68, s32
    s_mov_b32 s69, s33
    s_mov_b32 s70, 0x240000
    s_mov_b32 s71, 0x20000
    s_mov_b32 s72, s36
    s_mov_b32 s73, s37
    s_mov_b32 s74, 0x240000
    s_mov_b32 s75, 0x20000
    s_add_u32 s76, s36, 0x840000
    s_addc_u32 s77, s37, 0
    s_mov_b32 s78, 0x4000
    s_mov_b32 s79, 0x20000
    s_not_b32 s93, s90
    v_xor_b32 v8, s93, v0
    v_lshrrev_b32 v6, 1, v0
    v_lshlrev_b32 v6, 6, v6
    v_and_b32 v8, 1, v8
    v_lshl_add_u32 v6, v8, 4, v6
    s_lshr_b32 s92, s90, 2
    s_lshl_b32 s92, s92, 15
    s_and_b32 s93, s90, 1
    s_lshl_b32 s93, s93, 14
    s_add_u32 s92, s92, s93
    s_and_b32 s93, s90, 2
    s_lshl_b32 s93, s93, 4
    s_add_u32 s92, s92, s93
    s_lshr_b32 s94, s90, 2
    s_lshl_b32 s94, s94, 12
    s_and_b32 s93, s90, 3
    s_lshl_b32 s93, s93, 4
    s_add_u32 s94, s94, s93
    s_lshl_b32 s93, s38, 10
    s_add_u32 s94, s94, s93
    s_add_u32 s94, s94, 0x200000
    v_lshlrev_b32 v9, 6, v2
    s_lshl_b32 s93, s90, 5
    s_and_b32 s95, s93, 0x1f80
    v_xor_b32 v6, s95, v6
    s_and_b32 s95, s93, 0x380
    v_xor_b32 v9, s95, v9
    s_and_b32 s95, s93, 0xc00
    s_xor_b32 s94, s94, s95
    s_and_b32 s93, s90, 1
    s_lshl_b32 s93, s93, 13
    s_xor_b32 s92, s92, s93
    s_xor_b32 s93, s92, 0x2000
    s_mul_i32 s95, s38, 2304
    s_add_u32 s95, s95, 17088
    v_lshl_add_u32 v117, v114, 5, s95
    v_lshl_add_u32 v110, v114, 3, s95
    s_lshl_b32 s95, s38, 9
    s_add_u32 s95, s95, 26368
    v_lshl_add_u32 v108, v1, 2, s95
    v_lshl_add_u32 v109, v1, 4, s95
    s_mov_b32 s95, 0x02020000
    v_mul_lo_u32 v118, v113, s95
    v_add_u32 v118, 0x01000c0c, v118
    v_lshlrev_b32 v8, 2, v0
    v_add_u32 v8, 17088, v8
    s_lshl_b32 s95, s38, 6
    s_add_u32 s95, s95, 19136
    v_lshl_add_u32 v119, v2, 2, s95
    s_waitcnt vmcnt(0)
    v_lshlrev_b32 v20, 16, v10
    v_and_b32 v21, 0xffff0000, v10
    v_lshlrev_b32 v22, 16, v11
    v_and_b32 v23, 0xffff0000, v11
    v_lshlrev_b32 v24, 16, v12
    v_and_b32 v25, 0xffff0000, v12
    v_lshlrev_b32 v26, 16, v13
    v_and_b32 v27, 0xffff0000, v13
    v_lshlrev_b32 v28, 16, v14
    v_and_b32 v29, 0xffff0000, v14
    v_lshlrev_b32 v30, 16, v15
    v_and_b32 v31, 0xffff0000, v15
    v_lshlrev_b32 v32, 16, v16
    v_and_b32 v33, 0xffff0000, v16
    v_lshlrev_b32 v34, 16, v17
    v_and_b32 v35, 0xffff0000, v17
    v_lshlrev_b32 v36, 16, v18
    v_and_b32 v37, 0xffff0000, v18
    v_lshlrev_b32 v80, 16, v50
    v_and_b32 v81, 0xffff0000, v50
    v_lshlrev_b32 v82, 16, v51
    v_and_b32 v83, 0xffff0000, v51
    v_lshlrev_b32 v84, 16, v52
    v_and_b32 v85, 0xffff0000, v52
    v_lshlrev_b32 v86, 16, v53
    v_and_b32 v87, 0xffff0000, v53
    v_lshlrev_b32 v88, 16, v54
    v_and_b32 v89, 0xffff0000, v54
    v_lshlrev_b32 v90, 16, v55
    v_and_b32 v91, 0xffff0000, v55
    v_lshlrev_b32 v92, 16, v56
    v_and_b32 v93, 0xffff0000, v56
    v_lshlrev_b32 v94, 16, v57
    v_and_b32 v95, 0xffff0000, v57
    v_lshlrev_b32 v96, 16, v58
    v_and_b32 v97, 0xffff0000, v58
    v_pk_add_f32 v[78:79], v[80:81], v[82:83]
    v_pk_add_f32 v[78:79], v[78:79], v[84:85]
    v_pk_add_f32 v[78:79], v[78:79], v[86:87]
    v_pk_add_f32 v[78:79], v[78:79], v[88:89]
    v_pk_add_f32 v[78:79], v[78:79], v[90:91]
    v_pk_add_f32 v[78:79], v[78:79], v[92:93]
    v_pk_add_f32 v[78:79], v[78:79], v[94:95]
    v_pk_add_f32 v[78:79], v[78:79], v[96:97]
    v_add_f32 v78, v78, v79
    s_nop 1
    v_add_f32_dpp v78, v78, v78 row_ror:8 row_mask:0xf bank_mask:0xf
    s_nop 1
    v_add_f32_dpp v78, v78, v78 row_ror:4 row_mask:0xf bank_mask:0xf
    s_nop 1
    v_add_f32_dpp v78, v78, v78 row_ror:2 row_mask:0xf bank_mask:0xf
    s_nop 1
    v_add_f32_dpp v78, v78, v78 row_ror:1 row_mask:0xf bank_mask:0xf
    v_mov_b32 v79, v78
    s_nop 1
    v_permlane16_swap_b32 v78, v79
    v_add_f32 v78, v78, v79
    v_sub_u32 v98, 0x87ff, v112
    v_lshl_add_u32 v99, v116, 1, v113
    v_lshlrev_b32 v99, 2, v99
    s_lshl_b32 s97, s90, 5
W_83:
    s_sleep 1
    ds_read_b32 v60, v4 offset:52
    s_sub_u32 s39, s39, 1
    s_cbranch_scc1 KS_ABORT
    s_waitcnt lgkmcnt(0)
    v_cmp_ne_u32 vcc, s84, v60
    s_cbranch_vccnz W_83
    s_setprio 3
    s_branch ZPE_85
ZP_84:
    s_sleep 1
ZPE_85:
    buffer_load_dwordx4 v[68:71], v4, s[64:67], s94 offen sc1
    s_sub_u32 s39, s39, 1
    s_cbranch_scc1 KS_ABORT
    s_waitcnt vmcnt(0)
    v_max3_u32 v44, v68, v69, v70
    v_max_u32 v44, v44, v71
    v_cmp_eq_u32 vcc, -1, v44
    s_cbranch_vccnz ZP_84
    s_branch ZPE_87
ZP_86:
    s_sleep 1
ZPE_87:
    buffer_load_dwordx4 v[60:63], v6, s[64:67], s92 offen sc1
    buffer_load_dwordx4 v[64:67], v6, s[64:67], s93 offen sc1
    buffer_load_dwordx4 v[68:71], v9, s[64:67], s94 offen sc1
    s_sub_u32 s39, s39, 1
    s_cbranch_scc1 KS_ABORT
    s_waitcnt vmcnt(2)
    ds_write2st64_b32 v8, v60, v61 offset0:0 offset1:9
    ds_write2st64_b32 v8, v62, v63 offset0:18 offset1:27
    v_max3_u32 v44, v60, v61, v61
    v_max3_u32 v44, v62, v63, v44
    s_waitcnt vmcnt(1)
    ds_write2st64_b32 v8, v64, v65 offset0:4 offset1:13
    ds_write2st64_b32 v8, v66, v67 offset0:22 offset1:31
    v_max3_u32 v44, v64, v65, v44
    v_max3_u32 v44, v66, v67, v44
    s_waitcnt vmcnt(0)
    ds_write2st64_b32 v119, v68, v69 offset0:0 offset1:9
    ds_write2st64_b32 v119, v70, v71 offset0:18 offset1:27
    v_max3_u32 v44, v68, v69, v44
    v_max3_u32 v44, v70, v71, v44
    v_cmp_eq_u32 vcc, -1, v44
    s_cbranch_vccnz ZP_86
    ds_write_b8 v116, v5 offset:20
ZW_88:
    ds_read_b32 v44, v4 offset:20
    ds_read_b128 v[60:63], v117 offset:0
    ds_read_b128 v[64:67], v117 offset:16
    ds_read_b128 v[68:71], v117 offset:1024
    ds_read_b128 v[72:75], v117 offset:1040
    ds_read_b64 v[76:77], v110 offset:2048
    s_sub_u32 s39, s39, 1
    s_cbranch_scc1 KS_ABORT
    s_waitcnt lgkmcnt(5)
    v_cmp_ne_u32 vcc, s84, v44
    s_cbranch_vccnz ZW_88
    s_waitcnt lgkmcnt(4)
    v_perm_b32 v60, v60, v60, v118
    v_perm_b32 v61, v61, v61, v118
    v_pk_add_f32 v[20:21], v[60:61], v[20:21]
    v_pk_mul_f32 v[42:43], v[20:21], v[20:21]
    v_pk_mul_f32 v[44:45], v[20:21], v[80:81]
    v_perm_b32 v62, v62, v62, v118
    v_perm_b32 v63, v63, v63, v118
    v_pk_add_f32 v[22:23], v[62:63], v[22:23]
    v_pk_fma_f32 v[42:43], v[22:23], v[22:23], v[42:43]
    v_pk_fma_f32 v[44:45], v[22:23], v[82:83], v[44:45]
    v_pk_add_f32 v[40:41], v[22:23], v[20:21]
    s_waitcnt lgkmcnt(3)
    v_perm_b32 v64, v64, v64, v118
    v_perm_b32 v65, v65, v65, v118
    v_pk_add_f32 v[24:25], v[64:65], v[24:25]
    v_pk_fma_f32 v[42:43], v[24:25], v[24:25], v[42:43]
    v_pk_fma_f32 v[44:45], v[24:25], v[84:85], v[44:45]
    v_pk_add_f32 v[40:41], v[24:25], v[40:41]
    v_perm_b32 v66, v66, v66, v118
    v_perm_b32 v67, v67, v67, v118
    v_pk_add_f32 v[26:27], v[66:67], v[26:27]
    v_pk_fma_f32 v[42:43], v[26:27], v[26:27], v[42:43]
    v_pk_fma_f32 v[44:45], v[26:27], v[86:87], v[44:45]
    v_pk_add_f32 v[40:41], v[26:27], v[40:41]
    s_waitcnt lgkmcnt(2)
    v_perm_b32 v68, v68, v68, v118
    v_perm_b32 v69, v69, v69, v118
    v_pk_add_f32 v[28:29], v[68:69], v[28:29]
    v_pk_fma_f32 v[42:43], v[28:29], v[28:29], v[42:43]
    v_pk_fma_f32 v[44:45], v[28:29], v[88:89], v[44:45]
    v_pk_add_f32 v[40:41], v[28:29], v[40:41]
    v_perm_b32 v70, v70, v70, v118
    v_perm_b32 v71, v71, v71, v118
    v_pk_add_f32 v[30:31], v[70:71], v[30:31]
    v_pk_fma_f32 v[42:43], v[30:31], v[30:31], v[42:43]
    v_pk_fma_f32 v[44:45], v[30:31], v[90:91], v[44:45]
    v_pk_add_f32 v[40:41], v[30:31], v[40:41]
    s_waitcnt lgkmcnt(1)
    v_perm_b32 v72, v72, v72, v118
    v_perm_b32 v73, v73, v73, v118
    v_pk_add_f32 v[32:33], v[72:73], v[32:33]
    v_pk_fma_f32 v[42:43], v[32:33], v[32:33], v[42:43]
    v_pk_fma_f32 v[44:45], v[32:33], v[92:93], v[44:45]
    v_pk_add_f32 v[40:41], v[32:33], v[40:41]
    v_perm_b32 v74, v74, v74, v118
    v_perm_b32 v75, v75, v75, v118
    v_pk_add_f32 v[34:35], v[74:75], v[34:35]
    v_pk_fma_f32 v[42:43], v[34:35], v[34:35], v[42:43]
    v_pk_fma_f32 v[44:45], v[34:35], v[94:95], v[44:45]
    v_pk_add_f32 v[40:41], v[34:35], v[40:41]
    s_waitcnt lgkmcnt(0)
    v_perm_b32 v76, v76, v76, v118
    v_perm_b32 v77, v77, v77, v118
    v_pk_add_f32 v[36:37], v[76:77], v[36:37]
    v_pk_fma_f32 v[42:43], v[36:37], v[36:37], v[42:43]
    v_pk_fma_f32 v[44:45], v[36:37], v[96:97], v[44:45]
    v_pk_add_f32 v[40:41], v[36:37], v[40:41]
    v_add_f32 v42, v42, v43
    v_add_f32 v44, v44, v45
    v_add_f32 v40, v40, v41
    v_mov_b32 v41, v40
    v_permlane16_swap_b32 v42, v44
    s_nop 0
    v_permlane16_swap_b32 v40, v41
    v_add_f32 v42, v42, v44
    v_add_f32 v40, v40, v41
    s_nop 0
    v_add_f32_dpp v42, v42, v42 row_ror:8 row_mask:0xf bank_mask:0xf
    v_add_f32_dpp v40, v40, v40 row_ror:8 row_mask:0xf bank_mask:0xf
    s_nop 0
    v_add_f32_dpp v42, v42, v42 row_ror:4 row_mask:0xf bank_mask:0xf
    v_add_f32_dpp v40, v40, v40 row_ror:4 row_mask:0xf bank_mask:0xf
    s_nop 0
    v_add_f32_dpp v42, v42, v42 row_ror:2 row_mask:0xf bank_mask:0xf
    v_add_f32_dpp v40, v40, v40 row_ror:2 row_mask:0xf bank_mask:0xf
    s_nop 0
    v_add_f32_dpp v42, v42, v42 row_ror:1 row_mask:0xf bank_mask:0xf
    v_add_f32_dpp v40, v40, v40 row_ror:1 row_mask:0xf bank_mask:0xf
    v_mul_f32 v40, 0x3ae38e39, v40
    v_mov_b32 v44, v42
    v_cvt_pk_bf16_f32 v41, 0, v40
    v_mul_f32 v40, v40, v40
    v_permlane16_swap_b32 v42, v44
    v_mov_b32 v43, 0x3ae38e39
    v_fma_f32 v42, v42, v43, -v40
    v_fma_f32 v44, -v41, v78, v44
    v_max_f32 v42, 0, v42
    v_cvt_pk_bf16_f32 v42, 0, v42
    v_add_f32 v42, 0x3727c5ac, v42
    v_cvt_pk_bf16_f32 v42, 0, v42
    v_sqrt_f32 v42, v42
    s_nop 0
    v_cvt_pk_bf16_f32 v42, 0, v42
    v_rcp_f32 v42, v42
    s_nop 0
    v_mul_f32 v60, v44, v42
    v_cvt_pk_bf16_f32 v60, v60, v60
    v_ashrrev_i32 v61, 31, v60
    v_or_b32 v61, 0x80000000, v61
    s_mov_b32 s95, 0xffff0000
    v_xor_b32 v60, v60, v61
    v_and_or_b32 v60, v60, s95, v98
    v_mov_b32 v61, v60
    s_nop 1
    v_permlane32_swap_b32 v60, v61
    s_mov_b64 exec, 1
    buffer_store_dwordx2 v[60:61], v99, s[76:79], s97 offen sc1
    ds_write_b8 v116, v5 offset:12
    s_mov_b64 exec, -1
    s_setprio 2
    v_cvt_pk_bf16_f32 v20, 0, v20
    v_cvt_pk_bf16_f32 v21, 0, v21
    v_cvt_pk_bf16_f32 v22, 0, v22
    v_cvt_pk_bf16_f32 v23, 0, v23
    v_cvt_pk_bf16_f32 v24, 0, v24
    v_cvt_pk_bf16_f32 v25, 0, v25
    v_cvt_pk_bf16_f32 v26, 0, v26
    v_cvt_pk_bf16_f32 v27, 0, v27
    v_cvt_pk_bf16_f32 v28, 0, v28
    v_cvt_pk_bf16_f32 v29, 0, v29
    v_cvt_pk_bf16_f32 v30, 0, v30
    v_cvt_pk_bf16_f32 v31, 0, v31
    v_cvt_pk_bf16_f32 v32, 0, v32
    v_cvt_pk_bf16_f32 v33, 0, v33
    v_cvt_pk_bf16_f32 v34, 0, v34
    v_cvt_pk_bf16_f32 v35, 0, v35
    v_cvt_pk_bf16_f32 v36, 0, v36
    v_cvt_pk_bf16_f32 v37, 0, v37
    v_pk_add_f32 v[44:45], v[20:21], v[22:23]
    v_pk_add_f32 v[46:47], v[24:25], v[26:27]
    v_pk_add_f32 v[44:45], v[44:45], v[28:29]
    v_pk_add_f32 v[46:47], v[46:47], v[30:31]
    v_pk_add_f32 v[44:45], v[44:45], v[32:33]
    v_pk_add_f32 v[46:47], v[46:47], v[34:35]
    v_pk_add_f32 v[44:45], v[44:45], v[36:37]
    v_pk_add_f32 v[44:45], v[44:45], v[46:47]
    v_add_f32 v44, v44, v45
    s_nop 1
    v_add_f32_dpp v44, v44, v44 row_ror:8 row_mask:0xf bank_mask:0xf
    s_nop 1
    v_add_f32_dpp v44, v44, v44 row_ror:4 row_mask:0xf bank_mask:0xf
    s_nop 1
    v_add_f32_dpp v44, v44, v44 row_ror:2 row_mask:0xf bank_mask:0xf
    s_nop 1
    v_add_f32_dpp v44, v44, v44 row_ror:1 row_mask:0xf bank_mask:0xf
    v_mov_b32 v46, v44
    s_nop 1
    v_permlane16_swap_b32 v44, v46
    v_add_f32 v44, v44, v46
    v_mul_f32 v48, 0x3ae38e39, v44
    v_mov_b32 v49, v48
    v_cvt_pk_bf16_f32 v40, 0, v48
    v_cvt_pk_bf16_f32 v41, 0, v48
    v_pk_add_f32 v[42:43], v[20:21], v[48:49] neg_lo:[0,1] neg_hi:[0,1]
    v_pk_mul_f32 v[44:45], v[42:43], v[42:43]
    v_pk_add_f32 v[42:43], v[22:23], v[48:49] neg_lo:[0,1] neg_hi:[0,1]
    v_pk_mul_f32 v[46:47], v[42:43], v[42:43]
    v_pk_add_f32 v[42:43], v[24:25], v[48:49] neg_lo:[0,1] neg_hi:[0,1]
    v_pk_fma_f32 v[44:45], v[42:43], v[42:43], v[44:45]
    v_pk_add_f32 v[42:43], v[26:27], v[48:49] neg_lo:[0,1] neg_hi:[0,1]
    v_pk_fma_f32 v[46:47], v[42:43], v[42:43], v[46:47]
    v_pk_add_f32 v[42:43], v[28:29], v[48:49] neg_lo:[0,1] neg_hi:[0,1]
    v_pk_fma_f32 v[44:45], v[42:43], v[42:43], v[44:45]
    v_pk_add_f32 v[42:43], v[30:31], v[48:49] neg_lo:[0,1] neg_hi:[0,1]
    v_pk_fma_f32 v[46:47], v[42:43], v[42:43], v[46:47]
    v_pk_add_f32 v[42:43], v[32:33], v[48:49] neg_lo:[0,1] neg_hi:[0,1]
    v_pk_fma_f32 v[44:45], v[42:43], v[42:43], v[44:45]
    v_pk_add_f32 v[42:43], v[34:35], v[48:49] neg_lo:[0,1] neg_hi:[0,1]
    v_pk_fma_f32 v[46:47], v[42:43], v[42:43], v[46:47]
    v_pk_add_f32 v[42:43], v[36:37], v[48:49] neg_lo:[0,1] neg_hi:[0,1]
    v_pk_fma_f32 v[44:45], v[42:43], v[42:43], v[44:45]
    v_pk_add_f32 v[44:45], v[44:45], v[46:47]
    v_add_f32 v44, v44, v45
    s_nop 1
    v_add_f32_dpp v44, v44, v44 row_ror:8 row_mask:0xf bank_mask:0xf
    s_nop 1
    v_add_f32_dpp v44, v44, v44 row_ror:4 row_mask:0xf bank_mask:0xf
    s_nop 1
    v_add_f32_dpp v44, v44, v44 row_ror:2 row_mask:0xf bank_mask:0xf
    s_nop 1
    v_add_f32_dpp v44, v44, v44 row_ror:1 row_mask:0xf bank_mask:0xf
    v_mov_b32 v46, v44
    s_nop 1
    v_permlane16_swap_b32 v44, v46
    v_add_f32 v44, v44, v46
    v_mul_f32 v44, 0x3ae38e39, v44
    v_cvt_pk_bf16_f32 v44, 0, v44
    v_add_f32 v44, 0x3727c5ac, v44
    v_cvt_pk_bf16_f32 v44, 0, v44
    v_sqrt_f32 v44, v44
    s_nop 0
    v_cvt_pk_bf16_f32 v44, 0, v44
    v_rcp_f32 v42, v44
    s_nop 0
    v_mov_b32 v43, v42
    v_pk_add_f32 v[44:45], v[20:21], v[40:41] neg_lo:[0,1] neg_hi:[0,1]
    v_cvt_pk_bf16_f32 v44, 0, v44
    v_cvt_pk_bf16_f32 v45, 0, v45
    v_pk_mul_f32 v[44:45], v[44:45], v[42:43]
    v_cvt_pk_bf16_f32 v10, v44, v45
    v_cvt_pk_bf16_f32 v44, 0, v44
    v_cvt_pk_bf16_f32 v45, 0, v45
    v_pk_add_f32 v[20:21], v[44:45], v[20:21]
    v_pk_add_f32 v[44:45], v[22:23], v[40:41] neg_lo:[0,1] neg_hi:[0,1]
    v_cvt_pk_bf16_f32 v44, 0, v44
    v_cvt_pk_bf16_f32 v45, 0, v45
    v_pk_mul_f32 v[44:45], v[44:45], v[42:43]
    v_cvt_pk_bf16_f32 v11, v44, v45
    v_cvt_pk_bf16_f32 v44, 0, v44
    v_cvt_pk_bf16_f32 v45, 0, v45
    v_pk_add_f32 v[22:23], v[44:45], v[22:23]
    v_pk_add_f32 v[44:45], v[24:25], v[40:41] neg_lo:[0,1] neg_hi:[0,1]
    v_cvt_pk_bf16_f32 v44, 0, v44
    v_cvt_pk_bf16_f32 v45, 0, v45
    v_pk_mul_f32 v[44:45], v[44:45], v[42:43]
    v_cvt_pk_bf16_f32 v12, v44, v45
    v_cvt_pk_bf16_f32 v44, 0, v44
    v_cvt_pk_bf16_f32 v45, 0, v45
    v_pk_add_f32 v[24:25], v[44:45], v[24:25]
    v_pk_add_f32 v[44:45], v[26:27], v[40:41] neg_lo:[0,1] neg_hi:[0,1]
    v_cvt_pk_bf16_f32 v44, 0, v44
    v_cvt_pk_bf16_f32 v45, 0, v45
    v_pk_mul_f32 v[44:45], v[44:45], v[42:43]
    v_cvt_pk_bf16_f32 v13, v44, v45
    v_cvt_pk_bf16_f32 v44, 0, v44
    v_cvt_pk_bf16_f32 v45, 0, v45
    v_pk_add_f32 v[26:27], v[44:45], v[26:27]
    v_pk_add_f32 v[44:45], v[28:29], v[40:41] neg_lo:[0,1] neg_hi:[0,1]
    v_cvt_pk_bf16_f32 v44, 0, v44
    v_cvt_pk_bf16_f32 v45, 0, v45
    v_pk_mul_f32 v[44:45], v[44:45], v[42:43]
    v_cvt_pk_bf16_f32 v14, v44, v45
    v_cvt_pk_bf16_f32 v44, 0, v44
    v_cvt_pk_bf16_f32 v45, 0, v45
    v_pk_add_f32 v[28:29], v[44:45], v[28:29]
    v_pk_add_f32 v[44:45], v[30:31], v[40:41] neg_lo:[0,1] neg_hi:[0,1]
    v_cvt_pk_bf16_f32 v44, 0, v44
    v_cvt_pk_bf16_f32 v45, 0, v45
    v_pk_mul_f32 v[44:45], v[44:45], v[42:43]
    v_cvt_pk_bf16_f32 v15, v44, v45
    v_cvt_pk_bf16_f32 v44, 0, v44
    v_cvt_pk_bf16_f32 v45, 0, v45
    v_pk_add_f32 v[30:31], v[44:45], v[30:31]
    v_pk_add_f32 v[44:45], v[32:33], v[40:41] neg_lo:[0,1] neg_hi:[0,1]
    v_cvt_pk_bf16_f32 v44, 0, v44
    v_cvt_pk_bf16_f32 v45, 0, v45
    v_pk_mul_f32 v[44:45], v[44:45], v[42:43]
    v_cvt_pk_bf16_f32 v16, v44, v45
    v_cvt_pk_bf16_f32 v44, 0, v44
    v_cvt_pk_bf16_f32 v45, 0, v45
    v_pk_add_f32 v[32:33], v[44:45], v[32:33]
    v_pk_add_f32 v[44:45], v[34:35], v[40:41] neg_lo:[0,1] neg_hi:[0,1]
    v_cvt_pk_bf16_f32 v44, 0, v44
    v_cvt_pk_bf16_f32 v45, 0, v45
    v_pk_mul_f32 v[44:45], v[44:45], v[42:43]
    v_cvt_pk_bf16_f32 v17, v44, v45
    v_cvt_pk_bf16_f32 v44, 0, v44
    v_cvt_pk_bf16_f32 v45, 0, v45
    v_pk_add_f32 v[34:35], v[44:45], v[34:35]
    v_pk_add_f32 v[44:45], v[36:37], v[40:41] neg_lo:[0,1] neg_hi:[0,1]
    v_cvt_pk_bf16_f32 v44, 0, v44
    v_cvt_pk_bf16_f32 v45, 0, v45
    v_pk_mul_f32 v[44:45], v[44:45], v[42:43]
    v_cvt_pk_bf16_f32 v18, v44, v45
    v_cvt_pk_bf16_f32 v44, 0, v44
    v_cvt_pk_bf16_f32 v45, 0, v45
    v_pk_add_f32 v[36:37], v[44:45], v[36:37]
    v_cvt_pk_bf16_f32 v58, v36, v37
    ds_write_b32 v108, v18
    ds_write_b32 v108, v58 offset:256
    ds_read_b128 v[64:67], v109
    buffer_store_dwordx4 v[10:13], v115, s[72:75], 0 offen sc1
    buffer_store_dwordx4 v[14:17], v115, s[72:75], 0 offen offset:512 sc1
    v_cvt_pk_bf16_f32 v50, v20, v21
    v_cvt_pk_bf16_f32 v51, v22, v23
    v_cvt_pk_bf16_f32 v52, v24, v25
    v_cvt_pk_bf16_f32 v53, v26, v27
    v_cvt_pk_bf16_f32 v54, v28, v29
    v_cvt_pk_bf16_f32 v55, v30, v31
    v_cvt_pk_bf16_f32 v56, v32, v33
    v_cvt_pk_bf16_f32 v57, v34, v35
    s_mov_b64 exec, 0xffff
    s_waitcnt lgkmcnt(0)
    buffer_store_dwordx4 v[64:67], v111, s[72:75], 0 offen offset:1024 sc1
    s_mov_b64 exec, -1
    s_setprio 0
    s_add_u32 s80, s36, 0x850000
    s_addc_u32 s81, s37, 0
    s_mov_b32 s82, 0x148800
    s_mov_b32 s83, 0x20000
    v_bfe_u32 v16, v1, 2, 2
    v_lshl_add_u32 v16, v3, 3, v16
    v_mul_u32_u24 v16, 1152, v16
    v_and_b32 v17, 3, v1
    v_lshl_add_u32 v16, v17, 3, v16
    s_lshl_b32 s10, s38, 7
    s_add_u32 s11, s10, 109184
    v_add_u32 v16, s11, v16
    v_lshrrev_b32 v18, 2, v1
    v_mul_u32_u24 v18, 9344, v18
    v_lshl_add_u32 v18, v17, 4, v18
    s_mul_i32 s9, s38, 149504
    s_lshl_b32 s11, s89, 6
    s_add_u32 s9, s9, s11
    v_lshl_add_u32 v19, v17, 5, s10
    v_lshl_add_u32 v19, v3, 3, v19
    s_mul_i32 s8, s89, 9344
    s_lshl_b32 s11, s38, 10
    s_add_u32 s8, s8, s11
    s_movk_i32 s10, 0x3f80
    s_mov_b32 s11, 0x3f800000
    v_mov_b32 v28, 0
    v_mov_b32 v29, 0
    v_lshlrev_b32 v17, 4, v1
    s_cmp_ge_u32 s41, 18
    s_cbranch_scc1 KS_LO
W_89:
    ds_read_b32 v20, v4 offset:40
    s_sub_u32 s39, s39, 1
    s_cbranch_scc1 KS_ABORT
    s_waitcnt lgkmcnt(0)
    v_cmp_ne_u32 vcc, s84, v20
    s_cbranch_vccnz W_89
    ds_read_b64_tr_b16 v[80:81], v16 offset:0
    ds_read_b64_tr_b16 v[82:83], v16 offset:4608
    ds_read_b64_tr_b16 v[84:85], v16 offset:32
    ds_read_b64_tr_b16 v[86:87], v16 offset:4640
    ds_read_b64_tr_b16 v[88:89], v16 offset:64
    ds_read_b64_tr_b16 v[90:91], v16 offset:4672
    ds_read_b64_tr_b16 v[92:93], v16 offset:96
    ds_read_b64_tr_b16 v[94:95], v16 offset:4704
    v_and_b32 v16, 7, v2
    v_lshlrev_b32 v16, 6, v16
    v_lshl_add_u32 v16, v3, 4, v16
    s_mul_i32 s92, s89, 9344
    s_add_u32 s92, s92, 0x850000
    s_add_u32 s64, s36, s92
    s_addc_u32 s65, s37, 0
    s_cmp_lt_u32 s41, 18
    s_cselect_b32 s66, 9216, 0
    s_mov_b32 s67, 0x20000
    s_mul_i32 s92, s38, 3072
    v_lshlrev_b32 v8, 4, v1
    v_mov_b32 v60, -1
    v_mov_b32 v61, -1
    v_mov_b32 v62, -1
    v_mov_b32 v63, -1
    buffer_store_dwordx4 v[60:63], v8, s[64:67], s92 offen offset:0 sc1
    buffer_store_dwordx4 v[60:63], v8, s[64:67], s92 offen offset:1024 sc1
    buffer_store_dwordx4 v[60:63], v8, s[64:67], s92 offen offset:2048 sc1
    s_waitcnt vmcnt(0)
    s_mov_b64 exec, 1
    ds_add_rtn_u32 v62, v4, v5 offset:196
    s_lshl_b32 s92, s2, 4
    s_add_u32 s92, s92, 8192
    s_waitcnt lgkmcnt(0)
    v_cmp_eq_u32 vcc, 3, v62
    s_and_b64 exec, exec, vcc
    s_cbranch_execz NOF_90
    buffer_store_dword v5, v4, s[76:79], s92 offen sc1
NOF_90:
    s_mov_b64 exec, -1
    s_sleep 16
    s_branch KS_LO2
KS_LO:
    s_sleep 8
    s_waitcnt vmcnt(0)
    s_mov_b64 exec, 1
    ds_add_rtn_u32 v62, v4, v5 offset:196
    s_lshl_b32 s92, s2, 4
    s_add_u32 s92, s92, 8192
    s_waitcnt lgkmcnt(0)
    v_cmp_eq_u32 vcc, 3, v62
    s_and_b64 exec, exec, vcc
    s_cbranch_execz NOF_91
    buffer_store_dword v5, v4, s[76:79], s92 offen sc1
NOF_91:
    s_mov_b64 exec, -1
    s_sleep 24
KS_LO2:
    s_mov_b64 exec, 0xffff0000
    buffer_store_dwordx4 v[64:67], v111, s[68:71], 0 offen offset:1024 sc1
    s_mov_b64 exec, -1
    buffer_store_dwordx4 v[50:53], v115, s[68:71], 0 offen sc1
    buffer_store_dwordx4 v[54:57], v115, s[68:71], 0 offen offset:512 sc1
    s_setprio 2
    s_waitcnt vmcnt(0)
    s_mov_b64 exec, 1
    ds_add_rtn_u32 v62, v4, v5 offset:176
    s_lshl_b32 s92, s2, 4
    s_add_u32 s92, s92, 12288
    s_waitcnt lgkmcnt(0)
    v_cmp_eq_u32 vcc, 3, v62
    s_and_b64 exec, exec, vcc
    s_cbranch_execz NOF_92
    buffer_store_dword v5, v4, s[76:79], s92 offen sc1
NOF_92:
    s_mov_b64 exec, -1
    s_cmp_lt_u32 s41, 18
    s_cbranch_scc1 KS_B
    s_waitcnt lgkmcnt(0)
    s_endpgm
KS_T:
    s_setprio 0
    s_cmp_ge_u32 s38, 10
    s_cbranch_scc1 KS_PEND
    s_add_u32 s76, s36, 0x840000
    s_addc_u32 s77, s37, 0
    s_mov_b32 s78, 0x4000
    s_mov_b32 s79, 0x20000
    s_cmp_eq_u32 s38, 9
    s_cbranch_scc1 KS_W9
    s_add_u32 s80, s36, 0x850000
    s_addc_u32 s81, s37, 0
    s_mov_b32 s82, 0x148800
    s_mov_b32 s83, 0x20000
    v_bfe_u32 v16, v1, 2, 2
    v_lshl_add_u32 v16, v3, 3, v16
    v_mul_u32_u24 v16, 1152, v16
    v_and_b32 v17, 3, v1
    v_lshl_add_u32 v16, v17, 3, v16
    s_lshl_b32 s10, s38, 7
    s_add_u32 s11, s10, 109184
    v_add_u32 v16, s11, v16
    v_lshrrev_b32 v18, 2, v1
    v_mul_u32_u24 v18, 9344, v18
    v_lshl_add_u32 v18, v17, 4, v18
    s_mul_i32 s9, s38, 149504
    s_lshl_b32 s11, s89, 6
    s_add_u32 s9, s9, s11
    v_lshl_add_u32 v19, v17, 5, s10
    v_lshl_add_u32 v19, v3, 3, v19
    s_mul_i32 s8, s89, 9344
    s_lshl_b32 s11, s38, 10
    s_add_u32 s8, s8, s11
    s_movk_i32 s10, 0x3f80
    s_mov_b32 s11, 0x3f800000
    v_mov_b32 v28, 0
    v_mov_b32 v29, 0
    v_lshlrev_b32 v17, 4, v1
    s_mov_b32 s72, s36
    s_mov_b32 s73, s37
    s_mov_b32 s74, 0x240000
    s_mov_b32 s75, 0x20000
    v_and_b32 v6, 1, v1
    v_and_b32 v7, 1, v3
    v_lshl_add_u32 v6, v7, 1, v6
    v_lshlrev_b32 v6, 2, v6
    ds_read_b32 v8, v6 offset:224
    s_lshl_b32 s92, s38, 11
    s_add_u32 s92, s92, 8896
    v_add_u32 v12, s92, v17
    s_waitcnt lgkmcnt(0)
    v_lshrrev_b32 v9, 3, v8
    v_lshrrev_b32 v10, 6, v8
    v_lshrrev_b32 v11, 9, v8
    s_cmp_eq_u32 s38, 8
    s_cbranch_scc1 KS_L2W
W_93:
    ds_read_b32 v20, v4 offset:40
    s_sub_u32 s39, s39, 1
    s_cbranch_scc1 KS_ABORT
    s_waitcnt lgkmcnt(0)
    v_cmp_ne_u32 vcc, s84, v20
    s_cbranch_vccnz W_93
    ds_read_b64_tr_b16 v[80:81], v16 offset:0
    ds_read_b64_tr_b16 v[82:83], v16 offset:4608
    ds_read_b64_tr_b16 v[84:85], v16 offset:32
    ds_read_b64_tr_b16 v[86:87], v16 offset:4640
    ds_read_b64_tr_b16 v[88:89], v16 offset:64
    ds_read_b64_tr_b16 v[90:91], v16 offset:4672
    ds_read_b64_tr_b16 v[92:93], v16 offset:96
    ds_read_b64_tr_b16 v[94:95], v16 offset:4704
    v_and_b32 v16, 7, v2
    v_lshlrev_b32 v16, 6, v16
    v_lshl_add_u32 v16, v3, 4, v16
W_94:
    s_sleep 2
    ds_read_b32 v20, v4 offset:768
    s_sub_u32 s39, s39, 1
    s_cbranch_scc1 KS_ABORT
    s_waitcnt lgkmcnt(0)
    v_cmp_eq_u32 vcc, 0, v20
    s_cbranch_vccnz W_94
    s_setprio 1
W_95:
    s_sleep 1
    ds_read_b32 v20, v4 offset:32
    s_sub_u32 s39, s39, 1
    s_cbranch_scc1 KS_ABORT
    s_waitcnt lgkmcnt(0)
    v_cmp_eq_u32 vcc, 0, v20
    s_cbranch_vccnz W_95
    ds_read_b128 v[20:23], v12
    ds_read_b128 v[24:27], v12 offset:1024
    s_waitcnt lgkmcnt(1)
    v_xor_b32 v13, v8, v20
    v_bitop3_b32 v13, v13, v9, v21 bitop3:0xf6
    v_bitop3_b32 v13, v13, v10, v22 bitop3:0xf6
    v_bitop3_b32 v13, v13, v11, v23 bitop3:0xf6
    v_and_b32 v13, 0x70007, v13
    s_waitcnt lgkmcnt(0)
    v_xor_b32 v14, v8, v24
    v_bitop3_b32 v14, v14, v9, v25 bitop3:0xf6
    v_bitop3_b32 v14, v14, v10, v26 bitop3:0xf6
    v_bitop3_b32 v14, v14, v11, v27 bitop3:0xf6
    v_and_b32 v14, 0x70007, v14
    v_min_u32 v13, v13, v14
KS_CK:
    v_cmp_eq_u32 vcc, 0, v13
    s_cbranch_vccz KS_B
    ds_write_b32 v4, v5 offset:24
    s_branch KS_B
KS_L2W:
    s_movk_i32 s92, 4096
    s_movk_i32 s96, -1152
    s_mov_b32 s93, 0
    v_mov_b32 v57, 0
    v_and_b32 v41, 1, v1
    v_lshl_add_u32 v41, v3, 1, v41
    v_lshlrev_b32 v41, 4, v41
    v_add_u32 v41, 2358144, v41
    v_lshlrev_b32 v7, 1, v1
    v_and_b32 v7, 28, v7
W_96:
    s_sleep 2
    ds_read_b32 v20, v4 offset:20
    s_sub_u32 s39, s39, 1
    s_cbranch_scc1 KS_ABORT
    s_waitcnt lgkmcnt(0)
    v_cmp_ne_u32 vcc, s84, v20
    s_cbranch_vccnz W_96
    s_setprio 3
W_97:
    s_sleep 1
    ds_read_b32 v20, v4 offset:12
    s_sub_u32 s39, s39, 1
    s_cbranch_scc1 KS_ABORT
    s_waitcnt lgkmcnt(0)
    v_cmp_ne_u32 vcc, s84, v20
    s_cbranch_vccnz W_97
    s_setprio 3
    s_sleep 27
    s_branch KS_Q1
KS_Q0:
    s_sleep 1
KS_Q1:
    buffer_load_dwordx4 v[96:99], v17, s[76:79], 0 offen offset:0 sc1
    buffer_load_dwordx4 v[100:103], v17, s[76:79], 0 offen offset:1024 sc1
    buffer_load_dwordx4 v[104:107], v17, s[76:79], 0 offen offset:2048 sc1
    buffer_load_dwordx4 v[108:111], v17, s[76:79], 0 offen offset:3072 sc1
    buffer_load_dwordx4 v[112:115], v17, s[76:79], s92 offen offset:0 sc1
    buffer_load_dwordx4 v[116:119], v17, s[76:79], s92 offen offset:1024 sc1
    buffer_load_dwordx4 v[120:123], v17, s[76:79], s92 offen offset:2048 sc1
    buffer_load_dwordx4 v[124:127], v17, s[76:79], s92 offen offset:3072 sc1
    s_sub_u32 s39, s39, 1
    s_cbranch_scc1 KS_ABORT
    s_waitcnt vmcnt(7)
    v_max_u32 v42, v96, v97
    v_max_u32 v44, v98, v99
    v_min_u32 v43, v96, v97
    v_min_u32 v45, v98, v99
    s_waitcnt vmcnt(6)
    v_med3_u32 v46, v42, v100, v101
    v_med3_u32 v47, v44, v102, v103
    v_max3_u32 v42, v42, v100, v101
    v_max3_u32 v44, v44, v102, v103
    v_max_u32 v43, v43, v46
    v_max_u32 v45, v45, v47
    s_waitcnt vmcnt(5)
    v_med3_u32 v46, v42, v104, v105
    v_med3_u32 v47, v44, v106, v107
    v_max3_u32 v42, v42, v104, v105
    v_max3_u32 v44, v44, v106, v107
    v_max_u32 v43, v43, v46
    v_max_u32 v45, v45, v47
    s_waitcnt vmcnt(4)
    v_med3_u32 v46, v42, v108, v109
    v_med3_u32 v47, v44, v110, v111
    v_max3_u32 v42, v42, v108, v109
    v_max3_u32 v44, v44, v110, v111
    v_max_u32 v43, v43, v46
    v_max_u32 v45, v45, v47
    s_waitcnt vmcnt(3)
    v_med3_u32 v46, v42, v112, v113
    v_med3_u32 v47, v44, v114, v115
    v_max3_u32 v42, v42, v112, v113
    v_max3_u32 v44, v44, v114, v115
    v_max_u32 v43, v43, v46
    v_max_u32 v45, v45, v47
    s_waitcnt vmcnt(2)
    v_med3_u32 v46, v42, v116, v117
    v_med3_u32 v47, v44, v118, v119
    v_max3_u32 v42, v42, v116, v117
    v_max3_u32 v44, v44, v118, v119
    v_max_u32 v43, v43, v46
    v_max_u32 v45, v45, v47
    s_waitcnt vmcnt(1)
    v_med3_u32 v46, v42, v120, v121
    v_med3_u32 v47, v44, v122, v123
    v_max3_u32 v42, v42, v120, v121
    v_max3_u32 v44, v44, v122, v123
    v_max_u32 v43, v43, v46
    v_max_u32 v45, v45, v47
    v_max_u32 v43, v43, v45
    s_waitcnt vmcnt(0)
    v_med3_u32 v46, v42, v124, v125
    v_med3_u32 v47, v44, v126, v127
    v_max3_u32 v42, v42, v124, v125
    v_max3_u32 v44, v44, v126, v127
    v_max3_u32 v43, v43, v46, v47
    v_max_u32 v48, v42, v44
    v_med3_u32 v49, v42, v44, v43
    v_cmp_eq_u32 vcc, -1, v48
    v_mov_b32 v56, v49
KS_QN:
    v_max_u32_dpp v50, v49, v48 row_half_mirror row_mask:0xf bank_mask:0x5
    v_max_u32_dpp v51, v48, v49 row_half_mirror row_mask:0xf bank_mask:0x5
    v_min_u32_dpp v50, v49, v48 row_half_mirror row_mask:0xf bank_mask:0xa
    v_min_u32_dpp v51, v48, v49 row_half_mirror row_mask:0xf bank_mask:0xa
    s_cbranch_vccnz KS_Q0
    s_cmp_eq_u32 s93, 1
    s_mov_b32 m0, 17088
    v_min_u32 v53, v50, v51
    v_max_u32 v52, v50, v51
    s_nop 1
    v_max_u32_dpp v50, v53, v52 row_mirror row_mask:0xf bank_mask:0x3
    v_max_u32_dpp v51, v52, v53 row_mirror row_mask:0xf bank_mask:0x3
    v_min_u32_dpp v50, v53, v52 row_mirror row_mask:0xf bank_mask:0xc
    v_min_u32_dpp v51, v52, v53 row_mirror row_mask:0xf bank_mask:0xc
    s_nop 0
    v_max_u32_dpp v52, v50, v50 row_half_mirror row_mask:0xf bank_mask:0x5
    v_max_u32_dpp v53, v51, v51 row_half_mirror row_mask:0xf bank_mask:0x5
    v_min_u32_dpp v52, v50, v50 row_half_mirror row_mask:0xf bank_mask:0xa
    v_min_u32_dpp v53, v51, v51 row_half_mirror row_mask:0xf bank_mask:0xa
    v_max_u32 v48, v52, v53
    v_max_u32 v54, v52, v53
    v_min_u32 v49, v52, v53
    v_min_u32 v55, v52, v53
    v_permlane32_swap_b32 v48, v54
    s_nop 0
    v_permlane32_swap_b32 v49, v55
    s_nop 1
    v_max_u32_dpp v51, v54, v49 row_mirror row_mask:0xf bank_mask:0xf
    v_max_u32_dpp v50, v55, v48 row_mirror row_mask:0xf bank_mask:0xf
    s_nop 1
    v_max_u32_dpp v52, v50, v50 row_ror:8 row_mask:0xf bank_mask:0x3
    v_max_u32_dpp v53, v51, v51 row_ror:8 row_mask:0xf bank_mask:0x3
    v_min_u32_dpp v52, v50, v50 row_ror:8 row_mask:0xf bank_mask:0xc
    v_min_u32_dpp v53, v51, v51 row_ror:8 row_mask:0xf bank_mask:0xc
    s_nop 0
    v_max_u32_dpp v50, v52, v52 row_half_mirror row_mask:0xf bank_mask:0x5
    v_max_u32_dpp v51, v53, v53 row_half_mirror row_mask:0xf bank_mask:0x5
    v_min_u32_dpp v50, v52, v52 row_half_mirror row_mask:0xf bank_mask:0xa
    v_min_u32_dpp v51, v53, v53 row_half_mirror row_mask:0xf bank_mask:0xa
    v_max_u32 v48, v50, v51
    v_max_u32 v54, v50, v51
    v_min_u32 v49, v50, v51
    v_min_u32 v55, v50, v51
    v_permlane16_swap_b32 v48, v54
    s_nop 0
    v_permlane16_swap_b32 v49, v55
    s_nop 1
    v_max_u32_dpp v51, v54, v49 row_mirror row_mask:0xf bank_mask:0xf
    v_max_u32_dpp v50, v55, v48 row_mirror row_mask:0xf bank_mask:0xf
    s_nop 1
    v_max_u32_dpp v52, v50, v50 row_ror:8 row_mask:0xf bank_mask:0x3
    v_max_u32_dpp v53, v51, v51 row_ror:8 row_mask:0xf bank_mask:0x3
    v_min_u32_dpp v52, v50, v50 row_ror:8 row_mask:0xf bank_mask:0xc
    v_min_u32_dpp v53, v51, v51 row_ror:8 row_mask:0xf bank_mask:0xc
    s_nop 0
    v_max_u32_dpp v50, v52, v52 row_half_mirror row_mask:0xf bank_mask:0x5
    v_max_u32_dpp v51, v53, v53 row_half_mirror row_mask:0xf bank_mask:0x5
    v_min_u32_dpp v50, v52, v52 row_half_mirror row_mask:0xf bank_mask:0xa
    v_min_u32_dpp v51, v53, v53 row_half_mirror row_mask:0xf bank_mask:0xa
    v_min_u32 v49, v50, v51
    v_max_u32 v48, v50, v51
    s_nop 0
    v_mov_b32_dpp v55, v49 row_mirror row_mask:0xf bank_mask:0xf
    v_mov_b32_dpp v54, v48 row_mirror row_mask:0xf bank_mask:0xf
    s_nop 0
    v_max_u32_dpp v50, v55, v48 quad_perm:[1,0,3,2] row_mask:0xf bank_mask:0xf
    v_max_u32_dpp v51, v54, v49 quad_perm:[1,0,3,2] row_mask:0xf bank_mask:0xf
    s_nop 0
    v_max_u32_dpp v52, v50, v50 row_ror:8 row_mask:0xf bank_mask:0x3
    v_max_u32_dpp v53, v51, v51 row_ror:8 row_mask:0xf bank_mask:0x3
    v_min_u32_dpp v52, v50, v50 row_ror:8 row_mask:0xf bank_mask:0xc
    v_min_u32_dpp v53, v51, v51 row_ror:8 row_mask:0xf bank_mask:0xc
    s_nop 0
    v_max_u32_dpp v50, v52, v52 row_half_mirror row_mask:0xf bank_mask:0x5
    v_max_u32_dpp v51, v53, v53 row_half_mirror row_mask:0xf bank_mask:0x5
    v_min_u32_dpp v50, v52, v52 row_half_mirror row_mask:0xf bank_mask:0xa
    v_min_u32_dpp v51, v53, v53 row_half_mirror row_mask:0xf bank_mask:0xa
    v_min_u32 v49, v50, v51
    v_max_u32 v48, v50, v51
    s_nop 0
    v_mov_b32_dpp v55, v49 row_mirror row_mask:0xf bank_mask:0xf
    s_nop 1
    v_max_u32_dpp v59, v55, v48 quad_perm:[2,3,0,1] row_mask:0xf bank_mask:0xf
    s_cbranch_scc1 KS_QF2
    v_and_b32 v61, 0x7ff, v59
    v_mad_i32_i24 v61, v61, s96, v41
    buffer_load_dwordx4 v61, s[72:75], 0 offen offset:0 sc1 lds
    s_mov_b32 m0, 17984
    s_nop 0
    buffer_load_dwordx4 v61, s[72:75], 0 offen offset:128 sc1 lds
    s_mov_b32 m0, 18880
    s_nop 0
    buffer_load_dwordx4 v61, s[72:75], 0 offen offset:256 sc1 lds
    s_mov_b32 m0, 19776
    s_nop 0
    buffer_load_dwordx4 v61, s[72:75], 0 offen offset:384 sc1 lds
    s_mov_b32 m0, 20672
    s_nop 0
    buffer_load_dwordx4 v61, s[72:75], 0 offen offset:512 sc1 lds
    s_mov_b32 m0, 21568
    s_nop 0
    buffer_load_dwordx4 v61, s[72:75], 0 offen offset:640 sc1 lds
    s_mov_b32 m0, 22464
    s_nop 0
    buffer_load_dwordx4 v61, s[72:75], 0 offen offset:768 sc1 lds
    s_mov_b32 m0, 23360
    s_nop 0
    buffer_load_dwordx4 v61, s[72:75], 0 offen offset:896 sc1 lds
    s_mov_b32 m0, 24256
    s_nop 0
    buffer_load_dwordx4 v61, s[72:75], 0 offen offset:1024 sc1 lds
    v_sub_u32 v96, v96, v56
    v_min_u32_dpp v60, v59, v59 quad_perm:[2,3,0,1] row_mask:0xf bank_mask:0xf
    v_sub_u32 v97, v97, v56
    v_sub_u32 v98, v98, v56
    v_max3_u32 v47, v96, v97, v98
    v_sub_u32 v99, v99, v56
    v_sub_u32 v100, v100, v56
    v_min_u32_dpp v60, v60, v60 row_half_mirror row_mask:0xf bank_mask:0xf
    v_max3_u32 v47, v47, v99, v100
    v_sub_u32 v101, v101, v56
    v_sub_u32 v102, v102, v56
    v_max3_u32 v47, v47, v101, v102
    v_sub_u32 v103, v103, v56
    v_sub_u32 v104, v104, v56
    v_min_u32_dpp v60, v60, v60 row_ror:8 row_mask:0xf bank_mask:0xf
    v_max3_u32 v47, v47, v103, v104
    v_sub_u32 v105, v105, v56
    v_sub_u32 v106, v106, v56
    v_max3_u32 v47, v47, v105, v106
    v_sub_u32 v107, v107, v56
    v_sub_u32 v108, v108, v56
    v_max3_u32 v47, v47, v107, v108
    v_sub_u32 v109, v109, v56
    v_sub_u32 v110, v110, v56
    v_max3_u32 v47, v47, v109, v110
    v_sub_u32 v111, v111, v56
    v_sub_u32 v112, v112, v56
    v_max3_u32 v47, v47, v111, v112
    v_sub_u32 v113, v113, v56
    v_sub_u32 v114, v114, v56
    v_max3_u32 v47, v47, v113, v114
    v_sub_u32 v115, v115, v56
    v_sub_u32 v116, v116, v56
    v_max3_u32 v47, v47, v115, v116
    v_sub_u32 v117, v117, v56
    v_sub_u32 v118, v118, v56
    v_max3_u32 v47, v47, v117, v118
    v_sub_u32 v119, v119, v56
    v_sub_u32 v120, v120, v56
    v_max3_u32 v47, v47, v119, v120
    v_sub_u32 v121, v121, v56
    v_sub_u32 v122, v122, v56
    v_max3_u32 v47, v47, v121, v122
    v_sub_u32 v123, v123, v56
    v_sub_u32 v124, v124, v56
    v_max3_u32 v47, v47, v123, v124
    v_sub_u32 v125, v125, v56
    v_sub_u32 v126, v126, v56
    v_max3_u32 v47, v47, v125, v126
    v_sub_u32 v127, v127, v56
    v_add_u32 v57, v57, v56
    v_max_u32 v47, v47, v127
    v_add_u32 v47, v47, v57
    v_cmp_gt_u32 vcc, v47, v60
    s_cbranch_vccnz KS_QF1
    ds_write_b32 v7, v59 offset:768
W_98:
    ds_read_b32 v20, v4 offset:40
    s_sub_u32 s39, s39, 1
    s_cbranch_scc1 KS_ABORT
    s_waitcnt lgkmcnt(0)
    v_cmp_ne_u32 vcc, s84, v20
    s_cbranch_vccnz W_98
    ds_read_b64_tr_b16 v[80:81], v16 offset:0
    ds_read_b64_tr_b16 v[82:83], v16 offset:4608
    ds_read_b64_tr_b16 v[84:85], v16 offset:32
    ds_read_b64_tr_b16 v[86:87], v16 offset:4640
    ds_read_b64_tr_b16 v[88:89], v16 offset:64
    ds_read_b64_tr_b16 v[90:91], v16 offset:4672
    ds_read_b64_tr_b16 v[92:93], v16 offset:96
    ds_read_b64_tr_b16 v[94:95], v16 offset:4704
    v_and_b32 v16, 7, v2
    v_lshlrev_b32 v16, 6, v16
    v_lshl_add_u32 v16, v3, 4, v16
    s_waitcnt vmcnt(0)
    ds_write_b32 v4, v5 offset:32
    s_setprio 1
    ds_read_b128 v[20:23], v12
    s_waitcnt lgkmcnt(0)
    v_xor_b32 v13, v8, v20
    v_bitop3_b32 v13, v13, v9, v21 bitop3:0xf6
    v_bitop3_b32 v13, v13, v10, v22 bitop3:0xf6
    v_bitop3_b32 v13, v13, v11, v23 bitop3:0xf6
    v_and_b32 v13, 0x70007, v13
    s_branch KS_CK
KS_QF1:
    s_sub_u32 s39, s39, 1
    s_cbranch_scc1 KS_ABORT
    v_mov_b32 v58, v59
    v_max_u32 v42, v96, v97
    v_max_u32 v44, v98, v99
    v_min_u32 v43, v96, v97
    v_min_u32 v45, v98, v99
    v_med3_u32 v46, v42, v100, v101
    v_med3_u32 v47, v44, v102, v103
    v_max3_u32 v42, v42, v100, v101
    v_max3_u32 v44, v44, v102, v103
    v_max_u32 v43, v43, v46
    v_max_u32 v45, v45, v47
    v_med3_u32 v46, v42, v104, v105
    v_med3_u32 v47, v44, v106, v107
    v_max3_u32 v42, v42, v104, v105
    v_max3_u32 v44, v44, v106, v107
    v_max_u32 v43, v43, v46
    v_max_u32 v45, v45, v47
    v_med3_u32 v46, v42, v108, v109
    v_med3_u32 v47, v44, v110, v111
    v_max3_u32 v42, v42, v108, v109
    v_max3_u32 v44, v44, v110, v111
    v_max_u32 v43, v43, v46
    v_max_u32 v45, v45, v47
    v_med3_u32 v46, v42, v112, v113
    v_med3_u32 v47, v44, v114, v115
    v_max3_u32 v42, v42, v112, v113
    v_max3_u32 v44, v44, v114, v115
    v_max_u32 v43, v43, v46
    v_max_u32 v45, v45, v47
    v_med3_u32 v46, v42, v116, v117
    v_med3_u32 v47, v44, v118, v119
    v_max3_u32 v42, v42, v116, v117
    v_max3_u32 v44, v44, v118, v119
    v_max_u32 v43, v43, v46
    v_max_u32 v45, v45, v47
    v_med3_u32 v46, v42, v120, v121
    v_med3_u32 v47, v44, v122, v123
    v_max3_u32 v42, v42, v120, v121
    v_max3_u32 v44, v44, v122, v123
    v_max_u32 v43, v43, v46
    v_max_u32 v45, v45, v47
    v_max_u32 v43, v43, v45
    v_med3_u32 v46, v42, v124, v125
    v_med3_u32 v47, v44, v126, v127
    v_max3_u32 v42, v42, v124, v125
    v_max3_u32 v44, v44, v126, v127
    v_max3_u32 v43, v43, v46, v47
    v_max_u32 v48, v42, v44
    v_med3_u32 v56, v42, v44, v43
    v_add_u32 v48, v48, v57
    v_add_u32 v49, v56, v57
    s_mov_b32 s93, 1
    s_mov_b64 vcc, 0
    s_nop 2
    s_branch KS_QN
KS_QF2:
    v_mov_b32 v48, 0
    v_mov_b32 v49, 0
    s_mov_b64 exec, 0x5555
    v_max_u32 v48, v59, v58
    v_min_u32 v49, v59, v58
    s_mov_b64 exec, -1
    s_mov_b32 s93, 2
    s_mov_b64 vcc, 0
    s_waitcnt vmcnt(0)
    s_nop 5
    s_branch KS_QN
KS_BR:
    s_mov_b64 exec, -1
    s_cmp_lg_u32 s38, 8
    s_cbranch_scc1 KS_BR1
    s_movk_i32 s92, 0x2000
    s_nop 7
    s_branch ZPE_100
ZP_99:
    s_sleep 2
ZPE_100:
    buffer_load_dword v20, v17, s[76:79], s92 offen offset:0 sc1
    buffer_load_dword v21, v17, s[76:79], s92 offen offset:1024 sc1
    buffer_load_dword v22, v17, s[76:79], s92 offen offset:2048 sc1
    buffer_load_dword v23, v17, s[76:79], s92 offen offset:3072 sc1
    s_sub_u32 s39, s39, 1
    s_cbranch_scc1 KS_ABORT
    s_waitcnt vmcnt(0)
    v_max3_u32 v44, v20, v21, v22
    v_max_u32 v44, v44, v23
    v_cmp_eq_u32 vcc, -1, v44
    s_cbranch_vccnz ZP_99
    s_mov_b32 m0, 17088
    s_nop 0
    buffer_load_dwordx4 v61, s[72:75], 0 offen offset:0 sc1 lds
    s_mov_b32 m0, 17984
    s_nop 0
    buffer_load_dwordx4 v61, s[72:75], 0 offen offset:128 sc1 lds
    s_mov_b32 m0, 18880
    s_nop 0
    buffer_load_dwordx4 v61, s[72:75], 0 offen offset:256 sc1 lds
    s_mov_b32 m0, 19776
    s_nop 0
    buffer_load_dwordx4 v61, s[72:75], 0 offen offset:384 sc1 lds
    s_mov_b32 m0, 20672
    s_nop 0
    buffer_load_dwordx4 v61, s[72:75], 0 offen offset:512 sc1 lds
    s_mov_b32 m0, 21568
    s_nop 0
    buffer_load_dwordx4 v61, s[72:75], 0 offen offset:640 sc1 lds
    s_mov_b32 m0, 22464
    s_nop 0
    buffer_load_dwordx4 v61, s[72:75], 0 offen offset:768 sc1 lds
    s_mov_b32 m0, 23360
    s_nop 0
    buffer_load_dwordx4 v61, s[72:75], 0 offen offset:896 sc1 lds
    s_mov_b32 m0, 24256
    s_nop 0
    buffer_load_dwordx4 v61, s[72:75], 0 offen offset:1024 sc1 lds
    s_waitcnt vmcnt(0)
    s_barrier
    ds_write_b32 v4, v4 offset:24
    s_branch KS_B
KS_BR1:
    s_barrier
    s_branch KS_B
KS_W9:
    v_lshlrev_b32 v33, 4, v1
    s_movk_i32 s92, 0x2000
    v_and_b32 v7, 7, v1
    v_lshlrev_b32 v7, 2, v7
    s_add_u32 s64, s36, 0x600000
    s_addc_u32 s65, s37, 0
    s_mov_b32 s66, 0x240000
    s_mov_b32 s67, 0x20000
    s_mov_b32 s68, s4
    s_mov_b32 s69, s5
    s_mov_b32 s70, 0x240000
    s_mov_b32 s71, 0x20000
    v_bfe_u32 v43, v1, 3, 2
    s_lshl_b32 s93, s89, 2
    v_add_u32 v43, s93, v43
    v_bfe_u32 v40, v43, 4, 1
    v_and_b32 v41, 3, v1
    v_lshl_add_u32 v40, v40, 2, v41
    v_lshlrev_b32 v40, 2, v40
    v_and_b32 v41, 0x3cf, v43
    v_bfe_u32 v42, v43, 5, 1
    v_lshl_add_u32 v41, v42, 4, v41
    v_bfe_u32 v42, v1, 2, 1
    v_lshl_add_u32 v41, v42, 5, v41
    v_lshrrev_b32 v42, 4, v41
    v_lshlrev_b32 v42, 8, v42
    v_lshl_add_u32 v42, v40, 3, v42
    v_and_b32 v43, 15, v41
    v_lshl_add_u32 v42, v43, 1, v42
W_101:
    s_sleep 1
    ds_read_b32 v12, v7 offset:768
    s_sub_u32 s39, s39, 1
    s_cbranch_scc1 KS_ABORT
    s_waitcnt lgkmcnt(0)
    v_cmp_eq_u32 vcc, 0, v12
    s_cbranch_vccnz W_101
    ds_read_b32 v19, v40 offset:768
    s_waitcnt lgkmcnt(0)
    v_and_b32 v14, 0x7ff, v19
    v_sub_u32 v14, 2047, v14
    v_mul_u32_u24 v23, 1152, v14
    v_lshl_add_u32 v23, v41, 1, v23
    buffer_load_ushort v17, v23, s[68:71], 0 offen
    v_lshrrev_b32 v15, 9, v14
    v_bfe_u32 v16, v14, 6, 2
    v_lshl_add_u32 v15, v15, 2, v16
    v_bfe_u32 v16, v14, 2, 2
    v_lshl_add_u32 v15, v15, 2, v16
    v_bfe_u32 v16, v14, 4, 1
    v_bfe_u32 v24, v14, 8, 1
    v_and_b32 v25, 3, v14
    v_lshl_add_u32 v24, v24, 2, v25
    v_lshlrev_b32 v24, 1, v24
    v_bfe_u32 v25, v14, 5, 1
    v_lshl_add_u32 v24, v25, 5, v24
    v_lshl_add_u32 v25, v15, 1, v16
    v_lshl_add_u32 v25, v25, 14, v24
    v_lshrrev_b32 v26, 1, v41
    v_lshl_add_u32 v25, v26, 6, v25
    v_xor_b32 v26, v41, v16
    v_not_b32 v26, v26
    v_and_b32 v26, 1, v26
    v_lshl_add_u32 v25, v26, 4, v25
    v_lshl_add_u32 v26, v15, 12, v24
    v_lshl_add_u32 v26, v16, 4, v26
    v_lshl_add_u32 v26, v41, 6, v26
    v_add_u32 v26, 2064384, v26
    v_lshl_add_u32 v27, v16, 6, v15
    v_lshlrev_b32 v27, 7, v27
    v_xor_b32 v25, v27, v25
    v_and_b32 v27, 0xf80, v27
    v_xor_b32 v26, v27, v26
    v_cmp_gt_u32 vcc, 0x200, v41
    s_nop 1
    v_cndmask_b32 v25, v26, v25, vcc
    buffer_load_ushort v18, v25, s[64:67], 0 offen sc1
    v_ashrrev_i32 v22, 31, v19
    v_not_b32 v22, v22
    v_or_b32 v22, 0x80000000, v22
    v_xor_b32 v22, v19, v22
    v_and_b32 v22, 0xffff0000, v22
    v_mul_f32 v22, 0xbfb8aa3b, v22
    v_exp_f32 v22, v22
    s_nop 0
    v_add_f32 v22, 1.0, v22
    v_rcp_f32 v22, v22
    s_nop 0
    v_cvt_pk_bf16_f32 v22, 0, v22
    s_add_u32 s72, s36, 0xb10000
    s_addc_u32 s73, s37, 0
    s_mov_b32 s74, 0x40
    s_mov_b32 s75, 0x20000
    s_mov_b32 s68, s32
    s_mov_b32 s69, s33
    s_mov_b32 s70, 0x240000
    s_mov_b32 s71, 0x20000
    buffer_load_dword v8, v33, s[76:79], s92 offen offset:0 sc1
    buffer_load_dword v9, v33, s[76:79], s92 offen offset:1024 sc1
    buffer_load_dword v10, v33, s[76:79], s92 offen offset:2048 sc1
    buffer_load_dword v11, v33, s[76:79], s92 offen offset:3072 sc1
    s_cmp_lg_u32 s2, 0
    s_cbranch_scc1 KS_W9B
    buffer_store_dword v12, v7, s[72:75], 0 offen
    s_branch KS_W9B
KS_W9R:
    s_barrier
KS_W9B:
    s_barrier
    ds_read_b32 v13, v4 offset:24
    ds_read_u16 v20, v42 offset:17088
    s_waitcnt lgkmcnt(0)
    v_cmp_ne_u32 vcc, 0, v13
    s_cbranch_vccnz KS_W9R
    s_setprio 2
    s_branch KS_F3B
KS_F3A:
    s_sleep 2
    buffer_load_dword v8, v33, s[76:79], s92 offen offset:0 sc1
    buffer_load_dword v9, v33, s[76:79], s92 offen offset:1024 sc1
    buffer_load_dword v10, v33, s[76:79], s92 offen offset:2048 sc1
    buffer_load_dword v11, v33, s[76:79], s92 offen offset:3072 sc1
KS_F3B:
    s_sub_u32 s39, s39, 1
    s_cbranch_scc1 KS_ABORT
    s_waitcnt vmcnt(0)
    v_max3_u32 v44, v8, v9, v10
    v_max_u32 v44, v44, v11
    v_cmp_eq_u32 vcc, -1, v44
    s_cbranch_vccnz KS_F3A
    ds_write_b32 v4, v5 offset:28
    s_movk_i32 s92, 0x3000
    s_sleep 12
    s_branch ZPE_103
ZP_102:
    s_sleep 2
ZPE_103:
    buffer_load_dword v8, v33, s[76:79], s92 offen offset:0 sc1
    buffer_load_dword v9, v33, s[76:79], s92 offen offset:1024 sc1
    buffer_load_dword v10, v33, s[76:79], s92 offen offset:2048 sc1
    buffer_load_dword v11, v33, s[76:79], s92 offen offset:3072 sc1
    s_sub_u32 s39, s39, 1
    s_cbranch_scc1 KS_ABORT
    s_waitcnt vmcnt(0)
    v_max3_u32 v44, v8, v9, v10
    v_max_u32 v44, v44, v11
    v_cmp_eq_u32 vcc, -1, v44
    s_cbranch_vccnz ZP_102
    v_lshlrev_b32 v17, 16, v17
    v_lshlrev_b32 v18, 16, v18
    v_add_f32 v17, v17, v18
    v_cvt_pk_bf16_f32 v17, v17, v17
    v_and_b32 v21, 0xffff0000, v17
    v_lshlrev_b32 v20, 16, v20
    v_lshlrev_b32 v14, 2, v1
    v_add_u32 v14, 1536, v14
    s_mov_b32 exec_lo, -1
    s_mov_b32 exec_hi, 0
    s_setprio 3
    s_barrier
    ds_read2_b32 v[32:33], v14 offset0:0 offset1:32
    ds_read2_b32 v[34:35], v14 offset0:64 offset1:96
    ds_read2_b32 v[36:37], v14 offset0:128 offset1:160
    ds_read2_b32 v[38:39], v14 offset0:192 offset1:224
    ds_read_b32 v40, v14 offset:1024
    s_waitcnt lgkmcnt(3)
    v_pk_add_f32 v[32:33], v[32:33], v[34:35]
    s_waitcnt lgkmcnt(1)
    v_pk_add_f32 v[36:37], v[36:37], v[38:39]
    v_add_f32 v32, v32, v33
    s_waitcnt lgkmcnt(0)
    v_add_f32 v36, v36, v37
    v_add_f32 v32, v32, v40
    v_add_f32 v8, v32, v36
    v_cvt_pk_bf16_f32 v8, 0, v8
    v_mul_f32 v8, v8, v22
    v_cvt_pk_bf16_f32 v8, 0, v8
    v_add_f32 v8, v8, v20
    v_cvt_pk_bf16_f32 v8, 0, v8
    v_add_f32 v8, v8, v21
    v_cvt_pk_bf16_f32 v8, v8, v8
    buffer_store_short v8, v23, s[68:71], 0 offen
    s_endpgm
KS_B:
    s_setprio 2
    s_waitcnt lgkmcnt(0)
    s_barrier
    ds_read_b128 v[20:23], v16 offset:1024
    ds_read_b32 v30, v4 offset:24
    s_waitcnt lgkmcnt(1)
    v_mfma_f32_16x16x32_bf16 v[32:35], v[20:23], v[80:83], 0
    v_mfma_f32_16x16x32_bf16 v[40:43], v[20:23], v[88:91], 0
    v_mfma_f32_16x16x32_bf16 v[36:39], v[20:23], v[84:87], 0
    v_mfma_f32_16x16x32_bf16 v[44:47], v[20:23], v[92:95], 0
    s_waitcnt lgkmcnt(0)
    v_cmp_ne_u32 vcc, 0, v30
    s_mov_b32 exec_lo, -1
    s_mov_b32 exec_hi, 0
    s_cbranch_vccnz KS_BR
    v_cvt_pk_bf16_f32 v24, v32, v33
    v_cvt_pk_bf16_f32 v25, v34, v35
    v_cvt_pk_bf16_f32 v26, v40, v41
    v_cvt_pk_bf16_f32 v27, v42, v43
    s_mov_b32 exec_lo, 0
    s_mov_b32 exec_hi, -1
    v_cvt_pk_bf16_f32 v24, v36, v37
    v_cvt_pk_bf16_f32 v25, v38, v39
    v_cvt_pk_bf16_f32 v26, v44, v45
    v_cvt_pk_bf16_f32 v27, v46, v47
    s_mov_b64 exec, -1
    v_min_u32 v24, -2, v24
    v_min_u32 v25, -2, v25
    v_min_u32 v26, -2, v26
    v_min_u32 v27, -2, v27
    buffer_store_dwordx4 v[24:27], v17, s[80:83], s8 offen sc1
    s_sleep 13
W_104:
    ds_read_b32 v30, v4 offset:28
    s_sub_u32 s39, s39, 1
    s_cbranch_scc1 KS_ABORT
    s_waitcnt lgkmcnt(0)
    v_cmp_eq_u32 vcc, 0, v30
    s_cbranch_vccnz W_104
    s_branch ZPE_106
ZP_105:
    s_sleep 1
ZPE_106:
    buffer_load_dwordx4 v[32:35], v18, s[80:83], s9 offen sc1
    s_sub_u32 s39, s39, 1
    s_cbranch_scc1 KS_ABORT
    s_waitcnt vmcnt(0)
    v_max3_u32 v44, v32, v33, v34
    v_max_u32 v44, v44, v35
    v_cmp_eq_u32 vcc, -1, v44
    s_cbranch_vccnz ZP_105
    v_permlane32_swap_b32 v32, v34
    v_permlane32_swap_b32 v33, v35
    s_nop 1
    v_permlane16_swap_b32 v32, v33
    v_permlane16_swap_b32 v34, v35
    v_dot2c_f32_bf16 v28, s10, v32
    v_dot2c_f32_bf16 v29, s11, v32
    v_dot2c_f32_bf16 v28, s10, v33
    v_dot2c_f32_bf16 v29, s11, v33
    v_dot2c_f32_bf16 v28, s10, v34
    v_dot2c_f32_bf16 v29, s11, v34
    v_dot2c_f32_bf16 v28, s10, v35
    v_dot2c_f32_bf16 v29, s11, v35
    s_nop 1
    v_add_f32_dpp v28, v28, v28 row_ror:8 row_mask:0xf bank_mask:0xf
    v_add_f32_dpp v29, v29, v29 row_ror:8 row_mask:0xf bank_mask:0xf
    s_nop 0
    v_add_f32_dpp v28, v28, v28 row_ror:4 row_mask:0xf bank_mask:0xf
    v_add_f32_dpp v29, v29, v29 row_ror:4 row_mask:0xf bank_mask:0xf
    s_mov_b32 exec_lo, 0x000f000f
    s_mov_b32 exec_hi, 0x000f000f
    ds_write_b64 v19, v[28:29] offset:1536
    s_waitcnt lgkmcnt(0)
    s_barrier
    s_endpgm
KS_G0:
    ds_write_b8 v15, v5 offset:68
    s_setprio 0
KS_G:
    s_waitcnt vmcnt(0)
    s_sub_u32 s87, s38, 12
    s_and_b32 s95, s87, 1
    s_cselect_b32 s72, s28, s26
    s_cselect_b32 s73, s29, s27
    s_mov_b32 s74, 0x510000
    s_mov_b32 s75, 0x20000
    v_lshrrev_b32 v6, 3, v1
    v_lshrrev_b32 v7, 5, v1
    v_xor_b32 v6, v6, v7
    v_and_b32 v6, 1, v6
    v_lshl_add_u32 v6, s95, 1, v6
    v_xor_b32 v6, v6, v1
    v_and_b32 v6, 3, v6
    v_lshrrev_b32 v7, 2, v1
    v_mul_u32_u24 v7, 9216, v7
    v_lshl_add_u32 v46, v6, 4, v7
    s_lshl_b32 s96, s89, 6
    v_mov_b32 v6, s87
    s_mul_i32 s97, s95, 36864
    s_add_u32 s97, s97, 35328
    s_mov_b32 s68, s30
    s_mov_b32 s69, s31
    s_mov_b32 s70, 0x510000
    s_mov_b32 s71, 0x20000
    v_lshlrev_b32 v8, 4, v1
    s_mul_i32 s92, s89, 36864
    s_mul_i32 s93, s87, 9216
    s_add_u32 s92, s92, s93
    s_add_u32 s93, s93, 109184
    s_cmp_lt_u32 s41, 8
    s_cselect_b32 s94, 0, 100
    v_mov_b32 v9, s94
W_107:
    s_sleep 2
    ds_read_b32 v10, v9 offset:100
    s_sub_u32 s39, s39, 1
    s_cbranch_scc1 KS_ABORT
    s_waitcnt lgkmcnt(0)
    v_cmp_ne_u32 vcc, s84, v10
    s_cbranch_vccnz W_107
    s_cmp_ge_u32 s41, 8
    s_cselect_b64 vcc, -1, 0
    s_cbranch_scc1 KS_GD1
    s_add_u32 m0, s93, 0
    s_nop 0
    buffer_load_dwordx4 v8, s[68:71], s92 offen offset:0 nt lds
    buffer_load_dwordx4 v8, s[68:71], s92 offen offset:1024 nt lds
    buffer_load_dwordx4 v8, s[68:71], s92 offen offset:2048 nt lds
    buffer_load_dwordx4 v8, s[68:71], s92 offen offset:3072 nt lds
    s_add_u32 m0, s93, 4096
    s_add_u32 s92, s92, 4096
    buffer_load_dwordx4 v8, s[68:71], s92 offen offset:0 nt lds
    buffer_load_dwordx4 v8, s[68:71], s92 offen offset:1024 nt lds
    buffer_load_dwordx4 v8, s[68:71], s92 offen offset:2048 nt lds
    buffer_load_dwordx4 v8, s[68:71], s92 offen offset:3072 nt lds
    s_add_u32 m0, s93, 8192
    s_add_u32 s92, s92, 4096
    buffer_load_dwordx4 v8, s[68:71], s92 offen offset:0 nt lds
KS_GD1:
    s_cmp_ge_u32 s87, 2
    s_cbranch_scc1 KS_GL
    buffer_load_dwordx4 v[48:51], v46, s[72:75], s96 offen nt
    s_sleep 5
    s_add_u32 s96, s96, 147456
    buffer_load_dwordx4 v[52:55], v46, s[72:75], s96 offen nt
    s_sleep 5
    s_add_u32 s96, s96, 147456
    buffer_load_dwordx4 v[56:59], v46, s[72:75], s96 offen nt
    s_sleep 5
    s_add_u32 s96, s96, 147456
    buffer_load_dwordx4 v[60:63], v46, s[72:75], s96 offen nt
    s_sleep 5
    s_add_u32 s96, s96, 147456
    buffer_load_dwordx4 v[64:67], v46, s[72:75], s96 offen nt
    s_sleep 5
    s_add_u32 s96, s96, 147456
    buffer_load_dwordx4 v[68:71], v46, s[72:75], s96 offen nt
    s_sleep 5
    s_add_u32 s96, s96, 147456
    buffer_load_dwordx4 v[72:75], v46, s[72:75], s96 offen nt
    s_sleep 5
    s_add_u32 s96, s96, 147456
    buffer_load_dwordx4 v[76:79], v46, s[72:75], s96 offen nt
    s_sleep 5
    s_add_u32 s96, s96, 147456
    buffer_load_dwordx4 v[80:83], v46, s[72:75], s96 offen nt
    s_sleep 5
    s_add_u32 s96, s96, 147456
    buffer_load_dwordx4 v[84:87], v46, s[72:75], s96 offen nt
    s_sleep 5
    s_add_u32 s96, s96, 147456
    buffer_load_dwordx4 v[88:91], v46, s[72:75], s96 offen nt
    s_sleep 5
    s_add_u32 s96, s96, 147456
    buffer_load_dwordx4 v[92:95], v46, s[72:75], s96 offen nt
    s_sleep 5
    s_add_u32 s96, s96, 147456
    buffer_load_dwordx4 v[96:99], v46, s[72:75], s96 offen nt
    s_sleep 5
    s_add_u32 s96, s96, 147456
    buffer_load_dwordx4 v[100:103], v46, s[72:75], s96 offen nt
    s_sleep 5
    s_add_u32 s96, s96, 147456
    buffer_load_dwordx4 v[104:107], v46, s[72:75], s96 offen nt
    s_sleep 5
    s_add_u32 s96, s96, 147456
    buffer_load_dwordx4 v[108:111], v46, s[72:75], s96 offen nt
    s_sleep 5
    s_add_u32 s96, s96, 147456
    buffer_load_dwordx4 v[112:115], v46, s[72:75], s96 offen nt
    s_sleep 5
    s_add_u32 s96, s96, 147456
    buffer_load_dwordx4 v[116:119], v46, s[72:75], s96 offen nt
    v_add_u32 v8, s97, v8
    s_waitcnt vmcnt(0)
    ds_write_b8 v6, v5 offset:40
W_108:
    s_sleep 2
    ds_read_b32 v10, v4 offset:52
    s_sub_u32 s39, s39, 1
    s_cbranch_scc1 KS_ABORT
    s_waitcnt lgkmcnt(0)
    v_cmp_ne_u32 vcc, s84, v10
    s_cbranch_vccnz W_108
    ds_write_b128 v8, v[48:51] offset:0
    ds_write_b128 v8, v[52:55] offset:1024
    ds_write_b128 v8, v[56:59] offset:2048
    ds_write_b128 v8, v[60:63] offset:3072
    ds_write_b128 v8, v[64:67] offset:4096
    ds_write_b128 v8, v[68:71] offset:5120
    ds_write_b128 v8, v[72:75] offset:6144
    ds_write_b128 v8, v[76:79] offset:7168
    ds_write_b128 v8, v[80:83] offset:8192
    ds_write_b128 v8, v[84:87] offset:9216
    ds_write_b128 v8, v[88:91] offset:10240
    ds_write_b128 v8, v[92:95] offset:11264
    ds_write_b128 v8, v[96:99] offset:12288
    ds_write_b128 v8, v[100:103] offset:13312
    ds_write_b128 v8, v[104:107] offset:14336
    ds_write_b128 v8, v[108:111] offset:15360
    ds_write_b128 v8, v[112:115] offset:16384
    ds_write_b128 v8, v[116:119] offset:17408
    s_branch KS_G4
KS_GL:
    s_add_u32 s96, s96, 2654208
    s_add_u32 s97, s97, 18432
    v_add_u32 v8, s97, v8
    s_waitcnt vmcnt(0)
    ds_write_b8 v6, v5 offset:40
W_109:
    s_sleep 2
    ds_read_b32 v10, v4 offset:52
    s_sub_u32 s39, s39, 1
    s_cbranch_scc1 KS_ABORT
    s_waitcnt lgkmcnt(0)
    v_cmp_ne_u32 vcc, s84, v10
    s_cbranch_vccnz W_109
    s_setprio 1
    s_add_u32 m0, s97, 0
    s_nop 0
    buffer_load_dwordx4 v46, s[72:75], s96 offen offset:0 lds
    s_add_u32 s96, s96, 146432
    buffer_load_dwordx4 v46, s[72:75], s96 offen offset:1024 lds
    s_add_u32 s96, s96, 146432
    buffer_load_dwordx4 v46, s[72:75], s96 offen offset:2048 lds
    s_add_u32 s96, s96, 146432
    buffer_load_dwordx4 v46, s[72:75], s96 offen offset:3072 lds
    s_add_u32 m0, s97, 4096
    s_add_u32 s96, s96, 150528
    buffer_load_dwordx4 v46, s[72:75], s96 offen offset:0 lds
    s_add_u32 s96, s96, 146432
    buffer_load_dwordx4 v46, s[72:75], s96 offen offset:1024 lds
    s_add_u32 s96, s96, 146432
    buffer_load_dwordx4 v46, s[72:75], s96 offen offset:2048 lds
    s_add_u32 s96, s96, 146432
    buffer_load_dwordx4 v46, s[72:75], s96 offen offset:3072 lds
    s_add_u32 m0, s97, 8192
    s_add_u32 s96, s96, 150528
    buffer_load_dwordx4 v46, s[72:75], s96 offen offset:0 lds
    s_add_u32 s96, s96, 146432
    buffer_load_dwordx4 v46, s[72:75], s96 offen offset:1024 lds
    s_add_u32 s96, s96, 146432
    buffer_load_dwordx4 v46, s[72:75], s96 offen offset:2048 lds
    s_add_u32 s96, s96, 146432
    buffer_load_dwordx4 v46, s[72:75], s96 offen offset:3072 lds
    s_add_u32 m0, s97, 12288
    s_add_u32 s96, s96, 150528
    buffer_load_dwordx4 v46, s[72:75], s96 offen offset:0 lds
    s_add_u32 s96, s96, 146432
    buffer_load_dwordx4 v46, s[72:75], s96 offen offset:1024 lds
    s_add_u32 s96, s96, 146432
    buffer_load_dwordx4 v46, s[72:75], s96 offen offset:2048 lds
    s_add_u32 s96, s96, 146432
    buffer_load_dwordx4 v46, s[72:75], s96 offen offset:3072 lds
    s_add_u32 m0, s97, 16384
    s_add_u32 s96, s96, 150528
    buffer_load_dwordx4 v46, s[72:75], s96 offen offset:0 lds
    s_add_u32 s96, s96, 146432
    buffer_load_dwordx4 v46, s[72:75], s96 offen offset:1024 lds
    s_setprio 0
    s_waitcnt vmcnt(0)
KS_G4:
    ds_write_b8 v6, v5 offset:192
    v_lshrrev_b32 v6, 3, v1
    v_xor_b32 v6, v6, v3
    v_and_b32 v6, 1, v6
    v_and_b32 v7, 2, v1
    v_or_b32 v6, v6, v7
    v_xor_b32 v6, s87, v6
    v_mul_u32_u24 v7, 18432, v7
    v_lshl_add_u32 v7, v6, 4, v7
    v_and_b32 v6, 1, v1
    v_lshl_add_u32 v7, v6, 3, v7
    v_bfe_u32 v6, v1, 2, 2
    v_lshl_add_u32 v6, v3, 3, v6
    v_lshl_add_u32 v7, v6, 6, v7
    v_add_u32 v8, 35328, v7
    v_and_b32 v9, 7, v1
    v_lshrrev_b32 v10, 1, v3
    v_and_b32 v11, 1, v3
    v_lshlrev_b32 v6, 5, v9
    v_lshl_add_u32 v6, v10, 8, v6
    v_lshl_add_u32 v6, v11, 4, v6
    v_add_u32 v6, 17088, v6
    s_lshl_b32 s92, s87, 4
    v_lshl_add_u32 v7, v9, 6, s92
    v_lshl_add_u32 v7, v11, 3, v7
    v_lshl_add_u32 v7, v10, 2, v7
    v_bfe_u32 v9, v1, 3, 1
    v_lshl_add_u32 v7, v9, 1, v7
W_110:
    s_sleep 2
    ds_read_b32 v10, v4 offset:192
    s_sub_u32 s39, s39, 1
    s_cbranch_scc1 KS_ABORT
    s_waitcnt lgkmcnt(0)
    v_cmp_ne_u32 vcc, s84, v10
    s_cbranch_vccnz W_110
W_111:
    s_sleep 2
    ds_read_b32 v10, v4 offset:12
    s_sub_u32 s39, s39, 1
    s_cbranch_scc1 KS_ABORT
    s_waitcnt lgkmcnt(0)
    v_cmp_ne_u32 vcc, s84, v10
    s_cbranch_vccnz W_111
    s_sleep 10
    ds_read_b64_tr_b16 v[48:49], v8 offset:0
    ds_read_b64_tr_b16 v[50:51], v8 offset:256
    ds_read_b64_tr_b16 v[52:53], v8 offset:2048
    ds_read_b64_tr_b16 v[54:55], v8 offset:2304
    ds_read_b64_tr_b16 v[56:57], v8 offset:4096
    ds_read_b64_tr_b16 v[58:59], v8 offset:4352
    ds_read_b64_tr_b16 v[60:61], v8 offset:6144
    ds_read_b64_tr_b16 v[62:63], v8 offset:6400
    ds_read_b64_tr_b16 v[64:65], v8 offset:8192
    ds_read_b64_tr_b16 v[66:67], v8 offset:8448
    ds_read_b64_tr_b16 v[68:69], v8 offset:10240
    ds_read_b64_tr_b16 v[70:71], v8 offset:10496
    ds_read_b64_tr_b16 v[72:73], v8 offset:12288
    ds_read_b64_tr_b16 v[74:75], v8 offset:12544
    ds_read_b64_tr_b16 v[76:77], v8 offset:14336
    ds_read_b64_tr_b16 v[78:79], v8 offset:14592
    ds_read_b64_tr_b16 v[80:81], v8 offset:16384
    ds_read_b64_tr_b16 v[82:83], v8 offset:16640
    ds_read_b64_tr_b16 v[84:85], v8 offset:18432
    ds_read_b64_tr_b16 v[86:87], v8 offset:18688
    ds_read_b64_tr_b16 v[88:89], v8 offset:20480
    ds_read_b64_tr_b16 v[90:91], v8 offset:20736
    ds_read_b64_tr_b16 v[92:93], v8 offset:22528
    ds_read_b64_tr_b16 v[94:95], v8 offset:22784
    ds_read_b64_tr_b16 v[96:97], v8 offset:24576
    ds_read_b64_tr_b16 v[98:99], v8 offset:24832
    ds_read_b64_tr_b16 v[100:101], v8 offset:26624
    ds_read_b64_tr_b16 v[102:103], v8 offset:26880
    ds_read_b64_tr_b16 v[104:105], v8 offset:28672
    ds_read_b64_tr_b16 v[106:107], v8 offset:28928
    ds_read_b64_tr_b16 v[108:109], v8 offset:30720
    ds_read_b64_tr_b16 v[110:111], v8 offset:30976
    ds_read_b64_tr_b16 v[112:113], v8 offset:32768
    ds_read_b64_tr_b16 v[114:115], v8 offset:33024
    ds_read_b64_tr_b16 v[116:117], v8 offset:34816
    ds_read_b64_tr_b16 v[118:119], v8 offset:35072
W_112:
    s_sleep 2
    ds_read_b32 v10, v4 offset:768
    s_sub_u32 s39, s39, 1
    s_cbranch_scc1 KS_ABORT
    s_waitcnt lgkmcnt(0)
    v_cmp_eq_u32 vcc, 0, v10
    s_cbranch_vccnz W_112
    s_setprio 3
KS_GC:
    s_mov_b32 exec_lo, 0x00ff00ff
    s_mov_b32 exec_hi, 0x00ff00ff
KS_GW:
    ds_read_b32 v0, v4 offset:32
    ds_read_b128 v[8:11], v6 offset:0
    ds_read_b128 v[12:15], v6 offset:512
    ds_read_b128 v[16:19], v6 offset:1024
    ds_read_b128 v[20:23], v6 offset:1536
    s_sub_u32 s39, s39, 1
    s_cbranch_scc1 KS_ABORT
    s_waitcnt lgkmcnt(4)
    v_cmp_eq_u32 vcc, 0, v0
    s_cbranch_vccnz KS_GW
    s_waitcnt lgkmcnt(3)
    v_mfma_f32_16x16x32_bf16 v[120:123], v[48:51], v[8:11], 0
    ds_read_b128 v[24:27], v6 offset:2048
    ds_read_b128 v[28:31], v6 offset:2560
    s_waitcnt lgkmcnt(4)
    v_mfma_f32_16x16x32_bf16 v[124:127], v[52:55], v[12:15], 0
    ds_read_b128 v[32:35], v6 offset:3072
    ds_read_b128 v[36:39], v6 offset:3584
    s_waitcnt lgkmcnt(5)
    v_mfma_f32_16x16x32_bf16 v[120:123], v[56:59], v[16:19], v[120:123]
    ds_read_b128 v[40:43], v6 offset:4096
    ds_read_b128 v[44:47], v6 offset:4608
    s_waitcnt lgkmcnt(6)
    v_mfma_f32_16x16x32_bf16 v[124:127], v[60:63], v[20:23], v[124:127]
    ds_read_b128 v[8:11], v6 offset:5120
    ds_read_b128 v[12:15], v6 offset:5632
    s_waitcnt lgkmcnt(7)
    v_mfma_f32_16x16x32_bf16 v[120:123], v[64:67], v[24:27], v[120:123]
    ds_read_b128 v[16:19], v6 offset:6144
    ds_read_b128 v[20:23], v6 offset:6656
    s_waitcnt lgkmcnt(8)
    v_mfma_f32_16x16x32_bf16 v[124:127], v[68:71], v[28:31], v[124:127]
    ds_read_b128 v[24:27], v6 offset:7168
    ds_read_b128 v[28:31], v6 offset:7680
    s_waitcnt lgkmcnt(9)
    v_mfma_f32_16x16x32_bf16 v[120:123], v[72:75], v[32:35], v[120:123]
    ds_read_b128 v[32:35], v6 offset:8192
    s_waitcnt lgkmcnt(9)
    v_mfma_f32_16x16x32_bf16 v[124:127], v[76:79], v[36:39], v[124:127]
    ds_read_b128 v[36:39], v6 offset:8704
    s_waitcnt lgkmcnt(9)
    v_mfma_f32_16x16x32_bf16 v[120:123], v[80:83], v[40:43], v[120:123]
    s_waitcnt lgkmcnt(8)
    v_mfma_f32_16x16x32_bf16 v[124:127], v[84:87], v[44:47], v[124:127]
    s_waitcnt lgkmcnt(7)
    v_mfma_f32_16x16x32_bf16 v[120:123], v[88:91], v[8:11], v[120:123]
    s_waitcnt lgkmcnt(6)
    v_mfma_f32_16x16x32_bf16 v[124:127], v[92:95], v[12:15], v[124:127]
    s_waitcnt lgkmcnt(5)
    v_mfma_f32_16x16x32_bf16 v[120:123], v[96:99], v[16:19], v[120:123]
    s_waitcnt lgkmcnt(4)
    v_mfma_f32_16x16x32_bf16 v[124:127], v[100:103], v[20:23], v[124:127]
    s_waitcnt lgkmcnt(3)
    v_mfma_f32_16x16x32_bf16 v[120:123], v[104:107], v[24:27], v[120:123]
    s_waitcnt lgkmcnt(2)
    v_mfma_f32_16x16x32_bf16 v[124:127], v[108:111], v[28:31], v[124:127]
    s_waitcnt lgkmcnt(1)
    v_mfma_f32_16x16x32_bf16 v[120:123], v[112:115], v[32:35], v[120:123]
    s_waitcnt lgkmcnt(0)
    v_mfma_f32_16x16x32_bf16 v[124:127], v[116:119], v[36:39], v[124:127]
    s_mov_b64 exec, -1
    s_nop 6
    v_pk_add_f32 v[120:121], v[120:121], v[124:125]
    v_pk_add_f32 v[122:123], v[122:123], v[126:127]
    s_nop 1
    v_permlane32_swap_b32 v121, v123
    v_permlane32_swap_b32 v120, v122
    s_nop 0
    v_mov_b32_dpp v120, v121 row_shr:8 row_mask:0xf bank_mask:0xc
    v_mov_b32_dpp v122, v123 row_shr:8 row_mask:0xf bank_mask:0xc
    v_cvt_pk_bf16_f32 v120, 0, v120
    v_mul_f32 v121, 0xbfb8aa3b, v120
    v_exp_f32 v121, v121
    v_cvt_pk_bf16_f32 v122, 0, v122
    v_add_f32 v121, 1.0, v121
    v_rcp_f32 v121, v121
    s_nop 0
    v_mul_f32 v121, v120, v121
    v_cvt_pk_bf16_f32 v121, 0, v121
    v_mul_f32 v121, v121, v122
    v_cvt_pk_bf16_f32 v121, v121, v121
    ds_write_b16 v7, v121 offset:1024
    s_waitcnt lgkmcnt(0)
    s_barrier
    s_setprio 0
    ds_read_b32 v0, v4 offset:24
    s_waitcnt lgkmcnt(0)
    v_cmp_eq_u32 vcc, 0, v0
    s_cbranch_vccnz KS_PEND
    s_barrier
    s_branch KS_GC
KS_PEND:
KS_ABORT:
KS_END:
    s_endpgm
.section .rodata,"a"
.p2align 6
.amdhsa_kernel sequential_preLN__ssm_conv_s4__moe_arch_mod__prompt_kernel
  .amdhsa_next_free_vgpr 128
  .amdhsa_next_free_sgpr 100
  .amdhsa_accum_offset 128
  .amdhsa_group_segment_fixed_size 0
  .amdhsa_kernarg_size 136
  .amdhsa_user_sgpr_count 2
  .amdhsa_user_sgpr_kernarg_segment_ptr 1
  .amdhsa_system_sgpr_workgroup_id_x 1
  .amdhsa_float_denorm_mode_32 3
.end_amdhsa_kernel
```

```asm
; @launch grid=(256,1,1) block=(1024,1,1) lds=154240
.amdgcn_target "amdgcn-amd-amdhsa--gfx950"
.text
.globl sequential_preLN__ssm_conv_s4__moe_arch_mod__prompt_kernel
.p2align 8
.type sequential_preLN__ssm_conv_s4__moe_arch_mod__prompt_kernel,@function
sequential_preLN__ssm_conv_s4__moe_arch_mod__prompt_kernel:
    s_cmp_ge_u32 s2, 256
    s_cbranch_scc1 KS_END
    s_load_dwordx16 s[4:19], s[0:1], 0
    s_load_dwordx16 s[20:35], s[0:1], 64
    s_load_dwordx2 s[36:37], s[0:1], 128
    v_readfirstlane_b32 s38, v0
    s_lshr_b32 s38, s38, 6
    s_and_b32 s40, s2, 7
    s_lshr_b32 s41, s2, 3
    s_cmp_lg_u32 s38, 0
    s_cbranch_scc1 KS_CPE
    s_getpc_b64 s[42:43]
KS_PC:
    s_and_b32 s92, s41, 7
    s_mul_i32 s92, s92, 4608
    v_and_b32 v126, 63, v0
    v_lshl_add_u32 v126, v126, 7, s92
    v_min_u32 v126, KS_END-KS_PC, v126
    global_load_dword v127, v126, s[42:43]
KS_CPE:
    s_add_u32 s92, s38, 8
    s_sub_u32 s93, s38, 4
    s_cmp_lt_u32 s38, 8
    s_cselect_b32 s92, s92, s93
    s_cmp_lt_u32 s38, 4
    s_cselect_b32 s38, s38, s92
    v_and_b32 v1, 63, v0
    v_and_b32 v2, 15, v1
    v_lshrrev_b32 v3, 4, v1
    v_mov_b32 v4, 0
    v_mov_b32 v5, 1
    s_mov_b32 s39, 524288
    s_mov_b32 s84, 0x01010101
    s_lshl_b32 s90, s40, 5
    s_add_u32 s90, s90, s41
    s_mul_i32 s89, s40, 18
    s_add_u32 s89, s89, s41
    s_cmp_lt_u32 s38, 4
    s_cbranch_scc1 KS_L
    s_cmp_ge_u32 s38, 12
    s_cbranch_scc1 KS_X
    s_setprio 2
    s_lshr_b32 s87, s38, 2
    s_sub_u32 s87, s87, 1
    s_mul_i32 s86, s87, 3
    s_xor_b32 s86, s86, s38
    s_and_b32 s86, s86, 3
    s_lshl_b32 s88, s90, 1
    s_add_u32 s88, s88, s87
    s_lshl_b32 s92, s86, 11
    s_add_u32 s92, s92, 146048
    v_lshl_add_u32 v28, v1, 3, s92
    s_cmp_eq_u32 s86, 3
    s_cbranch_scc1 PX_1
    v_lshlrev_b32 v26, 3, v2
    v_mov_b32 v21, 0x80
    s_cmp_eq_u32 s86, 1
    s_cbranch_scc1 PX_2
    s_cmp_eq_u32 s86, 2
    s_cbranch_scc1 PX_3
    v_lshl_add_u32 v26, v3, 1, v26
    v_mov_b32 v22, 1
    s_branch PX_4
PX_2:
    v_cmp_gt_u32 vcc, 2, v3
    v_lshl_add_u32 v20, v3, 2, v26
    v_add_u32 v20, 256, v20
    v_lshl_add_u32 v26, v3, 8, v26
    v_cndmask_b32 v26, v26, v20, vcc
    v_cndmask_b32 v22, v21, 2, vcc
    v_cndmask_b32 v21, 4, v21, vcc
    s_branch PX_4
PX_3:
    v_lshl_add_u32 v26, v3, 9, v26
    v_add_u32 v26, 0x400, v26
    v_mov_b32 v22, 0x100
PX_4:
    v_mad_u32_u24 v26, v22, s87, v26
    v_add_u32 v27, v26, v21
    s_movk_i32 s96, 31232
    s_movk_i32 s97, -19072
    s_lshl_b32 s95, s87, 9
    v_cvt_f32_u32 v20, v26
    v_max_u32 v22, 0x800, v26
    v_cvt_f32_u32 v21, v27
    v_max_u32 v23, 0x800, v27
    v_cmp_gt_u32 vcc, 0x80, v26
    v_lshrrev_b32 v24, 16, v20
    v_add3_u32 v24, v24, v22, s97
    v_cndmask_b32 v24, v24, v26, vcc
    v_cmp_gt_u32 vcc, 0x80, v27
    v_lshrrev_b32 v25, 16, v21
    v_add3_u32 v25, v25, v23, s97
    v_cndmask_b32 v25, v25, v27, vcc
    v_min_u32 v24, 642, v24
    v_lshl_add_u32 v24, v24, 1, s96
    v_min_u32 v25, 642, v25
    v_lshl_add_u32 v25, v25, 1, s96
    v_add_u32 v29, s95, v28
    v_lshl_or_b32 v24, v25, 16, v24
    v_lshl_or_b32 v25, v27, 16, v26
    ds_write_b64 v29, v[24:25]
PX_1:
KS_GRP:
    s_lshl_b32 s92, s88, 8
    v_lshl_add_u32 v20, v1, 2, s92
    s_lshl_b32 s92, s88, 1
    v_mov_b32 v21, s92
    s_mul_i32 s85, s87, 36672
    s_add_u32 s85, s85, 35840
    s_waitcnt lgkmcnt(0)
    global_load_ushort v46, v21, s[18:19]
    global_load_dword v40, v20, s[6:7]
    global_load_dword v41, v20, s[8:9]
    global_load_dword v42, v20, s[10:11]
    global_load_dword v43, v20, s[12:13]
    global_load_dword v44, v20, s[14:15]
    global_load_dword v45, v20, s[16:17]
    global_load_ushort v107, v21, s[20:21]
    s_barrier
    s_movk_i32 s96, 31232
    s_cmp_eq_u32 s87, 2
    s_cbranch_scc1 PREE_7
    v_mov_b32 v32, 641
    s_cmp_eq_u32 s87, 1
    s_cbranch_scc1 PREB_5
    v_mov_b32 v33, 32514
    s_cmp_eq_u32 s86, 1
    s_cbranch_scc1 PRE_9
    s_cmp_eq_u32 s86, 2
    s_cbranch_scc1 PRE_10
    s_cmp_eq_u32 s86, 3
    s_cbranch_scc1 PRE_11
    v_lshlrev_b32 v23, 1, v1
    v_sub_u32 v30, 93, v23
    v_cmp_lt_u32 vcc, 61, v30
    v_lshlrev_b32 v31, 2, v30
    v_add_u32 v31, 32010, v31
    v_cndmask_b32 v24, v31, v33, vcc
    v_sub_u32 v30, 92, v23
    v_cmp_lt_u32 vcc, 61, v30
    v_lshlrev_b32 v31, 2, v30
    v_add_u32 v31, 32010, v31
    v_cndmask_b32 v25, v31, v33, vcc
    v_sub_u32 v30, 94, v23
    v_cmp_lt_u32 vcc, 62, v30
    v_lshlrev_b32 v31, 2, v30
    v_add_u32 v31, 32008, v31
    v_cndmask_b32 v26, v31, v33, vcc
    v_sub_u32 v30, 93, v23
    v_cmp_lt_u32 vcc, 62, v30
    v_lshlrev_b32 v31, 2, v30
    v_add_u32 v31, 32008, v31
    v_cndmask_b32 v27, v31, v33, vcc
    s_branch PREW_6
PRE_9:
    v_min_u32 v23, 47, v1
    v_lshlrev_b32 v23, 1, v23
    v_sub_u32 v30, 64, v23
    v_cmp_lt_u32 vcc, 63, v30
    v_lshlrev_b32 v31, 2, v30
    v_add_u32 v31, 32258, v31
    v_cndmask_b32 v24, v31, v33, vcc
    v_sub_u32 v30, 63, v23
    v_cmp_lt_u32 vcc, 63, v30
    v_lshlrev_b32 v31, 2, v30
    v_add_u32 v31, 32258, v31
    v_cndmask_b32 v25, v31, v33, vcc
    v_sub_u32 v30, 62, v23
    v_cmp_lt_u32 vcc, 63, v30
    v_lshlrev_b32 v31, 2, v30
    v_add_u32 v31, 32258, v31
    v_cndmask_b32 v27, v31, v33, vcc
    v_mov_b32 v26, v25
    s_branch PREW_6
PRE_10:
    v_min_u32 v23, 47, v1
    v_lshlrev_b32 v23, 1, v23
    v_sub_u32 v30, 64, v23
    v_cmp_lt_u32 vcc, 63, v30
    v_lshlrev_b32 v31, 2, v30
    v_add_u32 v31, 32260, v31
    v_cndmask_b32 v24, v31, v33, vcc
    v_sub_u32 v30, 63, v23
    v_cmp_lt_u32 vcc, 63, v30
    v_lshlrev_b32 v31, 2, v30
    v_add_u32 v31, 32260, v31
    v_cndmask_b32 v25, v31, v33, vcc
    v_sub_u32 v30, 62, v23
    v_cmp_lt_u32 vcc, 63, v30
    v_lshlrev_b32 v31, 2, v30
    v_add_u32 v31, 32260, v31
    v_cndmask_b32 v27, v31, v33, vcc
    v_mov_b32 v26, v25
    s_branch PREW_6
PRE_11:
    v_cmp_gt_u32 vcc, 9, v1
    v_add_u32 v23, 0x100, v1
    v_mov_b32 v33, 0x200
    v_cndmask_b32 v23, v23, v1, vcc
    v_lshlrev_b32 v23, 1, v23
    v_sub_u32 v30, 544, v23
    v_cvt_f32_i32 v31, v30
    v_cmp_gt_u32 vcc, 0x100, v30
    v_cvt_pk_bf16_f32 v31, v31, v31
    v_and_b32 v31, 0xffff, v31
    v_subrev_u32 v31, 0x4280, v31
    v_cndmask_b32 v31, v31, v30, vcc
    v_cmp_lt_u32 vcc, 0x20d, v30
    v_or_b32 v30, 1, v23
    s_nop 0
    v_cndmask_b32 v31, v31, v32, vcc
    v_cmp_eq_u32 vcc, 0x25d, v30
    s_nop 1
    v_cndmask_b32 v31, v31, v33, vcc
    v_lshl_add_u32 v24, v31, 1, s96
    v_add_u32 v23, 1, v23
    v_sub_u32 v30, 544, v23
    v_cvt_f32_i32 v31, v30
    v_cmp_gt_u32 vcc, 0x100, v30
    v_cvt_pk_bf16_f32 v31, v31, v31
    v_and_b32 v31, 0xffff, v31
    v_subrev_u32 v31, 0x4280, v31
    v_cndmask_b32 v31, v31, v30, vcc
    v_cmp_lt_u32 vcc, 0x20d, v30
    v_or_b32 v30, 1, v23
    s_nop 0
    v_cndmask_b32 v31, v31, v32, vcc
    v_cmp_eq_u32 vcc, 0x25d, v30
    s_nop 1
    v_cndmask_b32 v31, v31, v33, vcc
    v_lshl_add_u32 v25, v31, 1, s96
    v_add_u32 v23, 1, v23
    v_sub_u32 v30, 544, v23
    v_cvt_f32_i32 v31, v30
    v_cmp_gt_u32 vcc, 0x100, v30
    v_cvt_pk_bf16_f32 v31, v31, v31
    v_and_b32 v31, 0xffff, v31
    v_subrev_u32 v31, 0x4280, v31
    v_cndmask_b32 v31, v31, v30, vcc
    v_cmp_lt_u32 vcc, 0x20d, v30
    v_or_b32 v30, 1, v23
    s_nop 0
    v_cndmask_b32 v31, v31, v32, vcc
    v_cmp_eq_u32 vcc, 0x25d, v30
    s_nop 1
    v_cndmask_b32 v31, v31, v33, vcc
    v_lshl_add_u32 v27, v31, 1, s96
    v_mov_b32 v26, v25
    s_branch PREW_6
PREB_5:
    s_lshl_b32 s93, s86, 7
    s_add_u32 s93, s93, 18
    v_lshl_add_u32 v23, v1, 1, s93
    v_sub_u32 v30, 544, v23
    v_cvt_f32_i32 v31, v30
    v_cmp_gt_u32 vcc, 0x100, v30
    v_cvt_pk_bf16_f32 v31, v31, v31
    v_and_b32 v31, 0xffff, v31
    v_subrev_u32 v31, 0x4280, v31
    v_cndmask_b32 v31, v31, v30, vcc
    v_cmp_lt_u32 vcc, 0x20d, v30
    s_nop 1
    v_cndmask_b32 v31, v31, v32, vcc
    v_lshl_add_u32 v24, v31, 1, s96
    v_add_u32 v23, 1, v23
    v_sub_u32 v30, 544, v23
    v_cvt_f32_i32 v31, v30
    v_cmp_gt_u32 vcc, 0x100, v30
    v_cvt_pk_bf16_f32 v31, v31, v31
    v_and_b32 v31, 0xffff, v31
    v_subrev_u32 v31, 0x4280, v31
    v_cndmask_b32 v31, v31, v30, vcc
    v_cmp_lt_u32 vcc, 0x20d, v30
    s_nop 1
    v_cndmask_b32 v31, v31, v32, vcc
    v_lshl_add_u32 v25, v31, 1, s96
    v_add_u32 v23, 1, v23
    v_sub_u32 v30, 544, v23
    v_cvt_f32_i32 v31, v30
    v_cmp_gt_u32 vcc, 0x100, v30
    v_cvt_pk_bf16_f32 v31, v31, v31
    v_and_b32 v31, 0xffff, v31
    v_subrev_u32 v31, 0x4280, v31
    v_cndmask_b32 v31, v31, v30, vcc
    v_cmp_lt_u32 vcc, 0x20d, v30
    s_nop 1
    v_cndmask_b32 v31, v31, v32, vcc
    v_lshl_add_u32 v26, v31, 1, s96
    s_sub_u32 s93, s86, 1
    s_cmp_lt_u32 s93, 2
    s_cselect_b32 s94, 47, 63
    s_mul_i32 s93, s93, 384
    s_add_u32 s93, s93, 35664
    s_cmp_eq_u32 s86, 0
    s_cselect_b32 s93, 35152, s93
    s_cmp_eq_u32 s86, 3
    s_cselect_b32 s93, 32528, s93
    s_cselect_b32 s95, 0x100, 0
    v_cmp_gt_u32 vcc, 9, v1
    v_min_u32 v23, s94, v1
    v_add_u32 v30, s95, v23
    v_cndmask_b32 v23, v30, v23, vcc
    s_sub_u32 s93, s93, 5244
    v_lshl_add_u32 v27, v23, 2, s93
    v_lshl_or_b32 v24, v25, 16, v24
    v_lshl_or_b32 v25, v27, 16, v26
    ds_write_b64 v28, v[24:25] offset:1024
    v_mov_b32 v24, s86
    ds_write_b8 v24, v5 offset:212
    s_branch PREE_7
PREW_6:
    v_lshl_or_b32 v24, v25, 16, v24
    v_lshl_or_b32 v25, v27, 16, v26
    ds_write_b64 v28, v[24:25] offset:1536
    v_mov_b32 v24, s86
    ds_write_b8 v24, v5 offset:208
PREE_7:
    s_mul_i32 s93, s86, 8704
    s_min_u32 s94, s93, 22304
    s_add_u32 s94, s94, s85
    s_lshl_b32 s92, s87, 4
    v_mov_b32 v14, s92
    v_add_u32 v15, s86, v14
    v_lshl_add_u32 v72, v1, 3, s94
    v_add_u32 v73, 2176, v72
    v_add_u32 v74, 4352, v72
    v_add_u32 v75, 6528, v72
    v_mul_u32_u24 v126, 544, v2
    v_lshl_add_u32 v126, v3, 4, v126
    v_add_u32 v126, s85, v126
    v_add_u32 v127, s93, v126
    v_lshlrev_b32 v20, 3, v3
    v_sub_u32 v20, v20, v2
    v_add_u32 v21, 16, v20
    v_lshrrev_b32 v21, 1, v21
    v_and_b32 v23, 1, v21
    s_movk_i32 s93, -5244
    v_and_b32 v22, 1, v2
    s_add_u32 s92, s85, 32528
    v_lshl_add_u32 v21, v21, 2, s92
    s_movk_i32 s92, 1344
    s_movk_i32 s94, 192
    v_mad_i32_i24 v21, v23, s93, v21
    v_mad_u32_u24 v6, v22, s92, v21
    v_add_u32 v7, 640, v6
    v_mad_u32_u24 v23, v22, s94, v21
    v_add_u32 v13, 3136, v23
    v_lshlrev_b32 v23, 2, v3
    v_sub_u32 v23, v23, v2
    s_add_u32 s92, s85, 29968
    v_lshl_add_u32 v11, v23, 2, s92
    s_movk_i32 s93, 5244
    v_mad_u32_u24 v11, v22, s93, v11
    s_mul_i32 s94, s87, 4672
    s_add_u32 s94, s94, 3072
    v_lshl_add_u32 v23, v2, 5, s94
    v_lshl_add_u32 v8, v3, 4, v23
    v_bfe_u32 v20, v1, 2, 2
    v_and_b32 v21, 3, v1
    v_lshl_add_u32 v20, v3, 3, v20
    v_lshlrev_b32 v105, 2, v21
    v_lshl_add_u32 v21, v21, 3, s85
    v_lshl_add_u32 v9, v20, 4, v21
    v_lshl_add_u32 v10, v20, 5, v21
    v_lshlrev_b32 v12, 4, v1
    s_add_u32 s64, s36, 0x600000
    s_addc_u32 s65, s37, 0
    s_mov_b32 s66, 0x240000
    s_mov_b32 s67, 0x20000
    s_mov_b32 s10, 0x8080
    s_lshl_b32 s92, s86, 19
    s_lshl_b32 s93, s90, 6
    s_add_u32 s92, s92, s93
    s_lshl_b32 s93, s86, 16
    s_lshl_b32 s95, s88, 6
    s_add_u32 s93, s93, s95
    s_add_u32 s93, s93, 2064384
    s_cmp_eq_u32 s87, 2
    s_cselect_b32 s6, s93, s92
    s_cselect_b32 s8, 0x1080, s10
    s_cselect_b32 s92, 1, 3
    s_and_b32 s92, s92, s86
    s_lshl_b32 s92, s92, 11
    s_xor_b32 s6, s6, s92
    s_and_b32 s10, s6, 0x7c0
    s_xor_b32 s6, s6, s10
    s_xor_b32 s7, s6, 0x6000
    s_and_b32 s9, s87, 1
    s_lshl_b32 s9, s9, 4
    s_mov_b32 s12, 0x55555555
    s_mov_b32 s13, 0x55555555
    s_lshl_b32 s92, s86, 8
    s_add_u32 s92, s92, s85
    s_add_u32 s92, s92, 36
    v_lshl_add_u32 v124, v1, 2, s92
    s_movk_i32 s92, 192
    s_cmp_eq_u32 s86, 0
    s_cselect_b32 s92, 256, s92
    s_cmp_eq_u32 s86, 3
    s_cselect_b32 s92, 1344, s92
    v_mov_b32 v20, s85
    ds_write_b16 v20, v4 offset:32514
    s_mov_b32 s18, s92
    v_mov_b32 v125, v28
W_12:
    ds_read_b64 v[18:19], v4 offset:208
    s_sub_u32 s39, s39, 1
    s_cbranch_scc1 KS_ABORT
    s_waitcnt lgkmcnt(0)
    v_and_b32 v18, v18, v19
    v_cmp_ne_u32 vcc, s84, v18
    s_cbranch_vccnz W_12
    ds_read2st64_b64 v[28:31], v125 offset0:0 offset1:1
    ds_read2st64_b64 v[32:35], v125 offset0:2 offset1:3
    s_waitcnt lgkmcnt(0)
    v_add_u32_sdwa v108, s85, v28 dst_sel:DWORD dst_unused:UNUSED_PAD src0_sel:DWORD src1_sel:WORD_0
    v_add_u32_sdwa v109, s85, v28 dst_sel:DWORD dst_unused:UNUSED_PAD src0_sel:DWORD src1_sel:WORD_1
    v_cvt_f32_u32_sdwa v110, v29 dst_sel:DWORD dst_unused:UNUSED_PAD src0_sel:WORD_0
    v_cvt_f32_u32_sdwa v111, v29 dst_sel:DWORD dst_unused:UNUSED_PAD src0_sel:WORD_1
    v_add_u32_sdwa v112, s85, v30 dst_sel:DWORD dst_unused:UNUSED_PAD src0_sel:DWORD src1_sel:WORD_0
    v_add_u32_sdwa v113, s85, v30 dst_sel:DWORD dst_unused:UNUSED_PAD src0_sel:DWORD src1_sel:WORD_1
    v_cvt_f32_u32_sdwa v114, v31 dst_sel:DWORD dst_unused:UNUSED_PAD src0_sel:WORD_0
    v_cvt_f32_u32_sdwa v115, v31 dst_sel:DWORD dst_unused:UNUSED_PAD src0_sel:WORD_1
    v_add_u32_sdwa v116, s85, v32 dst_sel:DWORD dst_unused:UNUSED_PAD src0_sel:DWORD src1_sel:WORD_0
    v_add_u32_sdwa v117, s85, v32 dst_sel:DWORD dst_unused:UNUSED_PAD src0_sel:DWORD src1_sel:WORD_1
    v_add_u32_sdwa v118, s85, v33 dst_sel:DWORD dst_unused:UNUSED_PAD src0_sel:DWORD src1_sel:WORD_0
    v_add_u32_sdwa v119, s85, v33 dst_sel:DWORD dst_unused:UNUSED_PAD src0_sel:DWORD src1_sel:WORD_1
    v_add_u32_sdwa v120, s85, v34 dst_sel:DWORD dst_unused:UNUSED_PAD src0_sel:DWORD src1_sel:WORD_0
    v_add_u32_sdwa v121, s85, v34 dst_sel:DWORD dst_unused:UNUSED_PAD src0_sel:DWORD src1_sel:WORD_1
    v_add_u32_sdwa v122, s85, v35 dst_sel:DWORD dst_unused:UNUSED_PAD src0_sel:DWORD src1_sel:WORD_0
    v_add_u32_sdwa v123, s85, v35 dst_sel:DWORD dst_unused:UNUSED_PAD src0_sel:DWORD src1_sel:WORD_1
    v_add_u32 v125, s18, v119
    s_lshl_b32 s92, s87, 5
    s_add_u32 s92, s92, s41
    s_cmp_ge_u32 s92, 88
    s_cbranch_scc1 KC_RECV
    s_mov_b32 s92, 0x3fb8aa3b
    s_mov_b32 s93, 0x32a57060
    s_mov_b32 s94, 0x3e22f983
    s_mov_b32 s95, 0x31dc9c88
    s_waitcnt vmcnt(7)
    v_lshlrev_b32 v16, 16, v46
    v_mul_f32 v17, s92, v16
    v_fma_f32 v19, v16, s92, -v17
    v_fmac_f32 v19, s93, v16
    v_exp_f32 v17, v17
    v_mul_f32 v19, 0x3f317218, v19
    v_fmac_f32 v17, v17, v19
    v_cvt_pk_bf16_f32 v16, 0, v17
    s_waitcnt vmcnt(5)
    ds_write_b32 v4, v5 offset:36
    v_lshlrev_b32 v20, 16, v40
    v_and_b32 v21, 0xffff0000, v40
    v_lshlrev_b32 v22, 16, v41
    v_and_b32 v23, 0xffff0000, v41
    v_pk_mul_f32 v[20:21], v[20:21], v[16:17] op_sel_hi:[1,0]
    v_pk_mul_f32 v[22:23], v[22:23], v[16:17] op_sel_hi:[1,0]
    v_max_f32 v36, v20, v21
    v_pk_mul_f32 v[68:69], v[22:23], s[94:95] op_sel_hi:[1,0]
    v_pk_fma_f32 v[70:71], v[22:23], s[94:95], v[68:69] op_sel_hi:[1,0,1] neg_lo:[0,0,1] neg_hi:[0,0,1]
    v_pk_fma_f32 v[70:71], v[22:23], s[94:95], v[70:71] op_sel:[0,1,0]
    s_cmp_eq_u32 s86, 3
    s_cbranch_scc1 SK_14
    s_waitcnt vmcnt(1)
    v_lshlrev_b32 v24, 16, v42
    v_and_b32 v25, 0xffff0000, v42
    v_lshlrev_b32 v26, 16, v43
    v_and_b32 v27, 0xffff0000, v43
    v_lshlrev_b32 v28, 16, v44
    v_and_b32 v29, 0xffff0000, v44
    v_lshlrev_b32 v30, 16, v45
    v_and_b32 v31, 0xffff0000, v45
    v_pk_mul_f32 v[24:25], v[24:25], v[16:17] op_sel_hi:[1,0]
    v_pk_mul_f32 v[26:27], v[26:27], v[16:17] op_sel_hi:[1,0]
    v_pk_mul_f32 v[90:91], v[30:31], v[26:27]
    v_pk_mul_f32 v[92:93], v[30:31], v[24:25]
    v_pk_fma_f32 v[34:35], v[28:29], v[26:27], v[92:93]
    v_pk_fma_f32 v[32:33], v[28:29], v[24:25], v[90:91] neg_lo:[0,0,1] neg_hi:[0,0,1]
    v_max3_f32 v37, abs(v34), abs(v35), abs(v32)
    v_max_f32 v37, v37, abs(v33)
SK_14:
    s_waitcnt vmcnt(0)
    s_nop 0
    v_permlane32_swap_b32 v36, v37
    v_max_f32 v36, v36, v37
    s_nop 1
    v_max_f32_dpp v36, v36, v36 row_ror:8 row_mask:0xf bank_mask:0xf
    s_nop 1
    v_max_f32_dpp v36, v36, v36 row_ror:4 row_mask:0xf bank_mask:0xf
    s_nop 1
    v_max_f32_dpp v36, v36, v36 row_ror:2 row_mask:0xf bank_mask:0xf
    s_nop 1
    v_max_f32_dpp v36, v36, v36 row_ror:1 row_mask:0xf bank_mask:0xf
    v_mov_b32 v38, v36
    s_nop 1
    v_permlane16_swap_b32 v36, v38
    v_max_f32 v36, v36, v38
    s_nop 0
    v_readlane_b32 s14, v36, 0
    v_readlane_b32 s15, v36, 32
    s_add_u32 s15, s15, 0x7fffff
    s_lshr_b32 s15, s15, 23
    s_max_u32 s15, s15, 24
    s_sub_u32 s16, 269, s15
    s_lshl_b32 s16, s16, 23
    v_subrev_f32 v20, s14, v20
    v_subrev_f32 v21, s14, v21
    v_mul_f32 v20, 0x3fb8aa3b, v20
    v_mul_f32 v21, 0x3fb8aa3b, v21
    s_cmp_eq_u32 s86, 3
    s_cbranch_scc1 JOB_18
    s_cmp_eq_u32 s86, 1
    s_cbranch_scc1 JOB_16
    s_cmp_eq_u32 s86, 2
    s_cbranch_scc1 JOB_17
    v_mul_f32 v91, 0x43000000, v68
    v_mul_f32 v90, 0x43000000, v20
    v_mul_f32 v95, 0x43000000, v69
    v_mul_f32 v94, 0x43000000, v21
    v_fract_f32 v91, v91
    v_fract_f32 v95, v95
    v_fmac_f32 v91, 0x43000000, v70
    v_fmac_f32 v95, 0x43000000, v71
    v_exp_f32 v90, v90
    v_cos_f32 v92, v91
    v_sin_f32 v91, v91
    v_exp_f32 v94, v94
    v_cos_f32 v96, v95
    v_sin_f32 v95, v95
    v_mul_f32 v44, v90, v92
    v_mul_f32 v46, v90, v91
    v_mul_f32 v45, v94, v96
    v_mul_f32 v47, v94, v95
    v_pk_mul_f32 v[32:33], v[32:33], s[16:17] op_sel_hi:[1,0]
    v_pk_mul_f32 v[34:35], v[34:35], s[16:17] op_sel_hi:[1,0]
    v_fract_f32 v91, v68
    v_fract_f32 v95, v69
    v_fmac_f32 v91, 1.0, v70
    v_fmac_f32 v95, 1.0, v71
    v_exp_f32 v90, v20
    v_cos_f32 v92, v91
    v_sin_f32 v91, v91
    v_exp_f32 v94, v21
    v_cos_f32 v96, v95
    v_sin_f32 v95, v95
    v_mul_f32 v40, v90, v92
    v_mul_f32 v42, v90, v91
    v_mul_f32 v41, v94, v96
    v_mul_f32 v43, v94, v95
    v_pk_mul_f32 v[90:91], v[34:35], v[46:47]
    v_pk_mul_f32 v[94:95], v[34:35], v[42:43]
    v_pk_mul_f32 v[92:93], v[34:35], v[44:45]
    v_pk_mul_f32 v[96:97], v[34:35], v[40:41]
    v_pk_fma_f32 v[62:63], v[32:33], v[46:47], v[92:93]
    v_pk_fma_f32 v[54:55], v[32:33], v[42:43], v[96:97]
    v_pk_fma_f32 v[60:61], v[32:33], v[44:45], v[90:91] neg_lo:[0,0,1] neg_hi:[0,0,1]
    v_pk_fma_f32 v[52:53], v[32:33], v[40:41], v[94:95] neg_lo:[0,0,1] neg_hi:[0,0,1]
    v_cvt_pk_f16_f32 v98, v32, v34
    v_cvt_pk_f16_f32 v99, v33, v35
    v_cvt_pk_f16_f32 v100, v60, v62
    v_cvt_pk_f16_f32 v101, v61, v63
    ds_write2_b64 v72, v[98:99], v[100:101] offset0:0 offset1:68
    v_pk_mul_f32 v[90:91], v[54:55], v[46:47]
    v_pk_mul_f32 v[94:95], v[54:55], v[42:43]
    v_pk_mul_f32 v[92:93], v[54:55], v[44:45]
    v_pk_mul_f32 v[96:97], v[54:55], v[40:41]
    v_pk_fma_f32 v[62:63], v[52:53], v[46:47], v[92:93]
    v_pk_fma_f32 v[58:59], v[52:53], v[42:43], v[96:97]
    v_pk_fma_f32 v[60:61], v[52:53], v[44:45], v[90:91] neg_lo:[0,0,1] neg_hi:[0,0,1]
    v_pk_fma_f32 v[56:57], v[52:53], v[40:41], v[94:95] neg_lo:[0,0,1] neg_hi:[0,0,1]
    v_cvt_pk_f16_f32 v76, v52, v54
    v_cvt_pk_f16_f32 v77, v53, v55
    v_cvt_pk_f16_f32 v78, v60, v62
    v_cvt_pk_f16_f32 v79, v61, v63
    ds_write2_b64 v72, v[76:77], v[78:79] offset0:136 offset1:204
    v_pk_mul_f32 v[90:91], v[58:59], v[46:47]
    v_pk_mul_f32 v[94:95], v[58:59], v[42:43]
    v_pk_mul_f32 v[92:93], v[58:59], v[44:45]
    v_pk_mul_f32 v[96:97], v[58:59], v[40:41]
    v_pk_fma_f32 v[62:63], v[56:57], v[46:47], v[92:93]
    v_pk_fma_f32 v[54:55], v[56:57], v[42:43], v[96:97]
    v_pk_fma_f32 v[60:61], v[56:57], v[44:45], v[90:91] neg_lo:[0,0,1] neg_hi:[0,0,1]
    v_pk_fma_f32 v[52:53], v[56:57], v[40:41], v[94:95] neg_lo:[0,0,1] neg_hi:[0,0,1]
    v_cvt_pk_f16_f32 v98, v56, v58
    v_cvt_pk_f16_f32 v99, v57, v59
    v_cvt_pk_f16_f32 v100, v60, v62
    v_cvt_pk_f16_f32 v101, v61, v63
    ds_write2_b64 v73, v[98:99], v[100:101] offset0:0 offset1:68
    v_pk_mul_f32 v[90:91], v[54:55], v[46:47]
    v_pk_mul_f32 v[94:95], v[54:55], v[42:43]
    v_pk_mul_f32 v[92:93], v[54:55], v[44:45]
    v_pk_mul_f32 v[96:97], v[54:55], v[40:41]
    v_pk_fma_f32 v[62:63], v[52:53], v[46:47], v[92:93]
    v_pk_fma_f32 v[58:59], v[52:53], v[42:43], v[96:97]
    v_pk_fma_f32 v[60:61], v[52:53], v[44:45], v[90:91] neg_lo:[0,0,1] neg_hi:[0,0,1]
    v_pk_fma_f32 v[56:57], v[52:53], v[40:41], v[94:95] neg_lo:[0,0,1] neg_hi:[0,0,1]
    v_cvt_pk_f16_f32 v76, v52, v54
    v_cvt_pk_f16_f32 v77, v53, v55
    v_cvt_pk_f16_f32 v78, v60, v62
    v_cvt_pk_f16_f32 v79, v61, v63
    ds_write2_b64 v73, v[76:77], v[78:79] offset0:136 offset1:204
    v_pk_mul_f32 v[90:91], v[58:59], v[46:47]
    v_pk_mul_f32 v[94:95], v[58:59], v[42:43]
    v_pk_mul_f32 v[92:93], v[58:59], v[44:45]
    v_pk_mul_f32 v[96:97], v[58:59], v[40:41]
    v_pk_fma_f32 v[62:63], v[56:57], v[46:47], v[92:93]
    v_pk_fma_f32 v[54:55], v[56:57], v[42:43], v[96:97]
    v_pk_fma_f32 v[60:61], v[56:57], v[44:45], v[90:91] neg_lo:[0,0,1] neg_hi:[0,0,1]
    v_pk_fma_f32 v[52:53], v[56:57], v[40:41], v[94:95] neg_lo:[0,0,1] neg_hi:[0,0,1]
    v_cvt_pk_f16_f32 v98, v56, v58
    v_cvt_pk_f16_f32 v99, v57, v59
    v_cvt_pk_f16_f32 v100, v60, v62
    v_cvt_pk_f16_f32 v101, v61, v63
    ds_write2_b64 v74, v[98:99], v[100:101] offset0:0 offset1:68
    v_pk_mul_f32 v[90:91], v[54:55], v[46:47]
    v_pk_mul_f32 v[94:95], v[54:55], v[42:43]
    v_pk_mul_f32 v[92:93], v[54:55], v[44:45]
    v_pk_mul_f32 v[96:97], v[54:55], v[40:41]
    v_pk_fma_f32 v[62:63], v[52:53], v[46:47], v[92:93]
    v_pk_fma_f32 v[58:59], v[52:53], v[42:43], v[96:97]
    v_pk_fma_f32 v[60:61], v[52:53], v[44:45], v[90:91] neg_lo:[0,0,1] neg_hi:[0,0,1]
    v_pk_fma_f32 v[56:57], v[52:53], v[40:41], v[94:95] neg_lo:[0,0,1] neg_hi:[0,0,1]
    v_cvt_pk_f16_f32 v76, v52, v54
    v_cvt_pk_f16_f32 v77, v53, v55
    v_cvt_pk_f16_f32 v78, v60, v62
    v_cvt_pk_f16_f32 v79, v61, v63
    ds_write2_b64 v74, v[76:77], v[78:79] offset0:136 offset1:204
    v_pk_mul_f32 v[90:91], v[58:59], v[46:47]
    v_pk_mul_f32 v[94:95], v[58:59], v[42:43]
    v_pk_mul_f32 v[92:93], v[58:59], v[44:45]
    v_pk_mul_f32 v[96:97], v[58:59], v[40:41]
    v_pk_fma_f32 v[62:63], v[56:57], v[46:47], v[92:93]
    v_pk_fma_f32 v[54:55], v[56:57], v[42:43], v[96:97]
    v_pk_fma_f32 v[60:61], v[56:57], v[44:45], v[90:91] neg_lo:[0,0,1] neg_hi:[0,0,1]
    v_pk_fma_f32 v[52:53], v[56:57], v[40:41], v[94:95] neg_lo:[0,0,1] neg_hi:[0,0,1]
    v_cvt_pk_f16_f32 v98, v56, v58
    v_cvt_pk_f16_f32 v99, v57, v59
    v_cvt_pk_f16_f32 v100, v60, v62
    v_cvt_pk_f16_f32 v101, v61, v63
    ds_write2_b64 v75, v[98:99], v[100:101] offset0:0 offset1:68
    v_pk_mul_f32 v[90:91], v[54:55], v[46:47]
    v_pk_mul_f32 v[92:93], v[54:55], v[44:45]
    v_pk_fma_f32 v[62:63], v[52:53], v[46:47], v[92:93]
    v_pk_fma_f32 v[60:61], v[52:53], v[44:45], v[90:91] neg_lo:[0,0,1] neg_hi:[0,0,1]
    v_cvt_pk_f16_f32 v76, v52, v54
    v_cvt_pk_f16_f32 v77, v53, v55
    v_cvt_pk_f16_f32 v78, v60, v62
    v_cvt_pk_f16_f32 v79, v61, v63
    ds_write2_b64 v75, v[76:77], v[78:79] offset0:136 offset1:204
    s_branch JOBJ_19
JOB_16:
    v_mul_f32 v91, 0x43000000, v68
    v_mul_f32 v90, 0x43000000, v20
    v_mul_f32 v95, 0x43000000, v69
    v_mul_f32 v94, 0x43000000, v21
    v_fract_f32 v91, v91
    v_fract_f32 v95, v95
    v_fmac_f32 v91, 0x43000000, v70
    v_fmac_f32 v95, 0x43000000, v71
    v_exp_f32 v90, v90
    v_cos_f32 v92, v91
    v_sin_f32 v91, v91
    v_exp_f32 v94, v94
    v_cos_f32 v96, v95
    v_sin_f32 v95, v95
    v_mul_f32 v44, v90, v92
    v_mul_f32 v46, v90, v91
    v_mul_f32 v45, v94, v96
    v_mul_f32 v47, v94, v95
    v_pk_mul_f32 v[32:33], v[32:33], s[16:17] op_sel_hi:[1,0]
    v_pk_mul_f32 v[34:35], v[34:35], s[16:17] op_sel_hi:[1,0]
    v_pk_mul_f32 v[90:91], v[46:47], v[46:47]
    v_pk_mul_f32 v[92:93], v[44:45], v[46:47]
    v_pk_fma_f32 v[48:49], v[44:45], v[44:45], v[90:91] neg_lo:[0,0,1] neg_hi:[0,0,1]
    v_pk_add_f32 v[50:51], v[92:93], v[92:93]
    v_mul_f32 v91, 2.0, v68
    v_mul_f32 v90, 2.0, v20
    v_mul_f32 v95, 2.0, v69
    v_mul_f32 v94, 2.0, v21
    v_fract_f32 v91, v91
    v_fract_f32 v95, v95
    v_fmac_f32 v91, 2.0, v70
    v_fmac_f32 v95, 2.0, v71
    v_exp_f32 v90, v90
    v_cos_f32 v92, v91
    v_sin_f32 v91, v91
    v_exp_f32 v94, v94
    v_cos_f32 v96, v95
    v_sin_f32 v95, v95
    v_mul_f32 v40, v90, v92
    v_mul_f32 v42, v90, v91
    v_mul_f32 v41, v94, v96
    v_mul_f32 v43, v94, v95
    v_pk_mul_f32 v[90:91], v[34:35], v[50:51]
    v_pk_mul_f32 v[92:93], v[34:35], v[48:49]
    v_pk_fma_f32 v[54:55], v[32:33], v[50:51], v[92:93]
    v_pk_fma_f32 v[52:53], v[32:33], v[48:49], v[90:91] neg_lo:[0,0,1] neg_hi:[0,0,1]
    v_pk_mul_f32 v[90:91], v[54:55], v[50:51]
    v_pk_mul_f32 v[92:93], v[54:55], v[48:49]
    v_pk_fma_f32 v[66:67], v[52:53], v[50:51], v[92:93]
    v_pk_fma_f32 v[64:65], v[52:53], v[48:49], v[90:91] neg_lo:[0,0,1] neg_hi:[0,0,1]
    v_pk_mul_f32 v[90:91], v[54:55], v[46:47]
    v_pk_mul_f32 v[94:95], v[54:55], v[42:43]
    v_pk_mul_f32 v[92:93], v[54:55], v[44:45]
    v_pk_mul_f32 v[96:97], v[54:55], v[40:41]
    v_pk_fma_f32 v[62:63], v[52:53], v[46:47], v[92:93]
    v_pk_fma_f32 v[58:59], v[52:53], v[42:43], v[96:97]
    v_pk_fma_f32 v[60:61], v[52:53], v[44:45], v[90:91] neg_lo:[0,0,1] neg_hi:[0,0,1]
    v_pk_fma_f32 v[56:57], v[52:53], v[40:41], v[94:95] neg_lo:[0,0,1] neg_hi:[0,0,1]
    v_cvt_pk_f16_f32 v98, v52, v54
    v_cvt_pk_f16_f32 v99, v53, v55
    v_cvt_pk_f16_f32 v100, v60, v62
    v_cvt_pk_f16_f32 v101, v61, v63
    ds_write2_b64 v72, v[98:99], v[100:101] offset0:0 offset1:68
    v_pk_mul_f32 v[90:91], v[58:59], v[46:47]
    v_pk_mul_f32 v[94:95], v[58:59], v[42:43]
    v_pk_mul_f32 v[92:93], v[58:59], v[44:45]
    v_pk_mul_f32 v[96:97], v[58:59], v[40:41]
    v_pk_fma_f32 v[62:63], v[56:57], v[46:47], v[92:93]
    v_pk_fma_f32 v[54:55], v[56:57], v[42:43], v[96:97]
    v_pk_fma_f32 v[60:61], v[56:57], v[44:45], v[90:91] neg_lo:[0,0,1] neg_hi:[0,0,1]
    v_pk_fma_f32 v[52:53], v[56:57], v[40:41], v[94:95] neg_lo:[0,0,1] neg_hi:[0,0,1]
    v_cvt_pk_f16_f32 v76, v56, v58
    v_cvt_pk_f16_f32 v77, v57, v59
    v_cvt_pk_f16_f32 v78, v60, v62
    v_cvt_pk_f16_f32 v79, v61, v63
    ds_write2_b64 v72, v[76:77], v[78:79] offset0:136 offset1:204
    v_pk_mul_f32 v[90:91], v[54:55], v[46:47]
    v_pk_mul_f32 v[94:95], v[54:55], v[42:43]
    v_pk_mul_f32 v[92:93], v[54:55], v[44:45]
    v_pk_mul_f32 v[96:97], v[54:55], v[40:41]
    v_pk_fma_f32 v[62:63], v[52:53], v[46:47], v[92:93]
    v_pk_fma_f32 v[58:59], v[52:53], v[42:43], v[96:97]
    v_pk_fma_f32 v[60:61], v[52:53], v[44:45], v[90:91] neg_lo:[0,0,1] neg_hi:[0,0,1]
    v_pk_fma_f32 v[56:57], v[52:53], v[40:41], v[94:95] neg_lo:[0,0,1] neg_hi:[0,0,1]
    v_cvt_pk_f16_f32 v98, v52, v54
    v_cvt_pk_f16_f32 v99, v53, v55
    v_cvt_pk_f16_f32 v100, v60, v62
    v_cvt_pk_f16_f32 v101, v61, v63
    ds_write2_b64 v73, v[98:99], v[100:101] offset0:0 offset1:68
    v_pk_mul_f32 v[90:91], v[58:59], v[46:47]
    v_pk_mul_f32 v[94:95], v[42:43], v[42:43]
    v_pk_mul_f32 v[92:93], v[58:59], v[44:45]
    v_pk_mul_f32 v[96:97], v[40:41], v[42:43]
    v_pk_fma_f32 v[62:63], v[56:57], v[46:47], v[92:93]
    v_pk_fma_f32 v[48:49], v[40:41], v[40:41], v[94:95] neg_lo:[0,0,1] neg_hi:[0,0,1]
    v_pk_fma_f32 v[60:61], v[56:57], v[44:45], v[90:91] neg_lo:[0,0,1] neg_hi:[0,0,1]
    v_pk_add_f32 v[50:51], v[96:97], v[96:97]
    v_cvt_pk_f16_f32 v76, v56, v58
    v_cvt_pk_f16_f32 v77, v57, v59
    v_cvt_pk_f16_f32 v78, v60, v62
    v_cvt_pk_f16_f32 v79, v61, v63
    ds_write2_b64 v73, v[76:77], v[78:79] offset0:136 offset1:204
    v_pk_mul_f32 v[90:91], v[66:67], v[50:51]
    v_pk_mul_f32 v[94:95], v[66:67], v[46:47]
    v_pk_mul_f32 v[92:93], v[66:67], v[48:49]
    v_pk_mul_f32 v[96:97], v[66:67], v[44:45]
    v_pk_fma_f32 v[62:63], v[64:65], v[50:51], v[92:93]
    v_pk_fma_f32 v[54:55], v[64:65], v[46:47], v[96:97]
    v_pk_fma_f32 v[60:61], v[64:65], v[48:49], v[90:91] neg_lo:[0,0,1] neg_hi:[0,0,1]
    v_pk_fma_f32 v[52:53], v[64:65], v[44:45], v[94:95] neg_lo:[0,0,1] neg_hi:[0,0,1]
    v_cvt_pk_f16_f32 v98, v64, v66
    v_cvt_pk_f16_f32 v99, v65, v67
    v_cvt_pk_f16_f32 v100, v60, v62
    v_cvt_pk_f16_f32 v101, v61, v63
    ds_write2_b64 v74, v[98:99], v[100:101] offset0:0 offset1:68
    v_pk_mul_f32 v[90:91], v[54:55], v[50:51]
    v_pk_mul_f32 v[94:95], v[54:55], v[46:47]
    v_pk_mul_f32 v[92:93], v[54:55], v[48:49]
    v_pk_mul_f32 v[96:97], v[54:55], v[44:45]
    v_pk_fma_f32 v[62:63], v[52:53], v[50:51], v[92:93]
    v_pk_fma_f32 v[58:59], v[52:53], v[46:47], v[96:97]
    v_pk_fma_f32 v[60:61], v[52:53], v[48:49], v[90:91] neg_lo:[0,0,1] neg_hi:[0,0,1]
    v_pk_fma_f32 v[56:57], v[52:53], v[44:45], v[94:95] neg_lo:[0,0,1] neg_hi:[0,0,1]
    v_cvt_pk_f16_f32 v76, v52, v54
    v_cvt_pk_f16_f32 v77, v53, v55
    v_cvt_pk_f16_f32 v78, v60, v62
    v_cvt_pk_f16_f32 v79, v61, v63
    ds_write2_b64 v74, v[76:77], v[78:79] offset0:136 offset1:204
    v_pk_mul_f32 v[90:91], v[58:59], v[50:51]
    v_pk_mul_f32 v[94:95], v[58:59], v[46:47]
    v_pk_mul_f32 v[92:93], v[58:59], v[48:49]
    v_pk_mul_f32 v[96:97], v[58:59], v[44:45]
    v_pk_fma_f32 v[62:63], v[56:57], v[50:51], v[92:93]
    v_pk_fma_f32 v[54:55], v[56:57], v[46:47], v[96:97]
    v_pk_fma_f32 v[60:61], v[56:57], v[48:49], v[90:91] neg_lo:[0,0,1] neg_hi:[0,0,1]
    v_pk_fma_f32 v[52:53], v[56:57], v[44:45], v[94:95] neg_lo:[0,0,1] neg_hi:[0,0,1]
    v_cvt_pk_f16_f32 v98, v56, v58
    v_cvt_pk_f16_f32 v99, v57, v59
    v_cvt_pk_f16_f32 v100, v60, v62
    v_cvt_pk_f16_f32 v101, v61, v63
    ds_write2_b64 v75, v[98:99], v[100:101] offset0:0 offset1:68
    v_pk_mul_f32 v[90:91], v[54:55], v[50:51]
    v_pk_mul_f32 v[92:93], v[54:55], v[48:49]
    v_pk_fma_f32 v[62:63], v[52:53], v[50:51], v[92:93]
    v_pk_fma_f32 v[60:61], v[52:53], v[48:49], v[90:91] neg_lo:[0,0,1] neg_hi:[0,0,1]
    v_cvt_pk_f16_f32 v76, v52, v54
    v_cvt_pk_f16_f32 v77, v53, v55
    v_cvt_pk_f16_f32 v78, v60, v62
    v_cvt_pk_f16_f32 v79, v61, v63
    ds_write2_b64 v75, v[76:77], v[78:79] offset0:136 offset1:204
    s_branch JOBJ_19
JOB_18:
    v_mul_f32 v91, 0x41000000, v68
    v_mul_f32 v90, 0x41000000, v20
    v_mul_f32 v95, 0x41000000, v69
    v_mul_f32 v94, 0x41000000, v21
    v_fract_f32 v91, v91
    v_fract_f32 v95, v95
    v_fmac_f32 v91, 0x41000000, v70
    v_fmac_f32 v95, 0x41000000, v71
    v_exp_f32 v90, v90
    v_cos_f32 v92, v91
    v_sin_f32 v91, v91
    v_exp_f32 v94, v94
    v_cos_f32 v96, v95
    v_sin_f32 v95, v95
    v_mul_f32 v40, v90, v92
    v_mul_f32 v42, v90, -v91
    v_mul_f32 v41, v94, v96
    v_mul_f32 v43, v94, -v95
    v_mov_b32 v52, 0x47000000
    v_mov_b32 v53, 0x47000000
    v_mov_b32 v54, 0
    v_mov_b32 v55, 0
    v_pk_mul_f32 v[90:91], v[42:43], v[42:43]
    v_pk_mul_f32 v[60:61], v[40:41], v[52:53]
    v_pk_mul_f32 v[92:93], v[40:41], v[42:43]
    v_pk_mul_f32 v[62:63], v[42:43], v[52:53]
    v_pk_fma_f32 v[44:45], v[40:41], v[40:41], v[90:91] neg_lo:[0,0,1] neg_hi:[0,0,1]
    v_pk_add_f32 v[46:47], v[92:93], v[92:93]
    v_pk_mul_f32 v[56:57], v[44:45], v[52:53]
    v_pk_mul_f32 v[94:95], v[62:63], v[46:47]
    v_pk_mul_f32 v[58:59], v[46:47], v[52:53]
    v_pk_mul_f32 v[96:97], v[62:63], v[44:45]
    v_pk_fma_f32 v[66:67], v[60:61], v[46:47], v[96:97]
    v_pk_fma_f32 v[64:65], v[60:61], v[44:45], v[94:95] neg_lo:[0,0,1] neg_hi:[0,0,1]
    v_cvt_pk_f16_f32 v98, v52, v54
    v_cvt_pk_f16_f32 v99, v53, v55
    v_cvt_pk_f16_f32 v100, v60, v62
    v_cvt_pk_f16_f32 v101, v61, v63
    ds_write2_b64 v72, v[98:99], v[100:101] offset0:0 offset1:68
    v_pk_mul_f32 v[90:91], v[58:59], v[46:47]
    v_pk_mul_f32 v[94:95], v[66:67], v[46:47]
    v_pk_mul_f32 v[92:93], v[58:59], v[44:45]
    v_pk_mul_f32 v[96:97], v[66:67], v[44:45]
    v_pk_fma_f32 v[54:55], v[56:57], v[46:47], v[92:93]
    v_pk_fma_f32 v[62:63], v[64:65], v[46:47], v[96:97]
    v_pk_fma_f32 v[52:53], v[56:57], v[44:45], v[90:91] neg_lo:[0,0,1] neg_hi:[0,0,1]
    v_pk_fma_f32 v[60:61], v[64:65], v[44:45], v[94:95] neg_lo:[0,0,1] neg_hi:[0,0,1]
    v_cvt_pk_f16_f32 v76, v56, v58
    v_cvt_pk_f16_f32 v77, v57, v59
    v_cvt_pk_f16_f32 v78, v64, v66
    v_cvt_pk_f16_f32 v79, v65, v67
    ds_write2_b64 v72, v[76:77], v[78:79] offset0:136 offset1:204
    v_pk_mul_f32 v[90:91], v[54:55], v[46:47]
    v_pk_mul_f32 v[94:95], v[62:63], v[46:47]
    v_pk_mul_f32 v[92:93], v[54:55], v[44:45]
    v_pk_mul_f32 v[96:97], v[62:63], v[44:45]
    v_pk_fma_f32 v[58:59], v[52:53], v[46:47], v[92:93]
    v_pk_fma_f32 v[66:67], v[60:61], v[46:47], v[96:97]
    v_pk_fma_f32 v[56:57], v[52:53], v[44:45], v[90:91] neg_lo:[0,0,1] neg_hi:[0,0,1]
    v_pk_fma_f32 v[64:65], v[60:61], v[44:45], v[94:95] neg_lo:[0,0,1] neg_hi:[0,0,1]
    v_cvt_pk_f16_f32 v98, v52, v54
    v_cvt_pk_f16_f32 v99, v53, v55
    v_cvt_pk_f16_f32 v100, v60, v62
    v_cvt_pk_f16_f32 v101, v61, v63
    ds_write2_b64 v73, v[98:99], v[100:101] offset0:0 offset1:68
    v_pk_mul_f32 v[90:91], v[58:59], v[46:47]
    v_pk_mul_f32 v[94:95], v[66:67], v[46:47]
    v_pk_mul_f32 v[92:93], v[58:59], v[44:45]
    v_pk_mul_f32 v[96:97], v[66:67], v[44:45]
    v_pk_fma_f32 v[54:55], v[56:57], v[46:47], v[92:93]
    v_pk_fma_f32 v[62:63], v[64:65], v[46:47], v[96:97]
    v_pk_fma_f32 v[52:53], v[56:57], v[44:45], v[90:91] neg_lo:[0,0,1] neg_hi:[0,0,1]
    v_pk_fma_f32 v[60:61], v[64:65], v[44:45], v[94:95] neg_lo:[0,0,1] neg_hi:[0,0,1]
    v_cvt_pk_f16_f32 v76, v56, v58
    v_cvt_pk_f16_f32 v77, v57, v59
    v_cvt_pk_f16_f32 v78, v64, v66
    v_cvt_pk_f16_f32 v79, v65, v67
    ds_write2_b64 v73, v[76:77], v[78:79] offset0:136 offset1:204
    v_pk_mul_f32 v[90:91], v[54:55], v[46:47]
    v_pk_mul_f32 v[94:95], v[62:63], v[46:47]
    v_pk_mul_f32 v[92:93], v[54:55], v[44:45]
    v_pk_mul_f32 v[96:97], v[62:63], v[44:45]
    v_pk_fma_f32 v[58:59], v[52:53], v[46:47], v[92:93]
    v_pk_fma_f32 v[66:67], v[60:61], v[46:47], v[96:97]
    v_pk_fma_f32 v[56:57], v[52:53], v[44:45], v[90:91] neg_lo:[0,0,1] neg_hi:[0,0,1]
    v_pk_fma_f32 v[64:65], v[60:61], v[44:45], v[94:95] neg_lo:[0,0,1] neg_hi:[0,0,1]
    v_cvt_pk_f16_f32 v98, v52, v54
    v_cvt_pk_f16_f32 v99, v53, v55
    v_cvt_pk_f16_f32 v100, v60, v62
    v_cvt_pk_f16_f32 v101, v61, v63
    ds_write2_b64 v74, v[98:99], v[100:101] offset0:0 offset1:68
    v_pk_mul_f32 v[90:91], v[58:59], v[46:47]
    v_pk_mul_f32 v[94:95], v[66:67], v[46:47]
    v_pk_mul_f32 v[92:93], v[58:59], v[44:45]
    v_pk_mul_f32 v[96:97], v[66:67], v[44:45]
    v_pk_fma_f32 v[54:55], v[56:57], v[46:47], v[92:93]
    v_pk_fma_f32 v[62:63], v[64:65], v[46:47], v[96:97]
    v_pk_fma_f32 v[52:53], v[56:57], v[44:45], v[90:91] neg_lo:[0,0,1] neg_hi:[0,0,1]
    v_pk_fma_f32 v[60:61], v[64:65], v[44:45], v[94:95] neg_lo:[0,0,1] neg_hi:[0,0,1]
    v_cvt_pk_f16_f32 v76, v56, v58
    v_cvt_pk_f16_f32 v77, v57, v59
    v_cvt_pk_f16_f32 v78, v64, v66
    v_cvt_pk_f16_f32 v79, v65, v67
    ds_write2_b64 v74, v[76:77], v[78:79] offset0:136 offset1:204
    v_pk_mul_f32 v[90:91], v[54:55], v[46:47]
    v_pk_mul_f32 v[94:95], v[62:63], v[46:47]
    v_pk_mul_f32 v[92:93], v[54:55], v[44:45]
    v_pk_mul_f32 v[96:97], v[62:63], v[44:45]
    v_pk_fma_f32 v[58:59], v[52:53], v[46:47], v[92:93]
    v_pk_fma_f32 v[66:67], v[60:61], v[46:47], v[96:97]
    v_pk_fma_f32 v[56:57], v[52:53], v[44:45], v[90:91] neg_lo:[0,0,1] neg_hi:[0,0,1]
    v_pk_fma_f32 v[64:65], v[60:61], v[44:45], v[94:95] neg_lo:[0,0,1] neg_hi:[0,0,1]
    v_cvt_pk_f16_f32 v98, v52, v54
    v_cvt_pk_f16_f32 v99, v53, v55
    v_cvt_pk_f16_f32 v100, v60, v62
    v_cvt_pk_f16_f32 v101, v61, v63
    ds_write2_b64 v75, v[98:99], v[100:101] offset0:0 offset1:68
    v_cvt_pk_f16_f32 v76, v56, v58
    v_cvt_pk_f16_f32 v77, v57, v59
    v_cvt_pk_f16_f32 v78, v64, v66
    v_cvt_pk_f16_f32 v79, v65, v67
    ds_write2_b64 v75, v[76:77], v[78:79] offset0:136 offset1:204
    ds_write_b8 v15, v5 offset:64
    s_cmp_eq_u32 s87, 2
    s_cbranch_scc1 KS_G0
    s_branch EXP_13
KC_SEND:
W_20:
    ds_read_b32 v104, v105 offset:224
    s_sub_u32 s39, s39, 1
    s_cbranch_scc1 KS_ABORT
    s_waitcnt lgkmcnt(0)
    v_cmp_eq_u32 vcc, 0, v104
    s_cbranch_vccnz W_20
    s_lshl_b32 s92, s88, 12
    s_lshl_b32 s93, s86, 10
    s_add_u32 s92, s92, s93
    s_add_u32 s92, s92, 0x920000
    v_add_u32 v24, s92, v12
    s_mov_b32 s93, 0xffff
    v_lshlrev_b32 v25, 16, v104
    v_cvt_f16_f32 v20, v20
    v_cvt_f16_f32 v21, v21
    v_cvt_f16_f32 v22, v22
    v_cvt_f16_f32 v23, v23
    s_cmp_lg_u32 s86, 2
    s_cbranch_scc1 KC_S2
    s_mov_b32 exec_lo, 0
    s_mov_b32 exec_hi, 0xffff0000
    v_mov_b32 v20, v106
    v_lshrrev_b32 v21, 16, v106
    s_mov_b64 exec, -1
KC_S2:
    v_bfi_b32 v20, s93, v20, v104
    v_bfi_b32 v21, s93, v21, v25
    v_bfi_b32 v22, s93, v22, v104
    v_bfi_b32 v23, s93, v23, v25
    global_store_dwordx4 v24, v[20:23], s[36:37] sc1
    s_branch KS_G0
KC_RECV:
    s_cmp_eq_u32 s86, 3
    s_cbranch_scc1 EXP_13
    s_lshl_b32 s92, s88, 12
    s_lshl_b32 s93, s86, 10
    s_add_u32 s92, s92, s93
    s_add_u32 s92, s92, 0x920000
    v_add_u32 v24, s92, v12
W_21:
    s_sleep 2
    ds_read_b32 v104, v105 offset:224
    s_sub_u32 s39, s39, 1
    s_cbranch_scc1 KS_ABORT
    s_waitcnt lgkmcnt(0)
    v_cmp_eq_u32 vcc, 0, v104
    s_cbranch_vccnz W_21
    v_lshlrev_b32 v25, 16, v104
W_22:
    s_sleep 2
    ds_read_b32 v17, v4 offset:72
    s_sub_u32 s39, s39, 1
    s_cbranch_scc1 KS_ABORT
    s_waitcnt lgkmcnt(0)
    v_cmp_ne_u32 vcc, s84, v17
    s_cbranch_vccnz W_22
    s_sleep 8
    s_branch KPE_24
KP_23:
    s_sleep 2
KPE_24:
    global_load_dwordx4 v[20:23], v24, s[36:37] sc1
    s_sub_u32 s39, s39, 1
    s_cbranch_scc1 KS_ABORT
    s_waitcnt vmcnt(0)
    v_xor_b32 v20, v104, v20
    v_xor_b32 v21, v25, v21
    v_xor_b32 v22, v104, v22
    v_xor_b32 v23, v25, v23
    v_or3_b32 v26, v20, v21, v22
    v_or_b32 v26, v26, v23
    v_cmp_lt_u32 vcc, 0xffff, v26
    s_cbranch_vccnz KP_23
    v_xor_b32 v20, v104, v20
    v_xor_b32 v22, v104, v22
    ds_write_b16 v108, v20
    ds_write_b16 v109, v21
    ds_write_b16 v112, v22
    ds_write_b16 v113, v23
    s_cmp_lg_u32 s86, 2
    s_cbranch_scc1 EXP_13
    v_and_b32 v20, 0xffff, v20
    v_lshl_or_b32 v20, v21, 16, v20
    v_lshlrev_b32 v21, 16, v107
    s_mov_b32 exec_lo, 0
    s_mov_b32 exec_hi, 0x10000
    ds_write_b64 v14, v[20:21] offset:832
    s_mov_b64 exec, -1
    s_branch EXP_13
JOB_17:
    v_mul_f32 v91, 0x43000000, v68
    v_mul_f32 v90, 0x43000000, v20
    v_mul_f32 v95, 0x43000000, v69
    v_mul_f32 v94, 0x43000000, v21
    v_fract_f32 v91, v91
    v_fract_f32 v95, v95
    v_fmac_f32 v91, 0x43000000, v70
    v_fmac_f32 v95, 0x43000000, v71
    v_exp_f32 v90, v90
    v_cos_f32 v92, v91
    v_sin_f32 v91, v91
    v_exp_f32 v94, v94
    v_cos_f32 v96, v95
    v_sin_f32 v95, v95
    v_mul_f32 v44, v90, v92
    v_mul_f32 v46, v90, v91
    v_mul_f32 v45, v94, v96
    v_mul_f32 v47, v94, v95
    v_pk_mul_f32 v[32:33], v[32:33], s[16:17] op_sel_hi:[1,0]
    v_pk_mul_f32 v[34:35], v[34:35], s[16:17] op_sel_hi:[1,0]
    v_pk_mul_f32 v[90:91], v[46:47], v[46:47]
    v_pk_mul_f32 v[94:95], v[34:35], v[46:47]
    v_pk_mul_f32 v[92:93], v[44:45], v[46:47]
    v_pk_mul_f32 v[96:97], v[34:35], v[44:45]
    v_pk_fma_f32 v[40:41], v[44:45], v[44:45], v[90:91] neg_lo:[0,0,1] neg_hi:[0,0,1]
    v_pk_fma_f32 v[66:67], v[32:33], v[46:47], v[96:97]
    v_pk_add_f32 v[42:43], v[92:93], v[92:93]
    v_pk_fma_f32 v[64:65], v[32:33], v[44:45], v[94:95] neg_lo:[0,0,1] neg_hi:[0,0,1]
    v_pk_mul_f32 v[90:91], v[42:43], v[42:43]
    v_pk_mul_f32 v[92:93], v[40:41], v[42:43]
    v_pk_fma_f32 v[48:49], v[40:41], v[40:41], v[90:91] neg_lo:[0,0,1] neg_hi:[0,0,1]
    v_pk_add_f32 v[50:51], v[92:93], v[92:93]
    v_pk_mul_f32 v[90:91], v[50:51], v[50:51]
    v_pk_mul_f32 v[92:93], v[48:49], v[50:51]
    v_pk_fma_f32 v[48:49], v[48:49], v[48:49], v[90:91] neg_lo:[0,0,1] neg_hi:[0,0,1]
    v_pk_add_f32 v[50:51], v[92:93], v[92:93]
    v_pk_mul_f32 v[90:91], v[34:35], v[50:51]
    v_pk_mul_f32 v[94:95], v[66:67], v[50:51]
    v_pk_mul_f32 v[92:93], v[34:35], v[48:49]
    v_pk_mul_f32 v[96:97], v[66:67], v[48:49]
    v_pk_fma_f32 v[54:55], v[32:33], v[50:51], v[92:93]
    v_pk_fma_f32 v[62:63], v[64:65], v[50:51], v[96:97]
    v_pk_fma_f32 v[52:53], v[32:33], v[48:49], v[90:91] neg_lo:[0,0,1] neg_hi:[0,0,1]
    v_pk_fma_f32 v[60:61], v[64:65], v[48:49], v[94:95] neg_lo:[0,0,1] neg_hi:[0,0,1]
    v_pk_mul_f32 v[90:91], v[54:55], v[42:43]
    v_pk_mul_f32 v[94:95], v[62:63], v[42:43]
    v_pk_mul_f32 v[92:93], v[54:55], v[40:41]
    v_pk_mul_f32 v[96:97], v[62:63], v[40:41]
    v_pk_fma_f32 v[58:59], v[52:53], v[42:43], v[92:93]
    v_pk_fma_f32 v[66:67], v[60:61], v[42:43], v[96:97]
    v_pk_fma_f32 v[56:57], v[52:53], v[40:41], v[90:91] neg_lo:[0,0,1] neg_hi:[0,0,1]
    v_pk_fma_f32 v[64:65], v[60:61], v[40:41], v[94:95] neg_lo:[0,0,1] neg_hi:[0,0,1]
    v_cvt_pk_f16_f32 v98, v52, v54
    v_cvt_pk_f16_f32 v99, v53, v55
    v_cvt_pk_f16_f32 v100, v60, v62
    v_cvt_pk_f16_f32 v101, v61, v63
    ds_write2_b64 v72, v[98:99], v[100:101] offset0:0 offset1:68
    v_pk_mul_f32 v[90:91], v[58:59], v[42:43]
    v_pk_mul_f32 v[94:95], v[66:67], v[42:43]
    v_pk_mul_f32 v[92:93], v[58:59], v[40:41]
    v_pk_mul_f32 v[96:97], v[66:67], v[40:41]
    v_pk_fma_f32 v[54:55], v[56:57], v[42:43], v[92:93]
    v_pk_fma_f32 v[62:63], v[64:65], v[42:43], v[96:97]
    v_pk_fma_f32 v[52:53], v[56:57], v[40:41], v[90:91] neg_lo:[0,0,1] neg_hi:[0,0,1]
    v_pk_fma_f32 v[60:61], v[64:65], v[40:41], v[94:95] neg_lo:[0,0,1] neg_hi:[0,0,1]
    v_cvt_pk_f16_f32 v76, v56, v58
    v_cvt_pk_f16_f32 v77, v57, v59
    v_cvt_pk_f16_f32 v78, v64, v66
    v_cvt_pk_f16_f32 v79, v65, v67
    ds_write2_b64 v72, v[76:77], v[78:79] offset0:136 offset1:204
    v_pk_mul_f32 v[90:91], v[54:55], v[42:43]
    v_pk_mul_f32 v[94:95], v[62:63], v[42:43]
    v_pk_mul_f32 v[92:93], v[54:55], v[40:41]
    v_pk_mul_f32 v[96:97], v[62:63], v[40:41]
    v_pk_fma_f32 v[58:59], v[52:53], v[42:43], v[92:93]
    v_pk_fma_f32 v[66:67], v[60:61], v[42:43], v[96:97]
    v_pk_fma_f32 v[56:57], v[52:53], v[40:41], v[90:91] neg_lo:[0,0,1] neg_hi:[0,0,1]
    v_pk_fma_f32 v[64:65], v[60:61], v[40:41], v[94:95] neg_lo:[0,0,1] neg_hi:[0,0,1]
    v_cvt_pk_f16_f32 v98, v52, v54
    v_cvt_pk_f16_f32 v99, v53, v55
    v_cvt_pk_f16_f32 v100, v60, v62
    v_cvt_pk_f16_f32 v101, v61, v63
    ds_write2_b64 v73, v[98:99], v[100:101] offset0:0 offset1:68
    v_pk_mul_f32 v[90:91], v[58:59], v[42:43]
    v_pk_mul_f32 v[92:93], v[58:59], v[40:41]
    v_pk_fma_f32 v[54:55], v[56:57], v[42:43], v[92:93]
    v_pk_fma_f32 v[52:53], v[56:57], v[40:41], v[90:91] neg_lo:[0,0,1] neg_hi:[0,0,1]
    v_cvt_pk_f16_f32 v76, v56, v58
    v_cvt_pk_f16_f32 v77, v57, v59
    v_cvt_pk_f16_f32 v78, v64, v66
    v_cvt_pk_f16_f32 v79, v65, v67
    ds_write2_b64 v73, v[76:77], v[78:79] offset0:136 offset1:204
    v_cvt_pk_f16_f32 v98, v52, v54
    v_cvt_pk_f16_f32 v99, v53, v55
    v_mov_b32 v36, 0x4538aa3b
    v_mul_f32 v24, s14, v36
    v_max_f32 v24, 0, v24
    v_exp_f32 v24, v24
    ds_write_b64 v74, v[98:99] offset:0
    s_sub_u32 s11, s15, 7
    s_lshl_b32 s11, s11, 23
    v_lshlrev_b32 v25, 16, v107
    v_mul_f32 v24, s11, v24
    v_mov_b32 v106, v24
    ds_write_b64 v14, v[24:25] offset:832
JOBJ_19:
    ds_write_b8 v15, v5 offset:64
    ds_read_b128 v[40:43], v127 offset:0
    ds_read_b128 v[44:47], v127 offset:64
    ds_read_b128 v[48:51], v127 offset:128
    ds_read_b128 v[52:55], v127 offset:192
    ds_read_b128 v[56:59], v127 offset:256
    ds_read_b128 v[60:63], v127 offset:320
    ds_read_b128 v[64:67], v127 offset:384
    ds_read_b128 v[68:71], v127 offset:448
    v_mov_b32 v36, 0x3fb8aa3b
    v_mul_f32 v36, s14, v36
    v_mul_f32 v37, 0x45000000, v36
    v_max_f32 v37, 0, v37
    v_add_f32 v37, 0x41b80000, v37
    v_fma_f32 v110, v110, v36, -v37
    v_fma_f32 v111, v111, v36, -v37
    v_fma_f32 v114, v114, v36, -v37
    v_fma_f32 v115, v115, v36, -v37
    v_exp_f32 v110, v110
    v_exp_f32 v111, v111
    v_exp_f32 v114, v114
    v_exp_f32 v115, v115
W_25:
    ds_read_u8 v17, v14 offset:67
    s_sub_u32 s39, s39, 1
    s_cbranch_scc1 KS_ABORT
    s_waitcnt lgkmcnt(0)
    v_cmp_eq_u32 vcc, 0, v17
    s_cbranch_vccnz W_25
    ds_read_b128 v[72:75], v126 offset:22304
    ds_read_b128 v[76:79], v126 offset:22368
    ds_read_b128 v[80:83], v126 offset:22432
    ds_read_b128 v[84:87], v126 offset:22496
    ds_read_b128 v[88:91], v126 offset:22560
    ds_read_b128 v[92:95], v126 offset:22624
    ds_read_b128 v[96:99], v126 offset:22688
    ds_read_b128 v[100:103], v126 offset:22752
    s_waitcnt lgkmcnt(7)
    v_mfma_f32_16x16x32_f16 v[20:23], v[40:43], v[72:75], 0
    s_waitcnt lgkmcnt(6)
    v_mfma_f32_16x16x32_f16 v[24:27], v[44:47], v[76:79], 0
    s_waitcnt lgkmcnt(5)
    v_mfma_f32_16x16x32_f16 v[20:23], v[48:51], v[80:83], v[20:23]
    s_waitcnt lgkmcnt(4)
    v_mfma_f32_16x16x32_f16 v[24:27], v[52:55], v[84:87], v[24:27]
    s_waitcnt lgkmcnt(3)
    v_mfma_f32_16x16x32_f16 v[20:23], v[56:59], v[88:91], v[20:23]
    s_waitcnt lgkmcnt(2)
    v_mfma_f32_16x16x32_f16 v[24:27], v[60:63], v[92:95], v[24:27]
    s_waitcnt lgkmcnt(1)
    v_mfma_f32_16x16x32_f16 v[20:23], v[64:67], v[96:99], v[20:23]
    s_waitcnt lgkmcnt(0)
    v_mfma_f32_16x16x32_f16 v[24:27], v[68:71], v[100:103], v[24:27]
    s_nop 7
    v_add_f32 v20, v20, v24
    v_add_f32 v21, v21, v25
    v_add_f32 v22, v22, v26
    v_add_f32 v23, v23, v27
    v_mul_f32 v20, v20, v110
    v_mul_f32 v21, v21, v111
    v_mul_f32 v22, v22, v114
    v_mul_f32 v23, v23, v115
    s_cmp_eq_u32 s87, 2
    s_cbranch_scc1 KC_SEND
    v_cvt_f16_f32 v20, v20
    ds_write_b16 v108, v20
    v_cvt_f16_f32 v21, v21
    ds_write_b16 v109, v21
    v_cvt_f16_f32 v22, v22
    ds_write_b16 v112, v22
    v_cvt_f16_f32 v23, v23
    ds_write_b16 v113, v23
EXP_13:
    ds_write_b8 v15, v5 offset:68
    v_mov_b32 v28, 0
    v_mov_b32 v29, 0
    v_mov_b32 v30, 0
    v_mov_b32 v31, 0
    v_mov_b32 v32, s85
    s_waitcnt vmcnt(0)
W_26:
    ds_read_b32 v20, v14 offset:68
    s_sub_u32 s39, s39, 1
    s_cbranch_scc1 KS_ABORT
    s_waitcnt lgkmcnt(0)
    v_cmp_ne_u32 vcc, s84, v20
    s_cbranch_vccnz W_26
    ds_read_u16 v20, v116
    ds_read_u16 v21, v117
    ds_read_u16 v22, v118
    ds_read_u16 v23, v120
    ds_read_u16 v24, v121
    ds_read_u16 v25, v122
    ds_read_u16 v26, v123
    s_mov_b64 exec, 1
    ds_write_b128 v32, v[28:31] offset:3088
    ds_write_b128 v32, v[28:31] offset:8224
    ds_write_b128 v32, v[28:31] offset:3072
    s_mov_b64 exec, -1
    s_waitcnt lgkmcnt(7)
    v_lshl_or_b32 v28, v21, 16, v20
    v_lshl_or_b32 v29, v22, 16, v21
    ds_write_b32 v124, v28 offset:32528
    ds_write_b32 v124, v29 offset:33872
    ds_write_b32 v124, v28 offset:27284
    ds_write_b32 v124, v29 offset:28628
    s_waitcnt lgkmcnt(7)
    v_lshl_or_b32 v30, v24, 16, v23
    v_lshl_or_b32 v31, v26, 16, v25
    ds_write_b32 v119, v30
    ds_write_b32 v125, v31
    ds_write_b32 v119, v30 offset:5244
    ds_write_b32 v125, v31 offset:5244
    ds_write_b8 v15, v5 offset:72
W_27:
    ds_read_b32 v20, v14 offset:72
    s_sub_u32 s39, s39, 1
    s_cbranch_scc1 KS_ABORT
    s_waitcnt lgkmcnt(0)
    v_cmp_ne_u32 vcc, s84, v20
    s_cbranch_vccnz W_27
    ds_read_b64 v[16:17], v14 offset:832
    s_cmp_eq_u32 s86, 1
    s_cbranch_scc1 CV_29
    s_cmp_eq_u32 s86, 2
    s_cbranch_scc1 CV_30
    s_cmp_eq_u32 s86, 3
    s_cbranch_scc1 CV_31
    ds_read_b64 v[32:33], v6 offset:576
    ds_read_b64 v[34:35], v6 offset:584
    ds_read_b64 v[36:37], v6 offset:64
    ds_read_b64 v[38:39], v6 offset:72
    ds_read_b64 v[40:41], v6 offset:640
    ds_read_b64 v[42:43], v6 offset:648
    ds_read_b64 v[44:45], v6 offset:128
    ds_read_b64 v[46:47], v6 offset:136
    ds_read_b64 v[48:49], v6 offset:704
    ds_read_b64 v[50:51], v6 offset:712
    ds_read_b64 v[52:53], v6 offset:192
    ds_read_b64 v[54:55], v6 offset:200
    ds_read_b64 v[56:57], v6 offset:768
    ds_read_b64 v[58:59], v6 offset:776
    ds_read_b64 v[60:61], v6 offset:256
    ds_read_b64 v[62:63], v6 offset:264
    ds_read_b64 v[64:65], v6 offset:832
    ds_read_b64 v[66:67], v6 offset:840
    ds_read_b64 v[68:69], v6 offset:320
    ds_read_b64 v[70:71], v6 offset:328
    ds_read_b64 v[72:73], v6 offset:896
    ds_read_b64 v[74:75], v6 offset:904
    ds_read_b64 v[76:77], v6 offset:384
    ds_read_b64 v[78:79], v6 offset:392
    ds_read_b64 v[80:81], v6 offset:960
    ds_read_b64 v[82:83], v6 offset:968
    ds_read_b64 v[84:85], v6 offset:448
    ds_read_b64 v[86:87], v6 offset:456
    ds_read_b64 v[88:89], v6 offset:1024
    ds_read_b64 v[90:91], v6 offset:1032
    ds_read_b64 v[92:93], v6 offset:512
    ds_read_b64 v[94:95], v6 offset:520
    v_lshlrev_b32 v18, 3, v3
    v_sub_u32 v18, v8, v18
    v_lshrrev_b32 v19, 2, v2
    v_lshl_add_u32 v19, v19, 2, v3
    v_and_b32 v28, 3, v2
    v_lshlrev_b32 v28, 4, v28
    v_mul_u32_u24 v19, s8, v19
    v_xor_b32 v19, s10, v19
    s_waitcnt lgkmcnt(0)
    v_mov_b32 v7, v18
    v_add_u32 v6, v19, v28
    v_xor_b32 v12, s9, v12
W_33:
    ds_read_b32 v18, v4 offset:16
    s_sub_u32 s39, s39, 1
    s_cbranch_scc1 KS_ABORT
    s_waitcnt lgkmcnt(0)
    v_cmp_ne_u32 vcc, s84, v18
    s_cbranch_vccnz W_33
    s_setprio 1
    ds_read_b128 v[96:99], v8 offset:0
    ds_read_b128 v[100:103], v8 offset:64
    ds_read_b128 v[104:107], v8 offset:128
    ds_read_b128 v[108:111], v8 offset:192
    s_waitcnt lgkmcnt(3)
    v_mfma_f32_16x16x32_f16 v[20:23], v[32:35], v[96:99], 0
    v_mfma_f32_16x16x32_f16 v[24:27], v[36:39], v[96:99], 0
    ds_read_b128 v[112:115], v8 offset:256
    s_waitcnt lgkmcnt(3)
    v_mfma_f32_16x16x32_f16 v[20:23], v[40:43], v[100:103], v[20:23]
    ds_read_b64 v[28:29], v7 offset:480
    ds_read_b64 v[30:31], v7 offset:992
    v_mfma_f32_16x16x32_f16 v[24:27], v[44:47], v[100:103], v[24:27]
    ds_read_b128 v[116:119], v8 offset:320
    s_waitcnt lgkmcnt(5)
    v_mfma_f32_16x16x32_f16 v[20:23], v[48:51], v[104:107], v[20:23]
    v_mfma_f32_16x16x32_f16 v[24:27], v[52:55], v[104:107], v[24:27]
    ds_read_b128 v[120:123], v8 offset:384
    s_waitcnt lgkmcnt(2)
    v_fma_mix_f32 v104, v28, v17, 0 op_sel_hi:[1,0,0]
    v_fma_mix_f32 v105, v28, v17, 0 op_sel:[1,0,0] op_sel_hi:[1,0,0]
    v_mfma_f32_16x16x32_f16 v[20:23], v[56:59], v[108:111], v[20:23]
    v_fma_mix_f32 v106, v29, v17, 0 op_sel_hi:[1,0,0]
    v_fma_mix_f32 v107, v29, v17, 0 op_sel:[1,0,0] op_sel_hi:[1,0,0]
    v_mfma_f32_16x16x32_f16 v[24:27], v[60:63], v[108:111], v[24:27]
    ds_read_b128 v[124:127], v8 offset:448
    v_cvt_pk_bf16_f32 v104, 0, v104
    v_cvt_pk_bf16_f32 v105, 0, v105
    v_mfma_f32_16x16x32_f16 v[20:23], v[64:67], v[112:115], v[20:23]
    v_cvt_pk_bf16_f32 v106, 0, v106
    v_cvt_pk_bf16_f32 v107, 0, v107
    v_mfma_f32_16x16x32_f16 v[24:27], v[68:71], v[112:115], v[24:27]
    ds_read_b128 v[36:39], v8 offset:512
    v_fma_mix_f32 v112, v30, v17, 0 op_sel_hi:[1,0,0]
    v_fma_mix_f32 v113, v30, v17, 0 op_sel:[1,0,0] op_sel_hi:[1,0,0]
    s_waitcnt lgkmcnt(3)
    v_mfma_f32_16x16x32_f16 v[20:23], v[72:75], v[116:119], v[20:23]
    ds_read_b128 v[96:99], v8 offset:576
    v_fma_mix_f32 v114, v31, v17, 0 op_sel_hi:[1,0,0]
    v_fma_mix_f32 v115, v31, v17, 0 op_sel:[1,0,0] op_sel_hi:[1,0,0]
    v_mfma_f32_16x16x32_f16 v[24:27], v[76:79], v[116:119], v[24:27]
    ds_read_b128 v[44:47], v8 offset:640
    v_cvt_pk_bf16_f32 v112, 0, v112
    v_cvt_pk_bf16_f32 v113, 0, v113
    s_waitcnt lgkmcnt(4)
    v_mfma_f32_16x16x32_f16 v[20:23], v[80:83], v[120:123], v[20:23]
    ds_read_b128 v[100:103], v8 offset:704
    v_cvt_pk_bf16_f32 v114, 0, v114
    v_cvt_pk_bf16_f32 v115, 0, v115
    v_mfma_f32_16x16x32_f16 v[24:27], v[84:87], v[120:123], v[24:27]
    ds_read_b128 v[52:55], v8 offset:768
    s_waitcnt lgkmcnt(5)
    v_mfma_f32_16x16x32_f16 v[20:23], v[88:91], v[124:127], v[20:23]
    ds_read_b128 v[60:63], v8 offset:832
    v_mfma_f32_16x16x32_f16 v[24:27], v[92:95], v[124:127], v[24:27]
    ds_read_b128 v[108:111], v8 offset:896
    s_waitcnt lgkmcnt(6)
    v_mfma_f32_16x16x32_f16 v[24:27], v[32:35], v[36:39], v[24:27]
    ds_read_b128 v[68:71], v8 offset:960
    s_nop 1
    v_mul_f32 v20, v20, v16
    v_mul_f32 v21, v21, v16
    s_waitcnt lgkmcnt(6)
    v_mfma_f32_16x16x32_f16 v[24:27], v[40:43], v[96:99], v[24:27]
    v_mul_f32 v22, v22, v16
    v_mul_f32 v23, v23, v16
    s_waitcnt lgkmcnt(5)
    v_mfma_f32_16x16x32_f16 v[24:27], v[48:51], v[44:47], v[24:27]
    v_cvt_pk_bf16_f32 v20, 0, v20
    v_cvt_pk_bf16_f32 v21, 0, v21
    s_waitcnt lgkmcnt(4)
    v_mfma_f32_16x16x32_f16 v[24:27], v[56:59], v[100:103], v[24:27]
    v_cvt_pk_bf16_f32 v22, 0, v22
    v_cvt_pk_bf16_f32 v23, 0, v23
    s_waitcnt lgkmcnt(3)
    v_mfma_f32_16x16x32_f16 v[24:27], v[64:67], v[52:55], v[24:27]
    v_add_f32 v20, v20, v104
    v_add_f32 v21, v21, v105
    s_waitcnt lgkmcnt(2)
    v_mfma_f32_16x16x32_f16 v[24:27], v[72:75], v[60:63], v[24:27]
    v_add_f32 v22, v22, v106
    v_add_f32 v23, v23, v107
    s_waitcnt lgkmcnt(1)
    v_mfma_f32_16x16x32_f16 v[24:27], v[80:83], v[108:111], v[24:27]
    v_cvt_pk_bf16_f32 v28, v20, v21
    v_cvt_pk_bf16_f32 v29, v22, v23
    s_waitcnt lgkmcnt(0)
    v_mfma_f32_16x16x32_f16 v[24:27], v[88:91], v[68:71], v[24:27]
    v_min_u32 v28, -2, v28
    v_min_u32 v29, -2, v29
    ds_read_u8 v18, v14 offset:112
    ds_read_b128 v[20:23], v12 offset:46592
    s_nop 3
    v_mul_f32 v24, v24, v16
    v_mul_f32 v25, v25, v16
    v_mul_f32 v26, v26, v16
    v_mul_f32 v27, v27, v16
    v_cvt_pk_bf16_f32 v24, 0, v24
    v_cvt_pk_bf16_f32 v25, 0, v25
    v_cvt_pk_bf16_f32 v26, 0, v26
    v_cvt_pk_bf16_f32 v27, 0, v27
    v_add_f32 v24, v24, v112
    v_add_f32 v25, v25, v113
    v_add_f32 v26, v26, v114
    v_add_f32 v27, v27, v115
    v_cvt_pk_bf16_f32 v30, v24, v25
    v_cvt_pk_bf16_f32 v31, v26, v27
    v_min_u32 v30, -2, v30
    v_min_u32 v31, -2, v31
    s_branch CVE_32
CV_29:
    ds_read_b64 v[32:33], v6 offset:0
    ds_read_b64 v[34:35], v6 offset:8
    ds_read_b64 v[36:37], v6 offset:64
    ds_read_b64 v[38:39], v6 offset:72
    ds_read_b64 v[40:41], v6 offset:128
    ds_read_b64 v[42:43], v6 offset:136
    ds_read_b64 v[44:45], v6 offset:192
    ds_read_b64 v[46:47], v6 offset:200
    ds_read_b64 v[48:49], v6 offset:256
    ds_read_b64 v[50:51], v6 offset:264
    ds_read_b64 v[52:53], v6 offset:320
    ds_read_b64 v[54:55], v6 offset:328
    ds_read_b64 v[56:57], v6 offset:384
    ds_read_b64 v[58:59], v6 offset:392
    ds_read_b64 v[60:61], v6 offset:448
    ds_read_b64 v[62:63], v6 offset:456
    ds_read_b64 v[64:65], v6 offset:512
    ds_read_b64 v[66:67], v6 offset:520
    ds_read_b64 v[68:69], v6 offset:576
    ds_read_b64 v[70:71], v6 offset:584
    ds_read_b64 v[72:73], v6 offset:640
    ds_read_b64 v[74:75], v6 offset:648
    ds_read_b64 v[76:77], v6 offset:704
    ds_read_b64 v[78:79], v6 offset:712
    ds_read_b64 v[80:81], v6 offset:768
    ds_read_b64 v[82:83], v6 offset:776
    ds_read_b64 v[84:85], v6 offset:832
    ds_read_b64 v[86:87], v6 offset:840
    ds_read_b64 v[88:89], v6 offset:896
    ds_read_b64 v[90:91], v6 offset:904
    ds_read_b64 v[92:93], v6 offset:960
    ds_read_b64 v[94:95], v6 offset:968
    ds_read_b64 v[96:97], v6 offset:1024
    ds_read_b64 v[98:99], v6 offset:1032
    ds_read_b64 v[100:101], v11 offset:128
    ds_read_b64 v[102:103], v11 offset:136
    ds_read_b64 v[104:105], v11 offset:384
    ds_read_b64 v[106:107], v11 offset:392
    v_lshlrev_b32 v18, 3, v3
    v_sub_u32 v18, v8, v18
    v_lshrrev_b32 v19, 2, v2
    v_lshl_add_u32 v19, v19, 2, v3
    v_and_b32 v28, 3, v2
    v_lshlrev_b32 v28, 4, v28
    v_mul_u32_u24 v19, s8, v19
    v_xor_b32 v19, s10, v19
    s_waitcnt lgkmcnt(0)
    v_mov_b32 v7, v18
    v_add_u32 v6, v19, v28
    v_xor_b32 v12, s9, v12
W_34:
    ds_read_b32 v18, v4 offset:16
    s_sub_u32 s39, s39, 1
    s_cbranch_scc1 KS_ABORT
    s_waitcnt lgkmcnt(0)
    v_cmp_ne_u32 vcc, s84, v18
    s_cbranch_vccnz W_34
    s_setprio 1
    ds_read_b128 v[108:111], v8 offset:448
    ds_read_b128 v[112:115], v8 offset:512
    ds_read_b128 v[116:119], v8 offset:576
    ds_read_b128 v[120:123], v8 offset:640
    ds_read_b128 v[124:127], v8 offset:704
    s_waitcnt lgkmcnt(4)
    v_mfma_f32_16x16x32_f16 v[20:23], v[32:35], v[108:111], 0
    ds_read_b128 v[108:111], v8 offset:768
    s_waitcnt lgkmcnt(4)
    v_mfma_f32_16x16x32_f16 v[20:23], v[36:39], v[112:115], v[20:23]
    ds_read_b128 v[112:115], v8 offset:832
    s_waitcnt lgkmcnt(4)
    v_mfma_f32_16x16x32_f16 v[20:23], v[40:43], v[116:119], v[20:23]
    ds_read_b128 v[116:119], v8 offset:896
    ds_read_b64 v[28:29], v7 offset:1504
    ds_read_b64 v[30:31], v7 offset:2016
    s_waitcnt lgkmcnt(6)
    v_mfma_f32_16x16x32_f16 v[20:23], v[44:47], v[120:123], v[20:23]
    ds_read_b128 v[120:123], v8 offset:960
    s_waitcnt lgkmcnt(6)
    v_mfma_f32_16x16x32_f16 v[20:23], v[48:51], v[124:127], v[20:23]
    ds_read_b128 v[124:127], v8 offset:1024
    s_waitcnt lgkmcnt(6)
    v_mfma_f32_16x16x32_f16 v[20:23], v[52:55], v[108:111], v[20:23]
    ds_read_b128 v[108:111], v8 offset:1088
    s_waitcnt lgkmcnt(6)
    v_mfma_f32_16x16x32_f16 v[20:23], v[56:59], v[112:115], v[20:23]
    s_waitcnt lgkmcnt(5)
    v_mfma_f32_16x16x32_f16 v[20:23], v[60:63], v[116:119], v[20:23]
    ds_read_b128 v[112:115], v8 offset:1152
    s_waitcnt lgkmcnt(3)
    v_mfma_f32_16x16x32_f16 v[20:23], v[64:67], v[120:123], v[20:23]
    v_mfma_f32_16x16x32_f16 v[24:27], v[32:35], v[120:123], 0
    ds_read_b128 v[116:119], v8 offset:1216
    v_fma_mix_f32 v120, v28, v17, 0 op_sel_hi:[1,0,0]
    v_fma_mix_f32 v121, v28, v17, 0 op_sel:[1,0,0] op_sel_hi:[1,0,0]
    s_waitcnt lgkmcnt(3)
    v_mfma_f32_16x16x32_f16 v[20:23], v[68:71], v[124:127], v[20:23]
    v_fma_mix_f32 v122, v29, v17, 0 op_sel_hi:[1,0,0]
    v_fma_mix_f32 v123, v29, v17, 0 op_sel:[1,0,0] op_sel_hi:[1,0,0]
    v_mfma_f32_16x16x32_f16 v[24:27], v[36:39], v[124:127], v[24:27]
    ds_read_b128 v[32:35], v8 offset:1280
    v_cvt_pk_bf16_f32 v120, 0, v120
    v_cvt_pk_bf16_f32 v121, 0, v121
    s_waitcnt lgkmcnt(3)
    v_mfma_f32_16x16x32_f16 v[20:23], v[72:75], v[108:111], v[20:23]
    v_cvt_pk_bf16_f32 v122, 0, v122
    v_cvt_pk_bf16_f32 v123, 0, v123
    v_mfma_f32_16x16x32_f16 v[24:27], v[40:43], v[108:111], v[24:27]
    ds_read_b128 v[36:39], v8 offset:1344
    v_fma_mix_f32 v108, v30, v17, 0 op_sel_hi:[1,0,0]
    v_fma_mix_f32 v109, v30, v17, 0 op_sel:[1,0,0] op_sel_hi:[1,0,0]
    s_waitcnt lgkmcnt(3)
    v_mfma_f32_16x16x32_f16 v[20:23], v[76:79], v[112:115], v[20:23]
    v_fma_mix_f32 v110, v31, v17, 0 op_sel_hi:[1,0,0]
    v_fma_mix_f32 v111, v31, v17, 0 op_sel:[1,0,0] op_sel_hi:[1,0,0]
    v_mfma_f32_16x16x32_f16 v[24:27], v[44:47], v[112:115], v[24:27]
    ds_read_b128 v[124:127], v8 offset:1408
    v_cvt_pk_bf16_f32 v108, 0, v108
    v_cvt_pk_bf16_f32 v109, 0, v109
    s_waitcnt lgkmcnt(3)
    v_mfma_f32_16x16x32_f16 v[20:23], v[80:83], v[116:119], v[20:23]
    v_cvt_pk_bf16_f32 v110, 0, v110
    v_cvt_pk_bf16_f32 v111, 0, v111
    v_mfma_f32_16x16x32_f16 v[24:27], v[48:51], v[116:119], v[24:27]
    ds_read_b128 v[40:43], v8 offset:1472
    s_waitcnt lgkmcnt(3)
    v_mfma_f32_16x16x32_f16 v[20:23], v[84:87], v[32:35], v[20:23]
    v_mfma_f32_16x16x32_f16 v[24:27], v[52:55], v[32:35], v[24:27]
    ds_read_b128 v[44:47], v8 offset:1536
    s_waitcnt lgkmcnt(3)
    v_mfma_f32_16x16x32_f16 v[20:23], v[88:91], v[36:39], v[20:23]
    ds_read_b128 v[112:115], v8 offset:1600
    v_mfma_f32_16x16x32_f16 v[24:27], v[56:59], v[36:39], v[24:27]
    ds_read_b128 v[48:51], v8 offset:1664
    s_waitcnt lgkmcnt(4)
    v_mfma_f32_16x16x32_f16 v[20:23], v[92:95], v[124:127], v[20:23]
    ds_read_b128 v[116:119], v8 offset:1728
    v_mfma_f32_16x16x32_f16 v[24:27], v[60:63], v[124:127], v[24:27]
    ds_read_b128 v[52:55], v8 offset:1792
    s_waitcnt lgkmcnt(5)
    v_mfma_f32_16x16x32_f16 v[20:23], v[96:99], v[40:43], v[20:23]
    ds_read_b128 v[32:35], v8 offset:1856
    v_mfma_f32_16x16x32_f16 v[24:27], v[64:67], v[40:43], v[24:27]
    ds_read_b32 v18, v14 offset:76
    ds_read_b128 v[56:59], v8 offset:1920
    s_waitcnt lgkmcnt(7)
    v_mfma_f32_16x16x32_f16 v[24:27], v[68:71], v[44:47], v[24:27]
    ds_read_b128 v[36:39], v8 offset:1984
    s_waitcnt lgkmcnt(7)
    v_mfma_f32_16x16x32_f16 v[24:27], v[72:75], v[112:115], v[24:27]
    ds_read_b64 v[60:61], v11 offset:64
    ds_read_b64 v[62:63], v11 offset:72
    s_waitcnt lgkmcnt(8)
    v_mfma_f32_16x16x32_f16 v[24:27], v[76:79], v[48:51], v[24:27]
    s_waitcnt lgkmcnt(4)
    v_cmp_ne_u32 vcc, s84, v18
    s_cbranch_vccnz WS_35
WB_36:
    ds_read_b64_tr_b16 v[124:125], v9 offset:0
    ds_read_b64_tr_b16 v[126:127], v9 offset:64
    ds_read_b64_tr_b16 v[64:65], v9 offset:3088
    ds_read_b64_tr_b16 v[66:67], v9 offset:3152
    v_mfma_f32_16x16x32_f16 v[24:27], v[80:83], v[116:119], v[24:27]
    v_mfma_f32_16x16x32_f16 v[24:27], v[84:87], v[52:55], v[24:27]
    ds_read_b64_tr_b16 v[40:41], v9 offset:512
    ds_read_b64_tr_b16 v[42:43], v9 offset:576
    ds_read_b64 v[68:69], v11 offset:320
    ds_read_b64 v[70:71], v11 offset:328
    v_mfma_f32_16x16x32_f16 v[24:27], v[88:91], v[32:35], v[24:27]
    s_waitcnt lgkmcnt(11)
    v_mfma_f32_16x16x32_f16 v[24:27], v[92:95], v[56:59], v[24:27]
    ds_read_b64_tr_b16 v[44:45], v9 offset:3600
    ds_read_b64_tr_b16 v[46:47], v9 offset:3664
    s_waitcnt lgkmcnt(12)
    v_mfma_f32_16x16x32_f16 v[24:27], v[96:99], v[36:39], v[24:27]
    s_waitcnt lgkmcnt(8)
    v_mfma_f32_16x16x32_f16 v[20:23], v[124:127], v[100:103], v[20:23]
    s_waitcnt lgkmcnt(6)
    v_mfma_f32_16x16x32_f16 v[20:23], v[64:67], v[104:107], v[20:23]
    v_mfma_f32_16x16x32_f16 v[24:27], v[124:127], v[60:63], v[24:27]
    s_waitcnt lgkmcnt(4)
    v_mfma_f32_16x16x32_f16 v[24:27], v[40:43], v[100:103], v[24:27]
    s_nop 4
    v_mul_f32 v20, v20, v16
    v_mul_f32 v21, v21, v16
    s_waitcnt lgkmcnt(2)
    v_mfma_f32_16x16x32_f16 v[24:27], v[64:67], v[68:71], v[24:27]
    v_mul_f32 v22, v22, v16
    v_mul_f32 v23, v23, v16
    s_waitcnt lgkmcnt(0)
    v_mfma_f32_16x16x32_f16 v[24:27], v[44:47], v[104:107], v[24:27]
    v_cvt_pk_bf16_f32 v20, 0, v20
    v_cvt_pk_bf16_f32 v21, 0, v21
    v_cvt_pk_bf16_f32 v22, 0, v22
    v_cvt_pk_bf16_f32 v23, 0, v23
    v_add_f32 v20, v20, v120
    v_add_f32 v21, v21, v121
    v_add_f32 v22, v22, v122
    v_add_f32 v23, v23, v123
    v_cvt_pk_bf16_f32 v28, v20, v21
    v_cvt_pk_bf16_f32 v29, v22, v23
    v_min_u32 v28, -2, v28
    v_min_u32 v29, -2, v29
    ds_read_u8 v18, v14 offset:113
    ds_read_b128 v[20:23], v12 offset:47616
    v_mul_f32 v24, v24, v16
    v_mul_f32 v25, v25, v16
    v_mul_f32 v26, v26, v16
    v_mul_f32 v27, v27, v16
    v_cvt_pk_bf16_f32 v24, 0, v24
    v_cvt_pk_bf16_f32 v25, 0, v25
    v_cvt_pk_bf16_f32 v26, 0, v26
    v_cvt_pk_bf16_f32 v27, 0, v27
    v_add_f32 v24, v24, v108
    v_add_f32 v25, v25, v109
    v_add_f32 v26, v26, v110
    v_add_f32 v27, v27, v111
    v_cvt_pk_bf16_f32 v30, v24, v25
    v_cvt_pk_bf16_f32 v31, v26, v27
    v_min_u32 v30, -2, v30
    v_min_u32 v31, -2, v31
    s_branch CVE_32
CV_30:
    ds_read_b64 v[32:33], v6 offset:1152
    ds_read_b64 v[34:35], v6 offset:1160
    ds_read_b64 v[36:37], v6 offset:0
    ds_read_b64 v[38:39], v6 offset:8
    ds_read_b64 v[40:41], v6 offset:64
    ds_read_b64 v[42:43], v6 offset:72
    ds_read_b64 v[44:45], v6 offset:128
    ds_read_b64 v[46:47], v6 offset:136
    ds_read_b64 v[48:49], v6 offset:192
    ds_read_b64 v[50:51], v6 offset:200
    ds_read_b64 v[52:53], v6 offset:256
    ds_read_b64 v[54:55], v6 offset:264
    ds_read_b64 v[56:57], v6 offset:320
    ds_read_b64 v[58:59], v6 offset:328
    ds_read_b64 v[60:61], v6 offset:384
    ds_read_b64 v[62:63], v6 offset:392
    ds_read_b64 v[64:65], v6 offset:448
    ds_read_b64 v[66:67], v6 offset:456
    ds_read_b64 v[68:69], v6 offset:512
    ds_read_b64 v[70:71], v6 offset:520
    ds_read_b64 v[72:73], v6 offset:576
    ds_read_b64 v[74:75], v6 offset:584
    ds_read_b64 v[76:77], v6 offset:640
    ds_read_b64 v[78:79], v6 offset:648
    ds_read_b64 v[80:81], v6 offset:704
    ds_read_b64 v[82:83], v6 offset:712
    ds_read_b64 v[84:85], v6 offset:768
    ds_read_b64 v[86:87], v6 offset:776
    ds_read_b64 v[88:89], v6 offset:832
    ds_read_b64 v[90:91], v6 offset:840
    ds_read_b64 v[92:93], v6 offset:896
    ds_read_b64 v[94:95], v6 offset:904
    ds_read_b64 v[96:97], v6 offset:960
    ds_read_b64 v[98:99], v6 offset:968
    ds_read_b64 v[100:101], v6 offset:1024
    ds_read_b64 v[102:103], v6 offset:1032
    ds_read_b64 v[104:105], v11 offset:0
    ds_read_b64 v[106:107], v11 offset:8
    v_lshlrev_b32 v18, 3, v3
    v_sub_u32 v18, v8, v18
    v_lshrrev_b32 v19, 2, v2
    v_lshl_add_u32 v19, v19, 2, v3
    v_and_b32 v28, 3, v2
    v_lshlrev_b32 v28, 4, v28
    v_mul_u32_u24 v19, s8, v19
    v_xor_b32 v19, s10, v19
    s_waitcnt lgkmcnt(0)
    v_mov_b32 v7, v18
    v_add_u32 v6, v19, v28
    v_xor_b32 v12, s9, v12
W_37:
    ds_read_b32 v18, v4 offset:16
    s_sub_u32 s39, s39, 1
    s_cbranch_scc1 KS_ABORT
    s_waitcnt lgkmcnt(0)
    v_cmp_ne_u32 vcc, s84, v18
    s_cbranch_vccnz W_37
    s_setprio 1
    ds_read_b128 v[108:111], v8 offset:448
    ds_read_b128 v[112:115], v8 offset:960
    ds_read_b128 v[116:119], v8 offset:1472
    ds_read_b128 v[120:123], v8 offset:1536
    ds_read_b128 v[124:127], v8 offset:1600
    s_waitcnt lgkmcnt(4)
    v_mfma_f32_16x16x32_f16 v[20:23], v[32:35], v[108:111], 0
    ds_read_b128 v[108:111], v8 offset:1664
    s_waitcnt lgkmcnt(4)
    v_mfma_f32_16x16x32_f16 v[24:27], v[32:35], v[112:115], 0
    ds_read_b128 v[32:35], v8 offset:1728
    ds_read_b128 v[112:115], v8 offset:1792
    s_waitcnt lgkmcnt(5)
    v_mfma_f32_16x16x32_f16 v[20:23], v[36:39], v[116:119], v[20:23]
    ds_read_b128 v[116:119], v8 offset:1856
    ds_read_b64 v[28:29], v7 offset:2528
    ds_read_b64 v[30:31], v7 offset:3040
    s_waitcnt lgkmcnt(7)
    v_mfma_f32_16x16x32_f16 v[20:23], v[40:43], v[120:123], v[20:23]
    ds_read_b128 v[120:123], v8 offset:1920
    s_waitcnt lgkmcnt(7)
    v_mfma_f32_16x16x32_f16 v[20:23], v[44:47], v[124:127], v[20:23]
    ds_read_b128 v[124:127], v8 offset:1984
    s_waitcnt lgkmcnt(7)
    v_mfma_f32_16x16x32_f16 v[20:23], v[48:51], v[108:111], v[20:23]
    ds_read_b128 v[108:111], v8 offset:2048
    s_waitcnt lgkmcnt(7)
    v_mfma_f32_16x16x32_f16 v[20:23], v[52:55], v[32:35], v[20:23]
    s_waitcnt lgkmcnt(6)
    v_mfma_f32_16x16x32_f16 v[20:23], v[56:59], v[112:115], v[20:23]
    ds_read_b128 v[32:35], v8 offset:2112
    s_waitcnt lgkmcnt(6)
    v_mfma_f32_16x16x32_f16 v[20:23], v[60:63], v[116:119], v[20:23]
    s_waitcnt lgkmcnt(4)
    v_fma_mix_f32 v116, v28, v17, 0 op_sel_hi:[1,0,0]
    v_fma_mix_f32 v117, v28, v17, 0 op_sel:[1,0,0] op_sel_hi:[1,0,0]
    s_waitcnt lgkmcnt(3)
    v_mfma_f32_16x16x32_f16 v[20:23], v[64:67], v[120:123], v[20:23]
    ds_read_b128 v[112:115], v8 offset:2176
    v_fma_mix_f32 v118, v29, v17, 0 op_sel_hi:[1,0,0]
    v_fma_mix_f32 v119, v29, v17, 0 op_sel:[1,0,0] op_sel_hi:[1,0,0]
    s_waitcnt lgkmcnt(3)
    v_mfma_f32_16x16x32_f16 v[20:23], v[68:71], v[124:127], v[20:23]
    v_cvt_pk_bf16_f32 v116, 0, v116
    v_cvt_pk_bf16_f32 v117, 0, v117
    v_mfma_f32_16x16x32_f16 v[24:27], v[36:39], v[124:127], v[24:27]
    ds_read_b128 v[120:123], v8 offset:2240
    v_cvt_pk_bf16_f32 v118, 0, v118
    v_cvt_pk_bf16_f32 v119, 0, v119
    s_waitcnt lgkmcnt(3)
    v_mfma_f32_16x16x32_f16 v[20:23], v[72:75], v[108:111], v[20:23]
    v_fma_mix_f32 v124, v30, v17, 0 op_sel_hi:[1,0,0]
    v_fma_mix_f32 v125, v30, v17, 0 op_sel:[1,0,0] op_sel_hi:[1,0,0]
    v_mfma_f32_16x16x32_f16 v[24:27], v[40:43], v[108:111], v[24:27]
    ds_read_b128 v[36:39], v8 offset:2304
    v_fma_mix_f32 v126, v31, v17, 0 op_sel_hi:[1,0,0]
    v_fma_mix_f32 v127, v31, v17, 0 op_sel:[1,0,0] op_sel_hi:[1,0,0]
    s_waitcnt lgkmcnt(3)
    v_mfma_f32_16x16x32_f16 v[20:23], v[76:79], v[32:35], v[20:23]
    v_cvt_pk_bf16_f32 v124, 0, v124
    v_cvt_pk_bf16_f32 v125, 0, v125
    v_mfma_f32_16x16x32_f16 v[24:27], v[44:47], v[32:35], v[24:27]
    ds_read_b128 v[40:43], v8 offset:2368
    v_cvt_pk_bf16_f32 v126, 0, v126
    v_cvt_pk_bf16_f32 v127, 0, v127
    s_waitcnt lgkmcnt(3)
    v_mfma_f32_16x16x32_f16 v[20:23], v[80:83], v[112:115], v[20:23]
    v_mfma_f32_16x16x32_f16 v[24:27], v[48:51], v[112:115], v[24:27]
    ds_read_b128 v[108:111], v8 offset:2432
    s_waitcnt lgkmcnt(3)
    v_mfma_f32_16x16x32_f16 v[20:23], v[84:87], v[120:123], v[20:23]
    v_mfma_f32_16x16x32_f16 v[24:27], v[52:55], v[120:123], v[24:27]
    ds_read_b128 v[44:47], v8 offset:2496
    s_waitcnt lgkmcnt(3)
    v_mfma_f32_16x16x32_f16 v[20:23], v[88:91], v[36:39], v[20:23]
    v_mfma_f32_16x16x32_f16 v[24:27], v[56:59], v[36:39], v[24:27]
    ds_read_b128 v[32:35], v8 offset:2560
    s_waitcnt lgkmcnt(3)
    v_mfma_f32_16x16x32_f16 v[20:23], v[92:95], v[40:43], v[20:23]
    ds_read_b128 v[48:51], v8 offset:2624
    v_mfma_f32_16x16x32_f16 v[24:27], v[60:63], v[40:43], v[24:27]
    ds_read_b128 v[112:115], v8 offset:2688
    s_waitcnt lgkmcnt(4)
    v_mfma_f32_16x16x32_f16 v[20:23], v[96:99], v[108:111], v[20:23]
    ds_read_b128 v[52:55], v8 offset:2752
    v_mfma_f32_16x16x32_f16 v[24:27], v[64:67], v[108:111], v[24:27]
    ds_read_b128 v[120:123], v8 offset:2816
    s_waitcnt lgkmcnt(5)
    v_mfma_f32_16x16x32_f16 v[20:23], v[100:103], v[44:47], v[20:23]
    ds_read_b128 v[56:59], v8 offset:2880
    v_mfma_f32_16x16x32_f16 v[24:27], v[68:71], v[44:47], v[24:27]
    ds_read_b32 v18, v14 offset:76
    ds_read_b128 v[36:39], v8 offset:2944
    s_waitcnt lgkmcnt(7)
    v_mfma_f32_16x16x32_f16 v[24:27], v[72:75], v[32:35], v[24:27]
    ds_read_b128 v[60:63], v8 offset:3008
    s_waitcnt lgkmcnt(7)
    v_mfma_f32_16x16x32_f16 v[24:27], v[76:79], v[48:51], v[24:27]
    ds_read_b64 v[40:41], v11 offset:64
    ds_read_b64 v[42:43], v11 offset:72
    ds_read_b64 v[64:65], v11 offset:128
    ds_read_b64 v[66:67], v11 offset:136
    s_waitcnt lgkmcnt(10)
    v_mfma_f32_16x16x32_f16 v[24:27], v[80:83], v[112:115], v[24:27]
    s_waitcnt lgkmcnt(6)
    v_cmp_ne_u32 vcc, s84, v18
    s_cbranch_vccnz WS_38
WB_39:
    ds_read_b64_tr_b16 v[108:109], v9 offset:0
    ds_read_b64_tr_b16 v[110:111], v9 offset:64
    ds_read_b64_tr_b16 v[68:69], v9 offset:512
    ds_read_b64_tr_b16 v[70:71], v9 offset:576
    v_mfma_f32_16x16x32_f16 v[24:27], v[84:87], v[52:55], v[24:27]
    ds_read_b64_tr_b16 v[44:45], v9 offset:1024
    ds_read_b64_tr_b16 v[46:47], v9 offset:1088
    v_mfma_f32_16x16x32_f16 v[24:27], v[88:91], v[120:123], v[24:27]
    ds_read_b64_tr_b16 v[72:73], v9 offset:3088
    ds_read_b64_tr_b16 v[74:75], v9 offset:3152
    ds_read_b64 v[32:33], v11 offset:256
    ds_read_b64 v[34:35], v11 offset:264
    v_mfma_f32_16x16x32_f16 v[24:27], v[92:95], v[56:59], v[24:27]
    ds_read_b64_tr_b16 v[76:77], v9 offset:3600
    ds_read_b64_tr_b16 v[78:79], v9 offset:3664
    ds_read_b64 v[48:49], v11 offset:320
    ds_read_b64 v[50:51], v11 offset:328
    v_mfma_f32_16x16x32_f16 v[24:27], v[96:99], v[36:39], v[24:27]
    ds_read_b64_tr_b16 v[80:81], v9 offset:4112
    ds_read_b64_tr_b16 v[82:83], v9 offset:4176
    ds_read_b64 v[112:113], v11 offset:384
    ds_read_b64 v[114:115], v11 offset:392
    v_mfma_f32_16x16x32_f16 v[24:27], v[100:103], v[60:63], v[24:27]
    ds_read_b64_tr_b16 v[84:85], v10 offset:6176
    ds_read_b64_tr_b16 v[86:87], v10 offset:6304
    ds_read_b64 v[52:53], v13 offset:96
    ds_read_b64 v[54:55], v13 offset:104
    v_mfma_f32_16x16x32_f16 v[20:23], v[108:111], v[104:107], v[20:23]
    ds_read_b64_tr_b16 v[88:89], v10 offset:8224
    ds_read_b64_tr_b16 v[90:91], v10 offset:8352
    ds_read_b64 v[120:121], v13 offset:480
    ds_read_b64 v[122:123], v13 offset:488
    v_mfma_f32_16x16x32_f16 v[20:23], v[68:71], v[40:43], v[20:23]
    v_mfma_f32_16x16x32_f16 v[20:23], v[44:47], v[64:67], v[20:23]
    v_mfma_f32_16x16x32_f16 v[20:23], v[72:75], v[32:35], v[20:23]
    ds_read_b64_tr_b16 v[92:93], v9 offset:1536
    ds_read_b64_tr_b16 v[94:95], v9 offset:1600
    s_waitcnt lgkmcnt(14)
    v_mfma_f32_16x16x32_f16 v[20:23], v[76:79], v[48:51], v[20:23]
    s_waitcnt lgkmcnt(10)
    v_mfma_f32_16x16x32_f16 v[20:23], v[80:83], v[112:115], v[20:23]
    s_waitcnt lgkmcnt(6)
    v_mfma_f32_16x16x32_f16 v[20:23], v[84:87], v[52:55], v[20:23]
    ds_read_b64_tr_b16 v[56:57], v9 offset:4624
    ds_read_b64_tr_b16 v[58:59], v9 offset:4688
    ds_read_b64 v[96:97], v13 offset:64
    ds_read_b64 v[98:99], v13 offset:72
    s_waitcnt lgkmcnt(6)
    v_mfma_f32_16x16x32_f16 v[20:23], v[88:91], v[120:123], v[20:23]
    ds_read_b64 v[36:37], v13 offset:448
    ds_read_b64 v[38:39], v13 offset:456
    v_mfma_f32_16x16x32_f16 v[24:27], v[68:71], v[104:107], v[24:27]
    v_mfma_f32_16x16x32_f16 v[24:27], v[44:47], v[40:43], v[24:27]
    s_nop 3
    v_mul_f32 v20, v20, v16
    v_mul_f32 v21, v21, v16
    s_waitcnt lgkmcnt(6)
    v_mfma_f32_16x16x32_f16 v[24:27], v[92:95], v[64:67], v[24:27]
    v_mul_f32 v22, v22, v16
    v_mul_f32 v23, v23, v16
    v_mfma_f32_16x16x32_f16 v[24:27], v[76:79], v[32:35], v[24:27]
    v_cvt_pk_bf16_f32 v20, 0, v20
    v_cvt_pk_bf16_f32 v21, 0, v21
    v_mfma_f32_16x16x32_f16 v[24:27], v[80:83], v[48:51], v[24:27]
    v_cvt_pk_bf16_f32 v22, 0, v22
    v_cvt_pk_bf16_f32 v23, 0, v23
    s_waitcnt lgkmcnt(4)
    v_mfma_f32_16x16x32_f16 v[24:27], v[56:59], v[112:115], v[24:27]
    v_add_f32 v20, v20, v116
    v_add_f32 v21, v21, v117
    s_waitcnt lgkmcnt(2)
    v_mfma_f32_16x16x32_f16 v[24:27], v[84:87], v[96:99], v[24:27]
    v_add_f32 v22, v22, v118
    v_add_f32 v23, v23, v119
    s_waitcnt lgkmcnt(0)
    v_mfma_f32_16x16x32_f16 v[24:27], v[88:91], v[36:39], v[24:27]
    v_cvt_pk_bf16_f32 v28, v20, v21
    v_cvt_pk_bf16_f32 v29, v22, v23
    v_min_u32 v28, -2, v28
    v_min_u32 v29, -2, v29
    ds_read_u8 v18, v14 offset:114
    ds_read_b128 v[20:23], v12 offset:48640
    s_nop 1
    v_mul_f32 v24, v24, v16
    v_mul_f32 v25, v25, v16
    v_mul_f32 v26, v26, v16
    v_mul_f32 v27, v27, v16
    v_cvt_pk_bf16_f32 v24, 0, v24
    v_cvt_pk_bf16_f32 v25, 0, v25
    v_cvt_pk_bf16_f32 v26, 0, v26
    v_cvt_pk_bf16_f32 v27, 0, v27
    v_add_f32 v24, v24, v124
    v_add_f32 v25, v25, v125
    v_add_f32 v26, v26, v126
    v_add_f32 v27, v27, v127
    v_cvt_pk_bf16_f32 v30, v24, v25
    v_cvt_pk_bf16_f32 v31, v26, v27
    v_min_u32 v30, -2, v30
    v_min_u32 v31, -2, v31
    s_branch CVE_32
CV_31:
    ds_read_b64 v[32:33], v6 offset:1152
    ds_read_b64 v[34:35], v6 offset:1160
    ds_read_b64 v[36:37], v6 offset:0
    ds_read_b64 v[38:39], v6 offset:8
    ds_read_b64 v[40:41], v6 offset:64
    ds_read_b64 v[42:43], v6 offset:72
    ds_read_b64 v[44:45], v6 offset:128
    ds_read_b64 v[46:47], v6 offset:136
    ds_read_b64 v[48:49], v6 offset:192
    ds_read_b64 v[50:51], v6 offset:200
    ds_read_b64 v[52:53], v6 offset:256
    ds_read_b64 v[54:55], v6 offset:264
    ds_read_b64 v[56:57], v6 offset:320
    ds_read_b64 v[58:59], v6 offset:328
    ds_read_b64 v[60:61], v6 offset:384
    ds_read_b64 v[62:63], v6 offset:392
    ds_read_b64 v[64:65], v6 offset:448
    ds_read_b64 v[66:67], v6 offset:456
    ds_read_b64 v[68:69], v6 offset:512
    ds_read_b64 v[70:71], v6 offset:520
    ds_read_b64 v[72:73], v6 offset:576
    ds_read_b64 v[74:75], v6 offset:584
    ds_read_b64 v[76:77], v6 offset:640
    ds_read_b64 v[78:79], v6 offset:648
    ds_read_b64 v[80:81], v6 offset:704
    ds_read_b64 v[82:83], v6 offset:712
    ds_read_b64 v[84:85], v6 offset:768
    ds_read_b64 v[86:87], v6 offset:776
    ds_read_b64 v[88:89], v6 offset:832
    ds_read_b64 v[90:91], v6 offset:840
    ds_read_b64 v[92:93], v6 offset:896
    ds_read_b64 v[94:95], v6 offset:904
    ds_read_b64 v[96:97], v6 offset:960
    ds_read_b64 v[98:99], v6 offset:968
    ds_read_b64 v[100:101], v6 offset:1024
    ds_read_b64 v[102:103], v6 offset:1032
    ds_read_b64 v[104:105], v11 offset:0
    ds_read_b64 v[106:107], v11 offset:8
    v_lshlrev_b32 v18, 3, v3
    v_sub_u32 v18, v8, v18
    v_lshrrev_b32 v19, 2, v2
    v_lshl_add_u32 v19, v19, 2, v3
    v_and_b32 v28, 3, v2
    v_lshlrev_b32 v28, 4, v28
    v_mul_u32_u24 v19, s8, v19
    v_xor_b32 v19, s10, v19
    s_waitcnt lgkmcnt(0)
    v_mov_b32 v7, v18
    v_add_u32 v6, v19, v28
    v_xor_b32 v12, s9, v12
W_40:
    ds_read_b32 v18, v4 offset:16
    s_sub_u32 s39, s39, 1
    s_cbranch_scc1 KS_ABORT
    s_waitcnt lgkmcnt(0)
    v_cmp_ne_u32 vcc, s84, v18
    s_cbranch_vccnz W_40
    s_setprio 1
    ds_read_b128 v[108:111], v8 offset:1472
    ds_read_b128 v[112:115], v8 offset:1984
    ds_read_b128 v[116:119], v8 offset:2496
    ds_read_b128 v[120:123], v8 offset:2560
    ds_read_b128 v[124:127], v8 offset:2624
    s_waitcnt lgkmcnt(4)
    v_mfma_f32_16x16x32_f16 v[20:23], v[32:35], v[108:111], 0
    ds_read_b128 v[108:111], v8 offset:2688
    s_waitcnt lgkmcnt(4)
    v_mfma_f32_16x16x32_f16 v[24:27], v[32:35], v[112:115], 0
    ds_read_b128 v[32:35], v8 offset:2752
    ds_read_b128 v[112:115], v8 offset:2816
    s_waitcnt lgkmcnt(5)
    v_mfma_f32_16x16x32_f16 v[20:23], v[36:39], v[116:119], v[20:23]
    ds_read_b128 v[116:119], v8 offset:2880
    ds_read_b64 v[28:29], v7 offset:3552
    ds_read_b64 v[30:31], v7 offset:4064
    s_waitcnt lgkmcnt(7)
    v_mfma_f32_16x16x32_f16 v[20:23], v[40:43], v[120:123], v[20:23]
    ds_read_b128 v[120:123], v8 offset:2944
    s_waitcnt lgkmcnt(7)
    v_mfma_f32_16x16x32_f16 v[20:23], v[44:47], v[124:127], v[20:23]
    ds_read_b128 v[124:127], v8 offset:3008
    s_waitcnt lgkmcnt(7)
    v_mfma_f32_16x16x32_f16 v[20:23], v[48:51], v[108:111], v[20:23]
    ds_read_b128 v[108:111], v8 offset:3072
    s_waitcnt lgkmcnt(7)
    v_mfma_f32_16x16x32_f16 v[20:23], v[52:55], v[32:35], v[20:23]
    s_waitcnt lgkmcnt(6)
    v_mfma_f32_16x16x32_f16 v[20:23], v[56:59], v[112:115], v[20:23]
    ds_read_b128 v[32:35], v8 offset:3136
    s_waitcnt lgkmcnt(6)
    v_mfma_f32_16x16x32_f16 v[20:23], v[60:63], v[116:119], v[20:23]
    s_waitcnt lgkmcnt(4)
    v_fma_mix_f32 v116, v28, v17, 0 op_sel_hi:[1,0,0]
    v_fma_mix_f32 v117, v28, v17, 0 op_sel:[1,0,0] op_sel_hi:[1,0,0]
    s_waitcnt lgkmcnt(3)
    v_mfma_f32_16x16x32_f16 v[20:23], v[64:67], v[120:123], v[20:23]
    ds_read_b128 v[112:115], v8 offset:3200
    v_fma_mix_f32 v118, v29, v17, 0 op_sel_hi:[1,0,0]
    v_fma_mix_f32 v119, v29, v17, 0 op_sel:[1,0,0] op_sel_hi:[1,0,0]
    s_waitcnt lgkmcnt(3)
    v_mfma_f32_16x16x32_f16 v[20:23], v[68:71], v[124:127], v[20:23]
    v_cvt_pk_bf16_f32 v116, 0, v116
    v_cvt_pk_bf16_f32 v117, 0, v117
    v_mfma_f32_16x16x32_f16 v[24:27], v[36:39], v[124:127], v[24:27]
    ds_read_b128 v[120:123], v8 offset:3264
    v_cvt_pk_bf16_f32 v118, 0, v118
    v_cvt_pk_bf16_f32 v119, 0, v119
    s_waitcnt lgkmcnt(3)
    v_mfma_f32_16x16x32_f16 v[20:23], v[72:75], v[108:111], v[20:23]
    v_fma_mix_f32 v124, v30, v17, 0 op_sel_hi:[1,0,0]
    v_fma_mix_f32 v125, v30, v17, 0 op_sel:[1,0,0] op_sel_hi:[1,0,0]
    v_mfma_f32_16x16x32_f16 v[24:27], v[40:43], v[108:111], v[24:27]
    ds_read_b128 v[36:39], v8 offset:3328
    v_fma_mix_f32 v126, v31, v17, 0 op_sel_hi:[1,0,0]
    v_fma_mix_f32 v127, v31, v17, 0 op_sel:[1,0,0] op_sel_hi:[1,0,0]
    s_waitcnt lgkmcnt(3)
    v_mfma_f32_16x16x32_f16 v[20:23], v[76:79], v[32:35], v[20:23]
    v_cvt_pk_bf16_f32 v124, 0, v124
    v_cvt_pk_bf16_f32 v125, 0, v125
    v_mfma_f32_16x16x32_f16 v[24:27], v[44:47], v[32:35], v[24:27]
    ds_read_b128 v[40:43], v8 offset:3392
    v_cvt_pk_bf16_f32 v126, 0, v126
    v_cvt_pk_bf16_f32 v127, 0, v127
    s_waitcnt lgkmcnt(3)
    v_mfma_f32_16x16x32_f16 v[20:23], v[80:83], v[112:115], v[20:23]
    v_mfma_f32_16x16x32_f16 v[24:27], v[48:51], v[112:115], v[24:27]
    ds_read_b128 v[108:111], v8 offset:3456
    s_waitcnt lgkmcnt(3)
    v_mfma_f32_16x16x32_f16 v[20:23], v[84:87], v[120:123], v[20:23]
    v_mfma_f32_16x16x32_f16 v[24:27], v[52:55], v[120:123], v[24:27]
    ds_read_b128 v[44:47], v8 offset:3520
    s_waitcnt lgkmcnt(3)
    v_mfma_f32_16x16x32_f16 v[20:23], v[88:91], v[36:39], v[20:23]
    v_mfma_f32_16x16x32_f16 v[24:27], v[56:59], v[36:39], v[24:27]
    ds_read_b128 v[32:35], v8 offset:3584
    s_waitcnt lgkmcnt(3)
    v_mfma_f32_16x16x32_f16 v[20:23], v[92:95], v[40:43], v[20:23]
    ds_read_b128 v[48:51], v8 offset:3648
    v_mfma_f32_16x16x32_f16 v[24:27], v[60:63], v[40:43], v[24:27]
    ds_read_b128 v[112:115], v8 offset:3712
    s_waitcnt lgkmcnt(4)
    v_mfma_f32_16x16x32_f16 v[20:23], v[96:99], v[108:111], v[20:23]
    ds_read_b128 v[52:55], v8 offset:3776
    v_mfma_f32_16x16x32_f16 v[24:27], v[64:67], v[108:111], v[24:27]
    ds_read_b128 v[120:123], v8 offset:3840
    s_waitcnt lgkmcnt(5)
    v_mfma_f32_16x16x32_f16 v[20:23], v[100:103], v[44:47], v[20:23]
    ds_read_b128 v[56:59], v8 offset:3904
    v_mfma_f32_16x16x32_f16 v[24:27], v[68:71], v[44:47], v[24:27]
    ds_read_b32 v18, v14 offset:76
    ds_read_b128 v[36:39], v8 offset:3968
    s_waitcnt lgkmcnt(7)
    v_mfma_f32_16x16x32_f16 v[24:27], v[72:75], v[32:35], v[24:27]
    ds_read_b128 v[60:63], v8 offset:4032
    s_waitcnt lgkmcnt(7)
    v_mfma_f32_16x16x32_f16 v[24:27], v[76:79], v[48:51], v[24:27]
    ds_read_b64 v[40:41], v11 offset:64
    ds_read_b64 v[42:43], v11 offset:72
    ds_read_b64 v[64:65], v11 offset:128
    ds_read_b64 v[66:67], v11 offset:136
    s_waitcnt lgkmcnt(10)
    v_mfma_f32_16x16x32_f16 v[24:27], v[80:83], v[112:115], v[24:27]
    s_waitcnt lgkmcnt(6)
    v_cmp_ne_u32 vcc, s84, v18
    s_cbranch_vccnz WS_41
WB_42:
    ds_read_b64_tr_b16 v[108:109], v9 offset:1024
    ds_read_b64_tr_b16 v[110:111], v9 offset:1088
    ds_read_b64_tr_b16 v[68:69], v9 offset:1536
    ds_read_b64_tr_b16 v[70:71], v9 offset:1600
    v_mfma_f32_16x16x32_f16 v[24:27], v[84:87], v[52:55], v[24:27]
    ds_read_b64_tr_b16 v[44:45], v9 offset:2048
    ds_read_b64_tr_b16 v[46:47], v9 offset:2112
    v_mfma_f32_16x16x32_f16 v[24:27], v[88:91], v[120:123], v[24:27]
    ds_read_b64_tr_b16 v[72:73], v9 offset:4112
    ds_read_b64_tr_b16 v[74:75], v9 offset:4176
    ds_read_b64 v[32:33], v11 offset:256
    ds_read_b64 v[34:35], v11 offset:264
    v_mfma_f32_16x16x32_f16 v[24:27], v[92:95], v[56:59], v[24:27]
    ds_read_b64_tr_b16 v[76:77], v9 offset:4624
    ds_read_b64_tr_b16 v[78:79], v9 offset:4688
    ds_read_b64 v[48:49], v11 offset:320
    ds_read_b64 v[50:51], v11 offset:328
    v_mfma_f32_16x16x32_f16 v[24:27], v[96:99], v[36:39], v[24:27]
    ds_read_b64_tr_b16 v[80:81], v9 offset:5136
    ds_read_b64_tr_b16 v[82:83], v9 offset:5200
    ds_read_b64 v[112:113], v11 offset:384
    ds_read_b64 v[114:115], v11 offset:392
    v_mfma_f32_16x16x32_f16 v[24:27], v[100:103], v[60:63], v[24:27]
    ds_read_b64_tr_b16 v[84:85], v10 offset:6176
    ds_read_b64_tr_b16 v[86:87], v10 offset:6304
    ds_read_b64 v[52:53], v13 offset:32
    ds_read_b64 v[54:55], v13 offset:40
    v_mfma_f32_16x16x32_f16 v[20:23], v[108:111], v[104:107], v[20:23]
    ds_read_b64_tr_b16 v[88:89], v10 offset:7200
    ds_read_b64_tr_b16 v[90:91], v10 offset:7328
    ds_read_b64 v[120:121], v13 offset:96
    ds_read_b64 v[122:123], v13 offset:104
    v_mfma_f32_16x16x32_f16 v[20:23], v[68:71], v[40:43], v[20:23]
    ds_read_b64_tr_b16 v[92:93], v10 offset:8224
    ds_read_b64_tr_b16 v[94:95], v10 offset:8352
    ds_read_b64 v[56:57], v13 offset:416
    ds_read_b64 v[58:59], v13 offset:424
    v_mfma_f32_16x16x32_f16 v[20:23], v[44:47], v[64:67], v[20:23]
    ds_read_b64_tr_b16 v[96:97], v10 offset:9248
    ds_read_b64_tr_b16 v[98:99], v10 offset:9376
    ds_read_b64 v[36:37], v13 offset:480
    ds_read_b64 v[38:39], v13 offset:488
    v_mfma_f32_16x16x32_f16 v[20:23], v[72:75], v[32:35], v[20:23]
    v_mfma_f32_16x16x32_f16 v[20:23], v[76:79], v[48:51], v[20:23]
    v_mfma_f32_16x16x32_f16 v[20:23], v[80:83], v[112:115], v[20:23]
    ds_read_b64_tr_b16 v[100:101], v9 offset:2560
    ds_read_b64_tr_b16 v[102:103], v9 offset:2624
    s_waitcnt lgkmcnt(14)
    v_mfma_f32_16x16x32_f16 v[20:23], v[84:87], v[52:55], v[20:23]
    s_waitcnt lgkmcnt(10)
    v_mfma_f32_16x16x32_f16 v[20:23], v[88:91], v[120:123], v[20:23]
    s_waitcnt lgkmcnt(6)
    v_mfma_f32_16x16x32_f16 v[20:23], v[92:95], v[56:59], v[20:23]
    ds_read_b64_tr_b16 v[60:61], v9 offset:5648
    ds_read_b64_tr_b16 v[62:63], v9 offset:5712
    ds_read_b64 v[108:109], v13 offset:0
    ds_read_b64 v[110:111], v13 offset:8
    s_waitcnt lgkmcnt(6)
    v_mfma_f32_16x16x32_f16 v[20:23], v[96:99], v[36:39], v[20:23]
    ds_read_b64 v[72:73], v13 offset:64
    ds_read_b64 v[74:75], v13 offset:72
    ds_read_b64 v[52:53], v13 offset:384
    ds_read_b64 v[54:55], v13 offset:392
    v_mfma_f32_16x16x32_f16 v[24:27], v[68:71], v[104:107], v[24:27]
    ds_read_b64 v[120:121], v13 offset:448
    ds_read_b64 v[122:123], v13 offset:456
    v_mfma_f32_16x16x32_f16 v[24:27], v[44:47], v[40:43], v[24:27]
    v_mul_f32 v20, v20, v16
    v_mul_f32 v21, v21, v16
    s_waitcnt lgkmcnt(10)
    v_mfma_f32_16x16x32_f16 v[24:27], v[100:103], v[64:67], v[24:27]
    v_mul_f32 v22, v22, v16
    v_mul_f32 v23, v23, v16
    v_mfma_f32_16x16x32_f16 v[24:27], v[76:79], v[32:35], v[24:27]
    v_cvt_pk_bf16_f32 v20, 0, v20
    v_cvt_pk_bf16_f32 v21, 0, v21
    v_mfma_f32_16x16x32_f16 v[24:27], v[80:83], v[48:51], v[24:27]
    v_cvt_pk_bf16_f32 v22, 0, v22
    v_cvt_pk_bf16_f32 v23, 0, v23
    s_waitcnt lgkmcnt(8)
    v_mfma_f32_16x16x32_f16 v[24:27], v[60:63], v[112:115], v[24:27]
    v_add_f32 v20, v20, v116
    v_add_f32 v21, v21, v117
    s_waitcnt lgkmcnt(6)
    v_mfma_f32_16x16x32_f16 v[24:27], v[84:87], v[108:111], v[24:27]
    v_add_f32 v22, v22, v118
    v_add_f32 v23, v23, v119
    s_waitcnt lgkmcnt(4)
    v_mfma_f32_16x16x32_f16 v[24:27], v[88:91], v[72:75], v[24:27]
    v_cvt_pk_bf16_f32 v28, v20, v21
    v_cvt_pk_bf16_f32 v29, v22, v23
    s_waitcnt lgkmcnt(2)
    v_mfma_f32_16x16x32_f16 v[24:27], v[92:95], v[52:55], v[24:27]
    v_min_u32 v28, -2, v28
    v_min_u32 v29, -2, v29
    s_waitcnt lgkmcnt(0)
    v_mfma_f32_16x16x32_f16 v[24:27], v[96:99], v[120:123], v[24:27]
    ds_read_u8 v18, v14 offset:115
    ds_read_b128 v[20:23], v12 offset:49664
    s_nop 5
    v_mul_f32 v24, v24, v16
    v_mul_f32 v25, v25, v16
    v_mul_f32 v26, v26, v16
    v_mul_f32 v27, v27, v16
    v_cvt_pk_bf16_f32 v24, 0, v24
    v_cvt_pk_bf16_f32 v25, 0, v25
    v_cvt_pk_bf16_f32 v26, 0, v26
    v_cvt_pk_bf16_f32 v27, 0, v27
    v_add_f32 v24, v24, v124
    v_add_f32 v25, v25, v125
    v_add_f32 v26, v26, v126
    v_add_f32 v27, v27, v127
    v_cvt_pk_bf16_f32 v30, v24, v25
    v_cvt_pk_bf16_f32 v31, v26, v27
    v_min_u32 v30, -2, v30
    v_min_u32 v31, -2, v31
CVE_32:
    s_waitcnt lgkmcnt(0)
    s_cmp_lg_u32 s87, 1
    s_cbranch_scc1 ZA_43
    v_cmp_ne_u32 vcc, 1, v18
    s_cbranch_vccnz ZS_45
ZB_46:
    s_mov_b64 exec, s[12:13]
    v_swap_b32 v28, v20
    v_swap_b32 v29, v21
    v_swap_b32 v30, v22
    v_swap_b32 v31, v23
    s_mov_b64 exec, -1
    buffer_store_dwordx4 v[28:31], v6, s[64:67], s7 offen sc1
    buffer_store_dwordx4 v[20:23], v6, s[64:67], s6 offen sc1
    s_branch ZD_48
WS_35:
W_49:
    ds_read_b32 v18, v14 offset:76
    s_sub_u32 s39, s39, 1
    s_cbranch_scc1 KS_ABORT
    s_waitcnt lgkmcnt(0)
    v_cmp_ne_u32 vcc, s84, v18
    s_cbranch_vccnz W_49
    s_branch WB_36
WS_38:
W_50:
    ds_read_b32 v18, v14 offset:76
    s_sub_u32 s39, s39, 1
    s_cbranch_scc1 KS_ABORT
    s_waitcnt lgkmcnt(0)
    v_cmp_ne_u32 vcc, s84, v18
    s_cbranch_vccnz W_50
    s_branch WB_39
WS_41:
W_51:
    ds_read_b32 v18, v14 offset:76
    s_sub_u32 s39, s39, 1
    s_cbranch_scc1 KS_ABORT
    s_waitcnt lgkmcnt(0)
    v_cmp_ne_u32 vcc, s84, v18
    s_cbranch_vccnz W_51
    s_branch WB_42
ZS_45:
    v_mov_b32 v19, s86
ZW_52:
    ds_read_u8 v18, v19 offset:128
    s_sub_u32 s39, s39, 1
    s_cbranch_scc1 KS_ABORT
    s_waitcnt lgkmcnt(0)
    v_cmp_ne_u32 vcc, 1, v18
    s_cbranch_vccnz ZW_52
    v_lshl_add_u32 v19, v19, 10, v12
    ds_read_b128 v[20:23], v19 offset:46592
    s_waitcnt lgkmcnt(0)
    s_branch ZB_46
ZA_43:
    v_cmp_eq_u32 vcc, 1, v18
    s_cbranch_vccnz KS_CLK
W_53:
    ds_read_b32 v18, v4 offset:112
    s_sub_u32 s39, s39, 1
    s_cbranch_scc1 KS_ABORT
    s_waitcnt lgkmcnt(0)
    v_cmp_ne_u32 vcc, s84, v18
    s_cbranch_vccnz W_53
KS_CLK:
    s_cmp_lg_u32 s87, 0
    s_cbranch_scc1 ZC_44
    v_mov_b32 v19, s86
    v_lshl_add_u32 v18, v19, 10, v12
    ds_write_b128 v18, v[28:31] offset:46592
    ds_write_b8 v19, v5 offset:128
    s_branch ZD_48
ZC_44:
    buffer_store_dwordx4 v[28:31], v6, s[64:67], s6 offen sc1
ZD_48:
    s_lshl_b32 s92, s87, 2
    s_add_u32 s92, s92, s86
    v_mov_b32 v8, s92
    s_waitcnt vmcnt(0)
    ds_write_b8 v8, v5 offset:48
    s_branch KS_K1
    s_cmp_lg_u32 s38, 4
    s_cbranch_scc1 KS_K1
    s_setprio 0
    s_add_u32 s76, s36, 0x840000
    s_addc_u32 s77, s37, 0
    s_mov_b32 s78, 0x4000
    s_mov_b32 s79, 0x20000
    v_and_b32 v6, 1, v1
    v_lshlrev_b32 v6, 4, v6
    s_lshl_b32 s92, s90, 5
W_54:
    s_sleep 1
    ds_read_b32 v8, v4 offset:20
    s_sub_u32 s39, s39, 1
    s_cbranch_scc1 KS_ABORT
    s_waitcnt lgkmcnt(0)
    v_cmp_ne_u32 vcc, s84, v8
    s_cbranch_vccnz W_54
    s_mov_b64 exec, 3
    s_setprio 1
KS_K0:
    ds_read_b128 v[8:11], v6 offset:800
    s_sub_u32 s39, s39, 1
    s_cbranch_scc1 KS_ABORT
    s_waitcnt lgkmcnt(0)
    v_min3_u32 v12, v8, v9, v10
    v_min_u32 v12, v12, v11
    v_cmp_eq_u32 vcc, 0, v12
    s_cbranch_vccnz KS_K0
    buffer_store_dwordx4 v[8:11], v6, s[76:79], s92 offen sc1
    s_mov_b64 exec, -1
    s_waitcnt vmcnt(0)
    ds_write_b32 v4, v5 offset:24
KS_K1:
    s_cmp_lt_u32 s41, 18
    s_cbranch_scc1 KS_T
    s_waitcnt lgkmcnt(0)
    s_endpgm
KS_X:
    s_cmp_lt_u32 s41, 24
    s_cbranch_scc1 KS_X2
    s_setprio 2
KS_XC:
    s_mov_b32 s87, 2
    s_add_u32 s86, s38, 3
    s_and_b32 s86, s86, 3
    s_lshl_b32 s88, s40, 3
    s_and_b32 s92, s41, 7
    s_add_u32 s88, s88, s92
    s_add_u32 s88, s88, 512
    s_lshl_b32 s92, s86, 11
    s_add_u32 s92, s92, 146048
    v_lshl_add_u32 v28, v1, 3, s92
    s_branch KS_GRP
KS_X2:
    s_cmp_lt_u32 s41, 8
    s_cbranch_scc1 KS_X3
    s_sub_u32 s97, s38, 8
    s_branch KS_LN1
KS_X3:
    s_lshl_b32 s92, s2, 4
    s_add_u32 s92, s92, s38
    s_cmp_lg_u32 s92, 44
    s_cbranch_scc1 KS_X3B
    s_setprio 3
    s_memrealtime s[92:93]
    v_and_b32 v6, 3, v1
    v_lshlrev_b32 v7, 2, v6
    v_min_u32 v6, 2, v6
    v_lshlrev_b32 v6, 2, v6
    v_cmp_eq_u32 vcc, 3, v1
    s_waitcnt lgkmcnt(0)
    v_mov_b32 v8, s92
    v_mov_b32 v9, s93
    v_alignbit_b32 v8, v8, v8, v6
    v_cndmask_b32 v9, v4, v9, vcc
    v_xor_b32 v8, v8, v9
    v_and_b32 v9, 0xf0000fff, v8
    v_and_b32 v10, 0xfff000, v8
    v_lshl_or_b32 v9, v10, 4, v9
    v_lshrrev_b32 v10, 12, v8
    v_and_b32 v10, 0xf000, v10
    v_or3_b32 v9, v9, v10, v9
    v_or_b32 v9, 0x80000000, v9
    s_mov_b64 exec, 15
    global_store_dword v7, v9, s[34:35] sc1
    s_mov_b64 exec, -1
    s_setprio 0
KS_X3B:
    s_setprio 3
    s_branch KS_XC
    s_waitcnt lgkmcnt(0)
    s_barrier
    s_branch KS_G
KS_X4:
    s_setprio 0
    s_cmp_lt_u32 s41, 18
    s_cbranch_scc1 KS_GN
    v_mul_u32_u24 v46, 57, v1
    v_lshrrev_b32 v46, 9, v46
    v_mul_u32_u24 v47, 9, v46
    v_sub_u32 v47, v1, v47
    v_mul_u32_u24 v46, 9216, v46
    v_lshl_add_u32 v46, v47, 7, v46
    s_mul_i32 s94, s38, 6
    s_add_u32 s94, s94, s41
    s_sub_u32 s94, s94, 90
W_55:
    s_sleep 2
    ds_read_b32 v10, v4 offset:200
    s_sub_u32 s39, s39, 1
    s_cbranch_scc1 KS_ABORT
    s_waitcnt lgkmcnt(0)
    v_cmp_ne_u32 vcc, s84, v10
    s_cbranch_vccnz W_55
    s_bitcmp1_b32 s94, 0
    s_cselect_b32 s72, s28, s26
    s_cselect_b32 s73, s29, s27
    s_mov_b32 s74, 0x510000
    s_mov_b32 s75, 0x20000
    s_lshr_b32 s95, s94, 1
    s_mul_i32 s95, s95, 64512
    s_mul_i32 s96, s40, 1152
    s_add_u32 s95, s95, s96
    s_add_u32 s96, s95, 2644992
    buffer_load_dword v47, v46, s[72:75], s96 offen nt
    buffer_load_dword v47, v46, s[72:75], s96 offen sc1
KS_XPE:
    s_waitcnt vmcnt(0) lgkmcnt(0)
    s_endpgm
KS_L:
    v_lshlrev_b32 v6, 2, v0
    ds_write_b32 v6, v4
    v_mov_b32 v8, 0
    v_mov_b32 v9, 0
    s_min_u32 s92, s38, 2
    s_mul_i32 s92, s92, 4672
    v_min_u32 v6, 59, v1
    v_lshl_add_u32 v6, v6, 3, s92
    ds_write_b64 v6, v[8:9] offset:3072
    s_mov_b32 s97, s38
    s_sub_u32 s92, s41, 8
    s_cmp_lt_u32 s92, 16
    s_cbranch_scc0 KS_L0
KS_LN1:
    s_setprio 3
    s_sub_u32 s92, s41, 8
    s_and_b32 s88, s92, 7
    s_lshr_b32 s92, s92, 3
    s_lshl_b32 s92, s92, 4
    s_add_u32 s88, s88, s92
    s_and_b32 s92, s40, 1
    s_lshl_b32 s92, s92, 3
    s_add_u32 s88, s88, s92
    s_lshr_b32 s92, s40, 1
    s_lshl_b32 s92, s92, 5
    s_add_u32 s88, s88, s92
    v_lshrrev_b32 v36, 5, v1
    v_and_b32 v37, 31, v1
    v_mul_u32_u24 v38, 9216, v36
    v_lshl_add_u32 v39, v37, 2, v38
    v_lshl_add_u32 v38, v37, 4, v38
    s_mul_i32 s93, s88, 18432
    s_mul_i32 s94, s97, 1152
    s_add_u32 s93, s93, s94
    s_mov_b32 s66, 0x240000
    s_mov_b32 s67, 0x20000
    s_waitcnt lgkmcnt(0)
    s_mov_b32 s64, s4
    s_mov_b32 s65, s5
    buffer_load_dwordx4 v[26:29], v38, s[64:67], s93 offen
    buffer_load_dwordx4 v[30:33], v38, s[64:67], s93 offen offset:512
    buffer_load_dword v34, v39, s[64:67], s93 offen offset:1024
    s_barrier
    s_mul_i32 s94, s97, 2368
    s_add_u32 s94, s94, 16576
    v_lshl_add_u32 v6, v37, 1, v36
    v_lshl_add_u32 v6, v6, 2, s94
    v_and_b32 v59, 3, v1
    v_bfe_u32 v7, v1, 2, 2
    v_mul_u32_u24 v7, 2368, v7
    v_lshl_add_u32 v40, v3, 2, v59
    v_lshl_add_u32 v7, v40, 3, v7
    s_lshl_b32 s94, s97, 7
    s_add_u32 s92, s94, 18624
    v_add_u32 v44, s92, v7
    s_lshl_b32 s94, s97, 8
    s_add_u32 s94, s94, 16576
    v_add_u32 v7, s94, v7
    v_lshlrev_b32 v41, 4, v59
    s_nop 1
    v_mov_b32_dpp v40, v41 quad_perm:[0,2,1,3] row_mask:0xf bank_mask:0xf
    v_lshlrev_b32 v59, 2, v59
    v_lshrrev_b32 v41, 2, v1
    v_mul_u32_u24 v35, 0x8200, v41
    s_lshl_b32 s92, s88, 6
    s_and_b32 s93, s92, 0x1e00
    v_xad_u32 v35, v35, s93, v40
    s_lshl_b32 s93, s97, 4
    v_add_u32 v41, s93, v41
    v_mul_u32_u24 v45, 0x2080, v41
    v_xad_u32 v45, v45, s92, v40
    s_and_b32 s93, s97, 3
    s_mul_i32 s93, s93, 0x2080
    s_and_b32 s92, s92, 0x1c0
    s_xor_b32 s83, s92, s93
    s_lshr_b32 s93, s97, 2
    s_lshl_b32 s93, s93, 20
    s_add_u32 s83, s83, s93
    s_add_u32 s96, s83, 0x80000
    s_mov_b32 s80, 0x3f80
    s_mov_b32 s81, 0x3f800000
    s_mov_b32 s82, 0x3f803f80
    s_mov_b32 s98, 0x70007
    s_mov_b32 s99, 0x200000
    v_mov_b32 v40, 0
    v_mov_b32 v41, 0
    v_mov_b32 v42, 0x3ae38e39
    s_mov_b32 s72, s36
    s_mov_b32 s73, s37
    s_mov_b32 s74, 0x240000
    s_mov_b32 s75, 0x20000
    s_cmp_lt_u32 s97, 4
    s_cbranch_scc1 LN1A_56
    s_cmp_ge_u32 s41, 18
    s_cbranch_scc1 LN1A_56
    s_mov_b32 s68, s30
    s_mov_b32 s69, s31
    s_mov_b32 s70, 0x510000
    s_mov_b32 s71, 0x20000
    v_lshlrev_b32 v46, 4, v1
    s_mul_i32 s92, s89, 36864
    s_mul_i32 s93, s97, 9216
    s_add_u32 s92, s92, s93
    s_sub_u32 s92, s92, 36864
    s_add_u32 s93, s93, 72320
    s_add_u32 m0, s93, 0
    s_nop 0
    buffer_load_dwordx4 v46, s[68:71], s92 offen offset:0 nt lds
    buffer_load_dwordx4 v46, s[68:71], s92 offen offset:1024 nt lds
    buffer_load_dwordx4 v46, s[68:71], s92 offen offset:2048 nt lds
    buffer_load_dwordx4 v46, s[68:71], s92 offen offset:3072 nt lds
    s_add_u32 m0, s93, 4096
    s_add_u32 s92, s92, 4096
    buffer_load_dwordx4 v46, s[68:71], s92 offen offset:0 nt lds
    buffer_load_dwordx4 v46, s[68:71], s92 offen offset:1024 nt lds
    buffer_load_dwordx4 v46, s[68:71], s92 offen offset:2048 nt lds
    buffer_load_dwordx4 v46, s[68:71], s92 offen offset:3072 nt lds
    s_add_u32 m0, s93, 8192
    s_add_u32 s92, s92, 4096
    buffer_load_dwordx4 v46, s[68:71], s92 offen offset:0 nt lds
    s_waitcnt vmcnt(11)
    v_dot2c_f32_bf16 v40, s82, v26
    v_dot2c_f32_bf16 v41, v26, v26
    v_dot2c_f32_bf16 v40, s82, v27
    v_dot2c_f32_bf16 v41, v27, v27
    v_dot2c_f32_bf16 v40, s82, v28
    v_dot2c_f32_bf16 v41, v28, v28
    v_dot2c_f32_bf16 v40, s82, v29
    v_dot2c_f32_bf16 v41, v29, v29
    s_waitcnt vmcnt(10)
    v_dot2c_f32_bf16 v40, s82, v30
    v_dot2c_f32_bf16 v41, v30, v30
    v_dot2c_f32_bf16 v40, s82, v31
    v_dot2c_f32_bf16 v41, v31, v31
    v_dot2c_f32_bf16 v40, s82, v32
    v_dot2c_f32_bf16 v41, v32, v32
    v_dot2c_f32_bf16 v40, s82, v33
    v_dot2c_f32_bf16 v41, v33, v33
    s_waitcnt vmcnt(9)
    v_dot2c_f32_bf16 v40, s82, v34
    v_dot2c_f32_bf16 v41, v34, v34
    s_branch LN1B_57
LN1A_56:
    s_waitcnt vmcnt(2)
    v_dot2c_f32_bf16 v40, s82, v26
    v_dot2c_f32_bf16 v41, v26, v26
    v_dot2c_f32_bf16 v40, s82, v27
    v_dot2c_f32_bf16 v41, v27, v27
    v_dot2c_f32_bf16 v40, s82, v28
    v_dot2c_f32_bf16 v41, v28, v28
    v_dot2c_f32_bf16 v40, s82, v29
    v_dot2c_f32_bf16 v41, v29, v29
    s_waitcnt vmcnt(1)
    v_dot2c_f32_bf16 v40, s82, v30
    v_dot2c_f32_bf16 v41, v30, v30
    v_dot2c_f32_bf16 v40, s82, v31
    v_dot2c_f32_bf16 v41, v31, v31
    v_dot2c_f32_bf16 v40, s82, v32
    v_dot2c_f32_bf16 v41, v32, v32
    v_dot2c_f32_bf16 v40, s82, v33
    v_dot2c_f32_bf16 v41, v33, v33
    s_waitcnt vmcnt(0)
    v_dot2c_f32_bf16 v40, s82, v34
    v_dot2c_f32_bf16 v41, v34, v34
LN1B_57:
    s_nop 1
    v_add_f32_dpp v36, v40, v40 row_ror:8 row_mask:0xf bank_mask:0x3
    v_add_f32_dpp v36, v41, v41 row_ror:8 row_mask:0xf bank_mask:0xc
    s_nop 1
    v_add_f32_dpp v36, v36, v36 row_half_mirror row_mask:0xf bank_mask:0xf
    s_nop 1
    v_add_f32_dpp v36, v36, v36 quad_perm:[1,0,3,2] row_mask:0xf bank_mask:0xf
    s_nop 1
    v_add_f32_dpp v36, v36, v36 quad_perm:[2,3,0,1] row_mask:0xf bank_mask:0xf
    v_mov_b32 v37, v36
    s_nop 1
    v_permlane16_swap_b32 v36, v37
    v_add_f32 v36, v36, v37
    s_nop 1
    v_mul_f32_dpp v40, v36, v42 row_newbcast:0 row_mask:0xf bank_mask:0xf
    v_mul_f32_dpp v41, v36, v42 row_newbcast:8 row_mask:0xf bank_mask:0xf
    v_cvt_pk_bf16_f32 v36, 0, -v40
    v_fma_f32 v41, -v40, v40, v41
    v_dot2_f32_bf16 v8, v26, s80, v36
    v_dot2_f32_bf16 v9, v26, s81, v36
    v_max_f32 v41, 0, v41
    v_dot2_f32_bf16 v10, v27, s80, v36
    v_dot2_f32_bf16 v11, v27, s81, v36
    v_cvt_pk_bf16_f32 v41, 0, v41
    v_dot2_f32_bf16 v12, v28, s80, v36
    v_dot2_f32_bf16 v13, v28, s81, v36
    v_add_f32 v41, 0x3727c5ac, v41
    v_cvt_pk_bf16_f32 v8, 0, v8
    v_cvt_pk_bf16_f32 v9, 0, v9
    v_dot2_f32_bf16 v14, v29, s80, v36
    v_dot2_f32_bf16 v15, v29, s81, v36
    v_cvt_pk_bf16_f32 v41, 0, v41
    v_cvt_pk_bf16_f32 v10, 0, v10
    v_cvt_pk_bf16_f32 v11, 0, v11
    v_dot2_f32_bf16 v16, v30, s80, v36
    v_dot2_f32_bf16 v17, v30, s81, v36
    v_sqrt_f32 v41, v41
    v_cvt_pk_bf16_f32 v12, 0, v12
    v_cvt_pk_bf16_f32 v13, 0, v13
    v_dot2_f32_bf16 v18, v31, s80, v36
    v_dot2_f32_bf16 v19, v31, s81, v36
    v_cvt_pk_bf16_f32 v41, 0, v41
    v_cvt_pk_bf16_f32 v14, 0, v14
    v_cvt_pk_bf16_f32 v15, 0, v15
    v_dot2_f32_bf16 v20, v32, s80, v36
    v_dot2_f32_bf16 v21, v32, s81, v36
    v_rcp_f32 v38, v41
    v_cvt_pk_bf16_f32 v16, 0, v16
    v_cvt_pk_bf16_f32 v17, 0, v17
    v_dot2_f32_bf16 v22, v33, s80, v36
    v_dot2_f32_bf16 v23, v33, s81, v36
    v_cvt_pk_bf16_f32 v18, 0, v18
    v_cvt_pk_bf16_f32 v19, 0, v19
    v_dot2_f32_bf16 v24, v34, s80, v36
    v_dot2_f32_bf16 v25, v34, s81, v36
    v_cvt_pk_bf16_f32 v20, 0, v20
    v_cvt_pk_bf16_f32 v21, 0, v21
    v_cvt_pk_bf16_f32 v22, 0, v22
    v_cvt_pk_bf16_f32 v23, 0, v23
    v_pk_mul_f32 v[8:9], v[8:9], v[38:39] op_sel_hi:[1,0]
    v_cvt_pkrtz_f16_f32 v26, v8, v9
    v_add_u32 v26, 0x40004, v26
    v_cvt_pk_bf16_f32 v24, 0, v24
    v_cvt_pk_bf16_f32 v25, 0, v25
    v_pk_mul_f32 v[10:11], v[10:11], v[38:39] op_sel_hi:[1,0]
    v_cvt_pkrtz_f16_f32 v27, v10, v11
    v_add_u32 v27, 0x40004, v27
    ds_write2st64_b32 v6, v26, v27 offset0:0 offset1:1
    v_pk_mul_f32 v[12:13], v[12:13], v[38:39] op_sel_hi:[1,0]
    v_cvt_pkrtz_f16_f32 v28, v12, v13
    v_add_u32 v28, 0x40004, v28
    s_load_dwordx4 s[76:79], s[34:35], 0
    v_pk_mul_f32 v[14:15], v[14:15], v[38:39] op_sel_hi:[1,0]
    v_cvt_pkrtz_f16_f32 v29, v14, v15
    v_add_u32 v29, 0x40004, v29
    ds_write2st64_b32 v6, v28, v29 offset0:2 offset1:3
    v_pk_mul_f32 v[16:17], v[16:17], v[38:39] op_sel_hi:[1,0]
    v_cvt_pkrtz_f16_f32 v30, v16, v17
    v_add_u32 v30, 0x40004, v30
    v_pk_mul_f32 v[18:19], v[18:19], v[38:39] op_sel_hi:[1,0]
    v_cvt_pkrtz_f16_f32 v31, v18, v19
    v_add_u32 v31, 0x40004, v31
    ds_write2st64_b32 v6, v30, v31 offset0:4 offset1:5
    v_pk_mul_f32 v[20:21], v[20:21], v[38:39] op_sel_hi:[1,0]
    v_cvt_pkrtz_f16_f32 v32, v20, v21
    v_add_u32 v32, 0x40004, v32
    v_pk_mul_f32 v[22:23], v[22:23], v[38:39] op_sel_hi:[1,0]
    v_cvt_pkrtz_f16_f32 v33, v22, v23
    v_add_u32 v33, 0x40004, v33
    ds_write2st64_b32 v6, v32, v33 offset0:6 offset1:7
    v_pk_mul_f32 v[24:25], v[24:25], v[38:39] op_sel_hi:[1,0]
    v_cvt_pkrtz_f16_f32 v34, v24, v25
    v_add_u32 v34, 0x40004, v34
    ds_write_b32 v6, v34 offset:2048
    v_mov_b32 v6, s97
    ds_write_b8 v6, v5 offset:0
    s_waitcnt lgkmcnt(0)
    v_mov_b32 v58, s76
    v_mov_b32 v57, s77
    v_mov_b32 v56, s78
    v_mov_b32 v55, s79
    v_cmp_eq_u32 vcc, 4, v59
    s_nop 1
    v_cndmask_b32 v58, v58, v57, vcc
    v_cmp_eq_u32 vcc, 12, v59
    s_nop 1
    v_cndmask_b32 v56, v56, v55, vcc
    v_cmp_lt_u32 vcc, 4, v59
    s_nop 1
    v_cndmask_b32 v58, v58, v56, vcc
    s_waitcnt vmcnt(63)
DBP_58:
    v_cmp_eq_u32 vcc, 0, v58
    s_cbranch_vccz DBG_59
    s_sleep 1
    global_load_dword v58, v59, s[34:35] sc1
    s_sub_u32 s39, s39, 1
    s_cbranch_scc1 KS_ABORT
    s_waitcnt vmcnt(0)
    s_branch DBP_58
DBG_59:
    v_mov_b32_dpp v40, v58 quad_perm:[0,2,1,3] row_mask:0xf bank_mask:0xf
    v_lshrrev_b32 v41, 3, v40
    v_lshrrev_b32 v42, 6, v40
    v_lshrrev_b32 v43, 9, v40
W_60:
    ds_read_b64 v[20:21], v4 offset:0
    s_sub_u32 s39, s39, 1
    s_cbranch_scc1 KS_ABORT
    s_waitcnt lgkmcnt(0)
    v_and_b32 v20, v20, v21
    v_cmp_ne_u32 vcc, s84, v20
    s_cbranch_vccnz W_60
    ds_read_b64_tr_b16 v[20:21], v7 offset:0
    ds_read_b64_tr_b16 v[22:23], v7 offset:9472
    ds_read_b64_tr_b16 v[24:25], v7 offset:128
    ds_read_b64_tr_b16 v[26:27], v7 offset:9600
    ds_read_b64_tr_b16 v[28:29], v44 offset:0
    ds_read_b64_tr_b16 v[30:31], v44 offset:9472
    s_waitcnt lgkmcnt(4)
    v_bfi_b32 v20, s98, v40, v20
    v_bfi_b32 v21, s98, v41, v21
    v_bfi_b32 v22, s98, v42, v22
    v_bfi_b32 v23, s98, v43, v23
    buffer_store_dwordx4 v[20:23], v35, s[72:75], s83 offen sc1
    s_waitcnt lgkmcnt(2)
    v_bfi_b32 v24, s98, v40, v24
    v_bfi_b32 v25, s98, v41, v25
    v_bfi_b32 v26, s98, v42, v26
    v_bfi_b32 v27, s98, v43, v27
    buffer_store_dwordx4 v[24:27], v35, s[72:75], s96 offen sc1
    s_waitcnt lgkmcnt(0)
    s_cmp_ge_u32 s97, 4
    s_cbranch_scc1 KS_X4
    v_bfi_b32 v28, s98, v40, v28
    v_bfi_b32 v29, s98, v41, v29
    v_bfi_b32 v30, s98, v42, v30
    v_bfi_b32 v31, s98, v43, v31
    buffer_store_dwordx4 v[28:31], v45, s[72:75], s99 offen sc1
    ds_write_b8 v6, v5 offset:200
    ds_write_b32 v59, v58 offset:224
    v_lshrrev_b32 v57, 3, v58
    v_lshrrev_b32 v56, 6, v58
    v_lshrrev_b32 v55, 9, v58
    s_mov_b32 s87, 1
    s_branch KS_L2B
KS_L0:
    s_and_b32 s92, s41, 15
    s_lshl_b32 s93, s40, 4
    s_add_u32 s92, s92, s93
    v_and_b32 v59, 3, v1
    v_lshlrev_b32 v59, 2, v59
    s_lshl_b32 s96, s92, 6
    s_add_u32 s93, s96, 0xb00000
    v_add_u32 v7, s93, v59
    s_mul_i32 s93, s92, 18560
    s_add_u32 s93, s93, 0x600000
    v_lshlrev_b32 v6, 4, v0
    v_mov_b32 v12, -1
    v_mov_b32 v13, -1
    v_mov_b32 v14, -1
    v_mov_b32 v15, -1
    s_setprio 3
    v_mul_u32_u24 v16, 57, v1
    v_lshrrev_b32 v16, 9, v16
    v_mul_u32_u24 v17, 9, v16
    v_sub_u32 v17, v1, v17
    v_mul_u32_u24 v16, 9216, v16
    v_lshl_add_u32 v16, v17, 7, v16
    s_waitcnt lgkmcnt(0)
    s_add_u32 s68, s36, s93
    s_addc_u32 s69, s37, 0
    s_mov_b32 s70, 18560
    s_mov_b32 s71, 0x20000
    s_barrier
W_61:
    s_sleep 2
    ds_read_b32 v8, v4 offset:36
    s_sub_u32 s39, s39, 1
    s_cbranch_scc1 KS_ABORT
    s_waitcnt lgkmcnt(0)
    v_cmp_eq_u32 vcc, 0, v8
    s_cbranch_vccnz W_61
    s_mov_b32 s92, 0
    buffer_store_dwordx4 v[12:15], v6, s[68:71], s92 offen sc1
    s_mov_b32 s92, 4096
    buffer_store_dwordx4 v[12:15], v6, s[68:71], s92 offen sc1
    s_mov_b32 s92, 8192
    buffer_store_dwordx4 v[12:15], v6, s[68:71], s92 offen sc1
    s_mov_b32 s92, 12288
    buffer_store_dwordx4 v[12:15], v6, s[68:71], s92 offen sc1
    s_mov_b32 s92, 16384
    buffer_store_dwordx4 v[12:15], v6, s[68:71], s92 offen sc1
    global_load_dword v58, v59, s[34:35] sc1
    s_and_b32 s94, s41, 7
    s_lshl_b32 s95, s38, 3
    s_add_u32 s94, s94, s95
    s_bitcmp1_b32 s94, 0
    s_cselect_b32 s72, s28, s26
    s_cselect_b32 s73, s29, s27
    s_mov_b32 s74, 0x510000
    s_mov_b32 s75, 0x20000
    s_lshr_b32 s95, s94, 1
    s_mul_i32 s95, s95, 64512
    s_mul_i32 s96, s40, 1152
    s_add_u32 s95, s95, s96
    s_cmp_lt_u32 s41, 24
    s_cselect_b32 s74, 0, s74
    s_add_u32 s96, s95, 3419136
    s_cmp_ge_u32 s38, 4
    s_cselect_b32 s74, 0, s74
    buffer_load_dword v18, v16, s[72:75], s96 offen nt
    buffer_load_dword v18, v16, s[72:75], s96 offen sc1
    s_waitcnt vmcnt(2)
DBP_62:
    v_cmp_eq_u32 vcc, 0, v58
    s_cbranch_vccz DBG_63
    s_sleep 1
    global_load_dword v58, v59, s[34:35] sc1
    s_sub_u32 s39, s39, 1
    s_cbranch_scc1 KS_ABORT
    s_waitcnt vmcnt(0)
    s_branch DBP_62
DBG_63:
    ds_write_b32 v59, v58 offset:224
    s_mov_b64 exec, 1
    ds_add_rtn_u32 v8, v4, v5 offset:8
    s_mov_b64 exec, -1
    v_lshrrev_b32 v57, 3, v58
    v_lshrrev_b32 v56, 6, v58
    v_lshrrev_b32 v55, 9, v58
    s_waitcnt lgkmcnt(0)
    v_readfirstlane_b32 s92, v8
    s_cmp_lg_u32 s92, 3
    s_cbranch_scc1 KS_L2
    s_mov_b64 exec, 15
    global_store_dword v7, v58, s[36:37] sc1
    s_mov_b64 exec, -1
    s_and_b32 s94, s41, 7
    s_cmp_ge_u32 s41, 8
    s_cbranch_scc1 KS_L1C
    s_branch KS_L2
KS_L1C:
KS_L2:
    s_mov_b32 s87, 0
KS_L2B:
    s_mov_b32 s64, s36
    s_mov_b32 s65, s37
    s_mov_b32 s66, 0x240000
    s_mov_b32 s67, 0x20000
    v_lshrrev_b32 v7, 1, v1
    v_lshlrev_b32 v7, 6, v7
    v_and_b32 v10, 1, v1
    v_lshl_add_u32 v7, v10, 4, v7
    v_lshlrev_b32 v9, 4, v1
    s_lshl_b32 s92, s38, 11
    s_lshl_b32 s93, s90, 13
    s_add_u32 s93, s93, s92
    s_lshl_b32 s94, s90, 7
    s_and_b32 s95, s94, 0x380
    v_xor_b32 v13, s95, v9
    s_and_b32 s94, s94, 0x1c00
    s_xor_b32 s93, s93, s94
    s_xor_b32 s97, s93, 0x400
    s_lshl_b32 s95, s40, 3
    s_add_u32 s95, s95, s41
    s_add_u32 s95, s95, 488
    s_lshr_b32 s96, s95, 1
    s_lshl_b32 s96, s96, 13
    s_and_b32 s95, s95, 1
    s_lshl_b32 s95, s95, 5
    s_add_u32 s95, s95, s96
    s_add_u32 s95, s95, s92
    s_lshr_b32 s96, s96, 6
    s_and_b32 s94, s96, 0x780
    v_xor_b32 v7, s94, v7
    s_and_b32 s96, s96, 0x1800
    s_xor_b32 s95, s95, s96
    s_cmp_lt_u32 s41, 24
    s_cselect_b32 s95, 2359296, s95
    s_cselect_b32 s94, 0, 0x70007
    v_mov_b32_dpp v64, v58 quad_perm:[0,1,0,1] row_mask:0xf bank_mask:0xf
    v_mov_b32_dpp v65, v58 quad_perm:[2,3,2,3] row_mask:0xf bank_mask:0xf
    s_bitcmp1_b32 s41, 0
    s_cselect_b64 vcc, -1, 0
    v_cndmask_b32 v64, v64, v65, vcc
    v_and_b32 v60, 0x70007, v58
    v_and_b32 v61, 0x70007, v57
    v_and_b32 v62, 0x70007, v56
    v_and_b32 v63, 0x70007, v55
    v_lshrrev_b32 v67, 9, v64
    v_lshrrev_b32 v66, 6, v64
    v_lshrrev_b32 v65, 3, v64
    v_and_b32 v64, s94, v64
    v_and_b32 v65, s94, v65
    v_and_b32 v66, s94, v66
    v_and_b32 v67, s94, v67
    s_lshl_b32 s96, s38, 10
    s_add_u32 s96, s96, 3552
    v_bfe_u32 v11, v1, 1, 1
    v_mul_u32_u24 v11, 4672, v11
    v_lshl_add_u32 v11, v10, 4, v11
    v_lshrrev_b32 v10, 2, v1
    v_lshl_add_u32 v11, v10, 5, v11
    v_add_u32 v11, s96, v11
    v_add_u32 v10, s96, v9
    v_mov_b32 v116, s38
    s_add_u32 s92, s92, 0xb00000
    v_lshrrev_b32 v12, 2, v1
    v_lshl_add_u32 v12, v12, 6, v59
    v_add_u32 v12, s92, v12
    s_cmp_lt_u32 s41, 8
    s_cselect_b32 s94, 8, 8
    s_cmp_ge_u32 s41, 24
    s_cselect_b32 s94, 20, s94
    v_mov_b32 v14, s94
    s_setprio 0
    ds_write_b8 v116, v5 offset:204
W_64:
    s_sleep 2
    ds_read_b32 v8, v14 offset:64
    s_sub_u32 s39, s39, 1
    s_cbranch_scc1 KS_ABORT
    s_waitcnt lgkmcnt(0)
    v_cmp_ne_u32 vcc, s84, v8
    s_cbranch_vccnz W_64
    s_setprio 3
    s_branch UPE_66
UP_65:
    s_sleep 2
UPE_66:
    buffer_load_dwordx4 v[20:23], v13, s[64:67], s93 offen sc1
    buffer_load_dwordx4 v[24:27], v13, s[64:67], s97 offen sc1
    buffer_load_dwordx4 v[28:31], v7, s[64:67], s95 offen sc1
    s_sub_u32 s39, s39, 1
    s_cbranch_scc1 KS_ABORT
    s_waitcnt vmcnt(2)
    v_xor_b32 v20, v60, v20
    v_xor_b32 v21, v61, v21
    v_xor_b32 v22, v62, v22
    v_xor_b32 v23, v63, v23
    v_or3_b32 v44, v20, v21, v21
    v_or3_b32 v44, v22, v23, v44
    s_waitcnt vmcnt(1)
    v_xor_b32 v24, v60, v24
    v_xor_b32 v25, v61, v25
    v_xor_b32 v26, v62, v26
    v_xor_b32 v27, v63, v27
    v_or3_b32 v44, v24, v25, v44
    v_or3_b32 v44, v26, v27, v44
    s_waitcnt vmcnt(0)
    v_xor_b32 v28, v64, v28
    v_xor_b32 v29, v65, v29
    v_xor_b32 v30, v66, v30
    v_xor_b32 v31, v67, v31
    v_or3_b32 v44, v28, v29, v44
    v_or3_b32 v44, v30, v31, v44
    v_and_b32 v44, 0x70007, v44
    v_cmp_ne_u32 vcc, 0, v44
    s_cbranch_vccnz UP_65
    ds_write_b128 v11, v[20:23]
    ds_write_b128 v11, v[24:27] offset:512
    ds_write_b128 v10, v[28:31] offset:9344
    ds_write_b8 v116, v5 offset:16
    s_cmp_eq_u32 s38, 2
    s_cbranch_scc1 WJ2_69
    s_add_u32 s92, s38, 1
    s_lshr_b32 s92, s92, 2
    s_cmp_eq_u32 s38, 1
    s_cselect_b32 s92, 2, s92
    s_lshl_b32 s92, s92, 10
    v_lshl_add_u32 v10, v1, 4, s92
    v_add_u32 v11, 35840, v10
W_70:
    ds_read_b32 v12, v4 offset:16
    s_sub_u32 s39, s39, 1
    s_cbranch_scc1 KS_ABORT
    s_waitcnt lgkmcnt(0)
    v_cmp_ne_u32 vcc, s84, v12
    s_cbranch_vccnz W_70
    s_setprio 3
    ds_read_b128 v[20:23], v10 offset:3520
    ds_read_b128 v[24:27], v10 offset:3536
    ds_read_b64 v[28:29], v10 offset:3552
    ds_read_b128 v[32:35], v10 offset:8192
    ds_read_b128 v[36:39], v10 offset:8208
    ds_read_b64 v[40:41], v10 offset:8224
    ds_read_b128 v[44:47], v10 offset:12864
    ds_read_b128 v[48:51], v10 offset:12880
    ds_read_b64 v[52:53], v10 offset:12896
    s_cmp_eq_u32 s38, 1
    s_cbranch_scc1 WJ1_68
    ds_read_b32 v12, v4 offset:68
    s_waitcnt lgkmcnt(7)
    v_alignbit_b32 v57, v22, v21, 16
    v_alignbit_b32 v58, v23, v22, 16
    v_alignbit_b32 v59, v24, v23, 16
    v_alignbit_b32 v60, v25, v24, 16
    v_alignbit_b32 v61, v26, v25, 16
    v_alignbit_b32 v62, v27, v26, 16
    v_alignbit_b32 v63, v28, v27, 16
    v_alignbit_b32 v64, v29, v28, 16
    v_pk_add_f16 v66, v57, v22
    v_pk_add_f16 v67, v58, v23
    v_pk_add_f16 v68, v59, v24
    v_pk_add_f16 v69, v60, v25
    v_pk_add_f16 v70, v61, v26
    v_pk_add_f16 v71, v62, v27
    v_pk_add_f16 v72, v63, v28
    v_pk_add_f16 v73, v64, v29
    v_pk_add_f16 v80, v66, v58
    v_pk_add_f16 v81, v67, v59
    v_pk_add_f16 v82, v68, v60
    v_pk_add_f16 v83, v69, v61
    v_pk_add_f16 v74, v67, v68
    v_pk_add_f16 v75, v68, v69
    v_pk_add_f16 v76, v69, v70
    v_pk_add_f16 v77, v70, v71
    v_pk_add_f16 v78, v71, v72
    v_pk_add_f16 v79, v72, v73
    s_waitcnt lgkmcnt(0)
    v_cmp_eq_u32 vcc, s84, v12
    s_cbranch_vccnz WJK_71
W_72:
    s_sleep 1
    ds_read_b32 v12, v4 offset:68
    s_sub_u32 s39, s39, 1
    s_cbranch_scc1 KS_ABORT
    s_waitcnt lgkmcnt(0)
    v_cmp_ne_u32 vcc, s84, v12
    s_cbranch_vccnz W_72
WJK_71:
    ds_write_b128 v11, v[80:83] offset:0
    v_pk_add_f16 v87, v22, v74
    v_pk_add_f16 v88, v23, v75
    v_pk_add_f16 v89, v24, v76
    v_pk_add_f16 v90, v25, v77
    v_pk_add_f16 v91, v26, v78
    ds_write_b128 v11, v[88:91] offset:3104
    v_pk_add_f16 v84, v70, v62
    v_pk_add_f16 v85, v71, v63
    v_pk_add_f16 v86, v72, v64
    v_pk_add_f16 v92, v74, v83
    v_pk_add_f16 v93, v75, v84
    v_pk_add_f16 v94, v76, v85
    v_pk_add_f16 v95, v77, v86
    ds_write_b128 v11, v[92:95] offset:6176
    v_pk_add_f16 v96, v87, v76
    v_pk_add_f16 v97, v88, v77
    v_pk_add_f16 v98, v89, v78
    v_pk_add_f16 v99, v90, v79
    ds_write_b128 v11, v[96:99] offset:8240
    ds_write_b8 v116, v5 offset:76
    ds_read_b32 v12, v4 offset:84
    v_alignbit_b32 v57, v34, v33, 16
    v_alignbit_b32 v58, v35, v34, 16
    v_alignbit_b32 v59, v36, v35, 16
    v_alignbit_b32 v60, v37, v36, 16
    v_alignbit_b32 v61, v38, v37, 16
    v_alignbit_b32 v62, v39, v38, 16
    v_alignbit_b32 v63, v40, v39, 16
    v_alignbit_b32 v64, v41, v40, 16
    v_pk_add_f16 v66, v57, v34
    v_pk_add_f16 v67, v58, v35
    v_pk_add_f16 v68, v59, v36
    v_pk_add_f16 v69, v60, v37
    v_pk_add_f16 v70, v61, v38
    v_pk_add_f16 v71, v62, v39
    v_pk_add_f16 v72, v63, v40
    v_pk_add_f16 v73, v64, v41
    v_pk_add_f16 v80, v66, v58
    v_pk_add_f16 v81, v67, v59
    v_pk_add_f16 v82, v68, v60
    v_pk_add_f16 v83, v69, v61
    v_pk_add_f16 v74, v67, v68
    v_pk_add_f16 v75, v68, v69
    v_pk_add_f16 v76, v69, v70
    v_pk_add_f16 v77, v70, v71
    v_pk_add_f16 v78, v71, v72
    v_pk_add_f16 v79, v72, v73
    s_waitcnt lgkmcnt(0)
    v_cmp_eq_u32 vcc, s84, v12
    s_cbranch_vccnz WJK_73
W_74:
    s_sleep 1
    ds_read_b32 v12, v4 offset:84
    s_sub_u32 s39, s39, 1
    s_cbranch_scc1 KS_ABORT
    s_waitcnt lgkmcnt(0)
    v_cmp_ne_u32 vcc, s84, v12
    s_cbranch_vccnz W_74
WJK_73:
    ds_write_b128 v11, v[80:83] offset:36672
    v_pk_add_f16 v87, v34, v74
    v_pk_add_f16 v88, v35, v75
    v_pk_add_f16 v89, v36, v76
    v_pk_add_f16 v90, v37, v77
    v_pk_add_f16 v91, v38, v78
    ds_write_b128 v11, v[88:91] offset:39776
    v_pk_add_f16 v84, v70, v62
    v_pk_add_f16 v85, v71, v63
    v_pk_add_f16 v86, v72, v64
    v_pk_add_f16 v92, v74, v83
    v_pk_add_f16 v93, v75, v84
    v_pk_add_f16 v94, v76, v85
    v_pk_add_f16 v95, v77, v86
    ds_write_b128 v11, v[92:95] offset:42848
    v_pk_add_f16 v96, v87, v76
    v_pk_add_f16 v97, v88, v77
    v_pk_add_f16 v98, v89, v78
    v_pk_add_f16 v99, v90, v79
    ds_write_b128 v11, v[96:99] offset:44912
    ds_write_b8 v116, v5 offset:92
    s_cmp_lt_u32 s41, 24
    s_cbranch_scc1 WJE_67
    ds_read_b32 v12, v4 offset:100
    v_alignbit_b32 v57, v46, v45, 16
    v_alignbit_b32 v58, v47, v46, 16
    v_alignbit_b32 v59, v48, v47, 16
    v_alignbit_b32 v60, v49, v48, 16
    v_alignbit_b32 v61, v50, v49, 16
    v_alignbit_b32 v62, v51, v50, 16
    v_alignbit_b32 v63, v52, v51, 16
    v_alignbit_b32 v64, v53, v52, 16
    v_pk_add_f16 v66, v57, v46
    v_pk_add_f16 v67, v58, v47
    v_pk_add_f16 v68, v59, v48
    v_pk_add_f16 v69, v60, v49
    v_pk_add_f16 v70, v61, v50
    v_pk_add_f16 v71, v62, v51
    v_pk_add_f16 v72, v63, v52
    v_pk_add_f16 v73, v64, v53
    v_pk_add_f16 v80, v66, v58
    v_pk_add_f16 v81, v67, v59
    v_pk_add_f16 v82, v68, v60
    v_pk_add_f16 v83, v69, v61
    v_pk_add_f16 v74, v67, v68
    v_pk_add_f16 v75, v68, v69
    v_pk_add_f16 v76, v69, v70
    v_pk_add_f16 v77, v70, v71
    v_pk_add_f16 v78, v71, v72
    v_pk_add_f16 v79, v72, v73
    s_waitcnt lgkmcnt(0)
    v_cmp_eq_u32 vcc, s84, v12
    s_cbranch_vccnz WJK_75
W_76:
    s_sleep 1
    ds_read_b32 v12, v4 offset:100
    s_sub_u32 s39, s39, 1
    s_cbranch_scc1 KS_ABORT
    s_waitcnt lgkmcnt(0)
    v_cmp_ne_u32 vcc, s84, v12
    s_cbranch_vccnz W_76
WJK_75:
    v_add_u32 v11, 73344, v11
    ds_write_b128 v11, v[80:83] offset:0
    v_pk_add_f16 v87, v46, v74
    v_pk_add_f16 v88, v47, v75
    v_pk_add_f16 v89, v48, v76
    v_pk_add_f16 v90, v49, v77
    v_pk_add_f16 v91, v50, v78
    ds_write_b128 v11, v[88:91] offset:3104
    v_pk_add_f16 v84, v70, v62
    v_pk_add_f16 v85, v71, v63
    v_pk_add_f16 v86, v72, v64
    v_pk_add_f16 v92, v74, v83
    v_pk_add_f16 v93, v75, v84
    v_pk_add_f16 v94, v76, v85
    v_pk_add_f16 v95, v77, v86
    ds_write_b128 v11, v[92:95] offset:6176
    v_pk_add_f16 v96, v87, v76
    v_pk_add_f16 v97, v88, v77
    v_pk_add_f16 v98, v89, v78
    v_pk_add_f16 v99, v90, v79
    ds_write_b128 v11, v[96:99] offset:8240
    ds_write_b8 v116, v5 offset:108
    s_branch WJE_67
WJ1_68:
    ds_read_b32 v12, v4 offset:68
    s_waitcnt lgkmcnt(7)
    v_alignbit_b32 v57, v22, v21, 16
    v_alignbit_b32 v58, v23, v22, 16
    v_alignbit_b32 v59, v24, v23, 16
    v_alignbit_b32 v60, v25, v24, 16
    v_alignbit_b32 v61, v26, v25, 16
    v_alignbit_b32 v62, v27, v26, 16
    v_alignbit_b32 v63, v28, v27, 16
    v_pk_add_f16 v66, v57, v22
    v_pk_add_f16 v67, v58, v23
    v_pk_add_f16 v68, v59, v24
    v_pk_add_f16 v69, v60, v25
    v_pk_add_f16 v70, v61, v26
    v_pk_add_f16 v71, v62, v27
    v_pk_add_f16 v72, v63, v28
    v_pk_add_f16 v80, v66, v58
    v_pk_add_f16 v81, v67, v59
    v_pk_add_f16 v82, v68, v60
    v_pk_add_f16 v83, v69, v61
    v_pk_add_f16 v75, v68, v69
    v_pk_add_f16 v76, v69, v70
    v_pk_add_f16 v77, v70, v71
    v_pk_add_f16 v78, v71, v72
    s_waitcnt lgkmcnt(0)
    v_cmp_eq_u32 vcc, s84, v12
    s_cbranch_vccnz WJK_77
W_78:
    s_sleep 1
    ds_read_b32 v12, v4 offset:68
    s_sub_u32 s39, s39, 1
    s_cbranch_scc1 KS_ABORT
    s_waitcnt lgkmcnt(0)
    v_cmp_ne_u32 vcc, s84, v12
    s_cbranch_vccnz W_78
WJK_77:
    ds_write_b128 v11, v[80:83] offset:0
    v_pk_add_f16 v88, v23, v75
    v_pk_add_f16 v89, v24, v76
    v_pk_add_f16 v90, v25, v77
    v_pk_add_f16 v91, v26, v78
    ds_write_b128 v11, v[88:91] offset:3104
    ds_write_b8 v116, v5 offset:76
    ds_read_b32 v12, v4 offset:84
    v_alignbit_b32 v57, v34, v33, 16
    v_alignbit_b32 v58, v35, v34, 16
    v_alignbit_b32 v59, v36, v35, 16
    v_alignbit_b32 v60, v37, v36, 16
    v_alignbit_b32 v61, v38, v37, 16
    v_alignbit_b32 v62, v39, v38, 16
    v_alignbit_b32 v63, v40, v39, 16
    v_pk_add_f16 v66, v57, v34
    v_pk_add_f16 v67, v58, v35
    v_pk_add_f16 v68, v59, v36
    v_pk_add_f16 v69, v60, v37
    v_pk_add_f16 v70, v61, v38
    v_pk_add_f16 v71, v62, v39
    v_pk_add_f16 v72, v63, v40
    v_pk_add_f16 v80, v66, v58
    v_pk_add_f16 v81, v67, v59
    v_pk_add_f16 v82, v68, v60
    v_pk_add_f16 v83, v69, v61
    v_pk_add_f16 v75, v68, v69
    v_pk_add_f16 v76, v69, v70
    v_pk_add_f16 v77, v70, v71
    v_pk_add_f16 v78, v71, v72
    s_waitcnt lgkmcnt(0)
    v_cmp_eq_u32 vcc, s84, v12
    s_cbranch_vccnz WJK_79
W_80:
    s_sleep 1
    ds_read_b32 v12, v4 offset:84
    s_sub_u32 s39, s39, 1
    s_cbranch_scc1 KS_ABORT
    s_waitcnt lgkmcnt(0)
    v_cmp_ne_u32 vcc, s84, v12
    s_cbranch_vccnz W_80
WJK_79:
    ds_write_b128 v11, v[80:83] offset:36672
    v_pk_add_f16 v88, v35, v75
    v_pk_add_f16 v89, v36, v76
    v_pk_add_f16 v90, v37, v77
    v_pk_add_f16 v91, v38, v78
    ds_write_b128 v11, v[88:91] offset:39776
    ds_write_b8 v116, v5 offset:92
    s_cmp_lt_u32 s41, 24
    s_cbranch_scc1 WJE_67
    ds_read_b32 v12, v4 offset:100
    v_alignbit_b32 v57, v46, v45, 16
    v_alignbit_b32 v58, v47, v46, 16
    v_alignbit_b32 v59, v48, v47, 16
    v_alignbit_b32 v60, v49, v48, 16
    v_alignbit_b32 v61, v50, v49, 16
    v_alignbit_b32 v62, v51, v50, 16
    v_alignbit_b32 v63, v52, v51, 16
    v_pk_add_f16 v66, v57, v46
    v_pk_add_f16 v67, v58, v47
    v_pk_add_f16 v68, v59, v48
    v_pk_add_f16 v69, v60, v49
    v_pk_add_f16 v70, v61, v50
    v_pk_add_f16 v71, v62, v51
    v_pk_add_f16 v72, v63, v52
    v_pk_add_f16 v80, v66, v58
    v_pk_add_f16 v81, v67, v59
    v_pk_add_f16 v82, v68, v60
    v_pk_add_f16 v83, v69, v61
    v_pk_add_f16 v75, v68, v69
    v_pk_add_f16 v76, v69, v70
    v_pk_add_f16 v77, v70, v71
    v_pk_add_f16 v78, v71, v72
    s_waitcnt lgkmcnt(0)
    v_cmp_eq_u32 vcc, s84, v12
    s_cbranch_vccnz WJK_81
W_82:
    s_sleep 1
    ds_read_b32 v12, v4 offset:100
    s_sub_u32 s39, s39, 1
    s_cbranch_scc1 KS_ABORT
    s_waitcnt lgkmcnt(0)
    v_cmp_ne_u32 vcc, s84, v12
    s_cbranch_vccnz W_82
WJK_81:
    v_add_u32 v11, 73344, v11
    ds_write_b128 v11, v[80:83] offset:0
    v_pk_add_f16 v88, v47, v75
    v_pk_add_f16 v89, v48, v76
    v_pk_add_f16 v90, v49, v77
    v_pk_add_f16 v91, v50, v78
    ds_write_b128 v11, v[88:91] offset:3104
    ds_write_b8 v116, v5 offset:108
    s_branch WJE_67
WJ2_69:
    ds_write_b8 v116, v5 offset:76
    ds_write_b8 v116, v5 offset:92
    ds_write_b8 v116, v5 offset:108
    s_setprio 0
    v_mov_b32_dpp v32, v58 quad_perm:[0,0,0,0] row_mask:0xf bank_mask:0xf
    v_mov_b32_dpp v33, v58 quad_perm:[1,1,1,1] row_mask:0xf bank_mask:0xf
    v_mov_b32_dpp v34, v58 quad_perm:[2,2,2,2] row_mask:0xf bank_mask:0xf
    v_mov_b32_dpp v35, v58 quad_perm:[3,3,3,3] row_mask:0xf bank_mask:0xf
    v_lshlrev_b32 v12, 6, v1
    v_add_u32 v12, 0xb00800, v12
    v_mov_b32 v13, s84
    s_branch FPE_84
FP_83:
    s_sleep 2
FPE_84:
    global_load_dwordx4 v[20:23], v12, s[36:37] offset:-2048 sc1
    global_load_dwordx4 v[24:27], v12, s[36:37] offset:2048 sc1
    s_sub_u32 s39, s39, 1
    s_cbranch_scc1 KS_ABORT
    s_waitcnt vmcnt(0)
    v_xor_b32 v20, v32, v20
    v_xor_b32 v21, v33, v21
    v_xor_b32 v22, v34, v22
    v_xor_b32 v23, v35, v23
    v_xor_b32 v24, v32, v24
    v_xor_b32 v25, v33, v25
    v_xor_b32 v26, v34, v26
    v_xor_b32 v27, v35, v27
    v_or3_b32 v20, v20, v21, v22
    v_or3_b32 v23, v23, v24, v25
    v_or3_b32 v20, v20, v26, v27
    v_or_b32 v20, v20, v23
    v_cmp_ne_u32 vcc, 0, v20
    s_cbranch_vccnz FP_83
    ds_write2_b32 v4, v13, v13 offset0:28 offset1:36
    s_sub_u32 s94, s41, 18
    s_and_b32 s94, s94, 31
    s_cmp_ge_u32 s94, 14
    s_cbranch_scc1 WJE_67
    v_mul_u32_u24 v100, 57, v1
    v_lshrrev_b32 v100, 9, v100
    v_mul_u32_u24 v101, 9, v100
    v_sub_u32 v101, v1, v101
    v_mul_u32_u24 v100, 9216, v100
    v_lshl_add_u32 v100, v101, 7, v100
W_85:
    s_sleep 1
    ds_read_b32 v12, v4 offset:16
    s_sub_u32 s39, s39, 1
    s_cbranch_scc1 KS_ABORT
    s_waitcnt lgkmcnt(0)
    v_cmp_ne_u32 vcc, s84, v12
    s_cbranch_vccnz W_85
    s_bitcmp1_b32 s94, 0
    s_cselect_b32 s72, s28, s26
    s_cselect_b32 s73, s29, s27
    s_mov_b32 s74, 0x510000
    s_mov_b32 s75, 0x20000
    s_lshr_b32 s95, s94, 1
    s_mul_i32 s95, s95, 64512
    s_mul_i32 s96, s40, 1152
    s_add_u32 s95, s95, s96
    s_add_u32 s96, s95, 4451328
    buffer_load_dword v102, v100, s[72:75], s96 offen nt
    buffer_load_dword v102, v100, s[72:75], s96 offen sc1
    s_add_u32 s96, s95, 4902912
    buffer_load_dword v102, v100, s[72:75], s96 offen nt
    buffer_load_dword v102, v100, s[72:75], s96 offen sc1
KS_PF2D:
WJE_67:
    s_setprio 0
    s_lshr_b32 s92, s90, 6
    s_lshl_b32 s92, s92, 9
    s_bfe_u32 s93, s90, 0x20004
    s_lshl_b32 s93, s93, 6
    s_add_u32 s92, s92, s93
    s_and_b32 s93, s90, 3
    s_lshl_b32 s93, s93, 4
    s_add_u32 s92, s92, s93
    s_and_b32 s93, s90, 12
    s_add_u32 s92, s92, s93
    s_lshr_b32 s93, s38, 1
    s_lshl_b32 s93, s93, 8
    s_add_u32 s92, s92, s93
    s_and_b32 s93, s38, 1
    s_lshl_b32 s93, s93, 1
    s_add_u32 s92, s92, s93
    v_lshrrev_b32 v113, 5, v1
    v_and_b32 v114, 31, v1
    v_add_u32 v112, s92, v113
    v_mul_u32_u24 v115, 1152, v112
    v_lshl_add_u32 v8, v114, 2, v115
    v_lshl_add_u32 v115, v114, 4, v115
    v_lshlrev_b32 v7, 2, v114
    v_lshlrev_b32 v6, 4, v114
    v_bfe_u32 v111, v1, 3, 1
    v_add_u32 v111, s92, v111
    v_mul_u32_u24 v111, 1152, v111
    v_and_b32 v9, 7, v1
    v_lshl_add_u32 v111, v9, 4, v111
    s_mov_b32 s64, s4
    s_mov_b32 s65, s5
    s_mov_b32 s66, 0x240000
    s_mov_b32 s67, 0x20000
    s_mov_b32 s68, s24
    s_mov_b32 s69, s25
    s_mov_b32 s70, 0x480
    s_mov_b32 s71, 0x20000
    buffer_load_dwordx4 v[10:13], v115, s[64:67], 0 offen
    buffer_load_dwordx4 v[14:17], v115, s[64:67], 0 offen offset:512
    buffer_load_dword v18, v8, s[64:67], 0 offen offset:1024
    buffer_load_dwordx4 v[50:53], v6, s[68:71], 0 offen
    buffer_load_dwordx4 v[54:57], v6, s[68:71], 0 offen offset:512
    buffer_load_dword v58, v7, s[68:71], 0 offen offset:1024
KS_L4:
    s_add_u32 s64, s36, 0x600000
    s_addc_u32 s65, s37, 0
    s_mov_b32 s66, 0x240000
    s_mov_b32 s67, 0x20000
    s_mov_b32 s68, s32
    s_mov_b32 s69, s33
    s_mov_b32 s70, 0x240000
    s_mov_b32 s71, 0x20000
    s_mov_b32 s72, s36
    s_mov_b32 s73, s37
    s_mov_b32 s74, 0x240000
    s_mov_b32 s75, 0x20000
    s_add_u32 s76, s36, 0x840000
    s_addc_u32 s77, s37, 0
    s_mov_b32 s78, 0x4000
    s_mov_b32 s79, 0x20000
    s_not_b32 s93, s90
    v_xor_b32 v8, s93, v0
    v_lshrrev_b32 v6, 1, v0
    v_lshlrev_b32 v6, 6, v6
    v_and_b32 v8, 1, v8
    v_lshl_add_u32 v6, v8, 4, v6
    s_lshr_b32 s92, s90, 2
    s_lshl_b32 s92, s92, 15
    s_and_b32 s93, s90, 1
    s_lshl_b32 s93, s93, 14
    s_add_u32 s92, s92, s93
    s_and_b32 s93, s90, 2
    s_lshl_b32 s93, s93, 4
    s_add_u32 s92, s92, s93
    s_lshr_b32 s94, s90, 2
    s_lshl_b32 s94, s94, 12
    s_and_b32 s93, s90, 3
    s_lshl_b32 s93, s93, 4
    s_add_u32 s94, s94, s93
    s_lshl_b32 s93, s38, 10
    s_add_u32 s94, s94, s93
    s_add_u32 s94, s94, 0x200000
    v_lshlrev_b32 v9, 6, v2
    s_lshl_b32 s93, s90, 5
    s_and_b32 s95, s93, 0x1f80
    v_xor_b32 v6, s95, v6
    s_and_b32 s95, s93, 0x380
    v_xor_b32 v9, s95, v9
    s_and_b32 s95, s93, 0xc00
    s_xor_b32 s94, s94, s95
    s_and_b32 s93, s90, 1
    s_lshl_b32 s93, s93, 13
    s_xor_b32 s92, s92, s93
    s_xor_b32 s93, s92, 0x2000
    s_mul_i32 s95, s38, 2304
    s_add_u32 s95, s95, 17088
    v_lshl_add_u32 v117, v114, 5, s95
    v_lshl_add_u32 v110, v114, 3, s95
    s_lshl_b32 s95, s38, 9
    s_add_u32 s95, s95, 26368
    v_lshl_add_u32 v108, v1, 2, s95
    v_lshl_add_u32 v109, v1, 4, s95
    v_lshlrev_b32 v118, 4, v113
    s_movk_i32 s95, 0x3f80
    v_lshlrev_b32 v118, v118, s95
    v_lshlrev_b32 v8, 2, v0
    v_add_u32 v8, 17088, v8
    s_lshl_b32 s95, s38, 6
    s_add_u32 s95, s95, 19136
    v_lshl_add_u32 v119, v2, 2, s95
    s_waitcnt vmcnt(0)
    v_lshlrev_b32 v20, 16, v10
    v_and_b32 v21, 0xffff0000, v10
    v_lshlrev_b32 v22, 16, v11
    v_and_b32 v23, 0xffff0000, v11
    v_lshlrev_b32 v24, 16, v12
    v_and_b32 v25, 0xffff0000, v12
    v_lshlrev_b32 v26, 16, v13
    v_and_b32 v27, 0xffff0000, v13
    v_lshlrev_b32 v28, 16, v14
    v_and_b32 v29, 0xffff0000, v14
    v_lshlrev_b32 v30, 16, v15
    v_and_b32 v31, 0xffff0000, v15
    v_lshlrev_b32 v32, 16, v16
    v_and_b32 v33, 0xffff0000, v16
    v_lshlrev_b32 v34, 16, v17
    v_and_b32 v35, 0xffff0000, v17
    v_lshlrev_b32 v36, 16, v18
    v_and_b32 v37, 0xffff0000, v18
    v_lshlrev_b32 v80, 16, v50
    v_and_b32 v81, 0xffff0000, v50
    v_lshlrev_b32 v82, 16, v51
    v_and_b32 v83, 0xffff0000, v51
    v_lshlrev_b32 v84, 16, v52
    v_and_b32 v85, 0xffff0000, v52
    v_lshlrev_b32 v86, 16, v53
    v_and_b32 v87, 0xffff0000, v53
    v_lshlrev_b32 v88, 16, v54
    v_and_b32 v89, 0xffff0000, v54
    v_lshlrev_b32 v90, 16, v55
    v_and_b32 v91, 0xffff0000, v55
    v_lshlrev_b32 v92, 16, v56
    v_and_b32 v93, 0xffff0000, v56
    v_lshlrev_b32 v94, 16, v57
    v_and_b32 v95, 0xffff0000, v57
    v_lshlrev_b32 v96, 16, v58
    v_and_b32 v97, 0xffff0000, v58
    v_pk_add_f32 v[78:79], v[80:81], v[82:83]
    v_pk_add_f32 v[78:79], v[78:79], v[84:85]
    v_pk_add_f32 v[78:79], v[78:79], v[86:87]
    v_pk_add_f32 v[78:79], v[78:79], v[88:89]
    v_pk_add_f32 v[78:79], v[78:79], v[90:91]
    v_pk_add_f32 v[78:79], v[78:79], v[92:93]
    v_pk_add_f32 v[78:79], v[78:79], v[94:95]
    v_pk_add_f32 v[78:79], v[78:79], v[96:97]
    v_add_f32 v78, v78, v79
    s_nop 1
    v_add_f32_dpp v78, v78, v78 row_ror:8 row_mask:0xf bank_mask:0xf
    s_nop 1
    v_add_f32_dpp v78, v78, v78 row_ror:4 row_mask:0xf bank_mask:0xf
    s_nop 1
    v_add_f32_dpp v78, v78, v78 row_ror:2 row_mask:0xf bank_mask:0xf
    s_nop 1
    v_add_f32_dpp v78, v78, v78 row_ror:1 row_mask:0xf bank_mask:0xf
    v_mov_b32 v79, v78
    s_nop 1
    v_permlane16_swap_b32 v78, v79
    v_add_f32 v78, v78, v79
    v_sub_u32 v98, 0x87ff, v112
    v_lshl_add_u32 v99, v116, 1, v113
    v_lshlrev_b32 v99, 2, v99
    s_lshl_b32 s97, s90, 5
W_86:
    s_sleep 1
    ds_read_b32 v60, v4 offset:52
    s_sub_u32 s39, s39, 1
    s_cbranch_scc1 KS_ABORT
    s_waitcnt lgkmcnt(0)
    v_cmp_ne_u32 vcc, s84, v60
    s_cbranch_vccnz W_86
    s_setprio 3
    s_branch ZPE_88
ZP_87:
    s_sleep 1
ZPE_88:
    buffer_load_dwordx4 v[68:71], v4, s[64:67], s94 offen sc1
    s_sub_u32 s39, s39, 1
    s_cbranch_scc1 KS_ABORT
    s_waitcnt vmcnt(0)
    v_max3_u32 v44, v68, v69, v70
    v_max_u32 v44, v44, v71
    v_cmp_eq_u32 vcc, -1, v44
    s_cbranch_vccnz ZP_87
    s_branch ZPE_90
ZP_89:
    s_sleep 1
ZPE_90:
    buffer_load_dwordx4 v[60:63], v6, s[64:67], s92 offen sc1
    buffer_load_dwordx4 v[64:67], v6, s[64:67], s93 offen sc1
    buffer_load_dwordx4 v[68:71], v9, s[64:67], s94 offen sc1
    s_sub_u32 s39, s39, 1
    s_cbranch_scc1 KS_ABORT
    s_waitcnt vmcnt(2)
    ds_write2st64_b32 v8, v60, v61 offset0:0 offset1:9
    ds_write2st64_b32 v8, v62, v63 offset0:18 offset1:27
    v_max3_u32 v44, v60, v61, v61
    v_max3_u32 v44, v62, v63, v44
    s_waitcnt vmcnt(1)
    ds_write2st64_b32 v8, v64, v65 offset0:4 offset1:13
    ds_write2st64_b32 v8, v66, v67 offset0:22 offset1:31
    v_max3_u32 v44, v64, v65, v44
    v_max3_u32 v44, v66, v67, v44
    s_waitcnt vmcnt(0)
    ds_write2st64_b32 v119, v68, v69 offset0:0 offset1:9
    ds_write2st64_b32 v119, v70, v71 offset0:18 offset1:27
    v_max3_u32 v44, v68, v69, v44
    v_max3_u32 v44, v70, v71, v44
    v_cmp_eq_u32 vcc, -1, v44
    s_cbranch_vccnz ZP_89
    ds_write_b8 v116, v5 offset:20
ZW_91:
    ds_read_b32 v44, v4 offset:20
    ds_read_b128 v[60:63], v117 offset:0
    ds_read_b128 v[64:67], v117 offset:16
    ds_read_b128 v[68:71], v117 offset:1024
    ds_read_b128 v[72:75], v117 offset:1040
    ds_read_b64 v[76:77], v110 offset:2048
    s_sub_u32 s39, s39, 1
    s_cbranch_scc1 KS_ABORT
    s_waitcnt lgkmcnt(5)
    v_cmp_ne_u32 vcc, s84, v44
    s_cbranch_vccnz ZW_91
    s_waitcnt lgkmcnt(4)
    v_dot2c_f32_bf16 v20, v60, v118
    v_dot2c_f32_bf16 v21, v61, v118
    v_dot2c_f32_bf16 v22, v62, v118
    v_dot2c_f32_bf16 v23, v63, v118
    s_waitcnt lgkmcnt(3)
    v_dot2c_f32_bf16 v24, v64, v118
    v_dot2c_f32_bf16 v25, v65, v118
    v_pk_mul_f32 v[42:43], v[20:21], v[20:21]
    v_pk_mul_f32 v[44:45], v[20:21], v[80:81]
    v_dot2c_f32_bf16 v26, v66, v118
    v_dot2c_f32_bf16 v27, v67, v118
    v_pk_fma_f32 v[42:43], v[22:23], v[22:23], v[42:43]
    v_pk_fma_f32 v[44:45], v[22:23], v[82:83], v[44:45]
    v_pk_add_f32 v[40:41], v[22:23], v[20:21]
    s_waitcnt lgkmcnt(2)
    v_dot2c_f32_bf16 v28, v68, v118
    v_dot2c_f32_bf16 v29, v69, v118
    v_pk_fma_f32 v[42:43], v[24:25], v[24:25], v[42:43]
    v_pk_fma_f32 v[44:45], v[24:25], v[84:85], v[44:45]
    v_pk_add_f32 v[40:41], v[24:25], v[40:41]
    v_dot2c_f32_bf16 v30, v70, v118
    v_dot2c_f32_bf16 v31, v71, v118
    v_pk_fma_f32 v[42:43], v[26:27], v[26:27], v[42:43]
    v_pk_fma_f32 v[44:45], v[26:27], v[86:87], v[44:45]
    v_pk_add_f32 v[40:41], v[26:27], v[40:41]
    s_waitcnt lgkmcnt(1)
    v_dot2c_f32_bf16 v32, v72, v118
    v_dot2c_f32_bf16 v33, v73, v118
    v_pk_fma_f32 v[42:43], v[28:29], v[28:29], v[42:43]
    v_pk_fma_f32 v[44:45], v[28:29], v[88:89], v[44:45]
    v_pk_add_f32 v[40:41], v[28:29], v[40:41]
    v_dot2c_f32_bf16 v34, v74, v118
    v_dot2c_f32_bf16 v35, v75, v118
    v_pk_fma_f32 v[42:43], v[30:31], v[30:31], v[42:43]
    v_pk_fma_f32 v[44:45], v[30:31], v[90:91], v[44:45]
    v_pk_add_f32 v[40:41], v[30:31], v[40:41]
    s_waitcnt lgkmcnt(0)
    v_dot2c_f32_bf16 v36, v76, v118
    v_dot2c_f32_bf16 v37, v77, v118
    v_pk_fma_f32 v[42:43], v[32:33], v[32:33], v[42:43]
    v_pk_fma_f32 v[44:45], v[32:33], v[92:93], v[44:45]
    v_pk_add_f32 v[40:41], v[32:33], v[40:41]
    v_pk_fma_f32 v[42:43], v[34:35], v[34:35], v[42:43]
    v_pk_fma_f32 v[44:45], v[34:35], v[94:95], v[44:45]
    v_pk_add_f32 v[40:41], v[34:35], v[40:41]
    v_pk_fma_f32 v[42:43], v[36:37], v[36:37], v[42:43]
    v_pk_fma_f32 v[44:45], v[36:37], v[96:97], v[44:45]
    v_pk_add_f32 v[40:41], v[36:37], v[40:41]
    v_add_f32 v42, v42, v43
    v_add_f32 v44, v44, v45
    v_add_f32 v40, v40, v41
    v_mov_b32 v41, v40
    v_permlane16_swap_b32 v42, v44
    s_nop 0
    v_permlane16_swap_b32 v40, v41
    v_add_f32 v42, v42, v44
    v_add_f32 v40, v40, v41
    s_nop 0
    v_add_f32_dpp v42, v42, v42 row_ror:8 row_mask:0xf bank_mask:0xf
    v_add_f32_dpp v40, v40, v40 row_ror:8 row_mask:0xf bank_mask:0xf
    s_nop 0
    v_add_f32_dpp v42, v42, v42 row_ror:4 row_mask:0xf bank_mask:0xf
    v_add_f32_dpp v40, v40, v40 row_ror:4 row_mask:0xf bank_mask:0xf
    s_nop 0
    v_add_f32_dpp v42, v42, v42 row_ror:2 row_mask:0xf bank_mask:0xf
    v_add_f32_dpp v40, v40, v40 row_ror:2 row_mask:0xf bank_mask:0xf
    s_nop 0
    v_add_f32_dpp v42, v42, v42 row_ror:1 row_mask:0xf bank_mask:0xf
    v_add_f32_dpp v40, v40, v40 row_ror:1 row_mask:0xf bank_mask:0xf
    v_mul_f32 v40, 0x3ae38e39, v40
    v_mov_b32 v44, v42
    v_cvt_pk_bf16_f32 v41, 0, v40
    v_mul_f32 v40, v40, v40
    v_permlane16_swap_b32 v42, v44
    v_mov_b32 v43, 0x3ae38e39
    v_fma_f32 v42, v42, v43, -v40
    v_fma_f32 v44, -v41, v78, v44
    v_max_f32 v42, 0, v42
    v_cvt_pk_bf16_f32 v42, 0, v42
    v_add_f32 v42, 0x3727c5ac, v42
    v_cvt_pk_bf16_f32 v42, 0, v42
    v_sqrt_f32 v42, v42
    s_nop 0
    v_cvt_pk_bf16_f32 v42, 0, v42
    v_rcp_f32 v42, v42
    s_nop 0
    v_mul_f32 v60, v44, v42
    v_cvt_pk_bf16_f32 v60, v60, v60
    v_ashrrev_i32 v61, 31, v60
    v_or_b32 v61, 0x80000000, v61
    s_mov_b32 s95, 0xffff0000
    v_xor_b32 v60, v60, v61
    v_and_or_b32 v60, v60, s95, v98
    v_mov_b32 v61, v60
    s_nop 1
    v_permlane32_swap_b32 v60, v61
    s_mov_b64 exec, 1
    buffer_store_dwordx2 v[60:61], v99, s[76:79], s97 offen sc1
    ds_write_b8 v116, v5 offset:12
    s_mov_b64 exec, -1
    s_setprio 2
    v_cvt_pk_bf16_f32 v20, 0, v20
    v_cvt_pk_bf16_f32 v21, 0, v21
    v_cvt_pk_bf16_f32 v22, 0, v22
    v_cvt_pk_bf16_f32 v23, 0, v23
    v_cvt_pk_bf16_f32 v24, 0, v24
    v_cvt_pk_bf16_f32 v25, 0, v25
    v_cvt_pk_bf16_f32 v26, 0, v26
    v_cvt_pk_bf16_f32 v27, 0, v27
    v_cvt_pk_bf16_f32 v28, 0, v28
    v_cvt_pk_bf16_f32 v29, 0, v29
    v_cvt_pk_bf16_f32 v30, 0, v30
    v_cvt_pk_bf16_f32 v31, 0, v31
    v_cvt_pk_bf16_f32 v32, 0, v32
    v_cvt_pk_bf16_f32 v33, 0, v33
    v_cvt_pk_bf16_f32 v34, 0, v34
    v_cvt_pk_bf16_f32 v35, 0, v35
    v_cvt_pk_bf16_f32 v36, 0, v36
    v_cvt_pk_bf16_f32 v37, 0, v37
    v_pk_add_f32 v[44:45], v[20:21], v[22:23]
    v_pk_add_f32 v[46:47], v[24:25], v[26:27]
    v_pk_add_f32 v[44:45], v[44:45], v[28:29]
    v_pk_add_f32 v[46:47], v[46:47], v[30:31]
    v_pk_add_f32 v[44:45], v[44:45], v[32:33]
    v_pk_add_f32 v[46:47], v[46:47], v[34:35]
    v_pk_add_f32 v[44:45], v[44:45], v[36:37]
    v_pk_add_f32 v[44:45], v[44:45], v[46:47]
    v_add_f32 v44, v44, v45
    s_nop 1
    v_add_f32_dpp v44, v44, v44 row_ror:8 row_mask:0xf bank_mask:0xf
    s_nop 1
    v_add_f32_dpp v44, v44, v44 row_ror:4 row_mask:0xf bank_mask:0xf
    s_nop 1
    v_add_f32_dpp v44, v44, v44 row_ror:2 row_mask:0xf bank_mask:0xf
    s_nop 1
    v_add_f32_dpp v44, v44, v44 row_ror:1 row_mask:0xf bank_mask:0xf
    v_mov_b32 v46, v44
    s_nop 1
    v_permlane16_swap_b32 v44, v46
    v_add_f32 v44, v44, v46
    v_mul_f32 v48, 0x3ae38e39, v44
    v_mov_b32 v49, v48
    v_cvt_pk_bf16_f32 v40, 0, v48
    v_cvt_pk_bf16_f32 v41, 0, v48
    v_pk_add_f32 v[42:43], v[20:21], v[48:49] neg_lo:[0,1] neg_hi:[0,1]
    v_pk_mul_f32 v[44:45], v[42:43], v[42:43]
    v_pk_add_f32 v[42:43], v[22:23], v[48:49] neg_lo:[0,1] neg_hi:[0,1]
    v_pk_mul_f32 v[46:47], v[42:43], v[42:43]
    v_pk_add_f32 v[42:43], v[24:25], v[48:49] neg_lo:[0,1] neg_hi:[0,1]
    v_pk_fma_f32 v[44:45], v[42:43], v[42:43], v[44:45]
    v_pk_add_f32 v[42:43], v[26:27], v[48:49] neg_lo:[0,1] neg_hi:[0,1]
    v_pk_fma_f32 v[46:47], v[42:43], v[42:43], v[46:47]
    v_pk_add_f32 v[42:43], v[28:29], v[48:49] neg_lo:[0,1] neg_hi:[0,1]
    v_pk_fma_f32 v[44:45], v[42:43], v[42:43], v[44:45]
    v_pk_add_f32 v[42:43], v[30:31], v[48:49] neg_lo:[0,1] neg_hi:[0,1]
    v_pk_fma_f32 v[46:47], v[42:43], v[42:43], v[46:47]
    v_pk_add_f32 v[42:43], v[32:33], v[48:49] neg_lo:[0,1] neg_hi:[0,1]
    v_pk_fma_f32 v[44:45], v[42:43], v[42:43], v[44:45]
    v_pk_add_f32 v[42:43], v[34:35], v[48:49] neg_lo:[0,1] neg_hi:[0,1]
    v_pk_fma_f32 v[46:47], v[42:43], v[42:43], v[46:47]
    v_pk_add_f32 v[42:43], v[36:37], v[48:49] neg_lo:[0,1] neg_hi:[0,1]
    v_pk_fma_f32 v[44:45], v[42:43], v[42:43], v[44:45]
    v_pk_add_f32 v[44:45], v[44:45], v[46:47]
    v_add_f32 v44, v44, v45
    s_nop 1
    v_add_f32_dpp v44, v44, v44 row_ror:8 row_mask:0xf bank_mask:0xf
    s_nop 1
    v_add_f32_dpp v44, v44, v44 row_ror:4 row_mask:0xf bank_mask:0xf
    s_nop 1
    v_add_f32_dpp v44, v44, v44 row_ror:2 row_mask:0xf bank_mask:0xf
    s_nop 1
    v_add_f32_dpp v44, v44, v44 row_ror:1 row_mask:0xf bank_mask:0xf
    v_mov_b32 v46, v44
    s_nop 1
    v_permlane16_swap_b32 v44, v46
    v_add_f32 v44, v44, v46
    v_mul_f32 v44, 0x3ae38e39, v44
    v_cvt_pk_bf16_f32 v44, 0, v44
    v_add_f32 v44, 0x3727c5ac, v44
    v_cvt_pk_bf16_f32 v44, 0, v44
    v_sqrt_f32 v44, v44
    s_nop 0
    v_cvt_pk_bf16_f32 v44, 0, v44
    v_rcp_f32 v42, v44
    s_nop 0
    v_mov_b32 v43, v42
    v_pk_add_f32 v[44:45], v[20:21], v[40:41] neg_lo:[0,1] neg_hi:[0,1]
    v_cvt_pk_bf16_f32 v44, 0, v44
    v_cvt_pk_bf16_f32 v45, 0, v45
    v_pk_mul_f32 v[44:45], v[44:45], v[42:43]
    v_cvt_pk_bf16_f32 v10, v44, v45
    v_cvt_pk_bf16_f32 v44, 0, v44
    v_cvt_pk_bf16_f32 v45, 0, v45
    v_pk_add_f32 v[20:21], v[44:45], v[20:21]
    v_pk_add_f32 v[44:45], v[22:23], v[40:41] neg_lo:[0,1] neg_hi:[0,1]
    v_cvt_pk_bf16_f32 v44, 0, v44
    v_cvt_pk_bf16_f32 v45, 0, v45
    v_pk_mul_f32 v[44:45], v[44:45], v[42:43]
    v_cvt_pk_bf16_f32 v11, v44, v45
    v_cvt_pk_bf16_f32 v44, 0, v44
    v_cvt_pk_bf16_f32 v45, 0, v45
    v_pk_add_f32 v[22:23], v[44:45], v[22:23]
    v_pk_add_f32 v[44:45], v[24:25], v[40:41] neg_lo:[0,1] neg_hi:[0,1]
    v_cvt_pk_bf16_f32 v44, 0, v44
    v_cvt_pk_bf16_f32 v45, 0, v45
    v_pk_mul_f32 v[44:45], v[44:45], v[42:43]
    v_cvt_pk_bf16_f32 v12, v44, v45
    v_cvt_pk_bf16_f32 v44, 0, v44
    v_cvt_pk_bf16_f32 v45, 0, v45
    v_pk_add_f32 v[24:25], v[44:45], v[24:25]
    v_pk_add_f32 v[44:45], v[26:27], v[40:41] neg_lo:[0,1] neg_hi:[0,1]
    v_cvt_pk_bf16_f32 v44, 0, v44
    v_cvt_pk_bf16_f32 v45, 0, v45
    v_pk_mul_f32 v[44:45], v[44:45], v[42:43]
    v_cvt_pk_bf16_f32 v13, v44, v45
    v_cvt_pk_bf16_f32 v44, 0, v44
    v_cvt_pk_bf16_f32 v45, 0, v45
    v_pk_add_f32 v[26:27], v[44:45], v[26:27]
    v_pk_add_f32 v[44:45], v[28:29], v[40:41] neg_lo:[0,1] neg_hi:[0,1]
    v_cvt_pk_bf16_f32 v44, 0, v44
    v_cvt_pk_bf16_f32 v45, 0, v45
    v_pk_mul_f32 v[44:45], v[44:45], v[42:43]
    v_cvt_pk_bf16_f32 v14, v44, v45
    v_cvt_pk_bf16_f32 v44, 0, v44
    v_cvt_pk_bf16_f32 v45, 0, v45
    v_pk_add_f32 v[28:29], v[44:45], v[28:29]
    v_pk_add_f32 v[44:45], v[30:31], v[40:41] neg_lo:[0,1] neg_hi:[0,1]
    v_cvt_pk_bf16_f32 v44, 0, v44
    v_cvt_pk_bf16_f32 v45, 0, v45
    v_pk_mul_f32 v[44:45], v[44:45], v[42:43]
    v_cvt_pk_bf16_f32 v15, v44, v45
    v_cvt_pk_bf16_f32 v44, 0, v44
    v_cvt_pk_bf16_f32 v45, 0, v45
    v_pk_add_f32 v[30:31], v[44:45], v[30:31]
    v_pk_add_f32 v[44:45], v[32:33], v[40:41] neg_lo:[0,1] neg_hi:[0,1]
    v_cvt_pk_bf16_f32 v44, 0, v44
    v_cvt_pk_bf16_f32 v45, 0, v45
    v_pk_mul_f32 v[44:45], v[44:45], v[42:43]
    v_cvt_pk_bf16_f32 v16, v44, v45
    v_cvt_pk_bf16_f32 v44, 0, v44
    v_cvt_pk_bf16_f32 v45, 0, v45
    v_pk_add_f32 v[32:33], v[44:45], v[32:33]
    v_pk_add_f32 v[44:45], v[34:35], v[40:41] neg_lo:[0,1] neg_hi:[0,1]
    v_cvt_pk_bf16_f32 v44, 0, v44
    v_cvt_pk_bf16_f32 v45, 0, v45
    v_pk_mul_f32 v[44:45], v[44:45], v[42:43]
    v_cvt_pk_bf16_f32 v17, v44, v45
    v_cvt_pk_bf16_f32 v44, 0, v44
    v_cvt_pk_bf16_f32 v45, 0, v45
    v_pk_add_f32 v[34:35], v[44:45], v[34:35]
    v_pk_add_f32 v[44:45], v[36:37], v[40:41] neg_lo:[0,1] neg_hi:[0,1]
    v_cvt_pk_bf16_f32 v44, 0, v44
    v_cvt_pk_bf16_f32 v45, 0, v45
    v_pk_mul_f32 v[44:45], v[44:45], v[42:43]
    v_cvt_pk_bf16_f32 v18, v44, v45
    v_cvt_pk_bf16_f32 v44, 0, v44
    v_cvt_pk_bf16_f32 v45, 0, v45
    v_pk_add_f32 v[36:37], v[44:45], v[36:37]
    v_cvt_pk_bf16_f32 v58, v36, v37
    ds_write_b32 v108, v18
    ds_write_b32 v108, v58 offset:256
    ds_read_b128 v[64:67], v109
    buffer_store_dwordx4 v[10:13], v115, s[72:75], 0 offen sc1
    buffer_store_dwordx4 v[14:17], v115, s[72:75], 0 offen offset:512 sc1
    v_cvt_pk_bf16_f32 v50, v20, v21
    v_cvt_pk_bf16_f32 v51, v22, v23
    v_cvt_pk_bf16_f32 v52, v24, v25
    v_cvt_pk_bf16_f32 v53, v26, v27
    v_cvt_pk_bf16_f32 v54, v28, v29
    v_cvt_pk_bf16_f32 v55, v30, v31
    v_cvt_pk_bf16_f32 v56, v32, v33
    v_cvt_pk_bf16_f32 v57, v34, v35
    s_mov_b64 exec, 0xffff
    s_waitcnt lgkmcnt(0)
    buffer_store_dwordx4 v[64:67], v111, s[72:75], 0 offen offset:1024 sc1
    s_mov_b64 exec, -1
    s_setprio 0
    s_add_u32 s80, s36, 0x850000
    s_addc_u32 s81, s37, 0
    s_mov_b32 s82, 0x148800
    s_mov_b32 s83, 0x20000
    v_bfe_u32 v16, v1, 2, 2
    v_lshl_add_u32 v16, v3, 3, v16
    v_mul_u32_u24 v16, 1152, v16
    v_and_b32 v17, 3, v1
    v_lshl_add_u32 v16, v17, 3, v16
    s_lshl_b32 s10, s38, 7
    s_add_u32 s11, s10, 109184
    v_add_u32 v16, s11, v16
    v_lshrrev_b32 v18, 2, v1
    v_mul_u32_u24 v18, 9344, v18
    v_lshl_add_u32 v18, v17, 4, v18
    s_mul_i32 s9, s38, 149504
    s_lshl_b32 s11, s89, 6
    s_add_u32 s9, s9, s11
    v_lshl_add_u32 v19, v17, 5, s10
    v_lshl_add_u32 v19, v3, 3, v19
    s_mul_i32 s8, s89, 9344
    s_lshl_b32 s11, s38, 10
    s_add_u32 s8, s8, s11
    s_movk_i32 s10, 0x3f80
    s_mov_b32 s11, 0x3f800000
    v_mov_b32 v28, 0
    v_mov_b32 v29, 0
    v_lshlrev_b32 v17, 4, v1
    s_cmp_ge_u32 s41, 18
    s_cbranch_scc1 KS_LO
W_92:
    ds_read_b32 v20, v4 offset:40
    s_sub_u32 s39, s39, 1
    s_cbranch_scc1 KS_ABORT
    s_waitcnt lgkmcnt(0)
    v_cmp_ne_u32 vcc, s84, v20
    s_cbranch_vccnz W_92
    ds_read_b64_tr_b16 v[80:81], v16 offset:0
    ds_read_b64_tr_b16 v[82:83], v16 offset:4608
    ds_read_b64_tr_b16 v[84:85], v16 offset:32
    ds_read_b64_tr_b16 v[86:87], v16 offset:4640
    ds_read_b64_tr_b16 v[88:89], v16 offset:64
    ds_read_b64_tr_b16 v[90:91], v16 offset:4672
    ds_read_b64_tr_b16 v[92:93], v16 offset:96
    ds_read_b64_tr_b16 v[94:95], v16 offset:4704
    v_and_b32 v16, 7, v2
    v_lshlrev_b32 v16, 6, v16
    v_lshl_add_u32 v16, v3, 4, v16
    s_mul_i32 s92, s89, 9344
    s_add_u32 s92, s92, 0x850000
    s_add_u32 s64, s36, s92
    s_addc_u32 s65, s37, 0
    s_cmp_lt_u32 s41, 18
    s_cselect_b32 s66, 9216, 0
    s_mov_b32 s67, 0x20000
    s_mul_i32 s92, s38, 3072
    v_lshlrev_b32 v8, 4, v1
    v_mov_b32 v60, -1
    v_mov_b32 v61, -1
    v_mov_b32 v62, -1
    v_mov_b32 v63, -1
    buffer_store_dwordx4 v[60:63], v8, s[64:67], s92 offen offset:0 sc1
    buffer_store_dwordx4 v[60:63], v8, s[64:67], s92 offen offset:1024 sc1
    buffer_store_dwordx4 v[60:63], v8, s[64:67], s92 offen offset:2048 sc1
    s_waitcnt vmcnt(0)
    s_mov_b64 exec, 1
    ds_add_rtn_u32 v62, v4, v5 offset:196
    s_lshl_b32 s92, s2, 4
    s_add_u32 s92, s92, 8192
    s_waitcnt lgkmcnt(0)
    v_cmp_eq_u32 vcc, 3, v62
    s_and_b64 exec, exec, vcc
    s_cbranch_execz NOF_93
    buffer_store_dword v5, v4, s[76:79], s92 offen sc1
NOF_93:
    s_mov_b64 exec, -1
    s_sleep 16
    s_branch KS_LO2
KS_LO:
    s_sleep 8
    s_waitcnt vmcnt(0)
    s_mov_b64 exec, 1
    ds_add_rtn_u32 v62, v4, v5 offset:196
    s_lshl_b32 s92, s2, 4
    s_add_u32 s92, s92, 8192
    s_waitcnt lgkmcnt(0)
    v_cmp_eq_u32 vcc, 3, v62
    s_and_b64 exec, exec, vcc
    s_cbranch_execz NOF_94
    buffer_store_dword v5, v4, s[76:79], s92 offen sc1
NOF_94:
    s_mov_b64 exec, -1
    s_sleep 24
KS_LO2:
    s_mov_b64 exec, 0xffff0000
    buffer_store_dwordx4 v[64:67], v111, s[68:71], 0 offen offset:1024 sc1
    s_mov_b64 exec, -1
    buffer_store_dwordx4 v[50:53], v115, s[68:71], 0 offen sc1
    buffer_store_dwordx4 v[54:57], v115, s[68:71], 0 offen offset:512 sc1
    s_setprio 2
    s_waitcnt vmcnt(0)
    s_mov_b64 exec, 1
    ds_add_rtn_u32 v62, v4, v5 offset:176
    s_lshl_b32 s92, s2, 4
    s_add_u32 s92, s92, 12288
    s_waitcnt lgkmcnt(0)
    v_cmp_eq_u32 vcc, 3, v62
    s_and_b64 exec, exec, vcc
    s_cbranch_execz NOF_95
    buffer_store_dword v5, v4, s[76:79], s92 offen sc1
NOF_95:
    s_mov_b64 exec, -1
    s_cmp_lt_u32 s41, 18
    s_cbranch_scc1 KS_B
    s_waitcnt lgkmcnt(0)
    s_endpgm
KS_T:
    s_setprio 0
    s_cmp_ge_u32 s38, 10
    s_cbranch_scc1 KS_PEND
    s_add_u32 s76, s36, 0x840000
    s_addc_u32 s77, s37, 0
    s_mov_b32 s78, 0x4000
    s_mov_b32 s79, 0x20000
    s_cmp_eq_u32 s38, 9
    s_cbranch_scc1 KS_W9
    s_add_u32 s80, s36, 0x850000
    s_addc_u32 s81, s37, 0
    s_mov_b32 s82, 0x148800
    s_mov_b32 s83, 0x20000
    v_bfe_u32 v16, v1, 2, 2
    v_lshl_add_u32 v16, v3, 3, v16
    v_mul_u32_u24 v16, 1152, v16
    v_and_b32 v17, 3, v1
    v_lshl_add_u32 v16, v17, 3, v16
    s_lshl_b32 s10, s38, 7
    s_add_u32 s11, s10, 109184
    v_add_u32 v16, s11, v16
    v_lshrrev_b32 v18, 2, v1
    v_mul_u32_u24 v18, 9344, v18
    v_lshl_add_u32 v18, v17, 4, v18
    s_mul_i32 s9, s38, 149504
    s_lshl_b32 s11, s89, 6
    s_add_u32 s9, s9, s11
    v_lshl_add_u32 v19, v17, 5, s10
    v_lshl_add_u32 v19, v3, 3, v19
    s_mul_i32 s8, s89, 9344
    s_lshl_b32 s11, s38, 10
    s_add_u32 s8, s8, s11
    s_movk_i32 s10, 0x3f80
    s_mov_b32 s11, 0x3f800000
    v_mov_b32 v28, 0
    v_mov_b32 v29, 0
    v_lshlrev_b32 v17, 4, v1
    s_mov_b32 s72, s36
    s_mov_b32 s73, s37
    s_mov_b32 s74, 0x240000
    s_mov_b32 s75, 0x20000
    v_and_b32 v6, 1, v1
    v_and_b32 v7, 1, v3
    v_lshl_add_u32 v6, v7, 1, v6
    v_lshlrev_b32 v6, 2, v6
    ds_read_b32 v8, v6 offset:224
    s_lshl_b32 s92, s38, 11
    s_add_u32 s92, s92, 8896
    v_add_u32 v12, s92, v17
    s_waitcnt lgkmcnt(0)
    v_lshrrev_b32 v9, 3, v8
    v_lshrrev_b32 v10, 6, v8
    v_lshrrev_b32 v11, 9, v8
    s_cmp_eq_u32 s38, 8
    s_cbranch_scc1 KS_L2W
W_96:
    ds_read_b32 v20, v4 offset:40
    s_sub_u32 s39, s39, 1
    s_cbranch_scc1 KS_ABORT
    s_waitcnt lgkmcnt(0)
    v_cmp_ne_u32 vcc, s84, v20
    s_cbranch_vccnz W_96
    ds_read_b64_tr_b16 v[80:81], v16 offset:0
    ds_read_b64_tr_b16 v[82:83], v16 offset:4608
    ds_read_b64_tr_b16 v[84:85], v16 offset:32
    ds_read_b64_tr_b16 v[86:87], v16 offset:4640
    ds_read_b64_tr_b16 v[88:89], v16 offset:64
    ds_read_b64_tr_b16 v[90:91], v16 offset:4672
    ds_read_b64_tr_b16 v[92:93], v16 offset:96
    ds_read_b64_tr_b16 v[94:95], v16 offset:4704
    v_and_b32 v16, 7, v2
    v_lshlrev_b32 v16, 6, v16
    v_lshl_add_u32 v16, v3, 4, v16
W_97:
    s_sleep 2
    ds_read_b32 v20, v4 offset:768
    s_sub_u32 s39, s39, 1
    s_cbranch_scc1 KS_ABORT
    s_waitcnt lgkmcnt(0)
    v_cmp_eq_u32 vcc, 0, v20
    s_cbranch_vccnz W_97
    s_setprio 1
W_98:
    s_sleep 1
    ds_read_b32 v20, v4 offset:32
    s_sub_u32 s39, s39, 1
    s_cbranch_scc1 KS_ABORT
    s_waitcnt lgkmcnt(0)
    v_cmp_eq_u32 vcc, 0, v20
    s_cbranch_vccnz W_98
    ds_read_b128 v[20:23], v12
    ds_read_b128 v[24:27], v12 offset:1024
    s_waitcnt lgkmcnt(1)
    v_xor_b32 v13, v8, v20
    v_bitop3_b32 v13, v13, v9, v21 bitop3:0xf6
    v_bitop3_b32 v13, v13, v10, v22 bitop3:0xf6
    v_bitop3_b32 v13, v13, v11, v23 bitop3:0xf6
    v_and_b32 v13, 0x70007, v13
    s_waitcnt lgkmcnt(0)
    v_xor_b32 v14, v8, v24
    v_bitop3_b32 v14, v14, v9, v25 bitop3:0xf6
    v_bitop3_b32 v14, v14, v10, v26 bitop3:0xf6
    v_bitop3_b32 v14, v14, v11, v27 bitop3:0xf6
    v_and_b32 v14, 0x70007, v14
    v_min_u32 v13, v13, v14
KS_CK:
    v_cmp_eq_u32 vcc, 0, v13
    s_cbranch_vccz KS_B
    ds_write_b32 v4, v5 offset:24
    s_branch KS_B
KS_L2W:
    s_movk_i32 s92, 4096
    s_movk_i32 s96, -1152
    s_mov_b32 s93, 0
    v_mov_b32 v57, 0
    v_and_b32 v41, 1, v1
    v_lshl_add_u32 v41, v3, 1, v41
    v_lshlrev_b32 v41, 4, v41
    v_add_u32 v41, 2358144, v41
    v_lshlrev_b32 v7, 1, v1
    v_and_b32 v7, 28, v7
W_99:
    s_sleep 2
    ds_read_b32 v20, v4 offset:20
    s_sub_u32 s39, s39, 1
    s_cbranch_scc1 KS_ABORT
    s_waitcnt lgkmcnt(0)
    v_cmp_ne_u32 vcc, s84, v20
    s_cbranch_vccnz W_99
    s_setprio 3
W_100:
    s_sleep 1
    ds_read_b32 v20, v4 offset:12
    s_sub_u32 s39, s39, 1
    s_cbranch_scc1 KS_ABORT
    s_waitcnt lgkmcnt(0)
    v_cmp_ne_u32 vcc, s84, v20
    s_cbranch_vccnz W_100
    s_setprio 3
    s_sleep 27
    s_branch KS_Q1
KS_Q0:
    s_sleep 1
KS_Q1:
    buffer_load_dwordx4 v[96:99], v17, s[76:79], 0 offen offset:0 sc1
    buffer_load_dwordx4 v[100:103], v17, s[76:79], 0 offen offset:1024 sc1
    buffer_load_dwordx4 v[104:107], v17, s[76:79], 0 offen offset:2048 sc1
    buffer_load_dwordx4 v[108:111], v17, s[76:79], 0 offen offset:3072 sc1
    buffer_load_dwordx4 v[112:115], v17, s[76:79], s92 offen offset:0 sc1
    buffer_load_dwordx4 v[116:119], v17, s[76:79], s92 offen offset:1024 sc1
    buffer_load_dwordx4 v[120:123], v17, s[76:79], s92 offen offset:2048 sc1
    buffer_load_dwordx4 v[124:127], v17, s[76:79], s92 offen offset:3072 sc1
    s_sub_u32 s39, s39, 1
    s_cbranch_scc1 KS_ABORT
    s_waitcnt vmcnt(7)
    v_max_u32 v42, v96, v97
    v_max_u32 v44, v98, v99
    v_min_u32 v43, v96, v97
    v_min_u32 v45, v98, v99
    s_waitcnt vmcnt(6)
    v_med3_u32 v46, v42, v100, v101
    v_med3_u32 v47, v44, v102, v103
    v_max3_u32 v42, v42, v100, v101
    v_max3_u32 v44, v44, v102, v103
    v_max_u32 v43, v43, v46
    v_max_u32 v45, v45, v47
    s_waitcnt vmcnt(5)
    v_med3_u32 v46, v42, v104, v105
    v_med3_u32 v47, v44, v106, v107
    v_max3_u32 v42, v42, v104, v105
    v_max3_u32 v44, v44, v106, v107
    v_max_u32 v43, v43, v46
    v_max_u32 v45, v45, v47
    s_waitcnt vmcnt(4)
    v_med3_u32 v46, v42, v108, v109
    v_med3_u32 v47, v44, v110, v111
    v_max3_u32 v42, v42, v108, v109
    v_max3_u32 v44, v44, v110, v111
    v_max_u32 v43, v43, v46
    v_max_u32 v45, v45, v47
    s_waitcnt vmcnt(3)
    v_med3_u32 v46, v42, v112, v113
    v_med3_u32 v47, v44, v114, v115
    v_max3_u32 v42, v42, v112, v113
    v_max3_u32 v44, v44, v114, v115
    v_max_u32 v43, v43, v46
    v_max_u32 v45, v45, v47
    s_waitcnt vmcnt(2)
    v_med3_u32 v46, v42, v116, v117
    v_med3_u32 v47, v44, v118, v119
    v_max3_u32 v42, v42, v116, v117
    v_max3_u32 v44, v44, v118, v119
    v_max_u32 v43, v43, v46
    v_max_u32 v45, v45, v47
    s_waitcnt vmcnt(1)
    v_med3_u32 v46, v42, v120, v121
    v_med3_u32 v47, v44, v122, v123
    v_max3_u32 v42, v42, v120, v121
    v_max3_u32 v44, v44, v122, v123
    v_max_u32 v43, v43, v46
    v_max_u32 v45, v45, v47
    v_max_u32 v43, v43, v45
    s_waitcnt vmcnt(0)
    v_med3_u32 v46, v42, v124, v125
    v_med3_u32 v47, v44, v126, v127
    v_max3_u32 v42, v42, v124, v125
    v_max3_u32 v44, v44, v126, v127
    v_max3_u32 v43, v43, v46, v47
    v_max_u32 v48, v42, v44
    v_med3_u32 v49, v42, v44, v43
    v_cmp_eq_u32 vcc, -1, v48
    v_mov_b32 v56, v49
KS_QN:
    v_max_u32_dpp v50, v49, v48 row_half_mirror row_mask:0xf bank_mask:0x5
    v_max_u32_dpp v51, v48, v49 row_half_mirror row_mask:0xf bank_mask:0x5
    v_min_u32_dpp v50, v49, v48 row_half_mirror row_mask:0xf bank_mask:0xa
    v_min_u32_dpp v51, v48, v49 row_half_mirror row_mask:0xf bank_mask:0xa
    s_cbranch_vccnz KS_Q0
    s_cmp_eq_u32 s93, 1
    s_mov_b32 m0, 17088
    v_min_u32 v53, v50, v51
    v_max_u32 v52, v50, v51
    s_nop 1
    v_max_u32_dpp v50, v53, v52 row_mirror row_mask:0xf bank_mask:0x3
    v_max_u32_dpp v51, v52, v53 row_mirror row_mask:0xf bank_mask:0x3
    v_min_u32_dpp v50, v53, v52 row_mirror row_mask:0xf bank_mask:0xc
    v_min_u32_dpp v51, v52, v53 row_mirror row_mask:0xf bank_mask:0xc
    s_nop 0
    v_max_u32_dpp v52, v50, v50 row_half_mirror row_mask:0xf bank_mask:0x5
    v_max_u32_dpp v53, v51, v51 row_half_mirror row_mask:0xf bank_mask:0x5
    v_min_u32_dpp v52, v50, v50 row_half_mirror row_mask:0xf bank_mask:0xa
    v_min_u32_dpp v53, v51, v51 row_half_mirror row_mask:0xf bank_mask:0xa
    v_max_u32 v48, v52, v53
    v_max_u32 v54, v52, v53
    v_min_u32 v49, v52, v53
    v_min_u32 v55, v52, v53
    v_permlane32_swap_b32 v48, v54
    s_nop 0
    v_permlane32_swap_b32 v49, v55
    s_nop 1
    v_max_u32_dpp v51, v54, v49 row_mirror row_mask:0xf bank_mask:0xf
    v_max_u32_dpp v50, v55, v48 row_mirror row_mask:0xf bank_mask:0xf
    s_nop 1
    v_max_u32_dpp v52, v50, v50 row_ror:8 row_mask:0xf bank_mask:0x3
    v_max_u32_dpp v53, v51, v51 row_ror:8 row_mask:0xf bank_mask:0x3
    v_min_u32_dpp v52, v50, v50 row_ror:8 row_mask:0xf bank_mask:0xc
    v_min_u32_dpp v53, v51, v51 row_ror:8 row_mask:0xf bank_mask:0xc
    s_nop 0
    v_max_u32_dpp v50, v52, v52 row_half_mirror row_mask:0xf bank_mask:0x5
    v_max_u32_dpp v51, v53, v53 row_half_mirror row_mask:0xf bank_mask:0x5
    v_min_u32_dpp v50, v52, v52 row_half_mirror row_mask:0xf bank_mask:0xa
    v_min_u32_dpp v51, v53, v53 row_half_mirror row_mask:0xf bank_mask:0xa
    v_max_u32 v48, v50, v51
    v_max_u32 v54, v50, v51
    v_min_u32 v49, v50, v51
    v_min_u32 v55, v50, v51
    v_permlane16_swap_b32 v48, v54
    s_nop 0
    v_permlane16_swap_b32 v49, v55
    s_nop 1
    v_max_u32_dpp v51, v54, v49 row_mirror row_mask:0xf bank_mask:0xf
    v_max_u32_dpp v50, v55, v48 row_mirror row_mask:0xf bank_mask:0xf
    s_nop 1
    v_max_u32_dpp v52, v50, v50 row_ror:8 row_mask:0xf bank_mask:0x3
    v_max_u32_dpp v53, v51, v51 row_ror:8 row_mask:0xf bank_mask:0x3
    v_min_u32_dpp v52, v50, v50 row_ror:8 row_mask:0xf bank_mask:0xc
    v_min_u32_dpp v53, v51, v51 row_ror:8 row_mask:0xf bank_mask:0xc
    s_nop 0
    v_max_u32_dpp v50, v52, v52 row_half_mirror row_mask:0xf bank_mask:0x5
    v_max_u32_dpp v51, v53, v53 row_half_mirror row_mask:0xf bank_mask:0x5
    v_min_u32_dpp v50, v52, v52 row_half_mirror row_mask:0xf bank_mask:0xa
    v_min_u32_dpp v51, v53, v53 row_half_mirror row_mask:0xf bank_mask:0xa
    v_min_u32 v49, v50, v51
    v_max_u32 v48, v50, v51
    s_nop 0
    v_mov_b32_dpp v55, v49 row_mirror row_mask:0xf bank_mask:0xf
    v_mov_b32_dpp v54, v48 row_mirror row_mask:0xf bank_mask:0xf
    s_nop 0
    v_max_u32_dpp v50, v55, v48 quad_perm:[1,0,3,2] row_mask:0xf bank_mask:0xf
    v_max_u32_dpp v51, v54, v49 quad_perm:[1,0,3,2] row_mask:0xf bank_mask:0xf
    s_nop 0
    v_max_u32_dpp v52, v50, v50 row_ror:8 row_mask:0xf bank_mask:0x3
    v_max_u32_dpp v53, v51, v51 row_ror:8 row_mask:0xf bank_mask:0x3
    v_min_u32_dpp v52, v50, v50 row_ror:8 row_mask:0xf bank_mask:0xc
    v_min_u32_dpp v53, v51, v51 row_ror:8 row_mask:0xf bank_mask:0xc
    s_nop 0
    v_max_u32_dpp v50, v52, v52 row_half_mirror row_mask:0xf bank_mask:0x5
    v_max_u32_dpp v51, v53, v53 row_half_mirror row_mask:0xf bank_mask:0x5
    v_min_u32_dpp v50, v52, v52 row_half_mirror row_mask:0xf bank_mask:0xa
    v_min_u32_dpp v51, v53, v53 row_half_mirror row_mask:0xf bank_mask:0xa
    v_min_u32 v49, v50, v51
    v_max_u32 v48, v50, v51
    s_nop 0
    v_mov_b32_dpp v55, v49 row_mirror row_mask:0xf bank_mask:0xf
    s_nop 1
    v_max_u32_dpp v59, v55, v48 quad_perm:[2,3,0,1] row_mask:0xf bank_mask:0xf
    s_cbranch_scc1 KS_QF2
    v_and_b32 v61, 0x7ff, v59
    v_mad_i32_i24 v61, v61, s96, v41
    buffer_load_dwordx4 v61, s[72:75], 0 offen offset:0 sc1 lds
    s_mov_b32 m0, 17984
    s_nop 0
    buffer_load_dwordx4 v61, s[72:75], 0 offen offset:128 sc1 lds
    s_mov_b32 m0, 18880
    s_nop 0
    buffer_load_dwordx4 v61, s[72:75], 0 offen offset:256 sc1 lds
    s_mov_b32 m0, 19776
    s_nop 0
    buffer_load_dwordx4 v61, s[72:75], 0 offen offset:384 sc1 lds
    s_mov_b32 m0, 20672
    s_nop 0
    buffer_load_dwordx4 v61, s[72:75], 0 offen offset:512 sc1 lds
    s_mov_b32 m0, 21568
    s_nop 0
    buffer_load_dwordx4 v61, s[72:75], 0 offen offset:640 sc1 lds
    s_mov_b32 m0, 22464
    s_nop 0
    buffer_load_dwordx4 v61, s[72:75], 0 offen offset:768 sc1 lds
    s_mov_b32 m0, 23360
    s_nop 0
    buffer_load_dwordx4 v61, s[72:75], 0 offen offset:896 sc1 lds
    s_mov_b32 m0, 24256
    s_nop 0
    buffer_load_dwordx4 v61, s[72:75], 0 offen offset:1024 sc1 lds
    v_sub_u32 v96, v96, v56
    v_min_u32_dpp v60, v59, v59 quad_perm:[2,3,0,1] row_mask:0xf bank_mask:0xf
    v_sub_u32 v97, v97, v56
    v_sub_u32 v98, v98, v56
    v_max3_u32 v47, v96, v97, v98
    v_sub_u32 v99, v99, v56
    v_sub_u32 v100, v100, v56
    v_min_u32_dpp v60, v60, v60 row_half_mirror row_mask:0xf bank_mask:0xf
    v_max3_u32 v47, v47, v99, v100
    v_sub_u32 v101, v101, v56
    v_sub_u32 v102, v102, v56
    v_max3_u32 v47, v47, v101, v102
    v_sub_u32 v103, v103, v56
    v_sub_u32 v104, v104, v56
    v_min_u32_dpp v60, v60, v60 row_ror:8 row_mask:0xf bank_mask:0xf
    v_max3_u32 v47, v47, v103, v104
    v_sub_u32 v105, v105, v56
    v_sub_u32 v106, v106, v56
    v_max3_u32 v47, v47, v105, v106
    v_sub_u32 v107, v107, v56
    v_sub_u32 v108, v108, v56
    v_max3_u32 v47, v47, v107, v108
    v_sub_u32 v109, v109, v56
    v_sub_u32 v110, v110, v56
    v_max3_u32 v47, v47, v109, v110
    v_sub_u32 v111, v111, v56
    v_sub_u32 v112, v112, v56
    v_max3_u32 v47, v47, v111, v112
    v_sub_u32 v113, v113, v56
    v_sub_u32 v114, v114, v56
    v_max3_u32 v47, v47, v113, v114
    v_sub_u32 v115, v115, v56
    v_sub_u32 v116, v116, v56
    v_max3_u32 v47, v47, v115, v116
    v_sub_u32 v117, v117, v56
    v_sub_u32 v118, v118, v56
    v_max3_u32 v47, v47, v117, v118
    v_sub_u32 v119, v119, v56
    v_sub_u32 v120, v120, v56
    v_max3_u32 v47, v47, v119, v120
    v_sub_u32 v121, v121, v56
    v_sub_u32 v122, v122, v56
    v_max3_u32 v47, v47, v121, v122
    v_sub_u32 v123, v123, v56
    v_sub_u32 v124, v124, v56
    v_max3_u32 v47, v47, v123, v124
    v_sub_u32 v125, v125, v56
    v_sub_u32 v126, v126, v56
    v_max3_u32 v47, v47, v125, v126
    v_sub_u32 v127, v127, v56
    v_add_u32 v57, v57, v56
    v_max_u32 v47, v47, v127
    v_add_u32 v47, v47, v57
    v_cmp_gt_u32 vcc, v47, v60
    s_cbranch_vccnz KS_QF1
    ds_write_b32 v7, v59 offset:768
W_101:
    ds_read_b32 v20, v4 offset:40
    s_sub_u32 s39, s39, 1
    s_cbranch_scc1 KS_ABORT
    s_waitcnt lgkmcnt(0)
    v_cmp_ne_u32 vcc, s84, v20
    s_cbranch_vccnz W_101
    ds_read_b64_tr_b16 v[80:81], v16 offset:0
    ds_read_b64_tr_b16 v[82:83], v16 offset:4608
    ds_read_b64_tr_b16 v[84:85], v16 offset:32
    ds_read_b64_tr_b16 v[86:87], v16 offset:4640
    ds_read_b64_tr_b16 v[88:89], v16 offset:64
    ds_read_b64_tr_b16 v[90:91], v16 offset:4672
    ds_read_b64_tr_b16 v[92:93], v16 offset:96
    ds_read_b64_tr_b16 v[94:95], v16 offset:4704
    v_and_b32 v16, 7, v2
    v_lshlrev_b32 v16, 6, v16
    v_lshl_add_u32 v16, v3, 4, v16
    s_waitcnt vmcnt(0)
    ds_write_b32 v4, v5 offset:32
    s_setprio 1
    ds_read_b128 v[20:23], v12
    s_waitcnt lgkmcnt(0)
    v_xor_b32 v13, v8, v20
    v_bitop3_b32 v13, v13, v9, v21 bitop3:0xf6
    v_bitop3_b32 v13, v13, v10, v22 bitop3:0xf6
    v_bitop3_b32 v13, v13, v11, v23 bitop3:0xf6
    v_and_b32 v13, 0x70007, v13
    s_branch KS_CK
KS_QF1:
    s_sub_u32 s39, s39, 1
    s_cbranch_scc1 KS_ABORT
    v_mov_b32 v58, v59
    v_max_u32 v42, v96, v97
    v_max_u32 v44, v98, v99
    v_min_u32 v43, v96, v97
    v_min_u32 v45, v98, v99
    v_med3_u32 v46, v42, v100, v101
    v_med3_u32 v47, v44, v102, v103
    v_max3_u32 v42, v42, v100, v101
    v_max3_u32 v44, v44, v102, v103
    v_max_u32 v43, v43, v46
    v_max_u32 v45, v45, v47
    v_med3_u32 v46, v42, v104, v105
    v_med3_u32 v47, v44, v106, v107
    v_max3_u32 v42, v42, v104, v105
    v_max3_u32 v44, v44, v106, v107
    v_max_u32 v43, v43, v46
    v_max_u32 v45, v45, v47
    v_med3_u32 v46, v42, v108, v109
    v_med3_u32 v47, v44, v110, v111
    v_max3_u32 v42, v42, v108, v109
    v_max3_u32 v44, v44, v110, v111
    v_max_u32 v43, v43, v46
    v_max_u32 v45, v45, v47
    v_med3_u32 v46, v42, v112, v113
    v_med3_u32 v47, v44, v114, v115
    v_max3_u32 v42, v42, v112, v113
    v_max3_u32 v44, v44, v114, v115
    v_max_u32 v43, v43, v46
    v_max_u32 v45, v45, v47
    v_med3_u32 v46, v42, v116, v117
    v_med3_u32 v47, v44, v118, v119
    v_max3_u32 v42, v42, v116, v117
    v_max3_u32 v44, v44, v118, v119
    v_max_u32 v43, v43, v46
    v_max_u32 v45, v45, v47
    v_med3_u32 v46, v42, v120, v121
    v_med3_u32 v47, v44, v122, v123
    v_max3_u32 v42, v42, v120, v121
    v_max3_u32 v44, v44, v122, v123
    v_max_u32 v43, v43, v46
    v_max_u32 v45, v45, v47
    v_max_u32 v43, v43, v45
    v_med3_u32 v46, v42, v124, v125
    v_med3_u32 v47, v44, v126, v127
    v_max3_u32 v42, v42, v124, v125
    v_max3_u32 v44, v44, v126, v127
    v_max3_u32 v43, v43, v46, v47
    v_max_u32 v48, v42, v44
    v_med3_u32 v56, v42, v44, v43
    v_add_u32 v48, v48, v57
    v_add_u32 v49, v56, v57
    s_mov_b32 s93, 1
    s_mov_b64 vcc, 0
    s_nop 2
    s_branch KS_QN
KS_QF2:
    v_mov_b32 v48, 0
    v_mov_b32 v49, 0
    s_mov_b64 exec, 0x5555
    v_max_u32 v48, v59, v58
    v_min_u32 v49, v59, v58
    s_mov_b64 exec, -1
    s_mov_b32 s93, 2
    s_mov_b64 vcc, 0
    s_waitcnt vmcnt(0)
    s_nop 5
    s_branch KS_QN
KS_BR:
    s_mov_b64 exec, -1
    s_cmp_lg_u32 s38, 8
    s_cbranch_scc1 KS_BR1
    s_movk_i32 s92, 0x2000
    s_nop 7
    s_branch ZPE_103
ZP_102:
    s_sleep 2
ZPE_103:
    buffer_load_dword v20, v17, s[76:79], s92 offen offset:0 sc1
    buffer_load_dword v21, v17, s[76:79], s92 offen offset:1024 sc1
    buffer_load_dword v22, v17, s[76:79], s92 offen offset:2048 sc1
    buffer_load_dword v23, v17, s[76:79], s92 offen offset:3072 sc1
    s_sub_u32 s39, s39, 1
    s_cbranch_scc1 KS_ABORT
    s_waitcnt vmcnt(0)
    v_max3_u32 v44, v20, v21, v22
    v_max_u32 v44, v44, v23
    v_cmp_eq_u32 vcc, -1, v44
    s_cbranch_vccnz ZP_102
    s_mov_b32 m0, 17088
    s_nop 0
    buffer_load_dwordx4 v61, s[72:75], 0 offen offset:0 sc1 lds
    s_mov_b32 m0, 17984
    s_nop 0
    buffer_load_dwordx4 v61, s[72:75], 0 offen offset:128 sc1 lds
    s_mov_b32 m0, 18880
    s_nop 0
    buffer_load_dwordx4 v61, s[72:75], 0 offen offset:256 sc1 lds
    s_mov_b32 m0, 19776
    s_nop 0
    buffer_load_dwordx4 v61, s[72:75], 0 offen offset:384 sc1 lds
    s_mov_b32 m0, 20672
    s_nop 0
    buffer_load_dwordx4 v61, s[72:75], 0 offen offset:512 sc1 lds
    s_mov_b32 m0, 21568
    s_nop 0
    buffer_load_dwordx4 v61, s[72:75], 0 offen offset:640 sc1 lds
    s_mov_b32 m0, 22464
    s_nop 0
    buffer_load_dwordx4 v61, s[72:75], 0 offen offset:768 sc1 lds
    s_mov_b32 m0, 23360
    s_nop 0
    buffer_load_dwordx4 v61, s[72:75], 0 offen offset:896 sc1 lds
    s_mov_b32 m0, 24256
    s_nop 0
    buffer_load_dwordx4 v61, s[72:75], 0 offen offset:1024 sc1 lds
    s_waitcnt vmcnt(0)
    s_barrier
    ds_write_b32 v4, v4 offset:24
    s_branch KS_B
KS_BR1:
    s_barrier
    s_branch KS_B
KS_W9:
    v_lshlrev_b32 v33, 4, v1
    s_movk_i32 s92, 0x2000
    v_and_b32 v7, 7, v1
    v_lshlrev_b32 v7, 2, v7
    s_add_u32 s64, s36, 0x600000
    s_addc_u32 s65, s37, 0
    s_mov_b32 s66, 0x240000
    s_mov_b32 s67, 0x20000
    s_mov_b32 s68, s4
    s_mov_b32 s69, s5
    s_mov_b32 s70, 0x240000
    s_mov_b32 s71, 0x20000
    v_bfe_u32 v43, v1, 3, 2
    s_lshl_b32 s93, s89, 2
    v_add_u32 v43, s93, v43
    v_bfe_u32 v40, v43, 4, 1
    v_and_b32 v41, 3, v1
    v_lshl_add_u32 v40, v40, 2, v41
    v_lshlrev_b32 v40, 2, v40
    v_and_b32 v41, 0x3cf, v43
    v_bfe_u32 v42, v43, 5, 1
    v_lshl_add_u32 v41, v42, 4, v41
    v_bfe_u32 v42, v1, 2, 1
    v_lshl_add_u32 v41, v42, 5, v41
    v_lshrrev_b32 v42, 4, v41
    v_lshlrev_b32 v42, 8, v42
    v_lshl_add_u32 v42, v40, 3, v42
    v_and_b32 v43, 15, v41
    v_lshl_add_u32 v42, v43, 1, v42
W_104:
    s_sleep 1
    ds_read_b32 v12, v7 offset:768
    s_sub_u32 s39, s39, 1
    s_cbranch_scc1 KS_ABORT
    s_waitcnt lgkmcnt(0)
    v_cmp_eq_u32 vcc, 0, v12
    s_cbranch_vccnz W_104
    ds_read_b32 v19, v40 offset:768
    s_waitcnt lgkmcnt(0)
    v_and_b32 v14, 0x7ff, v19
    v_sub_u32 v14, 2047, v14
    v_mul_u32_u24 v23, 1152, v14
    v_lshl_add_u32 v23, v41, 1, v23
    buffer_load_ushort v17, v23, s[68:71], 0 offen
    v_lshrrev_b32 v15, 9, v14
    v_bfe_u32 v16, v14, 6, 2
    v_lshl_add_u32 v15, v15, 2, v16
    v_bfe_u32 v16, v14, 2, 2
    v_lshl_add_u32 v15, v15, 2, v16
    v_bfe_u32 v16, v14, 4, 1
    v_bfe_u32 v24, v14, 8, 1
    v_and_b32 v25, 3, v14
    v_lshl_add_u32 v24, v24, 2, v25
    v_lshlrev_b32 v24, 1, v24
    v_bfe_u32 v25, v14, 5, 1
    v_lshl_add_u32 v24, v25, 5, v24
    v_lshl_add_u32 v25, v15, 1, v16
    v_lshl_add_u32 v25, v25, 14, v24
    v_lshrrev_b32 v26, 1, v41
    v_lshl_add_u32 v25, v26, 6, v25
    v_xor_b32 v26, v41, v16
    v_not_b32 v26, v26
    v_and_b32 v26, 1, v26
    v_lshl_add_u32 v25, v26, 4, v25
    v_lshl_add_u32 v26, v15, 12, v24
    v_lshl_add_u32 v26, v16, 4, v26
    v_lshl_add_u32 v26, v41, 6, v26
    v_add_u32 v26, 2064384, v26
    v_lshl_add_u32 v27, v16, 6, v15
    v_lshlrev_b32 v27, 7, v27
    v_xor_b32 v25, v27, v25
    v_and_b32 v27, 0xf80, v27
    v_xor_b32 v26, v27, v26
    v_cmp_gt_u32 vcc, 0x200, v41
    s_nop 1
    v_cndmask_b32 v25, v26, v25, vcc
    buffer_load_ushort v18, v25, s[64:67], 0 offen sc1
    v_ashrrev_i32 v22, 31, v19
    v_not_b32 v22, v22
    v_or_b32 v22, 0x80000000, v22
    v_xor_b32 v22, v19, v22
    v_and_b32 v22, 0xffff0000, v22
    v_mul_f32 v22, 0xbfb8aa3b, v22
    v_exp_f32 v22, v22
    s_nop 0
    v_add_f32 v22, 1.0, v22
    v_rcp_f32 v22, v22
    s_nop 0
    v_cvt_pk_bf16_f32 v22, 0, v22
    s_add_u32 s72, s36, 0xb10000
    s_addc_u32 s73, s37, 0
    s_mov_b32 s74, 0x40
    s_mov_b32 s75, 0x20000
    s_mov_b32 s68, s32
    s_mov_b32 s69, s33
    s_mov_b32 s70, 0x240000
    s_mov_b32 s71, 0x20000
    buffer_load_dword v8, v33, s[76:79], s92 offen offset:0 sc1
    buffer_load_dword v9, v33, s[76:79], s92 offen offset:1024 sc1
    buffer_load_dword v10, v33, s[76:79], s92 offen offset:2048 sc1
    buffer_load_dword v11, v33, s[76:79], s92 offen offset:3072 sc1
    s_cmp_lg_u32 s2, 0
    s_cbranch_scc1 KS_W9B
    buffer_store_dword v12, v7, s[72:75], 0 offen
    s_branch KS_W9B
KS_W9R:
    s_barrier
KS_W9B:
    s_barrier
    ds_read_b32 v13, v4 offset:24
    ds_read_u16 v20, v42 offset:17088
    s_waitcnt lgkmcnt(0)
    v_cmp_ne_u32 vcc, 0, v13
    s_cbranch_vccnz KS_W9R
    s_setprio 2
    s_branch KS_F3B
KS_F3A:
    s_sleep 2
    buffer_load_dword v8, v33, s[76:79], s92 offen offset:0 sc1
    buffer_load_dword v9, v33, s[76:79], s92 offen offset:1024 sc1
    buffer_load_dword v10, v33, s[76:79], s92 offen offset:2048 sc1
    buffer_load_dword v11, v33, s[76:79], s92 offen offset:3072 sc1
KS_F3B:
    s_sub_u32 s39, s39, 1
    s_cbranch_scc1 KS_ABORT
    s_waitcnt vmcnt(0)
    v_max3_u32 v44, v8, v9, v10
    v_max_u32 v44, v44, v11
    v_cmp_eq_u32 vcc, -1, v44
    s_cbranch_vccnz KS_F3A
    ds_write_b32 v4, v5 offset:28
    s_movk_i32 s92, 0x3000
    s_sleep 12
    s_branch ZPE_106
ZP_105:
    s_sleep 2
ZPE_106:
    buffer_load_dword v8, v33, s[76:79], s92 offen offset:0 sc1
    buffer_load_dword v9, v33, s[76:79], s92 offen offset:1024 sc1
    buffer_load_dword v10, v33, s[76:79], s92 offen offset:2048 sc1
    buffer_load_dword v11, v33, s[76:79], s92 offen offset:3072 sc1
    s_sub_u32 s39, s39, 1
    s_cbranch_scc1 KS_ABORT
    s_waitcnt vmcnt(0)
    v_max3_u32 v44, v8, v9, v10
    v_max_u32 v44, v44, v11
    v_cmp_eq_u32 vcc, -1, v44
    s_cbranch_vccnz ZP_105
    v_lshlrev_b32 v17, 16, v17
    v_lshlrev_b32 v18, 16, v18
    v_add_f32 v17, v17, v18
    v_cvt_pk_bf16_f32 v17, v17, v17
    v_and_b32 v21, 0xffff0000, v17
    v_lshlrev_b32 v20, 16, v20
    v_lshlrev_b32 v14, 2, v1
    v_add_u32 v14, 1536, v14
    s_mov_b32 exec_lo, -1
    s_mov_b32 exec_hi, 0
    s_setprio 3
    s_barrier
    ds_read2_b32 v[32:33], v14 offset0:0 offset1:32
    ds_read2_b32 v[34:35], v14 offset0:64 offset1:96
    ds_read2_b32 v[36:37], v14 offset0:128 offset1:160
    ds_read2_b32 v[38:39], v14 offset0:192 offset1:224
    ds_read_b32 v40, v14 offset:1024
    s_waitcnt lgkmcnt(3)
    v_pk_add_f32 v[32:33], v[32:33], v[34:35]
    s_waitcnt lgkmcnt(1)
    v_pk_add_f32 v[36:37], v[36:37], v[38:39]
    v_add_f32 v32, v32, v33
    s_waitcnt lgkmcnt(0)
    v_add_f32 v36, v36, v37
    v_add_f32 v32, v32, v40
    v_add_f32 v8, v32, v36
    v_cvt_pk_bf16_f32 v8, 0, v8
    v_mul_f32 v8, v8, v22
    v_cvt_pk_bf16_f32 v8, 0, v8
    v_add_f32 v8, v8, v20
    v_cvt_pk_bf16_f32 v8, 0, v8
    v_add_f32 v8, v8, v21
    v_cvt_pk_bf16_f32 v8, v8, v8
    buffer_store_short v8, v23, s[68:71], 0 offen
    s_endpgm
KS_B:
    s_setprio 2
    s_waitcnt lgkmcnt(0)
    s_barrier
    ds_read_b128 v[20:23], v16 offset:1024
    ds_read_b32 v30, v4 offset:24
    s_waitcnt lgkmcnt(1)
    v_mfma_f32_16x16x32_bf16 v[32:35], v[20:23], v[80:83], 0
    v_mfma_f32_16x16x32_bf16 v[40:43], v[20:23], v[88:91], 0
    v_mfma_f32_16x16x32_bf16 v[36:39], v[20:23], v[84:87], 0
    v_mfma_f32_16x16x32_bf16 v[44:47], v[20:23], v[92:95], 0
    s_waitcnt lgkmcnt(0)
    v_cmp_ne_u32 vcc, 0, v30
    s_mov_b32 exec_lo, -1
    s_mov_b32 exec_hi, 0
    s_cbranch_vccnz KS_BR
    v_cvt_pk_bf16_f32 v24, v32, v33
    v_cvt_pk_bf16_f32 v25, v34, v35
    v_cvt_pk_bf16_f32 v26, v40, v41
    v_cvt_pk_bf16_f32 v27, v42, v43
    s_mov_b32 exec_lo, 0
    s_mov_b32 exec_hi, -1
    v_cvt_pk_bf16_f32 v24, v36, v37
    v_cvt_pk_bf16_f32 v25, v38, v39
    v_cvt_pk_bf16_f32 v26, v44, v45
    v_cvt_pk_bf16_f32 v27, v46, v47
    s_mov_b64 exec, -1
    v_min_u32 v24, -2, v24
    v_min_u32 v25, -2, v25
    v_min_u32 v26, -2, v26
    v_min_u32 v27, -2, v27
    buffer_store_dwordx4 v[24:27], v17, s[80:83], s8 offen sc1
    s_sleep 13
W_107:
    ds_read_b32 v30, v4 offset:28
    s_sub_u32 s39, s39, 1
    s_cbranch_scc1 KS_ABORT
    s_waitcnt lgkmcnt(0)
    v_cmp_eq_u32 vcc, 0, v30
    s_cbranch_vccnz W_107
    s_branch ZPE_109
ZP_108:
    s_sleep 1
ZPE_109:
    buffer_load_dwordx4 v[32:35], v18, s[80:83], s9 offen sc1
    s_sub_u32 s39, s39, 1
    s_cbranch_scc1 KS_ABORT
    s_waitcnt vmcnt(0)
    v_max3_u32 v44, v32, v33, v34
    v_max_u32 v44, v44, v35
    v_cmp_eq_u32 vcc, -1, v44
    s_cbranch_vccnz ZP_108
    v_permlane32_swap_b32 v32, v34
    v_permlane32_swap_b32 v33, v35
    s_nop 1
    v_permlane16_swap_b32 v32, v33
    v_permlane16_swap_b32 v34, v35
    v_dot2c_f32_bf16 v28, s10, v32
    v_dot2c_f32_bf16 v29, s11, v32
    v_dot2c_f32_bf16 v28, s10, v33
    v_dot2c_f32_bf16 v29, s11, v33
    v_dot2c_f32_bf16 v28, s10, v34
    v_dot2c_f32_bf16 v29, s11, v34
    v_dot2c_f32_bf16 v28, s10, v35
    v_dot2c_f32_bf16 v29, s11, v35
    s_nop 1
    v_add_f32_dpp v28, v28, v28 row_ror:8 row_mask:0xf bank_mask:0xf
    v_add_f32_dpp v29, v29, v29 row_ror:8 row_mask:0xf bank_mask:0xf
    s_nop 0
    v_add_f32_dpp v28, v28, v28 row_ror:4 row_mask:0xf bank_mask:0xf
    v_add_f32_dpp v29, v29, v29 row_ror:4 row_mask:0xf bank_mask:0xf
    s_mov_b32 exec_lo, 0x000f000f
    s_mov_b32 exec_hi, 0x000f000f
    ds_write_b64 v19, v[28:29] offset:1536
    s_waitcnt lgkmcnt(0)
    s_barrier
    s_endpgm
KS_G0:
    ds_write_b8 v15, v5 offset:68
    s_setprio 0
KS_G:
    s_waitcnt vmcnt(0)
KS_GN:
    s_sub_u32 s87, s38, 12
    s_and_b32 s95, s87, 1
    s_cselect_b32 s72, s28, s26
    s_cselect_b32 s73, s29, s27
    s_mov_b32 s74, 0x510000
    s_mov_b32 s75, 0x20000
    v_lshrrev_b32 v6, 3, v1
    v_lshrrev_b32 v7, 5, v1
    v_xor_b32 v6, v6, v7
    v_and_b32 v6, 1, v6
    v_lshl_add_u32 v6, s95, 1, v6
    v_xor_b32 v6, v6, v1
    v_and_b32 v6, 3, v6
    v_lshrrev_b32 v7, 2, v1
    v_mul_u32_u24 v7, 9216, v7
    v_lshl_add_u32 v46, v6, 4, v7
    s_lshl_b32 s96, s89, 6
    v_mov_b32 v6, s87
    s_mul_i32 s97, s95, 36864
    s_add_u32 s97, s97, 35328
    s_mov_b32 s68, s30
    s_mov_b32 s69, s31
    s_mov_b32 s70, 0x510000
    s_mov_b32 s71, 0x20000
    v_lshlrev_b32 v8, 4, v1
    s_mul_i32 s92, s89, 36864
    s_mul_i32 s93, s87, 9216
    s_add_u32 s92, s92, s93
    s_add_u32 s93, s93, 109184
    s_cmp_lt_u32 s41, 8
    s_cselect_b32 s94, 0, 100
    v_mov_b32 v9, s94
W_110:
    s_sleep 2
    ds_read_b32 v10, v9 offset:100
    s_sub_u32 s39, s39, 1
    s_cbranch_scc1 KS_ABORT
    s_waitcnt lgkmcnt(0)
    v_cmp_ne_u32 vcc, s84, v10
    s_cbranch_vccnz W_110
    s_cmp_ge_u32 s41, 8
    s_cselect_b64 vcc, -1, 0
    s_cbranch_scc1 KS_GD1
    s_add_u32 m0, s93, 0
    s_add_u32 s94, s92, 0
    buffer_load_dwordx4 v8, s[68:71], s94 offen offset:0 nt lds
    buffer_load_dwordx4 v8, s[68:71], s94 offen offset:1024 nt lds
    buffer_load_dwordx4 v8, s[68:71], s94 offen offset:2048 nt lds
    buffer_load_dwordx4 v8, s[68:71], s94 offen offset:3072 nt lds
    s_add_u32 m0, s93, 4096
    s_add_u32 s94, s92, 4096
    buffer_load_dwordx4 v8, s[68:71], s94 offen offset:0 nt lds
    buffer_load_dwordx4 v8, s[68:71], s94 offen offset:1024 nt lds
    buffer_load_dwordx4 v8, s[68:71], s94 offen offset:2048 nt lds
    buffer_load_dwordx4 v8, s[68:71], s94 offen offset:3072 nt lds
    s_add_u32 m0, s93, 8192
    s_add_u32 s94, s92, 8192
    buffer_load_dwordx4 v8, s[68:71], s94 offen offset:0 nt lds
KS_GD1:
    s_cmp_ge_u32 s87, 2
    s_cbranch_scc1 KS_GL
    buffer_load_dwordx4 v[48:51], v46, s[72:75], s96 offen nt
    s_sleep 5
    s_add_u32 s96, s96, 147456
    buffer_load_dwordx4 v[52:55], v46, s[72:75], s96 offen nt
    s_sleep 5
    s_add_u32 s96, s96, 147456
    buffer_load_dwordx4 v[56:59], v46, s[72:75], s96 offen nt
    s_sleep 5
    s_add_u32 s96, s96, 147456
    buffer_load_dwordx4 v[60:63], v46, s[72:75], s96 offen nt
    s_sleep 5
    s_add_u32 s96, s96, 147456
    buffer_load_dwordx4 v[64:67], v46, s[72:75], s96 offen nt
    s_sleep 5
    s_add_u32 s96, s96, 147456
    buffer_load_dwordx4 v[68:71], v46, s[72:75], s96 offen nt
    s_sleep 5
    s_add_u32 s96, s96, 147456
    buffer_load_dwordx4 v[72:75], v46, s[72:75], s96 offen nt
    s_sleep 5
    s_add_u32 s96, s96, 147456
    buffer_load_dwordx4 v[76:79], v46, s[72:75], s96 offen nt
    s_sleep 5
    s_add_u32 s96, s96, 147456
    buffer_load_dwordx4 v[80:83], v46, s[72:75], s96 offen nt
    s_sleep 5
    s_add_u32 s96, s96, 147456
    buffer_load_dwordx4 v[84:87], v46, s[72:75], s96 offen nt
    s_sleep 5
    s_add_u32 s96, s96, 147456
    buffer_load_dwordx4 v[88:91], v46, s[72:75], s96 offen nt
    s_sleep 5
    s_add_u32 s96, s96, 147456
    buffer_load_dwordx4 v[92:95], v46, s[72:75], s96 offen nt
    s_sleep 5
    s_add_u32 s96, s96, 147456
    buffer_load_dwordx4 v[96:99], v46, s[72:75], s96 offen nt
    s_sleep 5
    s_add_u32 s96, s96, 147456
    buffer_load_dwordx4 v[100:103], v46, s[72:75], s96 offen nt
    s_sleep 5
    s_add_u32 s96, s96, 147456
    buffer_load_dwordx4 v[104:107], v46, s[72:75], s96 offen nt
    s_sleep 5
    s_add_u32 s96, s96, 147456
    buffer_load_dwordx4 v[108:111], v46, s[72:75], s96 offen nt
    s_sleep 5
    s_add_u32 s96, s96, 147456
    buffer_load_dwordx4 v[112:115], v46, s[72:75], s96 offen nt
    s_sleep 5
    s_add_u32 s96, s96, 147456
    buffer_load_dwordx4 v[116:119], v46, s[72:75], s96 offen nt
    v_add_u32 v8, s97, v8
    s_waitcnt vmcnt(0)
    ds_write_b8 v6, v5 offset:40
W_111:
    s_sleep 2
    ds_read_b32 v10, v4 offset:52
    s_sub_u32 s39, s39, 1
    s_cbranch_scc1 KS_ABORT
    s_waitcnt lgkmcnt(0)
    v_cmp_ne_u32 vcc, s84, v10
    s_cbranch_vccnz W_111
    ds_write_b128 v8, v[48:51] offset:0
    ds_write_b128 v8, v[52:55] offset:1024
    ds_write_b128 v8, v[56:59] offset:2048
    ds_write_b128 v8, v[60:63] offset:3072
    ds_write_b128 v8, v[64:67] offset:4096
    ds_write_b128 v8, v[68:71] offset:5120
    ds_write_b128 v8, v[72:75] offset:6144
    ds_write_b128 v8, v[76:79] offset:7168
    ds_write_b128 v8, v[80:83] offset:8192
    ds_write_b128 v8, v[84:87] offset:9216
    ds_write_b128 v8, v[88:91] offset:10240
    ds_write_b128 v8, v[92:95] offset:11264
    ds_write_b128 v8, v[96:99] offset:12288
    ds_write_b128 v8, v[100:103] offset:13312
    ds_write_b128 v8, v[104:107] offset:14336
    ds_write_b128 v8, v[108:111] offset:15360
    ds_write_b128 v8, v[112:115] offset:16384
    ds_write_b128 v8, v[116:119] offset:17408
    s_branch KS_G4
KS_GL:
    s_add_u32 s96, s96, 2654208
    s_add_u32 s97, s97, 18432
    v_add_u32 v8, s97, v8
    s_waitcnt vmcnt(0)
    ds_write_b8 v6, v5 offset:40
W_112:
    s_sleep 2
    ds_read_b32 v10, v4 offset:52
    s_sub_u32 s39, s39, 1
    s_cbranch_scc1 KS_ABORT
    s_waitcnt lgkmcnt(0)
    v_cmp_ne_u32 vcc, s84, v10
    s_cbranch_vccnz W_112
    s_setprio 1
    s_add_u32 m0, s97, 0
    s_nop 0
    buffer_load_dwordx4 v46, s[72:75], s96 offen offset:0 lds
    s_add_u32 s96, s96, 146432
    buffer_load_dwordx4 v46, s[72:75], s96 offen offset:1024 lds
    s_add_u32 s96, s96, 146432
    buffer_load_dwordx4 v46, s[72:75], s96 offen offset:2048 lds
    s_add_u32 s96, s96, 146432
    buffer_load_dwordx4 v46, s[72:75], s96 offen offset:3072 lds
    s_add_u32 m0, s97, 4096
    s_add_u32 s96, s96, 150528
    buffer_load_dwordx4 v46, s[72:75], s96 offen offset:0 lds
    s_add_u32 s96, s96, 146432
    buffer_load_dwordx4 v46, s[72:75], s96 offen offset:1024 lds
    s_add_u32 s96, s96, 146432
    buffer_load_dwordx4 v46, s[72:75], s96 offen offset:2048 lds
    s_add_u32 s96, s96, 146432
    buffer_load_dwordx4 v46, s[72:75], s96 offen offset:3072 lds
    s_add_u32 m0, s97, 8192
    s_add_u32 s96, s96, 150528
    buffer_load_dwordx4 v46, s[72:75], s96 offen offset:0 lds
    s_add_u32 s96, s96, 146432
    buffer_load_dwordx4 v46, s[72:75], s96 offen offset:1024 lds
    s_add_u32 s96, s96, 146432
    buffer_load_dwordx4 v46, s[72:75], s96 offen offset:2048 lds
    s_add_u32 s96, s96, 146432
    buffer_load_dwordx4 v46, s[72:75], s96 offen offset:3072 lds
    s_add_u32 m0, s97, 12288
    s_add_u32 s96, s96, 150528
    buffer_load_dwordx4 v46, s[72:75], s96 offen offset:0 lds
    s_add_u32 s96, s96, 146432
    buffer_load_dwordx4 v46, s[72:75], s96 offen offset:1024 lds
    s_add_u32 s96, s96, 146432
    buffer_load_dwordx4 v46, s[72:75], s96 offen offset:2048 lds
    s_add_u32 s96, s96, 146432
    buffer_load_dwordx4 v46, s[72:75], s96 offen offset:3072 lds
    s_add_u32 m0, s97, 16384
    s_add_u32 s96, s96, 150528
    buffer_load_dwordx4 v46, s[72:75], s96 offen offset:0 lds
    s_add_u32 s96, s96, 146432
    buffer_load_dwordx4 v46, s[72:75], s96 offen offset:1024 lds
    s_setprio 0
    s_waitcnt vmcnt(0)
KS_G4:
    ds_write_b8 v6, v5 offset:192
    v_lshrrev_b32 v6, 3, v1
    v_xor_b32 v6, v6, v3
    v_and_b32 v6, 1, v6
    v_and_b32 v7, 2, v1
    v_or_b32 v6, v6, v7
    v_xor_b32 v6, s87, v6
    v_mul_u32_u24 v7, 18432, v7
    v_lshl_add_u32 v7, v6, 4, v7
    v_and_b32 v6, 1, v1
    v_lshl_add_u32 v7, v6, 3, v7
    v_bfe_u32 v6, v1, 2, 2
    v_lshl_add_u32 v6, v3, 3, v6
    v_lshl_add_u32 v7, v6, 6, v7
    v_add_u32 v8, 35328, v7
    v_and_b32 v9, 7, v1
    v_lshrrev_b32 v10, 1, v3
    v_and_b32 v11, 1, v3
    v_lshlrev_b32 v6, 5, v9
    v_lshl_add_u32 v6, v10, 8, v6
    v_lshl_add_u32 v6, v11, 4, v6
    v_add_u32 v6, 17088, v6
    s_lshl_b32 s92, s87, 4
    v_lshl_add_u32 v7, v9, 6, s92
    v_lshl_add_u32 v7, v11, 3, v7
    v_lshl_add_u32 v7, v10, 2, v7
    v_bfe_u32 v9, v1, 3, 1
    v_lshl_add_u32 v7, v9, 1, v7
W_113:
    s_sleep 2
    ds_read_b32 v10, v4 offset:192
    s_sub_u32 s39, s39, 1
    s_cbranch_scc1 KS_ABORT
    s_waitcnt lgkmcnt(0)
    v_cmp_ne_u32 vcc, s84, v10
    s_cbranch_vccnz W_113
W_114:
    s_sleep 2
    ds_read_b32 v10, v4 offset:12
    s_sub_u32 s39, s39, 1
    s_cbranch_scc1 KS_ABORT
    s_waitcnt lgkmcnt(0)
    v_cmp_ne_u32 vcc, s84, v10
    s_cbranch_vccnz W_114
    s_sleep 10
    ds_read_b64_tr_b16 v[48:49], v8 offset:0
    ds_read_b64_tr_b16 v[50:51], v8 offset:256
    ds_read_b64_tr_b16 v[52:53], v8 offset:2048
    ds_read_b64_tr_b16 v[54:55], v8 offset:2304
    ds_read_b64_tr_b16 v[56:57], v8 offset:4096
    ds_read_b64_tr_b16 v[58:59], v8 offset:4352
    ds_read_b64_tr_b16 v[60:61], v8 offset:6144
    ds_read_b64_tr_b16 v[62:63], v8 offset:6400
    ds_read_b64_tr_b16 v[64:65], v8 offset:8192
    ds_read_b64_tr_b16 v[66:67], v8 offset:8448
    ds_read_b64_tr_b16 v[68:69], v8 offset:10240
    ds_read_b64_tr_b16 v[70:71], v8 offset:10496
    ds_read_b64_tr_b16 v[72:73], v8 offset:12288
    ds_read_b64_tr_b16 v[74:75], v8 offset:12544
    ds_read_b64_tr_b16 v[76:77], v8 offset:14336
    ds_read_b64_tr_b16 v[78:79], v8 offset:14592
    ds_read_b64_tr_b16 v[80:81], v8 offset:16384
    ds_read_b64_tr_b16 v[82:83], v8 offset:16640
    ds_read_b64_tr_b16 v[84:85], v8 offset:18432
    ds_read_b64_tr_b16 v[86:87], v8 offset:18688
    ds_read_b64_tr_b16 v[88:89], v8 offset:20480
    ds_read_b64_tr_b16 v[90:91], v8 offset:20736
    ds_read_b64_tr_b16 v[92:93], v8 offset:22528
    ds_read_b64_tr_b16 v[94:95], v8 offset:22784
    ds_read_b64_tr_b16 v[96:97], v8 offset:24576
    ds_read_b64_tr_b16 v[98:99], v8 offset:24832
    ds_read_b64_tr_b16 v[100:101], v8 offset:26624
    ds_read_b64_tr_b16 v[102:103], v8 offset:26880
    ds_read_b64_tr_b16 v[104:105], v8 offset:28672
    ds_read_b64_tr_b16 v[106:107], v8 offset:28928
    ds_read_b64_tr_b16 v[108:109], v8 offset:30720
    ds_read_b64_tr_b16 v[110:111], v8 offset:30976
    ds_read_b64_tr_b16 v[112:113], v8 offset:32768
    ds_read_b64_tr_b16 v[114:115], v8 offset:33024
    ds_read_b64_tr_b16 v[116:117], v8 offset:34816
    ds_read_b64_tr_b16 v[118:119], v8 offset:35072
W_115:
    s_sleep 2
    ds_read_b32 v10, v4 offset:768
    s_sub_u32 s39, s39, 1
    s_cbranch_scc1 KS_ABORT
    s_waitcnt lgkmcnt(0)
    v_cmp_eq_u32 vcc, 0, v10
    s_cbranch_vccnz W_115
    s_setprio 3
KS_GC:
    s_mov_b32 exec_lo, 0x00ff00ff
    s_mov_b32 exec_hi, 0x00ff00ff
KS_GW:
    ds_read_b32 v0, v4 offset:32
    ds_read_b128 v[8:11], v6 offset:0
    ds_read_b128 v[12:15], v6 offset:512
    ds_read_b128 v[16:19], v6 offset:1024
    ds_read_b128 v[20:23], v6 offset:1536
    s_sub_u32 s39, s39, 1
    s_cbranch_scc1 KS_ABORT
    s_waitcnt lgkmcnt(4)
    v_cmp_eq_u32 vcc, 0, v0
    s_cbranch_vccnz KS_GW
    s_waitcnt lgkmcnt(3)
    v_mfma_f32_16x16x32_bf16 v[120:123], v[48:51], v[8:11], 0
    ds_read_b128 v[24:27], v6 offset:2048
    ds_read_b128 v[28:31], v6 offset:2560
    s_waitcnt lgkmcnt(4)
    v_mfma_f32_16x16x32_bf16 v[124:127], v[52:55], v[12:15], 0
    ds_read_b128 v[32:35], v6 offset:3072
    ds_read_b128 v[36:39], v6 offset:3584
    s_waitcnt lgkmcnt(5)
    v_mfma_f32_16x16x32_bf16 v[120:123], v[56:59], v[16:19], v[120:123]
    ds_read_b128 v[40:43], v6 offset:4096
    ds_read_b128 v[44:47], v6 offset:4608
    s_waitcnt lgkmcnt(6)
    v_mfma_f32_16x16x32_bf16 v[124:127], v[60:63], v[20:23], v[124:127]
    ds_read_b128 v[8:11], v6 offset:5120
    ds_read_b128 v[12:15], v6 offset:5632
    s_waitcnt lgkmcnt(7)
    v_mfma_f32_16x16x32_bf16 v[120:123], v[64:67], v[24:27], v[120:123]
    ds_read_b128 v[16:19], v6 offset:6144
    ds_read_b128 v[20:23], v6 offset:6656
    s_waitcnt lgkmcnt(8)
    v_mfma_f32_16x16x32_bf16 v[124:127], v[68:71], v[28:31], v[124:127]
    ds_read_b128 v[24:27], v6 offset:7168
    ds_read_b128 v[28:31], v6 offset:7680
    s_waitcnt lgkmcnt(9)
    v_mfma_f32_16x16x32_bf16 v[120:123], v[72:75], v[32:35], v[120:123]
    ds_read_b128 v[32:35], v6 offset:8192
    s_waitcnt lgkmcnt(9)
    v_mfma_f32_16x16x32_bf16 v[124:127], v[76:79], v[36:39], v[124:127]
    ds_read_b128 v[36:39], v6 offset:8704
    s_waitcnt lgkmcnt(9)
    v_mfma_f32_16x16x32_bf16 v[120:123], v[80:83], v[40:43], v[120:123]
    s_waitcnt lgkmcnt(8)
    v_mfma_f32_16x16x32_bf16 v[124:127], v[84:87], v[44:47], v[124:127]
    s_waitcnt lgkmcnt(7)
    v_mfma_f32_16x16x32_bf16 v[120:123], v[88:91], v[8:11], v[120:123]
    s_waitcnt lgkmcnt(6)
    v_mfma_f32_16x16x32_bf16 v[124:127], v[92:95], v[12:15], v[124:127]
    s_waitcnt lgkmcnt(5)
    v_mfma_f32_16x16x32_bf16 v[120:123], v[96:99], v[16:19], v[120:123]
    s_waitcnt lgkmcnt(4)
    v_mfma_f32_16x16x32_bf16 v[124:127], v[100:103], v[20:23], v[124:127]
    s_waitcnt lgkmcnt(3)
    v_mfma_f32_16x16x32_bf16 v[120:123], v[104:107], v[24:27], v[120:123]
    s_waitcnt lgkmcnt(2)
    v_mfma_f32_16x16x32_bf16 v[124:127], v[108:111], v[28:31], v[124:127]
    s_waitcnt lgkmcnt(1)
    v_mfma_f32_16x16x32_bf16 v[120:123], v[112:115], v[32:35], v[120:123]
    s_waitcnt lgkmcnt(0)
    v_mfma_f32_16x16x32_bf16 v[124:127], v[116:119], v[36:39], v[124:127]
    s_mov_b64 exec, -1
    s_nop 6
    v_pk_add_f32 v[120:121], v[120:121], v[124:125]
    v_pk_add_f32 v[122:123], v[122:123], v[126:127]
    s_nop 1
    v_permlane32_swap_b32 v121, v123
    v_permlane32_swap_b32 v120, v122
    s_nop 0
    v_mov_b32_dpp v120, v121 row_shr:8 row_mask:0xf bank_mask:0xc
    v_mov_b32_dpp v122, v123 row_shr:8 row_mask:0xf bank_mask:0xc
    v_cvt_pk_bf16_f32 v120, 0, v120
    v_mul_f32 v121, 0xbfb8aa3b, v120
    v_exp_f32 v121, v121
    v_cvt_pk_bf16_f32 v122, 0, v122
    v_add_f32 v121, 1.0, v121
    v_rcp_f32 v121, v121
    s_nop 0
    v_mul_f32 v121, v120, v121
    v_cvt_pk_bf16_f32 v121, 0, v121
    v_mul_f32 v121, v121, v122
    v_cvt_pk_bf16_f32 v121, v121, v121
    ds_write_b16 v7, v121 offset:1024
    s_waitcnt lgkmcnt(0)
    s_barrier
    s_setprio 0
    ds_read_b32 v0, v4 offset:24
    s_waitcnt lgkmcnt(0)
    v_cmp_eq_u32 vcc, 0, v0
    s_cbranch_vccnz KS_PEND
    s_barrier
    s_branch KS_GC
KS_PEND:
KS_ABORT:
KS_END:
    s_endpgm
.section .rodata,"a"
.p2align 6
.amdhsa_kernel sequential_preLN__ssm_conv_s4__moe_arch_mod__prompt_kernel
  .amdhsa_next_free_vgpr 128
  .amdhsa_next_free_sgpr 100
  .amdhsa_accum_offset 128
  .amdhsa_group_segment_fixed_size 0
  .amdhsa_kernarg_size 136
  .amdhsa_user_sgpr_count 2
  .amdhsa_user_sgpr_kernarg_segment_ptr 1
  .amdhsa_system_sgpr_workgroup_id_x 1
  .amdhsa_float_denorm_mode_32 3
.end_amdhsa_kernel
```

```asm
; @launch grid=(256,1,1) block=(1024,1,1) lds=154240
.amdgcn_target "amdgcn-amd-amdhsa--gfx950"
.text
.globl sequential_preLN__ssm_conv_s4__moe_arch_mod__prompt_kernel
.p2align 8
.type sequential_preLN__ssm_conv_s4__moe_arch_mod__prompt_kernel,@function
sequential_preLN__ssm_conv_s4__moe_arch_mod__prompt_kernel:
    s_cmp_ge_u32 s2, 256
    s_cbranch_scc1 KS_END
    s_load_dwordx16 s[4:19], s[0:1], 0
    s_load_dwordx16 s[20:35], s[0:1], 64
    s_load_dwordx2 s[36:37], s[0:1], 128
    v_readfirstlane_b32 s38, v0
    s_lshr_b32 s38, s38, 6
    s_and_b32 s40, s2, 7
    s_lshr_b32 s41, s2, 3
    s_cmp_lg_u32 s38, 0
    s_cbranch_scc1 KS_CPE
    s_getpc_b64 s[42:43]
KS_PC:
    s_and_b32 s92, s41, 7
    s_mul_i32 s92, s92, 4608
    v_and_b32 v126, 63, v0
    v_lshl_add_u32 v126, v126, 7, s92
    v_min_u32 v126, KS_END-KS_PC, v126
    global_load_dword v127, v126, s[42:43]
KS_CPE:
    s_add_u32 s92, s38, 8
    s_sub_u32 s93, s38, 4
    s_cmp_lt_u32 s38, 8
    s_cselect_b32 s92, s92, s93
    s_cmp_lt_u32 s38, 4
    s_cselect_b32 s38, s38, s92
    v_and_b32 v1, 63, v0
    v_and_b32 v2, 15, v1
    v_lshrrev_b32 v3, 4, v1
    v_mov_b32 v4, 0
    v_mov_b32 v5, 1
    s_mov_b32 s39, 524288
    s_mov_b32 s84, 0x01010101
    s_lshl_b32 s90, s40, 5
    s_add_u32 s90, s90, s41
    s_mul_i32 s89, s40, 18
    s_add_u32 s89, s89, s41
    s_cmp_lt_u32 s38, 4
    s_cbranch_scc1 KS_L
    s_cmp_ge_u32 s38, 12
    s_cbranch_scc1 KS_X
    s_setprio 2
    s_lshr_b32 s87, s38, 2
    s_sub_u32 s87, s87, 1
    s_mul_i32 s86, s87, 3
    s_xor_b32 s86, s86, s38
    s_and_b32 s86, s86, 3
    s_lshl_b32 s88, s90, 1
    s_add_u32 s88, s88, s87
    s_lshl_b32 s92, s86, 11
    s_add_u32 s92, s92, 146048
    v_lshl_add_u32 v28, v1, 3, s92
    s_cmp_eq_u32 s86, 3
    s_cbranch_scc1 PX_1
    v_lshlrev_b32 v26, 3, v2
    v_mov_b32 v21, 0x80
    s_cmp_eq_u32 s86, 1
    s_cbranch_scc1 PX_2
    s_cmp_eq_u32 s86, 2
    s_cbranch_scc1 PX_3
    v_lshl_add_u32 v26, v3, 1, v26
    v_mov_b32 v22, 1
    s_branch PX_4
PX_2:
    v_cmp_gt_u32 vcc, 2, v3
    v_lshl_add_u32 v20, v3, 2, v26
    v_add_u32 v20, 256, v20
    v_lshl_add_u32 v26, v3, 8, v26
    v_cndmask_b32 v26, v26, v20, vcc
    v_cndmask_b32 v22, v21, 2, vcc
    v_cndmask_b32 v21, 4, v21, vcc
    s_branch PX_4
PX_3:
    v_lshl_add_u32 v26, v3, 9, v26
    v_add_u32 v26, 0x400, v26
    v_mov_b32 v22, 0x100
PX_4:
    v_mad_u32_u24 v26, v22, s87, v26
    v_add_u32 v27, v26, v21
    s_movk_i32 s96, 31232
    s_movk_i32 s97, -19072
    s_lshl_b32 s95, s87, 9
    v_cvt_f32_u32 v20, v26
    v_max_u32 v22, 0x800, v26
    v_cvt_f32_u32 v21, v27
    v_max_u32 v23, 0x800, v27
    v_cmp_gt_u32 vcc, 0x80, v26
    v_lshrrev_b32 v24, 16, v20
    v_add3_u32 v24, v24, v22, s97
    v_cndmask_b32 v24, v24, v26, vcc
    v_cmp_gt_u32 vcc, 0x80, v27
    v_lshrrev_b32 v25, 16, v21
    v_add3_u32 v25, v25, v23, s97
    v_cndmask_b32 v25, v25, v27, vcc
    v_min_u32 v24, 642, v24
    v_lshl_add_u32 v24, v24, 1, s96
    v_min_u32 v25, 642, v25
    v_lshl_add_u32 v25, v25, 1, s96
    v_add_u32 v29, s95, v28
    v_lshl_or_b32 v24, v25, 16, v24
    v_lshl_or_b32 v25, v27, 16, v26
    ds_write_b64 v29, v[24:25]
PX_1:
KS_GRP:
    s_lshl_b32 s92, s88, 8
    v_lshl_add_u32 v20, v1, 2, s92
    s_lshl_b32 s92, s88, 1
    v_mov_b32 v21, s92
    s_mul_i32 s85, s87, 36672
    s_add_u32 s85, s85, 35840
    s_waitcnt lgkmcnt(0)
    global_load_ushort v46, v21, s[18:19]
    global_load_dword v40, v20, s[6:7]
    global_load_dword v41, v20, s[8:9]
    global_load_dword v42, v20, s[10:11]
    global_load_dword v43, v20, s[12:13]
    global_load_dword v44, v20, s[14:15]
    global_load_dword v45, v20, s[16:17]
    global_load_ushort v107, v21, s[20:21]
    s_barrier
    s_movk_i32 s96, 31232
    s_cmp_eq_u32 s87, 2
    s_cbranch_scc1 PREE_7
    v_mov_b32 v32, 641
    s_cmp_eq_u32 s87, 1
    s_cbranch_scc1 PREB_5
    v_mov_b32 v33, 32514
    s_cmp_eq_u32 s86, 1
    s_cbranch_scc1 PRE_9
    s_cmp_eq_u32 s86, 2
    s_cbranch_scc1 PRE_10
    s_cmp_eq_u32 s86, 3
    s_cbranch_scc1 PRE_11
    v_lshlrev_b32 v23, 1, v1
    v_sub_u32 v30, 93, v23
    v_cmp_lt_u32 vcc, 61, v30
    v_lshlrev_b32 v31, 2, v30
    v_add_u32 v31, 32010, v31
    v_cndmask_b32 v24, v31, v33, vcc
    v_sub_u32 v30, 92, v23
    v_cmp_lt_u32 vcc, 61, v30
    v_lshlrev_b32 v31, 2, v30
    v_add_u32 v31, 32010, v31
    v_cndmask_b32 v25, v31, v33, vcc
    v_sub_u32 v30, 94, v23
    v_cmp_lt_u32 vcc, 62, v30
    v_lshlrev_b32 v31, 2, v30
    v_add_u32 v31, 32008, v31
    v_cndmask_b32 v26, v31, v33, vcc
    v_sub_u32 v30, 93, v23
    v_cmp_lt_u32 vcc, 62, v30
    v_lshlrev_b32 v31, 2, v30
    v_add_u32 v31, 32008, v31
    v_cndmask_b32 v27, v31, v33, vcc
    s_branch PREW_6
PRE_9:
    v_min_u32 v23, 47, v1
    v_lshlrev_b32 v23, 1, v23
    v_sub_u32 v30, 64, v23
    v_cmp_lt_u32 vcc, 63, v30
    v_lshlrev_b32 v31, 2, v30
    v_add_u32 v31, 32258, v31
    v_cndmask_b32 v24, v31, v33, vcc
    v_sub_u32 v30, 63, v23
    v_cmp_lt_u32 vcc, 63, v30
    v_lshlrev_b32 v31, 2, v30
    v_add_u32 v31, 32258, v31
    v_cndmask_b32 v25, v31, v33, vcc
    v_sub_u32 v30, 62, v23
    v_cmp_lt_u32 vcc, 63, v30
    v_lshlrev_b32 v31, 2, v30
    v_add_u32 v31, 32258, v31
    v_cndmask_b32 v27, v31, v33, vcc
    v_mov_b32 v26, v25
    s_branch PREW_6
PRE_10:
    v_min_u32 v23, 47, v1
    v_lshlrev_b32 v23, 1, v23
    v_sub_u32 v30, 64, v23
    v_cmp_lt_u32 vcc, 63, v30
    v_lshlrev_b32 v31, 2, v30
    v_add_u32 v31, 32260, v31
    v_cndmask_b32 v24, v31, v33, vcc
    v_sub_u32 v30, 63, v23
    v_cmp_lt_u32 vcc, 63, v30
    v_lshlrev_b32 v31, 2, v30
    v_add_u32 v31, 32260, v31
    v_cndmask_b32 v25, v31, v33, vcc
    v_sub_u32 v30, 62, v23
    v_cmp_lt_u32 vcc, 63, v30
    v_lshlrev_b32 v31, 2, v30
    v_add_u32 v31, 32260, v31
    v_cndmask_b32 v27, v31, v33, vcc
    v_mov_b32 v26, v25
    s_branch PREW_6
PRE_11:
    v_cmp_gt_u32 vcc, 9, v1
    v_add_u32 v23, 0x100, v1
    v_mov_b32 v33, 0x200
    v_cndmask_b32 v23, v23, v1, vcc
    v_lshlrev_b32 v23, 1, v23
    v_sub_u32 v30, 544, v23
    v_cvt_f32_i32 v31, v30
    v_cmp_gt_u32 vcc, 0x100, v30
    v_cvt_pk_bf16_f32 v31, v31, v31
    v_and_b32 v31, 0xffff, v31
    v_subrev_u32 v31, 0x4280, v31
    v_cndmask_b32 v31, v31, v30, vcc
    v_cmp_lt_u32 vcc, 0x20d, v30
    v_or_b32 v30, 1, v23
    s_nop 0
    v_cndmask_b32 v31, v31, v32, vcc
    v_cmp_eq_u32 vcc, 0x25d, v30
    s_nop 1
    v_cndmask_b32 v31, v31, v33, vcc
    v_lshl_add_u32 v24, v31, 1, s96
    v_add_u32 v23, 1, v23
    v_sub_u32 v30, 544, v23
    v_cvt_f32_i32 v31, v30
    v_cmp_gt_u32 vcc, 0x100, v30
    v_cvt_pk_bf16_f32 v31, v31, v31
    v_and_b32 v31, 0xffff, v31
    v_subrev_u32 v31, 0x4280, v31
    v_cndmask_b32 v31, v31, v30, vcc
    v_cmp_lt_u32 vcc, 0x20d, v30
    v_or_b32 v30, 1, v23
    s_nop 0
    v_cndmask_b32 v31, v31, v32, vcc
    v_cmp_eq_u32 vcc, 0x25d, v30
    s_nop 1
    v_cndmask_b32 v31, v31, v33, vcc
    v_lshl_add_u32 v25, v31, 1, s96
    v_add_u32 v23, 1, v23
    v_sub_u32 v30, 544, v23
    v_cvt_f32_i32 v31, v30
    v_cmp_gt_u32 vcc, 0x100, v30
    v_cvt_pk_bf16_f32 v31, v31, v31
    v_and_b32 v31, 0xffff, v31
    v_subrev_u32 v31, 0x4280, v31
    v_cndmask_b32 v31, v31, v30, vcc
    v_cmp_lt_u32 vcc, 0x20d, v30
    v_or_b32 v30, 1, v23
    s_nop 0
    v_cndmask_b32 v31, v31, v32, vcc
    v_cmp_eq_u32 vcc, 0x25d, v30
    s_nop 1
    v_cndmask_b32 v31, v31, v33, vcc
    v_lshl_add_u32 v27, v31, 1, s96
    v_mov_b32 v26, v25
    s_branch PREW_6
PREB_5:
    s_lshl_b32 s93, s86, 7
    s_add_u32 s93, s93, 18
    v_lshl_add_u32 v23, v1, 1, s93
    v_sub_u32 v30, 544, v23
    v_cvt_f32_i32 v31, v30
    v_cmp_gt_u32 vcc, 0x100, v30
    v_cvt_pk_bf16_f32 v31, v31, v31
    v_and_b32 v31, 0xffff, v31
    v_subrev_u32 v31, 0x4280, v31
    v_cndmask_b32 v31, v31, v30, vcc
    v_cmp_lt_u32 vcc, 0x20d, v30
    s_nop 1
    v_cndmask_b32 v31, v31, v32, vcc
    v_lshl_add_u32 v24, v31, 1, s96
    v_add_u32 v23, 1, v23
    v_sub_u32 v30, 544, v23
    v_cvt_f32_i32 v31, v30
    v_cmp_gt_u32 vcc, 0x100, v30
    v_cvt_pk_bf16_f32 v31, v31, v31
    v_and_b32 v31, 0xffff, v31
    v_subrev_u32 v31, 0x4280, v31
    v_cndmask_b32 v31, v31, v30, vcc
    v_cmp_lt_u32 vcc, 0x20d, v30
    s_nop 1
    v_cndmask_b32 v31, v31, v32, vcc
    v_lshl_add_u32 v25, v31, 1, s96
    v_add_u32 v23, 1, v23
    v_sub_u32 v30, 544, v23
    v_cvt_f32_i32 v31, v30
    v_cmp_gt_u32 vcc, 0x100, v30
    v_cvt_pk_bf16_f32 v31, v31, v31
    v_and_b32 v31, 0xffff, v31
    v_subrev_u32 v31, 0x4280, v31
    v_cndmask_b32 v31, v31, v30, vcc
    v_cmp_lt_u32 vcc, 0x20d, v30
    s_nop 1
    v_cndmask_b32 v31, v31, v32, vcc
    v_lshl_add_u32 v26, v31, 1, s96
    s_sub_u32 s93, s86, 1
    s_cmp_lt_u32 s93, 2
    s_cselect_b32 s94, 47, 63
    s_mul_i32 s93, s93, 384
    s_add_u32 s93, s93, 35664
    s_cmp_eq_u32 s86, 0
    s_cselect_b32 s93, 35152, s93
    s_cmp_eq_u32 s86, 3
    s_cselect_b32 s93, 32528, s93
    s_cselect_b32 s95, 0x100, 0
    v_cmp_gt_u32 vcc, 9, v1
    v_min_u32 v23, s94, v1
    v_add_u32 v30, s95, v23
    v_cndmask_b32 v23, v30, v23, vcc
    s_sub_u32 s93, s93, 5244
    v_lshl_add_u32 v27, v23, 2, s93
    v_lshl_or_b32 v24, v25, 16, v24
    v_lshl_or_b32 v25, v27, 16, v26
    ds_write_b64 v28, v[24:25] offset:1024
    v_mov_b32 v24, s86
    ds_write_b8 v24, v5 offset:212
    s_branch PREE_7
PREW_6:
    v_lshl_or_b32 v24, v25, 16, v24
    v_lshl_or_b32 v25, v27, 16, v26
    ds_write_b64 v28, v[24:25] offset:1536
    v_mov_b32 v24, s86
    ds_write_b8 v24, v5 offset:208
PREE_7:
    s_mul_i32 s93, s86, 8704
    s_min_u32 s94, s93, 22304
    s_add_u32 s94, s94, s85
    s_lshl_b32 s92, s87, 4
    v_mov_b32 v14, s92
    v_add_u32 v15, s86, v14
    v_lshl_add_u32 v72, v1, 3, s94
    v_add_u32 v73, 2176, v72
    v_add_u32 v74, 4352, v72
    v_add_u32 v75, 6528, v72
    v_mul_u32_u24 v126, 544, v2
    v_lshl_add_u32 v126, v3, 4, v126
    v_add_u32 v126, s85, v126
    v_add_u32 v127, s93, v126
    v_lshlrev_b32 v20, 3, v3
    v_sub_u32 v20, v20, v2
    v_add_u32 v21, 16, v20
    v_lshrrev_b32 v21, 1, v21
    v_and_b32 v23, 1, v21
    s_movk_i32 s93, -5244
    v_and_b32 v22, 1, v2
    s_add_u32 s92, s85, 32528
    v_lshl_add_u32 v21, v21, 2, s92
    s_movk_i32 s92, 1344
    s_movk_i32 s94, 192
    v_mad_i32_i24 v21, v23, s93, v21
    v_mad_u32_u24 v6, v22, s92, v21
    v_add_u32 v7, 640, v6
    v_mad_u32_u24 v23, v22, s94, v21
    v_add_u32 v13, 3136, v23
    v_lshlrev_b32 v23, 2, v3
    v_sub_u32 v23, v23, v2
    s_add_u32 s92, s85, 29968
    v_lshl_add_u32 v11, v23, 2, s92
    s_movk_i32 s93, 5244
    v_mad_u32_u24 v11, v22, s93, v11
    s_mul_i32 s94, s87, 4672
    s_add_u32 s94, s94, 3072
    v_lshl_add_u32 v23, v2, 5, s94
    v_lshl_add_u32 v8, v3, 4, v23
    v_bfe_u32 v20, v1, 2, 2
    v_and_b32 v21, 3, v1
    v_lshl_add_u32 v20, v3, 3, v20
    v_lshlrev_b32 v105, 2, v21
    v_lshl_add_u32 v21, v21, 3, s85
    v_lshl_add_u32 v9, v20, 4, v21
    v_lshl_add_u32 v10, v20, 5, v21
    v_lshlrev_b32 v12, 4, v1
    s_add_u32 s64, s36, 0x600000
    s_addc_u32 s65, s37, 0
    s_mov_b32 s66, 0x240000
    s_mov_b32 s67, 0x20000
    s_mov_b32 s10, 0x8080
    s_lshl_b32 s92, s86, 19
    s_lshl_b32 s93, s90, 6
    s_add_u32 s92, s92, s93
    s_lshl_b32 s93, s86, 16
    s_lshl_b32 s95, s88, 6
    s_add_u32 s93, s93, s95
    s_add_u32 s93, s93, 2064384
    s_cmp_eq_u32 s87, 2
    s_cselect_b32 s6, s93, s92
    s_cselect_b32 s8, 0x1080, s10
    s_cselect_b32 s92, 1, 3
    s_and_b32 s92, s92, s86
    s_lshl_b32 s92, s92, 11
    s_xor_b32 s6, s6, s92
    s_and_b32 s10, s6, 0x7c0
    s_xor_b32 s6, s6, s10
    s_xor_b32 s7, s6, 0x6000
    s_and_b32 s9, s87, 1
    s_lshl_b32 s9, s9, 4
    s_mov_b32 s12, 0x55555555
    s_mov_b32 s13, 0x55555555
    s_lshl_b32 s92, s86, 8
    s_add_u32 s92, s92, s85
    s_add_u32 s92, s92, 36
    v_lshl_add_u32 v124, v1, 2, s92
    s_movk_i32 s92, 192
    s_cmp_eq_u32 s86, 0
    s_cselect_b32 s92, 256, s92
    s_cmp_eq_u32 s86, 3
    s_cselect_b32 s92, 1344, s92
    v_mov_b32 v20, s85
    ds_write_b16 v20, v4 offset:32514
    s_mov_b32 s18, s92
    v_mov_b32 v125, v28
W_12:
    ds_read_b64 v[18:19], v4 offset:208
    s_sub_u32 s39, s39, 1
    s_cbranch_scc1 KS_ABORT
    s_waitcnt lgkmcnt(0)
    v_and_b32 v18, v18, v19
    v_cmp_ne_u32 vcc, s84, v18
    s_cbranch_vccnz W_12
    ds_read2st64_b64 v[28:31], v125 offset0:0 offset1:1
    ds_read2st64_b64 v[32:35], v125 offset0:2 offset1:3
    s_waitcnt lgkmcnt(0)
    v_add_u32_sdwa v108, s85, v28 dst_sel:DWORD dst_unused:UNUSED_PAD src0_sel:DWORD src1_sel:WORD_0
    v_add_u32_sdwa v109, s85, v28 dst_sel:DWORD dst_unused:UNUSED_PAD src0_sel:DWORD src1_sel:WORD_1
    v_cvt_f32_u32_sdwa v110, v29 dst_sel:DWORD dst_unused:UNUSED_PAD src0_sel:WORD_0
    v_cvt_f32_u32_sdwa v111, v29 dst_sel:DWORD dst_unused:UNUSED_PAD src0_sel:WORD_1
    v_add_u32_sdwa v112, s85, v30 dst_sel:DWORD dst_unused:UNUSED_PAD src0_sel:DWORD src1_sel:WORD_0
    v_add_u32_sdwa v113, s85, v30 dst_sel:DWORD dst_unused:UNUSED_PAD src0_sel:DWORD src1_sel:WORD_1
    v_cvt_f32_u32_sdwa v114, v31 dst_sel:DWORD dst_unused:UNUSED_PAD src0_sel:WORD_0
    v_cvt_f32_u32_sdwa v115, v31 dst_sel:DWORD dst_unused:UNUSED_PAD src0_sel:WORD_1
    v_add_u32_sdwa v116, s85, v32 dst_sel:DWORD dst_unused:UNUSED_PAD src0_sel:DWORD src1_sel:WORD_0
    v_add_u32_sdwa v117, s85, v32 dst_sel:DWORD dst_unused:UNUSED_PAD src0_sel:DWORD src1_sel:WORD_1
    v_add_u32_sdwa v118, s85, v33 dst_sel:DWORD dst_unused:UNUSED_PAD src0_sel:DWORD src1_sel:WORD_0
    v_add_u32_sdwa v119, s85, v33 dst_sel:DWORD dst_unused:UNUSED_PAD src0_sel:DWORD src1_sel:WORD_1
    v_add_u32_sdwa v120, s85, v34 dst_sel:DWORD dst_unused:UNUSED_PAD src0_sel:DWORD src1_sel:WORD_0
    v_add_u32_sdwa v121, s85, v34 dst_sel:DWORD dst_unused:UNUSED_PAD src0_sel:DWORD src1_sel:WORD_1
    v_add_u32_sdwa v122, s85, v35 dst_sel:DWORD dst_unused:UNUSED_PAD src0_sel:DWORD src1_sel:WORD_0
    v_add_u32_sdwa v123, s85, v35 dst_sel:DWORD dst_unused:UNUSED_PAD src0_sel:DWORD src1_sel:WORD_1
    v_add_u32 v125, s18, v119
    s_lshl_b32 s92, s87, 5
    s_add_u32 s92, s92, s41
    s_cmp_ge_u32 s92, 88
    s_cbranch_scc1 KC_RECV
    s_mov_b32 s92, 0x3fb8aa3b
    s_mov_b32 s93, 0x32a57060
    s_mov_b32 s94, 0x3e22f983
    s_mov_b32 s95, 0x31dc9c88
    s_waitcnt vmcnt(7)
    v_lshlrev_b32 v16, 16, v46
    v_mul_f32 v17, s92, v16
    v_fma_f32 v19, v16, s92, -v17
    v_fmac_f32 v19, s93, v16
    v_exp_f32 v17, v17
    v_mul_f32 v19, 0x3f317218, v19
    v_fmac_f32 v17, v17, v19
    v_cvt_pk_bf16_f32 v16, 0, v17
    s_waitcnt vmcnt(5)
    ds_write_b32 v4, v5 offset:36
    v_lshlrev_b32 v20, 16, v40
    v_and_b32 v21, 0xffff0000, v40
    v_lshlrev_b32 v22, 16, v41
    v_and_b32 v23, 0xffff0000, v41
    v_pk_mul_f32 v[20:21], v[20:21], v[16:17] op_sel_hi:[1,0]
    v_pk_mul_f32 v[22:23], v[22:23], v[16:17] op_sel_hi:[1,0]
    v_max_f32 v36, v20, v21
    v_pk_mul_f32 v[68:69], v[22:23], s[94:95] op_sel_hi:[1,0]
    v_pk_fma_f32 v[70:71], v[22:23], s[94:95], v[68:69] op_sel_hi:[1,0,1] neg_lo:[0,0,1] neg_hi:[0,0,1]
    v_pk_fma_f32 v[70:71], v[22:23], s[94:95], v[70:71] op_sel:[0,1,0]
    s_cmp_eq_u32 s86, 3
    s_cbranch_scc1 SK_14
    s_waitcnt vmcnt(1)
    v_lshlrev_b32 v24, 16, v42
    v_and_b32 v25, 0xffff0000, v42
    v_lshlrev_b32 v26, 16, v43
    v_and_b32 v27, 0xffff0000, v43
    v_lshlrev_b32 v28, 16, v44
    v_and_b32 v29, 0xffff0000, v44
    v_lshlrev_b32 v30, 16, v45
    v_and_b32 v31, 0xffff0000, v45
    v_pk_mul_f32 v[24:25], v[24:25], v[16:17] op_sel_hi:[1,0]
    v_pk_mul_f32 v[26:27], v[26:27], v[16:17] op_sel_hi:[1,0]
    v_pk_mul_f32 v[90:91], v[30:31], v[26:27]
    v_pk_mul_f32 v[92:93], v[30:31], v[24:25]
    v_pk_fma_f32 v[34:35], v[28:29], v[26:27], v[92:93]
    v_pk_fma_f32 v[32:33], v[28:29], v[24:25], v[90:91] neg_lo:[0,0,1] neg_hi:[0,0,1]
    v_max3_f32 v37, abs(v34), abs(v35), abs(v32)
    v_max_f32 v37, v37, abs(v33)
SK_14:
    s_waitcnt vmcnt(0)
    s_nop 0
    v_permlane32_swap_b32 v36, v37
    v_max_f32 v36, v36, v37
    s_nop 1
    v_max_f32_dpp v36, v36, v36 row_ror:8 row_mask:0xf bank_mask:0xf
    s_nop 1
    v_max_f32_dpp v36, v36, v36 row_ror:4 row_mask:0xf bank_mask:0xf
    s_nop 1
    v_max_f32_dpp v36, v36, v36 row_ror:2 row_mask:0xf bank_mask:0xf
    s_nop 1
    v_max_f32_dpp v36, v36, v36 row_ror:1 row_mask:0xf bank_mask:0xf
    v_mov_b32 v38, v36
    s_nop 1
    v_permlane16_swap_b32 v36, v38
    v_max_f32 v36, v36, v38
    s_nop 0
    v_readlane_b32 s14, v36, 0
    v_readlane_b32 s15, v36, 32
    s_add_u32 s15, s15, 0x7fffff
    s_lshr_b32 s15, s15, 23
    s_max_u32 s15, s15, 24
    s_sub_u32 s16, 269, s15
    s_lshl_b32 s16, s16, 23
    v_subrev_f32 v20, s14, v20
    v_subrev_f32 v21, s14, v21
    v_mul_f32 v20, 0x3fb8aa3b, v20
    v_mul_f32 v21, 0x3fb8aa3b, v21
    s_cmp_eq_u32 s86, 3
    s_cbranch_scc1 JOB_18
    s_cmp_eq_u32 s86, 1
    s_cbranch_scc1 JOB_16
    s_cmp_eq_u32 s86, 2
    s_cbranch_scc1 JOB_17
    v_mul_f32 v91, 0x43000000, v68
    v_mul_f32 v90, 0x43000000, v20
    v_mul_f32 v95, 0x43000000, v69
    v_mul_f32 v94, 0x43000000, v21
    v_fract_f32 v91, v91
    v_fract_f32 v95, v95
    v_fmac_f32 v91, 0x43000000, v70
    v_fmac_f32 v95, 0x43000000, v71
    v_exp_f32 v90, v90
    v_cos_f32 v92, v91
    v_sin_f32 v91, v91
    v_exp_f32 v94, v94
    v_cos_f32 v96, v95
    v_sin_f32 v95, v95
    v_mul_f32 v44, v90, v92
    v_mul_f32 v46, v90, v91
    v_mul_f32 v45, v94, v96
    v_mul_f32 v47, v94, v95
    v_pk_mul_f32 v[32:33], v[32:33], s[16:17] op_sel_hi:[1,0]
    v_pk_mul_f32 v[34:35], v[34:35], s[16:17] op_sel_hi:[1,0]
    v_fract_f32 v91, v68
    v_fract_f32 v95, v69
    v_fmac_f32 v91, 1.0, v70
    v_fmac_f32 v95, 1.0, v71
    v_exp_f32 v90, v20
    v_cos_f32 v92, v91
    v_sin_f32 v91, v91
    v_exp_f32 v94, v21
    v_cos_f32 v96, v95
    v_sin_f32 v95, v95
    v_mul_f32 v40, v90, v92
    v_mul_f32 v42, v90, v91
    v_mul_f32 v41, v94, v96
    v_mul_f32 v43, v94, v95
    v_pk_mul_f32 v[90:91], v[34:35], v[46:47]
    v_pk_mul_f32 v[94:95], v[34:35], v[42:43]
    v_pk_mul_f32 v[92:93], v[34:35], v[44:45]
    v_pk_mul_f32 v[96:97], v[34:35], v[40:41]
    v_pk_fma_f32 v[62:63], v[32:33], v[46:47], v[92:93]
    v_pk_fma_f32 v[54:55], v[32:33], v[42:43], v[96:97]
    v_pk_fma_f32 v[60:61], v[32:33], v[44:45], v[90:91] neg_lo:[0,0,1] neg_hi:[0,0,1]
    v_pk_fma_f32 v[52:53], v[32:33], v[40:41], v[94:95] neg_lo:[0,0,1] neg_hi:[0,0,1]
    v_cvt_pk_f16_f32 v98, v32, v34
    v_cvt_pk_f16_f32 v99, v33, v35
    v_cvt_pk_f16_f32 v100, v60, v62
    v_cvt_pk_f16_f32 v101, v61, v63
    ds_write2_b64 v72, v[98:99], v[100:101] offset0:0 offset1:68
    v_pk_mul_f32 v[90:91], v[54:55], v[46:47]
    v_pk_mul_f32 v[94:95], v[54:55], v[42:43]
    v_pk_mul_f32 v[92:93], v[54:55], v[44:45]
    v_pk_mul_f32 v[96:97], v[54:55], v[40:41]
    v_pk_fma_f32 v[62:63], v[52:53], v[46:47], v[92:93]
    v_pk_fma_f32 v[58:59], v[52:53], v[42:43], v[96:97]
    v_pk_fma_f32 v[60:61], v[52:53], v[44:45], v[90:91] neg_lo:[0,0,1] neg_hi:[0,0,1]
    v_pk_fma_f32 v[56:57], v[52:53], v[40:41], v[94:95] neg_lo:[0,0,1] neg_hi:[0,0,1]
    v_cvt_pk_f16_f32 v76, v52, v54
    v_cvt_pk_f16_f32 v77, v53, v55
    v_cvt_pk_f16_f32 v78, v60, v62
    v_cvt_pk_f16_f32 v79, v61, v63
    ds_write2_b64 v72, v[76:77], v[78:79] offset0:136 offset1:204
    v_pk_mul_f32 v[90:91], v[58:59], v[46:47]
    v_pk_mul_f32 v[94:95], v[58:59], v[42:43]
    v_pk_mul_f32 v[92:93], v[58:59], v[44:45]
    v_pk_mul_f32 v[96:97], v[58:59], v[40:41]
    v_pk_fma_f32 v[62:63], v[56:57], v[46:47], v[92:93]
    v_pk_fma_f32 v[54:55], v[56:57], v[42:43], v[96:97]
    v_pk_fma_f32 v[60:61], v[56:57], v[44:45], v[90:91] neg_lo:[0,0,1] neg_hi:[0,0,1]
    v_pk_fma_f32 v[52:53], v[56:57], v[40:41], v[94:95] neg_lo:[0,0,1] neg_hi:[0,0,1]
    v_cvt_pk_f16_f32 v98, v56, v58
    v_cvt_pk_f16_f32 v99, v57, v59
    v_cvt_pk_f16_f32 v100, v60, v62
    v_cvt_pk_f16_f32 v101, v61, v63
    ds_write2_b64 v73, v[98:99], v[100:101] offset0:0 offset1:68
    v_pk_mul_f32 v[90:91], v[54:55], v[46:47]
    v_pk_mul_f32 v[94:95], v[54:55], v[42:43]
    v_pk_mul_f32 v[92:93], v[54:55], v[44:45]
    v_pk_mul_f32 v[96:97], v[54:55], v[40:41]
    v_pk_fma_f32 v[62:63], v[52:53], v[46:47], v[92:93]
    v_pk_fma_f32 v[58:59], v[52:53], v[42:43], v[96:97]
    v_pk_fma_f32 v[60:61], v[52:53], v[44:45], v[90:91] neg_lo:[0,0,1] neg_hi:[0,0,1]
    v_pk_fma_f32 v[56:57], v[52:53], v[40:41], v[94:95] neg_lo:[0,0,1] neg_hi:[0,0,1]
    v_cvt_pk_f16_f32 v76, v52, v54
    v_cvt_pk_f16_f32 v77, v53, v55
    v_cvt_pk_f16_f32 v78, v60, v62
    v_cvt_pk_f16_f32 v79, v61, v63
    ds_write2_b64 v73, v[76:77], v[78:79] offset0:136 offset1:204
    v_pk_mul_f32 v[90:91], v[58:59], v[46:47]
    v_pk_mul_f32 v[94:95], v[58:59], v[42:43]
    v_pk_mul_f32 v[92:93], v[58:59], v[44:45]
    v_pk_mul_f32 v[96:97], v[58:59], v[40:41]
    v_pk_fma_f32 v[62:63], v[56:57], v[46:47], v[92:93]
    v_pk_fma_f32 v[54:55], v[56:57], v[42:43], v[96:97]
    v_pk_fma_f32 v[60:61], v[56:57], v[44:45], v[90:91] neg_lo:[0,0,1] neg_hi:[0,0,1]
    v_pk_fma_f32 v[52:53], v[56:57], v[40:41], v[94:95] neg_lo:[0,0,1] neg_hi:[0,0,1]
    v_cvt_pk_f16_f32 v98, v56, v58
    v_cvt_pk_f16_f32 v99, v57, v59
    v_cvt_pk_f16_f32 v100, v60, v62
    v_cvt_pk_f16_f32 v101, v61, v63
    ds_write2_b64 v74, v[98:99], v[100:101] offset0:0 offset1:68
    v_pk_mul_f32 v[90:91], v[54:55], v[46:47]
    v_pk_mul_f32 v[94:95], v[54:55], v[42:43]
    v_pk_mul_f32 v[92:93], v[54:55], v[44:45]
    v_pk_mul_f32 v[96:97], v[54:55], v[40:41]
    v_pk_fma_f32 v[62:63], v[52:53], v[46:47], v[92:93]
    v_pk_fma_f32 v[58:59], v[52:53], v[42:43], v[96:97]
    v_pk_fma_f32 v[60:61], v[52:53], v[44:45], v[90:91] neg_lo:[0,0,1] neg_hi:[0,0,1]
    v_pk_fma_f32 v[56:57], v[52:53], v[40:41], v[94:95] neg_lo:[0,0,1] neg_hi:[0,0,1]
    v_cvt_pk_f16_f32 v76, v52, v54
    v_cvt_pk_f16_f32 v77, v53, v55
    v_cvt_pk_f16_f32 v78, v60, v62
    v_cvt_pk_f16_f32 v79, v61, v63
    ds_write2_b64 v74, v[76:77], v[78:79] offset0:136 offset1:204
    v_pk_mul_f32 v[90:91], v[58:59], v[46:47]
    v_pk_mul_f32 v[94:95], v[58:59], v[42:43]
    v_pk_mul_f32 v[92:93], v[58:59], v[44:45]
    v_pk_mul_f32 v[96:97], v[58:59], v[40:41]
    v_pk_fma_f32 v[62:63], v[56:57], v[46:47], v[92:93]
    v_pk_fma_f32 v[54:55], v[56:57], v[42:43], v[96:97]
    v_pk_fma_f32 v[60:61], v[56:57], v[44:45], v[90:91] neg_lo:[0,0,1] neg_hi:[0,0,1]
    v_pk_fma_f32 v[52:53], v[56:57], v[40:41], v[94:95] neg_lo:[0,0,1] neg_hi:[0,0,1]
    v_cvt_pk_f16_f32 v98, v56, v58
    v_cvt_pk_f16_f32 v99, v57, v59
    v_cvt_pk_f16_f32 v100, v60, v62
    v_cvt_pk_f16_f32 v101, v61, v63
    ds_write2_b64 v75, v[98:99], v[100:101] offset0:0 offset1:68
    v_pk_mul_f32 v[90:91], v[54:55], v[46:47]
    v_pk_mul_f32 v[92:93], v[54:55], v[44:45]
    v_pk_fma_f32 v[62:63], v[52:53], v[46:47], v[92:93]
    v_pk_fma_f32 v[60:61], v[52:53], v[44:45], v[90:91] neg_lo:[0,0,1] neg_hi:[0,0,1]
    v_cvt_pk_f16_f32 v76, v52, v54
    v_cvt_pk_f16_f32 v77, v53, v55
    v_cvt_pk_f16_f32 v78, v60, v62
    v_cvt_pk_f16_f32 v79, v61, v63
    ds_write2_b64 v75, v[76:77], v[78:79] offset0:136 offset1:204
    s_branch JOBJ_19
JOB_16:
    v_mul_f32 v91, 0x43000000, v68
    v_mul_f32 v90, 0x43000000, v20
    v_mul_f32 v95, 0x43000000, v69
    v_mul_f32 v94, 0x43000000, v21
    v_fract_f32 v91, v91
    v_fract_f32 v95, v95
    v_fmac_f32 v91, 0x43000000, v70
    v_fmac_f32 v95, 0x43000000, v71
    v_exp_f32 v90, v90
    v_cos_f32 v92, v91
    v_sin_f32 v91, v91
    v_exp_f32 v94, v94
    v_cos_f32 v96, v95
    v_sin_f32 v95, v95
    v_mul_f32 v44, v90, v92
    v_mul_f32 v46, v90, v91
    v_mul_f32 v45, v94, v96
    v_mul_f32 v47, v94, v95
    v_pk_mul_f32 v[32:33], v[32:33], s[16:17] op_sel_hi:[1,0]
    v_pk_mul_f32 v[34:35], v[34:35], s[16:17] op_sel_hi:[1,0]
    v_pk_mul_f32 v[90:91], v[46:47], v[46:47]
    v_pk_mul_f32 v[92:93], v[44:45], v[46:47]
    v_pk_fma_f32 v[48:49], v[44:45], v[44:45], v[90:91] neg_lo:[0,0,1] neg_hi:[0,0,1]
    v_pk_add_f32 v[50:51], v[92:93], v[92:93]
    v_mul_f32 v91, 2.0, v68
    v_mul_f32 v90, 2.0, v20
    v_mul_f32 v95, 2.0, v69
    v_mul_f32 v94, 2.0, v21
    v_fract_f32 v91, v91
    v_fract_f32 v95, v95
    v_fmac_f32 v91, 2.0, v70
    v_fmac_f32 v95, 2.0, v71
    v_exp_f32 v90, v90
    v_cos_f32 v92, v91
    v_sin_f32 v91, v91
    v_exp_f32 v94, v94
    v_cos_f32 v96, v95
    v_sin_f32 v95, v95
    v_mul_f32 v40, v90, v92
    v_mul_f32 v42, v90, v91
    v_mul_f32 v41, v94, v96
    v_mul_f32 v43, v94, v95
    v_pk_mul_f32 v[90:91], v[34:35], v[50:51]
    v_pk_mul_f32 v[92:93], v[34:35], v[48:49]
    v_pk_fma_f32 v[54:55], v[32:33], v[50:51], v[92:93]
    v_pk_fma_f32 v[52:53], v[32:33], v[48:49], v[90:91] neg_lo:[0,0,1] neg_hi:[0,0,1]
    v_pk_mul_f32 v[90:91], v[54:55], v[50:51]
    v_pk_mul_f32 v[92:93], v[54:55], v[48:49]
    v_pk_fma_f32 v[66:67], v[52:53], v[50:51], v[92:93]
    v_pk_fma_f32 v[64:65], v[52:53], v[48:49], v[90:91] neg_lo:[0,0,1] neg_hi:[0,0,1]
    v_pk_mul_f32 v[90:91], v[54:55], v[46:47]
    v_pk_mul_f32 v[94:95], v[54:55], v[42:43]
    v_pk_mul_f32 v[92:93], v[54:55], v[44:45]
    v_pk_mul_f32 v[96:97], v[54:55], v[40:41]
    v_pk_fma_f32 v[62:63], v[52:53], v[46:47], v[92:93]
    v_pk_fma_f32 v[58:59], v[52:53], v[42:43], v[96:97]
    v_pk_fma_f32 v[60:61], v[52:53], v[44:45], v[90:91] neg_lo:[0,0,1] neg_hi:[0,0,1]
    v_pk_fma_f32 v[56:57], v[52:53], v[40:41], v[94:95] neg_lo:[0,0,1] neg_hi:[0,0,1]
    v_cvt_pk_f16_f32 v98, v52, v54
    v_cvt_pk_f16_f32 v99, v53, v55
    v_cvt_pk_f16_f32 v100, v60, v62
    v_cvt_pk_f16_f32 v101, v61, v63
    ds_write2_b64 v72, v[98:99], v[100:101] offset0:0 offset1:68
    v_pk_mul_f32 v[90:91], v[58:59], v[46:47]
    v_pk_mul_f32 v[94:95], v[58:59], v[42:43]
    v_pk_mul_f32 v[92:93], v[58:59], v[44:45]
    v_pk_mul_f32 v[96:97], v[58:59], v[40:41]
    v_pk_fma_f32 v[62:63], v[56:57], v[46:47], v[92:93]
    v_pk_fma_f32 v[54:55], v[56:57], v[42:43], v[96:97]
    v_pk_fma_f32 v[60:61], v[56:57], v[44:45], v[90:91] neg_lo:[0,0,1] neg_hi:[0,0,1]
    v_pk_fma_f32 v[52:53], v[56:57], v[40:41], v[94:95] neg_lo:[0,0,1] neg_hi:[0,0,1]
    v_cvt_pk_f16_f32 v76, v56, v58
    v_cvt_pk_f16_f32 v77, v57, v59
    v_cvt_pk_f16_f32 v78, v60, v62
    v_cvt_pk_f16_f32 v79, v61, v63
    ds_write2_b64 v72, v[76:77], v[78:79] offset0:136 offset1:204
    v_pk_mul_f32 v[90:91], v[54:55], v[46:47]
    v_pk_mul_f32 v[94:95], v[54:55], v[42:43]
    v_pk_mul_f32 v[92:93], v[54:55], v[44:45]
    v_pk_mul_f32 v[96:97], v[54:55], v[40:41]
    v_pk_fma_f32 v[62:63], v[52:53], v[46:47], v[92:93]
    v_pk_fma_f32 v[58:59], v[52:53], v[42:43], v[96:97]
    v_pk_fma_f32 v[60:61], v[52:53], v[44:45], v[90:91] neg_lo:[0,0,1] neg_hi:[0,0,1]
    v_pk_fma_f32 v[56:57], v[52:53], v[40:41], v[94:95] neg_lo:[0,0,1] neg_hi:[0,0,1]
    v_cvt_pk_f16_f32 v98, v52, v54
    v_cvt_pk_f16_f32 v99, v53, v55
    v_cvt_pk_f16_f32 v100, v60, v62
    v_cvt_pk_f16_f32 v101, v61, v63
    ds_write2_b64 v73, v[98:99], v[100:101] offset0:0 offset1:68
    v_pk_mul_f32 v[90:91], v[58:59], v[46:47]
    v_pk_mul_f32 v[94:95], v[42:43], v[42:43]
    v_pk_mul_f32 v[92:93], v[58:59], v[44:45]
    v_pk_mul_f32 v[96:97], v[40:41], v[42:43]
    v_pk_fma_f32 v[62:63], v[56:57], v[46:47], v[92:93]
    v_pk_fma_f32 v[48:49], v[40:41], v[40:41], v[94:95] neg_lo:[0,0,1] neg_hi:[0,0,1]
    v_pk_fma_f32 v[60:61], v[56:57], v[44:45], v[90:91] neg_lo:[0,0,1] neg_hi:[0,0,1]
    v_pk_add_f32 v[50:51], v[96:97], v[96:97]
    v_cvt_pk_f16_f32 v76, v56, v58
    v_cvt_pk_f16_f32 v77, v57, v59
    v_cvt_pk_f16_f32 v78, v60, v62
    v_cvt_pk_f16_f32 v79, v61, v63
    ds_write2_b64 v73, v[76:77], v[78:79] offset0:136 offset1:204
    v_pk_mul_f32 v[90:91], v[66:67], v[50:51]
    v_pk_mul_f32 v[94:95], v[66:67], v[46:47]
    v_pk_mul_f32 v[92:93], v[66:67], v[48:49]
    v_pk_mul_f32 v[96:97], v[66:67], v[44:45]
    v_pk_fma_f32 v[62:63], v[64:65], v[50:51], v[92:93]
    v_pk_fma_f32 v[54:55], v[64:65], v[46:47], v[96:97]
    v_pk_fma_f32 v[60:61], v[64:65], v[48:49], v[90:91] neg_lo:[0,0,1] neg_hi:[0,0,1]
    v_pk_fma_f32 v[52:53], v[64:65], v[44:45], v[94:95] neg_lo:[0,0,1] neg_hi:[0,0,1]
    v_cvt_pk_f16_f32 v98, v64, v66
    v_cvt_pk_f16_f32 v99, v65, v67
    v_cvt_pk_f16_f32 v100, v60, v62
    v_cvt_pk_f16_f32 v101, v61, v63
    ds_write2_b64 v74, v[98:99], v[100:101] offset0:0 offset1:68
    v_pk_mul_f32 v[90:91], v[54:55], v[50:51]
    v_pk_mul_f32 v[94:95], v[54:55], v[46:47]
    v_pk_mul_f32 v[92:93], v[54:55], v[48:49]
    v_pk_mul_f32 v[96:97], v[54:55], v[44:45]
    v_pk_fma_f32 v[62:63], v[52:53], v[50:51], v[92:93]
    v_pk_fma_f32 v[58:59], v[52:53], v[46:47], v[96:97]
    v_pk_fma_f32 v[60:61], v[52:53], v[48:49], v[90:91] neg_lo:[0,0,1] neg_hi:[0,0,1]
    v_pk_fma_f32 v[56:57], v[52:53], v[44:45], v[94:95] neg_lo:[0,0,1] neg_hi:[0,0,1]
    v_cvt_pk_f16_f32 v76, v52, v54
    v_cvt_pk_f16_f32 v77, v53, v55
    v_cvt_pk_f16_f32 v78, v60, v62
    v_cvt_pk_f16_f32 v79, v61, v63
    ds_write2_b64 v74, v[76:77], v[78:79] offset0:136 offset1:204
    v_pk_mul_f32 v[90:91], v[58:59], v[50:51]
    v_pk_mul_f32 v[94:95], v[58:59], v[46:47]
    v_pk_mul_f32 v[92:93], v[58:59], v[48:49]
    v_pk_mul_f32 v[96:97], v[58:59], v[44:45]
    v_pk_fma_f32 v[62:63], v[56:57], v[50:51], v[92:93]
    v_pk_fma_f32 v[54:55], v[56:57], v[46:47], v[96:97]
    v_pk_fma_f32 v[60:61], v[56:57], v[48:49], v[90:91] neg_lo:[0,0,1] neg_hi:[0,0,1]
    v_pk_fma_f32 v[52:53], v[56:57], v[44:45], v[94:95] neg_lo:[0,0,1] neg_hi:[0,0,1]
    v_cvt_pk_f16_f32 v98, v56, v58
    v_cvt_pk_f16_f32 v99, v57, v59
    v_cvt_pk_f16_f32 v100, v60, v62
    v_cvt_pk_f16_f32 v101, v61, v63
    ds_write2_b64 v75, v[98:99], v[100:101] offset0:0 offset1:68
    v_pk_mul_f32 v[90:91], v[54:55], v[50:51]
    v_pk_mul_f32 v[92:93], v[54:55], v[48:49]
    v_pk_fma_f32 v[62:63], v[52:53], v[50:51], v[92:93]
    v_pk_fma_f32 v[60:61], v[52:53], v[48:49], v[90:91] neg_lo:[0,0,1] neg_hi:[0,0,1]
    v_cvt_pk_f16_f32 v76, v52, v54
    v_cvt_pk_f16_f32 v77, v53, v55
    v_cvt_pk_f16_f32 v78, v60, v62
    v_cvt_pk_f16_f32 v79, v61, v63
    ds_write2_b64 v75, v[76:77], v[78:79] offset0:136 offset1:204
    s_branch JOBJ_19
JOB_18:
    v_mul_f32 v91, 0x41000000, v68
    v_mul_f32 v90, 0x41000000, v20
    v_mul_f32 v95, 0x41000000, v69
    v_mul_f32 v94, 0x41000000, v21
    v_fract_f32 v91, v91
    v_fract_f32 v95, v95
    v_fmac_f32 v91, 0x41000000, v70
    v_fmac_f32 v95, 0x41000000, v71
    v_exp_f32 v90, v90
    v_cos_f32 v92, v91
    v_sin_f32 v91, v91
    v_exp_f32 v94, v94
    v_cos_f32 v96, v95
    v_sin_f32 v95, v95
    v_mul_f32 v40, v90, v92
    v_mul_f32 v42, v90, -v91
    v_mul_f32 v41, v94, v96
    v_mul_f32 v43, v94, -v95
    v_mov_b32 v52, 0x47000000
    v_mov_b32 v53, 0x47000000
    v_mov_b32 v54, 0
    v_mov_b32 v55, 0
    v_pk_mul_f32 v[90:91], v[42:43], v[42:43]
    v_pk_mul_f32 v[60:61], v[40:41], v[52:53]
    v_pk_mul_f32 v[92:93], v[40:41], v[42:43]
    v_pk_mul_f32 v[62:63], v[42:43], v[52:53]
    v_pk_fma_f32 v[44:45], v[40:41], v[40:41], v[90:91] neg_lo:[0,0,1] neg_hi:[0,0,1]
    v_pk_add_f32 v[46:47], v[92:93], v[92:93]
    v_pk_mul_f32 v[56:57], v[44:45], v[52:53]
    v_pk_mul_f32 v[94:95], v[62:63], v[46:47]
    v_pk_mul_f32 v[58:59], v[46:47], v[52:53]
    v_pk_mul_f32 v[96:97], v[62:63], v[44:45]
    v_pk_fma_f32 v[66:67], v[60:61], v[46:47], v[96:97]
    v_pk_fma_f32 v[64:65], v[60:61], v[44:45], v[94:95] neg_lo:[0,0,1] neg_hi:[0,0,1]
    v_cvt_pk_f16_f32 v98, v52, v54
    v_cvt_pk_f16_f32 v99, v53, v55
    v_cvt_pk_f16_f32 v100, v60, v62
    v_cvt_pk_f16_f32 v101, v61, v63
    ds_write2_b64 v72, v[98:99], v[100:101] offset0:0 offset1:68
    v_pk_mul_f32 v[90:91], v[58:59], v[46:47]
    v_pk_mul_f32 v[94:95], v[66:67], v[46:47]
    v_pk_mul_f32 v[92:93], v[58:59], v[44:45]
    v_pk_mul_f32 v[96:97], v[66:67], v[44:45]
    v_pk_fma_f32 v[54:55], v[56:57], v[46:47], v[92:93]
    v_pk_fma_f32 v[62:63], v[64:65], v[46:47], v[96:97]
    v_pk_fma_f32 v[52:53], v[56:57], v[44:45], v[90:91] neg_lo:[0,0,1] neg_hi:[0,0,1]
    v_pk_fma_f32 v[60:61], v[64:65], v[44:45], v[94:95] neg_lo:[0,0,1] neg_hi:[0,0,1]
    v_cvt_pk_f16_f32 v76, v56, v58
    v_cvt_pk_f16_f32 v77, v57, v59
    v_cvt_pk_f16_f32 v78, v64, v66
    v_cvt_pk_f16_f32 v79, v65, v67
    ds_write2_b64 v72, v[76:77], v[78:79] offset0:136 offset1:204
    v_pk_mul_f32 v[90:91], v[54:55], v[46:47]
    v_pk_mul_f32 v[94:95], v[62:63], v[46:47]
    v_pk_mul_f32 v[92:93], v[54:55], v[44:45]
    v_pk_mul_f32 v[96:97], v[62:63], v[44:45]
    v_pk_fma_f32 v[58:59], v[52:53], v[46:47], v[92:93]
    v_pk_fma_f32 v[66:67], v[60:61], v[46:47], v[96:97]
    v_pk_fma_f32 v[56:57], v[52:53], v[44:45], v[90:91] neg_lo:[0,0,1] neg_hi:[0,0,1]
    v_pk_fma_f32 v[64:65], v[60:61], v[44:45], v[94:95] neg_lo:[0,0,1] neg_hi:[0,0,1]
    v_cvt_pk_f16_f32 v98, v52, v54
    v_cvt_pk_f16_f32 v99, v53, v55
    v_cvt_pk_f16_f32 v100, v60, v62
    v_cvt_pk_f16_f32 v101, v61, v63
    ds_write2_b64 v73, v[98:99], v[100:101] offset0:0 offset1:68
    v_pk_mul_f32 v[90:91], v[58:59], v[46:47]
    v_pk_mul_f32 v[94:95], v[66:67], v[46:47]
    v_pk_mul_f32 v[92:93], v[58:59], v[44:45]
    v_pk_mul_f32 v[96:97], v[66:67], v[44:45]
    v_pk_fma_f32 v[54:55], v[56:57], v[46:47], v[92:93]
    v_pk_fma_f32 v[62:63], v[64:65], v[46:47], v[96:97]
    v_pk_fma_f32 v[52:53], v[56:57], v[44:45], v[90:91] neg_lo:[0,0,1] neg_hi:[0,0,1]
    v_pk_fma_f32 v[60:61], v[64:65], v[44:45], v[94:95] neg_lo:[0,0,1] neg_hi:[0,0,1]
    v_cvt_pk_f16_f32 v76, v56, v58
    v_cvt_pk_f16_f32 v77, v57, v59
    v_cvt_pk_f16_f32 v78, v64, v66
    v_cvt_pk_f16_f32 v79, v65, v67
    ds_write2_b64 v73, v[76:77], v[78:79] offset0:136 offset1:204
    v_pk_mul_f32 v[90:91], v[54:55], v[46:47]
    v_pk_mul_f32 v[94:95], v[62:63], v[46:47]
    v_pk_mul_f32 v[92:93], v[54:55], v[44:45]
    v_pk_mul_f32 v[96:97], v[62:63], v[44:45]
    v_pk_fma_f32 v[58:59], v[52:53], v[46:47], v[92:93]
    v_pk_fma_f32 v[66:67], v[60:61], v[46:47], v[96:97]
    v_pk_fma_f32 v[56:57], v[52:53], v[44:45], v[90:91] neg_lo:[0,0,1] neg_hi:[0,0,1]
    v_pk_fma_f32 v[64:65], v[60:61], v[44:45], v[94:95] neg_lo:[0,0,1] neg_hi:[0,0,1]
    v_cvt_pk_f16_f32 v98, v52, v54
    v_cvt_pk_f16_f32 v99, v53, v55
    v_cvt_pk_f16_f32 v100, v60, v62
    v_cvt_pk_f16_f32 v101, v61, v63
    ds_write2_b64 v74, v[98:99], v[100:101] offset0:0 offset1:68
    v_pk_mul_f32 v[90:91], v[58:59], v[46:47]
    v_pk_mul_f32 v[94:95], v[66:67], v[46:47]
    v_pk_mul_f32 v[92:93], v[58:59], v[44:45]
    v_pk_mul_f32 v[96:97], v[66:67], v[44:45]
    v_pk_fma_f32 v[54:55], v[56:57], v[46:47], v[92:93]
    v_pk_fma_f32 v[62:63], v[64:65], v[46:47], v[96:97]
    v_pk_fma_f32 v[52:53], v[56:57], v[44:45], v[90:91] neg_lo:[0,0,1] neg_hi:[0,0,1]
    v_pk_fma_f32 v[60:61], v[64:65], v[44:45], v[94:95] neg_lo:[0,0,1] neg_hi:[0,0,1]
    v_cvt_pk_f16_f32 v76, v56, v58
    v_cvt_pk_f16_f32 v77, v57, v59
    v_cvt_pk_f16_f32 v78, v64, v66
    v_cvt_pk_f16_f32 v79, v65, v67
    ds_write2_b64 v74, v[76:77], v[78:79] offset0:136 offset1:204
    v_pk_mul_f32 v[90:91], v[54:55], v[46:47]
    v_pk_mul_f32 v[94:95], v[62:63], v[46:47]
    v_pk_mul_f32 v[92:93], v[54:55], v[44:45]
    v_pk_mul_f32 v[96:97], v[62:63], v[44:45]
    v_pk_fma_f32 v[58:59], v[52:53], v[46:47], v[92:93]
    v_pk_fma_f32 v[66:67], v[60:61], v[46:47], v[96:97]
    v_pk_fma_f32 v[56:57], v[52:53], v[44:45], v[90:91] neg_lo:[0,0,1] neg_hi:[0,0,1]
    v_pk_fma_f32 v[64:65], v[60:61], v[44:45], v[94:95] neg_lo:[0,0,1] neg_hi:[0,0,1]
    v_cvt_pk_f16_f32 v98, v52, v54
    v_cvt_pk_f16_f32 v99, v53, v55
    v_cvt_pk_f16_f32 v100, v60, v62
    v_cvt_pk_f16_f32 v101, v61, v63
    ds_write2_b64 v75, v[98:99], v[100:101] offset0:0 offset1:68
    v_cvt_pk_f16_f32 v76, v56, v58
    v_cvt_pk_f16_f32 v77, v57, v59
    v_cvt_pk_f16_f32 v78, v64, v66
    v_cvt_pk_f16_f32 v79, v65, v67
    ds_write2_b64 v75, v[76:77], v[78:79] offset0:136 offset1:204
    ds_write_b8 v15, v5 offset:64
    s_cmp_eq_u32 s87, 2
    s_cbranch_scc1 KS_G0
    s_branch EXP_13
KC_SEND:
W_20:
    ds_read_b32 v104, v105 offset:224
    s_sub_u32 s39, s39, 1
    s_cbranch_scc1 KS_ABORT
    s_waitcnt lgkmcnt(0)
    v_cmp_eq_u32 vcc, 0, v104
    s_cbranch_vccnz W_20
    s_lshl_b32 s92, s88, 12
    s_lshl_b32 s93, s86, 10
    s_add_u32 s92, s92, s93
    s_add_u32 s92, s92, 0x920000
    v_add_u32 v24, s92, v12
    s_mov_b32 s93, 0xffff
    v_lshlrev_b32 v25, 16, v104
    v_cvt_f16_f32 v20, v20
    v_cvt_f16_f32 v21, v21
    v_cvt_f16_f32 v22, v22
    v_cvt_f16_f32 v23, v23
    s_cmp_lg_u32 s86, 2
    s_cbranch_scc1 KC_S2
    s_mov_b32 exec_lo, 0
    s_mov_b32 exec_hi, 0xffff0000
    v_mov_b32 v20, v106
    v_lshrrev_b32 v21, 16, v106
    s_mov_b64 exec, -1
KC_S2:
    v_bfi_b32 v20, s93, v20, v104
    v_bfi_b32 v21, s93, v21, v25
    v_bfi_b32 v22, s93, v22, v104
    v_bfi_b32 v23, s93, v23, v25
    global_store_dwordx4 v24, v[20:23], s[36:37] sc1
    s_branch KS_G0
KC_RECV:
    s_cmp_eq_u32 s86, 3
    s_cbranch_scc1 EXP_13
    s_lshl_b32 s92, s88, 12
    s_lshl_b32 s93, s86, 10
    s_add_u32 s92, s92, s93
    s_add_u32 s92, s92, 0x920000
    v_add_u32 v24, s92, v12
W_21:
    s_sleep 2
    ds_read_b32 v104, v105 offset:224
    s_sub_u32 s39, s39, 1
    s_cbranch_scc1 KS_ABORT
    s_waitcnt lgkmcnt(0)
    v_cmp_eq_u32 vcc, 0, v104
    s_cbranch_vccnz W_21
    v_lshlrev_b32 v25, 16, v104
W_22:
    s_sleep 2
    ds_read_b32 v17, v4 offset:72
    s_sub_u32 s39, s39, 1
    s_cbranch_scc1 KS_ABORT
    s_waitcnt lgkmcnt(0)
    v_cmp_ne_u32 vcc, s84, v17
    s_cbranch_vccnz W_22
    s_sleep 8
    s_branch KPE_24
KP_23:
    s_sleep 2
KPE_24:
    global_load_dwordx4 v[20:23], v24, s[36:37] sc1
    s_sub_u32 s39, s39, 1
    s_cbranch_scc1 KS_ABORT
    s_waitcnt vmcnt(0)
    v_xor_b32 v20, v104, v20
    v_xor_b32 v21, v25, v21
    v_xor_b32 v22, v104, v22
    v_xor_b32 v23, v25, v23
    v_or3_b32 v26, v20, v21, v22
    v_or_b32 v26, v26, v23
    v_cmp_lt_u32 vcc, 0xffff, v26
    s_cbranch_vccnz KP_23
    v_xor_b32 v20, v104, v20
    v_xor_b32 v22, v104, v22
    ds_write_b16 v108, v20
    ds_write_b16 v109, v21
    ds_write_b16 v112, v22
    ds_write_b16 v113, v23
    s_cmp_lg_u32 s86, 2
    s_cbranch_scc1 EXP_13
    v_and_b32 v20, 0xffff, v20
    v_lshl_or_b32 v20, v21, 16, v20
    v_lshlrev_b32 v21, 16, v107
    s_mov_b32 exec_lo, 0
    s_mov_b32 exec_hi, 0x10000
    ds_write_b64 v14, v[20:21] offset:832
    s_mov_b64 exec, -1
    s_branch EXP_13
JOB_17:
    v_mul_f32 v91, 0x43000000, v68
    v_mul_f32 v90, 0x43000000, v20
    v_mul_f32 v95, 0x43000000, v69
    v_mul_f32 v94, 0x43000000, v21
    v_fract_f32 v91, v91
    v_fract_f32 v95, v95
    v_fmac_f32 v91, 0x43000000, v70
    v_fmac_f32 v95, 0x43000000, v71
    v_exp_f32 v90, v90
    v_cos_f32 v92, v91
    v_sin_f32 v91, v91
    v_exp_f32 v94, v94
    v_cos_f32 v96, v95
    v_sin_f32 v95, v95
    v_mul_f32 v44, v90, v92
    v_mul_f32 v46, v90, v91
    v_mul_f32 v45, v94, v96
    v_mul_f32 v47, v94, v95
    v_pk_mul_f32 v[32:33], v[32:33], s[16:17] op_sel_hi:[1,0]
    v_pk_mul_f32 v[34:35], v[34:35], s[16:17] op_sel_hi:[1,0]
    v_pk_mul_f32 v[90:91], v[46:47], v[46:47]
    v_pk_mul_f32 v[94:95], v[34:35], v[46:47]
    v_pk_mul_f32 v[92:93], v[44:45], v[46:47]
    v_pk_mul_f32 v[96:97], v[34:35], v[44:45]
    v_pk_fma_f32 v[40:41], v[44:45], v[44:45], v[90:91] neg_lo:[0,0,1] neg_hi:[0,0,1]
    v_pk_fma_f32 v[66:67], v[32:33], v[46:47], v[96:97]
    v_pk_add_f32 v[42:43], v[92:93], v[92:93]
    v_pk_fma_f32 v[64:65], v[32:33], v[44:45], v[94:95] neg_lo:[0,0,1] neg_hi:[0,0,1]
    v_pk_mul_f32 v[90:91], v[42:43], v[42:43]
    v_pk_mul_f32 v[92:93], v[40:41], v[42:43]
    v_pk_fma_f32 v[48:49], v[40:41], v[40:41], v[90:91] neg_lo:[0,0,1] neg_hi:[0,0,1]
    v_pk_add_f32 v[50:51], v[92:93], v[92:93]
    v_pk_mul_f32 v[90:91], v[50:51], v[50:51]
    v_pk_mul_f32 v[92:93], v[48:49], v[50:51]
    v_pk_fma_f32 v[48:49], v[48:49], v[48:49], v[90:91] neg_lo:[0,0,1] neg_hi:[0,0,1]
    v_pk_add_f32 v[50:51], v[92:93], v[92:93]
    v_pk_mul_f32 v[90:91], v[34:35], v[50:51]
    v_pk_mul_f32 v[94:95], v[66:67], v[50:51]
    v_pk_mul_f32 v[92:93], v[34:35], v[48:49]
    v_pk_mul_f32 v[96:97], v[66:67], v[48:49]
    v_pk_fma_f32 v[54:55], v[32:33], v[50:51], v[92:93]
    v_pk_fma_f32 v[62:63], v[64:65], v[50:51], v[96:97]
    v_pk_fma_f32 v[52:53], v[32:33], v[48:49], v[90:91] neg_lo:[0,0,1] neg_hi:[0,0,1]
    v_pk_fma_f32 v[60:61], v[64:65], v[48:49], v[94:95] neg_lo:[0,0,1] neg_hi:[0,0,1]
    v_pk_mul_f32 v[90:91], v[54:55], v[42:43]
    v_pk_mul_f32 v[94:95], v[62:63], v[42:43]
    v_pk_mul_f32 v[92:93], v[54:55], v[40:41]
    v_pk_mul_f32 v[96:97], v[62:63], v[40:41]
    v_pk_fma_f32 v[58:59], v[52:53], v[42:43], v[92:93]
    v_pk_fma_f32 v[66:67], v[60:61], v[42:43], v[96:97]
    v_pk_fma_f32 v[56:57], v[52:53], v[40:41], v[90:91] neg_lo:[0,0,1] neg_hi:[0,0,1]
    v_pk_fma_f32 v[64:65], v[60:61], v[40:41], v[94:95] neg_lo:[0,0,1] neg_hi:[0,0,1]
    v_cvt_pk_f16_f32 v98, v52, v54
    v_cvt_pk_f16_f32 v99, v53, v55
    v_cvt_pk_f16_f32 v100, v60, v62
    v_cvt_pk_f16_f32 v101, v61, v63
    ds_write2_b64 v72, v[98:99], v[100:101] offset0:0 offset1:68
    v_pk_mul_f32 v[90:91], v[58:59], v[42:43]
    v_pk_mul_f32 v[94:95], v[66:67], v[42:43]
    v_pk_mul_f32 v[92:93], v[58:59], v[40:41]
    v_pk_mul_f32 v[96:97], v[66:67], v[40:41]
    v_pk_fma_f32 v[54:55], v[56:57], v[42:43], v[92:93]
    v_pk_fma_f32 v[62:63], v[64:65], v[42:43], v[96:97]
    v_pk_fma_f32 v[52:53], v[56:57], v[40:41], v[90:91] neg_lo:[0,0,1] neg_hi:[0,0,1]
    v_pk_fma_f32 v[60:61], v[64:65], v[40:41], v[94:95] neg_lo:[0,0,1] neg_hi:[0,0,1]
    v_cvt_pk_f16_f32 v76, v56, v58
    v_cvt_pk_f16_f32 v77, v57, v59
    v_cvt_pk_f16_f32 v78, v64, v66
    v_cvt_pk_f16_f32 v79, v65, v67
    ds_write2_b64 v72, v[76:77], v[78:79] offset0:136 offset1:204
    v_pk_mul_f32 v[90:91], v[54:55], v[42:43]
    v_pk_mul_f32 v[94:95], v[62:63], v[42:43]
    v_pk_mul_f32 v[92:93], v[54:55], v[40:41]
    v_pk_mul_f32 v[96:97], v[62:63], v[40:41]
    v_pk_fma_f32 v[58:59], v[52:53], v[42:43], v[92:93]
    v_pk_fma_f32 v[66:67], v[60:61], v[42:43], v[96:97]
    v_pk_fma_f32 v[56:57], v[52:53], v[40:41], v[90:91] neg_lo:[0,0,1] neg_hi:[0,0,1]
    v_pk_fma_f32 v[64:65], v[60:61], v[40:41], v[94:95] neg_lo:[0,0,1] neg_hi:[0,0,1]
    v_cvt_pk_f16_f32 v98, v52, v54
    v_cvt_pk_f16_f32 v99, v53, v55
    v_cvt_pk_f16_f32 v100, v60, v62
    v_cvt_pk_f16_f32 v101, v61, v63
    ds_write2_b64 v73, v[98:99], v[100:101] offset0:0 offset1:68
    v_pk_mul_f32 v[90:91], v[58:59], v[42:43]
    v_pk_mul_f32 v[92:93], v[58:59], v[40:41]
    v_pk_fma_f32 v[54:55], v[56:57], v[42:43], v[92:93]
    v_pk_fma_f32 v[52:53], v[56:57], v[40:41], v[90:91] neg_lo:[0,0,1] neg_hi:[0,0,1]
    v_cvt_pk_f16_f32 v76, v56, v58
    v_cvt_pk_f16_f32 v77, v57, v59
    v_cvt_pk_f16_f32 v78, v64, v66
    v_cvt_pk_f16_f32 v79, v65, v67
    ds_write2_b64 v73, v[76:77], v[78:79] offset0:136 offset1:204
    v_cvt_pk_f16_f32 v98, v52, v54
    v_cvt_pk_f16_f32 v99, v53, v55
    v_mov_b32 v36, 0x4538aa3b
    v_mul_f32 v24, s14, v36
    v_max_f32 v24, 0, v24
    v_ceil_f32 v24, v24
    v_cvt_i32_f32 v24, v24
    ds_write_b64 v74, v[98:99] offset:0
    s_sub_u32 s11, s15, 7
    s_lshl_b32 s11, s11, 23
    v_lshlrev_b32 v25, 16, v107
    v_ldexp_f32 v24, s11, v24
    v_mov_b32 v106, v24
    ds_write_b64 v14, v[24:25] offset:832
JOBJ_19:
    ds_write_b8 v15, v5 offset:64
    ds_read_b128 v[40:43], v127 offset:0
    ds_read_b128 v[44:47], v127 offset:64
    ds_read_b128 v[48:51], v127 offset:128
    ds_read_b128 v[52:55], v127 offset:192
    ds_read_b128 v[56:59], v127 offset:256
    ds_read_b128 v[60:63], v127 offset:320
    ds_read_b128 v[64:67], v127 offset:384
    ds_read_b128 v[68:71], v127 offset:448
    v_mov_b32 v36, 0x3fb8aa3b
    v_mul_f32 v36, s14, v36
    v_mul_f32 v37, 0x45000000, v36
    v_max_f32 v37, 0, v37
    v_ceil_f32 v37, v37
    v_add_f32 v37, 0x41b80000, v37
    v_fma_f32 v110, v110, v36, -v37
    v_fma_f32 v111, v111, v36, -v37
    v_fma_f32 v114, v114, v36, -v37
    v_fma_f32 v115, v115, v36, -v37
    v_exp_f32 v110, v110
    v_exp_f32 v111, v111
    v_exp_f32 v114, v114
    v_exp_f32 v115, v115
W_25:
    ds_read_u8 v17, v14 offset:67
    s_sub_u32 s39, s39, 1
    s_cbranch_scc1 KS_ABORT
    s_waitcnt lgkmcnt(0)
    v_cmp_eq_u32 vcc, 0, v17
    s_cbranch_vccnz W_25
    ds_read_b128 v[72:75], v126 offset:22304
    ds_read_b128 v[76:79], v126 offset:22368
    ds_read_b128 v[80:83], v126 offset:22432
    ds_read_b128 v[84:87], v126 offset:22496
    ds_read_b128 v[88:91], v126 offset:22560
    ds_read_b128 v[92:95], v126 offset:22624
    ds_read_b128 v[96:99], v126 offset:22688
    ds_read_b128 v[100:103], v126 offset:22752
    s_waitcnt lgkmcnt(7)
    v_mfma_f32_16x16x32_f16 v[20:23], v[40:43], v[72:75], 0
    s_waitcnt lgkmcnt(6)
    v_mfma_f32_16x16x32_f16 v[24:27], v[44:47], v[76:79], 0
    s_waitcnt lgkmcnt(5)
    v_mfma_f32_16x16x32_f16 v[20:23], v[48:51], v[80:83], v[20:23]
    s_waitcnt lgkmcnt(4)
    v_mfma_f32_16x16x32_f16 v[24:27], v[52:55], v[84:87], v[24:27]
    s_waitcnt lgkmcnt(3)
    v_mfma_f32_16x16x32_f16 v[20:23], v[56:59], v[88:91], v[20:23]
    s_waitcnt lgkmcnt(2)
    v_mfma_f32_16x16x32_f16 v[24:27], v[60:63], v[92:95], v[24:27]
    s_waitcnt lgkmcnt(1)
    v_mfma_f32_16x16x32_f16 v[20:23], v[64:67], v[96:99], v[20:23]
    s_waitcnt lgkmcnt(0)
    v_mfma_f32_16x16x32_f16 v[24:27], v[68:71], v[100:103], v[24:27]
    s_nop 7
    v_add_f32 v20, v20, v24
    v_add_f32 v21, v21, v25
    v_add_f32 v22, v22, v26
    v_add_f32 v23, v23, v27
    v_mul_f32 v20, v20, v110
    v_mul_f32 v21, v21, v111
    v_mul_f32 v22, v22, v114
    v_mul_f32 v23, v23, v115
    s_cmp_eq_u32 s87, 2
    s_cbranch_scc1 KC_SEND
    v_cvt_f16_f32 v20, v20
    ds_write_b16 v108, v20
    v_cvt_f16_f32 v21, v21
    ds_write_b16 v109, v21
    v_cvt_f16_f32 v22, v22
    ds_write_b16 v112, v22
    v_cvt_f16_f32 v23, v23
    ds_write_b16 v113, v23
EXP_13:
    ds_write_b8 v15, v5 offset:68
    v_mov_b32 v28, 0
    v_mov_b32 v29, 0
    v_mov_b32 v30, 0
    v_mov_b32 v31, 0
    v_mov_b32 v32, s85
    s_waitcnt vmcnt(0)
W_26:
    ds_read_b32 v20, v14 offset:68
    s_sub_u32 s39, s39, 1
    s_cbranch_scc1 KS_ABORT
    s_waitcnt lgkmcnt(0)
    v_cmp_ne_u32 vcc, s84, v20
    s_cbranch_vccnz W_26
    ds_read_u16 v20, v116
    ds_read_u16 v21, v117
    ds_read_u16 v22, v118
    ds_read_u16 v23, v120
    ds_read_u16 v24, v121
    ds_read_u16 v25, v122
    ds_read_u16 v26, v123
    s_mov_b64 exec, 1
    ds_write_b128 v32, v[28:31] offset:3088
    ds_write_b128 v32, v[28:31] offset:8224
    ds_write_b128 v32, v[28:31] offset:3072
    s_mov_b64 exec, -1
    s_waitcnt lgkmcnt(7)
    v_lshl_or_b32 v28, v21, 16, v20
    v_lshl_or_b32 v29, v22, 16, v21
    ds_write_b32 v124, v28 offset:32528
    ds_write_b32 v124, v29 offset:33872
    ds_write_b32 v124, v28 offset:27284
    ds_write_b32 v124, v29 offset:28628
    s_waitcnt lgkmcnt(7)
    v_lshl_or_b32 v30, v24, 16, v23
    v_lshl_or_b32 v31, v26, 16, v25
    ds_write_b32 v119, v30
    ds_write_b32 v125, v31
    ds_write_b32 v119, v30 offset:5244
    ds_write_b32 v125, v31 offset:5244
    ds_write_b8 v15, v5 offset:72
W_27:
    ds_read_b32 v20, v14 offset:72
    s_sub_u32 s39, s39, 1
    s_cbranch_scc1 KS_ABORT
    s_waitcnt lgkmcnt(0)
    v_cmp_ne_u32 vcc, s84, v20
    s_cbranch_vccnz W_27
    ds_read_b64 v[16:17], v14 offset:832
    s_cmp_eq_u32 s86, 1
    s_cbranch_scc1 CV_29
    s_cmp_eq_u32 s86, 2
    s_cbranch_scc1 CV_30
    s_cmp_eq_u32 s86, 3
    s_cbranch_scc1 CV_31
    ds_read_b64 v[32:33], v6 offset:576
    ds_read_b64 v[34:35], v6 offset:584
    ds_read_b64 v[36:37], v6 offset:64
    ds_read_b64 v[38:39], v6 offset:72
    ds_read_b64 v[40:41], v6 offset:640
    ds_read_b64 v[42:43], v6 offset:648
    ds_read_b64 v[44:45], v6 offset:128
    ds_read_b64 v[46:47], v6 offset:136
    ds_read_b64 v[48:49], v6 offset:704
    ds_read_b64 v[50:51], v6 offset:712
    ds_read_b64 v[52:53], v6 offset:192
    ds_read_b64 v[54:55], v6 offset:200
    ds_read_b64 v[56:57], v6 offset:768
    ds_read_b64 v[58:59], v6 offset:776
    ds_read_b64 v[60:61], v6 offset:256
    ds_read_b64 v[62:63], v6 offset:264
    ds_read_b64 v[64:65], v6 offset:832
    ds_read_b64 v[66:67], v6 offset:840
    ds_read_b64 v[68:69], v6 offset:320
    ds_read_b64 v[70:71], v6 offset:328
    ds_read_b64 v[72:73], v6 offset:896
    ds_read_b64 v[74:75], v6 offset:904
    ds_read_b64 v[76:77], v6 offset:384
    ds_read_b64 v[78:79], v6 offset:392
    ds_read_b64 v[80:81], v6 offset:960
    ds_read_b64 v[82:83], v6 offset:968
    ds_read_b64 v[84:85], v6 offset:448
    ds_read_b64 v[86:87], v6 offset:456
    ds_read_b64 v[88:89], v6 offset:1024
    ds_read_b64 v[90:91], v6 offset:1032
    ds_read_b64 v[92:93], v6 offset:512
    ds_read_b64 v[94:95], v6 offset:520
    v_lshlrev_b32 v18, 3, v3
    v_sub_u32 v18, v8, v18
    v_lshrrev_b32 v19, 2, v2
    v_lshl_add_u32 v19, v19, 2, v3
    v_and_b32 v28, 3, v2
    v_lshlrev_b32 v28, 4, v28
    v_mul_u32_u24 v19, s8, v19
    v_xor_b32 v19, s10, v19
    s_waitcnt lgkmcnt(0)
    v_mov_b32 v7, v18
    v_add_u32 v6, v19, v28
    v_xor_b32 v12, s9, v12
W_33:
    ds_read_b32 v18, v4 offset:16
    s_sub_u32 s39, s39, 1
    s_cbranch_scc1 KS_ABORT
    s_waitcnt lgkmcnt(0)
    v_cmp_ne_u32 vcc, s84, v18
    s_cbranch_vccnz W_33
    s_setprio 1
    ds_read_b128 v[96:99], v8 offset:0
    ds_read_b128 v[100:103], v8 offset:64
    ds_read_b128 v[104:107], v8 offset:128
    ds_read_b128 v[108:111], v8 offset:192
    s_waitcnt lgkmcnt(3)
    v_mfma_f32_16x16x32_f16 v[20:23], v[32:35], v[96:99], 0
    v_mfma_f32_16x16x32_f16 v[24:27], v[36:39], v[96:99], 0
    ds_read_b128 v[112:115], v8 offset:256
    s_waitcnt lgkmcnt(3)
    v_mfma_f32_16x16x32_f16 v[20:23], v[40:43], v[100:103], v[20:23]
    ds_read_b64 v[28:29], v7 offset:480
    ds_read_b64 v[30:31], v7 offset:992
    v_mfma_f32_16x16x32_f16 v[24:27], v[44:47], v[100:103], v[24:27]
    ds_read_b128 v[116:119], v8 offset:320
    s_waitcnt lgkmcnt(5)
    v_mfma_f32_16x16x32_f16 v[20:23], v[48:51], v[104:107], v[20:23]
    v_mfma_f32_16x16x32_f16 v[24:27], v[52:55], v[104:107], v[24:27]
    ds_read_b128 v[120:123], v8 offset:384
    s_waitcnt lgkmcnt(2)
    v_fma_mix_f32 v104, v28, v17, 0 op_sel_hi:[1,0,0]
    v_fma_mix_f32 v105, v28, v17, 0 op_sel:[1,0,0] op_sel_hi:[1,0,0]
    v_mfma_f32_16x16x32_f16 v[20:23], v[56:59], v[108:111], v[20:23]
    v_fma_mix_f32 v106, v29, v17, 0 op_sel_hi:[1,0,0]
    v_fma_mix_f32 v107, v29, v17, 0 op_sel:[1,0,0] op_sel_hi:[1,0,0]
    v_mfma_f32_16x16x32_f16 v[24:27], v[60:63], v[108:111], v[24:27]
    ds_read_b128 v[124:127], v8 offset:448
    v_cvt_pk_bf16_f32 v104, 0, v104
    v_cvt_pk_bf16_f32 v105, 0, v105
    v_mfma_f32_16x16x32_f16 v[20:23], v[64:67], v[112:115], v[20:23]
    v_cvt_pk_bf16_f32 v106, 0, v106
    v_cvt_pk_bf16_f32 v107, 0, v107
    v_mfma_f32_16x16x32_f16 v[24:27], v[68:71], v[112:115], v[24:27]
    ds_read_b128 v[36:39], v8 offset:512
    v_fma_mix_f32 v112, v30, v17, 0 op_sel_hi:[1,0,0]
    v_fma_mix_f32 v113, v30, v17, 0 op_sel:[1,0,0] op_sel_hi:[1,0,0]
    s_waitcnt lgkmcnt(3)
    v_mfma_f32_16x16x32_f16 v[20:23], v[72:75], v[116:119], v[20:23]
    ds_read_b128 v[96:99], v8 offset:576
    v_fma_mix_f32 v114, v31, v17, 0 op_sel_hi:[1,0,0]
    v_fma_mix_f32 v115, v31, v17, 0 op_sel:[1,0,0] op_sel_hi:[1,0,0]
    v_mfma_f32_16x16x32_f16 v[24:27], v[76:79], v[116:119], v[24:27]
    ds_read_b128 v[44:47], v8 offset:640
    v_cvt_pk_bf16_f32 v112, 0, v112
    v_cvt_pk_bf16_f32 v113, 0, v113
    s_waitcnt lgkmcnt(4)
    v_mfma_f32_16x16x32_f16 v[20:23], v[80:83], v[120:123], v[20:23]
    ds_read_b128 v[100:103], v8 offset:704
    v_cvt_pk_bf16_f32 v114, 0, v114
    v_cvt_pk_bf16_f32 v115, 0, v115
    v_mfma_f32_16x16x32_f16 v[24:27], v[84:87], v[120:123], v[24:27]
    ds_read_b128 v[52:55], v8 offset:768
    s_waitcnt lgkmcnt(5)
    v_mfma_f32_16x16x32_f16 v[20:23], v[88:91], v[124:127], v[20:23]
    ds_read_b128 v[60:63], v8 offset:832
    v_mfma_f32_16x16x32_f16 v[24:27], v[92:95], v[124:127], v[24:27]
    ds_read_b128 v[108:111], v8 offset:896
    s_waitcnt lgkmcnt(6)
    v_mfma_f32_16x16x32_f16 v[24:27], v[32:35], v[36:39], v[24:27]
    ds_read_b128 v[68:71], v8 offset:960
    s_nop 1
    v_cvt_pk_bf16_f32 v20, 0, v20
    v_cvt_pk_bf16_f32 v21, 0, v21
    s_waitcnt lgkmcnt(6)
    v_mfma_f32_16x16x32_f16 v[24:27], v[40:43], v[96:99], v[24:27]
    v_cvt_pk_bf16_f32 v22, 0, v22
    v_cvt_pk_bf16_f32 v23, 0, v23
    s_waitcnt lgkmcnt(5)
    v_mfma_f32_16x16x32_f16 v[24:27], v[48:51], v[44:47], v[24:27]
    v_fma_f32 v20, v20, v16, v104
    v_fma_f32 v21, v21, v16, v105
    s_waitcnt lgkmcnt(4)
    v_mfma_f32_16x16x32_f16 v[24:27], v[56:59], v[100:103], v[24:27]
    v_fma_f32 v22, v22, v16, v106
    v_fma_f32 v23, v23, v16, v107
    s_waitcnt lgkmcnt(3)
    v_mfma_f32_16x16x32_f16 v[24:27], v[64:67], v[52:55], v[24:27]
    v_cvt_pk_bf16_f32 v28, v20, v21
    v_cvt_pk_bf16_f32 v29, v22, v23
    s_waitcnt lgkmcnt(2)
    v_mfma_f32_16x16x32_f16 v[24:27], v[72:75], v[60:63], v[24:27]
    v_min_u32 v28, -2, v28
    v_min_u32 v29, -2, v29
    s_waitcnt lgkmcnt(1)
    v_mfma_f32_16x16x32_f16 v[24:27], v[80:83], v[108:111], v[24:27]
    s_waitcnt lgkmcnt(0)
    v_mfma_f32_16x16x32_f16 v[24:27], v[88:91], v[68:71], v[24:27]
    ds_read_u8 v18, v14 offset:112
    ds_read_b128 v[20:23], v12 offset:46592
    s_nop 5
    v_cvt_pk_bf16_f32 v24, 0, v24
    v_cvt_pk_bf16_f32 v25, 0, v25
    v_cvt_pk_bf16_f32 v26, 0, v26
    v_cvt_pk_bf16_f32 v27, 0, v27
    v_fma_f32 v24, v24, v16, v112
    v_fma_f32 v25, v25, v16, v113
    v_fma_f32 v26, v26, v16, v114
    v_fma_f32 v27, v27, v16, v115
    v_cvt_pk_bf16_f32 v30, v24, v25
    v_cvt_pk_bf16_f32 v31, v26, v27
    v_min_u32 v30, -2, v30
    v_min_u32 v31, -2, v31
    s_branch CVE_32
CV_29:
    ds_read_b64 v[32:33], v6 offset:0
    ds_read_b64 v[34:35], v6 offset:8
    ds_read_b64 v[36:37], v6 offset:64
    ds_read_b64 v[38:39], v6 offset:72
    ds_read_b64 v[40:41], v6 offset:128
    ds_read_b64 v[42:43], v6 offset:136
    ds_read_b64 v[44:45], v6 offset:192
    ds_read_b64 v[46:47], v6 offset:200
    ds_read_b64 v[48:49], v6 offset:256
    ds_read_b64 v[50:51], v6 offset:264
    ds_read_b64 v[52:53], v6 offset:320
    ds_read_b64 v[54:55], v6 offset:328
    ds_read_b64 v[56:57], v6 offset:384
    ds_read_b64 v[58:59], v6 offset:392
    ds_read_b64 v[60:61], v6 offset:448
    ds_read_b64 v[62:63], v6 offset:456
    ds_read_b64 v[64:65], v6 offset:512
    ds_read_b64 v[66:67], v6 offset:520
    ds_read_b64 v[68:69], v6 offset:576
    ds_read_b64 v[70:71], v6 offset:584
    ds_read_b64 v[72:73], v6 offset:640
    ds_read_b64 v[74:75], v6 offset:648
    ds_read_b64 v[76:77], v6 offset:704
    ds_read_b64 v[78:79], v6 offset:712
    ds_read_b64 v[80:81], v6 offset:768
    ds_read_b64 v[82:83], v6 offset:776
    ds_read_b64 v[84:85], v6 offset:832
    ds_read_b64 v[86:87], v6 offset:840
    ds_read_b64 v[88:89], v6 offset:896
    ds_read_b64 v[90:91], v6 offset:904
    ds_read_b64 v[92:93], v6 offset:960
    ds_read_b64 v[94:95], v6 offset:968
    ds_read_b64 v[96:97], v6 offset:1024
    ds_read_b64 v[98:99], v6 offset:1032
    ds_read_b64 v[100:101], v11 offset:128
    ds_read_b64 v[102:103], v11 offset:136
    ds_read_b64 v[104:105], v11 offset:384
    ds_read_b64 v[106:107], v11 offset:392
    v_lshlrev_b32 v18, 3, v3
    v_sub_u32 v18, v8, v18
    v_lshrrev_b32 v19, 2, v2
    v_lshl_add_u32 v19, v19, 2, v3
    v_and_b32 v28, 3, v2
    v_lshlrev_b32 v28, 4, v28
    v_mul_u32_u24 v19, s8, v19
    v_xor_b32 v19, s10, v19
    s_waitcnt lgkmcnt(0)
    v_mov_b32 v7, v18
    v_add_u32 v6, v19, v28
    v_xor_b32 v12, s9, v12
W_34:
    ds_read_b32 v18, v4 offset:16
    s_sub_u32 s39, s39, 1
    s_cbranch_scc1 KS_ABORT
    s_waitcnt lgkmcnt(0)
    v_cmp_ne_u32 vcc, s84, v18
    s_cbranch_vccnz W_34
    s_setprio 1
    ds_read_b128 v[108:111], v8 offset:448
    ds_read_b128 v[112:115], v8 offset:512
    ds_read_b128 v[116:119], v8 offset:576
    ds_read_b128 v[120:123], v8 offset:640
    ds_read_b128 v[124:127], v8 offset:704
    s_waitcnt lgkmcnt(4)
    v_mfma_f32_16x16x32_f16 v[20:23], v[32:35], v[108:111], 0
    ds_read_b128 v[108:111], v8 offset:768
    s_waitcnt lgkmcnt(4)
    v_mfma_f32_16x16x32_f16 v[20:23], v[36:39], v[112:115], v[20:23]
    ds_read_b128 v[112:115], v8 offset:832
    s_waitcnt lgkmcnt(4)
    v_mfma_f32_16x16x32_f16 v[20:23], v[40:43], v[116:119], v[20:23]
    ds_read_b128 v[116:119], v8 offset:896
    ds_read_b64 v[28:29], v7 offset:1504
    ds_read_b64 v[30:31], v7 offset:2016
    s_waitcnt lgkmcnt(6)
    v_mfma_f32_16x16x32_f16 v[20:23], v[44:47], v[120:123], v[20:23]
    ds_read_b128 v[120:123], v8 offset:960
    s_waitcnt lgkmcnt(6)
    v_mfma_f32_16x16x32_f16 v[20:23], v[48:51], v[124:127], v[20:23]
    ds_read_b128 v[124:127], v8 offset:1024
    s_waitcnt lgkmcnt(6)
    v_mfma_f32_16x16x32_f16 v[20:23], v[52:55], v[108:111], v[20:23]
    ds_read_b128 v[108:111], v8 offset:1088
    s_waitcnt lgkmcnt(6)
    v_mfma_f32_16x16x32_f16 v[20:23], v[56:59], v[112:115], v[20:23]
    s_waitcnt lgkmcnt(5)
    v_mfma_f32_16x16x32_f16 v[20:23], v[60:63], v[116:119], v[20:23]
    ds_read_b128 v[112:115], v8 offset:1152
    s_waitcnt lgkmcnt(3)
    v_mfma_f32_16x16x32_f16 v[20:23], v[64:67], v[120:123], v[20:23]
    v_mfma_f32_16x16x32_f16 v[24:27], v[32:35], v[120:123], 0
    ds_read_b128 v[116:119], v8 offset:1216
    v_fma_mix_f32 v120, v28, v17, 0 op_sel_hi:[1,0,0]
    v_fma_mix_f32 v121, v28, v17, 0 op_sel:[1,0,0] op_sel_hi:[1,0,0]
    s_waitcnt lgkmcnt(3)
    v_mfma_f32_16x16x32_f16 v[20:23], v[68:71], v[124:127], v[20:23]
    v_fma_mix_f32 v122, v29, v17, 0 op_sel_hi:[1,0,0]
    v_fma_mix_f32 v123, v29, v17, 0 op_sel:[1,0,0] op_sel_hi:[1,0,0]
    v_mfma_f32_16x16x32_f16 v[24:27], v[36:39], v[124:127], v[24:27]
    ds_read_b128 v[32:35], v8 offset:1280
    v_cvt_pk_bf16_f32 v120, 0, v120
    v_cvt_pk_bf16_f32 v121, 0, v121
    s_waitcnt lgkmcnt(3)
    v_mfma_f32_16x16x32_f16 v[20:23], v[72:75], v[108:111], v[20:23]
    v_cvt_pk_bf16_f32 v122, 0, v122
    v_cvt_pk_bf16_f32 v123, 0, v123
    v_mfma_f32_16x16x32_f16 v[24:27], v[40:43], v[108:111], v[24:27]
    ds_read_b128 v[36:39], v8 offset:1344
    v_fma_mix_f32 v108, v30, v17, 0 op_sel_hi:[1,0,0]
    v_fma_mix_f32 v109, v30, v17, 0 op_sel:[1,0,0] op_sel_hi:[1,0,0]
    s_waitcnt lgkmcnt(3)
    v_mfma_f32_16x16x32_f16 v[20:23], v[76:79], v[112:115], v[20:23]
    v_fma_mix_f32 v110, v31, v17, 0 op_sel_hi:[1,0,0]
    v_fma_mix_f32 v111, v31, v17, 0 op_sel:[1,0,0] op_sel_hi:[1,0,0]
    v_mfma_f32_16x16x32_f16 v[24:27], v[44:47], v[112:115], v[24:27]
    ds_read_b128 v[124:127], v8 offset:1408
    v_cvt_pk_bf16_f32 v108, 0, v108
    v_cvt_pk_bf16_f32 v109, 0, v109
    s_waitcnt lgkmcnt(3)
    v_mfma_f32_16x16x32_f16 v[20:23], v[80:83], v[116:119], v[20:23]
    v_cvt_pk_bf16_f32 v110, 0, v110
    v_cvt_pk_bf16_f32 v111, 0, v111
    v_mfma_f32_16x16x32_f16 v[24:27], v[48:51], v[116:119], v[24:27]
    ds_read_b128 v[40:43], v8 offset:1472
    s_waitcnt lgkmcnt(3)
    v_mfma_f32_16x16x32_f16 v[20:23], v[84:87], v[32:35], v[20:23]
    v_mfma_f32_16x16x32_f16 v[24:27], v[52:55], v[32:35], v[24:27]
    ds_read_b128 v[44:47], v8 offset:1536
    s_waitcnt lgkmcnt(3)
    v_mfma_f32_16x16x32_f16 v[20:23], v[88:91], v[36:39], v[20:23]
    ds_read_b128 v[112:115], v8 offset:1600
    v_mfma_f32_16x16x32_f16 v[24:27], v[56:59], v[36:39], v[24:27]
    ds_read_b128 v[48:51], v8 offset:1664
    s_waitcnt lgkmcnt(4)
    v_mfma_f32_16x16x32_f16 v[20:23], v[92:95], v[124:127], v[20:23]
    ds_read_b128 v[116:119], v8 offset:1728
    v_mfma_f32_16x16x32_f16 v[24:27], v[60:63], v[124:127], v[24:27]
    ds_read_b128 v[52:55], v8 offset:1792
    s_waitcnt lgkmcnt(5)
    v_mfma_f32_16x16x32_f16 v[20:23], v[96:99], v[40:43], v[20:23]
    ds_read_b128 v[32:35], v8 offset:1856
    v_mfma_f32_16x16x32_f16 v[24:27], v[64:67], v[40:43], v[24:27]
    ds_read_b32 v18, v14 offset:76
    ds_read_b128 v[56:59], v8 offset:1920
    s_waitcnt lgkmcnt(7)
    v_mfma_f32_16x16x32_f16 v[24:27], v[68:71], v[44:47], v[24:27]
    ds_read_b128 v[36:39], v8 offset:1984
    s_waitcnt lgkmcnt(7)
    v_mfma_f32_16x16x32_f16 v[24:27], v[72:75], v[112:115], v[24:27]
    ds_read_b64 v[60:61], v11 offset:64
    ds_read_b64 v[62:63], v11 offset:72
    s_waitcnt lgkmcnt(8)
    v_mfma_f32_16x16x32_f16 v[24:27], v[76:79], v[48:51], v[24:27]
    s_waitcnt lgkmcnt(4)
    v_cmp_ne_u32 vcc, s84, v18
    s_cbranch_vccnz WS_35
WB_36:
    ds_read_b64_tr_b16 v[124:125], v9 offset:0
    ds_read_b64_tr_b16 v[126:127], v9 offset:64
    ds_read_b64_tr_b16 v[64:65], v9 offset:3088
    ds_read_b64_tr_b16 v[66:67], v9 offset:3152
    v_mfma_f32_16x16x32_f16 v[24:27], v[80:83], v[116:119], v[24:27]
    v_mfma_f32_16x16x32_f16 v[24:27], v[84:87], v[52:55], v[24:27]
    ds_read_b64_tr_b16 v[40:41], v9 offset:512
    ds_read_b64_tr_b16 v[42:43], v9 offset:576
    ds_read_b64 v[68:69], v11 offset:320
    ds_read_b64 v[70:71], v11 offset:328
    v_mfma_f32_16x16x32_f16 v[24:27], v[88:91], v[32:35], v[24:27]
    s_waitcnt lgkmcnt(11)
    v_mfma_f32_16x16x32_f16 v[24:27], v[92:95], v[56:59], v[24:27]
    ds_read_b64_tr_b16 v[44:45], v9 offset:3600
    ds_read_b64_tr_b16 v[46:47], v9 offset:3664
    s_waitcnt lgkmcnt(12)
    v_mfma_f32_16x16x32_f16 v[24:27], v[96:99], v[36:39], v[24:27]
    s_waitcnt lgkmcnt(8)
    v_mfma_f32_16x16x32_f16 v[20:23], v[124:127], v[100:103], v[20:23]
    s_waitcnt lgkmcnt(6)
    v_mfma_f32_16x16x32_f16 v[20:23], v[64:67], v[104:107], v[20:23]
    v_mfma_f32_16x16x32_f16 v[24:27], v[124:127], v[60:63], v[24:27]
    s_waitcnt lgkmcnt(4)
    v_mfma_f32_16x16x32_f16 v[24:27], v[40:43], v[100:103], v[24:27]
    s_nop 4
    v_cvt_pk_bf16_f32 v20, 0, v20
    v_cvt_pk_bf16_f32 v21, 0, v21
    s_waitcnt lgkmcnt(2)
    v_mfma_f32_16x16x32_f16 v[24:27], v[64:67], v[68:71], v[24:27]
    v_cvt_pk_bf16_f32 v22, 0, v22
    v_cvt_pk_bf16_f32 v23, 0, v23
    s_waitcnt lgkmcnt(0)
    v_mfma_f32_16x16x32_f16 v[24:27], v[44:47], v[104:107], v[24:27]
    v_fma_f32 v20, v20, v16, v120
    v_fma_f32 v21, v21, v16, v121
    v_fma_f32 v22, v22, v16, v122
    v_fma_f32 v23, v23, v16, v123
    v_cvt_pk_bf16_f32 v28, v20, v21
    v_cvt_pk_bf16_f32 v29, v22, v23
    v_min_u32 v28, -2, v28
    v_min_u32 v29, -2, v29
    ds_read_u8 v18, v14 offset:113
    ds_read_b128 v[20:23], v12 offset:47616
    v_cvt_pk_bf16_f32 v24, 0, v24
    v_cvt_pk_bf16_f32 v25, 0, v25
    v_cvt_pk_bf16_f32 v26, 0, v26
    v_cvt_pk_bf16_f32 v27, 0, v27
    v_fma_f32 v24, v24, v16, v108
    v_fma_f32 v25, v25, v16, v109
    v_fma_f32 v26, v26, v16, v110
    v_fma_f32 v27, v27, v16, v111
    v_cvt_pk_bf16_f32 v30, v24, v25
    v_cvt_pk_bf16_f32 v31, v26, v27
    v_min_u32 v30, -2, v30
    v_min_u32 v31, -2, v31
    s_branch CVE_32
CV_30:
    ds_read_b64 v[32:33], v6 offset:1152
    ds_read_b64 v[34:35], v6 offset:1160
    ds_read_b64 v[36:37], v6 offset:0
    ds_read_b64 v[38:39], v6 offset:8
    ds_read_b64 v[40:41], v6 offset:64
    ds_read_b64 v[42:43], v6 offset:72
    ds_read_b64 v[44:45], v6 offset:128
    ds_read_b64 v[46:47], v6 offset:136
    ds_read_b64 v[48:49], v6 offset:192
    ds_read_b64 v[50:51], v6 offset:200
    ds_read_b64 v[52:53], v6 offset:256
    ds_read_b64 v[54:55], v6 offset:264
    ds_read_b64 v[56:57], v6 offset:320
    ds_read_b64 v[58:59], v6 offset:328
    ds_read_b64 v[60:61], v6 offset:384
    ds_read_b64 v[62:63], v6 offset:392
    ds_read_b64 v[64:65], v6 offset:448
    ds_read_b64 v[66:67], v6 offset:456
    ds_read_b64 v[68:69], v6 offset:512
    ds_read_b64 v[70:71], v6 offset:520
    ds_read_b64 v[72:73], v6 offset:576
    ds_read_b64 v[74:75], v6 offset:584
    ds_read_b64 v[76:77], v6 offset:640
    ds_read_b64 v[78:79], v6 offset:648
    ds_read_b64 v[80:81], v6 offset:704
    ds_read_b64 v[82:83], v6 offset:712
    ds_read_b64 v[84:85], v6 offset:768
    ds_read_b64 v[86:87], v6 offset:776
    ds_read_b64 v[88:89], v6 offset:832
    ds_read_b64 v[90:91], v6 offset:840
    ds_read_b64 v[92:93], v6 offset:896
    ds_read_b64 v[94:95], v6 offset:904
    ds_read_b64 v[96:97], v6 offset:960
    ds_read_b64 v[98:99], v6 offset:968
    ds_read_b64 v[100:101], v6 offset:1024
    ds_read_b64 v[102:103], v6 offset:1032
    ds_read_b64 v[104:105], v11 offset:0
    ds_read_b64 v[106:107], v11 offset:8
    v_lshlrev_b32 v18, 3, v3
    v_sub_u32 v18, v8, v18
    v_lshrrev_b32 v19, 2, v2
    v_lshl_add_u32 v19, v19, 2, v3
    v_and_b32 v28, 3, v2
    v_lshlrev_b32 v28, 4, v28
    v_mul_u32_u24 v19, s8, v19
    v_xor_b32 v19, s10, v19
    s_waitcnt lgkmcnt(0)
    v_mov_b32 v7, v18
    v_add_u32 v6, v19, v28
    v_xor_b32 v12, s9, v12
W_37:
    ds_read_b32 v18, v4 offset:16
    s_sub_u32 s39, s39, 1
    s_cbranch_scc1 KS_ABORT
    s_waitcnt lgkmcnt(0)
    v_cmp_ne_u32 vcc, s84, v18
    s_cbranch_vccnz W_37
    s_setprio 1
    ds_read_b128 v[108:111], v8 offset:448
    ds_read_b128 v[112:115], v8 offset:960
    ds_read_b128 v[116:119], v8 offset:1472
    ds_read_b128 v[120:123], v8 offset:1536
    ds_read_b128 v[124:127], v8 offset:1600
    s_waitcnt lgkmcnt(4)
    v_mfma_f32_16x16x32_f16 v[20:23], v[32:35], v[108:111], 0
    ds_read_b128 v[108:111], v8 offset:1664
    s_waitcnt lgkmcnt(4)
    v_mfma_f32_16x16x32_f16 v[24:27], v[32:35], v[112:115], 0
    ds_read_b128 v[32:35], v8 offset:1728
    ds_read_b128 v[112:115], v8 offset:1792
    s_waitcnt lgkmcnt(5)
    v_mfma_f32_16x16x32_f16 v[20:23], v[36:39], v[116:119], v[20:23]
    ds_read_b128 v[116:119], v8 offset:1856
    ds_read_b64 v[28:29], v7 offset:2528
    ds_read_b64 v[30:31], v7 offset:3040
    s_waitcnt lgkmcnt(7)
    v_mfma_f32_16x16x32_f16 v[20:23], v[40:43], v[120:123], v[20:23]
    ds_read_b128 v[120:123], v8 offset:1920
    s_waitcnt lgkmcnt(7)
    v_mfma_f32_16x16x32_f16 v[20:23], v[44:47], v[124:127], v[20:23]
    ds_read_b128 v[124:127], v8 offset:1984
    s_waitcnt lgkmcnt(7)
    v_mfma_f32_16x16x32_f16 v[20:23], v[48:51], v[108:111], v[20:23]
    ds_read_b128 v[108:111], v8 offset:2048
    s_waitcnt lgkmcnt(7)
    v_mfma_f32_16x16x32_f16 v[20:23], v[52:55], v[32:35], v[20:23]
    s_waitcnt lgkmcnt(6)
    v_mfma_f32_16x16x32_f16 v[20:23], v[56:59], v[112:115], v[20:23]
    ds_read_b128 v[32:35], v8 offset:2112
    s_waitcnt lgkmcnt(6)
    v_mfma_f32_16x16x32_f16 v[20:23], v[60:63], v[116:119], v[20:23]
    s_waitcnt lgkmcnt(4)
    v_fma_mix_f32 v116, v28, v17, 0 op_sel_hi:[1,0,0]
    v_fma_mix_f32 v117, v28, v17, 0 op_sel:[1,0,0] op_sel_hi:[1,0,0]
    s_waitcnt lgkmcnt(3)
    v_mfma_f32_16x16x32_f16 v[20:23], v[64:67], v[120:123], v[20:23]
    ds_read_b128 v[112:115], v8 offset:2176
    v_fma_mix_f32 v118, v29, v17, 0 op_sel_hi:[1,0,0]
    v_fma_mix_f32 v119, v29, v17, 0 op_sel:[1,0,0] op_sel_hi:[1,0,0]
    s_waitcnt lgkmcnt(3)
    v_mfma_f32_16x16x32_f16 v[20:23], v[68:71], v[124:127], v[20:23]
    v_cvt_pk_bf16_f32 v116, 0, v116
    v_cvt_pk_bf16_f32 v117, 0, v117
    v_mfma_f32_16x16x32_f16 v[24:27], v[36:39], v[124:127], v[24:27]
    ds_read_b128 v[120:123], v8 offset:2240
    v_cvt_pk_bf16_f32 v118, 0, v118
    v_cvt_pk_bf16_f32 v119, 0, v119
    s_waitcnt lgkmcnt(3)
    v_mfma_f32_16x16x32_f16 v[20:23], v[72:75], v[108:111], v[20:23]
    v_fma_mix_f32 v124, v30, v17, 0 op_sel_hi:[1,0,0]
    v_fma_mix_f32 v125, v30, v17, 0 op_sel:[1,0,0] op_sel_hi:[1,0,0]
    v_mfma_f32_16x16x32_f16 v[24:27], v[40:43], v[108:111], v[24:27]
    ds_read_b128 v[36:39], v8 offset:2304
    v_fma_mix_f32 v126, v31, v17, 0 op_sel_hi:[1,0,0]
    v_fma_mix_f32 v127, v31, v17, 0 op_sel:[1,0,0] op_sel_hi:[1,0,0]
    s_waitcnt lgkmcnt(3)
    v_mfma_f32_16x16x32_f16 v[20:23], v[76:79], v[32:35], v[20:23]
    v_cvt_pk_bf16_f32 v124, 0, v124
    v_cvt_pk_bf16_f32 v125, 0, v125
    v_mfma_f32_16x16x32_f16 v[24:27], v[44:47], v[32:35], v[24:27]
    ds_read_b128 v[40:43], v8 offset:2368
    v_cvt_pk_bf16_f32 v126, 0, v126
    v_cvt_pk_bf16_f32 v127, 0, v127
    s_waitcnt lgkmcnt(3)
    v_mfma_f32_16x16x32_f16 v[20:23], v[80:83], v[112:115], v[20:23]
    v_mfma_f32_16x16x32_f16 v[24:27], v[48:51], v[112:115], v[24:27]
    ds_read_b128 v[108:111], v8 offset:2432
    s_waitcnt lgkmcnt(3)
    v_mfma_f32_16x16x32_f16 v[20:23], v[84:87], v[120:123], v[20:23]
    v_mfma_f32_16x16x32_f16 v[24:27], v[52:55], v[120:123], v[24:27]
    ds_read_b128 v[44:47], v8 offset:2496
    s_waitcnt lgkmcnt(3)
    v_mfma_f32_16x16x32_f16 v[20:23], v[88:91], v[36:39], v[20:23]
    v_mfma_f32_16x16x32_f16 v[24:27], v[56:59], v[36:39], v[24:27]
    ds_read_b128 v[32:35], v8 offset:2560
    s_waitcnt lgkmcnt(3)
    v_mfma_f32_16x16x32_f16 v[20:23], v[92:95], v[40:43], v[20:23]
    ds_read_b128 v[48:51], v8 offset:2624
    v_mfma_f32_16x16x32_f16 v[24:27], v[60:63], v[40:43], v[24:27]
    ds_read_b128 v[112:115], v8 offset:2688
    s_waitcnt lgkmcnt(4)
    v_mfma_f32_16x16x32_f16 v[20:23], v[96:99], v[108:111], v[20:23]
    ds_read_b128 v[52:55], v8 offset:2752
    v_mfma_f32_16x16x32_f16 v[24:27], v[64:67], v[108:111], v[24:27]
    ds_read_b128 v[120:123], v8 offset:2816
    s_waitcnt lgkmcnt(5)
    v_mfma_f32_16x16x32_f16 v[20:23], v[100:103], v[44:47], v[20:23]
    ds_read_b128 v[56:59], v8 offset:2880
    v_mfma_f32_16x16x32_f16 v[24:27], v[68:71], v[44:47], v[24:27]
    ds_read_b32 v18, v14 offset:76
    ds_read_b128 v[36:39], v8 offset:2944
    s_waitcnt lgkmcnt(7)
    v_mfma_f32_16x16x32_f16 v[24:27], v[72:75], v[32:35], v[24:27]
    ds_read_b128 v[60:63], v8 offset:3008
    s_waitcnt lgkmcnt(7)
    v_mfma_f32_16x16x32_f16 v[24:27], v[76:79], v[48:51], v[24:27]
    ds_read_b64 v[40:41], v11 offset:64
    ds_read_b64 v[42:43], v11 offset:72
    ds_read_b64 v[64:65], v11 offset:128
    ds_read_b64 v[66:67], v11 offset:136
    s_waitcnt lgkmcnt(10)
    v_mfma_f32_16x16x32_f16 v[24:27], v[80:83], v[112:115], v[24:27]
    s_waitcnt lgkmcnt(6)
    v_cmp_ne_u32 vcc, s84, v18
    s_cbranch_vccnz WS_38
WB_39:
    ds_read_b64_tr_b16 v[108:109], v9 offset:0
    ds_read_b64_tr_b16 v[110:111], v9 offset:64
    ds_read_b64_tr_b16 v[68:69], v9 offset:512
    ds_read_b64_tr_b16 v[70:71], v9 offset:576
    v_mfma_f32_16x16x32_f16 v[24:27], v[84:87], v[52:55], v[24:27]
    ds_read_b64_tr_b16 v[44:45], v9 offset:1024
    ds_read_b64_tr_b16 v[46:47], v9 offset:1088
    v_mfma_f32_16x16x32_f16 v[24:27], v[88:91], v[120:123], v[24:27]
    ds_read_b64_tr_b16 v[72:73], v9 offset:3088
    ds_read_b64_tr_b16 v[74:75], v9 offset:3152
    ds_read_b64 v[32:33], v11 offset:256
    ds_read_b64 v[34:35], v11 offset:264
    v_mfma_f32_16x16x32_f16 v[24:27], v[92:95], v[56:59], v[24:27]
    ds_read_b64_tr_b16 v[76:77], v9 offset:3600
    ds_read_b64_tr_b16 v[78:79], v9 offset:3664
    ds_read_b64 v[48:49], v11 offset:320
    ds_read_b64 v[50:51], v11 offset:328
    v_mfma_f32_16x16x32_f16 v[24:27], v[96:99], v[36:39], v[24:27]
    ds_read_b64_tr_b16 v[80:81], v9 offset:4112
    ds_read_b64_tr_b16 v[82:83], v9 offset:4176
    ds_read_b64 v[112:113], v11 offset:384
    ds_read_b64 v[114:115], v11 offset:392
    v_mfma_f32_16x16x32_f16 v[24:27], v[100:103], v[60:63], v[24:27]
    ds_read_b64_tr_b16 v[84:85], v10 offset:6176
    ds_read_b64_tr_b16 v[86:87], v10 offset:6304
    ds_read_b64 v[52:53], v13 offset:96
    ds_read_b64 v[54:55], v13 offset:104
    v_mfma_f32_16x16x32_f16 v[20:23], v[108:111], v[104:107], v[20:23]
    ds_read_b64_tr_b16 v[88:89], v10 offset:8224
    ds_read_b64_tr_b16 v[90:91], v10 offset:8352
    ds_read_b64 v[120:121], v13 offset:480
    ds_read_b64 v[122:123], v13 offset:488
    v_mfma_f32_16x16x32_f16 v[20:23], v[68:71], v[40:43], v[20:23]
    v_mfma_f32_16x16x32_f16 v[20:23], v[44:47], v[64:67], v[20:23]
    v_mfma_f32_16x16x32_f16 v[20:23], v[72:75], v[32:35], v[20:23]
    ds_read_b64_tr_b16 v[92:93], v9 offset:1536
    ds_read_b64_tr_b16 v[94:95], v9 offset:1600
    s_waitcnt lgkmcnt(14)
    v_mfma_f32_16x16x32_f16 v[20:23], v[76:79], v[48:51], v[20:23]
    s_waitcnt lgkmcnt(10)
    v_mfma_f32_16x16x32_f16 v[20:23], v[80:83], v[112:115], v[20:23]
    s_waitcnt lgkmcnt(6)
    v_mfma_f32_16x16x32_f16 v[20:23], v[84:87], v[52:55], v[20:23]
    ds_read_b64_tr_b16 v[56:57], v9 offset:4624
    ds_read_b64_tr_b16 v[58:59], v9 offset:4688
    ds_read_b64 v[96:97], v13 offset:64
    ds_read_b64 v[98:99], v13 offset:72
    s_waitcnt lgkmcnt(6)
    v_mfma_f32_16x16x32_f16 v[20:23], v[88:91], v[120:123], v[20:23]
    ds_read_b64 v[36:37], v13 offset:448
    ds_read_b64 v[38:39], v13 offset:456
    v_mfma_f32_16x16x32_f16 v[24:27], v[68:71], v[104:107], v[24:27]
    v_mfma_f32_16x16x32_f16 v[24:27], v[44:47], v[40:43], v[24:27]
    s_nop 3
    v_cvt_pk_bf16_f32 v20, 0, v20
    v_cvt_pk_bf16_f32 v21, 0, v21
    s_waitcnt lgkmcnt(6)
    v_mfma_f32_16x16x32_f16 v[24:27], v[92:95], v[64:67], v[24:27]
    v_cvt_pk_bf16_f32 v22, 0, v22
    v_cvt_pk_bf16_f32 v23, 0, v23
    v_mfma_f32_16x16x32_f16 v[24:27], v[76:79], v[32:35], v[24:27]
    v_fma_f32 v20, v20, v16, v116
    v_fma_f32 v21, v21, v16, v117
    v_mfma_f32_16x16x32_f16 v[24:27], v[80:83], v[48:51], v[24:27]
    v_fma_f32 v22, v22, v16, v118
    v_fma_f32 v23, v23, v16, v119
    s_waitcnt lgkmcnt(4)
    v_mfma_f32_16x16x32_f16 v[24:27], v[56:59], v[112:115], v[24:27]
    v_cvt_pk_bf16_f32 v28, v20, v21
    v_cvt_pk_bf16_f32 v29, v22, v23
    s_waitcnt lgkmcnt(2)
    v_mfma_f32_16x16x32_f16 v[24:27], v[84:87], v[96:99], v[24:27]
    v_min_u32 v28, -2, v28
    v_min_u32 v29, -2, v29
    s_waitcnt lgkmcnt(0)
    v_mfma_f32_16x16x32_f16 v[24:27], v[88:91], v[36:39], v[24:27]
    ds_read_u8 v18, v14 offset:114
    ds_read_b128 v[20:23], v12 offset:48640
    s_nop 5
    v_cvt_pk_bf16_f32 v24, 0, v24
    v_cvt_pk_bf16_f32 v25, 0, v25
    v_cvt_pk_bf16_f32 v26, 0, v26
    v_cvt_pk_bf16_f32 v27, 0, v27
    v_fma_f32 v24, v24, v16, v124
    v_fma_f32 v25, v25, v16, v125
    v_fma_f32 v26, v26, v16, v126
    v_fma_f32 v27, v27, v16, v127
    v_cvt_pk_bf16_f32 v30, v24, v25
    v_cvt_pk_bf16_f32 v31, v26, v27
    v_min_u32 v30, -2, v30
    v_min_u32 v31, -2, v31
    s_branch CVE_32
CV_31:
    ds_read_b64 v[32:33], v6 offset:1152
    ds_read_b64 v[34:35], v6 offset:1160
    ds_read_b64 v[36:37], v6 offset:0
    ds_read_b64 v[38:39], v6 offset:8
    ds_read_b64 v[40:41], v6 offset:64
    ds_read_b64 v[42:43], v6 offset:72
    ds_read_b64 v[44:45], v6 offset:128
    ds_read_b64 v[46:47], v6 offset:136
    ds_read_b64 v[48:49], v6 offset:192
    ds_read_b64 v[50:51], v6 offset:200
    ds_read_b64 v[52:53], v6 offset:256
    ds_read_b64 v[54:55], v6 offset:264
    ds_read_b64 v[56:57], v6 offset:320
    ds_read_b64 v[58:59], v6 offset:328
    ds_read_b64 v[60:61], v6 offset:384
    ds_read_b64 v[62:63], v6 offset:392
    ds_read_b64 v[64:65], v6 offset:448
    ds_read_b64 v[66:67], v6 offset:456
    ds_read_b64 v[68:69], v6 offset:512
    ds_read_b64 v[70:71], v6 offset:520
    ds_read_b64 v[72:73], v6 offset:576
    ds_read_b64 v[74:75], v6 offset:584
    ds_read_b64 v[76:77], v6 offset:640
    ds_read_b64 v[78:79], v6 offset:648
    ds_read_b64 v[80:81], v6 offset:704
    ds_read_b64 v[82:83], v6 offset:712
    ds_read_b64 v[84:85], v6 offset:768
    ds_read_b64 v[86:87], v6 offset:776
    ds_read_b64 v[88:89], v6 offset:832
    ds_read_b64 v[90:91], v6 offset:840
    ds_read_b64 v[92:93], v6 offset:896
    ds_read_b64 v[94:95], v6 offset:904
    ds_read_b64 v[96:97], v6 offset:960
    ds_read_b64 v[98:99], v6 offset:968
    ds_read_b64 v[100:101], v6 offset:1024
    ds_read_b64 v[102:103], v6 offset:1032
    ds_read_b64 v[104:105], v11 offset:0
    ds_read_b64 v[106:107], v11 offset:8
    v_lshlrev_b32 v18, 3, v3
    v_sub_u32 v18, v8, v18
    v_lshrrev_b32 v19, 2, v2
    v_lshl_add_u32 v19, v19, 2, v3
    v_and_b32 v28, 3, v2
    v_lshlrev_b32 v28, 4, v28
    v_mul_u32_u24 v19, s8, v19
    v_xor_b32 v19, s10, v19
    s_waitcnt lgkmcnt(0)
    v_mov_b32 v7, v18
    v_add_u32 v6, v19, v28
    v_xor_b32 v12, s9, v12
W_40:
    ds_read_b32 v18, v4 offset:16
    s_sub_u32 s39, s39, 1
    s_cbranch_scc1 KS_ABORT
    s_waitcnt lgkmcnt(0)
    v_cmp_ne_u32 vcc, s84, v18
    s_cbranch_vccnz W_40
    s_setprio 1
    ds_read_b128 v[108:111], v8 offset:1472
    ds_read_b128 v[112:115], v8 offset:1984
    ds_read_b128 v[116:119], v8 offset:2496
    ds_read_b128 v[120:123], v8 offset:2560
    ds_read_b128 v[124:127], v8 offset:2624
    s_waitcnt lgkmcnt(4)
    v_mfma_f32_16x16x32_f16 v[20:23], v[32:35], v[108:111], 0
    ds_read_b128 v[108:111], v8 offset:2688
    s_waitcnt lgkmcnt(4)
    v_mfma_f32_16x16x32_f16 v[24:27], v[32:35], v[112:115], 0
    ds_read_b128 v[32:35], v8 offset:2752
    ds_read_b128 v[112:115], v8 offset:2816
    s_waitcnt lgkmcnt(5)
    v_mfma_f32_16x16x32_f16 v[20:23], v[36:39], v[116:119], v[20:23]
    ds_read_b128 v[116:119], v8 offset:2880
    ds_read_b64 v[28:29], v7 offset:3552
    ds_read_b64 v[30:31], v7 offset:4064
    s_waitcnt lgkmcnt(7)
    v_mfma_f32_16x16x32_f16 v[20:23], v[40:43], v[120:123], v[20:23]
    ds_read_b128 v[120:123], v8 offset:2944
    s_waitcnt lgkmcnt(7)
    v_mfma_f32_16x16x32_f16 v[20:23], v[44:47], v[124:127], v[20:23]
    ds_read_b128 v[124:127], v8 offset:3008
    s_waitcnt lgkmcnt(7)
    v_mfma_f32_16x16x32_f16 v[20:23], v[48:51], v[108:111], v[20:23]
    ds_read_b128 v[108:111], v8 offset:3072
    s_waitcnt lgkmcnt(7)
    v_mfma_f32_16x16x32_f16 v[20:23], v[52:55], v[32:35], v[20:23]
    s_waitcnt lgkmcnt(6)
    v_mfma_f32_16x16x32_f16 v[20:23], v[56:59], v[112:115], v[20:23]
    ds_read_b128 v[32:35], v8 offset:3136
    s_waitcnt lgkmcnt(6)
    v_mfma_f32_16x16x32_f16 v[20:23], v[60:63], v[116:119], v[20:23]
    s_waitcnt lgkmcnt(4)
    v_fma_mix_f32 v116, v28, v17, 0 op_sel_hi:[1,0,0]
    v_fma_mix_f32 v117, v28, v17, 0 op_sel:[1,0,0] op_sel_hi:[1,0,0]
    s_waitcnt lgkmcnt(3)
    v_mfma_f32_16x16x32_f16 v[20:23], v[64:67], v[120:123], v[20:23]
    ds_read_b128 v[112:115], v8 offset:3200
    v_fma_mix_f32 v118, v29, v17, 0 op_sel_hi:[1,0,0]
    v_fma_mix_f32 v119, v29, v17, 0 op_sel:[1,0,0] op_sel_hi:[1,0,0]
    s_waitcnt lgkmcnt(3)
    v_mfma_f32_16x16x32_f16 v[20:23], v[68:71], v[124:127], v[20:23]
    v_cvt_pk_bf16_f32 v116, 0, v116
    v_cvt_pk_bf16_f32 v117, 0, v117
    v_mfma_f32_16x16x32_f16 v[24:27], v[36:39], v[124:127], v[24:27]
    ds_read_b128 v[120:123], v8 offset:3264
    v_cvt_pk_bf16_f32 v118, 0, v118
    v_cvt_pk_bf16_f32 v119, 0, v119
    s_waitcnt lgkmcnt(3)
    v_mfma_f32_16x16x32_f16 v[20:23], v[72:75], v[108:111], v[20:23]
    v_fma_mix_f32 v124, v30, v17, 0 op_sel_hi:[1,0,0]
    v_fma_mix_f32 v125, v30, v17, 0 op_sel:[1,0,0] op_sel_hi:[1,0,0]
    v_mfma_f32_16x16x32_f16 v[24:27], v[40:43], v[108:111], v[24:27]
    ds_read_b128 v[36:39], v8 offset:3328
    v_fma_mix_f32 v126, v31, v17, 0 op_sel_hi:[1,0,0]
    v_fma_mix_f32 v127, v31, v17, 0 op_sel:[1,0,0] op_sel_hi:[1,0,0]
    s_waitcnt lgkmcnt(3)
    v_mfma_f32_16x16x32_f16 v[20:23], v[76:79], v[32:35], v[20:23]
    v_cvt_pk_bf16_f32 v124, 0, v124
    v_cvt_pk_bf16_f32 v125, 0, v125
    v_mfma_f32_16x16x32_f16 v[24:27], v[44:47], v[32:35], v[24:27]
    ds_read_b128 v[40:43], v8 offset:3392
    v_cvt_pk_bf16_f32 v126, 0, v126
    v_cvt_pk_bf16_f32 v127, 0, v127
    s_waitcnt lgkmcnt(3)
    v_mfma_f32_16x16x32_f16 v[20:23], v[80:83], v[112:115], v[20:23]
    v_mfma_f32_16x16x32_f16 v[24:27], v[48:51], v[112:115], v[24:27]
    ds_read_b128 v[108:111], v8 offset:3456
    s_waitcnt lgkmcnt(3)
    v_mfma_f32_16x16x32_f16 v[20:23], v[84:87], v[120:123], v[20:23]
    v_mfma_f32_16x16x32_f16 v[24:27], v[52:55], v[120:123], v[24:27]
    ds_read_b128 v[44:47], v8 offset:3520
    s_waitcnt lgkmcnt(3)
    v_mfma_f32_16x16x32_f16 v[20:23], v[88:91], v[36:39], v[20:23]
    v_mfma_f32_16x16x32_f16 v[24:27], v[56:59], v[36:39], v[24:27]
    ds_read_b128 v[32:35], v8 offset:3584
    s_waitcnt lgkmcnt(3)
    v_mfma_f32_16x16x32_f16 v[20:23], v[92:95], v[40:43], v[20:23]
    ds_read_b128 v[48:51], v8 offset:3648
    v_mfma_f32_16x16x32_f16 v[24:27], v[60:63], v[40:43], v[24:27]
    ds_read_b128 v[112:115], v8 offset:3712
    s_waitcnt lgkmcnt(4)
    v_mfma_f32_16x16x32_f16 v[20:23], v[96:99], v[108:111], v[20:23]
    ds_read_b128 v[52:55], v8 offset:3776
    v_mfma_f32_16x16x32_f16 v[24:27], v[64:67], v[108:111], v[24:27]
    ds_read_b128 v[120:123], v8 offset:3840
    s_waitcnt lgkmcnt(5)
    v_mfma_f32_16x16x32_f16 v[20:23], v[100:103], v[44:47], v[20:23]
    ds_read_b128 v[56:59], v8 offset:3904
    v_mfma_f32_16x16x32_f16 v[24:27], v[68:71], v[44:47], v[24:27]
    ds_read_b32 v18, v14 offset:76
    ds_read_b128 v[36:39], v8 offset:3968
    s_waitcnt lgkmcnt(7)
    v_mfma_f32_16x16x32_f16 v[24:27], v[72:75], v[32:35], v[24:27]
    ds_read_b128 v[60:63], v8 offset:4032
    s_waitcnt lgkmcnt(7)
    v_mfma_f32_16x16x32_f16 v[24:27], v[76:79], v[48:51], v[24:27]
    ds_read_b64 v[40:41], v11 offset:64
    ds_read_b64 v[42:43], v11 offset:72
    ds_read_b64 v[64:65], v11 offset:128
    ds_read_b64 v[66:67], v11 offset:136
    s_waitcnt lgkmcnt(10)
    v_mfma_f32_16x16x32_f16 v[24:27], v[80:83], v[112:115], v[24:27]
    s_waitcnt lgkmcnt(6)
    v_cmp_ne_u32 vcc, s84, v18
    s_cbranch_vccnz WS_41
WB_42:
    ds_read_b64_tr_b16 v[108:109], v9 offset:1024
    ds_read_b64_tr_b16 v[110:111], v9 offset:1088
    ds_read_b64_tr_b16 v[68:69], v9 offset:1536
    ds_read_b64_tr_b16 v[70:71], v9 offset:1600
    v_mfma_f32_16x16x32_f16 v[24:27], v[84:87], v[52:55], v[24:27]
    ds_read_b64_tr_b16 v[44:45], v9 offset:2048
    ds_read_b64_tr_b16 v[46:47], v9 offset:2112
    v_mfma_f32_16x16x32_f16 v[24:27], v[88:91], v[120:123], v[24:27]
    ds_read_b64_tr_b16 v[72:73], v9 offset:4112
    ds_read_b64_tr_b16 v[74:75], v9 offset:4176
    ds_read_b64 v[32:33], v11 offset:256
    ds_read_b64 v[34:35], v11 offset:264
    v_mfma_f32_16x16x32_f16 v[24:27], v[92:95], v[56:59], v[24:27]
    ds_read_b64_tr_b16 v[76:77], v9 offset:4624
    ds_read_b64_tr_b16 v[78:79], v9 offset:4688
    ds_read_b64 v[48:49], v11 offset:320
    ds_read_b64 v[50:51], v11 offset:328
    v_mfma_f32_16x16x32_f16 v[24:27], v[96:99], v[36:39], v[24:27]
    ds_read_b64_tr_b16 v[80:81], v9 offset:5136
    ds_read_b64_tr_b16 v[82:83], v9 offset:5200
    ds_read_b64 v[112:113], v11 offset:384
    ds_read_b64 v[114:115], v11 offset:392
    v_mfma_f32_16x16x32_f16 v[24:27], v[100:103], v[60:63], v[24:27]
    ds_read_b64_tr_b16 v[84:85], v10 offset:6176
    ds_read_b64_tr_b16 v[86:87], v10 offset:6304
    ds_read_b64 v[52:53], v13 offset:32
    ds_read_b64 v[54:55], v13 offset:40
    v_mfma_f32_16x16x32_f16 v[20:23], v[108:111], v[104:107], v[20:23]
    ds_read_b64_tr_b16 v[88:89], v10 offset:7200
    ds_read_b64_tr_b16 v[90:91], v10 offset:7328
    ds_read_b64 v[120:121], v13 offset:96
    ds_read_b64 v[122:123], v13 offset:104
    v_mfma_f32_16x16x32_f16 v[20:23], v[68:71], v[40:43], v[20:23]
    ds_read_b64_tr_b16 v[92:93], v10 offset:8224
    ds_read_b64_tr_b16 v[94:95], v10 offset:8352
    ds_read_b64 v[56:57], v13 offset:416
    ds_read_b64 v[58:59], v13 offset:424
    v_mfma_f32_16x16x32_f16 v[20:23], v[44:47], v[64:67], v[20:23]
    ds_read_b64_tr_b16 v[96:97], v10 offset:9248
    ds_read_b64_tr_b16 v[98:99], v10 offset:9376
    ds_read_b64 v[36:37], v13 offset:480
    ds_read_b64 v[38:39], v13 offset:488
    v_mfma_f32_16x16x32_f16 v[20:23], v[72:75], v[32:35], v[20:23]
    v_mfma_f32_16x16x32_f16 v[20:23], v[76:79], v[48:51], v[20:23]
    v_mfma_f32_16x16x32_f16 v[20:23], v[80:83], v[112:115], v[20:23]
    ds_read_b64_tr_b16 v[100:101], v9 offset:2560
    ds_read_b64_tr_b16 v[102:103], v9 offset:2624
    s_waitcnt lgkmcnt(14)
    v_mfma_f32_16x16x32_f16 v[20:23], v[84:87], v[52:55], v[20:23]
    s_waitcnt lgkmcnt(10)
    v_mfma_f32_16x16x32_f16 v[20:23], v[88:91], v[120:123], v[20:23]
    s_waitcnt lgkmcnt(6)
    v_mfma_f32_16x16x32_f16 v[20:23], v[92:95], v[56:59], v[20:23]
    ds_read_b64_tr_b16 v[60:61], v9 offset:5648
    ds_read_b64_tr_b16 v[62:63], v9 offset:5712
    ds_read_b64 v[108:109], v13 offset:0
    ds_read_b64 v[110:111], v13 offset:8
    s_waitcnt lgkmcnt(6)
    v_mfma_f32_16x16x32_f16 v[20:23], v[96:99], v[36:39], v[20:23]
    ds_read_b64 v[72:73], v13 offset:64
    ds_read_b64 v[74:75], v13 offset:72
    ds_read_b64 v[52:53], v13 offset:384
    ds_read_b64 v[54:55], v13 offset:392
    v_mfma_f32_16x16x32_f16 v[24:27], v[68:71], v[104:107], v[24:27]
    ds_read_b64 v[120:121], v13 offset:448
    ds_read_b64 v[122:123], v13 offset:456
    v_mfma_f32_16x16x32_f16 v[24:27], v[44:47], v[40:43], v[24:27]
    v_cvt_pk_bf16_f32 v20, 0, v20
    v_cvt_pk_bf16_f32 v21, 0, v21
    s_waitcnt lgkmcnt(10)
    v_mfma_f32_16x16x32_f16 v[24:27], v[100:103], v[64:67], v[24:27]
    v_cvt_pk_bf16_f32 v22, 0, v22
    v_cvt_pk_bf16_f32 v23, 0, v23
    v_mfma_f32_16x16x32_f16 v[24:27], v[76:79], v[32:35], v[24:27]
    v_fma_f32 v20, v20, v16, v116
    v_fma_f32 v21, v21, v16, v117
    v_mfma_f32_16x16x32_f16 v[24:27], v[80:83], v[48:51], v[24:27]
    v_fma_f32 v22, v22, v16, v118
    v_fma_f32 v23, v23, v16, v119
    s_waitcnt lgkmcnt(8)
    v_mfma_f32_16x16x32_f16 v[24:27], v[60:63], v[112:115], v[24:27]
    v_cvt_pk_bf16_f32 v28, v20, v21
    v_cvt_pk_bf16_f32 v29, v22, v23
    s_waitcnt lgkmcnt(6)
    v_mfma_f32_16x16x32_f16 v[24:27], v[84:87], v[108:111], v[24:27]
    v_min_u32 v28, -2, v28
    v_min_u32 v29, -2, v29
    s_waitcnt lgkmcnt(4)
    v_mfma_f32_16x16x32_f16 v[24:27], v[88:91], v[72:75], v[24:27]
    s_waitcnt lgkmcnt(2)
    v_mfma_f32_16x16x32_f16 v[24:27], v[92:95], v[52:55], v[24:27]
    s_waitcnt lgkmcnt(0)
    v_mfma_f32_16x16x32_f16 v[24:27], v[96:99], v[120:123], v[24:27]
    ds_read_u8 v18, v14 offset:115
    ds_read_b128 v[20:23], v12 offset:49664
    s_nop 5
    v_cvt_pk_bf16_f32 v24, 0, v24
    v_cvt_pk_bf16_f32 v25, 0, v25
    v_cvt_pk_bf16_f32 v26, 0, v26
    v_cvt_pk_bf16_f32 v27, 0, v27
    v_fma_f32 v24, v24, v16, v124
    v_fma_f32 v25, v25, v16, v125
    v_fma_f32 v26, v26, v16, v126
    v_fma_f32 v27, v27, v16, v127
    v_cvt_pk_bf16_f32 v30, v24, v25
    v_cvt_pk_bf16_f32 v31, v26, v27
    v_min_u32 v30, -2, v30
    v_min_u32 v31, -2, v31
CVE_32:
    s_waitcnt lgkmcnt(0)
    s_cmp_lg_u32 s87, 1
    s_cbranch_scc1 ZA_43
    v_cmp_ne_u32 vcc, 1, v18
    s_cbranch_vccnz ZS_45
ZB_46:
    s_mov_b64 exec, s[12:13]
    v_swap_b32 v28, v20
    v_swap_b32 v29, v21
    v_swap_b32 v30, v22
    v_swap_b32 v31, v23
    s_mov_b64 exec, -1
    buffer_store_dwordx4 v[28:31], v6, s[64:67], s7 offen sc1
    buffer_store_dwordx4 v[20:23], v6, s[64:67], s6 offen sc1
    s_branch ZD_48
WS_35:
W_49:
    ds_read_b32 v18, v14 offset:76
    s_sub_u32 s39, s39, 1
    s_cbranch_scc1 KS_ABORT
    s_waitcnt lgkmcnt(0)
    v_cmp_ne_u32 vcc, s84, v18
    s_cbranch_vccnz W_49
    s_branch WB_36
WS_38:
W_50:
    ds_read_b32 v18, v14 offset:76
    s_sub_u32 s39, s39, 1
    s_cbranch_scc1 KS_ABORT
    s_waitcnt lgkmcnt(0)
    v_cmp_ne_u32 vcc, s84, v18
    s_cbranch_vccnz W_50
    s_branch WB_39
WS_41:
W_51:
    ds_read_b32 v18, v14 offset:76
    s_sub_u32 s39, s39, 1
    s_cbranch_scc1 KS_ABORT
    s_waitcnt lgkmcnt(0)
    v_cmp_ne_u32 vcc, s84, v18
    s_cbranch_vccnz W_51
    s_branch WB_42
ZS_45:
    v_mov_b32 v19, s86
    v_lshl_add_u32 v16, v19, 10, v12
ZW_52:
    ds_read_u8 v18, v19 offset:128
    ds_read_b128 v[20:23], v16 offset:46592
    s_sub_u32 s39, s39, 1
    s_cbranch_scc1 KS_ABORT
    s_waitcnt lgkmcnt(0)
    v_cmp_ne_u32 vcc, 1, v18
    s_cbranch_vccnz ZW_52
    s_branch ZB_46
ZA_43:
    v_cmp_eq_u32 vcc, 1, v18
    s_cbranch_vccnz KS_CLK
W_53:
    ds_read_b32 v18, v4 offset:112
    s_sub_u32 s39, s39, 1
    s_cbranch_scc1 KS_ABORT
    s_waitcnt lgkmcnt(0)
    v_cmp_ne_u32 vcc, s84, v18
    s_cbranch_vccnz W_53
KS_CLK:
    s_cmp_lg_u32 s87, 0
    s_cbranch_scc1 ZC_44
    v_mov_b32 v19, s86
    v_lshl_add_u32 v18, v19, 10, v12
    ds_write_b128 v18, v[28:31] offset:46592
    ds_write_b8 v19, v5 offset:128
    s_branch ZD_48
ZC_44:
    buffer_store_dwordx4 v[28:31], v6, s[64:67], s6 offen sc1
ZD_48:
    s_lshl_b32 s92, s87, 2
    s_add_u32 s92, s92, s86
    v_mov_b32 v8, s92
    s_waitcnt vmcnt(0)
    ds_write_b8 v8, v5 offset:48
    s_branch KS_K1
    s_cmp_lg_u32 s38, 4
    s_cbranch_scc1 KS_K1
    s_setprio 0
    s_add_u32 s76, s36, 0x840000
    s_addc_u32 s77, s37, 0
    s_mov_b32 s78, 0x4000
    s_mov_b32 s79, 0x20000
    v_and_b32 v6, 1, v1
    v_lshlrev_b32 v6, 4, v6
    s_lshl_b32 s92, s90, 5
W_54:
    s_sleep 1
    ds_read_b32 v8, v4 offset:20
    s_sub_u32 s39, s39, 1
    s_cbranch_scc1 KS_ABORT
    s_waitcnt lgkmcnt(0)
    v_cmp_ne_u32 vcc, s84, v8
    s_cbranch_vccnz W_54
    s_mov_b64 exec, 3
    s_setprio 1
KS_K0:
    ds_read_b128 v[8:11], v6 offset:800
    s_sub_u32 s39, s39, 1
    s_cbranch_scc1 KS_ABORT
    s_waitcnt lgkmcnt(0)
    v_min3_u32 v12, v8, v9, v10
    v_min_u32 v12, v12, v11
    v_cmp_eq_u32 vcc, 0, v12
    s_cbranch_vccnz KS_K0
    buffer_store_dwordx4 v[8:11], v6, s[76:79], s92 offen sc1
    s_mov_b64 exec, -1
    s_waitcnt vmcnt(0)
    ds_write_b32 v4, v5 offset:24
KS_K1:
    s_cmp_lt_u32 s41, 18
    s_cbranch_scc1 KS_T
    s_waitcnt lgkmcnt(0)
    s_endpgm
KS_X:
    s_cmp_lt_u32 s41, 24
    s_cbranch_scc1 KS_X2
    s_setprio 2
KS_XC:
    s_mov_b32 s87, 2
    s_add_u32 s86, s38, 3
    s_and_b32 s86, s86, 3
    s_lshl_b32 s88, s40, 3
    s_and_b32 s92, s41, 7
    s_add_u32 s88, s88, s92
    s_add_u32 s88, s88, 512
    s_lshl_b32 s92, s86, 11
    s_add_u32 s92, s92, 146048
    v_lshl_add_u32 v28, v1, 3, s92
    s_branch KS_GRP
KS_X2:
    s_cmp_lt_u32 s41, 8
    s_cbranch_scc1 KS_X3
    s_sub_u32 s97, s38, 8
    s_branch KS_LN1
KS_X3:
    s_lshl_b32 s92, s2, 4
    s_add_u32 s92, s92, s38
    s_cmp_lg_u32 s92, 44
    s_cbranch_scc1 KS_X3B
    s_setprio 3
    s_memrealtime s[92:93]
    v_and_b32 v6, 3, v1
    v_lshlrev_b32 v7, 2, v6
    v_min_u32 v6, 2, v6
    v_lshlrev_b32 v6, 2, v6
    v_cmp_eq_u32 vcc, 3, v1
    s_waitcnt lgkmcnt(0)
    v_mov_b32 v8, s92
    v_mov_b32 v9, s93
    v_alignbit_b32 v8, v8, v8, v6
    v_cndmask_b32 v9, v4, v9, vcc
    v_xor_b32 v8, v8, v9
    v_and_b32 v9, 0xf0000fff, v8
    v_and_b32 v10, 0xfff000, v8
    v_lshl_or_b32 v9, v10, 4, v9
    v_lshrrev_b32 v10, 12, v8
    v_and_b32 v10, 0xf000, v10
    v_or3_b32 v9, v9, v10, v9
    v_or_b32 v9, 0x80000000, v9
    s_mov_b64 exec, 15
    global_store_dword v7, v9, s[34:35] sc1
    s_mov_b64 exec, -1
    s_setprio 0
KS_X3B:
    s_setprio 3
    s_branch KS_XC
    s_waitcnt lgkmcnt(0)
    s_barrier
    s_branch KS_G
KS_X4:
    s_setprio 0
    s_cmp_lt_u32 s41, 18
    s_cbranch_scc1 KS_GN
KS_X5:
    v_mul_u32_u24 v46, 57, v1
    v_lshrrev_b32 v46, 9, v46
    v_mul_u32_u24 v47, 9, v46
    v_sub_u32 v47, v1, v47
    v_mul_u32_u24 v46, 9216, v46
    v_lshl_add_u32 v46, v47, 7, v46
    s_mul_i32 s94, s38, 6
    s_add_u32 s94, s94, s41
    s_sub_u32 s94, s94, 90
W_55:
    s_sleep 2
    ds_read_b32 v10, v4 offset:200
    s_sub_u32 s39, s39, 1
    s_cbranch_scc1 KS_ABORT
    s_waitcnt lgkmcnt(0)
    v_cmp_ne_u32 vcc, s84, v10
    s_cbranch_vccnz W_55
    s_bitcmp1_b32 s94, 0
    s_cselect_b32 s72, s28, s26
    s_cselect_b32 s73, s29, s27
    s_mov_b32 s74, 0x510000
    s_mov_b32 s75, 0x20000
    s_lshr_b32 s95, s94, 1
    s_mul_i32 s95, s95, 64512
    s_mul_i32 s96, s40, 1152
    s_add_u32 s95, s95, s96
    s_add_u32 s96, s95, 2644992
    buffer_load_dword v47, v46, s[72:75], s96 offen nt
    buffer_load_dword v47, v46, s[72:75], s96 offen sc1
KS_XPE:
    s_waitcnt vmcnt(0) lgkmcnt(0)
    s_endpgm
KS_L:
    v_lshlrev_b32 v6, 2, v0
    ds_write_b32 v6, v4
    v_mov_b32 v8, 0
    v_mov_b32 v9, 0
    s_min_u32 s92, s38, 2
    s_mul_i32 s92, s92, 4672
    v_min_u32 v6, 59, v1
    v_lshl_add_u32 v6, v6, 3, s92
    ds_write_b64 v6, v[8:9] offset:3072
    s_mov_b32 s97, s38
    s_sub_u32 s92, s41, 8
    s_cmp_lt_u32 s92, 16
    s_cbranch_scc0 KS_L0
KS_LN1:
    s_setprio 3
    s_sub_u32 s92, s41, 8
    s_and_b32 s88, s92, 7
    s_lshr_b32 s92, s92, 3
    s_lshl_b32 s92, s92, 4
    s_add_u32 s88, s88, s92
    s_and_b32 s92, s40, 1
    s_lshl_b32 s92, s92, 3
    s_add_u32 s88, s88, s92
    s_lshr_b32 s92, s40, 1
    s_lshl_b32 s92, s92, 5
    s_add_u32 s88, s88, s92
    v_lshrrev_b32 v36, 5, v1
    v_and_b32 v37, 31, v1
    v_mul_u32_u24 v38, 9216, v36
    v_lshl_add_u32 v39, v37, 2, v38
    v_lshl_add_u32 v38, v37, 4, v38
    s_mul_i32 s93, s88, 18432
    s_mul_i32 s94, s97, 1152
    s_add_u32 s93, s93, s94
    s_mov_b32 s66, 0x240000
    s_mov_b32 s67, 0x20000
    s_waitcnt lgkmcnt(0)
    s_mov_b32 s64, s4
    s_mov_b32 s65, s5
    buffer_load_dwordx4 v[26:29], v38, s[64:67], s93 offen
    buffer_load_dwordx4 v[30:33], v38, s[64:67], s93 offen offset:512
    buffer_load_dword v34, v39, s[64:67], s93 offen offset:1024
    s_barrier
    s_mul_i32 s94, s97, 2368
    s_add_u32 s94, s94, 16576
    v_lshl_add_u32 v6, v37, 1, v36
    v_lshl_add_u32 v6, v6, 2, s94
    v_and_b32 v59, 3, v1
    v_bfe_u32 v7, v1, 2, 2
    v_mul_u32_u24 v7, 2368, v7
    v_lshl_add_u32 v40, v3, 2, v59
    v_lshl_add_u32 v7, v40, 3, v7
    s_lshl_b32 s94, s97, 7
    s_add_u32 s92, s94, 18624
    v_add_u32 v44, s92, v7
    s_lshl_b32 s94, s97, 8
    s_add_u32 s94, s94, 16576
    v_add_u32 v7, s94, v7
    v_lshlrev_b32 v41, 4, v59
    s_nop 1
    v_mov_b32_dpp v40, v41 quad_perm:[0,2,1,3] row_mask:0xf bank_mask:0xf
    v_lshlrev_b32 v59, 2, v59
    v_lshrrev_b32 v41, 2, v1
    v_mul_u32_u24 v35, 0x8200, v41
    s_lshl_b32 s92, s88, 6
    s_and_b32 s93, s92, 0x1e00
    v_xad_u32 v35, v35, s93, v40
    s_lshl_b32 s93, s97, 4
    v_add_u32 v41, s93, v41
    v_mul_u32_u24 v45, 0x2080, v41
    v_xad_u32 v45, v45, s92, v40
    s_and_b32 s93, s97, 3
    s_mul_i32 s93, s93, 0x2080
    s_and_b32 s92, s92, 0x1c0
    s_xor_b32 s83, s92, s93
    s_lshr_b32 s93, s97, 2
    s_lshl_b32 s93, s93, 20
    s_add_u32 s83, s83, s93
    s_add_u32 s96, s83, 0x80000
    s_mov_b32 s80, 0x3f80
    s_mov_b32 s81, 0x3f800000
    s_mov_b32 s82, 0x3f803f80
    s_mov_b32 s98, 0x70007
    s_mov_b32 s99, 0x200000
    v_mov_b32 v40, 0
    v_mov_b32 v41, 0
    v_mov_b32 v42, 0x3ae38e39
    s_mov_b32 s72, s36
    s_mov_b32 s73, s37
    s_mov_b32 s74, 0x240000
    s_mov_b32 s75, 0x20000
    s_cmp_lt_u32 s97, 4
    s_cbranch_scc1 LN1A_56
    s_cmp_ge_u32 s41, 18
    s_cbranch_scc1 LN1A_56
    s_mov_b32 s68, s30
    s_mov_b32 s69, s31
    s_mov_b32 s70, 0x510000
    s_mov_b32 s71, 0x20000
    v_lshlrev_b32 v46, 4, v1
    s_mul_i32 s92, s89, 36864
    s_mul_i32 s93, s97, 9216
    s_add_u32 s92, s92, s93
    s_sub_u32 s92, s92, 36864
    s_add_u32 s93, s93, 72320
    s_add_u32 m0, s93, 0
    s_nop 0
    buffer_load_dwordx4 v46, s[68:71], s92 offen offset:0 nt lds
    buffer_load_dwordx4 v46, s[68:71], s92 offen offset:1024 nt lds
    buffer_load_dwordx4 v46, s[68:71], s92 offen offset:2048 nt lds
    buffer_load_dwordx4 v46, s[68:71], s92 offen offset:3072 nt lds
    s_add_u32 m0, s93, 4096
    s_add_u32 s92, s92, 4096
    buffer_load_dwordx4 v46, s[68:71], s92 offen offset:0 nt lds
    buffer_load_dwordx4 v46, s[68:71], s92 offen offset:1024 nt lds
    buffer_load_dwordx4 v46, s[68:71], s92 offen offset:2048 nt lds
    buffer_load_dwordx4 v46, s[68:71], s92 offen offset:3072 nt lds
    s_add_u32 m0, s93, 8192
    s_add_u32 s92, s92, 4096
    buffer_load_dwordx4 v46, s[68:71], s92 offen offset:0 nt lds
    s_waitcnt vmcnt(11)
    v_dot2c_f32_bf16 v40, s82, v26
    v_dot2c_f32_bf16 v41, v26, v26
    v_dot2c_f32_bf16 v40, s82, v27
    v_dot2c_f32_bf16 v41, v27, v27
    v_dot2c_f32_bf16 v40, s82, v28
    v_dot2c_f32_bf16 v41, v28, v28
    v_dot2c_f32_bf16 v40, s82, v29
    v_dot2c_f32_bf16 v41, v29, v29
    s_waitcnt vmcnt(10)
    v_dot2c_f32_bf16 v40, s82, v30
    v_dot2c_f32_bf16 v41, v30, v30
    v_dot2c_f32_bf16 v40, s82, v31
    v_dot2c_f32_bf16 v41, v31, v31
    v_dot2c_f32_bf16 v40, s82, v32
    v_dot2c_f32_bf16 v41, v32, v32
    v_dot2c_f32_bf16 v40, s82, v33
    v_dot2c_f32_bf16 v41, v33, v33
    s_waitcnt vmcnt(9)
    v_dot2c_f32_bf16 v40, s82, v34
    v_dot2c_f32_bf16 v41, v34, v34
    s_branch LN1B_57
LN1A_56:
    s_waitcnt vmcnt(2)
    v_dot2c_f32_bf16 v40, s82, v26
    v_dot2c_f32_bf16 v41, v26, v26
    v_dot2c_f32_bf16 v40, s82, v27
    v_dot2c_f32_bf16 v41, v27, v27
    v_dot2c_f32_bf16 v40, s82, v28
    v_dot2c_f32_bf16 v41, v28, v28
    v_dot2c_f32_bf16 v40, s82, v29
    v_dot2c_f32_bf16 v41, v29, v29
    s_waitcnt vmcnt(1)
    v_dot2c_f32_bf16 v40, s82, v30
    v_dot2c_f32_bf16 v41, v30, v30
    v_dot2c_f32_bf16 v40, s82, v31
    v_dot2c_f32_bf16 v41, v31, v31
    v_dot2c_f32_bf16 v40, s82, v32
    v_dot2c_f32_bf16 v41, v32, v32
    v_dot2c_f32_bf16 v40, s82, v33
    v_dot2c_f32_bf16 v41, v33, v33
    s_waitcnt vmcnt(0)
    v_dot2c_f32_bf16 v40, s82, v34
    v_dot2c_f32_bf16 v41, v34, v34
LN1B_57:
    s_nop 1
    v_add_f32_dpp v36, v40, v40 row_ror:8 row_mask:0xf bank_mask:0x3
    v_add_f32_dpp v36, v41, v41 row_ror:8 row_mask:0xf bank_mask:0xc
    s_nop 1
    v_add_f32_dpp v36, v36, v36 row_half_mirror row_mask:0xf bank_mask:0xf
    s_nop 1
    v_add_f32_dpp v36, v36, v36 quad_perm:[1,0,3,2] row_mask:0xf bank_mask:0xf
    s_nop 1
    v_add_f32_dpp v36, v36, v36 quad_perm:[2,3,0,1] row_mask:0xf bank_mask:0xf
    v_mov_b32 v37, v36
    s_nop 1
    v_permlane16_swap_b32 v36, v37
    v_add_f32 v36, v36, v37
    s_nop 1
    v_mul_f32_dpp v40, v36, v42 row_newbcast:0 row_mask:0xf bank_mask:0xf
    v_mul_f32_dpp v41, v36, v42 row_newbcast:8 row_mask:0xf bank_mask:0xf
    v_cvt_pk_bf16_f32 v36, 0, -v40
    v_fma_f32 v41, -v40, v40, v41
    v_dot2_f32_bf16 v8, v26, s80, v36
    v_dot2_f32_bf16 v9, v26, s81, v36
    v_max_f32 v41, 0, v41
    v_dot2_f32_bf16 v10, v27, s80, v36
    v_dot2_f32_bf16 v11, v27, s81, v36
    v_cvt_pk_bf16_f32 v41, 0, v41
    v_dot2_f32_bf16 v12, v28, s80, v36
    v_dot2_f32_bf16 v13, v28, s81, v36
    v_add_f32 v41, 0x3727c5ac, v41
    v_cvt_pk_bf16_f32 v8, 0, v8
    v_cvt_pk_bf16_f32 v9, 0, v9
    v_dot2_f32_bf16 v14, v29, s80, v36
    v_dot2_f32_bf16 v15, v29, s81, v36
    v_cvt_pk_bf16_f32 v41, 0, v41
    v_cvt_pk_bf16_f32 v10, 0, v10
    v_cvt_pk_bf16_f32 v11, 0, v11
    v_dot2_f32_bf16 v16, v30, s80, v36
    v_dot2_f32_bf16 v17, v30, s81, v36
    v_sqrt_f32 v41, v41
    v_cvt_pk_bf16_f32 v12, 0, v12
    v_cvt_pk_bf16_f32 v13, 0, v13
    v_dot2_f32_bf16 v18, v31, s80, v36
    v_dot2_f32_bf16 v19, v31, s81, v36
    v_cvt_pk_bf16_f32 v41, 0, v41
    v_cvt_pk_bf16_f32 v14, 0, v14
    v_cvt_pk_bf16_f32 v15, 0, v15
    v_dot2_f32_bf16 v20, v32, s80, v36
    v_dot2_f32_bf16 v21, v32, s81, v36
    v_rcp_f32 v38, v41
    v_cvt_pk_bf16_f32 v16, 0, v16
    v_cvt_pk_bf16_f32 v17, 0, v17
    v_dot2_f32_bf16 v22, v33, s80, v36
    v_dot2_f32_bf16 v23, v33, s81, v36
    v_cvt_pk_bf16_f32 v18, 0, v18
    v_cvt_pk_bf16_f32 v19, 0, v19
    v_dot2_f32_bf16 v24, v34, s80, v36
    v_dot2_f32_bf16 v25, v34, s81, v36
    v_cvt_pk_bf16_f32 v20, 0, v20
    v_cvt_pk_bf16_f32 v21, 0, v21
    v_cvt_pk_bf16_f32 v22, 0, v22
    v_cvt_pk_bf16_f32 v23, 0, v23
    v_pk_mul_f32 v[8:9], v[8:9], v[38:39] op_sel_hi:[1,0]
    v_cvt_pkrtz_f16_f32 v26, v8, v9
    v_add_u32 v26, 0x40004, v26
    v_cvt_pk_bf16_f32 v24, 0, v24
    v_cvt_pk_bf16_f32 v25, 0, v25
    v_pk_mul_f32 v[10:11], v[10:11], v[38:39] op_sel_hi:[1,0]
    v_cvt_pkrtz_f16_f32 v27, v10, v11
    v_add_u32 v27, 0x40004, v27
    ds_write2st64_b32 v6, v26, v27 offset0:0 offset1:1
    v_pk_mul_f32 v[12:13], v[12:13], v[38:39] op_sel_hi:[1,0]
    v_cvt_pkrtz_f16_f32 v28, v12, v13
    v_add_u32 v28, 0x40004, v28
    s_load_dwordx4 s[76:79], s[34:35], 0
    v_pk_mul_f32 v[14:15], v[14:15], v[38:39] op_sel_hi:[1,0]
    v_cvt_pkrtz_f16_f32 v29, v14, v15
    v_add_u32 v29, 0x40004, v29
    ds_write2st64_b32 v6, v28, v29 offset0:2 offset1:3
    v_pk_mul_f32 v[16:17], v[16:17], v[38:39] op_sel_hi:[1,0]
    v_cvt_pkrtz_f16_f32 v30, v16, v17
    v_add_u32 v30, 0x40004, v30
    v_pk_mul_f32 v[18:19], v[18:19], v[38:39] op_sel_hi:[1,0]
    v_cvt_pkrtz_f16_f32 v31, v18, v19
    v_add_u32 v31, 0x40004, v31
    ds_write2st64_b32 v6, v30, v31 offset0:4 offset1:5
    v_pk_mul_f32 v[20:21], v[20:21], v[38:39] op_sel_hi:[1,0]
    v_cvt_pkrtz_f16_f32 v32, v20, v21
    v_add_u32 v32, 0x40004, v32
    v_pk_mul_f32 v[22:23], v[22:23], v[38:39] op_sel_hi:[1,0]
    v_cvt_pkrtz_f16_f32 v33, v22, v23
    v_add_u32 v33, 0x40004, v33
    ds_write2st64_b32 v6, v32, v33 offset0:6 offset1:7
    v_pk_mul_f32 v[24:25], v[24:25], v[38:39] op_sel_hi:[1,0]
    v_cvt_pkrtz_f16_f32 v34, v24, v25
    v_add_u32 v34, 0x40004, v34
    ds_write_b32 v6, v34 offset:2048
    v_mov_b32 v6, s97
    ds_write_b8 v6, v5 offset:0
    s_waitcnt lgkmcnt(0)
    v_mov_b32 v58, s76
    v_mov_b32 v57, s77
    v_mov_b32 v56, s78
    v_mov_b32 v55, s79
    v_cmp_eq_u32 vcc, 4, v59
    s_nop 1
    v_cndmask_b32 v58, v58, v57, vcc
    v_cmp_eq_u32 vcc, 12, v59
    s_nop 1
    v_cndmask_b32 v56, v56, v55, vcc
    v_cmp_lt_u32 vcc, 4, v59
    s_nop 1
    v_cndmask_b32 v58, v58, v56, vcc
    s_waitcnt vmcnt(63)
DBP_58:
    v_cmp_eq_u32 vcc, 0, v58
    s_cbranch_vccz DBG_59
    s_sleep 1
    global_load_dword v58, v59, s[34:35] sc1
    s_sub_u32 s39, s39, 1
    s_cbranch_scc1 KS_ABORT
    s_waitcnt vmcnt(0)
    s_branch DBP_58
DBG_59:
    v_mov_b32_dpp v40, v58 quad_perm:[0,2,1,3] row_mask:0xf bank_mask:0xf
    v_lshrrev_b32 v41, 3, v40
    v_lshrrev_b32 v42, 6, v40
    v_lshrrev_b32 v43, 9, v40
W_60:
    ds_read_b64 v[20:21], v4 offset:0
    s_sub_u32 s39, s39, 1
    s_cbranch_scc1 KS_ABORT
    s_waitcnt lgkmcnt(0)
    v_and_b32 v20, v20, v21
    v_cmp_ne_u32 vcc, s84, v20
    s_cbranch_vccnz W_60
    ds_read_b64_tr_b16 v[20:21], v7 offset:0
    ds_read_b64_tr_b16 v[22:23], v7 offset:9472
    ds_read_b64_tr_b16 v[24:25], v7 offset:128
    ds_read_b64_tr_b16 v[26:27], v7 offset:9600
    ds_read_b64_tr_b16 v[28:29], v44 offset:0
    ds_read_b64_tr_b16 v[30:31], v44 offset:9472
    s_waitcnt lgkmcnt(4)
    v_bfi_b32 v20, s98, v40, v20
    v_bfi_b32 v21, s98, v41, v21
    v_bfi_b32 v22, s98, v42, v22
    v_bfi_b32 v23, s98, v43, v23
    buffer_store_dwordx4 v[20:23], v35, s[72:75], s83 offen sc1
    s_waitcnt lgkmcnt(2)
    v_bfi_b32 v24, s98, v40, v24
    v_bfi_b32 v25, s98, v41, v25
    v_bfi_b32 v26, s98, v42, v26
    v_bfi_b32 v27, s98, v43, v27
    buffer_store_dwordx4 v[24:27], v35, s[72:75], s96 offen sc1
    s_waitcnt lgkmcnt(0)
    s_cmp_ge_u32 s97, 4
    s_cbranch_scc1 KS_X4
    v_bfi_b32 v28, s98, v40, v28
    v_bfi_b32 v29, s98, v41, v29
    v_bfi_b32 v30, s98, v42, v30
    v_bfi_b32 v31, s98, v43, v31
    buffer_store_dwordx4 v[28:31], v45, s[72:75], s99 offen sc1
    ds_write_b8 v6, v5 offset:200
    ds_write_b32 v59, v58 offset:224
    v_lshrrev_b32 v57, 3, v58
    v_lshrrev_b32 v56, 6, v58
    v_lshrrev_b32 v55, 9, v58
    s_mov_b32 s87, 1
    s_branch KS_L2B
KS_L0:
    s_and_b32 s92, s41, 15
    s_lshl_b32 s93, s40, 4
    s_add_u32 s92, s92, s93
    v_and_b32 v59, 3, v1
    v_lshlrev_b32 v59, 2, v59
    s_lshl_b32 s96, s92, 6
    s_add_u32 s93, s96, 0xb00000
    v_add_u32 v7, s93, v59
    s_mul_i32 s93, s92, 18560
    s_add_u32 s93, s93, 0x600000
    v_lshlrev_b32 v6, 4, v0
    v_mov_b32 v12, -1
    v_mov_b32 v13, -1
    v_mov_b32 v14, -1
    v_mov_b32 v15, -1
    s_setprio 3
    v_mul_u32_u24 v16, 57, v1
    v_lshrrev_b32 v16, 9, v16
    v_mul_u32_u24 v17, 9, v16
    v_sub_u32 v17, v1, v17
    v_mul_u32_u24 v16, 9216, v16
    v_lshl_add_u32 v16, v17, 7, v16
    s_waitcnt lgkmcnt(0)
    s_add_u32 s68, s36, s93
    s_addc_u32 s69, s37, 0
    s_mov_b32 s70, 18560
    s_mov_b32 s71, 0x20000
    s_barrier
W_61:
    s_sleep 2
    ds_read_b32 v8, v4 offset:36
    s_sub_u32 s39, s39, 1
    s_cbranch_scc1 KS_ABORT
    s_waitcnt lgkmcnt(0)
    v_cmp_eq_u32 vcc, 0, v8
    s_cbranch_vccnz W_61
    s_mov_b32 s92, 0
    buffer_store_dwordx4 v[12:15], v6, s[68:71], s92 offen sc1
    s_mov_b32 s92, 4096
    buffer_store_dwordx4 v[12:15], v6, s[68:71], s92 offen sc1
    s_mov_b32 s92, 8192
    buffer_store_dwordx4 v[12:15], v6, s[68:71], s92 offen sc1
    s_mov_b32 s92, 12288
    buffer_store_dwordx4 v[12:15], v6, s[68:71], s92 offen sc1
    s_mov_b32 s92, 16384
    buffer_store_dwordx4 v[12:15], v6, s[68:71], s92 offen sc1
    global_load_dword v58, v59, s[34:35] sc1
    s_and_b32 s94, s41, 7
    s_lshl_b32 s95, s38, 3
    s_add_u32 s94, s94, s95
    s_bitcmp1_b32 s94, 0
    s_cselect_b32 s72, s28, s26
    s_cselect_b32 s73, s29, s27
    s_mov_b32 s74, 0x510000
    s_mov_b32 s75, 0x20000
    s_lshr_b32 s95, s94, 1
    s_mul_i32 s95, s95, 64512
    s_mul_i32 s96, s40, 1152
    s_add_u32 s95, s95, s96
    s_cmp_lt_u32 s41, 24
    s_cselect_b32 s74, 0, s74
    s_add_u32 s96, s95, 3419136
    s_cmp_ge_u32 s38, 4
    s_cselect_b32 s74, 0, s74
    buffer_load_dword v18, v16, s[72:75], s96 offen nt
    buffer_load_dword v18, v16, s[72:75], s96 offen sc1
    s_waitcnt vmcnt(2)
DBP_62:
    v_cmp_eq_u32 vcc, 0, v58
    s_cbranch_vccz DBG_63
    s_sleep 1
    global_load_dword v58, v59, s[34:35] sc1
    s_sub_u32 s39, s39, 1
    s_cbranch_scc1 KS_ABORT
    s_waitcnt vmcnt(0)
    s_branch DBP_62
DBG_63:
    ds_write_b32 v59, v58 offset:224
    s_mov_b64 exec, 1
    ds_add_rtn_u32 v8, v4, v5 offset:8
    s_mov_b64 exec, -1
    v_lshrrev_b32 v57, 3, v58
    v_lshrrev_b32 v56, 6, v58
    v_lshrrev_b32 v55, 9, v58
    s_waitcnt lgkmcnt(0)
    v_readfirstlane_b32 s92, v8
    s_cmp_lg_u32 s92, 3
    s_cbranch_scc1 KS_L2
    s_mov_b64 exec, 15
    global_store_dword v7, v58, s[36:37] sc1
    s_mov_b64 exec, -1
    s_and_b32 s94, s41, 7
    s_cmp_ge_u32 s41, 8
    s_cbranch_scc1 KS_L1C
    s_branch KS_L2
KS_L1C:
KS_L2:
    s_mov_b32 s87, 0
KS_L2B:
    s_mov_b32 s64, s36
    s_mov_b32 s65, s37
    s_mov_b32 s66, 0x240000
    s_mov_b32 s67, 0x20000
    v_lshrrev_b32 v7, 1, v1
    v_lshlrev_b32 v7, 6, v7
    v_and_b32 v10, 1, v1
    v_lshl_add_u32 v7, v10, 4, v7
    v_lshlrev_b32 v9, 4, v1
    s_lshl_b32 s92, s38, 11
    s_lshl_b32 s93, s90, 13
    s_add_u32 s93, s93, s92
    s_lshl_b32 s94, s90, 7
    s_and_b32 s95, s94, 0x380
    v_xor_b32 v13, s95, v9
    s_and_b32 s94, s94, 0x1c00
    s_xor_b32 s93, s93, s94
    s_xor_b32 s97, s93, 0x400
    s_lshl_b32 s95, s40, 3
    s_add_u32 s95, s95, s41
    s_add_u32 s95, s95, 488
    s_lshr_b32 s96, s95, 1
    s_lshl_b32 s96, s96, 13
    s_and_b32 s95, s95, 1
    s_lshl_b32 s95, s95, 5
    s_add_u32 s95, s95, s96
    s_add_u32 s95, s95, s92
    s_lshr_b32 s96, s96, 6
    s_and_b32 s94, s96, 0x780
    v_xor_b32 v7, s94, v7
    s_and_b32 s96, s96, 0x1800
    s_xor_b32 s95, s95, s96
    s_cmp_lt_u32 s41, 24
    s_cselect_b32 s95, 2359296, s95
    s_cselect_b32 s94, 0, 0x70007
    v_mov_b32_dpp v64, v58 quad_perm:[0,1,0,1] row_mask:0xf bank_mask:0xf
    v_mov_b32_dpp v65, v58 quad_perm:[2,3,2,3] row_mask:0xf bank_mask:0xf
    s_bitcmp1_b32 s41, 0
    s_cselect_b64 vcc, -1, 0
    v_cndmask_b32 v64, v64, v65, vcc
    v_and_b32 v60, 0x70007, v58
    v_and_b32 v61, 0x70007, v57
    v_and_b32 v62, 0x70007, v56
    v_and_b32 v63, 0x70007, v55
    v_lshrrev_b32 v67, 9, v64
    v_lshrrev_b32 v66, 6, v64
    v_lshrrev_b32 v65, 3, v64
    v_and_b32 v64, s94, v64
    v_and_b32 v65, s94, v65
    v_and_b32 v66, s94, v66
    v_and_b32 v67, s94, v67
    s_lshl_b32 s96, s38, 10
    s_add_u32 s96, s96, 3552
    v_bfe_u32 v11, v1, 1, 1
    v_mul_u32_u24 v11, 4672, v11
    v_lshl_add_u32 v11, v10, 4, v11
    v_lshrrev_b32 v10, 2, v1
    v_lshl_add_u32 v11, v10, 5, v11
    v_add_u32 v11, s96, v11
    v_add_u32 v10, s96, v9
    v_mov_b32 v116, s38
    s_add_u32 s92, s92, 0xb00000
    v_lshrrev_b32 v12, 2, v1
    v_lshl_add_u32 v12, v12, 6, v59
    v_add_u32 v12, s92, v12
    s_cmp_lt_u32 s41, 8
    s_cselect_b32 s94, 8, 8
    s_cmp_ge_u32 s41, 24
    s_cselect_b32 s94, 20, s94
    v_mov_b32 v14, s94
    s_setprio 0
    ds_write_b8 v116, v5 offset:204
W_64:
    s_sleep 2
    ds_read_b32 v8, v14 offset:64
    s_sub_u32 s39, s39, 1
    s_cbranch_scc1 KS_ABORT
    s_waitcnt lgkmcnt(0)
    v_cmp_ne_u32 vcc, s84, v8
    s_cbranch_vccnz W_64
    s_setprio 3
    s_branch UPE_66
UP_65:
    s_sleep 2
UPE_66:
    buffer_load_dwordx4 v[20:23], v13, s[64:67], s93 offen sc1
    buffer_load_dwordx4 v[24:27], v13, s[64:67], s97 offen sc1
    buffer_load_dwordx4 v[28:31], v7, s[64:67], s95 offen sc1
    s_sub_u32 s39, s39, 1
    s_cbranch_scc1 KS_ABORT
    s_waitcnt vmcnt(2)
    v_xor_b32 v20, v60, v20
    v_xor_b32 v21, v61, v21
    v_xor_b32 v22, v62, v22
    v_xor_b32 v23, v63, v23
    v_or3_b32 v44, v20, v21, v21
    v_or3_b32 v44, v22, v23, v44
    s_waitcnt vmcnt(1)
    v_xor_b32 v24, v60, v24
    v_xor_b32 v25, v61, v25
    v_xor_b32 v26, v62, v26
    v_xor_b32 v27, v63, v27
    v_or3_b32 v44, v24, v25, v44
    v_or3_b32 v44, v26, v27, v44
    s_waitcnt vmcnt(0)
    v_xor_b32 v28, v64, v28
    v_xor_b32 v29, v65, v29
    v_xor_b32 v30, v66, v30
    v_xor_b32 v31, v67, v31
    v_or3_b32 v44, v28, v29, v44
    v_or3_b32 v44, v30, v31, v44
    v_and_b32 v44, 0x70007, v44
    v_cmp_ne_u32 vcc, 0, v44
    s_cbranch_vccnz UP_65
    ds_write_b128 v11, v[20:23]
    ds_write_b128 v11, v[24:27] offset:512
    ds_write_b128 v10, v[28:31] offset:9344
    ds_write_b8 v116, v5 offset:16
    s_cmp_eq_u32 s38, 2
    s_cbranch_scc1 WJ2_69
    s_add_u32 s92, s38, 1
    s_lshr_b32 s92, s92, 2
    s_cmp_eq_u32 s38, 1
    s_cselect_b32 s92, 2, s92
    s_lshl_b32 s92, s92, 10
    v_lshl_add_u32 v10, v1, 4, s92
    v_add_u32 v11, 35840, v10
W_70:
    ds_read_b32 v12, v4 offset:16
    s_sub_u32 s39, s39, 1
    s_cbranch_scc1 KS_ABORT
    s_waitcnt lgkmcnt(0)
    v_cmp_ne_u32 vcc, s84, v12
    s_cbranch_vccnz W_70
    s_setprio 3
    ds_read_b128 v[20:23], v10 offset:3520
    ds_read_b128 v[24:27], v10 offset:3536
    ds_read_b64 v[28:29], v10 offset:3552
    ds_read_b128 v[32:35], v10 offset:8192
    ds_read_b128 v[36:39], v10 offset:8208
    ds_read_b64 v[40:41], v10 offset:8224
    ds_read_b128 v[44:47], v10 offset:12864
    ds_read_b128 v[48:51], v10 offset:12880
    ds_read_b64 v[52:53], v10 offset:12896
    s_cmp_eq_u32 s38, 1
    s_cbranch_scc1 WJ1_68
    ds_read_b32 v12, v4 offset:68
    s_waitcnt lgkmcnt(7)
    v_alignbit_b32 v57, v22, v21, 16
    v_alignbit_b32 v58, v23, v22, 16
    v_alignbit_b32 v59, v24, v23, 16
    v_alignbit_b32 v60, v25, v24, 16
    v_alignbit_b32 v61, v26, v25, 16
    v_alignbit_b32 v62, v27, v26, 16
    v_alignbit_b32 v63, v28, v27, 16
    v_alignbit_b32 v64, v29, v28, 16
    v_pk_add_f16 v66, v57, v22
    v_pk_add_f16 v67, v58, v23
    v_pk_add_f16 v68, v59, v24
    v_pk_add_f16 v69, v60, v25
    v_pk_add_f16 v70, v61, v26
    v_pk_add_f16 v71, v62, v27
    v_pk_add_f16 v72, v63, v28
    v_pk_add_f16 v73, v64, v29
    v_pk_add_f16 v80, v66, v58
    v_pk_add_f16 v81, v67, v59
    v_pk_add_f16 v82, v68, v60
    v_pk_add_f16 v83, v69, v61
    v_pk_add_f16 v74, v67, v68
    v_pk_add_f16 v75, v68, v69
    v_pk_add_f16 v76, v69, v70
    v_pk_add_f16 v77, v70, v71
    v_pk_add_f16 v78, v71, v72
    v_pk_add_f16 v79, v72, v73
    s_waitcnt lgkmcnt(0)
    v_cmp_eq_u32 vcc, s84, v12
    s_cbranch_vccnz WJK_71
W_72:
    s_sleep 1
    ds_read_b32 v12, v4 offset:68
    s_sub_u32 s39, s39, 1
    s_cbranch_scc1 KS_ABORT
    s_waitcnt lgkmcnt(0)
    v_cmp_ne_u32 vcc, s84, v12
    s_cbranch_vccnz W_72
WJK_71:
    ds_write_b128 v11, v[80:83] offset:0
    v_pk_add_f16 v87, v22, v74
    v_pk_add_f16 v88, v23, v75
    v_pk_add_f16 v89, v24, v76
    v_pk_add_f16 v90, v25, v77
    v_pk_add_f16 v91, v26, v78
    ds_write_b128 v11, v[88:91] offset:3104
    v_pk_add_f16 v84, v70, v62
    v_pk_add_f16 v85, v71, v63
    v_pk_add_f16 v86, v72, v64
    v_pk_add_f16 v92, v74, v83
    v_pk_add_f16 v93, v75, v84
    v_pk_add_f16 v94, v76, v85
    v_pk_add_f16 v95, v77, v86
    ds_write_b128 v11, v[92:95] offset:6176
    v_pk_add_f16 v96, v87, v76
    v_pk_add_f16 v97, v88, v77
    v_pk_add_f16 v98, v89, v78
    v_pk_add_f16 v99, v90, v79
    ds_write_b128 v11, v[96:99] offset:8240
    ds_write_b8 v116, v5 offset:76
    ds_read_b32 v12, v4 offset:84
    v_alignbit_b32 v57, v34, v33, 16
    v_alignbit_b32 v58, v35, v34, 16
    v_alignbit_b32 v59, v36, v35, 16
    v_alignbit_b32 v60, v37, v36, 16
    v_alignbit_b32 v61, v38, v37, 16
    v_alignbit_b32 v62, v39, v38, 16
    v_alignbit_b32 v63, v40, v39, 16
    v_alignbit_b32 v64, v41, v40, 16
    v_pk_add_f16 v66, v57, v34
    v_pk_add_f16 v67, v58, v35
    v_pk_add_f16 v68, v59, v36
    v_pk_add_f16 v69, v60, v37
    v_pk_add_f16 v70, v61, v38
    v_pk_add_f16 v71, v62, v39
    v_pk_add_f16 v72, v63, v40
    v_pk_add_f16 v73, v64, v41
    v_pk_add_f16 v80, v66, v58
    v_pk_add_f16 v81, v67, v59
    v_pk_add_f16 v82, v68, v60
    v_pk_add_f16 v83, v69, v61
    v_pk_add_f16 v74, v67, v68
    v_pk_add_f16 v75, v68, v69
    v_pk_add_f16 v76, v69, v70
    v_pk_add_f16 v77, v70, v71
    v_pk_add_f16 v78, v71, v72
    v_pk_add_f16 v79, v72, v73
    s_waitcnt lgkmcnt(0)
    v_cmp_eq_u32 vcc, s84, v12
    s_cbranch_vccnz WJK_73
W_74:
    s_sleep 1
    ds_read_b32 v12, v4 offset:84
    s_sub_u32 s39, s39, 1
    s_cbranch_scc1 KS_ABORT
    s_waitcnt lgkmcnt(0)
    v_cmp_ne_u32 vcc, s84, v12
    s_cbranch_vccnz W_74
WJK_73:
    ds_write_b128 v11, v[80:83] offset:36672
    v_pk_add_f16 v87, v34, v74
    v_pk_add_f16 v88, v35, v75
    v_pk_add_f16 v89, v36, v76
    v_pk_add_f16 v90, v37, v77
    v_pk_add_f16 v91, v38, v78
    ds_write_b128 v11, v[88:91] offset:39776
    v_pk_add_f16 v84, v70, v62
    v_pk_add_f16 v85, v71, v63
    v_pk_add_f16 v86, v72, v64
    v_pk_add_f16 v92, v74, v83
    v_pk_add_f16 v93, v75, v84
    v_pk_add_f16 v94, v76, v85
    v_pk_add_f16 v95, v77, v86
    ds_write_b128 v11, v[92:95] offset:42848
    v_pk_add_f16 v96, v87, v76
    v_pk_add_f16 v97, v88, v77
    v_pk_add_f16 v98, v89, v78
    v_pk_add_f16 v99, v90, v79
    ds_write_b128 v11, v[96:99] offset:44912
    ds_write_b8 v116, v5 offset:92
    s_cmp_lt_u32 s41, 24
    s_cbranch_scc1 WJE_67
    ds_read_b32 v12, v4 offset:100
    v_alignbit_b32 v57, v46, v45, 16
    v_alignbit_b32 v58, v47, v46, 16
    v_alignbit_b32 v59, v48, v47, 16
    v_alignbit_b32 v60, v49, v48, 16
    v_alignbit_b32 v61, v50, v49, 16
    v_alignbit_b32 v62, v51, v50, 16
    v_alignbit_b32 v63, v52, v51, 16
    v_alignbit_b32 v64, v53, v52, 16
    v_pk_add_f16 v66, v57, v46
    v_pk_add_f16 v67, v58, v47
    v_pk_add_f16 v68, v59, v48
    v_pk_add_f16 v69, v60, v49
    v_pk_add_f16 v70, v61, v50
    v_pk_add_f16 v71, v62, v51
    v_pk_add_f16 v72, v63, v52
    v_pk_add_f16 v73, v64, v53
    v_pk_add_f16 v80, v66, v58
    v_pk_add_f16 v81, v67, v59
    v_pk_add_f16 v82, v68, v60
    v_pk_add_f16 v83, v69, v61
    v_pk_add_f16 v74, v67, v68
    v_pk_add_f16 v75, v68, v69
    v_pk_add_f16 v76, v69, v70
    v_pk_add_f16 v77, v70, v71
    v_pk_add_f16 v78, v71, v72
    v_pk_add_f16 v79, v72, v73
    s_waitcnt lgkmcnt(0)
    v_cmp_eq_u32 vcc, s84, v12
    s_cbranch_vccnz WJK_75
W_76:
    s_sleep 1
    ds_read_b32 v12, v4 offset:100
    s_sub_u32 s39, s39, 1
    s_cbranch_scc1 KS_ABORT
    s_waitcnt lgkmcnt(0)
    v_cmp_ne_u32 vcc, s84, v12
    s_cbranch_vccnz W_76
WJK_75:
    v_add_u32 v11, 73344, v11
    ds_write_b128 v11, v[80:83] offset:0
    v_pk_add_f16 v87, v46, v74
    v_pk_add_f16 v88, v47, v75
    v_pk_add_f16 v89, v48, v76
    v_pk_add_f16 v90, v49, v77
    v_pk_add_f16 v91, v50, v78
    ds_write_b128 v11, v[88:91] offset:3104
    v_pk_add_f16 v84, v70, v62
    v_pk_add_f16 v85, v71, v63
    v_pk_add_f16 v86, v72, v64
    v_pk_add_f16 v92, v74, v83
    v_pk_add_f16 v93, v75, v84
    v_pk_add_f16 v94, v76, v85
    v_pk_add_f16 v95, v77, v86
    ds_write_b128 v11, v[92:95] offset:6176
    v_pk_add_f16 v96, v87, v76
    v_pk_add_f16 v97, v88, v77
    v_pk_add_f16 v98, v89, v78
    v_pk_add_f16 v99, v90, v79
    ds_write_b128 v11, v[96:99] offset:8240
    ds_write_b8 v116, v5 offset:108
    s_branch WJE_67
WJ1_68:
    ds_read_b32 v12, v4 offset:68
    s_waitcnt lgkmcnt(7)
    v_alignbit_b32 v57, v22, v21, 16
    v_alignbit_b32 v58, v23, v22, 16
    v_alignbit_b32 v59, v24, v23, 16
    v_alignbit_b32 v60, v25, v24, 16
    v_alignbit_b32 v61, v26, v25, 16
    v_alignbit_b32 v62, v27, v26, 16
    v_alignbit_b32 v63, v28, v27, 16
    v_pk_add_f16 v66, v57, v22
    v_pk_add_f16 v67, v58, v23
    v_pk_add_f16 v68, v59, v24
    v_pk_add_f16 v69, v60, v25
    v_pk_add_f16 v70, v61, v26
    v_pk_add_f16 v71, v62, v27
    v_pk_add_f16 v72, v63, v28
    v_pk_add_f16 v80, v66, v58
    v_pk_add_f16 v81, v67, v59
    v_pk_add_f16 v82, v68, v60
    v_pk_add_f16 v83, v69, v61
    v_pk_add_f16 v75, v68, v69
    v_pk_add_f16 v76, v69, v70
    v_pk_add_f16 v77, v70, v71
    v_pk_add_f16 v78, v71, v72
    s_waitcnt lgkmcnt(0)
    v_cmp_eq_u32 vcc, s84, v12
    s_cbranch_vccnz WJK_77
W_78:
    s_sleep 1
    ds_read_b32 v12, v4 offset:68
    s_sub_u32 s39, s39, 1
    s_cbranch_scc1 KS_ABORT
    s_waitcnt lgkmcnt(0)
    v_cmp_ne_u32 vcc, s84, v12
    s_cbranch_vccnz W_78
WJK_77:
    ds_write_b128 v11, v[80:83] offset:0
    v_pk_add_f16 v88, v23, v75
    v_pk_add_f16 v89, v24, v76
    v_pk_add_f16 v90, v25, v77
    v_pk_add_f16 v91, v26, v78
    ds_write_b128 v11, v[88:91] offset:3104
    ds_write_b8 v116, v5 offset:76
    ds_read_b32 v12, v4 offset:84
    v_alignbit_b32 v57, v34, v33, 16
    v_alignbit_b32 v58, v35, v34, 16
    v_alignbit_b32 v59, v36, v35, 16
    v_alignbit_b32 v60, v37, v36, 16
    v_alignbit_b32 v61, v38, v37, 16
    v_alignbit_b32 v62, v39, v38, 16
    v_alignbit_b32 v63, v40, v39, 16
    v_pk_add_f16 v66, v57, v34
    v_pk_add_f16 v67, v58, v35
    v_pk_add_f16 v68, v59, v36
    v_pk_add_f16 v69, v60, v37
    v_pk_add_f16 v70, v61, v38
    v_pk_add_f16 v71, v62, v39
    v_pk_add_f16 v72, v63, v40
    v_pk_add_f16 v80, v66, v58
    v_pk_add_f16 v81, v67, v59
    v_pk_add_f16 v82, v68, v60
    v_pk_add_f16 v83, v69, v61
    v_pk_add_f16 v75, v68, v69
    v_pk_add_f16 v76, v69, v70
    v_pk_add_f16 v77, v70, v71
    v_pk_add_f16 v78, v71, v72
    s_waitcnt lgkmcnt(0)
    v_cmp_eq_u32 vcc, s84, v12
    s_cbranch_vccnz WJK_79
W_80:
    s_sleep 1
    ds_read_b32 v12, v4 offset:84
    s_sub_u32 s39, s39, 1
    s_cbranch_scc1 KS_ABORT
    s_waitcnt lgkmcnt(0)
    v_cmp_ne_u32 vcc, s84, v12
    s_cbranch_vccnz W_80
WJK_79:
    ds_write_b128 v11, v[80:83] offset:36672
    v_pk_add_f16 v88, v35, v75
    v_pk_add_f16 v89, v36, v76
    v_pk_add_f16 v90, v37, v77
    v_pk_add_f16 v91, v38, v78
    ds_write_b128 v11, v[88:91] offset:39776
    ds_write_b8 v116, v5 offset:92
    s_cmp_lt_u32 s41, 24
    s_cbranch_scc1 WJE_67
    ds_read_b32 v12, v4 offset:100
    v_alignbit_b32 v57, v46, v45, 16
    v_alignbit_b32 v58, v47, v46, 16
    v_alignbit_b32 v59, v48, v47, 16
    v_alignbit_b32 v60, v49, v48, 16
    v_alignbit_b32 v61, v50, v49, 16
    v_alignbit_b32 v62, v51, v50, 16
    v_alignbit_b32 v63, v52, v51, 16
    v_pk_add_f16 v66, v57, v46
    v_pk_add_f16 v67, v58, v47
    v_pk_add_f16 v68, v59, v48
    v_pk_add_f16 v69, v60, v49
    v_pk_add_f16 v70, v61, v50
    v_pk_add_f16 v71, v62, v51
    v_pk_add_f16 v72, v63, v52
    v_pk_add_f16 v80, v66, v58
    v_pk_add_f16 v81, v67, v59
    v_pk_add_f16 v82, v68, v60
    v_pk_add_f16 v83, v69, v61
    v_pk_add_f16 v75, v68, v69
    v_pk_add_f16 v76, v69, v70
    v_pk_add_f16 v77, v70, v71
    v_pk_add_f16 v78, v71, v72
    s_waitcnt lgkmcnt(0)
    v_cmp_eq_u32 vcc, s84, v12
    s_cbranch_vccnz WJK_81
W_82:
    s_sleep 1
    ds_read_b32 v12, v4 offset:100
    s_sub_u32 s39, s39, 1
    s_cbranch_scc1 KS_ABORT
    s_waitcnt lgkmcnt(0)
    v_cmp_ne_u32 vcc, s84, v12
    s_cbranch_vccnz W_82
WJK_81:
    v_add_u32 v11, 73344, v11
    ds_write_b128 v11, v[80:83] offset:0
    v_pk_add_f16 v88, v47, v75
    v_pk_add_f16 v89, v48, v76
    v_pk_add_f16 v90, v49, v77
    v_pk_add_f16 v91, v50, v78
    ds_write_b128 v11, v[88:91] offset:3104
    ds_write_b8 v116, v5 offset:108
    s_branch WJE_67
WJ2_69:
    ds_write_b8 v116, v5 offset:76
    ds_write_b8 v116, v5 offset:92
    ds_write_b8 v116, v5 offset:108
    s_setprio 0
    v_mov_b32_dpp v32, v58 quad_perm:[0,0,0,0] row_mask:0xf bank_mask:0xf
    v_mov_b32_dpp v33, v58 quad_perm:[1,1,1,1] row_mask:0xf bank_mask:0xf
    v_mov_b32_dpp v34, v58 quad_perm:[2,2,2,2] row_mask:0xf bank_mask:0xf
    v_mov_b32_dpp v35, v58 quad_perm:[3,3,3,3] row_mask:0xf bank_mask:0xf
    v_lshlrev_b32 v12, 6, v1
    v_add_u32 v12, 0xb00800, v12
    v_mov_b32 v13, s84
    global_load_dwordx4 v[20:23], v12, s[36:37] offset:-2048 sc1
    global_load_dwordx4 v[24:27], v12, s[36:37] offset:2048 sc1
    s_sub_u32 s94, s41, 18
    s_and_b32 s94, s94, 31
    v_mul_u32_u24 v100, 57, v1
    v_lshrrev_b32 v100, 9, v100
    v_mul_u32_u24 v101, 9, v100
    v_sub_u32 v101, v1, v101
    v_mul_u32_u24 v100, 9216, v100
    v_lshl_add_u32 v100, v101, 7, v100
    s_bitcmp1_b32 s94, 0
    s_cselect_b32 s72, s28, s26
    s_cselect_b32 s73, s29, s27
    s_mov_b32 s74, 0x510000
    s_mov_b32 s75, 0x20000
    s_lshr_b32 s95, s94, 1
    s_mul_i32 s95, s95, 64512
    s_mul_i32 s96, s40, 1152
    s_add_u32 s95, s95, s96
    s_cmp_ge_u32 s94, 14
    s_cselect_b32 s74, 0, s74
W_85:
    s_sleep 1
    ds_read_b32 v102, v4 offset:16
    s_sub_u32 s39, s39, 1
    s_cbranch_scc1 KS_ABORT
    s_waitcnt lgkmcnt(0)
    v_cmp_ne_u32 vcc, s84, v102
    s_cbranch_vccnz W_85
    s_add_u32 s96, s95, 4451328
    buffer_load_dword v102, v100, s[72:75], s96 offen nt
    buffer_load_dword v102, v100, s[72:75], s96 offen sc1
    s_add_u32 s96, s95, 4902912
    buffer_load_dword v102, v100, s[72:75], s96 offen nt
    buffer_load_dword v102, v100, s[72:75], s96 offen sc1
    s_waitcnt vmcnt(4)
    s_branch FPE_84
FP_83:
    s_sleep 2
    global_load_dwordx4 v[20:23], v12, s[36:37] offset:-2048 sc1
    global_load_dwordx4 v[24:27], v12, s[36:37] offset:2048 sc1
    s_sub_u32 s39, s39, 1
    s_cbranch_scc1 KS_ABORT
    s_waitcnt vmcnt(0)
FPE_84:
    v_xor_b32 v20, v32, v20
    v_xor_b32 v21, v33, v21
    v_xor_b32 v22, v34, v22
    v_xor_b32 v23, v35, v23
    v_xor_b32 v24, v32, v24
    v_xor_b32 v25, v33, v25
    v_xor_b32 v26, v34, v26
    v_xor_b32 v27, v35, v27
    v_or3_b32 v20, v20, v21, v22
    v_or3_b32 v23, v23, v24, v25
    v_or3_b32 v20, v20, v26, v27
    v_or_b32 v20, v20, v23
    v_cmp_ne_u32 vcc, 0, v20
    s_cbranch_vccnz FP_83
    ds_write2_b32 v4, v13, v13 offset0:28 offset1:36
    s_branch WJE_67
    s_sub_u32 s94, s41, 18
    s_and_b32 s94, s94, 31
    s_cmp_ge_u32 s94, 14
    s_cbranch_scc1 WJE_67
    v_mul_u32_u24 v100, 57, v1
    v_lshrrev_b32 v100, 9, v100
    v_mul_u32_u24 v101, 9, v100
    v_sub_u32 v101, v1, v101
    v_mul_u32_u24 v100, 9216, v100
    v_lshl_add_u32 v100, v101, 7, v100
W_86:
    s_sleep 1
    ds_read_b32 v12, v4 offset:16
    s_sub_u32 s39, s39, 1
    s_cbranch_scc1 KS_ABORT
    s_waitcnt lgkmcnt(0)
    v_cmp_ne_u32 vcc, s84, v12
    s_cbranch_vccnz W_86
    s_bitcmp1_b32 s94, 0
    s_cselect_b32 s72, s28, s26
    s_cselect_b32 s73, s29, s27
    s_mov_b32 s74, 0x510000
    s_mov_b32 s75, 0x20000
    s_lshr_b32 s95, s94, 1
    s_mul_i32 s95, s95, 64512
    s_mul_i32 s96, s40, 1152
    s_add_u32 s95, s95, s96
    s_add_u32 s96, s95, 4451328
    buffer_load_dword v102, v100, s[72:75], s96 offen nt
    buffer_load_dword v102, v100, s[72:75], s96 offen sc1
    s_add_u32 s96, s95, 4902912
    buffer_load_dword v102, v100, s[72:75], s96 offen nt
    buffer_load_dword v102, v100, s[72:75], s96 offen sc1
KS_PF2D:
WJE_67:
    s_setprio 0
    s_lshr_b32 s92, s90, 6
    s_lshl_b32 s92, s92, 9
    s_bfe_u32 s93, s90, 0x20004
    s_lshl_b32 s93, s93, 6
    s_add_u32 s92, s92, s93
    s_and_b32 s93, s90, 3
    s_lshl_b32 s93, s93, 4
    s_add_u32 s92, s92, s93
    s_and_b32 s93, s90, 12
    s_add_u32 s92, s92, s93
    s_lshr_b32 s93, s38, 1
    s_lshl_b32 s93, s93, 8
    s_add_u32 s92, s92, s93
    s_and_b32 s93, s38, 1
    s_lshl_b32 s93, s93, 1
    s_add_u32 s92, s92, s93
    v_lshrrev_b32 v113, 5, v1
    v_and_b32 v114, 31, v1
    v_add_u32 v112, s92, v113
    v_mul_u32_u24 v115, 1152, v112
    v_lshl_add_u32 v8, v114, 2, v115
    v_lshl_add_u32 v115, v114, 4, v115
    v_lshlrev_b32 v7, 2, v114
    v_lshlrev_b32 v6, 4, v114
    v_bfe_u32 v111, v1, 3, 1
    v_add_u32 v111, s92, v111
    v_mul_u32_u24 v111, 1152, v111
    v_and_b32 v9, 7, v1
    v_lshl_add_u32 v111, v9, 4, v111
    s_mov_b32 s64, s4
    s_mov_b32 s65, s5
    s_mov_b32 s66, 0x240000
    s_mov_b32 s67, 0x20000
    s_mov_b32 s68, s24
    s_mov_b32 s69, s25
    s_mov_b32 s70, 0x480
    s_mov_b32 s71, 0x20000
    buffer_load_dwordx4 v[10:13], v115, s[64:67], 0 offen
    buffer_load_dwordx4 v[14:17], v115, s[64:67], 0 offen offset:512
    buffer_load_dword v18, v8, s[64:67], 0 offen offset:1024
    buffer_load_dwordx4 v[50:53], v6, s[68:71], 0 offen
    buffer_load_dwordx4 v[54:57], v6, s[68:71], 0 offen offset:512
    buffer_load_dword v58, v7, s[68:71], 0 offen offset:1024
KS_L4:
    s_add_u32 s64, s36, 0x600000
    s_addc_u32 s65, s37, 0
    s_mov_b32 s66, 0x240000
    s_mov_b32 s67, 0x20000
    s_mov_b32 s68, s32
    s_mov_b32 s69, s33
    s_mov_b32 s70, 0x240000
    s_mov_b32 s71, 0x20000
    s_mov_b32 s72, s36
    s_mov_b32 s73, s37
    s_mov_b32 s74, 0x240000
    s_mov_b32 s75, 0x20000
    s_add_u32 s76, s36, 0x840000
    s_addc_u32 s77, s37, 0
    s_mov_b32 s78, 0x4000
    s_mov_b32 s79, 0x20000
    s_not_b32 s93, s90
    v_xor_b32 v8, s93, v0
    v_lshrrev_b32 v6, 1, v0
    v_lshlrev_b32 v6, 6, v6
    v_and_b32 v8, 1, v8
    v_lshl_add_u32 v6, v8, 4, v6
    s_lshr_b32 s92, s90, 2
    s_lshl_b32 s92, s92, 15
    s_and_b32 s93, s90, 1
    s_lshl_b32 s93, s93, 14
    s_add_u32 s92, s92, s93
    s_and_b32 s93, s90, 2
    s_lshl_b32 s93, s93, 4
    s_add_u32 s92, s92, s93
    s_lshr_b32 s94, s90, 2
    s_lshl_b32 s94, s94, 12
    s_and_b32 s93, s90, 3
    s_lshl_b32 s93, s93, 4
    s_add_u32 s94, s94, s93
    s_lshl_b32 s93, s38, 10
    s_add_u32 s94, s94, s93
    s_add_u32 s94, s94, 0x200000
    v_lshlrev_b32 v9, 6, v2
    s_lshl_b32 s93, s90, 5
    s_and_b32 s95, s93, 0x1f80
    v_xor_b32 v6, s95, v6
    s_and_b32 s95, s93, 0x380
    v_xor_b32 v9, s95, v9
    s_and_b32 s95, s93, 0xc00
    s_xor_b32 s94, s94, s95
    s_and_b32 s93, s90, 1
    s_lshl_b32 s93, s93, 13
    s_xor_b32 s92, s92, s93
    s_xor_b32 s93, s92, 0x2000
    s_mul_i32 s95, s38, 2304
    s_add_u32 s95, s95, 17088
    v_lshl_add_u32 v117, v114, 5, s95
    v_lshl_add_u32 v110, v114, 3, s95
    s_lshl_b32 s95, s38, 9
    s_add_u32 s95, s95, 26368
    v_lshl_add_u32 v108, v1, 2, s95
    v_lshl_add_u32 v109, v1, 4, s95
    v_lshlrev_b32 v118, 4, v113
    s_movk_i32 s95, 0x3f80
    v_lshlrev_b32 v118, v118, s95
    v_lshlrev_b32 v8, 2, v0
    v_add_u32 v8, 17088, v8
    s_lshl_b32 s95, s38, 6
    s_add_u32 s95, s95, 19136
    v_lshl_add_u32 v119, v2, 2, s95
    s_waitcnt vmcnt(0)
    v_lshlrev_b32 v20, 16, v10
    v_and_b32 v21, 0xffff0000, v10
    v_lshlrev_b32 v22, 16, v11
    v_and_b32 v23, 0xffff0000, v11
    v_lshlrev_b32 v24, 16, v12
    v_and_b32 v25, 0xffff0000, v12
    v_lshlrev_b32 v26, 16, v13
    v_and_b32 v27, 0xffff0000, v13
    v_lshlrev_b32 v28, 16, v14
    v_and_b32 v29, 0xffff0000, v14
    v_lshlrev_b32 v30, 16, v15
    v_and_b32 v31, 0xffff0000, v15
    v_lshlrev_b32 v32, 16, v16
    v_and_b32 v33, 0xffff0000, v16
    v_lshlrev_b32 v34, 16, v17
    v_and_b32 v35, 0xffff0000, v17
    v_lshlrev_b32 v36, 16, v18
    v_and_b32 v37, 0xffff0000, v18
    v_lshlrev_b32 v80, 16, v50
    v_and_b32 v81, 0xffff0000, v50
    v_lshlrev_b32 v82, 16, v51
    v_and_b32 v83, 0xffff0000, v51
    v_lshlrev_b32 v84, 16, v52
    v_and_b32 v85, 0xffff0000, v52
    v_lshlrev_b32 v86, 16, v53
    v_and_b32 v87, 0xffff0000, v53
    v_lshlrev_b32 v88, 16, v54
    v_and_b32 v89, 0xffff0000, v54
    v_lshlrev_b32 v90, 16, v55
    v_and_b32 v91, 0xffff0000, v55
    v_lshlrev_b32 v92, 16, v56
    v_and_b32 v93, 0xffff0000, v56
    v_lshlrev_b32 v94, 16, v57
    v_and_b32 v95, 0xffff0000, v57
    v_lshlrev_b32 v96, 16, v58
    v_and_b32 v97, 0xffff0000, v58
    v_pk_add_f32 v[78:79], v[80:81], v[82:83]
    v_pk_add_f32 v[78:79], v[78:79], v[84:85]
    v_pk_add_f32 v[78:79], v[78:79], v[86:87]
    v_pk_add_f32 v[78:79], v[78:79], v[88:89]
    v_pk_add_f32 v[78:79], v[78:79], v[90:91]
    v_pk_add_f32 v[78:79], v[78:79], v[92:93]
    v_pk_add_f32 v[78:79], v[78:79], v[94:95]
    v_pk_add_f32 v[78:79], v[78:79], v[96:97]
    v_add_f32 v78, v78, v79
    s_nop 1
    v_add_f32_dpp v78, v78, v78 row_ror:8 row_mask:0xf bank_mask:0xf
    s_nop 1
    v_add_f32_dpp v78, v78, v78 row_ror:4 row_mask:0xf bank_mask:0xf
    s_nop 1
    v_add_f32_dpp v78, v78, v78 row_ror:2 row_mask:0xf bank_mask:0xf
    s_nop 1
    v_add_f32_dpp v78, v78, v78 row_ror:1 row_mask:0xf bank_mask:0xf
    v_mov_b32 v79, v78
    s_nop 1
    v_permlane16_swap_b32 v78, v79
    v_add_f32 v78, v78, v79
    v_sub_u32 v98, 0x87ff, v112
    v_lshl_add_u32 v99, v116, 1, v113
    v_lshlrev_b32 v99, 2, v99
    s_lshl_b32 s97, s90, 5
W_87:
    s_sleep 1
    ds_read_b32 v60, v4 offset:52
    s_sub_u32 s39, s39, 1
    s_cbranch_scc1 KS_ABORT
    s_waitcnt lgkmcnt(0)
    v_cmp_ne_u32 vcc, s84, v60
    s_cbranch_vccnz W_87
    s_setprio 3
    s_sub_u32 s95, s41, 8
    s_cmp_ge_u32 s95, 16
    s_cbranch_scc1 KS_ZGC
    s_branch ZPE_89
ZP_88:
    s_sleep 1
ZPE_89:
    buffer_load_dwordx4 v[68:71], v4, s[64:67], s94 offen sc1
    s_sub_u32 s39, s39, 1
    s_cbranch_scc1 KS_ABORT
    s_waitcnt vmcnt(0)
    v_max3_u32 v44, v68, v69, v70
    v_max_u32 v44, v44, v71
    v_cmp_eq_u32 vcc, -1, v44
    s_cbranch_vccnz ZP_88
KS_ZGC:
    s_branch ZPE_91
ZP_90:
    s_sleep 1
ZPE_91:
    buffer_load_dwordx4 v[60:63], v6, s[64:67], s92 offen sc1
    buffer_load_dwordx4 v[64:67], v6, s[64:67], s93 offen sc1
    buffer_load_dwordx4 v[68:71], v9, s[64:67], s94 offen sc1
    s_sub_u32 s39, s39, 1
    s_cbranch_scc1 KS_ABORT
    s_waitcnt vmcnt(2)
    ds_write2st64_b32 v8, v60, v61 offset0:0 offset1:9
    ds_write2st64_b32 v8, v62, v63 offset0:18 offset1:27
    v_max3_u32 v44, v60, v61, v61
    v_max3_u32 v44, v62, v63, v44
    s_waitcnt vmcnt(1)
    ds_write2st64_b32 v8, v64, v65 offset0:4 offset1:13
    ds_write2st64_b32 v8, v66, v67 offset0:22 offset1:31
    v_max3_u32 v44, v64, v65, v44
    v_max3_u32 v44, v66, v67, v44
    s_waitcnt vmcnt(0)
    ds_write2st64_b32 v119, v68, v69 offset0:0 offset1:9
    ds_write2st64_b32 v119, v70, v71 offset0:18 offset1:27
    v_max3_u32 v44, v68, v69, v44
    v_max3_u32 v44, v70, v71, v44
    v_cmp_eq_u32 vcc, -1, v44
    s_cbranch_vccnz ZP_90
    ds_write_b8 v116, v5 offset:20
ZW_92:
    ds_read_b32 v44, v4 offset:20
    ds_read_b128 v[60:63], v117 offset:0
    ds_read_b128 v[64:67], v117 offset:16
    ds_read_b128 v[68:71], v117 offset:1024
    ds_read_b128 v[72:75], v117 offset:1040
    ds_read_b64 v[76:77], v110 offset:2048
    s_sub_u32 s39, s39, 1
    s_cbranch_scc1 KS_ABORT
    s_waitcnt lgkmcnt(5)
    v_cmp_ne_u32 vcc, s84, v44
    s_cbranch_vccnz ZW_92
    s_waitcnt lgkmcnt(4)
    v_dot2c_f32_bf16 v20, v60, v118
    v_dot2c_f32_bf16 v21, v61, v118
    v_dot2c_f32_bf16 v22, v62, v118
    v_dot2c_f32_bf16 v23, v63, v118
    s_waitcnt lgkmcnt(3)
    v_dot2c_f32_bf16 v24, v64, v118
    v_dot2c_f32_bf16 v25, v65, v118
    v_pk_mul_f32 v[42:43], v[20:21], v[20:21]
    v_pk_mul_f32 v[44:45], v[20:21], v[80:81]
    v_dot2c_f32_bf16 v26, v66, v118
    v_dot2c_f32_bf16 v27, v67, v118
    v_pk_fma_f32 v[42:43], v[22:23], v[22:23], v[42:43]
    v_pk_fma_f32 v[44:45], v[22:23], v[82:83], v[44:45]
    v_pk_add_f32 v[40:41], v[22:23], v[20:21]
    s_waitcnt lgkmcnt(2)
    v_dot2c_f32_bf16 v28, v68, v118
    v_dot2c_f32_bf16 v29, v69, v118
    v_pk_fma_f32 v[42:43], v[24:25], v[24:25], v[42:43]
    v_pk_fma_f32 v[44:45], v[24:25], v[84:85], v[44:45]
    v_pk_add_f32 v[40:41], v[24:25], v[40:41]
    v_dot2c_f32_bf16 v30, v70, v118
    v_dot2c_f32_bf16 v31, v71, v118
    v_pk_fma_f32 v[42:43], v[26:27], v[26:27], v[42:43]
    v_pk_fma_f32 v[44:45], v[26:27], v[86:87], v[44:45]
    v_pk_add_f32 v[40:41], v[26:27], v[40:41]
    s_waitcnt lgkmcnt(1)
    v_dot2c_f32_bf16 v32, v72, v118
    v_dot2c_f32_bf16 v33, v73, v118
    v_pk_fma_f32 v[42:43], v[28:29], v[28:29], v[42:43]
    v_pk_fma_f32 v[44:45], v[28:29], v[88:89], v[44:45]
    v_pk_add_f32 v[40:41], v[28:29], v[40:41]
    v_dot2c_f32_bf16 v34, v74, v118
    v_dot2c_f32_bf16 v35, v75, v118
    v_pk_fma_f32 v[42:43], v[30:31], v[30:31], v[42:43]
    v_pk_fma_f32 v[44:45], v[30:31], v[90:91], v[44:45]
    v_pk_add_f32 v[40:41], v[30:31], v[40:41]
    s_waitcnt lgkmcnt(0)
    v_dot2c_f32_bf16 v36, v76, v118
    v_dot2c_f32_bf16 v37, v77, v118
    v_pk_fma_f32 v[42:43], v[32:33], v[32:33], v[42:43]
    v_pk_fma_f32 v[44:45], v[32:33], v[92:93], v[44:45]
    v_pk_add_f32 v[40:41], v[32:33], v[40:41]
    v_pk_fma_f32 v[42:43], v[34:35], v[34:35], v[42:43]
    v_pk_fma_f32 v[44:45], v[34:35], v[94:95], v[44:45]
    v_pk_add_f32 v[40:41], v[34:35], v[40:41]
    v_pk_fma_f32 v[42:43], v[36:37], v[36:37], v[42:43]
    v_pk_fma_f32 v[44:45], v[36:37], v[96:97], v[44:45]
    v_pk_add_f32 v[40:41], v[36:37], v[40:41]
    v_add_f32 v42, v42, v43
    v_add_f32 v44, v44, v45
    v_add_f32 v40, v40, v41
    v_mov_b32 v41, v40
    v_permlane16_swap_b32 v42, v44
    s_nop 0
    v_permlane16_swap_b32 v40, v41
    v_add_f32 v42, v42, v44
    v_add_f32 v40, v40, v41
    s_nop 0
    v_add_f32_dpp v42, v42, v42 row_ror:8 row_mask:0xf bank_mask:0xf
    v_add_f32_dpp v40, v40, v40 row_ror:8 row_mask:0xf bank_mask:0xf
    s_nop 0
    v_add_f32_dpp v42, v42, v42 row_ror:4 row_mask:0xf bank_mask:0xf
    v_add_f32_dpp v40, v40, v40 row_ror:4 row_mask:0xf bank_mask:0xf
    s_nop 0
    v_add_f32_dpp v42, v42, v42 row_ror:2 row_mask:0xf bank_mask:0xf
    v_add_f32_dpp v40, v40, v40 row_ror:2 row_mask:0xf bank_mask:0xf
    s_nop 0
    v_add_f32_dpp v42, v42, v42 row_ror:1 row_mask:0xf bank_mask:0xf
    v_add_f32_dpp v40, v40, v40 row_ror:1 row_mask:0xf bank_mask:0xf
    v_mul_f32 v40, 0x3ae38e39, v40
    v_mov_b32 v44, v42
    v_cvt_pk_bf16_f32 v41, 0, v40
    v_mul_f32 v40, v40, v40
    v_permlane16_swap_b32 v42, v44
    v_mov_b32 v43, 0x3ae38e39
    v_fma_f32 v42, v42, v43, -v40
    v_fma_f32 v44, -v41, v78, v44
    v_max_f32 v42, 0, v42
    v_cvt_pk_bf16_f32 v42, 0, v42
    v_add_f32 v42, 0x3727c5ac, v42
    v_cvt_pk_bf16_f32 v42, 0, v42
    v_sqrt_f32 v42, v42
    s_nop 0
    v_cvt_pk_bf16_f32 v42, 0, v42
    v_rcp_f32 v42, v42
    s_nop 0
    v_mul_f32 v60, v44, v42
    v_cvt_pk_bf16_f32 v60, v60, v60
    v_ashrrev_i32 v61, 31, v60
    v_or_b32 v61, 0x80000000, v61
    s_mov_b32 s95, 0xffff0000
    v_xor_b32 v60, v60, v61
    v_and_or_b32 v60, v60, s95, v98
    v_mov_b32 v61, v60
    s_nop 1
    v_permlane32_swap_b32 v60, v61
    s_mov_b64 exec, 1
    buffer_store_dwordx2 v[60:61], v99, s[76:79], s97 offen sc1
    ds_write_b8 v116, v5 offset:12
    s_mov_b64 exec, -1
    s_setprio 2
    v_cvt_pk_bf16_f32 v20, 0, v20
    v_cvt_pk_bf16_f32 v21, 0, v21
    v_cvt_pk_bf16_f32 v22, 0, v22
    v_cvt_pk_bf16_f32 v23, 0, v23
    v_cvt_pk_bf16_f32 v24, 0, v24
    v_cvt_pk_bf16_f32 v25, 0, v25
    v_cvt_pk_bf16_f32 v26, 0, v26
    v_cvt_pk_bf16_f32 v27, 0, v27
    v_cvt_pk_bf16_f32 v28, 0, v28
    v_cvt_pk_bf16_f32 v29, 0, v29
    v_cvt_pk_bf16_f32 v30, 0, v30
    v_cvt_pk_bf16_f32 v31, 0, v31
    v_cvt_pk_bf16_f32 v32, 0, v32
    v_cvt_pk_bf16_f32 v33, 0, v33
    v_cvt_pk_bf16_f32 v34, 0, v34
    v_cvt_pk_bf16_f32 v35, 0, v35
    v_cvt_pk_bf16_f32 v36, 0, v36
    v_cvt_pk_bf16_f32 v37, 0, v37
    v_pk_add_f32 v[44:45], v[20:21], v[22:23]
    v_pk_add_f32 v[46:47], v[24:25], v[26:27]
    v_pk_add_f32 v[44:45], v[44:45], v[28:29]
    v_pk_add_f32 v[46:47], v[46:47], v[30:31]
    v_pk_add_f32 v[44:45], v[44:45], v[32:33]
    v_pk_add_f32 v[46:47], v[46:47], v[34:35]
    v_pk_add_f32 v[44:45], v[44:45], v[36:37]
    v_pk_add_f32 v[44:45], v[44:45], v[46:47]
    v_add_f32 v44, v44, v45
    s_nop 1
    v_add_f32_dpp v44, v44, v44 row_ror:8 row_mask:0xf bank_mask:0xf
    s_nop 1
    v_add_f32_dpp v44, v44, v44 row_ror:4 row_mask:0xf bank_mask:0xf
    s_nop 1
    v_add_f32_dpp v44, v44, v44 row_ror:2 row_mask:0xf bank_mask:0xf
    s_nop 1
    v_add_f32_dpp v44, v44, v44 row_ror:1 row_mask:0xf bank_mask:0xf
    v_mov_b32 v46, v44
    s_nop 1
    v_permlane16_swap_b32 v44, v46
    v_add_f32 v44, v44, v46
    v_mul_f32 v48, 0x3ae38e39, v44
    v_mov_b32 v49, v48
    v_cvt_pk_bf16_f32 v40, 0, v48
    v_cvt_pk_bf16_f32 v41, 0, v48
    v_pk_add_f32 v[42:43], v[20:21], v[48:49] neg_lo:[0,1] neg_hi:[0,1]
    v_pk_mul_f32 v[44:45], v[42:43], v[42:43]
    v_pk_add_f32 v[42:43], v[22:23], v[48:49] neg_lo:[0,1] neg_hi:[0,1]
    v_pk_mul_f32 v[46:47], v[42:43], v[42:43]
    v_pk_add_f32 v[42:43], v[24:25], v[48:49] neg_lo:[0,1] neg_hi:[0,1]
    v_pk_fma_f32 v[44:45], v[42:43], v[42:43], v[44:45]
    v_pk_add_f32 v[42:43], v[26:27], v[48:49] neg_lo:[0,1] neg_hi:[0,1]
    v_pk_fma_f32 v[46:47], v[42:43], v[42:43], v[46:47]
    v_pk_add_f32 v[42:43], v[28:29], v[48:49] neg_lo:[0,1] neg_hi:[0,1]
    v_pk_fma_f32 v[44:45], v[42:43], v[42:43], v[44:45]
    v_pk_add_f32 v[42:43], v[30:31], v[48:49] neg_lo:[0,1] neg_hi:[0,1]
    v_pk_fma_f32 v[46:47], v[42:43], v[42:43], v[46:47]
    v_pk_add_f32 v[42:43], v[32:33], v[48:49] neg_lo:[0,1] neg_hi:[0,1]
    v_pk_fma_f32 v[44:45], v[42:43], v[42:43], v[44:45]
    v_pk_add_f32 v[42:43], v[34:35], v[48:49] neg_lo:[0,1] neg_hi:[0,1]
    v_pk_fma_f32 v[46:47], v[42:43], v[42:43], v[46:47]
    v_pk_add_f32 v[42:43], v[36:37], v[48:49] neg_lo:[0,1] neg_hi:[0,1]
    v_pk_fma_f32 v[44:45], v[42:43], v[42:43], v[44:45]
    v_pk_add_f32 v[44:45], v[44:45], v[46:47]
    v_add_f32 v44, v44, v45
    s_nop 1
    v_add_f32_dpp v44, v44, v44 row_ror:8 row_mask:0xf bank_mask:0xf
    s_nop 1
    v_add_f32_dpp v44, v44, v44 row_ror:4 row_mask:0xf bank_mask:0xf
    s_nop 1
    v_add_f32_dpp v44, v44, v44 row_ror:2 row_mask:0xf bank_mask:0xf
    s_nop 1
    v_add_f32_dpp v44, v44, v44 row_ror:1 row_mask:0xf bank_mask:0xf
    v_mov_b32 v46, v44
    s_nop 1
    v_permlane16_swap_b32 v44, v46
    v_add_f32 v44, v44, v46
    v_mul_f32 v44, 0x3ae38e39, v44
    v_cvt_pk_bf16_f32 v44, 0, v44
    v_add_f32 v44, 0x3727c5ac, v44
    v_cvt_pk_bf16_f32 v44, 0, v44
    v_sqrt_f32 v44, v44
    s_nop 0
    v_cvt_pk_bf16_f32 v44, 0, v44
    v_rcp_f32 v42, v44
    s_nop 0
    v_mov_b32 v43, v42
    v_pk_add_f32 v[44:45], v[20:21], v[40:41] neg_lo:[0,1] neg_hi:[0,1]
    v_cvt_pk_bf16_f32 v44, 0, v44
    v_cvt_pk_bf16_f32 v45, 0, v45
    v_pk_mul_f32 v[44:45], v[44:45], v[42:43]
    v_cvt_pk_bf16_f32 v10, v44, v45
    v_cvt_pk_bf16_f32 v44, 0, v44
    v_cvt_pk_bf16_f32 v45, 0, v45
    v_pk_add_f32 v[20:21], v[44:45], v[20:21]
    v_pk_add_f32 v[44:45], v[22:23], v[40:41] neg_lo:[0,1] neg_hi:[0,1]
    v_cvt_pk_bf16_f32 v44, 0, v44
    v_cvt_pk_bf16_f32 v45, 0, v45
    v_pk_mul_f32 v[44:45], v[44:45], v[42:43]
    v_cvt_pk_bf16_f32 v11, v44, v45
    v_cvt_pk_bf16_f32 v44, 0, v44
    v_cvt_pk_bf16_f32 v45, 0, v45
    v_pk_add_f32 v[22:23], v[44:45], v[22:23]
    v_pk_add_f32 v[44:45], v[24:25], v[40:41] neg_lo:[0,1] neg_hi:[0,1]
    v_cvt_pk_bf16_f32 v44, 0, v44
    v_cvt_pk_bf16_f32 v45, 0, v45
    v_pk_mul_f32 v[44:45], v[44:45], v[42:43]
    v_cvt_pk_bf16_f32 v12, v44, v45
    v_cvt_pk_bf16_f32 v44, 0, v44
    v_cvt_pk_bf16_f32 v45, 0, v45
    v_pk_add_f32 v[24:25], v[44:45], v[24:25]
    v_pk_add_f32 v[44:45], v[26:27], v[40:41] neg_lo:[0,1] neg_hi:[0,1]
    v_cvt_pk_bf16_f32 v44, 0, v44
    v_cvt_pk_bf16_f32 v45, 0, v45
    v_pk_mul_f32 v[44:45], v[44:45], v[42:43]
    v_cvt_pk_bf16_f32 v13, v44, v45
    v_cvt_pk_bf16_f32 v44, 0, v44
    v_cvt_pk_bf16_f32 v45, 0, v45
    v_pk_add_f32 v[26:27], v[44:45], v[26:27]
    v_pk_add_f32 v[44:45], v[28:29], v[40:41] neg_lo:[0,1] neg_hi:[0,1]
    v_cvt_pk_bf16_f32 v44, 0, v44
    v_cvt_pk_bf16_f32 v45, 0, v45
    v_pk_mul_f32 v[44:45], v[44:45], v[42:43]
    v_cvt_pk_bf16_f32 v14, v44, v45
    v_cvt_pk_bf16_f32 v44, 0, v44
    v_cvt_pk_bf16_f32 v45, 0, v45
    v_pk_add_f32 v[28:29], v[44:45], v[28:29]
    v_pk_add_f32 v[44:45], v[30:31], v[40:41] neg_lo:[0,1] neg_hi:[0,1]
    v_cvt_pk_bf16_f32 v44, 0, v44
    v_cvt_pk_bf16_f32 v45, 0, v45
    v_pk_mul_f32 v[44:45], v[44:45], v[42:43]
    v_cvt_pk_bf16_f32 v15, v44, v45
    v_cvt_pk_bf16_f32 v44, 0, v44
    v_cvt_pk_bf16_f32 v45, 0, v45
    v_pk_add_f32 v[30:31], v[44:45], v[30:31]
    v_pk_add_f32 v[44:45], v[32:33], v[40:41] neg_lo:[0,1] neg_hi:[0,1]
    v_cvt_pk_bf16_f32 v44, 0, v44
    v_cvt_pk_bf16_f32 v45, 0, v45
    v_pk_mul_f32 v[44:45], v[44:45], v[42:43]
    v_cvt_pk_bf16_f32 v16, v44, v45
    v_cvt_pk_bf16_f32 v44, 0, v44
    v_cvt_pk_bf16_f32 v45, 0, v45
    v_pk_add_f32 v[32:33], v[44:45], v[32:33]
    v_pk_add_f32 v[44:45], v[34:35], v[40:41] neg_lo:[0,1] neg_hi:[0,1]
    v_cvt_pk_bf16_f32 v44, 0, v44
    v_cvt_pk_bf16_f32 v45, 0, v45
    v_pk_mul_f32 v[44:45], v[44:45], v[42:43]
    v_cvt_pk_bf16_f32 v17, v44, v45
    v_cvt_pk_bf16_f32 v44, 0, v44
    v_cvt_pk_bf16_f32 v45, 0, v45
    v_pk_add_f32 v[34:35], v[44:45], v[34:35]
    v_pk_add_f32 v[44:45], v[36:37], v[40:41] neg_lo:[0,1] neg_hi:[0,1]
    v_cvt_pk_bf16_f32 v44, 0, v44
    v_cvt_pk_bf16_f32 v45, 0, v45
    v_pk_mul_f32 v[44:45], v[44:45], v[42:43]
    v_cvt_pk_bf16_f32 v18, v44, v45
    v_cvt_pk_bf16_f32 v44, 0, v44
    v_cvt_pk_bf16_f32 v45, 0, v45
    v_pk_add_f32 v[36:37], v[44:45], v[36:37]
    v_cvt_pk_bf16_f32 v58, v36, v37
    ds_write_b32 v108, v18
    ds_write_b32 v108, v58 offset:256
    ds_read_b128 v[64:67], v109
    buffer_store_dwordx4 v[10:13], v115, s[72:75], 0 offen sc1
    buffer_store_dwordx4 v[14:17], v115, s[72:75], 0 offen offset:512 sc1
    v_cvt_pk_bf16_f32 v50, v20, v21
    v_cvt_pk_bf16_f32 v51, v22, v23
    v_cvt_pk_bf16_f32 v52, v24, v25
    v_cvt_pk_bf16_f32 v53, v26, v27
    v_cvt_pk_bf16_f32 v54, v28, v29
    v_cvt_pk_bf16_f32 v55, v30, v31
    v_cvt_pk_bf16_f32 v56, v32, v33
    v_cvt_pk_bf16_f32 v57, v34, v35
    s_mov_b64 exec, 0xffff
    s_waitcnt lgkmcnt(0)
    buffer_store_dwordx4 v[64:67], v111, s[72:75], 0 offen offset:1024 sc1
    s_mov_b64 exec, -1
    s_setprio 0
    s_add_u32 s80, s36, 0x850000
    s_addc_u32 s81, s37, 0
    s_mov_b32 s82, 0x148800
    s_mov_b32 s83, 0x20000
    v_bfe_u32 v16, v1, 2, 2
    v_lshl_add_u32 v16, v3, 3, v16
    v_mul_u32_u24 v16, 1152, v16
    v_and_b32 v17, 3, v1
    v_lshl_add_u32 v16, v17, 3, v16
    s_lshl_b32 s10, s38, 7
    s_add_u32 s11, s10, 109184
    v_add_u32 v16, s11, v16
    v_lshrrev_b32 v18, 2, v1
    v_mul_u32_u24 v18, 9344, v18
    v_lshl_add_u32 v18, v17, 4, v18
    s_mul_i32 s9, s38, 149504
    s_lshl_b32 s11, s89, 6
    s_add_u32 s9, s9, s11
    v_lshl_add_u32 v19, v17, 5, s10
    v_lshl_add_u32 v19, v3, 3, v19
    s_mul_i32 s8, s89, 9344
    s_lshl_b32 s11, s38, 10
    s_add_u32 s8, s8, s11
    s_movk_i32 s10, 0x3f80
    s_mov_b32 s11, 0x3f800000
    v_mov_b32 v28, 0
    v_mov_b32 v29, 0
    v_lshlrev_b32 v17, 4, v1
    s_cmp_ge_u32 s41, 18
    s_cbranch_scc1 KS_LO
W_93:
    ds_read_b32 v20, v4 offset:40
    s_sub_u32 s39, s39, 1
    s_cbranch_scc1 KS_ABORT
    s_waitcnt lgkmcnt(0)
    v_cmp_ne_u32 vcc, s84, v20
    s_cbranch_vccnz W_93
    ds_read_b64_tr_b16 v[80:81], v16 offset:0
    ds_read_b64_tr_b16 v[82:83], v16 offset:4608
    ds_read_b64_tr_b16 v[84:85], v16 offset:32
    ds_read_b64_tr_b16 v[86:87], v16 offset:4640
    ds_read_b64_tr_b16 v[88:89], v16 offset:64
    ds_read_b64_tr_b16 v[90:91], v16 offset:4672
    ds_read_b64_tr_b16 v[92:93], v16 offset:96
    ds_read_b64_tr_b16 v[94:95], v16 offset:4704
    v_and_b32 v16, 7, v2
    v_lshlrev_b32 v16, 6, v16
    v_lshl_add_u32 v16, v3, 4, v16
    s_mul_i32 s92, s89, 9344
    s_add_u32 s92, s92, 0x850000
    s_add_u32 s64, s36, s92
    s_addc_u32 s65, s37, 0
    s_cmp_lt_u32 s41, 18
    s_cselect_b32 s66, 9216, 0
    s_mov_b32 s67, 0x20000
    s_mul_i32 s92, s38, 3072
    v_lshlrev_b32 v8, 4, v1
    v_mov_b32 v60, -1
    v_mov_b32 v61, -1
    v_mov_b32 v62, -1
    v_mov_b32 v63, -1
    buffer_store_dwordx4 v[60:63], v8, s[64:67], s92 offen offset:0 sc1
    buffer_store_dwordx4 v[60:63], v8, s[64:67], s92 offen offset:1024 sc1
    buffer_store_dwordx4 v[60:63], v8, s[64:67], s92 offen offset:2048 sc1
    s_waitcnt vmcnt(0)
    s_mov_b64 exec, 1
    ds_add_rtn_u32 v62, v4, v5 offset:196
    s_lshl_b32 s92, s2, 4
    s_add_u32 s92, s92, 8192
    s_waitcnt lgkmcnt(0)
    v_cmp_eq_u32 vcc, 3, v62
    s_and_b64 exec, exec, vcc
    s_cbranch_execz NOF_94
    buffer_store_dword v5, v4, s[76:79], s92 offen sc1
NOF_94:
    s_mov_b64 exec, -1
    s_sleep 16
    s_branch KS_LO2
KS_LO:
    s_sleep 8
    s_waitcnt vmcnt(0)
    s_mov_b64 exec, 1
    ds_add_rtn_u32 v62, v4, v5 offset:196
    s_lshl_b32 s92, s2, 4
    s_add_u32 s92, s92, 8192
    s_waitcnt lgkmcnt(0)
    v_cmp_eq_u32 vcc, 3, v62
    s_and_b64 exec, exec, vcc
    s_cbranch_execz NOF_95
    buffer_store_dword v5, v4, s[76:79], s92 offen sc1
NOF_95:
    s_mov_b64 exec, -1
    s_sleep 24
KS_LO2:
    s_mov_b64 exec, 0xffff0000
    buffer_store_dwordx4 v[64:67], v111, s[68:71], 0 offen offset:1024 sc1
    s_mov_b64 exec, -1
    buffer_store_dwordx4 v[50:53], v115, s[68:71], 0 offen sc1
    buffer_store_dwordx4 v[54:57], v115, s[68:71], 0 offen offset:512 sc1
    s_setprio 2
    s_waitcnt vmcnt(0)
    s_mov_b64 exec, 1
    ds_add_rtn_u32 v62, v4, v5 offset:176
    s_lshl_b32 s92, s2, 4
    s_add_u32 s92, s92, 12288
    s_waitcnt lgkmcnt(0)
    v_cmp_eq_u32 vcc, 3, v62
    s_and_b64 exec, exec, vcc
    s_cbranch_execz NOF_96
    buffer_store_dword v5, v4, s[76:79], s92 offen sc1
NOF_96:
    s_mov_b64 exec, -1
    s_cmp_lt_u32 s41, 18
    s_cbranch_scc1 KS_B
    s_waitcnt lgkmcnt(0)
    s_endpgm
KS_T:
    s_setprio 0
    s_cmp_ge_u32 s38, 10
    s_cbranch_scc1 KS_PEND
    s_add_u32 s76, s36, 0x840000
    s_addc_u32 s77, s37, 0
    s_mov_b32 s78, 0x4000
    s_mov_b32 s79, 0x20000
    s_cmp_eq_u32 s38, 9
    s_cbranch_scc1 KS_W9
    s_add_u32 s80, s36, 0x850000
    s_addc_u32 s81, s37, 0
    s_mov_b32 s82, 0x148800
    s_mov_b32 s83, 0x20000
    v_bfe_u32 v16, v1, 2, 2
    v_lshl_add_u32 v16, v3, 3, v16
    v_mul_u32_u24 v16, 1152, v16
    v_and_b32 v17, 3, v1
    v_lshl_add_u32 v16, v17, 3, v16
    s_lshl_b32 s10, s38, 7
    s_add_u32 s11, s10, 109184
    v_add_u32 v16, s11, v16
    v_lshrrev_b32 v18, 2, v1
    v_mul_u32_u24 v18, 9344, v18
    v_lshl_add_u32 v18, v17, 4, v18
    s_mul_i32 s9, s38, 149504
    s_lshl_b32 s11, s89, 6
    s_add_u32 s9, s9, s11
    v_lshl_add_u32 v19, v17, 5, s10
    v_lshl_add_u32 v19, v3, 3, v19
    s_mul_i32 s8, s89, 9344
    s_lshl_b32 s11, s38, 10
    s_add_u32 s8, s8, s11
    s_movk_i32 s10, 0x3f80
    s_mov_b32 s11, 0x3f800000
    v_mov_b32 v28, 0
    v_mov_b32 v29, 0
    v_lshlrev_b32 v17, 4, v1
    s_mov_b32 s72, s36
    s_mov_b32 s73, s37
    s_mov_b32 s74, 0x240000
    s_mov_b32 s75, 0x20000
    v_and_b32 v6, 1, v1
    v_and_b32 v7, 1, v3
    v_lshl_add_u32 v6, v7, 1, v6
    v_lshlrev_b32 v6, 2, v6
    ds_read_b32 v8, v6 offset:224
    s_lshl_b32 s92, s38, 11
    s_add_u32 s92, s92, 8896
    v_add_u32 v12, s92, v17
    s_waitcnt lgkmcnt(0)
    v_lshrrev_b32 v9, 3, v8
    v_lshrrev_b32 v10, 6, v8
    v_lshrrev_b32 v11, 9, v8
    s_cmp_eq_u32 s38, 8
    s_cbranch_scc1 KS_L2W
W_97:
    ds_read_b32 v20, v4 offset:40
    s_sub_u32 s39, s39, 1
    s_cbranch_scc1 KS_ABORT
    s_waitcnt lgkmcnt(0)
    v_cmp_ne_u32 vcc, s84, v20
    s_cbranch_vccnz W_97
    ds_read_b64_tr_b16 v[80:81], v16 offset:0
    ds_read_b64_tr_b16 v[82:83], v16 offset:4608
    ds_read_b64_tr_b16 v[84:85], v16 offset:32
    ds_read_b64_tr_b16 v[86:87], v16 offset:4640
    ds_read_b64_tr_b16 v[88:89], v16 offset:64
    ds_read_b64_tr_b16 v[90:91], v16 offset:4672
    ds_read_b64_tr_b16 v[92:93], v16 offset:96
    ds_read_b64_tr_b16 v[94:95], v16 offset:4704
    v_and_b32 v16, 7, v2
    v_lshlrev_b32 v16, 6, v16
    v_lshl_add_u32 v16, v3, 4, v16
W_98:
    s_sleep 2
    ds_read_b32 v20, v4 offset:768
    s_sub_u32 s39, s39, 1
    s_cbranch_scc1 KS_ABORT
    s_waitcnt lgkmcnt(0)
    v_cmp_eq_u32 vcc, 0, v20
    s_cbranch_vccnz W_98
    s_setprio 1
W_99:
    s_sleep 1
    ds_read_b32 v20, v4 offset:32
    s_sub_u32 s39, s39, 1
    s_cbranch_scc1 KS_ABORT
    s_waitcnt lgkmcnt(0)
    v_cmp_eq_u32 vcc, 0, v20
    s_cbranch_vccnz W_99
    ds_read_b128 v[20:23], v12
    ds_read_b128 v[24:27], v12 offset:1024
    s_waitcnt lgkmcnt(1)
    v_xor_b32 v13, v8, v20
    v_bitop3_b32 v13, v13, v9, v21 bitop3:0xf6
    v_bitop3_b32 v13, v13, v10, v22 bitop3:0xf6
    v_bitop3_b32 v13, v13, v11, v23 bitop3:0xf6
    v_and_b32 v13, 0x70007, v13
    s_waitcnt lgkmcnt(0)
    v_xor_b32 v14, v8, v24
    v_bitop3_b32 v14, v14, v9, v25 bitop3:0xf6
    v_bitop3_b32 v14, v14, v10, v26 bitop3:0xf6
    v_bitop3_b32 v14, v14, v11, v27 bitop3:0xf6
    v_and_b32 v14, 0x70007, v14
    v_min_u32 v13, v13, v14
KS_CK:
    v_cmp_eq_u32 vcc, 0, v13
    s_cbranch_vccz KS_B
    ds_write_b32 v4, v5 offset:24
    s_branch KS_B
KS_L2W:
    s_movk_i32 s92, 4096
    s_movk_i32 s96, -1152
    s_mov_b32 s93, 0
    v_mov_b32 v57, 0
    v_and_b32 v41, 1, v1
    v_lshl_add_u32 v41, v3, 1, v41
    v_lshlrev_b32 v41, 4, v41
    v_add_u32 v41, 2358144, v41
    v_lshlrev_b32 v7, 1, v1
    v_and_b32 v7, 28, v7
W_100:
    s_sleep 2
    ds_read_b32 v20, v4 offset:20
    s_sub_u32 s39, s39, 1
    s_cbranch_scc1 KS_ABORT
    s_waitcnt lgkmcnt(0)
    v_cmp_ne_u32 vcc, s84, v20
    s_cbranch_vccnz W_100
    s_setprio 3
W_101:
    s_sleep 1
    ds_read_b32 v20, v4 offset:12
    s_sub_u32 s39, s39, 1
    s_cbranch_scc1 KS_ABORT
    s_waitcnt lgkmcnt(0)
    v_cmp_ne_u32 vcc, s84, v20
    s_cbranch_vccnz W_101
    s_setprio 3
    s_sleep 27
    s_branch KS_Q1
KS_Q0:
    s_sleep 1
KS_Q1:
    buffer_load_dwordx4 v[96:99], v17, s[76:79], 0 offen offset:0 sc1
    buffer_load_dwordx4 v[100:103], v17, s[76:79], 0 offen offset:1024 sc1
    buffer_load_dwordx4 v[104:107], v17, s[76:79], 0 offen offset:2048 sc1
    buffer_load_dwordx4 v[108:111], v17, s[76:79], 0 offen offset:3072 sc1
    buffer_load_dwordx4 v[112:115], v17, s[76:79], s92 offen offset:0 sc1
    buffer_load_dwordx4 v[116:119], v17, s[76:79], s92 offen offset:1024 sc1
    buffer_load_dwordx4 v[120:123], v17, s[76:79], s92 offen offset:2048 sc1
    buffer_load_dwordx4 v[124:127], v17, s[76:79], s92 offen offset:3072 sc1
    s_sub_u32 s39, s39, 1
    s_cbranch_scc1 KS_ABORT
    s_waitcnt vmcnt(7)
    v_max_u32 v42, v96, v97
    v_max_u32 v44, v98, v99
    v_min_u32 v43, v96, v97
    v_min_u32 v45, v98, v99
    s_waitcnt vmcnt(6)
    v_med3_u32 v46, v42, v100, v101
    v_med3_u32 v47, v44, v102, v103
    v_max3_u32 v42, v42, v100, v101
    v_max3_u32 v44, v44, v102, v103
    v_max_u32 v43, v43, v46
    v_max_u32 v45, v45, v47
    s_waitcnt vmcnt(5)
    v_med3_u32 v46, v42, v104, v105
    v_med3_u32 v47, v44, v106, v107
    v_max3_u32 v42, v42, v104, v105
    v_max3_u32 v44, v44, v106, v107
    v_max_u32 v43, v43, v46
    v_max_u32 v45, v45, v47
    s_waitcnt vmcnt(4)
    v_med3_u32 v46, v42, v108, v109
    v_med3_u32 v47, v44, v110, v111
    v_max3_u32 v42, v42, v108, v109
    v_max3_u32 v44, v44, v110, v111
    v_max_u32 v43, v43, v46
    v_max_u32 v45, v45, v47
    s_waitcnt vmcnt(3)
    v_med3_u32 v46, v42, v112, v113
    v_med3_u32 v47, v44, v114, v115
    v_max3_u32 v42, v42, v112, v113
    v_max3_u32 v44, v44, v114, v115
    v_max_u32 v43, v43, v46
    v_max_u32 v45, v45, v47
    s_waitcnt vmcnt(2)
    v_med3_u32 v46, v42, v116, v117
    v_med3_u32 v47, v44, v118, v119
    v_max3_u32 v42, v42, v116, v117
    v_max3_u32 v44, v44, v118, v119
    v_max_u32 v43, v43, v46
    v_max_u32 v45, v45, v47
    s_waitcnt vmcnt(1)
    v_med3_u32 v46, v42, v120, v121
    v_med3_u32 v47, v44, v122, v123
    v_max3_u32 v42, v42, v120, v121
    v_max3_u32 v44, v44, v122, v123
    v_max_u32 v43, v43, v46
    v_max_u32 v45, v45, v47
    v_max_u32 v43, v43, v45
    s_waitcnt vmcnt(0)
    v_med3_u32 v46, v42, v124, v125
    v_med3_u32 v47, v44, v126, v127
    v_max3_u32 v42, v42, v124, v125
    v_max3_u32 v44, v44, v126, v127
    v_max3_u32 v43, v43, v46, v47
    v_max_u32 v48, v42, v44
    v_med3_u32 v49, v42, v44, v43
    v_cmp_eq_u32 vcc, -1, v48
    v_mov_b32 v56, v49
KS_QN:
    v_max_u32_dpp v50, v49, v48 row_half_mirror row_mask:0xf bank_mask:0x5
    v_max_u32_dpp v51, v48, v49 row_half_mirror row_mask:0xf bank_mask:0x5
    v_min_u32_dpp v50, v49, v48 row_half_mirror row_mask:0xf bank_mask:0xa
    v_min_u32_dpp v51, v48, v49 row_half_mirror row_mask:0xf bank_mask:0xa
    s_cbranch_vccnz KS_Q0
    s_cmp_eq_u32 s93, 1
    s_mov_b32 m0, 17088
    v_min_u32 v53, v50, v51
    v_max_u32 v52, v50, v51
    s_nop 1
    v_max_u32_dpp v50, v53, v52 row_mirror row_mask:0xf bank_mask:0x3
    v_max_u32_dpp v51, v52, v53 row_mirror row_mask:0xf bank_mask:0x3
    v_min_u32_dpp v50, v53, v52 row_mirror row_mask:0xf bank_mask:0xc
    v_min_u32_dpp v51, v52, v53 row_mirror row_mask:0xf bank_mask:0xc
    s_nop 0
    v_max_u32_dpp v52, v50, v50 row_half_mirror row_mask:0xf bank_mask:0x5
    v_max_u32_dpp v53, v51, v51 row_half_mirror row_mask:0xf bank_mask:0x5
    v_min_u32_dpp v52, v50, v50 row_half_mirror row_mask:0xf bank_mask:0xa
    v_min_u32_dpp v53, v51, v51 row_half_mirror row_mask:0xf bank_mask:0xa
    v_max_u32 v48, v52, v53
    v_max_u32 v54, v52, v53
    v_min_u32 v49, v52, v53
    v_min_u32 v55, v52, v53
    v_permlane32_swap_b32 v48, v54
    s_nop 0
    v_permlane32_swap_b32 v49, v55
    s_nop 1
    v_max_u32_dpp v51, v54, v49 row_mirror row_mask:0xf bank_mask:0xf
    v_max_u32_dpp v50, v55, v48 row_mirror row_mask:0xf bank_mask:0xf
    s_nop 1
    v_max_u32_dpp v52, v50, v50 row_ror:8 row_mask:0xf bank_mask:0x3
    v_max_u32_dpp v53, v51, v51 row_ror:8 row_mask:0xf bank_mask:0x3
    v_min_u32_dpp v52, v50, v50 row_ror:8 row_mask:0xf bank_mask:0xc
    v_min_u32_dpp v53, v51, v51 row_ror:8 row_mask:0xf bank_mask:0xc
    s_nop 0
    v_max_u32_dpp v50, v52, v52 row_half_mirror row_mask:0xf bank_mask:0x5
    v_max_u32_dpp v51, v53, v53 row_half_mirror row_mask:0xf bank_mask:0x5
    v_min_u32_dpp v50, v52, v52 row_half_mirror row_mask:0xf bank_mask:0xa
    v_min_u32_dpp v51, v53, v53 row_half_mirror row_mask:0xf bank_mask:0xa
    v_max_u32 v48, v50, v51
    v_max_u32 v54, v50, v51
    v_min_u32 v49, v50, v51
    v_min_u32 v55, v50, v51
    v_permlane16_swap_b32 v48, v54
    s_nop 0
    v_permlane16_swap_b32 v49, v55
    s_nop 1
    v_max_u32_dpp v51, v54, v49 row_mirror row_mask:0xf bank_mask:0xf
    v_max_u32_dpp v50, v55, v48 row_mirror row_mask:0xf bank_mask:0xf
    s_nop 1
    v_max_u32_dpp v52, v50, v50 row_ror:8 row_mask:0xf bank_mask:0x3
    v_max_u32_dpp v53, v51, v51 row_ror:8 row_mask:0xf bank_mask:0x3
    v_min_u32_dpp v52, v50, v50 row_ror:8 row_mask:0xf bank_mask:0xc
    v_min_u32_dpp v53, v51, v51 row_ror:8 row_mask:0xf bank_mask:0xc
    s_nop 0
    v_max_u32_dpp v50, v52, v52 row_half_mirror row_mask:0xf bank_mask:0x5
    v_max_u32_dpp v51, v53, v53 row_half_mirror row_mask:0xf bank_mask:0x5
    v_min_u32_dpp v50, v52, v52 row_half_mirror row_mask:0xf bank_mask:0xa
    v_min_u32_dpp v51, v53, v53 row_half_mirror row_mask:0xf bank_mask:0xa
    v_min_u32 v49, v50, v51
    v_max_u32 v48, v50, v51
    s_nop 0
    v_mov_b32_dpp v55, v49 row_mirror row_mask:0xf bank_mask:0xf
    v_mov_b32_dpp v54, v48 row_mirror row_mask:0xf bank_mask:0xf
    s_nop 0
    v_max_u32_dpp v50, v55, v48 quad_perm:[1,0,3,2] row_mask:0xf bank_mask:0xf
    v_max_u32_dpp v51, v54, v49 quad_perm:[1,0,3,2] row_mask:0xf bank_mask:0xf
    s_nop 0
    v_max_u32_dpp v52, v50, v50 row_ror:8 row_mask:0xf bank_mask:0x3
    v_max_u32_dpp v53, v51, v51 row_ror:8 row_mask:0xf bank_mask:0x3
    v_min_u32_dpp v52, v50, v50 row_ror:8 row_mask:0xf bank_mask:0xc
    v_min_u32_dpp v53, v51, v51 row_ror:8 row_mask:0xf bank_mask:0xc
    s_nop 0
    v_max_u32_dpp v50, v52, v52 row_half_mirror row_mask:0xf bank_mask:0x5
    v_max_u32_dpp v51, v53, v53 row_half_mirror row_mask:0xf bank_mask:0x5
    v_min_u32_dpp v50, v52, v52 row_half_mirror row_mask:0xf bank_mask:0xa
    v_min_u32_dpp v51, v53, v53 row_half_mirror row_mask:0xf bank_mask:0xa
    v_min_u32 v49, v50, v51
    v_max_u32 v48, v50, v51
    s_nop 0
    v_mov_b32_dpp v55, v49 row_mirror row_mask:0xf bank_mask:0xf
    s_nop 1
    v_max_u32_dpp v59, v55, v48 quad_perm:[2,3,0,1] row_mask:0xf bank_mask:0xf
    s_cbranch_scc1 KS_QF2
    v_and_b32 v61, 0x7ff, v59
    v_mad_i32_i24 v61, v61, s96, v41
    buffer_load_dwordx4 v61, s[72:75], 0 offen offset:0 sc1 lds
    s_mov_b32 m0, 17984
    s_nop 0
    buffer_load_dwordx4 v61, s[72:75], 0 offen offset:128 sc1 lds
    s_mov_b32 m0, 18880
    s_nop 0
    buffer_load_dwordx4 v61, s[72:75], 0 offen offset:256 sc1 lds
    s_mov_b32 m0, 19776
    s_nop 0
    buffer_load_dwordx4 v61, s[72:75], 0 offen offset:384 sc1 lds
    s_mov_b32 m0, 20672
    s_nop 0
    buffer_load_dwordx4 v61, s[72:75], 0 offen offset:512 sc1 lds
    s_mov_b32 m0, 21568
    s_nop 0
    buffer_load_dwordx4 v61, s[72:75], 0 offen offset:640 sc1 lds
    s_mov_b32 m0, 22464
    s_nop 0
    buffer_load_dwordx4 v61, s[72:75], 0 offen offset:768 sc1 lds
    s_mov_b32 m0, 23360
    s_nop 0
    buffer_load_dwordx4 v61, s[72:75], 0 offen offset:896 sc1 lds
    s_mov_b32 m0, 24256
    s_nop 0
    buffer_load_dwordx4 v61, s[72:75], 0 offen offset:1024 sc1 lds
    v_sub_u32 v96, v96, v56
    v_min_u32_dpp v60, v59, v59 quad_perm:[2,3,0,1] row_mask:0xf bank_mask:0xf
    v_sub_u32 v97, v97, v56
    v_sub_u32 v98, v98, v56
    v_max3_u32 v47, v96, v97, v98
    v_sub_u32 v99, v99, v56
    v_sub_u32 v100, v100, v56
    v_min_u32_dpp v60, v60, v60 row_half_mirror row_mask:0xf bank_mask:0xf
    v_max3_u32 v47, v47, v99, v100
    v_sub_u32 v101, v101, v56
    v_sub_u32 v102, v102, v56
    v_max3_u32 v47, v47, v101, v102
    v_sub_u32 v103, v103, v56
    v_sub_u32 v104, v104, v56
    v_min_u32_dpp v60, v60, v60 row_ror:8 row_mask:0xf bank_mask:0xf
    v_max3_u32 v47, v47, v103, v104
    v_sub_u32 v105, v105, v56
    v_sub_u32 v106, v106, v56
    v_max3_u32 v47, v47, v105, v106
    v_sub_u32 v107, v107, v56
    v_sub_u32 v108, v108, v56
    v_max3_u32 v47, v47, v107, v108
    v_sub_u32 v109, v109, v56
    v_sub_u32 v110, v110, v56
    v_max3_u32 v47, v47, v109, v110
    v_sub_u32 v111, v111, v56
    v_sub_u32 v112, v112, v56
    v_max3_u32 v47, v47, v111, v112
    v_sub_u32 v113, v113, v56
    v_sub_u32 v114, v114, v56
    v_max3_u32 v47, v47, v113, v114
    v_sub_u32 v115, v115, v56
    v_sub_u32 v116, v116, v56
    v_max3_u32 v47, v47, v115, v116
    v_sub_u32 v117, v117, v56
    v_sub_u32 v118, v118, v56
    v_max3_u32 v47, v47, v117, v118
    v_sub_u32 v119, v119, v56
    v_sub_u32 v120, v120, v56
    v_max3_u32 v47, v47, v119, v120
    v_sub_u32 v121, v121, v56
    v_sub_u32 v122, v122, v56
    v_max3_u32 v47, v47, v121, v122
    v_sub_u32 v123, v123, v56
    v_sub_u32 v124, v124, v56
    v_max3_u32 v47, v47, v123, v124
    v_sub_u32 v125, v125, v56
    v_sub_u32 v126, v126, v56
    v_max3_u32 v47, v47, v125, v126
    v_sub_u32 v127, v127, v56
    v_add_u32 v57, v57, v56
    v_max_u32 v47, v47, v127
    v_add_u32 v47, v47, v57
    v_cmp_gt_u32 vcc, v47, v60
    s_cbranch_vccnz KS_QF1
    ds_write_b32 v7, v59 offset:768
W_102:
    ds_read_b32 v20, v4 offset:40
    s_sub_u32 s39, s39, 1
    s_cbranch_scc1 KS_ABORT
    s_waitcnt lgkmcnt(0)
    v_cmp_ne_u32 vcc, s84, v20
    s_cbranch_vccnz W_102
    ds_read_b64_tr_b16 v[80:81], v16 offset:0
    ds_read_b64_tr_b16 v[82:83], v16 offset:4608
    ds_read_b64_tr_b16 v[84:85], v16 offset:32
    ds_read_b64_tr_b16 v[86:87], v16 offset:4640
    ds_read_b64_tr_b16 v[88:89], v16 offset:64
    ds_read_b64_tr_b16 v[90:91], v16 offset:4672
    ds_read_b64_tr_b16 v[92:93], v16 offset:96
    ds_read_b64_tr_b16 v[94:95], v16 offset:4704
    v_and_b32 v16, 7, v2
    v_lshlrev_b32 v16, 6, v16
    v_lshl_add_u32 v16, v3, 4, v16
    s_waitcnt vmcnt(0)
    ds_write_b32 v4, v5 offset:32
    s_setprio 1
    ds_read_b128 v[20:23], v12
    s_waitcnt lgkmcnt(0)
    v_xor_b32 v13, v8, v20
    v_bitop3_b32 v13, v13, v9, v21 bitop3:0xf6
    v_bitop3_b32 v13, v13, v10, v22 bitop3:0xf6
    v_bitop3_b32 v13, v13, v11, v23 bitop3:0xf6
    v_and_b32 v13, 0x70007, v13
    s_branch KS_CK
KS_QF1:
    s_sub_u32 s39, s39, 1
    s_cbranch_scc1 KS_ABORT
    v_mov_b32 v58, v59
    v_max_u32 v42, v96, v97
    v_max_u32 v44, v98, v99
    v_min_u32 v43, v96, v97
    v_min_u32 v45, v98, v99
    v_med3_u32 v46, v42, v100, v101
    v_med3_u32 v47, v44, v102, v103
    v_max3_u32 v42, v42, v100, v101
    v_max3_u32 v44, v44, v102, v103
    v_max_u32 v43, v43, v46
    v_max_u32 v45, v45, v47
    v_med3_u32 v46, v42, v104, v105
    v_med3_u32 v47, v44, v106, v107
    v_max3_u32 v42, v42, v104, v105
    v_max3_u32 v44, v44, v106, v107
    v_max_u32 v43, v43, v46
    v_max_u32 v45, v45, v47
    v_med3_u32 v46, v42, v108, v109
    v_med3_u32 v47, v44, v110, v111
    v_max3_u32 v42, v42, v108, v109
    v_max3_u32 v44, v44, v110, v111
    v_max_u32 v43, v43, v46
    v_max_u32 v45, v45, v47
    v_med3_u32 v46, v42, v112, v113
    v_med3_u32 v47, v44, v114, v115
    v_max3_u32 v42, v42, v112, v113
    v_max3_u32 v44, v44, v114, v115
    v_max_u32 v43, v43, v46
    v_max_u32 v45, v45, v47
    v_med3_u32 v46, v42, v116, v117
    v_med3_u32 v47, v44, v118, v119
    v_max3_u32 v42, v42, v116, v117
    v_max3_u32 v44, v44, v118, v119
    v_max_u32 v43, v43, v46
    v_max_u32 v45, v45, v47
    v_med3_u32 v46, v42, v120, v121
    v_med3_u32 v47, v44, v122, v123
    v_max3_u32 v42, v42, v120, v121
    v_max3_u32 v44, v44, v122, v123
    v_max_u32 v43, v43, v46
    v_max_u32 v45, v45, v47
    v_max_u32 v43, v43, v45
    v_med3_u32 v46, v42, v124, v125
    v_med3_u32 v47, v44, v126, v127
    v_max3_u32 v42, v42, v124, v125
    v_max3_u32 v44, v44, v126, v127
    v_max3_u32 v43, v43, v46, v47
    v_max_u32 v48, v42, v44
    v_med3_u32 v56, v42, v44, v43
    v_add_u32 v48, v48, v57
    v_add_u32 v49, v56, v57
    s_mov_b32 s93, 1
    s_mov_b64 vcc, 0
    s_nop 2
    s_branch KS_QN
KS_QF2:
    v_mov_b32 v48, 0
    v_mov_b32 v49, 0
    s_mov_b64 exec, 0x5555
    v_max_u32 v48, v59, v58
    v_min_u32 v49, v59, v58
    s_mov_b64 exec, -1
    s_mov_b32 s93, 2
    s_mov_b64 vcc, 0
    s_waitcnt vmcnt(0)
    s_nop 5
    s_branch KS_QN
KS_BR:
    s_mov_b64 exec, -1
    s_cmp_lg_u32 s38, 8
    s_cbranch_scc1 KS_BR1
    s_movk_i32 s92, 0x2000
    s_nop 7
    s_branch ZPE_104
ZP_103:
    s_sleep 2
ZPE_104:
    buffer_load_dword v20, v17, s[76:79], s92 offen offset:0 sc1
    buffer_load_dword v21, v17, s[76:79], s92 offen offset:1024 sc1
    buffer_load_dword v22, v17, s[76:79], s92 offen offset:2048 sc1
    buffer_load_dword v23, v17, s[76:79], s92 offen offset:3072 sc1
    s_sub_u32 s39, s39, 1
    s_cbranch_scc1 KS_ABORT
    s_waitcnt vmcnt(0)
    v_max3_u32 v44, v20, v21, v22
    v_max_u32 v44, v44, v23
    v_cmp_eq_u32 vcc, -1, v44
    s_cbranch_vccnz ZP_103
    s_mov_b32 m0, 17088
    s_nop 0
    buffer_load_dwordx4 v61, s[72:75], 0 offen offset:0 sc1 lds
    s_mov_b32 m0, 17984
    s_nop 0
    buffer_load_dwordx4 v61, s[72:75], 0 offen offset:128 sc1 lds
    s_mov_b32 m0, 18880
    s_nop 0
    buffer_load_dwordx4 v61, s[72:75], 0 offen offset:256 sc1 lds
    s_mov_b32 m0, 19776
    s_nop 0
    buffer_load_dwordx4 v61, s[72:75], 0 offen offset:384 sc1 lds
    s_mov_b32 m0, 20672
    s_nop 0
    buffer_load_dwordx4 v61, s[72:75], 0 offen offset:512 sc1 lds
    s_mov_b32 m0, 21568
    s_nop 0
    buffer_load_dwordx4 v61, s[72:75], 0 offen offset:640 sc1 lds
    s_mov_b32 m0, 22464
    s_nop 0
    buffer_load_dwordx4 v61, s[72:75], 0 offen offset:768 sc1 lds
    s_mov_b32 m0, 23360
    s_nop 0
    buffer_load_dwordx4 v61, s[72:75], 0 offen offset:896 sc1 lds
    s_mov_b32 m0, 24256
    s_nop 0
    buffer_load_dwordx4 v61, s[72:75], 0 offen offset:1024 sc1 lds
    s_waitcnt vmcnt(0)
    s_barrier
    ds_write_b32 v4, v4 offset:24
    s_branch KS_B
KS_BR1:
    s_barrier
    s_branch KS_B
KS_W9:
    v_lshlrev_b32 v33, 4, v1
    s_movk_i32 s92, 0x2000
    v_and_b32 v7, 7, v1
    v_lshlrev_b32 v7, 2, v7
    s_add_u32 s64, s36, 0x600000
    s_addc_u32 s65, s37, 0
    s_mov_b32 s66, 0x240000
    s_mov_b32 s67, 0x20000
    s_mov_b32 s68, s4
    s_mov_b32 s69, s5
    s_mov_b32 s70, 0x240000
    s_mov_b32 s71, 0x20000
    v_bfe_u32 v43, v1, 3, 2
    s_lshl_b32 s93, s89, 2
    v_add_u32 v43, s93, v43
    v_bfe_u32 v40, v43, 4, 1
    v_and_b32 v41, 3, v1
    v_lshl_add_u32 v40, v40, 2, v41
    v_lshlrev_b32 v40, 2, v40
    v_and_b32 v41, 0x3cf, v43
    v_bfe_u32 v42, v43, 5, 1
    v_lshl_add_u32 v41, v42, 4, v41
    v_bfe_u32 v42, v1, 2, 1
    v_lshl_add_u32 v41, v42, 5, v41
    v_lshrrev_b32 v42, 4, v41
    v_lshlrev_b32 v42, 8, v42
    v_lshl_add_u32 v42, v40, 3, v42
    v_and_b32 v43, 15, v41
    v_lshl_add_u32 v42, v43, 1, v42
W_105:
    s_sleep 1
    ds_read_b32 v12, v7 offset:768
    s_sub_u32 s39, s39, 1
    s_cbranch_scc1 KS_ABORT
    s_waitcnt lgkmcnt(0)
    v_cmp_eq_u32 vcc, 0, v12
    s_cbranch_vccnz W_105
    ds_read_b32 v19, v40 offset:768
    s_waitcnt lgkmcnt(0)
    v_and_b32 v14, 0x7ff, v19
    v_sub_u32 v14, 2047, v14
    v_mul_u32_u24 v23, 1152, v14
    v_lshl_add_u32 v23, v41, 1, v23
    buffer_load_ushort v17, v23, s[68:71], 0 offen
    v_lshrrev_b32 v15, 9, v14
    v_bfe_u32 v16, v14, 6, 2
    v_lshl_add_u32 v15, v15, 2, v16
    v_bfe_u32 v16, v14, 2, 2
    v_lshl_add_u32 v15, v15, 2, v16
    v_bfe_u32 v16, v14, 4, 1
    v_bfe_u32 v24, v14, 8, 1
    v_and_b32 v25, 3, v14
    v_lshl_add_u32 v24, v24, 2, v25
    v_lshlrev_b32 v24, 1, v24
    v_bfe_u32 v25, v14, 5, 1
    v_lshl_add_u32 v24, v25, 5, v24
    v_lshl_add_u32 v25, v15, 1, v16
    v_lshl_add_u32 v25, v25, 14, v24
    v_lshrrev_b32 v26, 1, v41
    v_lshl_add_u32 v25, v26, 6, v25
    v_xor_b32 v26, v41, v16
    v_not_b32 v26, v26
    v_and_b32 v26, 1, v26
    v_lshl_add_u32 v25, v26, 4, v25
    v_lshl_add_u32 v26, v15, 12, v24
    v_lshl_add_u32 v26, v16, 4, v26
    v_lshl_add_u32 v26, v41, 6, v26
    v_add_u32 v26, 2064384, v26
    v_lshl_add_u32 v27, v16, 6, v15
    v_lshlrev_b32 v27, 7, v27
    v_xor_b32 v25, v27, v25
    v_and_b32 v27, 0xf80, v27
    v_xor_b32 v26, v27, v26
    v_cmp_gt_u32 vcc, 0x200, v41
    s_nop 1
    v_cndmask_b32 v25, v26, v25, vcc
    buffer_load_ushort v18, v25, s[64:67], 0 offen sc1
    v_ashrrev_i32 v22, 31, v19
    v_not_b32 v22, v22
    v_or_b32 v22, 0x80000000, v22
    v_xor_b32 v22, v19, v22
    v_and_b32 v22, 0xffff0000, v22
    v_mul_f32 v22, 0xbfb8aa3b, v22
    v_exp_f32 v22, v22
    s_nop 0
    v_add_f32 v22, 1.0, v22
    v_rcp_f32 v22, v22
    s_nop 0
    v_cvt_pk_bf16_f32 v22, 0, v22
    s_add_u32 s72, s36, 0xb10000
    s_addc_u32 s73, s37, 0
    s_mov_b32 s74, 0x40
    s_mov_b32 s75, 0x20000
    s_mov_b32 s68, s32
    s_mov_b32 s69, s33
    s_mov_b32 s70, 0x240000
    s_mov_b32 s71, 0x20000
    buffer_load_dword v8, v33, s[76:79], s92 offen offset:0 sc1
    buffer_load_dword v9, v33, s[76:79], s92 offen offset:1024 sc1
    buffer_load_dword v10, v33, s[76:79], s92 offen offset:2048 sc1
    buffer_load_dword v11, v33, s[76:79], s92 offen offset:3072 sc1
    s_cmp_lg_u32 s2, 0
    s_cbranch_scc1 KS_W9B
    buffer_store_dword v12, v7, s[72:75], 0 offen
    s_branch KS_W9B
KS_W9R:
    s_barrier
KS_W9B:
    s_barrier
    ds_read_b32 v13, v4 offset:24
    ds_read_u16 v20, v42 offset:17088
    s_waitcnt lgkmcnt(0)
    v_cmp_ne_u32 vcc, 0, v13
    s_cbranch_vccnz KS_W9R
    s_setprio 2
    s_branch KS_F3B
KS_F3A:
    s_sleep 2
    buffer_load_dword v8, v33, s[76:79], s92 offen offset:0 sc1
    buffer_load_dword v9, v33, s[76:79], s92 offen offset:1024 sc1
    buffer_load_dword v10, v33, s[76:79], s92 offen offset:2048 sc1
    buffer_load_dword v11, v33, s[76:79], s92 offen offset:3072 sc1
KS_F3B:
    s_sub_u32 s39, s39, 1
    s_cbranch_scc1 KS_ABORT
    s_waitcnt vmcnt(0)
    v_max3_u32 v44, v8, v9, v10
    v_max_u32 v44, v44, v11
    v_cmp_eq_u32 vcc, -1, v44
    s_cbranch_vccnz KS_F3A
    ds_write_b32 v4, v5 offset:28
    s_movk_i32 s92, 0x3000
    s_sleep 12
    s_branch ZPE_107
ZP_106:
    s_sleep 2
ZPE_107:
    buffer_load_dword v8, v33, s[76:79], s92 offen offset:0 sc1
    buffer_load_dword v9, v33, s[76:79], s92 offen offset:1024 sc1
    buffer_load_dword v10, v33, s[76:79], s92 offen offset:2048 sc1
    buffer_load_dword v11, v33, s[76:79], s92 offen offset:3072 sc1
    s_sub_u32 s39, s39, 1
    s_cbranch_scc1 KS_ABORT
    s_waitcnt vmcnt(0)
    v_max3_u32 v44, v8, v9, v10
    v_max_u32 v44, v44, v11
    v_cmp_eq_u32 vcc, -1, v44
    s_cbranch_vccnz ZP_106
    v_lshlrev_b32 v17, 16, v17
    v_lshlrev_b32 v18, 16, v18
    v_add_f32 v17, v17, v18
    v_cvt_pk_bf16_f32 v17, v17, v17
    v_and_b32 v21, 0xffff0000, v17
    v_lshlrev_b32 v20, 16, v20
    v_lshlrev_b32 v14, 2, v1
    v_add_u32 v14, 1536, v14
    s_mov_b32 exec_lo, -1
    s_mov_b32 exec_hi, 0
    s_setprio 3
    s_barrier
    ds_read2_b32 v[32:33], v14 offset0:0 offset1:32
    ds_read2_b32 v[34:35], v14 offset0:64 offset1:96
    ds_read2_b32 v[36:37], v14 offset0:128 offset1:160
    ds_read2_b32 v[38:39], v14 offset0:192 offset1:224
    ds_read_b32 v40, v14 offset:1024
    s_waitcnt lgkmcnt(3)
    v_pk_add_f32 v[32:33], v[32:33], v[34:35]
    s_waitcnt lgkmcnt(1)
    v_pk_add_f32 v[36:37], v[36:37], v[38:39]
    v_add_f32 v32, v32, v33
    s_waitcnt lgkmcnt(0)
    v_add_f32 v36, v36, v37
    v_add_f32 v32, v32, v40
    v_add_f32 v8, v32, v36
    v_cvt_pk_bf16_f32 v8, 0, v8
    v_mul_f32 v8, v8, v22
    v_cvt_pk_bf16_f32 v8, 0, v8
    v_add_f32 v8, v8, v20
    v_cvt_pk_bf16_f32 v8, 0, v8
    v_add_f32 v8, v8, v21
    v_cvt_pk_bf16_f32 v8, v8, v8
    buffer_store_short v8, v23, s[68:71], 0 offen
    s_endpgm
KS_B:
    s_setprio 2
    s_waitcnt lgkmcnt(0)
    s_barrier
    ds_read_b128 v[20:23], v16 offset:1024
    ds_read_b32 v30, v4 offset:24
    s_waitcnt lgkmcnt(1)
    v_mfma_f32_16x16x32_bf16 v[32:35], v[20:23], v[80:83], 0
    v_mfma_f32_16x16x32_bf16 v[40:43], v[20:23], v[88:91], 0
    v_mfma_f32_16x16x32_bf16 v[36:39], v[20:23], v[84:87], 0
    v_mfma_f32_16x16x32_bf16 v[44:47], v[20:23], v[92:95], 0
    s_waitcnt lgkmcnt(0)
    v_cmp_ne_u32 vcc, 0, v30
    s_mov_b32 exec_lo, -1
    s_mov_b32 exec_hi, 0
    s_cbranch_vccnz KS_BR
    v_cvt_pk_bf16_f32 v24, v32, v33
    v_cvt_pk_bf16_f32 v25, v34, v35
    v_cvt_pk_bf16_f32 v26, v40, v41
    v_cvt_pk_bf16_f32 v27, v42, v43
    s_mov_b32 exec_lo, 0
    s_mov_b32 exec_hi, -1
    v_cvt_pk_bf16_f32 v24, v36, v37
    v_cvt_pk_bf16_f32 v25, v38, v39
    v_cvt_pk_bf16_f32 v26, v44, v45
    v_cvt_pk_bf16_f32 v27, v46, v47
    s_mov_b64 exec, -1
    v_min_u32 v24, -2, v24
    v_min_u32 v25, -2, v25
    v_min_u32 v26, -2, v26
    v_min_u32 v27, -2, v27
    buffer_store_dwordx4 v[24:27], v17, s[80:83], s8 offen sc1
    s_sleep 13
W_108:
    ds_read_b32 v30, v4 offset:28
    s_sub_u32 s39, s39, 1
    s_cbranch_scc1 KS_ABORT
    s_waitcnt lgkmcnt(0)
    v_cmp_eq_u32 vcc, 0, v30
    s_cbranch_vccnz W_108
    s_branch ZPE_110
ZP_109:
    s_sleep 1
ZPE_110:
    buffer_load_dwordx4 v[32:35], v18, s[80:83], s9 offen sc1
    s_sub_u32 s39, s39, 1
    s_cbranch_scc1 KS_ABORT
    s_waitcnt vmcnt(0)
    v_max3_u32 v44, v32, v33, v34
    v_max_u32 v44, v44, v35
    v_cmp_eq_u32 vcc, -1, v44
    s_cbranch_vccnz ZP_109
    v_permlane32_swap_b32 v32, v34
    v_permlane32_swap_b32 v33, v35
    s_nop 1
    v_permlane16_swap_b32 v32, v33
    v_permlane16_swap_b32 v34, v35
    v_dot2c_f32_bf16 v28, s10, v32
    v_dot2c_f32_bf16 v29, s11, v32
    v_dot2c_f32_bf16 v28, s10, v33
    v_dot2c_f32_bf16 v29, s11, v33
    v_dot2c_f32_bf16 v28, s10, v34
    v_dot2c_f32_bf16 v29, s11, v34
    v_dot2c_f32_bf16 v28, s10, v35
    v_dot2c_f32_bf16 v29, s11, v35
    s_nop 1
    v_add_f32_dpp v28, v28, v28 row_ror:8 row_mask:0xf bank_mask:0xf
    v_add_f32_dpp v29, v29, v29 row_ror:8 row_mask:0xf bank_mask:0xf
    s_nop 0
    v_add_f32_dpp v28, v28, v28 row_ror:4 row_mask:0xf bank_mask:0xf
    v_add_f32_dpp v29, v29, v29 row_ror:4 row_mask:0xf bank_mask:0xf
    s_mov_b32 exec_lo, 0x000f000f
    s_mov_b32 exec_hi, 0x000f000f
    ds_write_b64 v19, v[28:29] offset:1536
    s_waitcnt lgkmcnt(0)
    s_barrier
    s_endpgm
KS_G0:
    ds_write_b8 v15, v5 offset:68
    s_setprio 0
KS_G:
    s_waitcnt vmcnt(0)
KS_GN:
    s_sub_u32 s87, s38, 12
    s_and_b32 s95, s87, 1
    s_cselect_b32 s72, s28, s26
    s_cselect_b32 s73, s29, s27
    s_mov_b32 s74, 0x510000
    s_mov_b32 s75, 0x20000
    v_lshrrev_b32 v6, 3, v1
    v_lshrrev_b32 v7, 5, v1
    v_xor_b32 v6, v6, v7
    v_and_b32 v6, 1, v6
    v_lshl_add_u32 v6, s95, 1, v6
    v_xor_b32 v6, v6, v1
    v_and_b32 v6, 3, v6
    v_lshrrev_b32 v7, 2, v1
    v_mul_u32_u24 v7, 9216, v7
    v_lshl_add_u32 v46, v6, 4, v7
    s_lshl_b32 s96, s89, 6
    v_mov_b32 v6, s87
    s_mul_i32 s97, s95, 36864
    s_add_u32 s97, s97, 35328
    s_mov_b32 s68, s30
    s_mov_b32 s69, s31
    s_mov_b32 s70, 0x510000
    s_mov_b32 s71, 0x20000
    v_lshlrev_b32 v8, 4, v1
    s_mul_i32 s92, s89, 36864
    s_mul_i32 s93, s87, 9216
    s_add_u32 s92, s92, s93
    s_add_u32 s93, s93, 109184
    s_cmp_lt_u32 s41, 8
    s_cselect_b32 s94, 0, 100
    v_mov_b32 v9, s94
W_111:
    s_sleep 2
    ds_read_b32 v10, v9 offset:100
    s_sub_u32 s39, s39, 1
    s_cbranch_scc1 KS_ABORT
    s_waitcnt lgkmcnt(0)
    v_cmp_ne_u32 vcc, s84, v10
    s_cbranch_vccnz W_111
    s_cmp_ge_u32 s41, 8
    s_cselect_b64 vcc, -1, 0
    s_cbranch_scc1 KS_GD1
    s_add_u32 m0, s93, 0
    s_add_u32 s94, s92, 0
    buffer_load_dwordx4 v8, s[68:71], s94 offen offset:0 nt lds
    buffer_load_dwordx4 v8, s[68:71], s94 offen offset:1024 nt lds
    buffer_load_dwordx4 v8, s[68:71], s94 offen offset:2048 nt lds
    buffer_load_dwordx4 v8, s[68:71], s94 offen offset:3072 nt lds
    s_add_u32 m0, s93, 4096
    s_add_u32 s94, s92, 4096
    buffer_load_dwordx4 v8, s[68:71], s94 offen offset:0 nt lds
    buffer_load_dwordx4 v8, s[68:71], s94 offen offset:1024 nt lds
    buffer_load_dwordx4 v8, s[68:71], s94 offen offset:2048 nt lds
    buffer_load_dwordx4 v8, s[68:71], s94 offen offset:3072 nt lds
    s_add_u32 m0, s93, 8192
    s_add_u32 s94, s92, 8192
    buffer_load_dwordx4 v8, s[68:71], s94 offen offset:0 nt lds
KS_GD1:
    s_cmp_ge_u32 s87, 2
    s_cbranch_scc1 KS_GL
    buffer_load_dwordx4 v[48:51], v46, s[72:75], s96 offen nt
    s_sleep 6
    s_add_u32 s96, s96, 147456
    buffer_load_dwordx4 v[52:55], v46, s[72:75], s96 offen nt
    s_sleep 6
    s_add_u32 s96, s96, 147456
    buffer_load_dwordx4 v[56:59], v46, s[72:75], s96 offen nt
    s_sleep 6
    s_add_u32 s96, s96, 147456
    buffer_load_dwordx4 v[60:63], v46, s[72:75], s96 offen nt
    s_sleep 6
    s_add_u32 s96, s96, 147456
    buffer_load_dwordx4 v[64:67], v46, s[72:75], s96 offen nt
    s_sleep 6
    s_add_u32 s96, s96, 147456
    buffer_load_dwordx4 v[68:71], v46, s[72:75], s96 offen nt
    s_sleep 6
    s_add_u32 s96, s96, 147456
    buffer_load_dwordx4 v[72:75], v46, s[72:75], s96 offen nt
    s_sleep 6
    s_add_u32 s96, s96, 147456
    buffer_load_dwordx4 v[76:79], v46, s[72:75], s96 offen nt
    s_sleep 6
    s_add_u32 s96, s96, 147456
    buffer_load_dwordx4 v[80:83], v46, s[72:75], s96 offen nt
    s_sleep 6
    s_add_u32 s96, s96, 147456
    buffer_load_dwordx4 v[84:87], v46, s[72:75], s96 offen nt
    s_sleep 6
    s_add_u32 s96, s96, 147456
    buffer_load_dwordx4 v[88:91], v46, s[72:75], s96 offen nt
    s_sleep 6
    s_add_u32 s96, s96, 147456
    buffer_load_dwordx4 v[92:95], v46, s[72:75], s96 offen nt
    s_sleep 6
    s_add_u32 s96, s96, 147456
    buffer_load_dwordx4 v[96:99], v46, s[72:75], s96 offen nt
    s_sleep 6
    s_add_u32 s96, s96, 147456
    buffer_load_dwordx4 v[100:103], v46, s[72:75], s96 offen nt
    s_sleep 6
    s_add_u32 s96, s96, 147456
    buffer_load_dwordx4 v[104:107], v46, s[72:75], s96 offen nt
    s_sleep 6
    s_add_u32 s96, s96, 147456
    buffer_load_dwordx4 v[108:111], v46, s[72:75], s96 offen nt
    s_sleep 6
    s_add_u32 s96, s96, 147456
    buffer_load_dwordx4 v[112:115], v46, s[72:75], s96 offen nt
    s_sleep 6
    s_add_u32 s96, s96, 147456
    buffer_load_dwordx4 v[116:119], v46, s[72:75], s96 offen nt
    v_add_u32 v8, s97, v8
    s_waitcnt vmcnt(0)
    ds_write_b8 v6, v5 offset:40
W_112:
    s_sleep 2
    ds_read_b32 v10, v4 offset:52
    s_sub_u32 s39, s39, 1
    s_cbranch_scc1 KS_ABORT
    s_waitcnt lgkmcnt(0)
    v_cmp_ne_u32 vcc, s84, v10
    s_cbranch_vccnz W_112
W_113:
    s_sleep 2
    ds_read_b32 v10, v4 offset:12
    s_sub_u32 s39, s39, 1
    s_cbranch_scc1 KS_ABORT
    s_waitcnt lgkmcnt(0)
    v_cmp_ne_u32 vcc, s84, v10
    s_cbranch_vccnz W_113
    ds_write_b128 v8, v[48:51] offset:0
    ds_write_b128 v8, v[52:55] offset:1024
    ds_write_b128 v8, v[56:59] offset:2048
    ds_write_b128 v8, v[60:63] offset:3072
    ds_write_b128 v8, v[64:67] offset:4096
    ds_write_b128 v8, v[68:71] offset:5120
    ds_write_b128 v8, v[72:75] offset:6144
    ds_write_b128 v8, v[76:79] offset:7168
    ds_write_b128 v8, v[80:83] offset:8192
    ds_write_b128 v8, v[84:87] offset:9216
    ds_write_b128 v8, v[88:91] offset:10240
    ds_write_b128 v8, v[92:95] offset:11264
    ds_write_b128 v8, v[96:99] offset:12288
    ds_write_b128 v8, v[100:103] offset:13312
    ds_write_b128 v8, v[104:107] offset:14336
    ds_write_b128 v8, v[108:111] offset:15360
    ds_write_b128 v8, v[112:115] offset:16384
    ds_write_b128 v8, v[116:119] offset:17408
    s_branch KS_G4
KS_GL:
    s_add_u32 s96, s96, 2654208
    s_add_u32 s97, s97, 18432
    v_add_u32 v8, s97, v8
    s_waitcnt vmcnt(0)
    ds_write_b8 v6, v5 offset:40
W_114:
    s_sleep 2
    ds_read_b32 v10, v4 offset:52
    s_sub_u32 s39, s39, 1
    s_cbranch_scc1 KS_ABORT
    s_waitcnt lgkmcnt(0)
    v_cmp_ne_u32 vcc, s84, v10
    s_cbranch_vccnz W_114
    s_cmp_ge_u32 s41, 8
    s_cbranch_scc1 KS_GLZ
W_115:
    s_sleep 2
    ds_read_b32 v10, v4 offset:20
    s_sub_u32 s39, s39, 1
    s_cbranch_scc1 KS_ABORT
    s_waitcnt lgkmcnt(0)
    v_cmp_ne_u32 vcc, s84, v10
    s_cbranch_vccnz W_115
KS_GLZ:
    s_setprio 1
    s_add_u32 m0, s97, 0
    s_nop 0
    buffer_load_dwordx4 v46, s[72:75], s96 offen offset:0 lds
    s_add_u32 s96, s96, 146432
    buffer_load_dwordx4 v46, s[72:75], s96 offen offset:1024 lds
    s_add_u32 s96, s96, 146432
    buffer_load_dwordx4 v46, s[72:75], s96 offen offset:2048 lds
    s_add_u32 s96, s96, 146432
    buffer_load_dwordx4 v46, s[72:75], s96 offen offset:3072 lds
    s_add_u32 m0, s97, 4096
    s_add_u32 s96, s96, 150528
    buffer_load_dwordx4 v46, s[72:75], s96 offen offset:0 lds
    s_add_u32 s96, s96, 146432
    buffer_load_dwordx4 v46, s[72:75], s96 offen offset:1024 lds
    s_add_u32 s96, s96, 146432
    buffer_load_dwordx4 v46, s[72:75], s96 offen offset:2048 lds
    s_add_u32 s96, s96, 146432
    buffer_load_dwordx4 v46, s[72:75], s96 offen offset:3072 lds
    s_add_u32 m0, s97, 8192
    s_add_u32 s96, s96, 150528
    buffer_load_dwordx4 v46, s[72:75], s96 offen offset:0 lds
    s_add_u32 s96, s96, 146432
    buffer_load_dwordx4 v46, s[72:75], s96 offen offset:1024 lds
    s_add_u32 s96, s96, 146432
    buffer_load_dwordx4 v46, s[72:75], s96 offen offset:2048 lds
    s_add_u32 s96, s96, 146432
    buffer_load_dwordx4 v46, s[72:75], s96 offen offset:3072 lds
    s_add_u32 m0, s97, 12288
    s_add_u32 s96, s96, 150528
    buffer_load_dwordx4 v46, s[72:75], s96 offen offset:0 lds
    s_add_u32 s96, s96, 146432
    buffer_load_dwordx4 v46, s[72:75], s96 offen offset:1024 lds
    s_add_u32 s96, s96, 146432
    buffer_load_dwordx4 v46, s[72:75], s96 offen offset:2048 lds
    s_add_u32 s96, s96, 146432
    buffer_load_dwordx4 v46, s[72:75], s96 offen offset:3072 lds
    s_add_u32 m0, s97, 16384
    s_add_u32 s96, s96, 150528
    buffer_load_dwordx4 v46, s[72:75], s96 offen offset:0 lds
    s_add_u32 s96, s96, 146432
    buffer_load_dwordx4 v46, s[72:75], s96 offen offset:1024 lds
    s_setprio 0
    s_waitcnt vmcnt(0)
KS_G4:
    ds_write_b8 v6, v5 offset:192
    v_lshrrev_b32 v6, 3, v1
    v_xor_b32 v6, v6, v3
    v_and_b32 v6, 1, v6
    v_and_b32 v7, 2, v1
    v_or_b32 v6, v6, v7
    v_xor_b32 v6, s87, v6
    v_mul_u32_u24 v7, 18432, v7
    v_lshl_add_u32 v7, v6, 4, v7
    v_and_b32 v6, 1, v1
    v_lshl_add_u32 v7, v6, 3, v7
    v_bfe_u32 v6, v1, 2, 2
    v_lshl_add_u32 v6, v3, 3, v6
    v_lshl_add_u32 v7, v6, 6, v7
    v_add_u32 v8, 35328, v7
    v_and_b32 v9, 7, v1
    v_lshrrev_b32 v10, 1, v3
    v_and_b32 v11, 1, v3
    v_lshlrev_b32 v6, 5, v9
    v_lshl_add_u32 v6, v10, 8, v6
    v_lshl_add_u32 v6, v11, 4, v6
    v_add_u32 v6, 17088, v6
    s_lshl_b32 s92, s87, 4
    v_lshl_add_u32 v7, v9, 6, s92
    v_lshl_add_u32 v7, v11, 3, v7
    v_lshl_add_u32 v7, v10, 2, v7
    v_bfe_u32 v9, v1, 3, 1
    v_lshl_add_u32 v7, v9, 1, v7
W_116:
    s_sleep 2
    ds_read_b32 v10, v4 offset:192
    s_sub_u32 s39, s39, 1
    s_cbranch_scc1 KS_ABORT
    s_waitcnt lgkmcnt(0)
    v_cmp_ne_u32 vcc, s84, v10
    s_cbranch_vccnz W_116
W_117:
    s_sleep 2
    ds_read_b32 v10, v4 offset:12
    s_sub_u32 s39, s39, 1
    s_cbranch_scc1 KS_ABORT
    s_waitcnt lgkmcnt(0)
    v_cmp_ne_u32 vcc, s84, v10
    s_cbranch_vccnz W_117
    s_sleep 2
    ds_read_b64_tr_b16 v[48:49], v8 offset:0
    ds_read_b64_tr_b16 v[50:51], v8 offset:256
    ds_read_b64_tr_b16 v[52:53], v8 offset:2048
    ds_read_b64_tr_b16 v[54:55], v8 offset:2304
    ds_read_b64_tr_b16 v[56:57], v8 offset:4096
    ds_read_b64_tr_b16 v[58:59], v8 offset:4352
    ds_read_b64_tr_b16 v[60:61], v8 offset:6144
    ds_read_b64_tr_b16 v[62:63], v8 offset:6400
    ds_read_b64_tr_b16 v[64:65], v8 offset:8192
    ds_read_b64_tr_b16 v[66:67], v8 offset:8448
    ds_read_b64_tr_b16 v[68:69], v8 offset:10240
    ds_read_b64_tr_b16 v[70:71], v8 offset:10496
    ds_read_b64_tr_b16 v[72:73], v8 offset:12288
    ds_read_b64_tr_b16 v[74:75], v8 offset:12544
    ds_read_b64_tr_b16 v[76:77], v8 offset:14336
    ds_read_b64_tr_b16 v[78:79], v8 offset:14592
    ds_read_b64_tr_b16 v[80:81], v8 offset:16384
    ds_read_b64_tr_b16 v[82:83], v8 offset:16640
    ds_read_b64_tr_b16 v[84:85], v8 offset:18432
    ds_read_b64_tr_b16 v[86:87], v8 offset:18688
    ds_read_b64_tr_b16 v[88:89], v8 offset:20480
    ds_read_b64_tr_b16 v[90:91], v8 offset:20736
    ds_read_b64_tr_b16 v[92:93], v8 offset:22528
    ds_read_b64_tr_b16 v[94:95], v8 offset:22784
    ds_read_b64_tr_b16 v[96:97], v8 offset:24576
    ds_read_b64_tr_b16 v[98:99], v8 offset:24832
    ds_read_b64_tr_b16 v[100:101], v8 offset:26624
    ds_read_b64_tr_b16 v[102:103], v8 offset:26880
    ds_read_b64_tr_b16 v[104:105], v8 offset:28672
    ds_read_b64_tr_b16 v[106:107], v8 offset:28928
    ds_read_b64_tr_b16 v[108:109], v8 offset:30720
    ds_read_b64_tr_b16 v[110:111], v8 offset:30976
    ds_read_b64_tr_b16 v[112:113], v8 offset:32768
    ds_read_b64_tr_b16 v[114:115], v8 offset:33024
    ds_read_b64_tr_b16 v[116:117], v8 offset:34816
    ds_read_b64_tr_b16 v[118:119], v8 offset:35072
W_118:
    s_sleep 2
    ds_read_b32 v10, v4 offset:768
    s_sub_u32 s39, s39, 1
    s_cbranch_scc1 KS_ABORT
    s_waitcnt lgkmcnt(0)
    v_cmp_eq_u32 vcc, 0, v10
    s_cbranch_vccnz W_118
    s_setprio 3
KS_GC:
    s_mov_b32 exec_lo, 0x00ff00ff
    s_mov_b32 exec_hi, 0x00ff00ff
KS_GW:
    ds_read_b32 v0, v4 offset:32
    ds_read_b128 v[8:11], v6 offset:0
    ds_read_b128 v[12:15], v6 offset:512
    ds_read_b128 v[16:19], v6 offset:1024
    ds_read_b128 v[20:23], v6 offset:1536
    s_sub_u32 s39, s39, 1
    s_cbranch_scc1 KS_ABORT
    s_waitcnt lgkmcnt(4)
    v_cmp_eq_u32 vcc, 0, v0
    s_cbranch_vccnz KS_GW
    s_waitcnt lgkmcnt(3)
    v_mfma_f32_16x16x32_bf16 v[120:123], v[48:51], v[8:11], 0
    ds_read_b128 v[24:27], v6 offset:2048
    ds_read_b128 v[28:31], v6 offset:2560
    s_waitcnt lgkmcnt(4)
    v_mfma_f32_16x16x32_bf16 v[124:127], v[52:55], v[12:15], 0
    ds_read_b128 v[32:35], v6 offset:3072
    ds_read_b128 v[36:39], v6 offset:3584
    s_waitcnt lgkmcnt(5)
    v_mfma_f32_16x16x32_bf16 v[120:123], v[56:59], v[16:19], v[120:123]
    ds_read_b128 v[40:43], v6 offset:4096
    ds_read_b128 v[44:47], v6 offset:4608
    s_waitcnt lgkmcnt(6)
    v_mfma_f32_16x16x32_bf16 v[124:127], v[60:63], v[20:23], v[124:127]
    ds_read_b128 v[8:11], v6 offset:5120
    ds_read_b128 v[12:15], v6 offset:5632
    s_waitcnt lgkmcnt(7)
    v_mfma_f32_16x16x32_bf16 v[120:123], v[64:67], v[24:27], v[120:123]
    ds_read_b128 v[16:19], v6 offset:6144
    ds_read_b128 v[20:23], v6 offset:6656
    s_waitcnt lgkmcnt(8)
    v_mfma_f32_16x16x32_bf16 v[124:127], v[68:71], v[28:31], v[124:127]
    ds_read_b128 v[24:27], v6 offset:7168
    ds_read_b128 v[28:31], v6 offset:7680
    s_waitcnt lgkmcnt(9)
    v_mfma_f32_16x16x32_bf16 v[120:123], v[72:75], v[32:35], v[120:123]
    ds_read_b128 v[32:35], v6 offset:8192
    s_waitcnt lgkmcnt(9)
    v_mfma_f32_16x16x32_bf16 v[124:127], v[76:79], v[36:39], v[124:127]
    ds_read_b128 v[36:39], v6 offset:8704
    s_waitcnt lgkmcnt(9)
    v_mfma_f32_16x16x32_bf16 v[120:123], v[80:83], v[40:43], v[120:123]
    s_waitcnt lgkmcnt(8)
    v_mfma_f32_16x16x32_bf16 v[124:127], v[84:87], v[44:47], v[124:127]
    s_waitcnt lgkmcnt(7)
    v_mfma_f32_16x16x32_bf16 v[120:123], v[88:91], v[8:11], v[120:123]
    s_waitcnt lgkmcnt(6)
    v_mfma_f32_16x16x32_bf16 v[124:127], v[92:95], v[12:15], v[124:127]
    s_waitcnt lgkmcnt(5)
    v_mfma_f32_16x16x32_bf16 v[120:123], v[96:99], v[16:19], v[120:123]
    s_waitcnt lgkmcnt(4)
    v_mfma_f32_16x16x32_bf16 v[124:127], v[100:103], v[20:23], v[124:127]
    s_waitcnt lgkmcnt(3)
    v_mfma_f32_16x16x32_bf16 v[120:123], v[104:107], v[24:27], v[120:123]
    s_waitcnt lgkmcnt(2)
    v_mfma_f32_16x16x32_bf16 v[124:127], v[108:111], v[28:31], v[124:127]
    s_waitcnt lgkmcnt(1)
    v_mfma_f32_16x16x32_bf16 v[120:123], v[112:115], v[32:35], v[120:123]
    s_waitcnt lgkmcnt(0)
    v_mfma_f32_16x16x32_bf16 v[124:127], v[116:119], v[36:39], v[124:127]
    s_mov_b64 exec, -1
    s_nop 6
    v_pk_add_f32 v[120:121], v[120:121], v[124:125]
    v_pk_add_f32 v[122:123], v[122:123], v[126:127]
    s_nop 1
    v_permlane32_swap_b32 v121, v123
    v_permlane32_swap_b32 v120, v122
    s_nop 0
    v_mov_b32_dpp v120, v121 row_shr:8 row_mask:0xf bank_mask:0xc
    v_mov_b32_dpp v122, v123 row_shr:8 row_mask:0xf bank_mask:0xc
    v_cvt_pk_bf16_f32 v120, 0, v120
    v_mul_f32 v121, 0xbfb8aa3b, v120
    v_exp_f32 v121, v121
    v_cvt_pk_bf16_f32 v122, 0, v122
    v_add_f32 v121, 1.0, v121
    v_rcp_f32 v121, v121
    s_nop 0
    v_mul_f32 v121, v120, v121
    v_cvt_pk_bf16_f32 v121, 0, v121
    v_mul_f32 v121, v121, v122
    v_cvt_pk_bf16_f32 v121, v121, v121
    ds_write_b16 v7, v121 offset:1024
    s_waitcnt lgkmcnt(0)
    s_barrier
    s_setprio 0
    ds_read_b32 v0, v4 offset:24
    s_waitcnt lgkmcnt(0)
    v_cmp_eq_u32 vcc, 0, v0
    s_cbranch_vccnz KS_PEND
    s_barrier
    s_branch KS_GC
KS_PEND:
KS_ABORT:
KS_END:
    s_endpgm
.section .rodata,"a"
.p2align 6
.amdhsa_kernel sequential_preLN__ssm_conv_s4__moe_arch_mod__prompt_kernel
  .amdhsa_next_free_vgpr 128
  .amdhsa_next_free_sgpr 100
  .amdhsa_accum_offset 128
  .amdhsa_group_segment_fixed_size 0
  .amdhsa_kernarg_size 136
  .amdhsa_user_sgpr_count 2
  .amdhsa_user_sgpr_kernarg_segment_ptr 1
  .amdhsa_system_sgpr_workgroup_id_x 1
  .amdhsa_float_denorm_mode_32 3
.end_amdhsa_kernel
```

```asm
; @launch grid=(256,1,1) block=(1024,1,1) lds=154240
.amdgcn_target "amdgcn-amd-amdhsa--gfx950"
.text
.globl sequential_preLN__ssm_conv_s4__moe_arch_mod__prompt_kernel
.p2align 8
.type sequential_preLN__ssm_conv_s4__moe_arch_mod__prompt_kernel,@function
sequential_preLN__ssm_conv_s4__moe_arch_mod__prompt_kernel:
    s_cmp_ge_u32 s2, 256
    s_cbranch_scc1 KS_END
    s_load_dwordx16 s[4:19], s[0:1], 0
    s_load_dwordx16 s[20:35], s[0:1], 64
    s_load_dwordx2 s[36:37], s[0:1], 128
    v_readfirstlane_b32 s38, v0
    s_lshr_b32 s38, s38, 6
    s_and_b32 s40, s2, 7
    s_lshr_b32 s41, s2, 3
    s_cmp_lg_u32 s38, 0
    s_cbranch_scc1 KS_CPE
    s_getpc_b64 s[42:43]
KS_PC:
    s_and_b32 s92, s41, 7
    s_mul_i32 s92, s92, 4608
    v_and_b32 v126, 63, v0
    v_lshl_add_u32 v126, v126, 7, s92
    v_min_u32 v126, KS_END-KS_PC, v126
    global_load_dword v127, v126, s[42:43]
KS_CPE:
    s_add_u32 s92, s38, 8
    s_sub_u32 s93, s38, 4
    s_cmp_lt_u32 s38, 8
    s_cselect_b32 s92, s92, s93
    s_cmp_lt_u32 s38, 4
    s_cselect_b32 s38, s38, s92
    v_and_b32 v1, 63, v0
    v_and_b32 v2, 15, v1
    v_lshrrev_b32 v3, 4, v1
    v_mov_b32 v4, 0
    v_mov_b32 v5, 1
    s_mov_b32 s39, 524288
    s_mov_b32 s84, 0x01010101
    s_lshl_b32 s90, s40, 5
    s_add_u32 s90, s90, s41
    s_mul_i32 s89, s40, 18
    s_add_u32 s89, s89, s41
    s_cmp_lt_u32 s38, 4
    s_cbranch_scc1 KS_L
    s_cmp_ge_u32 s38, 12
    s_cbranch_scc1 KS_X
    s_setprio 2
    s_lshr_b32 s87, s38, 2
    s_sub_u32 s87, s87, 1
    s_mul_i32 s86, s87, 3
    s_xor_b32 s86, s86, s38
    s_and_b32 s86, s86, 3
    s_lshl_b32 s88, s90, 1
    s_add_u32 s88, s88, s87
    s_lshl_b32 s92, s86, 11
    s_add_u32 s92, s92, 146048
    v_lshl_add_u32 v28, v1, 3, s92
    s_cmp_eq_u32 s86, 3
    s_cbranch_scc1 PX_1
    v_lshlrev_b32 v26, 3, v2
    v_mov_b32 v21, 0x80
    s_cmp_eq_u32 s86, 1
    s_cbranch_scc1 PX_2
    s_cmp_eq_u32 s86, 2
    s_cbranch_scc1 PX_3
    v_lshl_add_u32 v26, v3, 1, v26
    v_mov_b32 v22, 1
    s_branch PX_4
PX_2:
    v_cmp_gt_u32 vcc, 2, v3
    v_lshl_add_u32 v20, v3, 2, v26
    v_add_u32 v20, 256, v20
    v_lshl_add_u32 v26, v3, 8, v26
    v_cndmask_b32 v26, v26, v20, vcc
    v_cndmask_b32 v22, v21, 2, vcc
    v_cndmask_b32 v21, 4, v21, vcc
    s_branch PX_4
PX_3:
    v_lshl_add_u32 v26, v3, 9, v26
    v_add_u32 v26, 0x400, v26
    v_mov_b32 v22, 0x100
PX_4:
    v_mad_u32_u24 v26, v22, s87, v26
    v_add_u32 v27, v26, v21
    s_movk_i32 s96, 31232
    s_movk_i32 s97, -19072
    s_lshl_b32 s95, s87, 9
    v_cvt_f32_u32 v20, v26
    v_max_u32 v22, 0x800, v26
    v_cvt_f32_u32 v21, v27
    v_max_u32 v23, 0x800, v27
    v_cmp_gt_u32 vcc, 0x80, v26
    v_lshrrev_b32 v24, 16, v20
    v_add3_u32 v24, v24, v22, s97
    v_cndmask_b32 v24, v24, v26, vcc
    v_cmp_gt_u32 vcc, 0x80, v27
    v_lshrrev_b32 v25, 16, v21
    v_add3_u32 v25, v25, v23, s97
    v_cndmask_b32 v25, v25, v27, vcc
    v_min_u32 v24, 642, v24
    v_lshl_add_u32 v24, v24, 1, s96
    v_min_u32 v25, 642, v25
    v_lshl_add_u32 v25, v25, 1, s96
    v_add_u32 v29, s95, v28
    v_lshl_or_b32 v24, v25, 16, v24
    v_lshl_or_b32 v25, v27, 16, v26
    ds_write_b64 v29, v[24:25]
PX_1:
KS_GRP:
    s_lshl_b32 s92, s88, 8
    v_lshl_add_u32 v20, v1, 2, s92
    s_lshl_b32 s92, s88, 1
    v_mov_b32 v21, s92
    s_mul_i32 s85, s87, 36672
    s_add_u32 s85, s85, 35840
    s_waitcnt lgkmcnt(0)
    global_load_ushort v46, v21, s[18:19]
    global_load_dword v40, v20, s[6:7]
    global_load_dword v41, v20, s[8:9]
    global_load_dword v42, v20, s[10:11]
    global_load_dword v43, v20, s[12:13]
    global_load_dword v44, v20, s[14:15]
    global_load_dword v45, v20, s[16:17]
    global_load_ushort v107, v21, s[20:21]
    s_barrier
    s_movk_i32 s96, 31232
    s_cmp_eq_u32 s87, 2
    s_cbranch_scc1 PREE_7
    v_mov_b32 v32, 641
    s_cmp_eq_u32 s87, 1
    s_cbranch_scc1 PREB_5
    v_mov_b32 v33, 32514
    s_cmp_eq_u32 s86, 1
    s_cbranch_scc1 PRE_9
    s_cmp_eq_u32 s86, 2
    s_cbranch_scc1 PRE_10
    s_cmp_eq_u32 s86, 3
    s_cbranch_scc1 PRE_11
    v_lshlrev_b32 v23, 1, v1
    v_sub_u32 v30, 93, v23
    v_cmp_lt_u32 vcc, 61, v30
    v_lshlrev_b32 v31, 2, v30
    v_add_u32 v31, 32010, v31
    v_cndmask_b32 v24, v31, v33, vcc
    v_sub_u32 v30, 92, v23
    v_cmp_lt_u32 vcc, 61, v30
    v_lshlrev_b32 v31, 2, v30
    v_add_u32 v31, 32010, v31
    v_cndmask_b32 v25, v31, v33, vcc
    v_sub_u32 v30, 94, v23
    v_cmp_lt_u32 vcc, 62, v30
    v_lshlrev_b32 v31, 2, v30
    v_add_u32 v31, 32008, v31
    v_cndmask_b32 v26, v31, v33, vcc
    v_sub_u32 v30, 93, v23
    v_cmp_lt_u32 vcc, 62, v30
    v_lshlrev_b32 v31, 2, v30
    v_add_u32 v31, 32008, v31
    v_cndmask_b32 v27, v31, v33, vcc
    s_branch PREW_6
PRE_9:
    v_min_u32 v23, 47, v1
    v_lshlrev_b32 v23, 1, v23
    v_sub_u32 v30, 64, v23
    v_cmp_lt_u32 vcc, 63, v30
    v_lshlrev_b32 v31, 2, v30
    v_add_u32 v31, 32258, v31
    v_cndmask_b32 v24, v31, v33, vcc
    v_sub_u32 v30, 63, v23
    v_cmp_lt_u32 vcc, 63, v30
    v_lshlrev_b32 v31, 2, v30
    v_add_u32 v31, 32258, v31
    v_cndmask_b32 v25, v31, v33, vcc
    v_sub_u32 v30, 62, v23
    v_cmp_lt_u32 vcc, 63, v30
    v_lshlrev_b32 v31, 2, v30
    v_add_u32 v31, 32258, v31
    v_cndmask_b32 v27, v31, v33, vcc
    v_mov_b32 v26, v25
    s_branch PREW_6
PRE_10:
    v_min_u32 v23, 47, v1
    v_lshlrev_b32 v23, 1, v23
    v_sub_u32 v30, 64, v23
    v_cmp_lt_u32 vcc, 63, v30
    v_lshlrev_b32 v31, 2, v30
    v_add_u32 v31, 32260, v31
    v_cndmask_b32 v24, v31, v33, vcc
    v_sub_u32 v30, 63, v23
    v_cmp_lt_u32 vcc, 63, v30
    v_lshlrev_b32 v31, 2, v30
    v_add_u32 v31, 32260, v31
    v_cndmask_b32 v25, v31, v33, vcc
    v_sub_u32 v30, 62, v23
    v_cmp_lt_u32 vcc, 63, v30
    v_lshlrev_b32 v31, 2, v30
    v_add_u32 v31, 32260, v31
    v_cndmask_b32 v27, v31, v33, vcc
    v_mov_b32 v26, v25
    s_branch PREW_6
PRE_11:
    v_cmp_gt_u32 vcc, 9, v1
    v_add_u32 v23, 0x100, v1
    v_mov_b32 v33, 0x200
    v_cndmask_b32 v23, v23, v1, vcc
    v_lshlrev_b32 v23, 1, v23
    v_sub_u32 v30, 544, v23
    v_cvt_f32_i32 v31, v30
    v_cmp_gt_u32 vcc, 0x100, v30
    v_cvt_pk_bf16_f32 v31, v31, v31
    v_and_b32 v31, 0xffff, v31
    v_subrev_u32 v31, 0x4280, v31
    v_cndmask_b32 v31, v31, v30, vcc
    v_cmp_lt_u32 vcc, 0x20d, v30
    v_or_b32 v30, 1, v23
    s_nop 0
    v_cndmask_b32 v31, v31, v32, vcc
    v_cmp_eq_u32 vcc, 0x25d, v30
    s_nop 1
    v_cndmask_b32 v31, v31, v33, vcc
    v_lshl_add_u32 v24, v31, 1, s96
    v_add_u32 v23, 1, v23
    v_sub_u32 v30, 544, v23
    v_cvt_f32_i32 v31, v30
    v_cmp_gt_u32 vcc, 0x100, v30
    v_cvt_pk_bf16_f32 v31, v31, v31
    v_and_b32 v31, 0xffff, v31
    v_subrev_u32 v31, 0x4280, v31
    v_cndmask_b32 v31, v31, v30, vcc
    v_cmp_lt_u32 vcc, 0x20d, v30
    v_or_b32 v30, 1, v23
    s_nop 0
    v_cndmask_b32 v31, v31, v32, vcc
    v_cmp_eq_u32 vcc, 0x25d, v30
    s_nop 1
    v_cndmask_b32 v31, v31, v33, vcc
    v_lshl_add_u32 v25, v31, 1, s96
    v_add_u32 v23, 1, v23
    v_sub_u32 v30, 544, v23
    v_cvt_f32_i32 v31, v30
    v_cmp_gt_u32 vcc, 0x100, v30
    v_cvt_pk_bf16_f32 v31, v31, v31
    v_and_b32 v31, 0xffff, v31
    v_subrev_u32 v31, 0x4280, v31
    v_cndmask_b32 v31, v31, v30, vcc
    v_cmp_lt_u32 vcc, 0x20d, v30
    v_or_b32 v30, 1, v23
    s_nop 0
    v_cndmask_b32 v31, v31, v32, vcc
    v_cmp_eq_u32 vcc, 0x25d, v30
    s_nop 1
    v_cndmask_b32 v31, v31, v33, vcc
    v_lshl_add_u32 v27, v31, 1, s96
    v_mov_b32 v26, v25
    s_branch PREW_6
PREB_5:
    s_lshl_b32 s93, s86, 7
    s_add_u32 s93, s93, 18
    v_lshl_add_u32 v23, v1, 1, s93
    v_sub_u32 v30, 544, v23
    v_cvt_f32_i32 v31, v30
    v_cmp_gt_u32 vcc, 0x100, v30
    v_cvt_pk_bf16_f32 v31, v31, v31
    v_and_b32 v31, 0xffff, v31
    v_subrev_u32 v31, 0x4280, v31
    v_cndmask_b32 v31, v31, v30, vcc
    v_cmp_lt_u32 vcc, 0x20d, v30
    s_nop 1
    v_cndmask_b32 v31, v31, v32, vcc
    v_lshl_add_u32 v24, v31, 1, s96
    v_add_u32 v23, 1, v23
    v_sub_u32 v30, 544, v23
    v_cvt_f32_i32 v31, v30
    v_cmp_gt_u32 vcc, 0x100, v30
    v_cvt_pk_bf16_f32 v31, v31, v31
    v_and_b32 v31, 0xffff, v31
    v_subrev_u32 v31, 0x4280, v31
    v_cndmask_b32 v31, v31, v30, vcc
    v_cmp_lt_u32 vcc, 0x20d, v30
    s_nop 1
    v_cndmask_b32 v31, v31, v32, vcc
    v_lshl_add_u32 v25, v31, 1, s96
    v_add_u32 v23, 1, v23
    v_sub_u32 v30, 544, v23
    v_cvt_f32_i32 v31, v30
    v_cmp_gt_u32 vcc, 0x100, v30
    v_cvt_pk_bf16_f32 v31, v31, v31
    v_and_b32 v31, 0xffff, v31
    v_subrev_u32 v31, 0x4280, v31
    v_cndmask_b32 v31, v31, v30, vcc
    v_cmp_lt_u32 vcc, 0x20d, v30
    s_nop 1
    v_cndmask_b32 v31, v31, v32, vcc
    v_lshl_add_u32 v26, v31, 1, s96
    s_sub_u32 s93, s86, 1
    s_cmp_lt_u32 s93, 2
    s_cselect_b32 s94, 47, 63
    s_mul_i32 s93, s93, 384
    s_add_u32 s93, s93, 35664
    s_cmp_eq_u32 s86, 0
    s_cselect_b32 s93, 35152, s93
    s_cmp_eq_u32 s86, 3
    s_cselect_b32 s93, 32528, s93
    s_cselect_b32 s95, 0x100, 0
    v_cmp_gt_u32 vcc, 9, v1
    v_min_u32 v23, s94, v1
    v_add_u32 v30, s95, v23
    v_cndmask_b32 v23, v30, v23, vcc
    s_sub_u32 s93, s93, 5244
    v_lshl_add_u32 v27, v23, 2, s93
    v_lshl_or_b32 v24, v25, 16, v24
    v_lshl_or_b32 v25, v27, 16, v26
    ds_write_b64 v28, v[24:25] offset:1024
    v_mov_b32 v24, s86
    ds_write_b8 v24, v5 offset:212
    s_branch PREE_7
PREW_6:
    v_lshl_or_b32 v24, v25, 16, v24
    v_lshl_or_b32 v25, v27, 16, v26
    ds_write_b64 v28, v[24:25] offset:1536
    v_mov_b32 v24, s86
    ds_write_b8 v24, v5 offset:208
PREE_7:
    s_mul_i32 s93, s86, 8704
    s_min_u32 s94, s93, 22304
    s_add_u32 s94, s94, s85
    s_lshl_b32 s92, s87, 4
    v_mov_b32 v14, s92
    v_add_u32 v15, s86, v14
    v_lshl_add_u32 v72, v1, 3, s94
    v_add_u32 v73, 2176, v72
    v_add_u32 v74, 4352, v72
    v_add_u32 v75, 6528, v72
    v_mul_u32_u24 v126, 544, v2
    v_lshl_add_u32 v126, v3, 4, v126
    v_add_u32 v126, s85, v126
    v_add_u32 v127, s93, v126
    v_lshlrev_b32 v20, 3, v3
    v_sub_u32 v20, v20, v2
    v_add_u32 v21, 16, v20
    v_lshrrev_b32 v21, 1, v21
    v_and_b32 v23, 1, v21
    s_movk_i32 s93, -5244
    v_and_b32 v22, 1, v2
    s_add_u32 s92, s85, 32528
    v_lshl_add_u32 v21, v21, 2, s92
    s_movk_i32 s92, 1344
    s_movk_i32 s94, 192
    v_mad_i32_i24 v21, v23, s93, v21
    v_mad_u32_u24 v6, v22, s92, v21
    v_add_u32 v7, 640, v6
    v_mad_u32_u24 v23, v22, s94, v21
    v_add_u32 v13, 3136, v23
    v_lshlrev_b32 v23, 2, v3
    v_sub_u32 v23, v23, v2
    s_add_u32 s92, s85, 29968
    v_lshl_add_u32 v11, v23, 2, s92
    s_movk_i32 s93, 5244
    v_mad_u32_u24 v11, v22, s93, v11
    s_mul_i32 s94, s87, 4672
    s_add_u32 s94, s94, 3072
    v_lshl_add_u32 v23, v2, 5, s94
    v_lshl_add_u32 v8, v3, 4, v23
    v_bfe_u32 v20, v1, 2, 2
    v_and_b32 v21, 3, v1
    v_lshl_add_u32 v20, v3, 3, v20
    v_lshlrev_b32 v105, 2, v21
    v_lshl_add_u32 v21, v21, 3, s85
    v_lshl_add_u32 v9, v20, 4, v21
    v_lshl_add_u32 v10, v20, 5, v21
    v_lshlrev_b32 v12, 4, v1
    s_add_u32 s64, s36, 0x600000
    s_addc_u32 s65, s37, 0
    s_mov_b32 s66, 0x240000
    s_mov_b32 s67, 0x20000
    s_mov_b32 s10, 0x8080
    s_lshl_b32 s92, s86, 19
    s_lshl_b32 s93, s90, 6
    s_add_u32 s92, s92, s93
    s_lshl_b32 s93, s86, 16
    s_lshl_b32 s95, s88, 6
    s_add_u32 s93, s93, s95
    s_add_u32 s93, s93, 2064384
    s_cmp_eq_u32 s87, 2
    s_cselect_b32 s6, s93, s92
    s_cselect_b32 s8, 0x1080, s10
    s_cselect_b32 s92, 1, 3
    s_and_b32 s92, s92, s86
    s_lshl_b32 s92, s92, 11
    s_xor_b32 s6, s6, s92
    s_and_b32 s10, s6, 0x7c0
    s_xor_b32 s6, s6, s10
    s_xor_b32 s7, s6, 0x6000
    s_and_b32 s9, s87, 1
    s_lshl_b32 s9, s9, 4
    s_mov_b32 s12, 0x55555555
    s_mov_b32 s13, 0x55555555
    s_lshl_b32 s92, s86, 8
    s_add_u32 s92, s92, s85
    s_add_u32 s92, s92, 36
    v_lshl_add_u32 v124, v1, 2, s92
    s_movk_i32 s92, 192
    s_cmp_eq_u32 s86, 0
    s_cselect_b32 s92, 256, s92
    s_cmp_eq_u32 s86, 3
    s_cselect_b32 s92, 1344, s92
    v_mov_b32 v20, s85
    ds_write_b16 v20, v4 offset:32514
    s_mov_b32 s18, s92
    v_mov_b32 v125, v28
W_12:
    ds_read_b64 v[18:19], v4 offset:208
    s_sub_u32 s39, s39, 1
    s_cbranch_scc1 KS_ABORT
    s_waitcnt lgkmcnt(0)
    v_and_b32 v18, v18, v19
    v_cmp_ne_u32 vcc, s84, v18
    s_cbranch_vccnz W_12
    ds_read2st64_b64 v[28:31], v125 offset0:0 offset1:1
    ds_read2st64_b64 v[32:35], v125 offset0:2 offset1:3
    s_waitcnt lgkmcnt(0)
    v_add_u32_sdwa v108, s85, v28 dst_sel:DWORD dst_unused:UNUSED_PAD src0_sel:DWORD src1_sel:WORD_0
    v_add_u32_sdwa v109, s85, v28 dst_sel:DWORD dst_unused:UNUSED_PAD src0_sel:DWORD src1_sel:WORD_1
    v_cvt_f32_u32_sdwa v110, v29 dst_sel:DWORD dst_unused:UNUSED_PAD src0_sel:WORD_0
    v_cvt_f32_u32_sdwa v111, v29 dst_sel:DWORD dst_unused:UNUSED_PAD src0_sel:WORD_1
    v_add_u32_sdwa v112, s85, v30 dst_sel:DWORD dst_unused:UNUSED_PAD src0_sel:DWORD src1_sel:WORD_0
    v_add_u32_sdwa v113, s85, v30 dst_sel:DWORD dst_unused:UNUSED_PAD src0_sel:DWORD src1_sel:WORD_1
    v_cvt_f32_u32_sdwa v114, v31 dst_sel:DWORD dst_unused:UNUSED_PAD src0_sel:WORD_0
    v_cvt_f32_u32_sdwa v115, v31 dst_sel:DWORD dst_unused:UNUSED_PAD src0_sel:WORD_1
    v_add_u32_sdwa v116, s85, v32 dst_sel:DWORD dst_unused:UNUSED_PAD src0_sel:DWORD src1_sel:WORD_0
    v_add_u32_sdwa v117, s85, v32 dst_sel:DWORD dst_unused:UNUSED_PAD src0_sel:DWORD src1_sel:WORD_1
    v_add_u32_sdwa v118, s85, v33 dst_sel:DWORD dst_unused:UNUSED_PAD src0_sel:DWORD src1_sel:WORD_0
    v_add_u32_sdwa v119, s85, v33 dst_sel:DWORD dst_unused:UNUSED_PAD src0_sel:DWORD src1_sel:WORD_1
    v_add_u32_sdwa v120, s85, v34 dst_sel:DWORD dst_unused:UNUSED_PAD src0_sel:DWORD src1_sel:WORD_0
    v_add_u32_sdwa v121, s85, v34 dst_sel:DWORD dst_unused:UNUSED_PAD src0_sel:DWORD src1_sel:WORD_1
    v_add_u32_sdwa v122, s85, v35 dst_sel:DWORD dst_unused:UNUSED_PAD src0_sel:DWORD src1_sel:WORD_0
    v_add_u32_sdwa v123, s85, v35 dst_sel:DWORD dst_unused:UNUSED_PAD src0_sel:DWORD src1_sel:WORD_1
    v_add_u32 v125, s18, v119
    s_lshl_b32 s92, s87, 5
    s_add_u32 s92, s92, s41
    s_cmp_ge_u32 s92, 88
    s_cbranch_scc1 KC_RECV
    s_mov_b32 s92, 0x3fb8aa3b
    s_mov_b32 s93, 0x32a57060
    s_mov_b32 s94, 0x3e22f983
    s_mov_b32 s95, 0x31dc9c88
    s_waitcnt vmcnt(7)
    v_lshlrev_b32 v16, 16, v46
    v_mul_f32 v17, s92, v16
    v_fma_f32 v19, v16, s92, -v17
    v_fmac_f32 v19, s93, v16
    v_exp_f32 v17, v17
    v_mul_f32 v19, 0x3f317218, v19
    v_fmac_f32 v17, v17, v19
    v_cvt_pk_bf16_f32 v16, 0, v17
    s_waitcnt vmcnt(5)
    ds_write_b32 v4, v5 offset:36
    v_lshlrev_b32 v20, 16, v40
    v_and_b32 v21, 0xffff0000, v40
    v_lshlrev_b32 v22, 16, v41
    v_and_b32 v23, 0xffff0000, v41
    v_pk_mul_f32 v[20:21], v[20:21], v[16:17] op_sel_hi:[1,0]
    v_pk_mul_f32 v[22:23], v[22:23], v[16:17] op_sel_hi:[1,0]
    v_max_f32 v36, v20, v21
    v_pk_mul_f32 v[68:69], v[22:23], s[94:95] op_sel_hi:[1,0]
    v_pk_fma_f32 v[70:71], v[22:23], s[94:95], v[68:69] op_sel_hi:[1,0,1] neg_lo:[0,0,1] neg_hi:[0,0,1]
    v_pk_fma_f32 v[70:71], v[22:23], s[94:95], v[70:71] op_sel:[0,1,0]
    s_cmp_eq_u32 s86, 3
    s_cbranch_scc1 SK_14
    s_waitcnt vmcnt(1)
    v_lshlrev_b32 v24, 16, v42
    v_and_b32 v25, 0xffff0000, v42
    v_lshlrev_b32 v26, 16, v43
    v_and_b32 v27, 0xffff0000, v43
    v_lshlrev_b32 v28, 16, v44
    v_and_b32 v29, 0xffff0000, v44
    v_lshlrev_b32 v30, 16, v45
    v_and_b32 v31, 0xffff0000, v45
    v_pk_mul_f32 v[24:25], v[24:25], v[16:17] op_sel_hi:[1,0]
    v_pk_mul_f32 v[26:27], v[26:27], v[16:17] op_sel_hi:[1,0]
    v_pk_mul_f32 v[90:91], v[30:31], v[26:27]
    v_pk_mul_f32 v[92:93], v[30:31], v[24:25]
    v_pk_fma_f32 v[34:35], v[28:29], v[26:27], v[92:93]
    v_pk_fma_f32 v[32:33], v[28:29], v[24:25], v[90:91] neg_lo:[0,0,1] neg_hi:[0,0,1]
    v_max3_f32 v37, abs(v34), abs(v35), abs(v32)
    v_max_f32 v37, v37, abs(v33)
SK_14:
    s_waitcnt vmcnt(0)
    s_nop 0
    v_permlane32_swap_b32 v36, v37
    v_max_f32 v36, v36, v37
    s_nop 1
    v_max_f32_dpp v36, v36, v36 row_ror:8 row_mask:0xf bank_mask:0xf
    s_nop 1
    v_max_f32_dpp v36, v36, v36 row_ror:4 row_mask:0xf bank_mask:0xf
    s_nop 1
    v_max_f32_dpp v36, v36, v36 row_ror:2 row_mask:0xf bank_mask:0xf
    s_nop 1
    v_max_f32_dpp v36, v36, v36 row_ror:1 row_mask:0xf bank_mask:0xf
    v_mov_b32 v38, v36
    s_nop 1
    v_permlane16_swap_b32 v36, v38
    v_max_f32 v36, v36, v38
    s_nop 0
    v_readlane_b32 s14, v36, 0
    v_readlane_b32 s15, v36, 32
    s_add_u32 s15, s15, 0x7fffff
    s_lshr_b32 s15, s15, 23
    s_max_u32 s15, s15, 24
    s_sub_u32 s16, 269, s15
    s_lshl_b32 s16, s16, 23
    v_subrev_f32 v20, s14, v20
    v_subrev_f32 v21, s14, v21
    v_mul_f32 v20, 0x3fb8aa3b, v20
    v_mul_f32 v21, 0x3fb8aa3b, v21
    s_cmp_eq_u32 s86, 3
    s_cbranch_scc1 JOB_18
    s_cmp_eq_u32 s86, 1
    s_cbranch_scc1 JOB_16
    s_cmp_eq_u32 s86, 2
    s_cbranch_scc1 JOB_17
    v_mul_f32 v91, 0x43000000, v68
    v_mul_f32 v90, 0x43000000, v20
    v_mul_f32 v95, 0x43000000, v69
    v_mul_f32 v94, 0x43000000, v21
    v_fract_f32 v91, v91
    v_fract_f32 v95, v95
    v_fmac_f32 v91, 0x43000000, v70
    v_fmac_f32 v95, 0x43000000, v71
    v_exp_f32 v90, v90
    v_cos_f32 v92, v91
    v_sin_f32 v91, v91
    v_exp_f32 v94, v94
    v_cos_f32 v96, v95
    v_sin_f32 v95, v95
    v_mul_f32 v44, v90, v92
    v_mul_f32 v46, v90, v91
    v_mul_f32 v45, v94, v96
    v_mul_f32 v47, v94, v95
    v_pk_mul_f32 v[32:33], v[32:33], s[16:17] op_sel_hi:[1,0]
    v_pk_mul_f32 v[34:35], v[34:35], s[16:17] op_sel_hi:[1,0]
    v_fract_f32 v91, v68
    v_fract_f32 v95, v69
    v_fmac_f32 v91, 1.0, v70
    v_fmac_f32 v95, 1.0, v71
    v_exp_f32 v90, v20
    v_cos_f32 v92, v91
    v_sin_f32 v91, v91
    v_exp_f32 v94, v21
    v_cos_f32 v96, v95
    v_sin_f32 v95, v95
    v_mul_f32 v40, v90, v92
    v_mul_f32 v42, v90, v91
    v_mul_f32 v41, v94, v96
    v_mul_f32 v43, v94, v95
    v_pk_mul_f32 v[90:91], v[34:35], v[46:47]
    v_pk_mul_f32 v[94:95], v[34:35], v[42:43]
    v_pk_mul_f32 v[92:93], v[34:35], v[44:45]
    v_pk_mul_f32 v[96:97], v[34:35], v[40:41]
    v_pk_fma_f32 v[62:63], v[32:33], v[46:47], v[92:93]
    v_pk_fma_f32 v[54:55], v[32:33], v[42:43], v[96:97]
    v_pk_fma_f32 v[60:61], v[32:33], v[44:45], v[90:91] neg_lo:[0,0,1] neg_hi:[0,0,1]
    v_pk_fma_f32 v[52:53], v[32:33], v[40:41], v[94:95] neg_lo:[0,0,1] neg_hi:[0,0,1]
    v_cvt_pk_f16_f32 v98, v32, v34
    v_cvt_pk_f16_f32 v99, v33, v35
    v_cvt_pk_f16_f32 v100, v60, v62
    v_cvt_pk_f16_f32 v101, v61, v63
    ds_write2_b64 v72, v[98:99], v[100:101] offset0:0 offset1:68
    v_pk_mul_f32 v[90:91], v[54:55], v[46:47]
    v_pk_mul_f32 v[94:95], v[54:55], v[42:43]
    v_pk_mul_f32 v[92:93], v[54:55], v[44:45]
    v_pk_mul_f32 v[96:97], v[54:55], v[40:41]
    v_pk_fma_f32 v[62:63], v[52:53], v[46:47], v[92:93]
    v_pk_fma_f32 v[58:59], v[52:53], v[42:43], v[96:97]
    v_pk_fma_f32 v[60:61], v[52:53], v[44:45], v[90:91] neg_lo:[0,0,1] neg_hi:[0,0,1]
    v_pk_fma_f32 v[56:57], v[52:53], v[40:41], v[94:95] neg_lo:[0,0,1] neg_hi:[0,0,1]
    v_cvt_pk_f16_f32 v76, v52, v54
    v_cvt_pk_f16_f32 v77, v53, v55
    v_cvt_pk_f16_f32 v78, v60, v62
    v_cvt_pk_f16_f32 v79, v61, v63
    ds_write2_b64 v72, v[76:77], v[78:79] offset0:136 offset1:204
    v_pk_mul_f32 v[90:91], v[58:59], v[46:47]
    v_pk_mul_f32 v[94:95], v[58:59], v[42:43]
    v_pk_mul_f32 v[92:93], v[58:59], v[44:45]
    v_pk_mul_f32 v[96:97], v[58:59], v[40:41]
    v_pk_fma_f32 v[62:63], v[56:57], v[46:47], v[92:93]
    v_pk_fma_f32 v[54:55], v[56:57], v[42:43], v[96:97]
    v_pk_fma_f32 v[60:61], v[56:57], v[44:45], v[90:91] neg_lo:[0,0,1] neg_hi:[0,0,1]
    v_pk_fma_f32 v[52:53], v[56:57], v[40:41], v[94:95] neg_lo:[0,0,1] neg_hi:[0,0,1]
    v_cvt_pk_f16_f32 v98, v56, v58
    v_cvt_pk_f16_f32 v99, v57, v59
    v_cvt_pk_f16_f32 v100, v60, v62
    v_cvt_pk_f16_f32 v101, v61, v63
    ds_write2_b64 v73, v[98:99], v[100:101] offset0:0 offset1:68
    v_pk_mul_f32 v[90:91], v[54:55], v[46:47]
    v_pk_mul_f32 v[94:95], v[54:55], v[42:43]
    v_pk_mul_f32 v[92:93], v[54:55], v[44:45]
    v_pk_mul_f32 v[96:97], v[54:55], v[40:41]
    v_pk_fma_f32 v[62:63], v[52:53], v[46:47], v[92:93]
    v_pk_fma_f32 v[58:59], v[52:53], v[42:43], v[96:97]
    v_pk_fma_f32 v[60:61], v[52:53], v[44:45], v[90:91] neg_lo:[0,0,1] neg_hi:[0,0,1]
    v_pk_fma_f32 v[56:57], v[52:53], v[40:41], v[94:95] neg_lo:[0,0,1] neg_hi:[0,0,1]
    v_cvt_pk_f16_f32 v76, v52, v54
    v_cvt_pk_f16_f32 v77, v53, v55
    v_cvt_pk_f16_f32 v78, v60, v62
    v_cvt_pk_f16_f32 v79, v61, v63
    ds_write2_b64 v73, v[76:77], v[78:79] offset0:136 offset1:204
    v_pk_mul_f32 v[90:91], v[58:59], v[46:47]
    v_pk_mul_f32 v[94:95], v[58:59], v[42:43]
    v_pk_mul_f32 v[92:93], v[58:59], v[44:45]
    v_pk_mul_f32 v[96:97], v[58:59], v[40:41]
    v_pk_fma_f32 v[62:63], v[56:57], v[46:47], v[92:93]
    v_pk_fma_f32 v[54:55], v[56:57], v[42:43], v[96:97]
    v_pk_fma_f32 v[60:61], v[56:57], v[44:45], v[90:91] neg_lo:[0,0,1] neg_hi:[0,0,1]
    v_pk_fma_f32 v[52:53], v[56:57], v[40:41], v[94:95] neg_lo:[0,0,1] neg_hi:[0,0,1]
    v_cvt_pk_f16_f32 v98, v56, v58
    v_cvt_pk_f16_f32 v99, v57, v59
    v_cvt_pk_f16_f32 v100, v60, v62
    v_cvt_pk_f16_f32 v101, v61, v63
    ds_write2_b64 v74, v[98:99], v[100:101] offset0:0 offset1:68
    v_pk_mul_f32 v[90:91], v[54:55], v[46:47]
    v_pk_mul_f32 v[94:95], v[54:55], v[42:43]
    v_pk_mul_f32 v[92:93], v[54:55], v[44:45]
    v_pk_mul_f32 v[96:97], v[54:55], v[40:41]
    v_pk_fma_f32 v[62:63], v[52:53], v[46:47], v[92:93]
    v_pk_fma_f32 v[58:59], v[52:53], v[42:43], v[96:97]
    v_pk_fma_f32 v[60:61], v[52:53], v[44:45], v[90:91] neg_lo:[0,0,1] neg_hi:[0,0,1]
    v_pk_fma_f32 v[56:57], v[52:53], v[40:41], v[94:95] neg_lo:[0,0,1] neg_hi:[0,0,1]
    v_cvt_pk_f16_f32 v76, v52, v54
    v_cvt_pk_f16_f32 v77, v53, v55
    v_cvt_pk_f16_f32 v78, v60, v62
    v_cvt_pk_f16_f32 v79, v61, v63
    ds_write2_b64 v74, v[76:77], v[78:79] offset0:136 offset1:204
    v_pk_mul_f32 v[90:91], v[58:59], v[46:47]
    v_pk_mul_f32 v[94:95], v[58:59], v[42:43]
    v_pk_mul_f32 v[92:93], v[58:59], v[44:45]
    v_pk_mul_f32 v[96:97], v[58:59], v[40:41]
    v_pk_fma_f32 v[62:63], v[56:57], v[46:47], v[92:93]
    v_pk_fma_f32 v[54:55], v[56:57], v[42:43], v[96:97]
    v_pk_fma_f32 v[60:61], v[56:57], v[44:45], v[90:91] neg_lo:[0,0,1] neg_hi:[0,0,1]
    v_pk_fma_f32 v[52:53], v[56:57], v[40:41], v[94:95] neg_lo:[0,0,1] neg_hi:[0,0,1]
    v_cvt_pk_f16_f32 v98, v56, v58
    v_cvt_pk_f16_f32 v99, v57, v59
    v_cvt_pk_f16_f32 v100, v60, v62
    v_cvt_pk_f16_f32 v101, v61, v63
    ds_write2_b64 v75, v[98:99], v[100:101] offset0:0 offset1:68
    v_pk_mul_f32 v[90:91], v[54:55], v[46:47]
    v_pk_mul_f32 v[92:93], v[54:55], v[44:45]
    v_pk_fma_f32 v[62:63], v[52:53], v[46:47], v[92:93]
    v_pk_fma_f32 v[60:61], v[52:53], v[44:45], v[90:91] neg_lo:[0,0,1] neg_hi:[0,0,1]
    v_cvt_pk_f16_f32 v76, v52, v54
    v_cvt_pk_f16_f32 v77, v53, v55
    v_cvt_pk_f16_f32 v78, v60, v62
    v_cvt_pk_f16_f32 v79, v61, v63
    ds_write2_b64 v75, v[76:77], v[78:79] offset0:136 offset1:204
    s_branch JOBJ_19
JOB_16:
    v_mul_f32 v91, 0x43000000, v68
    v_mul_f32 v90, 0x43000000, v20
    v_mul_f32 v95, 0x43000000, v69
    v_mul_f32 v94, 0x43000000, v21
    v_fract_f32 v91, v91
    v_fract_f32 v95, v95
    v_fmac_f32 v91, 0x43000000, v70
    v_fmac_f32 v95, 0x43000000, v71
    v_exp_f32 v90, v90
    v_cos_f32 v92, v91
    v_sin_f32 v91, v91
    v_exp_f32 v94, v94
    v_cos_f32 v96, v95
    v_sin_f32 v95, v95
    v_mul_f32 v44, v90, v92
    v_mul_f32 v46, v90, v91
    v_mul_f32 v45, v94, v96
    v_mul_f32 v47, v94, v95
    v_pk_mul_f32 v[32:33], v[32:33], s[16:17] op_sel_hi:[1,0]
    v_pk_mul_f32 v[34:35], v[34:35], s[16:17] op_sel_hi:[1,0]
    v_pk_mul_f32 v[90:91], v[46:47], v[46:47]
    v_pk_mul_f32 v[92:93], v[44:45], v[46:47]
    v_pk_fma_f32 v[48:49], v[44:45], v[44:45], v[90:91] neg_lo:[0,0,1] neg_hi:[0,0,1]
    v_pk_add_f32 v[50:51], v[92:93], v[92:93]
    v_mul_f32 v91, 2.0, v68
    v_mul_f32 v90, 2.0, v20
    v_mul_f32 v95, 2.0, v69
    v_mul_f32 v94, 2.0, v21
    v_fract_f32 v91, v91
    v_fract_f32 v95, v95
    v_fmac_f32 v91, 2.0, v70
    v_fmac_f32 v95, 2.0, v71
    v_exp_f32 v90, v90
    v_cos_f32 v92, v91
    v_sin_f32 v91, v91
    v_exp_f32 v94, v94
    v_cos_f32 v96, v95
    v_sin_f32 v95, v95
    v_mul_f32 v40, v90, v92
    v_mul_f32 v42, v90, v91
    v_mul_f32 v41, v94, v96
    v_mul_f32 v43, v94, v95
    v_pk_mul_f32 v[90:91], v[34:35], v[50:51]
    v_pk_mul_f32 v[92:93], v[34:35], v[48:49]
    v_pk_fma_f32 v[54:55], v[32:33], v[50:51], v[92:93]
    v_pk_fma_f32 v[52:53], v[32:33], v[48:49], v[90:91] neg_lo:[0,0,1] neg_hi:[0,0,1]
    v_pk_mul_f32 v[90:91], v[54:55], v[50:51]
    v_pk_mul_f32 v[92:93], v[54:55], v[48:49]
    v_pk_fma_f32 v[66:67], v[52:53], v[50:51], v[92:93]
    v_pk_fma_f32 v[64:65], v[52:53], v[48:49], v[90:91] neg_lo:[0,0,1] neg_hi:[0,0,1]
    v_pk_mul_f32 v[90:91], v[54:55], v[46:47]
    v_pk_mul_f32 v[94:95], v[54:55], v[42:43]
    v_pk_mul_f32 v[92:93], v[54:55], v[44:45]
    v_pk_mul_f32 v[96:97], v[54:55], v[40:41]
    v_pk_fma_f32 v[62:63], v[52:53], v[46:47], v[92:93]
    v_pk_fma_f32 v[58:59], v[52:53], v[42:43], v[96:97]
    v_pk_fma_f32 v[60:61], v[52:53], v[44:45], v[90:91] neg_lo:[0,0,1] neg_hi:[0,0,1]
    v_pk_fma_f32 v[56:57], v[52:53], v[40:41], v[94:95] neg_lo:[0,0,1] neg_hi:[0,0,1]
    v_cvt_pk_f16_f32 v98, v52, v54
    v_cvt_pk_f16_f32 v99, v53, v55
    v_cvt_pk_f16_f32 v100, v60, v62
    v_cvt_pk_f16_f32 v101, v61, v63
    ds_write2_b64 v72, v[98:99], v[100:101] offset0:0 offset1:68
    v_pk_mul_f32 v[90:91], v[58:59], v[46:47]
    v_pk_mul_f32 v[94:95], v[58:59], v[42:43]
    v_pk_mul_f32 v[92:93], v[58:59], v[44:45]
    v_pk_mul_f32 v[96:97], v[58:59], v[40:41]
    v_pk_fma_f32 v[62:63], v[56:57], v[46:47], v[92:93]
    v_pk_fma_f32 v[54:55], v[56:57], v[42:43], v[96:97]
    v_pk_fma_f32 v[60:61], v[56:57], v[44:45], v[90:91] neg_lo:[0,0,1] neg_hi:[0,0,1]
    v_pk_fma_f32 v[52:53], v[56:57], v[40:41], v[94:95] neg_lo:[0,0,1] neg_hi:[0,0,1]
    v_cvt_pk_f16_f32 v76, v56, v58
    v_cvt_pk_f16_f32 v77, v57, v59
    v_cvt_pk_f16_f32 v78, v60, v62
    v_cvt_pk_f16_f32 v79, v61, v63
    ds_write2_b64 v72, v[76:77], v[78:79] offset0:136 offset1:204
    v_pk_mul_f32 v[90:91], v[54:55], v[46:47]
    v_pk_mul_f32 v[94:95], v[54:55], v[42:43]
    v_pk_mul_f32 v[92:93], v[54:55], v[44:45]
    v_pk_mul_f32 v[96:97], v[54:55], v[40:41]
    v_pk_fma_f32 v[62:63], v[52:53], v[46:47], v[92:93]
    v_pk_fma_f32 v[58:59], v[52:53], v[42:43], v[96:97]
    v_pk_fma_f32 v[60:61], v[52:53], v[44:45], v[90:91] neg_lo:[0,0,1] neg_hi:[0,0,1]
    v_pk_fma_f32 v[56:57], v[52:53], v[40:41], v[94:95] neg_lo:[0,0,1] neg_hi:[0,0,1]
    v_cvt_pk_f16_f32 v98, v52, v54
    v_cvt_pk_f16_f32 v99, v53, v55
    v_cvt_pk_f16_f32 v100, v60, v62
    v_cvt_pk_f16_f32 v101, v61, v63
    ds_write2_b64 v73, v[98:99], v[100:101] offset0:0 offset1:68
    v_pk_mul_f32 v[90:91], v[58:59], v[46:47]
    v_pk_mul_f32 v[94:95], v[42:43], v[42:43]
    v_pk_mul_f32 v[92:93], v[58:59], v[44:45]
    v_pk_mul_f32 v[96:97], v[40:41], v[42:43]
    v_pk_fma_f32 v[62:63], v[56:57], v[46:47], v[92:93]
    v_pk_fma_f32 v[48:49], v[40:41], v[40:41], v[94:95] neg_lo:[0,0,1] neg_hi:[0,0,1]
    v_pk_fma_f32 v[60:61], v[56:57], v[44:45], v[90:91] neg_lo:[0,0,1] neg_hi:[0,0,1]
    v_pk_add_f32 v[50:51], v[96:97], v[96:97]
    v_cvt_pk_f16_f32 v76, v56, v58
    v_cvt_pk_f16_f32 v77, v57, v59
    v_cvt_pk_f16_f32 v78, v60, v62
    v_cvt_pk_f16_f32 v79, v61, v63
    ds_write2_b64 v73, v[76:77], v[78:79] offset0:136 offset1:204
    v_pk_mul_f32 v[90:91], v[66:67], v[50:51]
    v_pk_mul_f32 v[94:95], v[66:67], v[46:47]
    v_pk_mul_f32 v[92:93], v[66:67], v[48:49]
    v_pk_mul_f32 v[96:97], v[66:67], v[44:45]
    v_pk_fma_f32 v[62:63], v[64:65], v[50:51], v[92:93]
    v_pk_fma_f32 v[54:55], v[64:65], v[46:47], v[96:97]
    v_pk_fma_f32 v[60:61], v[64:65], v[48:49], v[90:91] neg_lo:[0,0,1] neg_hi:[0,0,1]
    v_pk_fma_f32 v[52:53], v[64:65], v[44:45], v[94:95] neg_lo:[0,0,1] neg_hi:[0,0,1]
    v_cvt_pk_f16_f32 v98, v64, v66
    v_cvt_pk_f16_f32 v99, v65, v67
    v_cvt_pk_f16_f32 v100, v60, v62
    v_cvt_pk_f16_f32 v101, v61, v63
    ds_write2_b64 v74, v[98:99], v[100:101] offset0:0 offset1:68
    v_pk_mul_f32 v[90:91], v[54:55], v[50:51]
    v_pk_mul_f32 v[94:95], v[54:55], v[46:47]
    v_pk_mul_f32 v[92:93], v[54:55], v[48:49]
    v_pk_mul_f32 v[96:97], v[54:55], v[44:45]
    v_pk_fma_f32 v[62:63], v[52:53], v[50:51], v[92:93]
    v_pk_fma_f32 v[58:59], v[52:53], v[46:47], v[96:97]
    v_pk_fma_f32 v[60:61], v[52:53], v[48:49], v[90:91] neg_lo:[0,0,1] neg_hi:[0,0,1]
    v_pk_fma_f32 v[56:57], v[52:53], v[44:45], v[94:95] neg_lo:[0,0,1] neg_hi:[0,0,1]
    v_cvt_pk_f16_f32 v76, v52, v54
    v_cvt_pk_f16_f32 v77, v53, v55
    v_cvt_pk_f16_f32 v78, v60, v62
    v_cvt_pk_f16_f32 v79, v61, v63
    ds_write2_b64 v74, v[76:77], v[78:79] offset0:136 offset1:204
    v_pk_mul_f32 v[90:91], v[58:59], v[50:51]
    v_pk_mul_f32 v[94:95], v[58:59], v[46:47]
    v_pk_mul_f32 v[92:93], v[58:59], v[48:49]
    v_pk_mul_f32 v[96:97], v[58:59], v[44:45]
    v_pk_fma_f32 v[62:63], v[56:57], v[50:51], v[92:93]
    v_pk_fma_f32 v[54:55], v[56:57], v[46:47], v[96:97]
    v_pk_fma_f32 v[60:61], v[56:57], v[48:49], v[90:91] neg_lo:[0,0,1] neg_hi:[0,0,1]
    v_pk_fma_f32 v[52:53], v[56:57], v[44:45], v[94:95] neg_lo:[0,0,1] neg_hi:[0,0,1]
    v_cvt_pk_f16_f32 v98, v56, v58
    v_cvt_pk_f16_f32 v99, v57, v59
    v_cvt_pk_f16_f32 v100, v60, v62
    v_cvt_pk_f16_f32 v101, v61, v63
    ds_write2_b64 v75, v[98:99], v[100:101] offset0:0 offset1:68
    v_pk_mul_f32 v[90:91], v[54:55], v[50:51]
    v_pk_mul_f32 v[92:93], v[54:55], v[48:49]
    v_pk_fma_f32 v[62:63], v[52:53], v[50:51], v[92:93]
    v_pk_fma_f32 v[60:61], v[52:53], v[48:49], v[90:91] neg_lo:[0,0,1] neg_hi:[0,0,1]
    v_cvt_pk_f16_f32 v76, v52, v54
    v_cvt_pk_f16_f32 v77, v53, v55
    v_cvt_pk_f16_f32 v78, v60, v62
    v_cvt_pk_f16_f32 v79, v61, v63
    ds_write2_b64 v75, v[76:77], v[78:79] offset0:136 offset1:204
    s_branch JOBJ_19
JOB_18:
    v_mul_f32 v91, 0x41000000, v68
    v_mul_f32 v90, 0x41000000, v20
    v_mul_f32 v95, 0x41000000, v69
    v_mul_f32 v94, 0x41000000, v21
    v_fract_f32 v91, v91
    v_fract_f32 v95, v95
    v_fmac_f32 v91, 0x41000000, v70
    v_fmac_f32 v95, 0x41000000, v71
    v_exp_f32 v90, v90
    v_cos_f32 v92, v91
    v_sin_f32 v91, v91
    v_exp_f32 v94, v94
    v_cos_f32 v96, v95
    v_sin_f32 v95, v95
    v_mul_f32 v40, v90, v92
    v_mul_f32 v42, v90, -v91
    v_mul_f32 v41, v94, v96
    v_mul_f32 v43, v94, -v95
    v_mov_b32 v52, 0x47000000
    v_mov_b32 v53, 0x47000000
    v_mov_b32 v54, 0
    v_mov_b32 v55, 0
    v_pk_mul_f32 v[90:91], v[42:43], v[42:43]
    v_pk_mul_f32 v[60:61], v[40:41], v[52:53]
    v_pk_mul_f32 v[92:93], v[40:41], v[42:43]
    v_pk_mul_f32 v[62:63], v[42:43], v[52:53]
    v_pk_fma_f32 v[44:45], v[40:41], v[40:41], v[90:91] neg_lo:[0,0,1] neg_hi:[0,0,1]
    v_pk_add_f32 v[46:47], v[92:93], v[92:93]
    v_pk_mul_f32 v[56:57], v[44:45], v[52:53]
    v_pk_mul_f32 v[94:95], v[62:63], v[46:47]
    v_pk_mul_f32 v[58:59], v[46:47], v[52:53]
    v_pk_mul_f32 v[96:97], v[62:63], v[44:45]
    v_pk_fma_f32 v[66:67], v[60:61], v[46:47], v[96:97]
    v_pk_fma_f32 v[64:65], v[60:61], v[44:45], v[94:95] neg_lo:[0,0,1] neg_hi:[0,0,1]
    v_cvt_pk_f16_f32 v98, v52, v54
    v_cvt_pk_f16_f32 v99, v53, v55
    v_cvt_pk_f16_f32 v100, v60, v62
    v_cvt_pk_f16_f32 v101, v61, v63
    ds_write2_b64 v72, v[98:99], v[100:101] offset0:0 offset1:68
    v_pk_mul_f32 v[90:91], v[58:59], v[46:47]
    v_pk_mul_f32 v[94:95], v[66:67], v[46:47]
    v_pk_mul_f32 v[92:93], v[58:59], v[44:45]
    v_pk_mul_f32 v[96:97], v[66:67], v[44:45]
    v_pk_fma_f32 v[54:55], v[56:57], v[46:47], v[92:93]
    v_pk_fma_f32 v[62:63], v[64:65], v[46:47], v[96:97]
    v_pk_fma_f32 v[52:53], v[56:57], v[44:45], v[90:91] neg_lo:[0,0,1] neg_hi:[0,0,1]
    v_pk_fma_f32 v[60:61], v[64:65], v[44:45], v[94:95] neg_lo:[0,0,1] neg_hi:[0,0,1]
    v_cvt_pk_f16_f32 v76, v56, v58
    v_cvt_pk_f16_f32 v77, v57, v59
    v_cvt_pk_f16_f32 v78, v64, v66
    v_cvt_pk_f16_f32 v79, v65, v67
    ds_write2_b64 v72, v[76:77], v[78:79] offset0:136 offset1:204
    v_pk_mul_f32 v[90:91], v[54:55], v[46:47]
    v_pk_mul_f32 v[94:95], v[62:63], v[46:47]
    v_pk_mul_f32 v[92:93], v[54:55], v[44:45]
    v_pk_mul_f32 v[96:97], v[62:63], v[44:45]
    v_pk_fma_f32 v[58:59], v[52:53], v[46:47], v[92:93]
    v_pk_fma_f32 v[66:67], v[60:61], v[46:47], v[96:97]
    v_pk_fma_f32 v[56:57], v[52:53], v[44:45], v[90:91] neg_lo:[0,0,1] neg_hi:[0,0,1]
    v_pk_fma_f32 v[64:65], v[60:61], v[44:45], v[94:95] neg_lo:[0,0,1] neg_hi:[0,0,1]
    v_cvt_pk_f16_f32 v98, v52, v54
    v_cvt_pk_f16_f32 v99, v53, v55
    v_cvt_pk_f16_f32 v100, v60, v62
    v_cvt_pk_f16_f32 v101, v61, v63
    ds_write2_b64 v73, v[98:99], v[100:101] offset0:0 offset1:68
    v_pk_mul_f32 v[90:91], v[58:59], v[46:47]
    v_pk_mul_f32 v[94:95], v[66:67], v[46:47]
    v_pk_mul_f32 v[92:93], v[58:59], v[44:45]
    v_pk_mul_f32 v[96:97], v[66:67], v[44:45]
    v_pk_fma_f32 v[54:55], v[56:57], v[46:47], v[92:93]
    v_pk_fma_f32 v[62:63], v[64:65], v[46:47], v[96:97]
    v_pk_fma_f32 v[52:53], v[56:57], v[44:45], v[90:91] neg_lo:[0,0,1] neg_hi:[0,0,1]
    v_pk_fma_f32 v[60:61], v[64:65], v[44:45], v[94:95] neg_lo:[0,0,1] neg_hi:[0,0,1]
    v_cvt_pk_f16_f32 v76, v56, v58
    v_cvt_pk_f16_f32 v77, v57, v59
    v_cvt_pk_f16_f32 v78, v64, v66
    v_cvt_pk_f16_f32 v79, v65, v67
    ds_write2_b64 v73, v[76:77], v[78:79] offset0:136 offset1:204
    v_pk_mul_f32 v[90:91], v[54:55], v[46:47]
    v_pk_mul_f32 v[94:95], v[62:63], v[46:47]
    v_pk_mul_f32 v[92:93], v[54:55], v[44:45]
    v_pk_mul_f32 v[96:97], v[62:63], v[44:45]
    v_pk_fma_f32 v[58:59], v[52:53], v[46:47], v[92:93]
    v_pk_fma_f32 v[66:67], v[60:61], v[46:47], v[96:97]
    v_pk_fma_f32 v[56:57], v[52:53], v[44:45], v[90:91] neg_lo:[0,0,1] neg_hi:[0,0,1]
    v_pk_fma_f32 v[64:65], v[60:61], v[44:45], v[94:95] neg_lo:[0,0,1] neg_hi:[0,0,1]
    v_cvt_pk_f16_f32 v98, v52, v54
    v_cvt_pk_f16_f32 v99, v53, v55
    v_cvt_pk_f16_f32 v100, v60, v62
    v_cvt_pk_f16_f32 v101, v61, v63
    ds_write2_b64 v74, v[98:99], v[100:101] offset0:0 offset1:68
    v_pk_mul_f32 v[90:91], v[58:59], v[46:47]
    v_pk_mul_f32 v[94:95], v[66:67], v[46:47]
    v_pk_mul_f32 v[92:93], v[58:59], v[44:45]
    v_pk_mul_f32 v[96:97], v[66:67], v[44:45]
    v_pk_fma_f32 v[54:55], v[56:57], v[46:47], v[92:93]
    v_pk_fma_f32 v[62:63], v[64:65], v[46:47], v[96:97]
    v_pk_fma_f32 v[52:53], v[56:57], v[44:45], v[90:91] neg_lo:[0,0,1] neg_hi:[0,0,1]
    v_pk_fma_f32 v[60:61], v[64:65], v[44:45], v[94:95] neg_lo:[0,0,1] neg_hi:[0,0,1]
    v_cvt_pk_f16_f32 v76, v56, v58
    v_cvt_pk_f16_f32 v77, v57, v59
    v_cvt_pk_f16_f32 v78, v64, v66
    v_cvt_pk_f16_f32 v79, v65, v67
    ds_write2_b64 v74, v[76:77], v[78:79] offset0:136 offset1:204
    v_pk_mul_f32 v[90:91], v[54:55], v[46:47]
    v_pk_mul_f32 v[94:95], v[62:63], v[46:47]
    v_pk_mul_f32 v[92:93], v[54:55], v[44:45]
    v_pk_mul_f32 v[96:97], v[62:63], v[44:45]
    v_pk_fma_f32 v[58:59], v[52:53], v[46:47], v[92:93]
    v_pk_fma_f32 v[66:67], v[60:61], v[46:47], v[96:97]
    v_pk_fma_f32 v[56:57], v[52:53], v[44:45], v[90:91] neg_lo:[0,0,1] neg_hi:[0,0,1]
    v_pk_fma_f32 v[64:65], v[60:61], v[44:45], v[94:95] neg_lo:[0,0,1] neg_hi:[0,0,1]
    v_cvt_pk_f16_f32 v98, v52, v54
    v_cvt_pk_f16_f32 v99, v53, v55
    v_cvt_pk_f16_f32 v100, v60, v62
    v_cvt_pk_f16_f32 v101, v61, v63
    ds_write2_b64 v75, v[98:99], v[100:101] offset0:0 offset1:68
    v_cvt_pk_f16_f32 v76, v56, v58
    v_cvt_pk_f16_f32 v77, v57, v59
    v_cvt_pk_f16_f32 v78, v64, v66
    v_cvt_pk_f16_f32 v79, v65, v67
    ds_write2_b64 v75, v[76:77], v[78:79] offset0:136 offset1:204
    ds_write_b8 v15, v5 offset:64
    s_cmp_eq_u32 s87, 2
    s_cbranch_scc1 KS_G0
KS_R3:
    ds_write_b8 v15, v5 offset:68
W_20:
    s_sleep 2
    ds_read_u16 v20, v14 offset:68
    s_sub_u32 s39, s39, 1
    s_cbranch_scc1 KS_ABORT
    s_waitcnt lgkmcnt(0)
    v_cmp_eq_u32 vcc, 0, v20
    s_cbranch_vccnz W_20
    s_branch EXP_13
KC_SEND:
W_21:
    ds_read_b32 v104, v105 offset:224
    s_sub_u32 s39, s39, 1
    s_cbranch_scc1 KS_ABORT
    s_waitcnt lgkmcnt(0)
    v_cmp_eq_u32 vcc, 0, v104
    s_cbranch_vccnz W_21
    s_lshl_b32 s92, s88, 12
    s_lshl_b32 s93, s86, 10
    s_add_u32 s92, s92, s93
    s_add_u32 s92, s92, 0x920000
    v_add_u32 v24, s92, v12
    s_mov_b32 s93, 0xffff
    v_lshlrev_b32 v25, 16, v104
    v_cvt_f16_f32 v20, v20
    v_cvt_f16_f32 v21, v21
    v_cvt_f16_f32 v22, v22
    v_cvt_f16_f32 v23, v23
    s_cmp_lg_u32 s86, 2
    s_cbranch_scc1 KC_S2
    s_mov_b32 exec_lo, 0
    s_mov_b32 exec_hi, 0xffff0000
    v_mov_b32 v20, v106
    v_lshrrev_b32 v21, 16, v106
    s_mov_b64 exec, -1
KC_S2:
    v_bfi_b32 v20, s93, v20, v104
    v_bfi_b32 v21, s93, v21, v25
    v_bfi_b32 v22, s93, v22, v104
    v_bfi_b32 v23, s93, v23, v25
    global_store_dwordx4 v24, v[20:23], s[36:37] sc1
    s_branch KS_G0
KC_RECV:
    s_cmp_eq_u32 s86, 3
    s_cbranch_scc1 KS_R3
    s_lshl_b32 s92, s88, 12
    s_lshl_b32 s93, s86, 10
    s_add_u32 s92, s92, s93
    s_add_u32 s92, s92, 0x920000
    v_add_u32 v24, s92, v12
W_22:
    s_sleep 2
    ds_read_b32 v104, v105 offset:224
    s_sub_u32 s39, s39, 1
    s_cbranch_scc1 KS_ABORT
    s_waitcnt lgkmcnt(0)
    v_cmp_eq_u32 vcc, 0, v104
    s_cbranch_vccnz W_22
    v_lshlrev_b32 v25, 16, v104
W_23:
    s_sleep 2
    ds_read_b32 v17, v4 offset:72
    s_sub_u32 s39, s39, 1
    s_cbranch_scc1 KS_ABORT
    s_waitcnt lgkmcnt(0)
    v_cmp_ne_u32 vcc, s84, v17
    s_cbranch_vccnz W_23
    s_sleep 8
    s_branch KPE_25
KP_24:
    s_sleep 2
KPE_25:
    global_load_dwordx4 v[20:23], v24, s[36:37] sc1
    s_sub_u32 s39, s39, 1
    s_cbranch_scc1 KS_ABORT
    s_waitcnt vmcnt(0)
    v_xor_b32 v20, v104, v20
    v_xor_b32 v21, v25, v21
    v_xor_b32 v22, v104, v22
    v_xor_b32 v23, v25, v23
    v_or3_b32 v26, v20, v21, v22
    v_or_b32 v26, v26, v23
    v_cmp_lt_u32 vcc, 0xffff, v26
    s_cbranch_vccnz KP_24
    v_xor_b32 v20, v104, v20
    v_xor_b32 v22, v104, v22
    ds_write_b16 v108, v20
    ds_write_b16 v109, v21
    ds_write_b16 v112, v22
    ds_write_b16 v113, v23
    s_cmp_lg_u32 s86, 2
    s_cbranch_scc1 EXP_13
    v_and_b32 v20, 0xffff, v20
    v_lshl_or_b32 v20, v21, 16, v20
    v_lshlrev_b32 v21, 16, v107
    s_mov_b32 exec_lo, 0
    s_mov_b32 exec_hi, 0x10000
    ds_write_b64 v14, v[20:21] offset:832
    s_mov_b64 exec, -1
    s_branch EXP_13
JOB_17:
    v_mul_f32 v91, 0x43000000, v68
    v_mul_f32 v90, 0x43000000, v20
    v_mul_f32 v95, 0x43000000, v69
    v_mul_f32 v94, 0x43000000, v21
    v_fract_f32 v91, v91
    v_fract_f32 v95, v95
    v_fmac_f32 v91, 0x43000000, v70
    v_fmac_f32 v95, 0x43000000, v71
    v_exp_f32 v90, v90
    v_cos_f32 v92, v91
    v_sin_f32 v91, v91
    v_exp_f32 v94, v94
    v_cos_f32 v96, v95
    v_sin_f32 v95, v95
    v_mul_f32 v44, v90, v92
    v_mul_f32 v46, v90, v91
    v_mul_f32 v45, v94, v96
    v_mul_f32 v47, v94, v95
    v_pk_mul_f32 v[32:33], v[32:33], s[16:17] op_sel_hi:[1,0]
    v_pk_mul_f32 v[34:35], v[34:35], s[16:17] op_sel_hi:[1,0]
    v_pk_mul_f32 v[90:91], v[46:47], v[46:47]
    v_pk_mul_f32 v[94:95], v[34:35], v[46:47]
    v_pk_mul_f32 v[92:93], v[44:45], v[46:47]
    v_pk_mul_f32 v[96:97], v[34:35], v[44:45]
    v_pk_fma_f32 v[40:41], v[44:45], v[44:45], v[90:91] neg_lo:[0,0,1] neg_hi:[0,0,1]
    v_pk_fma_f32 v[66:67], v[32:33], v[46:47], v[96:97]
    v_pk_add_f32 v[42:43], v[92:93], v[92:93]
    v_pk_fma_f32 v[64:65], v[32:33], v[44:45], v[94:95] neg_lo:[0,0,1] neg_hi:[0,0,1]
    v_pk_mul_f32 v[90:91], v[42:43], v[42:43]
    v_pk_mul_f32 v[92:93], v[40:41], v[42:43]
    v_pk_fma_f32 v[48:49], v[40:41], v[40:41], v[90:91] neg_lo:[0,0,1] neg_hi:[0,0,1]
    v_pk_add_f32 v[50:51], v[92:93], v[92:93]
    v_pk_mul_f32 v[90:91], v[50:51], v[50:51]
    v_pk_mul_f32 v[92:93], v[48:49], v[50:51]
    v_pk_fma_f32 v[48:49], v[48:49], v[48:49], v[90:91] neg_lo:[0,0,1] neg_hi:[0,0,1]
    v_pk_add_f32 v[50:51], v[92:93], v[92:93]
    v_pk_mul_f32 v[90:91], v[34:35], v[50:51]
    v_pk_mul_f32 v[94:95], v[66:67], v[50:51]
    v_pk_mul_f32 v[92:93], v[34:35], v[48:49]
    v_pk_mul_f32 v[96:97], v[66:67], v[48:49]
    v_pk_fma_f32 v[54:55], v[32:33], v[50:51], v[92:93]
    v_pk_fma_f32 v[62:63], v[64:65], v[50:51], v[96:97]
    v_pk_fma_f32 v[52:53], v[32:33], v[48:49], v[90:91] neg_lo:[0,0,1] neg_hi:[0,0,1]
    v_pk_fma_f32 v[60:61], v[64:65], v[48:49], v[94:95] neg_lo:[0,0,1] neg_hi:[0,0,1]
    v_pk_mul_f32 v[90:91], v[54:55], v[42:43]
    v_pk_mul_f32 v[94:95], v[62:63], v[42:43]
    v_pk_mul_f32 v[92:93], v[54:55], v[40:41]
    v_pk_mul_f32 v[96:97], v[62:63], v[40:41]
    v_pk_fma_f32 v[58:59], v[52:53], v[42:43], v[92:93]
    v_pk_fma_f32 v[66:67], v[60:61], v[42:43], v[96:97]
    v_pk_fma_f32 v[56:57], v[52:53], v[40:41], v[90:91] neg_lo:[0,0,1] neg_hi:[0,0,1]
    v_pk_fma_f32 v[64:65], v[60:61], v[40:41], v[94:95] neg_lo:[0,0,1] neg_hi:[0,0,1]
    v_cvt_pk_f16_f32 v98, v52, v54
    v_cvt_pk_f16_f32 v99, v53, v55
    v_cvt_pk_f16_f32 v100, v60, v62
    v_cvt_pk_f16_f32 v101, v61, v63
    ds_write2_b64 v72, v[98:99], v[100:101] offset0:0 offset1:68
    v_pk_mul_f32 v[90:91], v[58:59], v[42:43]
    v_pk_mul_f32 v[94:95], v[66:67], v[42:43]
    v_pk_mul_f32 v[92:93], v[58:59], v[40:41]
    v_pk_mul_f32 v[96:97], v[66:67], v[40:41]
    v_pk_fma_f32 v[54:55], v[56:57], v[42:43], v[92:93]
    v_pk_fma_f32 v[62:63], v[64:65], v[42:43], v[96:97]
    v_pk_fma_f32 v[52:53], v[56:57], v[40:41], v[90:91] neg_lo:[0,0,1] neg_hi:[0,0,1]
    v_pk_fma_f32 v[60:61], v[64:65], v[40:41], v[94:95] neg_lo:[0,0,1] neg_hi:[0,0,1]
    v_cvt_pk_f16_f32 v76, v56, v58
    v_cvt_pk_f16_f32 v77, v57, v59
    v_cvt_pk_f16_f32 v78, v64, v66
    v_cvt_pk_f16_f32 v79, v65, v67
    ds_write2_b64 v72, v[76:77], v[78:79] offset0:136 offset1:204
    v_pk_mul_f32 v[90:91], v[54:55], v[42:43]
    v_pk_mul_f32 v[94:95], v[62:63], v[42:43]
    v_pk_mul_f32 v[92:93], v[54:55], v[40:41]
    v_pk_mul_f32 v[96:97], v[62:63], v[40:41]
    v_pk_fma_f32 v[58:59], v[52:53], v[42:43], v[92:93]
    v_pk_fma_f32 v[66:67], v[60:61], v[42:43], v[96:97]
    v_pk_fma_f32 v[56:57], v[52:53], v[40:41], v[90:91] neg_lo:[0,0,1] neg_hi:[0,0,1]
    v_pk_fma_f32 v[64:65], v[60:61], v[40:41], v[94:95] neg_lo:[0,0,1] neg_hi:[0,0,1]
    v_cvt_pk_f16_f32 v98, v52, v54
    v_cvt_pk_f16_f32 v99, v53, v55
    v_cvt_pk_f16_f32 v100, v60, v62
    v_cvt_pk_f16_f32 v101, v61, v63
    ds_write2_b64 v73, v[98:99], v[100:101] offset0:0 offset1:68
    v_pk_mul_f32 v[90:91], v[58:59], v[42:43]
    v_pk_mul_f32 v[92:93], v[58:59], v[40:41]
    v_pk_fma_f32 v[54:55], v[56:57], v[42:43], v[92:93]
    v_pk_fma_f32 v[52:53], v[56:57], v[40:41], v[90:91] neg_lo:[0,0,1] neg_hi:[0,0,1]
    v_cvt_pk_f16_f32 v76, v56, v58
    v_cvt_pk_f16_f32 v77, v57, v59
    v_cvt_pk_f16_f32 v78, v64, v66
    v_cvt_pk_f16_f32 v79, v65, v67
    ds_write2_b64 v73, v[76:77], v[78:79] offset0:136 offset1:204
    v_cvt_pk_f16_f32 v98, v52, v54
    v_cvt_pk_f16_f32 v99, v53, v55
    v_mov_b32 v36, 0x4538aa3b
    v_mul_f32 v24, s14, v36
    v_max_f32 v24, 0, v24
    v_ceil_f32 v24, v24
    v_cvt_i32_f32 v24, v24
    ds_write_b64 v74, v[98:99] offset:0
    s_sub_u32 s11, s15, 7
    s_lshl_b32 s11, s11, 23
    v_lshlrev_b32 v25, 16, v107
    v_ldexp_f32 v24, s11, v24
    v_mov_b32 v106, v24
    ds_write_b64 v14, v[24:25] offset:832
JOBJ_19:
    ds_write_b8 v15, v5 offset:64
    ds_read_b128 v[40:43], v127 offset:0
    ds_read_b128 v[44:47], v127 offset:64
    ds_read_b128 v[48:51], v127 offset:128
    ds_read_b128 v[52:55], v127 offset:192
    ds_read_b128 v[56:59], v127 offset:256
    ds_read_b128 v[60:63], v127 offset:320
    ds_read_b128 v[64:67], v127 offset:384
    ds_read_b128 v[68:71], v127 offset:448
    v_mov_b32 v36, 0x3fb8aa3b
    v_mul_f32 v36, s14, v36
    v_mul_f32 v37, 0x45000000, v36
    v_max_f32 v37, 0, v37
    v_ceil_f32 v37, v37
    v_add_f32 v37, 0x41b80000, v37
    v_fma_f32 v110, v110, v36, -v37
    v_fma_f32 v111, v111, v36, -v37
    v_fma_f32 v114, v114, v36, -v37
    v_fma_f32 v115, v115, v36, -v37
    v_exp_f32 v110, v110
    v_exp_f32 v111, v111
    v_exp_f32 v114, v114
    v_exp_f32 v115, v115
W_27:
    ds_read_u8 v17, v14 offset:67
    s_sub_u32 s39, s39, 1
    s_cbranch_scc1 KS_ABORT
    s_waitcnt lgkmcnt(0)
    v_cmp_eq_u32 vcc, 0, v17
    s_cbranch_vccnz W_27
    ds_read_b128 v[72:75], v126 offset:22304
    ds_read_b128 v[76:79], v126 offset:22368
    ds_read_b128 v[80:83], v126 offset:22432
    ds_read_b128 v[84:87], v126 offset:22496
    ds_read_b128 v[88:91], v126 offset:22560
    ds_read_b128 v[92:95], v126 offset:22624
    ds_read_b128 v[96:99], v126 offset:22688
    ds_read_b128 v[100:103], v126 offset:22752
    s_waitcnt lgkmcnt(7)
    v_mfma_f32_16x16x32_f16 v[20:23], v[40:43], v[72:75], 0
    s_waitcnt lgkmcnt(6)
    v_mfma_f32_16x16x32_f16 v[24:27], v[44:47], v[76:79], 0
    s_waitcnt lgkmcnt(5)
    v_mfma_f32_16x16x32_f16 v[20:23], v[48:51], v[80:83], v[20:23]
    s_waitcnt lgkmcnt(4)
    v_mfma_f32_16x16x32_f16 v[24:27], v[52:55], v[84:87], v[24:27]
    s_waitcnt lgkmcnt(3)
    v_mfma_f32_16x16x32_f16 v[20:23], v[56:59], v[88:91], v[20:23]
    s_waitcnt lgkmcnt(2)
    v_mfma_f32_16x16x32_f16 v[24:27], v[60:63], v[92:95], v[24:27]
    s_waitcnt lgkmcnt(1)
    v_mfma_f32_16x16x32_f16 v[20:23], v[64:67], v[96:99], v[20:23]
    s_waitcnt lgkmcnt(0)
    v_mfma_f32_16x16x32_f16 v[24:27], v[68:71], v[100:103], v[24:27]
    s_nop 7
    v_add_f32 v20, v20, v24
    v_add_f32 v21, v21, v25
    v_add_f32 v22, v22, v26
    v_add_f32 v23, v23, v27
    v_mul_f32 v20, v20, v110
    v_mul_f32 v21, v21, v111
    v_mul_f32 v22, v22, v114
    v_mul_f32 v23, v23, v115
    s_cmp_eq_u32 s87, 2
    s_cbranch_scc1 KC_SEND
    v_cvt_f16_f32 v20, v20
    ds_write_b16 v108, v20
    v_cvt_f16_f32 v21, v21
    ds_write_b16 v109, v21
    v_cvt_f16_f32 v22, v22
    ds_write_b16 v112, v22
    v_cvt_f16_f32 v23, v23
    ds_write_b16 v113, v23
EXP_13:
    ds_write_b8 v15, v5 offset:68
    v_mov_b32 v28, 0
    v_mov_b32 v29, 0
    v_mov_b32 v30, 0
    v_mov_b32 v31, 0
    v_mov_b32 v32, s85
    s_waitcnt vmcnt(0)
W_29:
    ds_read_b32 v20, v14 offset:68
    s_sub_u32 s39, s39, 1
    s_cbranch_scc1 KS_ABORT
    s_waitcnt lgkmcnt(0)
    v_cmp_ne_u32 vcc, s84, v20
    s_cbranch_vccnz W_29
    ds_read_u16 v20, v116
    ds_read_u16 v21, v117
    ds_read_u16 v22, v118
    ds_read_u16 v23, v120
    ds_read_u16 v24, v121
    ds_read_u16 v25, v122
    ds_read_u16 v26, v123
    s_mov_b64 exec, 1
    ds_write_b128 v32, v[28:31] offset:3088
    ds_write_b128 v32, v[28:31] offset:8224
    ds_write_b128 v32, v[28:31] offset:3072
    s_mov_b64 exec, -1
    s_waitcnt lgkmcnt(7)
    v_lshl_or_b32 v28, v21, 16, v20
    v_lshl_or_b32 v29, v22, 16, v21
    ds_write_b32 v124, v28 offset:32528
    ds_write_b32 v124, v29 offset:33872
    ds_write_b32 v124, v28 offset:27284
    ds_write_b32 v124, v29 offset:28628
    s_waitcnt lgkmcnt(7)
    v_lshl_or_b32 v30, v24, 16, v23
    v_lshl_or_b32 v31, v26, 16, v25
    ds_write_b32 v119, v30
    ds_write_b32 v125, v31
    ds_write_b32 v119, v30 offset:5244
    ds_write_b32 v125, v31 offset:5244
    ds_write_b8 v15, v5 offset:72
    v_lshlrev_b32 v7, 3, v3
    v_sub_u32 v7, v8, v7
    v_lshrrev_b32 v19, 2, v2
    v_lshl_add_u32 v19, v19, 2, v3
    v_and_b32 v18, 3, v2
    v_mul_u32_u24 v19, s8, v19
    v_xor_b32 v19, s10, v19
    v_lshl_add_u32 v19, v18, 4, v19
    v_xor_b32 v12, s9, v12
W_30:
    ds_read_b32 v20, v14 offset:72
    s_sub_u32 s39, s39, 1
    s_cbranch_scc1 KS_ABORT
    s_waitcnt lgkmcnt(0)
    v_cmp_ne_u32 vcc, s84, v20
    s_cbranch_vccnz W_30
    ds_read_b64 v[16:17], v14 offset:832
    s_cmp_eq_u32 s86, 1
    s_cbranch_scc1 CV_32
    s_cmp_eq_u32 s86, 2
    s_cbranch_scc1 CV_33
    s_cmp_eq_u32 s86, 3
    s_cbranch_scc1 CV_34
    ds_read_b64 v[32:33], v6 offset:576
    ds_read_b64 v[34:35], v6 offset:584
    ds_read_b64 v[36:37], v6 offset:64
    ds_read_b64 v[38:39], v6 offset:72
    ds_read_b64 v[40:41], v6 offset:640
    ds_read_b64 v[42:43], v6 offset:648
    ds_read_b64 v[44:45], v6 offset:128
    ds_read_b64 v[46:47], v6 offset:136
    ds_read_b64 v[48:49], v6 offset:704
    ds_read_b64 v[50:51], v6 offset:712
    ds_read_b64 v[52:53], v6 offset:192
    ds_read_b64 v[54:55], v6 offset:200
    ds_read_b64 v[56:57], v6 offset:768
    ds_read_b64 v[58:59], v6 offset:776
    ds_read_b64 v[60:61], v6 offset:256
    ds_read_b64 v[62:63], v6 offset:264
    ds_read_b64 v[64:65], v6 offset:832
    ds_read_b64 v[66:67], v6 offset:840
    ds_read_b64 v[68:69], v6 offset:320
    ds_read_b64 v[70:71], v6 offset:328
    ds_read_b64 v[72:73], v6 offset:896
    ds_read_b64 v[74:75], v6 offset:904
    ds_read_b64 v[76:77], v6 offset:384
    ds_read_b64 v[78:79], v6 offset:392
    ds_read_b64 v[80:81], v6 offset:960
    ds_read_b64 v[82:83], v6 offset:968
    ds_read_b64 v[84:85], v6 offset:448
    ds_read_b64 v[86:87], v6 offset:456
    ds_read_b64 v[88:89], v6 offset:1024
    ds_read_b64 v[90:91], v6 offset:1032
    ds_read_b64 v[92:93], v6 offset:512
    ds_read_b64 v[94:95], v6 offset:520
    ds_read_b32 v18, v4 offset:16
    ds_read_b128 v[96:99], v8 offset:0
    ds_read_b128 v[100:103], v8 offset:64
    ds_read_b128 v[104:107], v8 offset:128
    ds_read_b128 v[108:111], v8 offset:192
    s_waitcnt lgkmcnt(4)
    v_cmp_ne_u32 vcc, s84, v18
    s_cbranch_vccnz US_36
UB_37:
    s_setprio 1
    s_waitcnt lgkmcnt(3)
    v_mfma_f32_16x16x32_f16 v[20:23], v[32:35], v[96:99], 0
    v_mov_b32 v6, v19
    v_mfma_f32_16x16x32_f16 v[24:27], v[36:39], v[96:99], 0
    ds_read_b128 v[112:115], v8 offset:256
    s_waitcnt lgkmcnt(3)
    v_mfma_f32_16x16x32_f16 v[20:23], v[40:43], v[100:103], v[20:23]
    ds_read_b64 v[28:29], v7 offset:480
    ds_read_b64 v[30:31], v7 offset:992
    v_mfma_f32_16x16x32_f16 v[24:27], v[44:47], v[100:103], v[24:27]
    ds_read_b128 v[116:119], v8 offset:320
    s_waitcnt lgkmcnt(5)
    v_mfma_f32_16x16x32_f16 v[20:23], v[48:51], v[104:107], v[20:23]
    v_mfma_f32_16x16x32_f16 v[24:27], v[52:55], v[104:107], v[24:27]
    ds_read_b128 v[120:123], v8 offset:384
    s_waitcnt lgkmcnt(2)
    v_fma_mix_f32 v104, v28, v17, 0 op_sel_hi:[1,0,0]
    v_fma_mix_f32 v105, v28, v17, 0 op_sel:[1,0,0] op_sel_hi:[1,0,0]
    v_mfma_f32_16x16x32_f16 v[20:23], v[56:59], v[108:111], v[20:23]
    v_fma_mix_f32 v106, v29, v17, 0 op_sel_hi:[1,0,0]
    v_fma_mix_f32 v107, v29, v17, 0 op_sel:[1,0,0] op_sel_hi:[1,0,0]
    v_mfma_f32_16x16x32_f16 v[24:27], v[60:63], v[108:111], v[24:27]
    ds_read_b128 v[124:127], v8 offset:448
    v_cvt_pk_bf16_f32 v104, 0, v104
    v_cvt_pk_bf16_f32 v105, 0, v105
    v_mfma_f32_16x16x32_f16 v[20:23], v[64:67], v[112:115], v[20:23]
    v_cvt_pk_bf16_f32 v106, 0, v106
    v_cvt_pk_bf16_f32 v107, 0, v107
    v_mfma_f32_16x16x32_f16 v[24:27], v[68:71], v[112:115], v[24:27]
    ds_read_b128 v[36:39], v8 offset:512
    v_fma_mix_f32 v112, v30, v17, 0 op_sel_hi:[1,0,0]
    v_fma_mix_f32 v113, v30, v17, 0 op_sel:[1,0,0] op_sel_hi:[1,0,0]
    s_waitcnt lgkmcnt(3)
    v_mfma_f32_16x16x32_f16 v[20:23], v[72:75], v[116:119], v[20:23]
    ds_read_b128 v[96:99], v8 offset:576
    v_fma_mix_f32 v114, v31, v17, 0 op_sel_hi:[1,0,0]
    v_fma_mix_f32 v115, v31, v17, 0 op_sel:[1,0,0] op_sel_hi:[1,0,0]
    v_mfma_f32_16x16x32_f16 v[24:27], v[76:79], v[116:119], v[24:27]
    ds_read_b128 v[44:47], v8 offset:640
    v_cvt_pk_bf16_f32 v112, 0, v112
    v_cvt_pk_bf16_f32 v113, 0, v113
    s_waitcnt lgkmcnt(4)
    v_mfma_f32_16x16x32_f16 v[20:23], v[80:83], v[120:123], v[20:23]
    ds_read_b128 v[100:103], v8 offset:704
    v_cvt_pk_bf16_f32 v114, 0, v114
    v_cvt_pk_bf16_f32 v115, 0, v115
    v_mfma_f32_16x16x32_f16 v[24:27], v[84:87], v[120:123], v[24:27]
    ds_read_b128 v[52:55], v8 offset:768
    s_waitcnt lgkmcnt(5)
    v_mfma_f32_16x16x32_f16 v[20:23], v[88:91], v[124:127], v[20:23]
    ds_read_b128 v[60:63], v8 offset:832
    v_mfma_f32_16x16x32_f16 v[24:27], v[92:95], v[124:127], v[24:27]
    ds_read_b128 v[108:111], v8 offset:896
    s_waitcnt lgkmcnt(6)
    v_mfma_f32_16x16x32_f16 v[24:27], v[32:35], v[36:39], v[24:27]
    ds_read_b128 v[68:71], v8 offset:960
    s_nop 1
    v_cvt_pk_bf16_f32 v20, 0, v20
    v_cvt_pk_bf16_f32 v21, 0, v21
    s_waitcnt lgkmcnt(6)
    v_mfma_f32_16x16x32_f16 v[24:27], v[40:43], v[96:99], v[24:27]
    v_cvt_pk_bf16_f32 v22, 0, v22
    v_cvt_pk_bf16_f32 v23, 0, v23
    s_waitcnt lgkmcnt(5)
    v_mfma_f32_16x16x32_f16 v[24:27], v[48:51], v[44:47], v[24:27]
    v_fma_f32 v20, v20, v16, v104
    v_fma_f32 v21, v21, v16, v105
    s_waitcnt lgkmcnt(4)
    v_mfma_f32_16x16x32_f16 v[24:27], v[56:59], v[100:103], v[24:27]
    v_fma_f32 v22, v22, v16, v106
    v_fma_f32 v23, v23, v16, v107
    s_waitcnt lgkmcnt(3)
    v_mfma_f32_16x16x32_f16 v[24:27], v[64:67], v[52:55], v[24:27]
    v_cvt_pk_bf16_f32 v28, v20, v21
    v_cvt_pk_bf16_f32 v29, v22, v23
    s_waitcnt lgkmcnt(2)
    v_mfma_f32_16x16x32_f16 v[24:27], v[72:75], v[60:63], v[24:27]
    v_min_u32 v28, -2, v28
    v_min_u32 v29, -2, v29
    s_waitcnt lgkmcnt(1)
    v_mfma_f32_16x16x32_f16 v[24:27], v[80:83], v[108:111], v[24:27]
    s_waitcnt lgkmcnt(0)
    v_mfma_f32_16x16x32_f16 v[24:27], v[88:91], v[68:71], v[24:27]
    ds_read_u8 v18, v14 offset:112
    ds_read_b128 v[20:23], v12 offset:46592
    s_nop 5
    v_cvt_pk_bf16_f32 v24, 0, v24
    v_cvt_pk_bf16_f32 v25, 0, v25
    v_cvt_pk_bf16_f32 v26, 0, v26
    v_cvt_pk_bf16_f32 v27, 0, v27
    v_fma_f32 v24, v24, v16, v112
    v_fma_f32 v25, v25, v16, v113
    v_fma_f32 v26, v26, v16, v114
    v_fma_f32 v27, v27, v16, v115
    v_cvt_pk_bf16_f32 v30, v24, v25
    v_cvt_pk_bf16_f32 v31, v26, v27
    v_min_u32 v30, -2, v30
    v_min_u32 v31, -2, v31
    s_branch CVE_35
CV_32:
    ds_read_b64 v[32:33], v6 offset:0
    ds_read_b64 v[34:35], v6 offset:8
    ds_read_b64 v[36:37], v6 offset:64
    ds_read_b64 v[38:39], v6 offset:72
    ds_read_b64 v[40:41], v6 offset:128
    ds_read_b64 v[42:43], v6 offset:136
    ds_read_b64 v[44:45], v6 offset:192
    ds_read_b64 v[46:47], v6 offset:200
    ds_read_b64 v[48:49], v6 offset:256
    ds_read_b64 v[50:51], v6 offset:264
    ds_read_b64 v[52:53], v6 offset:320
    ds_read_b64 v[54:55], v6 offset:328
    ds_read_b64 v[56:57], v6 offset:384
    ds_read_b64 v[58:59], v6 offset:392
    ds_read_b64 v[60:61], v6 offset:448
    ds_read_b64 v[62:63], v6 offset:456
    ds_read_b64 v[64:65], v6 offset:512
    ds_read_b64 v[66:67], v6 offset:520
    ds_read_b64 v[68:69], v6 offset:576
    ds_read_b64 v[70:71], v6 offset:584
    ds_read_b64 v[72:73], v6 offset:640
    ds_read_b64 v[74:75], v6 offset:648
    ds_read_b64 v[76:77], v6 offset:704
    ds_read_b64 v[78:79], v6 offset:712
    ds_read_b64 v[80:81], v6 offset:768
    ds_read_b64 v[82:83], v6 offset:776
    ds_read_b64 v[84:85], v6 offset:832
    ds_read_b64 v[86:87], v6 offset:840
    ds_read_b64 v[88:89], v6 offset:896
    ds_read_b64 v[90:91], v6 offset:904
    ds_read_b64 v[92:93], v6 offset:960
    ds_read_b64 v[94:95], v6 offset:968
    ds_read_b64 v[96:97], v6 offset:1024
    ds_read_b64 v[98:99], v6 offset:1032
    ds_read_b64 v[100:101], v11 offset:128
    ds_read_b64 v[102:103], v11 offset:136
    ds_read_b64 v[104:105], v11 offset:384
    ds_read_b64 v[106:107], v11 offset:392
    ds_read_b32 v18, v4 offset:16
    ds_read_b128 v[108:111], v8 offset:448
    ds_read_b128 v[112:115], v8 offset:512
    ds_read_b128 v[116:119], v8 offset:576
    ds_read_b128 v[120:123], v8 offset:640
    ds_read_b128 v[124:127], v8 offset:704
    s_waitcnt lgkmcnt(5)
    v_cmp_ne_u32 vcc, s84, v18
    s_cbranch_vccnz US_38
UB_39:
    s_setprio 1
    s_waitcnt lgkmcnt(4)
    v_mfma_f32_16x16x32_f16 v[20:23], v[32:35], v[108:111], 0
    ds_read_b128 v[108:111], v8 offset:768
    v_mov_b32 v6, v19
    s_waitcnt lgkmcnt(4)
    v_mfma_f32_16x16x32_f16 v[20:23], v[36:39], v[112:115], v[20:23]
    ds_read_b128 v[112:115], v8 offset:832
    s_waitcnt lgkmcnt(4)
    v_mfma_f32_16x16x32_f16 v[20:23], v[40:43], v[116:119], v[20:23]
    ds_read_b128 v[116:119], v8 offset:896
    ds_read_b64 v[28:29], v7 offset:1504
    ds_read_b64 v[30:31], v7 offset:2016
    s_waitcnt lgkmcnt(6)
    v_mfma_f32_16x16x32_f16 v[20:23], v[44:47], v[120:123], v[20:23]
    ds_read_b128 v[120:123], v8 offset:960
    s_waitcnt lgkmcnt(6)
    v_mfma_f32_16x16x32_f16 v[20:23], v[48:51], v[124:127], v[20:23]
    ds_read_b128 v[124:127], v8 offset:1024
    s_waitcnt lgkmcnt(6)
    v_mfma_f32_16x16x32_f16 v[20:23], v[52:55], v[108:111], v[20:23]
    ds_read_b128 v[108:111], v8 offset:1088
    s_waitcnt lgkmcnt(6)
    v_mfma_f32_16x16x32_f16 v[20:23], v[56:59], v[112:115], v[20:23]
    s_waitcnt lgkmcnt(5)
    v_mfma_f32_16x16x32_f16 v[20:23], v[60:63], v[116:119], v[20:23]
    ds_read_b128 v[112:115], v8 offset:1152
    s_waitcnt lgkmcnt(3)
    v_mfma_f32_16x16x32_f16 v[20:23], v[64:67], v[120:123], v[20:23]
    v_mfma_f32_16x16x32_f16 v[24:27], v[32:35], v[120:123], 0
    ds_read_b128 v[116:119], v8 offset:1216
    v_fma_mix_f32 v120, v28, v17, 0 op_sel_hi:[1,0,0]
    v_fma_mix_f32 v121, v28, v17, 0 op_sel:[1,0,0] op_sel_hi:[1,0,0]
    s_waitcnt lgkmcnt(3)
    v_mfma_f32_16x16x32_f16 v[20:23], v[68:71], v[124:127], v[20:23]
    v_fma_mix_f32 v122, v29, v17, 0 op_sel_hi:[1,0,0]
    v_fma_mix_f32 v123, v29, v17, 0 op_sel:[1,0,0] op_sel_hi:[1,0,0]
    v_mfma_f32_16x16x32_f16 v[24:27], v[36:39], v[124:127], v[24:27]
    ds_read_b128 v[32:35], v8 offset:1280
    v_cvt_pk_bf16_f32 v120, 0, v120
    v_cvt_pk_bf16_f32 v121, 0, v121
    s_waitcnt lgkmcnt(3)
    v_mfma_f32_16x16x32_f16 v[20:23], v[72:75], v[108:111], v[20:23]
    v_cvt_pk_bf16_f32 v122, 0, v122
    v_cvt_pk_bf16_f32 v123, 0, v123
    v_mfma_f32_16x16x32_f16 v[24:27], v[40:43], v[108:111], v[24:27]
    ds_read_b128 v[36:39], v8 offset:1344
    v_fma_mix_f32 v108, v30, v17, 0 op_sel_hi:[1,0,0]
    v_fma_mix_f32 v109, v30, v17, 0 op_sel:[1,0,0] op_sel_hi:[1,0,0]
    s_waitcnt lgkmcnt(3)
    v_mfma_f32_16x16x32_f16 v[20:23], v[76:79], v[112:115], v[20:23]
    v_fma_mix_f32 v110, v31, v17, 0 op_sel_hi:[1,0,0]
    v_fma_mix_f32 v111, v31, v17, 0 op_sel:[1,0,0] op_sel_hi:[1,0,0]
    v_mfma_f32_16x16x32_f16 v[24:27], v[44:47], v[112:115], v[24:27]
    ds_read_b128 v[124:127], v8 offset:1408
    v_cvt_pk_bf16_f32 v108, 0, v108
    v_cvt_pk_bf16_f32 v109, 0, v109
    s_waitcnt lgkmcnt(3)
    v_mfma_f32_16x16x32_f16 v[20:23], v[80:83], v[116:119], v[20:23]
    v_cvt_pk_bf16_f32 v110, 0, v110
    v_cvt_pk_bf16_f32 v111, 0, v111
    v_mfma_f32_16x16x32_f16 v[24:27], v[48:51], v[116:119], v[24:27]
    ds_read_b128 v[40:43], v8 offset:1472
    s_waitcnt lgkmcnt(3)
    v_mfma_f32_16x16x32_f16 v[20:23], v[84:87], v[32:35], v[20:23]
    v_mfma_f32_16x16x32_f16 v[24:27], v[52:55], v[32:35], v[24:27]
    ds_read_b128 v[44:47], v8 offset:1536
    s_waitcnt lgkmcnt(3)
    v_mfma_f32_16x16x32_f16 v[20:23], v[88:91], v[36:39], v[20:23]
    ds_read_b128 v[112:115], v8 offset:1600
    v_mfma_f32_16x16x32_f16 v[24:27], v[56:59], v[36:39], v[24:27]
    ds_read_b128 v[48:51], v8 offset:1664
    s_waitcnt lgkmcnt(4)
    v_mfma_f32_16x16x32_f16 v[20:23], v[92:95], v[124:127], v[20:23]
    ds_read_b128 v[116:119], v8 offset:1728
    v_mfma_f32_16x16x32_f16 v[24:27], v[60:63], v[124:127], v[24:27]
    ds_read_b128 v[52:55], v8 offset:1792
    s_waitcnt lgkmcnt(5)
    v_mfma_f32_16x16x32_f16 v[20:23], v[96:99], v[40:43], v[20:23]
    ds_read_b128 v[32:35], v8 offset:1856
    v_mfma_f32_16x16x32_f16 v[24:27], v[64:67], v[40:43], v[24:27]
    ds_read_b32 v18, v14 offset:76
    ds_read_b128 v[56:59], v8 offset:1920
    s_waitcnt lgkmcnt(7)
    v_mfma_f32_16x16x32_f16 v[24:27], v[68:71], v[44:47], v[24:27]
    ds_read_b128 v[36:39], v8 offset:1984
    s_waitcnt lgkmcnt(7)
    v_mfma_f32_16x16x32_f16 v[24:27], v[72:75], v[112:115], v[24:27]
    ds_read_b64 v[60:61], v11 offset:64
    ds_read_b64 v[62:63], v11 offset:72
    s_waitcnt lgkmcnt(8)
    v_mfma_f32_16x16x32_f16 v[24:27], v[76:79], v[48:51], v[24:27]
    s_waitcnt lgkmcnt(4)
    v_cmp_ne_u32 vcc, s84, v18
    s_cbranch_vccnz WS_40
WB_41:
    ds_read_b64_tr_b16 v[124:125], v9 offset:0
    ds_read_b64_tr_b16 v[126:127], v9 offset:64
    ds_read_b64_tr_b16 v[64:65], v9 offset:3088
    ds_read_b64_tr_b16 v[66:67], v9 offset:3152
    v_mfma_f32_16x16x32_f16 v[24:27], v[80:83], v[116:119], v[24:27]
    v_mfma_f32_16x16x32_f16 v[24:27], v[84:87], v[52:55], v[24:27]
    ds_read_b64_tr_b16 v[40:41], v9 offset:512
    ds_read_b64_tr_b16 v[42:43], v9 offset:576
    ds_read_b64 v[68:69], v11 offset:320
    ds_read_b64 v[70:71], v11 offset:328
    v_mfma_f32_16x16x32_f16 v[24:27], v[88:91], v[32:35], v[24:27]
    s_waitcnt lgkmcnt(11)
    v_mfma_f32_16x16x32_f16 v[24:27], v[92:95], v[56:59], v[24:27]
    ds_read_b64_tr_b16 v[44:45], v9 offset:3600
    ds_read_b64_tr_b16 v[46:47], v9 offset:3664
    s_waitcnt lgkmcnt(12)
    v_mfma_f32_16x16x32_f16 v[24:27], v[96:99], v[36:39], v[24:27]
    s_waitcnt lgkmcnt(8)
    v_mfma_f32_16x16x32_f16 v[20:23], v[124:127], v[100:103], v[20:23]
    s_waitcnt lgkmcnt(6)
    v_mfma_f32_16x16x32_f16 v[20:23], v[64:67], v[104:107], v[20:23]
    v_mfma_f32_16x16x32_f16 v[24:27], v[124:127], v[60:63], v[24:27]
    s_waitcnt lgkmcnt(4)
    v_mfma_f32_16x16x32_f16 v[24:27], v[40:43], v[100:103], v[24:27]
    s_nop 4
    v_cvt_pk_bf16_f32 v20, 0, v20
    v_cvt_pk_bf16_f32 v21, 0, v21
    s_waitcnt lgkmcnt(2)
    v_mfma_f32_16x16x32_f16 v[24:27], v[64:67], v[68:71], v[24:27]
    v_cvt_pk_bf16_f32 v22, 0, v22
    v_cvt_pk_bf16_f32 v23, 0, v23
    s_waitcnt lgkmcnt(0)
    v_mfma_f32_16x16x32_f16 v[24:27], v[44:47], v[104:107], v[24:27]
    v_fma_f32 v20, v20, v16, v120
    v_fma_f32 v21, v21, v16, v121
    v_fma_f32 v22, v22, v16, v122
    v_fma_f32 v23, v23, v16, v123
    v_cvt_pk_bf16_f32 v28, v20, v21
    v_cvt_pk_bf16_f32 v29, v22, v23
    v_min_u32 v28, -2, v28
    v_min_u32 v29, -2, v29
    ds_read_u8 v18, v14 offset:113
    ds_read_b128 v[20:23], v12 offset:47616
    v_cvt_pk_bf16_f32 v24, 0, v24
    v_cvt_pk_bf16_f32 v25, 0, v25
    v_cvt_pk_bf16_f32 v26, 0, v26
    v_cvt_pk_bf16_f32 v27, 0, v27
    v_fma_f32 v24, v24, v16, v108
    v_fma_f32 v25, v25, v16, v109
    v_fma_f32 v26, v26, v16, v110
    v_fma_f32 v27, v27, v16, v111
    v_cvt_pk_bf16_f32 v30, v24, v25
    v_cvt_pk_bf16_f32 v31, v26, v27
    v_min_u32 v30, -2, v30
    v_min_u32 v31, -2, v31
    s_branch CVE_35
CV_33:
    ds_read_b64 v[32:33], v6 offset:1152
    ds_read_b64 v[34:35], v6 offset:1160
    ds_read_b64 v[36:37], v6 offset:0
    ds_read_b64 v[38:39], v6 offset:8
    ds_read_b64 v[40:41], v6 offset:64
    ds_read_b64 v[42:43], v6 offset:72
    ds_read_b64 v[44:45], v6 offset:128
    ds_read_b64 v[46:47], v6 offset:136
    ds_read_b64 v[48:49], v6 offset:192
    ds_read_b64 v[50:51], v6 offset:200
    ds_read_b64 v[52:53], v6 offset:256
    ds_read_b64 v[54:55], v6 offset:264
    ds_read_b64 v[56:57], v6 offset:320
    ds_read_b64 v[58:59], v6 offset:328
    ds_read_b64 v[60:61], v6 offset:384
    ds_read_b64 v[62:63], v6 offset:392
    ds_read_b64 v[64:65], v6 offset:448
    ds_read_b64 v[66:67], v6 offset:456
    ds_read_b64 v[68:69], v6 offset:512
    ds_read_b64 v[70:71], v6 offset:520
    ds_read_b64 v[72:73], v6 offset:576
    ds_read_b64 v[74:75], v6 offset:584
    ds_read_b64 v[76:77], v6 offset:640
    ds_read_b64 v[78:79], v6 offset:648
    ds_read_b64 v[80:81], v6 offset:704
    ds_read_b64 v[82:83], v6 offset:712
    ds_read_b64 v[84:85], v6 offset:768
    ds_read_b64 v[86:87], v6 offset:776
    ds_read_b64 v[88:89], v6 offset:832
    ds_read_b64 v[90:91], v6 offset:840
    ds_read_b64 v[92:93], v6 offset:896
    ds_read_b64 v[94:95], v6 offset:904
    ds_read_b64 v[96:97], v6 offset:960
    ds_read_b64 v[98:99], v6 offset:968
    ds_read_b64 v[100:101], v6 offset:1024
    ds_read_b64 v[102:103], v6 offset:1032
    ds_read_b64 v[104:105], v11 offset:0
    ds_read_b64 v[106:107], v11 offset:8
    ds_read_b32 v18, v4 offset:16
    ds_read_b128 v[108:111], v8 offset:448
    ds_read_b128 v[112:115], v8 offset:960
    ds_read_b128 v[116:119], v8 offset:1472
    ds_read_b128 v[120:123], v8 offset:1536
    ds_read_b128 v[124:127], v8 offset:1600
    s_waitcnt lgkmcnt(5)
    v_cmp_ne_u32 vcc, s84, v18
    s_cbranch_vccnz US_42
UB_43:
    s_setprio 1
    s_waitcnt lgkmcnt(4)
    v_mfma_f32_16x16x32_f16 v[20:23], v[32:35], v[108:111], 0
    ds_read_b128 v[108:111], v8 offset:1664
    v_mov_b32 v6, v19
    s_waitcnt lgkmcnt(4)
    v_mfma_f32_16x16x32_f16 v[24:27], v[32:35], v[112:115], 0
    ds_read_b128 v[32:35], v8 offset:1728
    ds_read_b128 v[112:115], v8 offset:1792
    s_waitcnt lgkmcnt(5)
    v_mfma_f32_16x16x32_f16 v[20:23], v[36:39], v[116:119], v[20:23]
    ds_read_b128 v[116:119], v8 offset:1856
    ds_read_b64 v[28:29], v7 offset:2528
    ds_read_b64 v[30:31], v7 offset:3040
    s_waitcnt lgkmcnt(7)
    v_mfma_f32_16x16x32_f16 v[20:23], v[40:43], v[120:123], v[20:23]
    ds_read_b128 v[120:123], v8 offset:1920
    s_waitcnt lgkmcnt(7)
    v_mfma_f32_16x16x32_f16 v[20:23], v[44:47], v[124:127], v[20:23]
    ds_read_b128 v[124:127], v8 offset:1984
    s_waitcnt lgkmcnt(7)
    v_mfma_f32_16x16x32_f16 v[20:23], v[48:51], v[108:111], v[20:23]
    ds_read_b128 v[108:111], v8 offset:2048
    s_waitcnt lgkmcnt(7)
    v_mfma_f32_16x16x32_f16 v[20:23], v[52:55], v[32:35], v[20:23]
    s_waitcnt lgkmcnt(6)
    v_mfma_f32_16x16x32_f16 v[20:23], v[56:59], v[112:115], v[20:23]
    ds_read_b128 v[32:35], v8 offset:2112
    s_waitcnt lgkmcnt(6)
    v_mfma_f32_16x16x32_f16 v[20:23], v[60:63], v[116:119], v[20:23]
    s_waitcnt lgkmcnt(4)
    v_fma_mix_f32 v116, v28, v17, 0 op_sel_hi:[1,0,0]
    v_fma_mix_f32 v117, v28, v17, 0 op_sel:[1,0,0] op_sel_hi:[1,0,0]
    s_waitcnt lgkmcnt(3)
    v_mfma_f32_16x16x32_f16 v[20:23], v[64:67], v[120:123], v[20:23]
    ds_read_b128 v[112:115], v8 offset:2176
    v_fma_mix_f32 v118, v29, v17, 0 op_sel_hi:[1,0,0]
    v_fma_mix_f32 v119, v29, v17, 0 op_sel:[1,0,0] op_sel_hi:[1,0,0]
    s_waitcnt lgkmcnt(3)
    v_mfma_f32_16x16x32_f16 v[20:23], v[68:71], v[124:127], v[20:23]
    v_cvt_pk_bf16_f32 v116, 0, v116
    v_cvt_pk_bf16_f32 v117, 0, v117
    v_mfma_f32_16x16x32_f16 v[24:27], v[36:39], v[124:127], v[24:27]
    ds_read_b128 v[120:123], v8 offset:2240
    v_cvt_pk_bf16_f32 v118, 0, v118
    v_cvt_pk_bf16_f32 v119, 0, v119
    s_waitcnt lgkmcnt(3)
    v_mfma_f32_16x16x32_f16 v[20:23], v[72:75], v[108:111], v[20:23]
    v_fma_mix_f32 v124, v30, v17, 0 op_sel_hi:[1,0,0]
    v_fma_mix_f32 v125, v30, v17, 0 op_sel:[1,0,0] op_sel_hi:[1,0,0]
    v_mfma_f32_16x16x32_f16 v[24:27], v[40:43], v[108:111], v[24:27]
    ds_read_b128 v[36:39], v8 offset:2304
    v_fma_mix_f32 v126, v31, v17, 0 op_sel_hi:[1,0,0]
    v_fma_mix_f32 v127, v31, v17, 0 op_sel:[1,0,0] op_sel_hi:[1,0,0]
    s_waitcnt lgkmcnt(3)
    v_mfma_f32_16x16x32_f16 v[20:23], v[76:79], v[32:35], v[20:23]
    v_cvt_pk_bf16_f32 v124, 0, v124
    v_cvt_pk_bf16_f32 v125, 0, v125
    v_mfma_f32_16x16x32_f16 v[24:27], v[44:47], v[32:35], v[24:27]
    ds_read_b128 v[40:43], v8 offset:2368
    v_cvt_pk_bf16_f32 v126, 0, v126
    v_cvt_pk_bf16_f32 v127, 0, v127
    s_waitcnt lgkmcnt(3)
    v_mfma_f32_16x16x32_f16 v[20:23], v[80:83], v[112:115], v[20:23]
    v_mfma_f32_16x16x32_f16 v[24:27], v[48:51], v[112:115], v[24:27]
    ds_read_b128 v[108:111], v8 offset:2432
    s_waitcnt lgkmcnt(3)
    v_mfma_f32_16x16x32_f16 v[20:23], v[84:87], v[120:123], v[20:23]
    v_mfma_f32_16x16x32_f16 v[24:27], v[52:55], v[120:123], v[24:27]
    ds_read_b128 v[44:47], v8 offset:2496
    s_waitcnt lgkmcnt(3)
    v_mfma_f32_16x16x32_f16 v[20:23], v[88:91], v[36:39], v[20:23]
    v_mfma_f32_16x16x32_f16 v[24:27], v[56:59], v[36:39], v[24:27]
    ds_read_b128 v[32:35], v8 offset:2560
    s_waitcnt lgkmcnt(3)
    v_mfma_f32_16x16x32_f16 v[20:23], v[92:95], v[40:43], v[20:23]
    ds_read_b128 v[48:51], v8 offset:2624
    v_mfma_f32_16x16x32_f16 v[24:27], v[60:63], v[40:43], v[24:27]
    ds_read_b128 v[112:115], v8 offset:2688
    s_waitcnt lgkmcnt(4)
    v_mfma_f32_16x16x32_f16 v[20:23], v[96:99], v[108:111], v[20:23]
    ds_read_b128 v[52:55], v8 offset:2752
    v_mfma_f32_16x16x32_f16 v[24:27], v[64:67], v[108:111], v[24:27]
    ds_read_b128 v[120:123], v8 offset:2816
    s_waitcnt lgkmcnt(5)
    v_mfma_f32_16x16x32_f16 v[20:23], v[100:103], v[44:47], v[20:23]
    ds_read_b128 v[56:59], v8 offset:2880
    v_mfma_f32_16x16x32_f16 v[24:27], v[68:71], v[44:47], v[24:27]
    ds_read_b32 v18, v14 offset:76
    ds_read_b128 v[36:39], v8 offset:2944
    s_waitcnt lgkmcnt(7)
    v_mfma_f32_16x16x32_f16 v[24:27], v[72:75], v[32:35], v[24:27]
    ds_read_b128 v[60:63], v8 offset:3008
    s_waitcnt lgkmcnt(7)
    v_mfma_f32_16x16x32_f16 v[24:27], v[76:79], v[48:51], v[24:27]
    ds_read_b64 v[40:41], v11 offset:64
    ds_read_b64 v[42:43], v11 offset:72
    ds_read_b64 v[64:65], v11 offset:128
    ds_read_b64 v[66:67], v11 offset:136
    s_waitcnt lgkmcnt(10)
    v_mfma_f32_16x16x32_f16 v[24:27], v[80:83], v[112:115], v[24:27]
    s_waitcnt lgkmcnt(6)
    v_cmp_ne_u32 vcc, s84, v18
    s_cbranch_vccnz WS_44
WB_45:
    ds_read_b64_tr_b16 v[108:109], v9 offset:0
    ds_read_b64_tr_b16 v[110:111], v9 offset:64
    ds_read_b64_tr_b16 v[68:69], v9 offset:512
    ds_read_b64_tr_b16 v[70:71], v9 offset:576
    v_mfma_f32_16x16x32_f16 v[24:27], v[84:87], v[52:55], v[24:27]
    ds_read_b64_tr_b16 v[44:45], v9 offset:1024
    ds_read_b64_tr_b16 v[46:47], v9 offset:1088
    v_mfma_f32_16x16x32_f16 v[24:27], v[88:91], v[120:123], v[24:27]
    ds_read_b64_tr_b16 v[72:73], v9 offset:3088
    ds_read_b64_tr_b16 v[74:75], v9 offset:3152
    ds_read_b64 v[32:33], v11 offset:256
    ds_read_b64 v[34:35], v11 offset:264
    v_mfma_f32_16x16x32_f16 v[24:27], v[92:95], v[56:59], v[24:27]
    ds_read_b64_tr_b16 v[76:77], v9 offset:3600
    ds_read_b64_tr_b16 v[78:79], v9 offset:3664
    ds_read_b64 v[48:49], v11 offset:320
    ds_read_b64 v[50:51], v11 offset:328
    v_mfma_f32_16x16x32_f16 v[24:27], v[96:99], v[36:39], v[24:27]
    ds_read_b64_tr_b16 v[80:81], v9 offset:4112
    ds_read_b64_tr_b16 v[82:83], v9 offset:4176
    ds_read_b64 v[112:113], v11 offset:384
    ds_read_b64 v[114:115], v11 offset:392
    v_mfma_f32_16x16x32_f16 v[24:27], v[100:103], v[60:63], v[24:27]
    ds_read_b64_tr_b16 v[84:85], v10 offset:6176
    ds_read_b64_tr_b16 v[86:87], v10 offset:6304
    ds_read_b64 v[52:53], v13 offset:96
    ds_read_b64 v[54:55], v13 offset:104
    v_mfma_f32_16x16x32_f16 v[20:23], v[108:111], v[104:107], v[20:23]
    ds_read_b64_tr_b16 v[88:89], v10 offset:8224
    ds_read_b64_tr_b16 v[90:91], v10 offset:8352
    ds_read_b64 v[120:121], v13 offset:480
    ds_read_b64 v[122:123], v13 offset:488
    v_mfma_f32_16x16x32_f16 v[20:23], v[68:71], v[40:43], v[20:23]
    v_mfma_f32_16x16x32_f16 v[20:23], v[44:47], v[64:67], v[20:23]
    v_mfma_f32_16x16x32_f16 v[20:23], v[72:75], v[32:35], v[20:23]
    ds_read_b64_tr_b16 v[92:93], v9 offset:1536
    ds_read_b64_tr_b16 v[94:95], v9 offset:1600
    s_waitcnt lgkmcnt(14)
    v_mfma_f32_16x16x32_f16 v[20:23], v[76:79], v[48:51], v[20:23]
    s_waitcnt lgkmcnt(10)
    v_mfma_f32_16x16x32_f16 v[20:23], v[80:83], v[112:115], v[20:23]
    s_waitcnt lgkmcnt(6)
    v_mfma_f32_16x16x32_f16 v[20:23], v[84:87], v[52:55], v[20:23]
    ds_read_b64_tr_b16 v[56:57], v9 offset:4624
    ds_read_b64_tr_b16 v[58:59], v9 offset:4688
    ds_read_b64 v[96:97], v13 offset:64
    ds_read_b64 v[98:99], v13 offset:72
    s_waitcnt lgkmcnt(6)
    v_mfma_f32_16x16x32_f16 v[20:23], v[88:91], v[120:123], v[20:23]
    ds_read_b64 v[36:37], v13 offset:448
    ds_read_b64 v[38:39], v13 offset:456
    v_mfma_f32_16x16x32_f16 v[24:27], v[68:71], v[104:107], v[24:27]
    v_mfma_f32_16x16x32_f16 v[24:27], v[44:47], v[40:43], v[24:27]
    s_nop 3
    v_cvt_pk_bf16_f32 v20, 0, v20
    v_cvt_pk_bf16_f32 v21, 0, v21
    s_waitcnt lgkmcnt(6)
    v_mfma_f32_16x16x32_f16 v[24:27], v[92:95], v[64:67], v[24:27]
    v_cvt_pk_bf16_f32 v22, 0, v22
    v_cvt_pk_bf16_f32 v23, 0, v23
    v_mfma_f32_16x16x32_f16 v[24:27], v[76:79], v[32:35], v[24:27]
    v_fma_f32 v20, v20, v16, v116
    v_fma_f32 v21, v21, v16, v117
    v_mfma_f32_16x16x32_f16 v[24:27], v[80:83], v[48:51], v[24:27]
    v_fma_f32 v22, v22, v16, v118
    v_fma_f32 v23, v23, v16, v119
    s_waitcnt lgkmcnt(4)
    v_mfma_f32_16x16x32_f16 v[24:27], v[56:59], v[112:115], v[24:27]
    v_cvt_pk_bf16_f32 v28, v20, v21
    v_cvt_pk_bf16_f32 v29, v22, v23
    s_waitcnt lgkmcnt(2)
    v_mfma_f32_16x16x32_f16 v[24:27], v[84:87], v[96:99], v[24:27]
    v_min_u32 v28, -2, v28
    v_min_u32 v29, -2, v29
    s_waitcnt lgkmcnt(0)
    v_mfma_f32_16x16x32_f16 v[24:27], v[88:91], v[36:39], v[24:27]
    ds_read_u8 v18, v14 offset:114
    ds_read_b128 v[20:23], v12 offset:48640
    s_nop 5
    v_cvt_pk_bf16_f32 v24, 0, v24
    v_cvt_pk_bf16_f32 v25, 0, v25
    v_cvt_pk_bf16_f32 v26, 0, v26
    v_cvt_pk_bf16_f32 v27, 0, v27
    v_fma_f32 v24, v24, v16, v124
    v_fma_f32 v25, v25, v16, v125
    v_fma_f32 v26, v26, v16, v126
    v_fma_f32 v27, v27, v16, v127
    v_cvt_pk_bf16_f32 v30, v24, v25
    v_cvt_pk_bf16_f32 v31, v26, v27
    v_min_u32 v30, -2, v30
    v_min_u32 v31, -2, v31
    s_branch CVE_35
CV_34:
    ds_read_b64 v[32:33], v6 offset:1152
    ds_read_b64 v[34:35], v6 offset:1160
    ds_read_b64 v[36:37], v6 offset:0
    ds_read_b64 v[38:39], v6 offset:8
    ds_read_b64 v[40:41], v6 offset:64
    ds_read_b64 v[42:43], v6 offset:72
    ds_read_b64 v[44:45], v6 offset:128
    ds_read_b64 v[46:47], v6 offset:136
    ds_read_b64 v[48:49], v6 offset:192
    ds_read_b64 v[50:51], v6 offset:200
    ds_read_b64 v[52:53], v6 offset:256
    ds_read_b64 v[54:55], v6 offset:264
    ds_read_b64 v[56:57], v6 offset:320
    ds_read_b64 v[58:59], v6 offset:328
    ds_read_b64 v[60:61], v6 offset:384
    ds_read_b64 v[62:63], v6 offset:392
    ds_read_b64 v[64:65], v6 offset:448
    ds_read_b64 v[66:67], v6 offset:456
    ds_read_b64 v[68:69], v6 offset:512
    ds_read_b64 v[70:71], v6 offset:520
    ds_read_b64 v[72:73], v6 offset:576
    ds_read_b64 v[74:75], v6 offset:584
    ds_read_b64 v[76:77], v6 offset:640
    ds_read_b64 v[78:79], v6 offset:648
    ds_read_b64 v[80:81], v6 offset:704
    ds_read_b64 v[82:83], v6 offset:712
    ds_read_b64 v[84:85], v6 offset:768
    ds_read_b64 v[86:87], v6 offset:776
    ds_read_b64 v[88:89], v6 offset:832
    ds_read_b64 v[90:91], v6 offset:840
    ds_read_b64 v[92:93], v6 offset:896
    ds_read_b64 v[94:95], v6 offset:904
    ds_read_b64 v[96:97], v6 offset:960
    ds_read_b64 v[98:99], v6 offset:968
    ds_read_b64 v[100:101], v6 offset:1024
    ds_read_b64 v[102:103], v6 offset:1032
    ds_read_b64 v[104:105], v11 offset:0
    ds_read_b64 v[106:107], v11 offset:8
    ds_read_b32 v18, v4 offset:16
    ds_read_b128 v[108:111], v8 offset:1472
    ds_read_b128 v[112:115], v8 offset:1984
    ds_read_b128 v[116:119], v8 offset:2496
    ds_read_b128 v[120:123], v8 offset:2560
    ds_read_b128 v[124:127], v8 offset:2624
    s_waitcnt lgkmcnt(5)
    v_cmp_ne_u32 vcc, s84, v18
    s_cbranch_vccnz US_46
UB_47:
    s_setprio 1
    s_waitcnt lgkmcnt(4)
    v_mfma_f32_16x16x32_f16 v[20:23], v[32:35], v[108:111], 0
    ds_read_b128 v[108:111], v8 offset:2688
    v_mov_b32 v6, v19
    s_waitcnt lgkmcnt(4)
    v_mfma_f32_16x16x32_f16 v[24:27], v[32:35], v[112:115], 0
    ds_read_b128 v[32:35], v8 offset:2752
    ds_read_b128 v[112:115], v8 offset:2816
    s_waitcnt lgkmcnt(5)
    v_mfma_f32_16x16x32_f16 v[20:23], v[36:39], v[116:119], v[20:23]
    ds_read_b128 v[116:119], v8 offset:2880
    ds_read_b64 v[28:29], v7 offset:3552
    ds_read_b64 v[30:31], v7 offset:4064
    s_waitcnt lgkmcnt(7)
    v_mfma_f32_16x16x32_f16 v[20:23], v[40:43], v[120:123], v[20:23]
    ds_read_b128 v[120:123], v8 offset:2944
    s_waitcnt lgkmcnt(7)
    v_mfma_f32_16x16x32_f16 v[20:23], v[44:47], v[124:127], v[20:23]
    ds_read_b128 v[124:127], v8 offset:3008
    s_waitcnt lgkmcnt(7)
    v_mfma_f32_16x16x32_f16 v[20:23], v[48:51], v[108:111], v[20:23]
    ds_read_b128 v[108:111], v8 offset:3072
    s_waitcnt lgkmcnt(7)
    v_mfma_f32_16x16x32_f16 v[20:23], v[52:55], v[32:35], v[20:23]
    s_waitcnt lgkmcnt(6)
    v_mfma_f32_16x16x32_f16 v[20:23], v[56:59], v[112:115], v[20:23]
    ds_read_b128 v[32:35], v8 offset:3136
    s_waitcnt lgkmcnt(6)
    v_mfma_f32_16x16x32_f16 v[20:23], v[60:63], v[116:119], v[20:23]
    s_waitcnt lgkmcnt(4)
    v_fma_mix_f32 v116, v28, v17, 0 op_sel_hi:[1,0,0]
    v_fma_mix_f32 v117, v28, v17, 0 op_sel:[1,0,0] op_sel_hi:[1,0,0]
    s_waitcnt lgkmcnt(3)
    v_mfma_f32_16x16x32_f16 v[20:23], v[64:67], v[120:123], v[20:23]
    ds_read_b128 v[112:115], v8 offset:3200
    v_fma_mix_f32 v118, v29, v17, 0 op_sel_hi:[1,0,0]
    v_fma_mix_f32 v119, v29, v17, 0 op_sel:[1,0,0] op_sel_hi:[1,0,0]
    s_waitcnt lgkmcnt(3)
    v_mfma_f32_16x16x32_f16 v[20:23], v[68:71], v[124:127], v[20:23]
    v_cvt_pk_bf16_f32 v116, 0, v116
    v_cvt_pk_bf16_f32 v117, 0, v117
    v_mfma_f32_16x16x32_f16 v[24:27], v[36:39], v[124:127], v[24:27]
    ds_read_b128 v[120:123], v8 offset:3264
    v_cvt_pk_bf16_f32 v118, 0, v118
    v_cvt_pk_bf16_f32 v119, 0, v119
    s_waitcnt lgkmcnt(3)
    v_mfma_f32_16x16x32_f16 v[20:23], v[72:75], v[108:111], v[20:23]
    v_fma_mix_f32 v124, v30, v17, 0 op_sel_hi:[1,0,0]
    v_fma_mix_f32 v125, v30, v17, 0 op_sel:[1,0,0] op_sel_hi:[1,0,0]
    v_mfma_f32_16x16x32_f16 v[24:27], v[40:43], v[108:111], v[24:27]
    ds_read_b128 v[36:39], v8 offset:3328
    v_fma_mix_f32 v126, v31, v17, 0 op_sel_hi:[1,0,0]
    v_fma_mix_f32 v127, v31, v17, 0 op_sel:[1,0,0] op_sel_hi:[1,0,0]
    s_waitcnt lgkmcnt(3)
    v_mfma_f32_16x16x32_f16 v[20:23], v[76:79], v[32:35], v[20:23]
    v_cvt_pk_bf16_f32 v124, 0, v124
    v_cvt_pk_bf16_f32 v125, 0, v125
    v_mfma_f32_16x16x32_f16 v[24:27], v[44:47], v[32:35], v[24:27]
    ds_read_b128 v[40:43], v8 offset:3392
    v_cvt_pk_bf16_f32 v126, 0, v126
    v_cvt_pk_bf16_f32 v127, 0, v127
    s_waitcnt lgkmcnt(3)
    v_mfma_f32_16x16x32_f16 v[20:23], v[80:83], v[112:115], v[20:23]
    v_mfma_f32_16x16x32_f16 v[24:27], v[48:51], v[112:115], v[24:27]
    ds_read_b128 v[108:111], v8 offset:3456
    s_waitcnt lgkmcnt(3)
    v_mfma_f32_16x16x32_f16 v[20:23], v[84:87], v[120:123], v[20:23]
    v_mfma_f32_16x16x32_f16 v[24:27], v[52:55], v[120:123], v[24:27]
    ds_read_b128 v[44:47], v8 offset:3520
    s_waitcnt lgkmcnt(3)
    v_mfma_f32_16x16x32_f16 v[20:23], v[88:91], v[36:39], v[20:23]
    v_mfma_f32_16x16x32_f16 v[24:27], v[56:59], v[36:39], v[24:27]
    ds_read_b128 v[32:35], v8 offset:3584
    s_waitcnt lgkmcnt(3)
    v_mfma_f32_16x16x32_f16 v[20:23], v[92:95], v[40:43], v[20:23]
    ds_read_b128 v[48:51], v8 offset:3648
    v_mfma_f32_16x16x32_f16 v[24:27], v[60:63], v[40:43], v[24:27]
    ds_read_b128 v[112:115], v8 offset:3712
    s_waitcnt lgkmcnt(4)
    v_mfma_f32_16x16x32_f16 v[20:23], v[96:99], v[108:111], v[20:23]
    ds_read_b128 v[52:55], v8 offset:3776
    v_mfma_f32_16x16x32_f16 v[24:27], v[64:67], v[108:111], v[24:27]
    ds_read_b128 v[120:123], v8 offset:3840
    s_waitcnt lgkmcnt(5)
    v_mfma_f32_16x16x32_f16 v[20:23], v[100:103], v[44:47], v[20:23]
    ds_read_b128 v[56:59], v8 offset:3904
    v_mfma_f32_16x16x32_f16 v[24:27], v[68:71], v[44:47], v[24:27]
    ds_read_b32 v18, v14 offset:76
    ds_read_b128 v[36:39], v8 offset:3968
    s_waitcnt lgkmcnt(7)
    v_mfma_f32_16x16x32_f16 v[24:27], v[72:75], v[32:35], v[24:27]
    ds_read_b128 v[60:63], v8 offset:4032
    s_waitcnt lgkmcnt(7)
    v_mfma_f32_16x16x32_f16 v[24:27], v[76:79], v[48:51], v[24:27]
    ds_read_b64 v[40:41], v11 offset:64
    ds_read_b64 v[42:43], v11 offset:72
    ds_read_b64 v[64:65], v11 offset:128
    ds_read_b64 v[66:67], v11 offset:136
    s_waitcnt lgkmcnt(10)
    v_mfma_f32_16x16x32_f16 v[24:27], v[80:83], v[112:115], v[24:27]
    s_waitcnt lgkmcnt(6)
    v_cmp_ne_u32 vcc, s84, v18
    s_cbranch_vccnz WS_48
WB_49:
    ds_read_b64_tr_b16 v[108:109], v9 offset:1024
    ds_read_b64_tr_b16 v[110:111], v9 offset:1088
    ds_read_b64_tr_b16 v[68:69], v9 offset:1536
    ds_read_b64_tr_b16 v[70:71], v9 offset:1600
    v_mfma_f32_16x16x32_f16 v[24:27], v[84:87], v[52:55], v[24:27]
    ds_read_b64_tr_b16 v[44:45], v9 offset:2048
    ds_read_b64_tr_b16 v[46:47], v9 offset:2112
    v_mfma_f32_16x16x32_f16 v[24:27], v[88:91], v[120:123], v[24:27]
    ds_read_b64_tr_b16 v[72:73], v9 offset:4112
    ds_read_b64_tr_b16 v[74:75], v9 offset:4176
    ds_read_b64 v[32:33], v11 offset:256
    ds_read_b64 v[34:35], v11 offset:264
    v_mfma_f32_16x16x32_f16 v[24:27], v[92:95], v[56:59], v[24:27]
    ds_read_b64_tr_b16 v[76:77], v9 offset:4624
    ds_read_b64_tr_b16 v[78:79], v9 offset:4688
    ds_read_b64 v[48:49], v11 offset:320
    ds_read_b64 v[50:51], v11 offset:328
    v_mfma_f32_16x16x32_f16 v[24:27], v[96:99], v[36:39], v[24:27]
    ds_read_b64_tr_b16 v[80:81], v9 offset:5136
    ds_read_b64_tr_b16 v[82:83], v9 offset:5200
    ds_read_b64 v[112:113], v11 offset:384
    ds_read_b64 v[114:115], v11 offset:392
    v_mfma_f32_16x16x32_f16 v[24:27], v[100:103], v[60:63], v[24:27]
    ds_read_b64_tr_b16 v[84:85], v10 offset:6176
    ds_read_b64_tr_b16 v[86:87], v10 offset:6304
    ds_read_b64 v[52:53], v13 offset:32
    ds_read_b64 v[54:55], v13 offset:40
    v_mfma_f32_16x16x32_f16 v[20:23], v[108:111], v[104:107], v[20:23]
    ds_read_b64_tr_b16 v[88:89], v10 offset:7200
    ds_read_b64_tr_b16 v[90:91], v10 offset:7328
    ds_read_b64 v[120:121], v13 offset:96
    ds_read_b64 v[122:123], v13 offset:104
    v_mfma_f32_16x16x32_f16 v[20:23], v[68:71], v[40:43], v[20:23]
    ds_read_b64_tr_b16 v[92:93], v10 offset:8224
    ds_read_b64_tr_b16 v[94:95], v10 offset:8352
    ds_read_b64 v[56:57], v13 offset:416
    ds_read_b64 v[58:59], v13 offset:424
    v_mfma_f32_16x16x32_f16 v[20:23], v[44:47], v[64:67], v[20:23]
    ds_read_b64_tr_b16 v[96:97], v10 offset:9248
    ds_read_b64_tr_b16 v[98:99], v10 offset:9376
    ds_read_b64 v[36:37], v13 offset:480
    ds_read_b64 v[38:39], v13 offset:488
    v_mfma_f32_16x16x32_f16 v[20:23], v[72:75], v[32:35], v[20:23]
    v_mfma_f32_16x16x32_f16 v[20:23], v[76:79], v[48:51], v[20:23]
    v_mfma_f32_16x16x32_f16 v[20:23], v[80:83], v[112:115], v[20:23]
    ds_read_b64_tr_b16 v[100:101], v9 offset:2560
    ds_read_b64_tr_b16 v[102:103], v9 offset:2624
    s_waitcnt lgkmcnt(14)
    v_mfma_f32_16x16x32_f16 v[20:23], v[84:87], v[52:55], v[20:23]
    s_waitcnt lgkmcnt(10)
    v_mfma_f32_16x16x32_f16 v[20:23], v[88:91], v[120:123], v[20:23]
    s_waitcnt lgkmcnt(6)
    v_mfma_f32_16x16x32_f16 v[20:23], v[92:95], v[56:59], v[20:23]
    ds_read_b64_tr_b16 v[60:61], v9 offset:5648
    ds_read_b64_tr_b16 v[62:63], v9 offset:5712
    ds_read_b64 v[108:109], v13 offset:0
    ds_read_b64 v[110:111], v13 offset:8
    s_waitcnt lgkmcnt(6)
    v_mfma_f32_16x16x32_f16 v[20:23], v[96:99], v[36:39], v[20:23]
    ds_read_b64 v[72:73], v13 offset:64
    ds_read_b64 v[74:75], v13 offset:72
    ds_read_b64 v[52:53], v13 offset:384
    ds_read_b64 v[54:55], v13 offset:392
    v_mfma_f32_16x16x32_f16 v[24:27], v[68:71], v[104:107], v[24:27]
    ds_read_b64 v[120:121], v13 offset:448
    ds_read_b64 v[122:123], v13 offset:456
    v_mfma_f32_16x16x32_f16 v[24:27], v[44:47], v[40:43], v[24:27]
    v_cvt_pk_bf16_f32 v20, 0, v20
    v_cvt_pk_bf16_f32 v21, 0, v21
    s_waitcnt lgkmcnt(10)
    v_mfma_f32_16x16x32_f16 v[24:27], v[100:103], v[64:67], v[24:27]
    v_cvt_pk_bf16_f32 v22, 0, v22
    v_cvt_pk_bf16_f32 v23, 0, v23
    v_mfma_f32_16x16x32_f16 v[24:27], v[76:79], v[32:35], v[24:27]
    v_fma_f32 v20, v20, v16, v116
    v_fma_f32 v21, v21, v16, v117
    v_mfma_f32_16x16x32_f16 v[24:27], v[80:83], v[48:51], v[24:27]
    v_fma_f32 v22, v22, v16, v118
    v_fma_f32 v23, v23, v16, v119
    s_waitcnt lgkmcnt(8)
    v_mfma_f32_16x16x32_f16 v[24:27], v[60:63], v[112:115], v[24:27]
    v_cvt_pk_bf16_f32 v28, v20, v21
    v_cvt_pk_bf16_f32 v29, v22, v23
    s_waitcnt lgkmcnt(6)
    v_mfma_f32_16x16x32_f16 v[24:27], v[84:87], v[108:111], v[24:27]
    v_min_u32 v28, -2, v28
    v_min_u32 v29, -2, v29
    s_waitcnt lgkmcnt(4)
    v_mfma_f32_16x16x32_f16 v[24:27], v[88:91], v[72:75], v[24:27]
    s_waitcnt lgkmcnt(2)
    v_mfma_f32_16x16x32_f16 v[24:27], v[92:95], v[52:55], v[24:27]
    s_waitcnt lgkmcnt(0)
    v_mfma_f32_16x16x32_f16 v[24:27], v[96:99], v[120:123], v[24:27]
    ds_read_u8 v18, v14 offset:115
    ds_read_b128 v[20:23], v12 offset:49664
    s_nop 5
    v_cvt_pk_bf16_f32 v24, 0, v24
    v_cvt_pk_bf16_f32 v25, 0, v25
    v_cvt_pk_bf16_f32 v26, 0, v26
    v_cvt_pk_bf16_f32 v27, 0, v27
    v_fma_f32 v24, v24, v16, v124
    v_fma_f32 v25, v25, v16, v125
    v_fma_f32 v26, v26, v16, v126
    v_fma_f32 v27, v27, v16, v127
    v_cvt_pk_bf16_f32 v30, v24, v25
    v_cvt_pk_bf16_f32 v31, v26, v27
    v_min_u32 v30, -2, v30
    v_min_u32 v31, -2, v31
CVE_35:
    s_waitcnt lgkmcnt(0)
    s_cmp_lg_u32 s87, 1
    s_cbranch_scc1 ZA_50
    v_cmp_ne_u32 vcc, 1, v18
    s_cbranch_vccnz ZS_52
ZB_53:
    s_mov_b64 exec, s[12:13]
    v_swap_b32 v28, v20
    v_swap_b32 v29, v21
    v_swap_b32 v30, v22
    v_swap_b32 v31, v23
    s_mov_b64 exec, -1
    buffer_store_dwordx4 v[28:31], v6, s[64:67], s7 offen sc1
    buffer_store_dwordx4 v[20:23], v6, s[64:67], s6 offen sc1
    s_branch ZD_55
WS_40:
W_56:
    ds_read_b32 v18, v14 offset:76
    s_sub_u32 s39, s39, 1
    s_cbranch_scc1 KS_ABORT
    s_waitcnt lgkmcnt(0)
    v_cmp_ne_u32 vcc, s84, v18
    s_cbranch_vccnz W_56
    s_branch WB_41
WS_44:
W_57:
    ds_read_b32 v18, v14 offset:76
    s_sub_u32 s39, s39, 1
    s_cbranch_scc1 KS_ABORT
    s_waitcnt lgkmcnt(0)
    v_cmp_ne_u32 vcc, s84, v18
    s_cbranch_vccnz W_57
    s_branch WB_45
WS_48:
W_58:
    ds_read_b32 v18, v14 offset:76
    s_sub_u32 s39, s39, 1
    s_cbranch_scc1 KS_ABORT
    s_waitcnt lgkmcnt(0)
    v_cmp_ne_u32 vcc, s84, v18
    s_cbranch_vccnz W_58
    s_branch WB_49
US_36:
    s_setprio 0
W_59:
    s_sleep 1
    ds_read_b32 v18, v4 offset:16
    s_sub_u32 s39, s39, 1
    s_cbranch_scc1 KS_ABORT
    s_waitcnt lgkmcnt(0)
    v_cmp_eq_u32 vcc, 0, v18
    s_cbranch_vccnz W_59
W_60:
    ds_read_b32 v18, v4 offset:16
    s_sub_u32 s39, s39, 1
    s_cbranch_scc1 KS_ABORT
    s_waitcnt lgkmcnt(0)
    v_cmp_ne_u32 vcc, s84, v18
    s_cbranch_vccnz W_60
    ds_read_b128 v[96:99], v8 offset:0
    ds_read_b128 v[100:103], v8 offset:64
    ds_read_b128 v[104:107], v8 offset:128
    ds_read_b128 v[108:111], v8 offset:192
    s_branch UB_37
US_38:
    s_setprio 0
W_61:
    s_sleep 1
    ds_read_b32 v18, v4 offset:16
    s_sub_u32 s39, s39, 1
    s_cbranch_scc1 KS_ABORT
    s_waitcnt lgkmcnt(0)
    v_cmp_eq_u32 vcc, 0, v18
    s_cbranch_vccnz W_61
W_62:
    ds_read_b32 v18, v4 offset:16
    s_sub_u32 s39, s39, 1
    s_cbranch_scc1 KS_ABORT
    s_waitcnt lgkmcnt(0)
    v_cmp_ne_u32 vcc, s84, v18
    s_cbranch_vccnz W_62
    ds_read_b128 v[108:111], v8 offset:448
    ds_read_b128 v[112:115], v8 offset:512
    ds_read_b128 v[116:119], v8 offset:576
    ds_read_b128 v[120:123], v8 offset:640
    ds_read_b128 v[124:127], v8 offset:704
    s_branch UB_39
US_42:
    s_setprio 0
W_63:
    s_sleep 1
    ds_read_b32 v18, v4 offset:16
    s_sub_u32 s39, s39, 1
    s_cbranch_scc1 KS_ABORT
    s_waitcnt lgkmcnt(0)
    v_cmp_eq_u32 vcc, 0, v18
    s_cbranch_vccnz W_63
W_64:
    ds_read_b32 v18, v4 offset:16
    s_sub_u32 s39, s39, 1
    s_cbranch_scc1 KS_ABORT
    s_waitcnt lgkmcnt(0)
    v_cmp_ne_u32 vcc, s84, v18
    s_cbranch_vccnz W_64
    ds_read_b128 v[108:111], v8 offset:448
    ds_read_b128 v[112:115], v8 offset:960
    ds_read_b128 v[116:119], v8 offset:1472
    ds_read_b128 v[120:123], v8 offset:1536
    ds_read_b128 v[124:127], v8 offset:1600
    s_branch UB_43
US_46:
    s_setprio 0
W_65:
    s_sleep 1
    ds_read_b32 v18, v4 offset:16
    s_sub_u32 s39, s39, 1
    s_cbranch_scc1 KS_ABORT
    s_waitcnt lgkmcnt(0)
    v_cmp_eq_u32 vcc, 0, v18
    s_cbranch_vccnz W_65
W_66:
    ds_read_b32 v18, v4 offset:16
    s_sub_u32 s39, s39, 1
    s_cbranch_scc1 KS_ABORT
    s_waitcnt lgkmcnt(0)
    v_cmp_ne_u32 vcc, s84, v18
    s_cbranch_vccnz W_66
    ds_read_b128 v[108:111], v8 offset:1472
    ds_read_b128 v[112:115], v8 offset:1984
    ds_read_b128 v[116:119], v8 offset:2496
    ds_read_b128 v[120:123], v8 offset:2560
    ds_read_b128 v[124:127], v8 offset:2624
    s_branch UB_47
ZS_52:
    v_mov_b32 v19, s86
    v_lshl_add_u32 v16, v19, 10, v12
ZW_67:
    ds_read_u8 v18, v19 offset:128
    ds_read_b128 v[20:23], v16 offset:46592
    s_sub_u32 s39, s39, 1
    s_cbranch_scc1 KS_ABORT
    s_waitcnt lgkmcnt(0)
    v_cmp_ne_u32 vcc, 1, v18
    s_cbranch_vccnz ZW_67
    s_branch ZB_53
ZA_50:
    v_cmp_eq_u32 vcc, 1, v18
    s_cbranch_vccnz KS_CLK
W_68:
    ds_read_b32 v18, v4 offset:112
    s_sub_u32 s39, s39, 1
    s_cbranch_scc1 KS_ABORT
    s_waitcnt lgkmcnt(0)
    v_cmp_ne_u32 vcc, s84, v18
    s_cbranch_vccnz W_68
KS_CLK:
    s_cmp_lg_u32 s87, 0
    s_cbranch_scc1 ZC_51
    v_mov_b32 v19, s86
    v_lshl_add_u32 v18, v19, 10, v12
    ds_write_b128 v18, v[28:31] offset:46592
    ds_write_b8 v19, v5 offset:128
    s_branch ZD_55
ZC_51:
    buffer_store_dwordx4 v[28:31], v6, s[64:67], s6 offen sc1
ZD_55:
    s_lshl_b32 s92, s87, 2
    s_add_u32 s92, s92, s86
    v_mov_b32 v8, s92
    s_waitcnt vmcnt(0)
    ds_write_b8 v8, v5 offset:48
    s_branch KS_K1
    s_cmp_lg_u32 s38, 4
    s_cbranch_scc1 KS_K1
    s_setprio 0
    s_add_u32 s76, s36, 0x840000
    s_addc_u32 s77, s37, 0
    s_mov_b32 s78, 0x4000
    s_mov_b32 s79, 0x20000
    v_and_b32 v6, 1, v1
    v_lshlrev_b32 v6, 4, v6
    s_lshl_b32 s92, s90, 5
W_69:
    s_sleep 1
    ds_read_b32 v8, v4 offset:20
    s_sub_u32 s39, s39, 1
    s_cbranch_scc1 KS_ABORT
    s_waitcnt lgkmcnt(0)
    v_cmp_ne_u32 vcc, s84, v8
    s_cbranch_vccnz W_69
    s_mov_b64 exec, 3
    s_setprio 1
KS_K0:
    ds_read_b128 v[8:11], v6 offset:800
    s_sub_u32 s39, s39, 1
    s_cbranch_scc1 KS_ABORT
    s_waitcnt lgkmcnt(0)
    v_min3_u32 v12, v8, v9, v10
    v_min_u32 v12, v12, v11
    v_cmp_eq_u32 vcc, 0, v12
    s_cbranch_vccnz KS_K0
    buffer_store_dwordx4 v[8:11], v6, s[76:79], s92 offen sc1
    s_mov_b64 exec, -1
    s_waitcnt vmcnt(0)
    ds_write_b32 v4, v5 offset:24
KS_K1:
    s_cmp_lt_u32 s41, 18
    s_cbranch_scc1 KS_T
    s_waitcnt lgkmcnt(0)
    s_endpgm
KS_X:
    s_cmp_lt_u32 s41, 24
    s_cbranch_scc1 KS_X2
    s_setprio 2
KS_XC:
    s_add_u32 s86, s38, 3
KS_XD:
    s_mov_b32 s87, 2
    s_and_b32 s86, s86, 3
    s_lshl_b32 s88, s40, 3
    s_and_b32 s92, s41, 7
    s_add_u32 s88, s88, s92
    s_add_u32 s88, s88, 512
    s_lshl_b32 s92, s86, 11
    s_add_u32 s92, s92, 146048
    v_lshl_add_u32 v28, v1, 3, s92
    s_branch KS_GRP
KS_X2:
    s_cmp_lt_u32 s41, 8
    s_cbranch_scc1 KS_X3
    s_sub_u32 s97, s38, 8
    s_branch KS_LN1
KS_X3:
    s_lshl_b32 s92, s2, 4
    s_add_u32 s92, s92, s38
    s_cmp_lg_u32 s92, 44
    s_cbranch_scc1 KS_X3B
    s_setprio 3
    s_memrealtime s[92:93]
    v_and_b32 v6, 3, v1
    v_lshlrev_b32 v7, 2, v6
    v_min_u32 v6, 2, v6
    v_lshlrev_b32 v6, 2, v6
    v_cmp_eq_u32 vcc, 3, v1
    s_waitcnt lgkmcnt(0)
    v_mov_b32 v8, s92
    v_mov_b32 v9, s93
    v_alignbit_b32 v8, v8, v8, v6
    v_cndmask_b32 v9, v4, v9, vcc
    v_xor_b32 v8, v8, v9
    v_and_b32 v9, 0xf0000fff, v8
    v_and_b32 v10, 0xfff000, v8
    v_lshl_or_b32 v9, v10, 4, v9
    v_lshrrev_b32 v10, 12, v8
    v_and_b32 v10, 0xf000, v10
    v_or3_b32 v9, v9, v10, v9
    v_or_b32 v9, 0x80000000, v9
    s_mov_b64 exec, 15
    global_store_dword v7, v9, s[34:35] sc1
    s_mov_b64 exec, -1
    s_setprio 0
KS_X3B:
    s_setprio 3
    s_branch KS_XC
    s_waitcnt lgkmcnt(0)
    s_barrier
    s_branch KS_G
KS_X4:
    s_setprio 0
    s_cmp_lt_u32 s41, 18
    s_cbranch_scc1 KS_GN
KS_X5:
    v_mul_u32_u24 v46, 57, v1
    v_lshrrev_b32 v46, 9, v46
    v_mul_u32_u24 v47, 9, v46
    v_sub_u32 v47, v1, v47
    v_mul_u32_u24 v46, 9216, v46
    v_lshl_add_u32 v46, v47, 7, v46
    s_mul_i32 s94, s38, 6
    s_add_u32 s94, s94, s41
    s_sub_u32 s94, s94, 90
W_70:
    s_sleep 2
    ds_read_b32 v10, v4 offset:200
    s_sub_u32 s39, s39, 1
    s_cbranch_scc1 KS_ABORT
    s_waitcnt lgkmcnt(0)
    v_cmp_ne_u32 vcc, s84, v10
    s_cbranch_vccnz W_70
    s_bitcmp1_b32 s94, 0
    s_cselect_b32 s72, s28, s26
    s_cselect_b32 s73, s29, s27
    s_mov_b32 s74, 0x510000
    s_mov_b32 s75, 0x20000
    s_lshr_b32 s95, s94, 1
    s_mul_i32 s95, s95, 64512
    s_mul_i32 s96, s40, 1152
    s_add_u32 s95, s95, s96
    s_add_u32 s96, s95, 2644992
    buffer_load_dword v47, v46, s[72:75], s96 offen nt
    buffer_load_dword v47, v46, s[72:75], s96 offen sc1
KS_XPE:
    s_waitcnt vmcnt(0) lgkmcnt(0)
    s_endpgm
KS_L:
    v_lshlrev_b32 v6, 2, v0
    ds_write_b32 v6, v4
    v_mov_b32 v8, 0
    v_mov_b32 v9, 0
    s_min_u32 s92, s38, 2
    s_mul_i32 s92, s92, 4672
    v_min_u32 v6, 59, v1
    v_lshl_add_u32 v6, v6, 3, s92
    ds_write_b64 v6, v[8:9] offset:3072
    s_mov_b32 s97, s38
    s_sub_u32 s92, s41, 8
    s_cmp_lt_u32 s92, 16
    s_cbranch_scc0 KS_L0
KS_LN1:
    s_setprio 3
    s_sub_u32 s92, s41, 8
    s_and_b32 s88, s92, 7
    s_lshr_b32 s92, s92, 3
    s_lshl_b32 s92, s92, 4
    s_add_u32 s88, s88, s92
    s_and_b32 s92, s40, 1
    s_lshl_b32 s92, s92, 3
    s_add_u32 s88, s88, s92
    s_lshr_b32 s92, s40, 1
    s_lshl_b32 s92, s92, 5
    s_add_u32 s88, s88, s92
    v_lshrrev_b32 v36, 5, v1
    v_and_b32 v37, 31, v1
    v_mul_u32_u24 v38, 9216, v36
    v_lshl_add_u32 v39, v37, 2, v38
    v_lshl_add_u32 v38, v37, 4, v38
    s_mul_i32 s93, s88, 18432
    s_mul_i32 s94, s97, 1152
    s_add_u32 s93, s93, s94
    s_mov_b32 s66, 0x240000
    s_mov_b32 s67, 0x20000
    s_waitcnt lgkmcnt(0)
    s_mov_b32 s64, s4
    s_mov_b32 s65, s5
    buffer_load_dwordx4 v[26:29], v38, s[64:67], s93 offen
    buffer_load_dwordx4 v[30:33], v38, s[64:67], s93 offen offset:512
    buffer_load_dword v34, v39, s[64:67], s93 offen offset:1024
    s_barrier
    s_mul_i32 s94, s97, 2368
    s_add_u32 s94, s94, 16576
    v_lshl_add_u32 v6, v37, 1, v36
    v_lshl_add_u32 v6, v6, 2, s94
    v_and_b32 v59, 3, v1
    v_bfe_u32 v7, v1, 2, 2
    v_mul_u32_u24 v7, 2368, v7
    v_lshl_add_u32 v40, v3, 2, v59
    v_lshl_add_u32 v7, v40, 3, v7
    s_lshl_b32 s94, s97, 7
    s_add_u32 s92, s94, 18624
    v_add_u32 v44, s92, v7
    s_lshl_b32 s94, s97, 8
    s_add_u32 s94, s94, 16576
    v_add_u32 v7, s94, v7
    v_lshlrev_b32 v41, 4, v59
    s_nop 1
    v_mov_b32_dpp v40, v41 quad_perm:[0,2,1,3] row_mask:0xf bank_mask:0xf
    v_lshlrev_b32 v59, 2, v59
    v_lshrrev_b32 v41, 2, v1
    v_mul_u32_u24 v35, 0x8200, v41
    s_lshl_b32 s92, s88, 6
    s_and_b32 s93, s92, 0x1e00
    v_xad_u32 v35, v35, s93, v40
    s_lshl_b32 s93, s97, 4
    v_add_u32 v41, s93, v41
    v_mul_u32_u24 v45, 0x2080, v41
    v_xad_u32 v45, v45, s92, v40
    s_and_b32 s93, s97, 3
    s_mul_i32 s93, s93, 0x2080
    s_and_b32 s92, s92, 0x1c0
    s_xor_b32 s83, s92, s93
    s_lshr_b32 s93, s97, 2
    s_lshl_b32 s93, s93, 20
    s_add_u32 s83, s83, s93
    s_add_u32 s96, s83, 0x80000
    s_mov_b32 s80, 0x3f80
    s_mov_b32 s81, 0x3f800000
    s_mov_b32 s82, 0x3f803f80
    s_mov_b32 s98, 0x70007
    s_mov_b32 s99, 0x200000
    v_mov_b32 v40, 0
    v_mov_b32 v41, 0
    v_mov_b32 v42, 0x3ae38e39
    s_mov_b32 s72, s36
    s_mov_b32 s73, s37
    s_mov_b32 s74, 0x240000
    s_mov_b32 s75, 0x20000
    s_cmp_lt_u32 s97, 4
    s_cbranch_scc1 LN1A_71
    s_cmp_ge_u32 s41, 18
    s_cbranch_scc1 LN1A_71
    s_mov_b32 s68, s30
    s_mov_b32 s69, s31
    s_mov_b32 s70, 0x510000
    s_mov_b32 s71, 0x20000
    v_lshlrev_b32 v46, 4, v1
    s_mul_i32 s92, s89, 36864
    s_mul_i32 s93, s97, 9216
    s_add_u32 s92, s92, s93
    s_sub_u32 s92, s92, 36864
    s_add_u32 s93, s93, 72320
    s_add_u32 m0, s93, 0
    s_nop 0
    buffer_load_dwordx4 v46, s[68:71], s92 offen offset:0 nt lds
    buffer_load_dwordx4 v46, s[68:71], s92 offen offset:1024 nt lds
    buffer_load_dwordx4 v46, s[68:71], s92 offen offset:2048 nt lds
    buffer_load_dwordx4 v46, s[68:71], s92 offen offset:3072 nt lds
    s_add_u32 m0, s93, 4096
    s_add_u32 s92, s92, 4096
    buffer_load_dwordx4 v46, s[68:71], s92 offen offset:0 nt lds
    buffer_load_dwordx4 v46, s[68:71], s92 offen offset:1024 nt lds
    buffer_load_dwordx4 v46, s[68:71], s92 offen offset:2048 nt lds
    buffer_load_dwordx4 v46, s[68:71], s92 offen offset:3072 nt lds
    s_add_u32 m0, s93, 8192
    s_add_u32 s92, s92, 4096
    buffer_load_dwordx4 v46, s[68:71], s92 offen offset:0 nt lds
    s_waitcnt vmcnt(11)
    v_dot2c_f32_bf16 v40, s82, v26
    v_dot2c_f32_bf16 v41, v26, v26
    v_dot2c_f32_bf16 v40, s82, v27
    v_dot2c_f32_bf16 v41, v27, v27
    v_dot2c_f32_bf16 v40, s82, v28
    v_dot2c_f32_bf16 v41, v28, v28
    v_dot2c_f32_bf16 v40, s82, v29
    v_dot2c_f32_bf16 v41, v29, v29
    s_waitcnt vmcnt(10)
    v_dot2c_f32_bf16 v40, s82, v30
    v_dot2c_f32_bf16 v41, v30, v30
    v_dot2c_f32_bf16 v40, s82, v31
    v_dot2c_f32_bf16 v41, v31, v31
    v_dot2c_f32_bf16 v40, s82, v32
    v_dot2c_f32_bf16 v41, v32, v32
    v_dot2c_f32_bf16 v40, s82, v33
    v_dot2c_f32_bf16 v41, v33, v33
    s_waitcnt vmcnt(9)
    v_dot2c_f32_bf16 v40, s82, v34
    v_dot2c_f32_bf16 v41, v34, v34
    s_branch LN1B_72
LN1A_71:
    s_waitcnt vmcnt(2)
    v_dot2c_f32_bf16 v40, s82, v26
    v_dot2c_f32_bf16 v41, v26, v26
    v_dot2c_f32_bf16 v40, s82, v27
    v_dot2c_f32_bf16 v41, v27, v27
    v_dot2c_f32_bf16 v40, s82, v28
    v_dot2c_f32_bf16 v41, v28, v28
    v_dot2c_f32_bf16 v40, s82, v29
    v_dot2c_f32_bf16 v41, v29, v29
    s_waitcnt vmcnt(1)
    v_dot2c_f32_bf16 v40, s82, v30
    v_dot2c_f32_bf16 v41, v30, v30
    v_dot2c_f32_bf16 v40, s82, v31
    v_dot2c_f32_bf16 v41, v31, v31
    v_dot2c_f32_bf16 v40, s82, v32
    v_dot2c_f32_bf16 v41, v32, v32
    v_dot2c_f32_bf16 v40, s82, v33
    v_dot2c_f32_bf16 v41, v33, v33
    s_waitcnt vmcnt(0)
    v_dot2c_f32_bf16 v40, s82, v34
    v_dot2c_f32_bf16 v41, v34, v34
LN1B_72:
    s_nop 1
    v_add_f32_dpp v36, v40, v40 row_ror:8 row_mask:0xf bank_mask:0x3
    v_add_f32_dpp v36, v41, v41 row_ror:8 row_mask:0xf bank_mask:0xc
    s_nop 1
    v_add_f32_dpp v36, v36, v36 row_half_mirror row_mask:0xf bank_mask:0xf
    s_nop 1
    v_add_f32_dpp v36, v36, v36 quad_perm:[1,0,3,2] row_mask:0xf bank_mask:0xf
    s_nop 1
    v_add_f32_dpp v36, v36, v36 quad_perm:[2,3,0,1] row_mask:0xf bank_mask:0xf
    v_mov_b32 v37, v36
    s_nop 1
    v_permlane16_swap_b32 v36, v37
    v_add_f32 v36, v36, v37
    s_nop 1
    v_mul_f32_dpp v40, v36, v42 row_newbcast:0 row_mask:0xf bank_mask:0xf
    v_mul_f32_dpp v41, v36, v42 row_newbcast:8 row_mask:0xf bank_mask:0xf
    v_cvt_pk_bf16_f32 v36, 0, -v40
    v_fma_f32 v41, -v40, v40, v41
    v_dot2_f32_bf16 v8, v26, s80, v36
    v_dot2_f32_bf16 v9, v26, s81, v36
    v_max_f32 v41, 0, v41
    v_dot2_f32_bf16 v10, v27, s80, v36
    v_dot2_f32_bf16 v11, v27, s81, v36
    v_cvt_pk_bf16_f32 v41, 0, v41
    v_dot2_f32_bf16 v12, v28, s80, v36
    v_dot2_f32_bf16 v13, v28, s81, v36
    v_add_f32 v41, 0x3727c5ac, v41
    v_cvt_pk_bf16_f32 v8, 0, v8
    v_cvt_pk_bf16_f32 v9, 0, v9
    v_dot2_f32_bf16 v14, v29, s80, v36
    v_dot2_f32_bf16 v15, v29, s81, v36
    v_cvt_pk_bf16_f32 v41, 0, v41
    v_cvt_pk_bf16_f32 v10, 0, v10
    v_cvt_pk_bf16_f32 v11, 0, v11
    v_dot2_f32_bf16 v16, v30, s80, v36
    v_dot2_f32_bf16 v17, v30, s81, v36
    v_sqrt_f32 v41, v41
    v_cvt_pk_bf16_f32 v12, 0, v12
    v_cvt_pk_bf16_f32 v13, 0, v13
    v_dot2_f32_bf16 v18, v31, s80, v36
    v_dot2_f32_bf16 v19, v31, s81, v36
    v_cvt_pk_bf16_f32 v41, 0, v41
    v_cvt_pk_bf16_f32 v14, 0, v14
    v_cvt_pk_bf16_f32 v15, 0, v15
    v_dot2_f32_bf16 v20, v32, s80, v36
    v_dot2_f32_bf16 v21, v32, s81, v36
    v_rcp_f32 v38, v41
    v_cvt_pk_bf16_f32 v16, 0, v16
    v_cvt_pk_bf16_f32 v17, 0, v17
    v_dot2_f32_bf16 v22, v33, s80, v36
    v_dot2_f32_bf16 v23, v33, s81, v36
    v_cvt_pk_bf16_f32 v18, 0, v18
    v_cvt_pk_bf16_f32 v19, 0, v19
    v_dot2_f32_bf16 v24, v34, s80, v36
    v_dot2_f32_bf16 v25, v34, s81, v36
    v_cvt_pk_bf16_f32 v20, 0, v20
    v_cvt_pk_bf16_f32 v21, 0, v21
    v_cvt_pk_bf16_f32 v22, 0, v22
    v_cvt_pk_bf16_f32 v23, 0, v23
    v_pk_mul_f32 v[8:9], v[8:9], v[38:39] op_sel_hi:[1,0]
    v_cvt_pkrtz_f16_f32 v26, v8, v9
    v_add_u32 v26, 0x40004, v26
    v_cvt_pk_bf16_f32 v24, 0, v24
    v_cvt_pk_bf16_f32 v25, 0, v25
    v_pk_mul_f32 v[10:11], v[10:11], v[38:39] op_sel_hi:[1,0]
    v_cvt_pkrtz_f16_f32 v27, v10, v11
    v_add_u32 v27, 0x40004, v27
    ds_write2st64_b32 v6, v26, v27 offset0:0 offset1:1
    v_pk_mul_f32 v[12:13], v[12:13], v[38:39] op_sel_hi:[1,0]
    v_cvt_pkrtz_f16_f32 v28, v12, v13
    v_add_u32 v28, 0x40004, v28
    s_load_dwordx4 s[76:79], s[34:35], 0
    v_pk_mul_f32 v[14:15], v[14:15], v[38:39] op_sel_hi:[1,0]
    v_cvt_pkrtz_f16_f32 v29, v14, v15
    v_add_u32 v29, 0x40004, v29
    ds_write2st64_b32 v6, v28, v29 offset0:2 offset1:3
    v_pk_mul_f32 v[16:17], v[16:17], v[38:39] op_sel_hi:[1,0]
    v_cvt_pkrtz_f16_f32 v30, v16, v17
    v_add_u32 v30, 0x40004, v30
    v_pk_mul_f32 v[18:19], v[18:19], v[38:39] op_sel_hi:[1,0]
    v_cvt_pkrtz_f16_f32 v31, v18, v19
    v_add_u32 v31, 0x40004, v31
    ds_write2st64_b32 v6, v30, v31 offset0:4 offset1:5
    v_pk_mul_f32 v[20:21], v[20:21], v[38:39] op_sel_hi:[1,0]
    v_cvt_pkrtz_f16_f32 v32, v20, v21
    v_add_u32 v32, 0x40004, v32
    v_pk_mul_f32 v[22:23], v[22:23], v[38:39] op_sel_hi:[1,0]
    v_cvt_pkrtz_f16_f32 v33, v22, v23
    v_add_u32 v33, 0x40004, v33
    ds_write2st64_b32 v6, v32, v33 offset0:6 offset1:7
    v_pk_mul_f32 v[24:25], v[24:25], v[38:39] op_sel_hi:[1,0]
    v_cvt_pkrtz_f16_f32 v34, v24, v25
    v_add_u32 v34, 0x40004, v34
    ds_write_b32 v6, v34 offset:2048
    v_mov_b32 v6, s97
    ds_write_b8 v6, v5 offset:0
    s_waitcnt lgkmcnt(0)
    v_mov_b32 v58, s76
    v_mov_b32 v57, s77
    v_mov_b32 v56, s78
    v_mov_b32 v55, s79
    v_cmp_eq_u32 vcc, 4, v59
    s_nop 1
    v_cndmask_b32 v58, v58, v57, vcc
    v_cmp_eq_u32 vcc, 12, v59
    s_nop 1
    v_cndmask_b32 v56, v56, v55, vcc
    v_cmp_lt_u32 vcc, 4, v59
    s_nop 1
    v_cndmask_b32 v58, v58, v56, vcc
    s_waitcnt vmcnt(63)
DBP_73:
    v_cmp_eq_u32 vcc, 0, v58
    s_cbranch_vccz DBG_74
    s_sleep 1
    global_load_dword v58, v59, s[34:35] sc1
    s_sub_u32 s39, s39, 1
    s_cbranch_scc1 KS_ABORT
    s_waitcnt vmcnt(0)
    s_branch DBP_73
DBG_74:
    v_mov_b32_dpp v40, v58 quad_perm:[0,2,1,3] row_mask:0xf bank_mask:0xf
    v_lshrrev_b32 v41, 3, v40
    v_lshrrev_b32 v42, 6, v40
    v_lshrrev_b32 v43, 9, v40
W_75:
    ds_read_b64 v[20:21], v4 offset:0
    s_sub_u32 s39, s39, 1
    s_cbranch_scc1 KS_ABORT
    s_waitcnt lgkmcnt(0)
    v_and_b32 v20, v20, v21
    v_cmp_ne_u32 vcc, s84, v20
    s_cbranch_vccnz W_75
    ds_read_b64_tr_b16 v[20:21], v7 offset:0
    ds_read_b64_tr_b16 v[22:23], v7 offset:9472
    ds_read_b64_tr_b16 v[24:25], v7 offset:128
    ds_read_b64_tr_b16 v[26:27], v7 offset:9600
    ds_read_b64_tr_b16 v[28:29], v44 offset:0
    ds_read_b64_tr_b16 v[30:31], v44 offset:9472
    s_waitcnt lgkmcnt(4)
    v_bfi_b32 v20, s98, v40, v20
    v_bfi_b32 v21, s98, v41, v21
    v_bfi_b32 v22, s98, v42, v22
    v_bfi_b32 v23, s98, v43, v23
    buffer_store_dwordx4 v[20:23], v35, s[72:75], s83 offen sc1
    s_waitcnt lgkmcnt(2)
    v_bfi_b32 v24, s98, v40, v24
    v_bfi_b32 v25, s98, v41, v25
    v_bfi_b32 v26, s98, v42, v26
    v_bfi_b32 v27, s98, v43, v27
    buffer_store_dwordx4 v[24:27], v35, s[72:75], s96 offen sc1
    s_waitcnt lgkmcnt(0)
    s_cmp_ge_u32 s97, 4
    s_cbranch_scc1 KS_X4
    v_bfi_b32 v28, s98, v40, v28
    v_bfi_b32 v29, s98, v41, v29
    v_bfi_b32 v30, s98, v42, v30
    v_bfi_b32 v31, s98, v43, v31
    buffer_store_dwordx4 v[28:31], v45, s[72:75], s99 offen sc1
    ds_write_b8 v6, v5 offset:200
    ds_write_b32 v59, v58 offset:224
    v_lshrrev_b32 v57, 3, v58
    v_lshrrev_b32 v56, 6, v58
    v_lshrrev_b32 v55, 9, v58
    s_mov_b32 s87, 1
    s_branch KS_L2B
KS_L0:
    s_and_b32 s92, s41, 15
    s_lshl_b32 s93, s40, 4
    s_add_u32 s92, s92, s93
    v_and_b32 v59, 3, v1
    v_lshlrev_b32 v59, 2, v59
    s_lshl_b32 s96, s92, 6
    s_add_u32 s93, s96, 0xb00000
    v_add_u32 v7, s93, v59
    s_mul_i32 s93, s92, 18560
    s_add_u32 s93, s93, 0x600000
    v_lshlrev_b32 v6, 4, v0
    v_mov_b32 v12, -1
    v_mov_b32 v13, -1
    v_mov_b32 v14, -1
    v_mov_b32 v15, -1
    s_setprio 3
    v_mul_u32_u24 v16, 57, v1
    v_lshrrev_b32 v16, 9, v16
    v_mul_u32_u24 v17, 9, v16
    v_sub_u32 v17, v1, v17
    v_mul_u32_u24 v16, 9216, v16
    v_lshl_add_u32 v16, v17, 7, v16
    s_waitcnt lgkmcnt(0)
    s_add_u32 s68, s36, s93
    s_addc_u32 s69, s37, 0
    s_mov_b32 s70, 18560
    s_mov_b32 s71, 0x20000
    s_barrier
W_76:
    s_sleep 2
    ds_read_b32 v8, v4 offset:36
    s_sub_u32 s39, s39, 1
    s_cbranch_scc1 KS_ABORT
    s_waitcnt lgkmcnt(0)
    v_cmp_eq_u32 vcc, 0, v8
    s_cbranch_vccnz W_76
    s_mov_b32 s92, 0
    buffer_store_dwordx4 v[12:15], v6, s[68:71], s92 offen sc1
    s_mov_b32 s92, 4096
    buffer_store_dwordx4 v[12:15], v6, s[68:71], s92 offen sc1
    s_mov_b32 s92, 8192
    buffer_store_dwordx4 v[12:15], v6, s[68:71], s92 offen sc1
    s_mov_b32 s92, 12288
    buffer_store_dwordx4 v[12:15], v6, s[68:71], s92 offen sc1
    s_mov_b32 s92, 16384
    buffer_store_dwordx4 v[12:15], v6, s[68:71], s92 offen sc1
    global_load_dword v58, v59, s[34:35] sc1
    s_and_b32 s94, s41, 7
    s_lshl_b32 s95, s38, 3
    s_add_u32 s94, s94, s95
    s_bitcmp1_b32 s94, 0
    s_cselect_b32 s72, s28, s26
    s_cselect_b32 s73, s29, s27
    s_mov_b32 s74, 0x510000
    s_mov_b32 s75, 0x20000
    s_lshr_b32 s95, s94, 1
    s_mul_i32 s95, s95, 64512
    s_mul_i32 s96, s40, 1152
    s_add_u32 s95, s95, s96
    s_cmp_lt_u32 s41, 24
    s_cselect_b32 s74, 0, s74
    s_add_u32 s96, s95, 3419136
    s_cmp_ge_u32 s38, 4
    s_cselect_b32 s74, 0, s74
    buffer_load_dword v18, v16, s[72:75], s96 offen nt
    buffer_load_dword v18, v16, s[72:75], s96 offen sc1
    s_waitcnt vmcnt(2)
DBP_77:
    v_cmp_eq_u32 vcc, 0, v58
    s_cbranch_vccz DBG_78
    s_sleep 1
    global_load_dword v58, v59, s[34:35] sc1
    s_sub_u32 s39, s39, 1
    s_cbranch_scc1 KS_ABORT
    s_waitcnt vmcnt(0)
    s_branch DBP_77
DBG_78:
    ds_write_b32 v59, v58 offset:224
    s_mov_b64 exec, 1
    ds_add_rtn_u32 v8, v4, v5 offset:8
    s_mov_b64 exec, -1
    v_lshrrev_b32 v57, 3, v58
    v_lshrrev_b32 v56, 6, v58
    v_lshrrev_b32 v55, 9, v58
    s_waitcnt lgkmcnt(0)
    v_readfirstlane_b32 s92, v8
    s_cmp_lg_u32 s92, 3
    s_cbranch_scc1 KS_L2
    s_mov_b64 exec, 15
    global_store_dword v7, v58, s[36:37] sc1
    s_mov_b64 exec, -1
    s_and_b32 s94, s41, 7
    s_cmp_ge_u32 s41, 8
    s_cbranch_scc1 KS_L1C
    s_branch KS_L2
KS_L1C:
KS_L2:
    s_mov_b32 s87, 0
KS_L2B:
    s_mov_b32 s64, s36
    s_mov_b32 s65, s37
    s_mov_b32 s66, 0x240000
    s_mov_b32 s67, 0x20000
    v_lshrrev_b32 v7, 1, v1
    v_lshlrev_b32 v7, 6, v7
    v_and_b32 v10, 1, v1
    v_lshl_add_u32 v7, v10, 4, v7
    v_lshlrev_b32 v9, 4, v1
    s_lshl_b32 s92, s38, 11
    s_lshl_b32 s93, s90, 13
    s_add_u32 s93, s93, s92
    s_lshl_b32 s94, s90, 7
    s_and_b32 s95, s94, 0x380
    v_xor_b32 v13, s95, v9
    s_and_b32 s94, s94, 0x1c00
    s_xor_b32 s93, s93, s94
    s_xor_b32 s97, s93, 0x400
    s_lshl_b32 s95, s40, 3
    s_add_u32 s95, s95, s41
    s_add_u32 s95, s95, 488
    s_lshr_b32 s96, s95, 1
    s_lshl_b32 s96, s96, 13
    s_and_b32 s95, s95, 1
    s_lshl_b32 s95, s95, 5
    s_add_u32 s95, s95, s96
    s_add_u32 s95, s95, s92
    s_lshr_b32 s96, s96, 6
    s_and_b32 s94, s96, 0x780
    v_xor_b32 v7, s94, v7
    s_and_b32 s96, s96, 0x1800
    s_xor_b32 s95, s95, s96
    s_cmp_lt_u32 s41, 24
    s_cselect_b32 s95, 2359296, s95
    s_cselect_b32 s94, 0, 0x70007
    v_mov_b32_dpp v64, v58 quad_perm:[0,1,0,1] row_mask:0xf bank_mask:0xf
    v_mov_b32_dpp v65, v58 quad_perm:[2,3,2,3] row_mask:0xf bank_mask:0xf
    s_bitcmp1_b32 s41, 0
    s_cselect_b64 vcc, -1, 0
    v_cndmask_b32 v64, v64, v65, vcc
    v_and_b32 v60, 0x70007, v58
    v_and_b32 v61, 0x70007, v57
    v_and_b32 v62, 0x70007, v56
    v_and_b32 v63, 0x70007, v55
    v_lshrrev_b32 v67, 9, v64
    v_lshrrev_b32 v66, 6, v64
    v_lshrrev_b32 v65, 3, v64
    v_and_b32 v64, s94, v64
    v_and_b32 v65, s94, v65
    v_and_b32 v66, s94, v66
    v_and_b32 v67, s94, v67
    s_lshl_b32 s96, s38, 10
    s_add_u32 s96, s96, 3552
    v_bfe_u32 v11, v1, 1, 1
    v_mul_u32_u24 v11, 4672, v11
    v_lshl_add_u32 v11, v10, 4, v11
    v_lshrrev_b32 v10, 2, v1
    v_lshl_add_u32 v11, v10, 5, v11
    v_add_u32 v11, s96, v11
    v_add_u32 v10, s96, v9
    v_mov_b32 v116, s38
    s_add_u32 s92, s92, 0xb00000
    v_lshrrev_b32 v12, 2, v1
    v_lshl_add_u32 v12, v12, 6, v59
    v_add_u32 v12, s92, v12
    s_cmp_lt_u32 s41, 8
    s_cselect_b32 s94, 8, 8
    s_cmp_ge_u32 s41, 24
    s_cselect_b32 s94, 20, s94
    v_mov_b32 v14, s94
    s_setprio 0
    ds_write_b8 v116, v5 offset:204
W_79:
    s_sleep 2
    ds_read_b32 v8, v14 offset:64
    s_sub_u32 s39, s39, 1
    s_cbranch_scc1 KS_ABORT
    s_waitcnt lgkmcnt(0)
    v_cmp_ne_u32 vcc, s84, v8
    s_cbranch_vccnz W_79
    s_setprio 3
    s_branch UPE_81
UP_80:
    s_sleep 2
UPE_81:
    buffer_load_dwordx4 v[20:23], v13, s[64:67], s93 offen sc1
    buffer_load_dwordx4 v[24:27], v13, s[64:67], s97 offen sc1
    buffer_load_dwordx4 v[28:31], v7, s[64:67], s95 offen sc1
    s_sub_u32 s39, s39, 1
    s_cbranch_scc1 KS_ABORT
    s_waitcnt vmcnt(2)
    v_xor_b32 v20, v60, v20
    v_xor_b32 v21, v61, v21
    v_xor_b32 v22, v62, v22
    v_xor_b32 v23, v63, v23
    v_or3_b32 v44, v20, v21, v21
    v_or3_b32 v44, v22, v23, v44
    s_waitcnt vmcnt(1)
    v_xor_b32 v24, v60, v24
    v_xor_b32 v25, v61, v25
    v_xor_b32 v26, v62, v26
    v_xor_b32 v27, v63, v27
    v_or3_b32 v44, v24, v25, v44
    v_or3_b32 v44, v26, v27, v44
    s_waitcnt vmcnt(0)
    v_xor_b32 v28, v64, v28
    v_xor_b32 v29, v65, v29
    v_xor_b32 v30, v66, v30
    v_xor_b32 v31, v67, v31
    v_or3_b32 v44, v28, v29, v44
    v_or3_b32 v44, v30, v31, v44
    v_and_b32 v44, 0x70007, v44
    v_cmp_ne_u32 vcc, 0, v44
    s_cbranch_vccnz UP_80
    ds_write_b128 v11, v[20:23]
    ds_write_b128 v11, v[24:27] offset:512
    ds_write_b128 v10, v[28:31] offset:9344
    ds_write_b8 v116, v5 offset:16
    s_cmp_eq_u32 s38, 2
    s_cbranch_scc1 WJ2_84
    s_add_u32 s92, s38, 1
    s_lshr_b32 s92, s92, 2
    s_cmp_eq_u32 s38, 1
    s_cselect_b32 s92, 2, s92
    s_lshl_b32 s92, s92, 10
    v_lshl_add_u32 v10, v1, 4, s92
    v_add_u32 v11, 35840, v10
W_85:
    ds_read_b32 v12, v4 offset:16
    s_sub_u32 s39, s39, 1
    s_cbranch_scc1 KS_ABORT
    s_waitcnt lgkmcnt(0)
    v_cmp_ne_u32 vcc, s84, v12
    s_cbranch_vccnz W_85
    s_setprio 3
    ds_read_b128 v[20:23], v10 offset:3520
    ds_read_b128 v[24:27], v10 offset:3536
    ds_read_b64 v[28:29], v10 offset:3552
    ds_read_b128 v[32:35], v10 offset:8192
    ds_read_b128 v[36:39], v10 offset:8208
    ds_read_b64 v[40:41], v10 offset:8224
    ds_read_b128 v[44:47], v10 offset:12864
    ds_read_b128 v[48:51], v10 offset:12880
    ds_read_b64 v[52:53], v10 offset:12896
    s_cmp_eq_u32 s38, 1
    s_cbranch_scc1 WJ1_83
    ds_read_b32 v12, v4 offset:68
    s_waitcnt lgkmcnt(7)
    v_alignbit_b32 v57, v22, v21, 16
    v_alignbit_b32 v58, v23, v22, 16
    v_alignbit_b32 v59, v24, v23, 16
    v_alignbit_b32 v60, v25, v24, 16
    v_alignbit_b32 v61, v26, v25, 16
    v_alignbit_b32 v62, v27, v26, 16
    v_alignbit_b32 v63, v28, v27, 16
    v_alignbit_b32 v64, v29, v28, 16
    v_pk_add_f16 v66, v57, v22
    v_pk_add_f16 v67, v58, v23
    v_pk_add_f16 v68, v59, v24
    v_pk_add_f16 v69, v60, v25
    v_pk_add_f16 v70, v61, v26
    v_pk_add_f16 v71, v62, v27
    v_pk_add_f16 v72, v63, v28
    v_pk_add_f16 v73, v64, v29
    v_pk_add_f16 v80, v66, v58
    v_pk_add_f16 v81, v67, v59
    v_pk_add_f16 v82, v68, v60
    v_pk_add_f16 v83, v69, v61
    v_pk_add_f16 v74, v67, v68
    v_pk_add_f16 v75, v68, v69
    v_pk_add_f16 v76, v69, v70
    v_pk_add_f16 v77, v70, v71
    v_pk_add_f16 v78, v71, v72
    v_pk_add_f16 v79, v72, v73
    s_waitcnt lgkmcnt(0)
    v_cmp_eq_u32 vcc, s84, v12
    s_cbranch_vccnz WJK_86
W_87:
    s_sleep 1
    ds_read_b32 v12, v4 offset:68
    s_sub_u32 s39, s39, 1
    s_cbranch_scc1 KS_ABORT
    s_waitcnt lgkmcnt(0)
    v_cmp_ne_u32 vcc, s84, v12
    s_cbranch_vccnz W_87
WJK_86:
    ds_write_b128 v11, v[80:83] offset:0
    v_pk_add_f16 v87, v22, v74
    v_pk_add_f16 v88, v23, v75
    v_pk_add_f16 v89, v24, v76
    v_pk_add_f16 v90, v25, v77
    v_pk_add_f16 v91, v26, v78
    ds_write_b128 v11, v[88:91] offset:3104
    v_pk_add_f16 v84, v70, v62
    v_pk_add_f16 v85, v71, v63
    v_pk_add_f16 v86, v72, v64
    v_pk_add_f16 v92, v74, v83
    v_pk_add_f16 v93, v75, v84
    v_pk_add_f16 v94, v76, v85
    v_pk_add_f16 v95, v77, v86
    ds_write_b128 v11, v[92:95] offset:6176
    v_pk_add_f16 v96, v87, v76
    v_pk_add_f16 v97, v88, v77
    v_pk_add_f16 v98, v89, v78
    v_pk_add_f16 v99, v90, v79
    ds_write_b128 v11, v[96:99] offset:8240
    ds_write_b8 v116, v5 offset:76
    ds_read_b32 v12, v4 offset:84
    v_alignbit_b32 v57, v34, v33, 16
    v_alignbit_b32 v58, v35, v34, 16
    v_alignbit_b32 v59, v36, v35, 16
    v_alignbit_b32 v60, v37, v36, 16
    v_alignbit_b32 v61, v38, v37, 16
    v_alignbit_b32 v62, v39, v38, 16
    v_alignbit_b32 v63, v40, v39, 16
    v_alignbit_b32 v64, v41, v40, 16
    v_pk_add_f16 v66, v57, v34
    v_pk_add_f16 v67, v58, v35
    v_pk_add_f16 v68, v59, v36
    v_pk_add_f16 v69, v60, v37
    v_pk_add_f16 v70, v61, v38
    v_pk_add_f16 v71, v62, v39
    v_pk_add_f16 v72, v63, v40
    v_pk_add_f16 v73, v64, v41
    v_pk_add_f16 v80, v66, v58
    v_pk_add_f16 v81, v67, v59
    v_pk_add_f16 v82, v68, v60
    v_pk_add_f16 v83, v69, v61
    v_pk_add_f16 v74, v67, v68
    v_pk_add_f16 v75, v68, v69
    v_pk_add_f16 v76, v69, v70
    v_pk_add_f16 v77, v70, v71
    v_pk_add_f16 v78, v71, v72
    v_pk_add_f16 v79, v72, v73
    s_waitcnt lgkmcnt(0)
    v_cmp_eq_u32 vcc, s84, v12
    s_cbranch_vccnz WJK_88
W_89:
    s_sleep 1
    ds_read_b32 v12, v4 offset:84
    s_sub_u32 s39, s39, 1
    s_cbranch_scc1 KS_ABORT
    s_waitcnt lgkmcnt(0)
    v_cmp_ne_u32 vcc, s84, v12
    s_cbranch_vccnz W_89
WJK_88:
    ds_write_b128 v11, v[80:83] offset:36672
    v_pk_add_f16 v87, v34, v74
    v_pk_add_f16 v88, v35, v75
    v_pk_add_f16 v89, v36, v76
    v_pk_add_f16 v90, v37, v77
    v_pk_add_f16 v91, v38, v78
    ds_write_b128 v11, v[88:91] offset:39776
    v_pk_add_f16 v84, v70, v62
    v_pk_add_f16 v85, v71, v63
    v_pk_add_f16 v86, v72, v64
    v_pk_add_f16 v92, v74, v83
    v_pk_add_f16 v93, v75, v84
    v_pk_add_f16 v94, v76, v85
    v_pk_add_f16 v95, v77, v86
    ds_write_b128 v11, v[92:95] offset:42848
    v_pk_add_f16 v96, v87, v76
    v_pk_add_f16 v97, v88, v77
    v_pk_add_f16 v98, v89, v78
    v_pk_add_f16 v99, v90, v79
    ds_write_b128 v11, v[96:99] offset:44912
    ds_write_b8 v116, v5 offset:92
    s_cmp_lt_u32 s41, 24
    s_cbranch_scc1 WJE_82
    ds_read_b32 v12, v4 offset:100
    v_alignbit_b32 v57, v46, v45, 16
    v_alignbit_b32 v58, v47, v46, 16
    v_alignbit_b32 v59, v48, v47, 16
    v_alignbit_b32 v60, v49, v48, 16
    v_alignbit_b32 v61, v50, v49, 16
    v_alignbit_b32 v62, v51, v50, 16
    v_alignbit_b32 v63, v52, v51, 16
    v_alignbit_b32 v64, v53, v52, 16
    v_pk_add_f16 v66, v57, v46
    v_pk_add_f16 v67, v58, v47
    v_pk_add_f16 v68, v59, v48
    v_pk_add_f16 v69, v60, v49
    v_pk_add_f16 v70, v61, v50
    v_pk_add_f16 v71, v62, v51
    v_pk_add_f16 v72, v63, v52
    v_pk_add_f16 v73, v64, v53
    v_pk_add_f16 v80, v66, v58
    v_pk_add_f16 v81, v67, v59
    v_pk_add_f16 v82, v68, v60
    v_pk_add_f16 v83, v69, v61
    v_pk_add_f16 v74, v67, v68
    v_pk_add_f16 v75, v68, v69
    v_pk_add_f16 v76, v69, v70
    v_pk_add_f16 v77, v70, v71
    v_pk_add_f16 v78, v71, v72
    v_pk_add_f16 v79, v72, v73
    s_waitcnt lgkmcnt(0)
    v_cmp_eq_u32 vcc, s84, v12
    s_cbranch_vccnz WJK_90
W_91:
    s_sleep 1
    ds_read_b32 v12, v4 offset:100
    s_sub_u32 s39, s39, 1
    s_cbranch_scc1 KS_ABORT
    s_waitcnt lgkmcnt(0)
    v_cmp_ne_u32 vcc, s84, v12
    s_cbranch_vccnz W_91
WJK_90:
    v_add_u32 v11, 73344, v11
    ds_write_b128 v11, v[80:83] offset:0
    v_pk_add_f16 v87, v46, v74
    v_pk_add_f16 v88, v47, v75
    v_pk_add_f16 v89, v48, v76
    v_pk_add_f16 v90, v49, v77
    v_pk_add_f16 v91, v50, v78
    ds_write_b128 v11, v[88:91] offset:3104
    v_pk_add_f16 v84, v70, v62
    v_pk_add_f16 v85, v71, v63
    v_pk_add_f16 v86, v72, v64
    v_pk_add_f16 v92, v74, v83
    v_pk_add_f16 v93, v75, v84
    v_pk_add_f16 v94, v76, v85
    v_pk_add_f16 v95, v77, v86
    ds_write_b128 v11, v[92:95] offset:6176
    v_pk_add_f16 v96, v87, v76
    v_pk_add_f16 v97, v88, v77
    v_pk_add_f16 v98, v89, v78
    v_pk_add_f16 v99, v90, v79
    ds_write_b128 v11, v[96:99] offset:8240
    ds_write_b8 v116, v5 offset:108
    s_branch WJE_82
WJ1_83:
    ds_read_b32 v12, v4 offset:68
    s_waitcnt lgkmcnt(7)
    v_alignbit_b32 v57, v22, v21, 16
    v_alignbit_b32 v58, v23, v22, 16
    v_alignbit_b32 v59, v24, v23, 16
    v_alignbit_b32 v60, v25, v24, 16
    v_alignbit_b32 v61, v26, v25, 16
    v_alignbit_b32 v62, v27, v26, 16
    v_alignbit_b32 v63, v28, v27, 16
    v_pk_add_f16 v66, v57, v22
    v_pk_add_f16 v67, v58, v23
    v_pk_add_f16 v68, v59, v24
    v_pk_add_f16 v69, v60, v25
    v_pk_add_f16 v70, v61, v26
    v_pk_add_f16 v71, v62, v27
    v_pk_add_f16 v72, v63, v28
    v_pk_add_f16 v80, v66, v58
    v_pk_add_f16 v81, v67, v59
    v_pk_add_f16 v82, v68, v60
    v_pk_add_f16 v83, v69, v61
    v_pk_add_f16 v75, v68, v69
    v_pk_add_f16 v76, v69, v70
    v_pk_add_f16 v77, v70, v71
    v_pk_add_f16 v78, v71, v72
    s_waitcnt lgkmcnt(0)
    v_cmp_eq_u32 vcc, s84, v12
    s_cbranch_vccnz WJK_92
W_93:
    s_sleep 1
    ds_read_b32 v12, v4 offset:68
    s_sub_u32 s39, s39, 1
    s_cbranch_scc1 KS_ABORT
    s_waitcnt lgkmcnt(0)
    v_cmp_ne_u32 vcc, s84, v12
    s_cbranch_vccnz W_93
WJK_92:
    ds_write_b128 v11, v[80:83] offset:0
    v_pk_add_f16 v88, v23, v75
    v_pk_add_f16 v89, v24, v76
    v_pk_add_f16 v90, v25, v77
    v_pk_add_f16 v91, v26, v78
    ds_write_b128 v11, v[88:91] offset:3104
    ds_write_b8 v116, v5 offset:76
    ds_read_b32 v12, v4 offset:84
    v_alignbit_b32 v57, v34, v33, 16
    v_alignbit_b32 v58, v35, v34, 16
    v_alignbit_b32 v59, v36, v35, 16
    v_alignbit_b32 v60, v37, v36, 16
    v_alignbit_b32 v61, v38, v37, 16
    v_alignbit_b32 v62, v39, v38, 16
    v_alignbit_b32 v63, v40, v39, 16
    v_pk_add_f16 v66, v57, v34
    v_pk_add_f16 v67, v58, v35
    v_pk_add_f16 v68, v59, v36
    v_pk_add_f16 v69, v60, v37
    v_pk_add_f16 v70, v61, v38
    v_pk_add_f16 v71, v62, v39
    v_pk_add_f16 v72, v63, v40
    v_pk_add_f16 v80, v66, v58
    v_pk_add_f16 v81, v67, v59
    v_pk_add_f16 v82, v68, v60
    v_pk_add_f16 v83, v69, v61
    v_pk_add_f16 v75, v68, v69
    v_pk_add_f16 v76, v69, v70
    v_pk_add_f16 v77, v70, v71
    v_pk_add_f16 v78, v71, v72
    s_waitcnt lgkmcnt(0)
    v_cmp_eq_u32 vcc, s84, v12
    s_cbranch_vccnz WJK_94
W_95:
    s_sleep 1
    ds_read_b32 v12, v4 offset:84
    s_sub_u32 s39, s39, 1
    s_cbranch_scc1 KS_ABORT
    s_waitcnt lgkmcnt(0)
    v_cmp_ne_u32 vcc, s84, v12
    s_cbranch_vccnz W_95
WJK_94:
    ds_write_b128 v11, v[80:83] offset:36672
    v_pk_add_f16 v88, v35, v75
    v_pk_add_f16 v89, v36, v76
    v_pk_add_f16 v90, v37, v77
    v_pk_add_f16 v91, v38, v78
    ds_write_b128 v11, v[88:91] offset:39776
    ds_write_b8 v116, v5 offset:92
    s_cmp_lt_u32 s41, 24
    s_cbranch_scc1 WJE_82
    ds_read_b32 v12, v4 offset:100
    v_alignbit_b32 v57, v46, v45, 16
    v_alignbit_b32 v58, v47, v46, 16
    v_alignbit_b32 v59, v48, v47, 16
    v_alignbit_b32 v60, v49, v48, 16
    v_alignbit_b32 v61, v50, v49, 16
    v_alignbit_b32 v62, v51, v50, 16
    v_alignbit_b32 v63, v52, v51, 16
    v_pk_add_f16 v66, v57, v46
    v_pk_add_f16 v67, v58, v47
    v_pk_add_f16 v68, v59, v48
    v_pk_add_f16 v69, v60, v49
    v_pk_add_f16 v70, v61, v50
    v_pk_add_f16 v71, v62, v51
    v_pk_add_f16 v72, v63, v52
    v_pk_add_f16 v80, v66, v58
    v_pk_add_f16 v81, v67, v59
    v_pk_add_f16 v82, v68, v60
    v_pk_add_f16 v83, v69, v61
    v_pk_add_f16 v75, v68, v69
    v_pk_add_f16 v76, v69, v70
    v_pk_add_f16 v77, v70, v71
    v_pk_add_f16 v78, v71, v72
    s_waitcnt lgkmcnt(0)
    v_cmp_eq_u32 vcc, s84, v12
    s_cbranch_vccnz WJK_96
W_97:
    s_sleep 1
    ds_read_b32 v12, v4 offset:100
    s_sub_u32 s39, s39, 1
    s_cbranch_scc1 KS_ABORT
    s_waitcnt lgkmcnt(0)
    v_cmp_ne_u32 vcc, s84, v12
    s_cbranch_vccnz W_97
WJK_96:
    v_add_u32 v11, 73344, v11
    ds_write_b128 v11, v[80:83] offset:0
    v_pk_add_f16 v88, v47, v75
    v_pk_add_f16 v89, v48, v76
    v_pk_add_f16 v90, v49, v77
    v_pk_add_f16 v91, v50, v78
    ds_write_b128 v11, v[88:91] offset:3104
    ds_write_b8 v116, v5 offset:108
    s_branch WJE_82
WJ2_84:
    ds_write_b8 v116, v5 offset:76
    ds_write_b8 v116, v5 offset:92
    ds_write_b8 v116, v5 offset:108
    s_setprio 0
    v_mov_b32_dpp v32, v58 quad_perm:[0,0,0,0] row_mask:0xf bank_mask:0xf
    v_mov_b32_dpp v33, v58 quad_perm:[1,1,1,1] row_mask:0xf bank_mask:0xf
    v_mov_b32_dpp v34, v58 quad_perm:[2,2,2,2] row_mask:0xf bank_mask:0xf
    v_mov_b32_dpp v35, v58 quad_perm:[3,3,3,3] row_mask:0xf bank_mask:0xf
    v_lshlrev_b32 v12, 6, v1
    v_add_u32 v12, 0xb00800, v12
    v_mov_b32 v13, s84
    global_load_dwordx4 v[20:23], v12, s[36:37] offset:-2048 sc1
    global_load_dwordx4 v[24:27], v12, s[36:37] offset:2048 sc1
    s_sub_u32 s94, s41, 18
    s_and_b32 s94, s94, 31
    v_mul_u32_u24 v100, 57, v1
    v_lshrrev_b32 v100, 9, v100
    v_mul_u32_u24 v101, 9, v100
    v_sub_u32 v101, v1, v101
    v_mul_u32_u24 v100, 9216, v100
    v_lshl_add_u32 v100, v101, 7, v100
    s_bitcmp1_b32 s94, 0
    s_cselect_b32 s72, s28, s26
    s_cselect_b32 s73, s29, s27
    s_mov_b32 s74, 0x510000
    s_mov_b32 s75, 0x20000
    s_lshr_b32 s95, s94, 1
    s_mul_i32 s95, s95, 64512
    s_mul_i32 s96, s40, 1152
    s_add_u32 s95, s95, s96
    s_cmp_ge_u32 s94, 14
    s_cselect_b32 s74, 0, s74
W_100:
    s_sleep 1
    ds_read_b32 v102, v4 offset:16
    s_sub_u32 s39, s39, 1
    s_cbranch_scc1 KS_ABORT
    s_waitcnt lgkmcnt(0)
    v_cmp_ne_u32 vcc, s84, v102
    s_cbranch_vccnz W_100
    s_add_u32 s96, s95, 4451328
    buffer_load_dword v102, v100, s[72:75], s96 offen nt
    buffer_load_dword v102, v100, s[72:75], s96 offen sc1
    s_add_u32 s96, s95, 4902912
    buffer_load_dword v102, v100, s[72:75], s96 offen nt
    buffer_load_dword v102, v100, s[72:75], s96 offen sc1
    s_waitcnt vmcnt(4)
    s_branch FPE_99
FP_98:
    s_sleep 2
    global_load_dwordx4 v[20:23], v12, s[36:37] offset:-2048 sc1
    global_load_dwordx4 v[24:27], v12, s[36:37] offset:2048 sc1
    s_sub_u32 s39, s39, 1
    s_cbranch_scc1 KS_ABORT
    s_waitcnt vmcnt(0)
FPE_99:
    v_xor_b32 v20, v32, v20
    v_xor_b32 v21, v33, v21
    v_xor_b32 v22, v34, v22
    v_xor_b32 v23, v35, v23
    v_xor_b32 v24, v32, v24
    v_xor_b32 v25, v33, v25
    v_xor_b32 v26, v34, v26
    v_xor_b32 v27, v35, v27
    v_or3_b32 v20, v20, v21, v22
    v_or3_b32 v23, v23, v24, v25
    v_or3_b32 v20, v20, v26, v27
    v_or_b32 v20, v20, v23
    v_cmp_ne_u32 vcc, 0, v20
    s_cbranch_vccnz FP_98
    ds_write2_b32 v4, v13, v13 offset0:28 offset1:36
    s_branch WJE_82
    s_sub_u32 s94, s41, 18
    s_and_b32 s94, s94, 31
    s_cmp_ge_u32 s94, 14
    s_cbranch_scc1 WJE_82
    v_mul_u32_u24 v100, 57, v1
    v_lshrrev_b32 v100, 9, v100
    v_mul_u32_u24 v101, 9, v100
    v_sub_u32 v101, v1, v101
    v_mul_u32_u24 v100, 9216, v100
    v_lshl_add_u32 v100, v101, 7, v100
W_101:
    s_sleep 1
    ds_read_b32 v12, v4 offset:16
    s_sub_u32 s39, s39, 1
    s_cbranch_scc1 KS_ABORT
    s_waitcnt lgkmcnt(0)
    v_cmp_ne_u32 vcc, s84, v12
    s_cbranch_vccnz W_101
    s_bitcmp1_b32 s94, 0
    s_cselect_b32 s72, s28, s26
    s_cselect_b32 s73, s29, s27
    s_mov_b32 s74, 0x510000
    s_mov_b32 s75, 0x20000
    s_lshr_b32 s95, s94, 1
    s_mul_i32 s95, s95, 64512
    s_mul_i32 s96, s40, 1152
    s_add_u32 s95, s95, s96
    s_add_u32 s96, s95, 4451328
    buffer_load_dword v102, v100, s[72:75], s96 offen nt
    buffer_load_dword v102, v100, s[72:75], s96 offen sc1
    s_add_u32 s96, s95, 4902912
    buffer_load_dword v102, v100, s[72:75], s96 offen nt
    buffer_load_dword v102, v100, s[72:75], s96 offen sc1
KS_PF2D:
WJE_82:
    s_setprio 0
    s_lshr_b32 s92, s90, 6
    s_lshl_b32 s92, s92, 9
    s_bfe_u32 s93, s90, 0x20004
    s_lshl_b32 s93, s93, 6
    s_add_u32 s92, s92, s93
    s_and_b32 s93, s90, 3
    s_lshl_b32 s93, s93, 4
    s_add_u32 s92, s92, s93
    s_and_b32 s93, s90, 12
    s_add_u32 s92, s92, s93
    s_lshr_b32 s93, s38, 1
    s_lshl_b32 s93, s93, 8
    s_add_u32 s92, s92, s93
    s_and_b32 s93, s38, 1
    s_lshl_b32 s93, s93, 1
    s_add_u32 s92, s92, s93
    v_lshrrev_b32 v113, 5, v1
    v_and_b32 v114, 31, v1
    v_add_u32 v112, s92, v113
    v_mul_u32_u24 v115, 1152, v112
    v_lshl_add_u32 v8, v114, 2, v115
    v_lshl_add_u32 v115, v114, 4, v115
    v_lshlrev_b32 v7, 2, v114
    v_lshlrev_b32 v6, 4, v114
    v_bfe_u32 v111, v1, 3, 1
    v_add_u32 v111, s92, v111
    v_mul_u32_u24 v111, 1152, v111
    v_and_b32 v9, 7, v1
    v_lshl_add_u32 v111, v9, 4, v111
    s_mov_b32 s64, s4
    s_mov_b32 s65, s5
    s_mov_b32 s66, 0x240000
    s_mov_b32 s67, 0x20000
    s_mov_b32 s68, s24
    s_mov_b32 s69, s25
    s_mov_b32 s70, 0x480
    s_mov_b32 s71, 0x20000
    buffer_load_dwordx4 v[10:13], v115, s[64:67], 0 offen
    buffer_load_dwordx4 v[14:17], v115, s[64:67], 0 offen offset:512
    buffer_load_dword v18, v8, s[64:67], 0 offen offset:1024
    buffer_load_dwordx4 v[50:53], v6, s[68:71], 0 offen
    buffer_load_dwordx4 v[54:57], v6, s[68:71], 0 offen offset:512
    buffer_load_dword v58, v7, s[68:71], 0 offen offset:1024
KS_L4:
    s_add_u32 s64, s36, 0x600000
    s_addc_u32 s65, s37, 0
    s_mov_b32 s66, 0x240000
    s_mov_b32 s67, 0x20000
    s_mov_b32 s68, s32
    s_mov_b32 s69, s33
    s_mov_b32 s70, 0x240000
    s_mov_b32 s71, 0x20000
    s_mov_b32 s72, s36
    s_mov_b32 s73, s37
    s_mov_b32 s74, 0x240000
    s_mov_b32 s75, 0x20000
    s_add_u32 s76, s36, 0x840000
    s_addc_u32 s77, s37, 0
    s_mov_b32 s78, 0x4000
    s_mov_b32 s79, 0x20000
    s_not_b32 s93, s90
    v_xor_b32 v8, s93, v0
    v_lshrrev_b32 v6, 1, v0
    v_lshlrev_b32 v6, 6, v6
    v_and_b32 v8, 1, v8
    v_lshl_add_u32 v6, v8, 4, v6
    s_lshr_b32 s92, s90, 2
    s_lshl_b32 s92, s92, 15
    s_and_b32 s93, s90, 1
    s_lshl_b32 s93, s93, 14
    s_add_u32 s92, s92, s93
    s_and_b32 s93, s90, 2
    s_lshl_b32 s93, s93, 4
    s_add_u32 s92, s92, s93
    s_lshr_b32 s94, s90, 2
    s_lshl_b32 s94, s94, 12
    s_and_b32 s93, s90, 3
    s_lshl_b32 s93, s93, 4
    s_add_u32 s94, s94, s93
    s_lshl_b32 s93, s38, 10
    s_add_u32 s94, s94, s93
    s_add_u32 s94, s94, 0x200000
    v_lshlrev_b32 v9, 6, v2
    s_lshl_b32 s93, s90, 5
    s_and_b32 s95, s93, 0x1f80
    v_xor_b32 v6, s95, v6
    s_and_b32 s95, s93, 0x380
    v_xor_b32 v9, s95, v9
    s_and_b32 s95, s93, 0xc00
    s_xor_b32 s94, s94, s95
    s_and_b32 s93, s90, 1
    s_lshl_b32 s93, s93, 13
    s_xor_b32 s92, s92, s93
    s_xor_b32 s93, s92, 0x2000
    s_mul_i32 s95, s38, 2304
    s_add_u32 s95, s95, 17088
    v_lshl_add_u32 v117, v114, 5, s95
    v_lshl_add_u32 v110, v114, 3, s95
    s_lshl_b32 s95, s38, 9
    s_add_u32 s95, s95, 26368
    v_lshl_add_u32 v108, v1, 2, s95
    v_lshl_add_u32 v109, v1, 4, s95
    v_lshlrev_b32 v118, 4, v113
    s_movk_i32 s95, 0x3f80
    v_lshlrev_b32 v118, v118, s95
    v_lshlrev_b32 v8, 2, v0
    v_add_u32 v8, 17088, v8
    s_lshl_b32 s95, s38, 6
    s_add_u32 s95, s95, 19136
    v_lshl_add_u32 v119, v2, 2, s95
    s_waitcnt vmcnt(0)
    v_lshlrev_b32 v20, 16, v10
    v_and_b32 v21, 0xffff0000, v10
    v_lshlrev_b32 v22, 16, v11
    v_and_b32 v23, 0xffff0000, v11
    v_lshlrev_b32 v24, 16, v12
    v_and_b32 v25, 0xffff0000, v12
    v_lshlrev_b32 v26, 16, v13
    v_and_b32 v27, 0xffff0000, v13
    v_lshlrev_b32 v28, 16, v14
    v_and_b32 v29, 0xffff0000, v14
    v_lshlrev_b32 v30, 16, v15
    v_and_b32 v31, 0xffff0000, v15
    v_lshlrev_b32 v32, 16, v16
    v_and_b32 v33, 0xffff0000, v16
    v_lshlrev_b32 v34, 16, v17
    v_and_b32 v35, 0xffff0000, v17
    v_lshlrev_b32 v36, 16, v18
    v_and_b32 v37, 0xffff0000, v18
    v_lshlrev_b32 v80, 16, v50
    v_and_b32 v81, 0xffff0000, v50
    v_lshlrev_b32 v82, 16, v51
    v_and_b32 v83, 0xffff0000, v51
    v_lshlrev_b32 v84, 16, v52
    v_and_b32 v85, 0xffff0000, v52
    v_lshlrev_b32 v86, 16, v53
    v_and_b32 v87, 0xffff0000, v53
    v_lshlrev_b32 v88, 16, v54
    v_and_b32 v89, 0xffff0000, v54
    v_lshlrev_b32 v90, 16, v55
    v_and_b32 v91, 0xffff0000, v55
    v_lshlrev_b32 v92, 16, v56
    v_and_b32 v93, 0xffff0000, v56
    v_lshlrev_b32 v94, 16, v57
    v_and_b32 v95, 0xffff0000, v57
    v_lshlrev_b32 v96, 16, v58
    v_and_b32 v97, 0xffff0000, v58
    v_pk_add_f32 v[78:79], v[80:81], v[82:83]
    v_pk_add_f32 v[78:79], v[78:79], v[84:85]
    v_pk_add_f32 v[78:79], v[78:79], v[86:87]
    v_pk_add_f32 v[78:79], v[78:79], v[88:89]
    v_pk_add_f32 v[78:79], v[78:79], v[90:91]
    v_pk_add_f32 v[78:79], v[78:79], v[92:93]
    v_pk_add_f32 v[78:79], v[78:79], v[94:95]
    v_pk_add_f32 v[78:79], v[78:79], v[96:97]
    v_add_f32 v78, v78, v79
    s_nop 1
    v_add_f32_dpp v78, v78, v78 row_ror:8 row_mask:0xf bank_mask:0xf
    s_nop 1
    v_add_f32_dpp v78, v78, v78 row_ror:4 row_mask:0xf bank_mask:0xf
    s_nop 1
    v_add_f32_dpp v78, v78, v78 row_ror:2 row_mask:0xf bank_mask:0xf
    s_nop 1
    v_add_f32_dpp v78, v78, v78 row_ror:1 row_mask:0xf bank_mask:0xf
    v_mov_b32 v79, v78
    s_nop 1
    v_permlane16_swap_b32 v78, v79
    v_add_f32 v78, v78, v79
    v_sub_u32 v98, 0x87ff, v112
    v_lshl_add_u32 v99, v116, 1, v113
    v_lshlrev_b32 v99, 2, v99
    s_lshl_b32 s97, s90, 5
W_102:
    s_sleep 1
    ds_read_b32 v60, v4 offset:52
    s_sub_u32 s39, s39, 1
    s_cbranch_scc1 KS_ABORT
    s_waitcnt lgkmcnt(0)
    v_cmp_ne_u32 vcc, s84, v60
    s_cbranch_vccnz W_102
    s_setprio 3
    s_sub_u32 s95, s41, 8
    s_cmp_ge_u32 s95, 16
    s_cbranch_scc1 KS_ZGC
    s_branch ZPE_104
ZP_103:
    s_sleep 1
ZPE_104:
    buffer_load_dwordx4 v[68:71], v4, s[64:67], s94 offen sc1
    s_sub_u32 s39, s39, 1
    s_cbranch_scc1 KS_ABORT
    s_waitcnt vmcnt(0)
    v_max3_u32 v44, v68, v69, v70
    v_max_u32 v44, v44, v71
    v_cmp_eq_u32 vcc, -1, v44
    s_cbranch_vccnz ZP_103
KS_ZGC:
    s_branch ZPE_106
ZP_105:
    s_sleep 1
ZPE_106:
    buffer_load_dwordx4 v[60:63], v6, s[64:67], s92 offen sc1
    buffer_load_dwordx4 v[64:67], v6, s[64:67], s93 offen sc1
    buffer_load_dwordx4 v[68:71], v9, s[64:67], s94 offen sc1
    s_sub_u32 s39, s39, 1
    s_cbranch_scc1 KS_ABORT
    s_waitcnt vmcnt(2)
    ds_write2st64_b32 v8, v60, v61 offset0:0 offset1:9
    ds_write2st64_b32 v8, v62, v63 offset0:18 offset1:27
    v_max3_u32 v44, v60, v61, v61
    v_max3_u32 v44, v62, v63, v44
    s_waitcnt vmcnt(1)
    ds_write2st64_b32 v8, v64, v65 offset0:4 offset1:13
    ds_write2st64_b32 v8, v66, v67 offset0:22 offset1:31
    v_max3_u32 v44, v64, v65, v44
    v_max3_u32 v44, v66, v67, v44
    s_waitcnt vmcnt(0)
    ds_write2st64_b32 v119, v68, v69 offset0:0 offset1:9
    ds_write2st64_b32 v119, v70, v71 offset0:18 offset1:27
    v_max3_u32 v44, v68, v69, v44
    v_max3_u32 v44, v70, v71, v44
    v_cmp_eq_u32 vcc, -1, v44
    s_cbranch_vccnz ZP_105
    ds_write_b8 v116, v5 offset:20
ZW_107:
    ds_read_b32 v44, v4 offset:20
    ds_read_b128 v[60:63], v117 offset:0
    ds_read_b128 v[64:67], v117 offset:16
    ds_read_b128 v[68:71], v117 offset:1024
    ds_read_b128 v[72:75], v117 offset:1040
    ds_read_b64 v[76:77], v110 offset:2048
    s_sub_u32 s39, s39, 1
    s_cbranch_scc1 KS_ABORT
    s_waitcnt lgkmcnt(5)
    v_cmp_ne_u32 vcc, s84, v44
    s_cbranch_vccnz ZW_107
    s_waitcnt lgkmcnt(4)
    v_dot2c_f32_bf16 v20, v60, v118
    v_dot2c_f32_bf16 v21, v61, v118
    v_dot2c_f32_bf16 v22, v62, v118
    v_dot2c_f32_bf16 v23, v63, v118
    s_waitcnt lgkmcnt(3)
    v_dot2c_f32_bf16 v24, v64, v118
    v_dot2c_f32_bf16 v25, v65, v118
    v_pk_mul_f32 v[42:43], v[20:21], v[20:21]
    v_pk_mul_f32 v[44:45], v[20:21], v[80:81]
    v_dot2c_f32_bf16 v26, v66, v118
    v_dot2c_f32_bf16 v27, v67, v118
    v_pk_fma_f32 v[42:43], v[22:23], v[22:23], v[42:43]
    v_pk_fma_f32 v[44:45], v[22:23], v[82:83], v[44:45]
    v_pk_add_f32 v[40:41], v[22:23], v[20:21]
    s_waitcnt lgkmcnt(2)
    v_dot2c_f32_bf16 v28, v68, v118
    v_dot2c_f32_bf16 v29, v69, v118
    v_pk_fma_f32 v[42:43], v[24:25], v[24:25], v[42:43]
    v_pk_fma_f32 v[44:45], v[24:25], v[84:85], v[44:45]
    v_pk_add_f32 v[40:41], v[24:25], v[40:41]
    v_dot2c_f32_bf16 v30, v70, v118
    v_dot2c_f32_bf16 v31, v71, v118
    v_pk_fma_f32 v[42:43], v[26:27], v[26:27], v[42:43]
    v_pk_fma_f32 v[44:45], v[26:27], v[86:87], v[44:45]
    v_pk_add_f32 v[40:41], v[26:27], v[40:41]
    s_waitcnt lgkmcnt(1)
    v_dot2c_f32_bf16 v32, v72, v118
    v_dot2c_f32_bf16 v33, v73, v118
    v_pk_fma_f32 v[42:43], v[28:29], v[28:29], v[42:43]
    v_pk_fma_f32 v[44:45], v[28:29], v[88:89], v[44:45]
    v_pk_add_f32 v[40:41], v[28:29], v[40:41]
    v_dot2c_f32_bf16 v34, v74, v118
    v_dot2c_f32_bf16 v35, v75, v118
    v_pk_fma_f32 v[42:43], v[30:31], v[30:31], v[42:43]
    v_pk_fma_f32 v[44:45], v[30:31], v[90:91], v[44:45]
    v_pk_add_f32 v[40:41], v[30:31], v[40:41]
    s_waitcnt lgkmcnt(0)
    v_dot2c_f32_bf16 v36, v76, v118
    v_dot2c_f32_bf16 v37, v77, v118
    v_pk_fma_f32 v[42:43], v[32:33], v[32:33], v[42:43]
    v_pk_fma_f32 v[44:45], v[32:33], v[92:93], v[44:45]
    v_pk_add_f32 v[40:41], v[32:33], v[40:41]
    v_pk_fma_f32 v[42:43], v[34:35], v[34:35], v[42:43]
    v_pk_fma_f32 v[44:45], v[34:35], v[94:95], v[44:45]
    v_pk_add_f32 v[40:41], v[34:35], v[40:41]
    v_pk_fma_f32 v[42:43], v[36:37], v[36:37], v[42:43]
    v_pk_fma_f32 v[44:45], v[36:37], v[96:97], v[44:45]
    v_pk_add_f32 v[40:41], v[36:37], v[40:41]
    v_add_f32 v42, v42, v43
    v_add_f32 v44, v44, v45
    v_add_f32 v40, v40, v41
    v_mov_b32 v41, v40
    v_permlane16_swap_b32 v42, v44
    s_nop 0
    v_permlane16_swap_b32 v40, v41
    v_add_f32 v42, v42, v44
    v_add_f32 v40, v40, v41
    s_nop 0
    v_add_f32_dpp v42, v42, v42 row_ror:8 row_mask:0xf bank_mask:0xf
    v_add_f32_dpp v40, v40, v40 row_ror:8 row_mask:0xf bank_mask:0xf
    s_nop 0
    v_add_f32_dpp v42, v42, v42 row_ror:4 row_mask:0xf bank_mask:0xf
    v_add_f32_dpp v40, v40, v40 row_ror:4 row_mask:0xf bank_mask:0xf
    s_nop 0
    v_add_f32_dpp v42, v42, v42 row_ror:2 row_mask:0xf bank_mask:0xf
    v_add_f32_dpp v40, v40, v40 row_ror:2 row_mask:0xf bank_mask:0xf
    s_nop 0
    v_add_f32_dpp v42, v42, v42 row_ror:1 row_mask:0xf bank_mask:0xf
    v_add_f32_dpp v40, v40, v40 row_ror:1 row_mask:0xf bank_mask:0xf
    v_mul_f32 v40, 0x3ae38e39, v40
    v_mov_b32 v44, v42
    v_cvt_pk_bf16_f32 v41, 0, v40
    v_mul_f32 v40, v40, v40
    v_permlane16_swap_b32 v42, v44
    v_mov_b32 v43, 0x3ae38e39
    v_fma_f32 v42, v42, v43, -v40
    v_fma_f32 v44, -v41, v78, v44
    v_max_f32 v42, 0, v42
    v_cvt_pk_bf16_f32 v42, 0, v42
    v_add_f32 v42, 0x3727c5ac, v42
    v_cvt_pk_bf16_f32 v42, 0, v42
    v_sqrt_f32 v42, v42
    s_nop 0
    v_cvt_pk_bf16_f32 v42, 0, v42
    v_rcp_f32 v42, v42
    s_nop 0
    v_mul_f32 v60, v44, v42
    v_cvt_pk_bf16_f32 v60, v60, v60
    v_ashrrev_i32 v61, 31, v60
    v_or_b32 v61, 0x80000000, v61
    s_mov_b32 s95, 0xffff0000
    v_xor_b32 v60, v60, v61
    v_and_or_b32 v60, v60, s95, v98
    v_mov_b32 v61, v60
    s_nop 1
    v_permlane32_swap_b32 v60, v61
    s_mov_b64 exec, 1
    buffer_store_dwordx2 v[60:61], v99, s[76:79], s97 offen sc1
    ds_write_b8 v116, v5 offset:12
    s_mov_b64 exec, -1
    s_setprio 2
    v_cvt_pk_bf16_f32 v20, 0, v20
    v_cvt_pk_bf16_f32 v21, 0, v21
    v_cvt_pk_bf16_f32 v22, 0, v22
    v_cvt_pk_bf16_f32 v23, 0, v23
    v_cvt_pk_bf16_f32 v24, 0, v24
    v_cvt_pk_bf16_f32 v25, 0, v25
    v_cvt_pk_bf16_f32 v26, 0, v26
    v_cvt_pk_bf16_f32 v27, 0, v27
    v_cvt_pk_bf16_f32 v28, 0, v28
    v_cvt_pk_bf16_f32 v29, 0, v29
    v_cvt_pk_bf16_f32 v30, 0, v30
    v_cvt_pk_bf16_f32 v31, 0, v31
    v_cvt_pk_bf16_f32 v32, 0, v32
    v_cvt_pk_bf16_f32 v33, 0, v33
    v_cvt_pk_bf16_f32 v34, 0, v34
    v_cvt_pk_bf16_f32 v35, 0, v35
    v_cvt_pk_bf16_f32 v36, 0, v36
    v_cvt_pk_bf16_f32 v37, 0, v37
    v_pk_add_f32 v[44:45], v[20:21], v[22:23]
    v_pk_add_f32 v[46:47], v[24:25], v[26:27]
    v_pk_add_f32 v[44:45], v[44:45], v[28:29]
    v_pk_add_f32 v[46:47], v[46:47], v[30:31]
    v_pk_add_f32 v[44:45], v[44:45], v[32:33]
    v_pk_add_f32 v[46:47], v[46:47], v[34:35]
    v_pk_add_f32 v[44:45], v[44:45], v[36:37]
    v_pk_add_f32 v[44:45], v[44:45], v[46:47]
    v_add_f32 v44, v44, v45
    s_nop 1
    v_add_f32_dpp v44, v44, v44 row_ror:8 row_mask:0xf bank_mask:0xf
    s_nop 1
    v_add_f32_dpp v44, v44, v44 row_ror:4 row_mask:0xf bank_mask:0xf
    s_nop 1
    v_add_f32_dpp v44, v44, v44 row_ror:2 row_mask:0xf bank_mask:0xf
    s_nop 1
    v_add_f32_dpp v44, v44, v44 row_ror:1 row_mask:0xf bank_mask:0xf
    v_mov_b32 v46, v44
    s_nop 1
    v_permlane16_swap_b32 v44, v46
    v_add_f32 v44, v44, v46
    v_mul_f32 v48, 0x3ae38e39, v44
    v_mov_b32 v49, v48
    v_cvt_pk_bf16_f32 v40, 0, v48
    v_cvt_pk_bf16_f32 v41, 0, v48
    v_pk_add_f32 v[42:43], v[20:21], v[48:49] neg_lo:[0,1] neg_hi:[0,1]
    v_pk_mul_f32 v[44:45], v[42:43], v[42:43]
    v_pk_add_f32 v[42:43], v[22:23], v[48:49] neg_lo:[0,1] neg_hi:[0,1]
    v_pk_mul_f32 v[46:47], v[42:43], v[42:43]
    v_pk_add_f32 v[42:43], v[24:25], v[48:49] neg_lo:[0,1] neg_hi:[0,1]
    v_pk_fma_f32 v[44:45], v[42:43], v[42:43], v[44:45]
    v_pk_add_f32 v[42:43], v[26:27], v[48:49] neg_lo:[0,1] neg_hi:[0,1]
    v_pk_fma_f32 v[46:47], v[42:43], v[42:43], v[46:47]
    v_pk_add_f32 v[42:43], v[28:29], v[48:49] neg_lo:[0,1] neg_hi:[0,1]
    v_pk_fma_f32 v[44:45], v[42:43], v[42:43], v[44:45]
    v_pk_add_f32 v[42:43], v[30:31], v[48:49] neg_lo:[0,1] neg_hi:[0,1]
    v_pk_fma_f32 v[46:47], v[42:43], v[42:43], v[46:47]
    v_pk_add_f32 v[42:43], v[32:33], v[48:49] neg_lo:[0,1] neg_hi:[0,1]
    v_pk_fma_f32 v[44:45], v[42:43], v[42:43], v[44:45]
    v_pk_add_f32 v[42:43], v[34:35], v[48:49] neg_lo:[0,1] neg_hi:[0,1]
    v_pk_fma_f32 v[46:47], v[42:43], v[42:43], v[46:47]
    v_pk_add_f32 v[42:43], v[36:37], v[48:49] neg_lo:[0,1] neg_hi:[0,1]
    v_pk_fma_f32 v[44:45], v[42:43], v[42:43], v[44:45]
    v_pk_add_f32 v[44:45], v[44:45], v[46:47]
    v_add_f32 v44, v44, v45
    s_nop 1
    v_add_f32_dpp v44, v44, v44 row_ror:8 row_mask:0xf bank_mask:0xf
    s_nop 1
    v_add_f32_dpp v44, v44, v44 row_ror:4 row_mask:0xf bank_mask:0xf
    s_nop 1
    v_add_f32_dpp v44, v44, v44 row_ror:2 row_mask:0xf bank_mask:0xf
    s_nop 1
    v_add_f32_dpp v44, v44, v44 row_ror:1 row_mask:0xf bank_mask:0xf
    v_mov_b32 v46, v44
    s_nop 1
    v_permlane16_swap_b32 v44, v46
    v_add_f32 v44, v44, v46
    v_mul_f32 v44, 0x3ae38e39, v44
    v_cvt_pk_bf16_f32 v44, 0, v44
    v_add_f32 v44, 0x3727c5ac, v44
    v_cvt_pk_bf16_f32 v44, 0, v44
    v_sqrt_f32 v44, v44
    s_nop 0
    v_cvt_pk_bf16_f32 v44, 0, v44
    v_rcp_f32 v42, v44
    s_nop 0
    v_mov_b32 v43, v42
    v_pk_add_f32 v[44:45], v[20:21], v[40:41] neg_lo:[0,1] neg_hi:[0,1]
    v_cvt_pk_bf16_f32 v44, 0, v44
    v_cvt_pk_bf16_f32 v45, 0, v45
    v_pk_mul_f32 v[44:45], v[44:45], v[42:43]
    v_cvt_pk_bf16_f32 v10, v44, v45
    v_cvt_pk_bf16_f32 v44, 0, v44
    v_cvt_pk_bf16_f32 v45, 0, v45
    v_pk_add_f32 v[20:21], v[44:45], v[20:21]
    v_pk_add_f32 v[44:45], v[22:23], v[40:41] neg_lo:[0,1] neg_hi:[0,1]
    v_cvt_pk_bf16_f32 v44, 0, v44
    v_cvt_pk_bf16_f32 v45, 0, v45
    v_pk_mul_f32 v[44:45], v[44:45], v[42:43]
    v_cvt_pk_bf16_f32 v11, v44, v45
    v_cvt_pk_bf16_f32 v44, 0, v44
    v_cvt_pk_bf16_f32 v45, 0, v45
    v_pk_add_f32 v[22:23], v[44:45], v[22:23]
    v_pk_add_f32 v[44:45], v[24:25], v[40:41] neg_lo:[0,1] neg_hi:[0,1]
    v_cvt_pk_bf16_f32 v44, 0, v44
    v_cvt_pk_bf16_f32 v45, 0, v45
    v_pk_mul_f32 v[44:45], v[44:45], v[42:43]
    v_cvt_pk_bf16_f32 v12, v44, v45
    v_cvt_pk_bf16_f32 v44, 0, v44
    v_cvt_pk_bf16_f32 v45, 0, v45
    v_pk_add_f32 v[24:25], v[44:45], v[24:25]
    v_pk_add_f32 v[44:45], v[26:27], v[40:41] neg_lo:[0,1] neg_hi:[0,1]
    v_cvt_pk_bf16_f32 v44, 0, v44
    v_cvt_pk_bf16_f32 v45, 0, v45
    v_pk_mul_f32 v[44:45], v[44:45], v[42:43]
    v_cvt_pk_bf16_f32 v13, v44, v45
    v_cvt_pk_bf16_f32 v44, 0, v44
    v_cvt_pk_bf16_f32 v45, 0, v45
    v_pk_add_f32 v[26:27], v[44:45], v[26:27]
    v_pk_add_f32 v[44:45], v[28:29], v[40:41] neg_lo:[0,1] neg_hi:[0,1]
    v_cvt_pk_bf16_f32 v44, 0, v44
    v_cvt_pk_bf16_f32 v45, 0, v45
    v_pk_mul_f32 v[44:45], v[44:45], v[42:43]
    v_cvt_pk_bf16_f32 v14, v44, v45
    v_cvt_pk_bf16_f32 v44, 0, v44
    v_cvt_pk_bf16_f32 v45, 0, v45
    v_pk_add_f32 v[28:29], v[44:45], v[28:29]
    v_pk_add_f32 v[44:45], v[30:31], v[40:41] neg_lo:[0,1] neg_hi:[0,1]
    v_cvt_pk_bf16_f32 v44, 0, v44
    v_cvt_pk_bf16_f32 v45, 0, v45
    v_pk_mul_f32 v[44:45], v[44:45], v[42:43]
    v_cvt_pk_bf16_f32 v15, v44, v45
    v_cvt_pk_bf16_f32 v44, 0, v44
    v_cvt_pk_bf16_f32 v45, 0, v45
    v_pk_add_f32 v[30:31], v[44:45], v[30:31]
    v_pk_add_f32 v[44:45], v[32:33], v[40:41] neg_lo:[0,1] neg_hi:[0,1]
    v_cvt_pk_bf16_f32 v44, 0, v44
    v_cvt_pk_bf16_f32 v45, 0, v45
    v_pk_mul_f32 v[44:45], v[44:45], v[42:43]
    v_cvt_pk_bf16_f32 v16, v44, v45
    v_cvt_pk_bf16_f32 v44, 0, v44
    v_cvt_pk_bf16_f32 v45, 0, v45
    v_pk_add_f32 v[32:33], v[44:45], v[32:33]
    v_pk_add_f32 v[44:45], v[34:35], v[40:41] neg_lo:[0,1] neg_hi:[0,1]
    v_cvt_pk_bf16_f32 v44, 0, v44
    v_cvt_pk_bf16_f32 v45, 0, v45
    v_pk_mul_f32 v[44:45], v[44:45], v[42:43]
    v_cvt_pk_bf16_f32 v17, v44, v45
    v_cvt_pk_bf16_f32 v44, 0, v44
    v_cvt_pk_bf16_f32 v45, 0, v45
    v_pk_add_f32 v[34:35], v[44:45], v[34:35]
    v_pk_add_f32 v[44:45], v[36:37], v[40:41] neg_lo:[0,1] neg_hi:[0,1]
    v_cvt_pk_bf16_f32 v44, 0, v44
    v_cvt_pk_bf16_f32 v45, 0, v45
    v_pk_mul_f32 v[44:45], v[44:45], v[42:43]
    v_cvt_pk_bf16_f32 v18, v44, v45
    v_cvt_pk_bf16_f32 v44, 0, v44
    v_cvt_pk_bf16_f32 v45, 0, v45
    v_pk_add_f32 v[36:37], v[44:45], v[36:37]
    v_cvt_pk_bf16_f32 v58, v36, v37
    ds_write_b32 v108, v18
    ds_write_b32 v108, v58 offset:256
    ds_read_b128 v[64:67], v109
    buffer_store_dwordx4 v[10:13], v115, s[72:75], 0 offen sc1
    buffer_store_dwordx4 v[14:17], v115, s[72:75], 0 offen offset:512 sc1
    v_cvt_pk_bf16_f32 v50, v20, v21
    v_cvt_pk_bf16_f32 v51, v22, v23
    v_cvt_pk_bf16_f32 v52, v24, v25
    v_cvt_pk_bf16_f32 v53, v26, v27
    v_cvt_pk_bf16_f32 v54, v28, v29
    v_cvt_pk_bf16_f32 v55, v30, v31
    v_cvt_pk_bf16_f32 v56, v32, v33
    v_cvt_pk_bf16_f32 v57, v34, v35
    s_mov_b64 exec, 0xffff
    s_waitcnt lgkmcnt(0)
    buffer_store_dwordx4 v[64:67], v111, s[72:75], 0 offen offset:1024 sc1
    s_mov_b64 exec, -1
    s_setprio 0
    s_add_u32 s80, s36, 0x850000
    s_addc_u32 s81, s37, 0
    s_mov_b32 s82, 0x148800
    s_mov_b32 s83, 0x20000
    v_bfe_u32 v16, v1, 2, 2
    v_lshl_add_u32 v16, v3, 3, v16
    v_mul_u32_u24 v16, 1152, v16
    v_and_b32 v17, 3, v1
    v_lshl_add_u32 v16, v17, 3, v16
    s_lshl_b32 s10, s38, 7
    s_add_u32 s11, s10, 109184
    v_add_u32 v16, s11, v16
    v_lshrrev_b32 v18, 2, v1
    v_mul_u32_u24 v18, 9344, v18
    v_lshl_add_u32 v18, v17, 4, v18
    s_mul_i32 s9, s38, 149504
    s_lshl_b32 s11, s89, 6
    s_add_u32 s9, s9, s11
    v_lshl_add_u32 v19, v17, 5, s10
    v_lshl_add_u32 v19, v3, 3, v19
    s_mul_i32 s8, s89, 9344
    s_lshl_b32 s11, s38, 10
    s_add_u32 s8, s8, s11
    s_movk_i32 s10, 0x3f80
    s_mov_b32 s11, 0x3f800000
    v_mov_b32 v28, 0
    v_mov_b32 v29, 0
    v_lshlrev_b32 v17, 4, v1
    s_cmp_ge_u32 s41, 18
    s_cbranch_scc1 KS_LO
W_108:
    s_sleep 2
    ds_read_b32 v20, v4 offset:40
    s_sub_u32 s39, s39, 1
    s_cbranch_scc1 KS_ABORT
    s_waitcnt lgkmcnt(0)
    v_cmp_ne_u32 vcc, s84, v20
    s_cbranch_vccnz W_108
    ds_read_b64_tr_b16 v[80:81], v16 offset:0
    ds_read_b64_tr_b16 v[82:83], v16 offset:4608
    ds_read_b64_tr_b16 v[84:85], v16 offset:32
    ds_read_b64_tr_b16 v[86:87], v16 offset:4640
    ds_read_b64_tr_b16 v[88:89], v16 offset:64
    ds_read_b64_tr_b16 v[90:91], v16 offset:4672
    ds_read_b64_tr_b16 v[92:93], v16 offset:96
    ds_read_b64_tr_b16 v[94:95], v16 offset:4704
    v_and_b32 v16, 7, v2
    v_lshlrev_b32 v16, 6, v16
    v_lshl_add_u32 v16, v3, 4, v16
    s_mul_i32 s92, s89, 9344
    s_add_u32 s92, s92, 0x850000
    s_add_u32 s64, s36, s92
    s_addc_u32 s65, s37, 0
    s_cmp_lt_u32 s41, 18
    s_cselect_b32 s66, 9216, 0
    s_mov_b32 s67, 0x20000
    s_mul_i32 s92, s38, 3072
    v_lshlrev_b32 v8, 4, v1
    v_mov_b32 v60, -1
    v_mov_b32 v61, -1
    v_mov_b32 v62, -1
    v_mov_b32 v63, -1
    buffer_store_dwordx4 v[60:63], v8, s[64:67], s92 offen offset:0 sc1
    buffer_store_dwordx4 v[60:63], v8, s[64:67], s92 offen offset:1024 sc1
    buffer_store_dwordx4 v[60:63], v8, s[64:67], s92 offen offset:2048 sc1
    s_waitcnt vmcnt(0)
    s_mov_b64 exec, 1
    ds_add_rtn_u32 v62, v4, v5 offset:196
    s_lshl_b32 s92, s2, 4
    s_add_u32 s92, s92, 8192
    s_waitcnt lgkmcnt(0)
    v_cmp_eq_u32 vcc, 3, v62
    s_and_b64 exec, exec, vcc
    s_cbranch_execz NOF_109
    buffer_store_dword v5, v4, s[76:79], s92 offen sc1
NOF_109:
    s_mov_b64 exec, -1
    s_sleep 16
    s_branch KS_LO2
KS_LO:
    s_sleep 8
    s_waitcnt vmcnt(0)
    s_mov_b64 exec, 1
    ds_add_rtn_u32 v62, v4, v5 offset:196
    s_lshl_b32 s92, s2, 4
    s_add_u32 s92, s92, 8192
    s_waitcnt lgkmcnt(0)
    v_cmp_eq_u32 vcc, 3, v62
    s_and_b64 exec, exec, vcc
    s_cbranch_execz NOF_110
    buffer_store_dword v5, v4, s[76:79], s92 offen sc1
NOF_110:
    s_mov_b64 exec, -1
    s_sleep 24
KS_LO2:
    s_mov_b64 exec, 0xffff0000
    buffer_store_dwordx4 v[64:67], v111, s[68:71], 0 offen offset:1024 sc1
    s_mov_b64 exec, -1
    buffer_store_dwordx4 v[50:53], v115, s[68:71], 0 offen sc1
    buffer_store_dwordx4 v[54:57], v115, s[68:71], 0 offen offset:512 sc1
    s_setprio 2
    s_waitcnt vmcnt(0)
    s_mov_b64 exec, 1
    ds_add_rtn_u32 v62, v4, v5 offset:176
    s_lshl_b32 s92, s2, 4
    s_add_u32 s92, s92, 12288
    s_waitcnt lgkmcnt(0)
    v_cmp_eq_u32 vcc, 3, v62
    s_and_b64 exec, exec, vcc
    s_cbranch_execz NOF_111
    buffer_store_dword v5, v4, s[76:79], s92 offen sc1
NOF_111:
    s_mov_b64 exec, -1
    s_cmp_lt_u32 s41, 18
    s_cbranch_scc1 KS_B
    s_waitcnt lgkmcnt(0)
    s_endpgm
KS_T:
    s_setprio 0
    s_cmp_ge_u32 s38, 10
    s_cbranch_scc1 KS_PEND
    s_add_u32 s76, s36, 0x840000
    s_addc_u32 s77, s37, 0
    s_mov_b32 s78, 0x4000
    s_mov_b32 s79, 0x20000
    s_cmp_eq_u32 s38, 9
    s_cbranch_scc1 KS_W9
    s_add_u32 s80, s36, 0x850000
    s_addc_u32 s81, s37, 0
    s_mov_b32 s82, 0x148800
    s_mov_b32 s83, 0x20000
    v_bfe_u32 v16, v1, 2, 2
    v_lshl_add_u32 v16, v3, 3, v16
    v_mul_u32_u24 v16, 1152, v16
    v_and_b32 v17, 3, v1
    v_lshl_add_u32 v16, v17, 3, v16
    s_lshl_b32 s10, s38, 7
    s_add_u32 s11, s10, 109184
    v_add_u32 v16, s11, v16
    v_lshrrev_b32 v18, 2, v1
    v_mul_u32_u24 v18, 9344, v18
    v_lshl_add_u32 v18, v17, 4, v18
    s_mul_i32 s9, s38, 149504
    s_lshl_b32 s11, s89, 6
    s_add_u32 s9, s9, s11
    v_lshl_add_u32 v19, v17, 5, s10
    v_lshl_add_u32 v19, v3, 3, v19
    s_mul_i32 s8, s89, 9344
    s_lshl_b32 s11, s38, 10
    s_add_u32 s8, s8, s11
    s_movk_i32 s10, 0x3f80
    s_mov_b32 s11, 0x3f800000
    v_mov_b32 v28, 0
    v_mov_b32 v29, 0
    v_lshlrev_b32 v17, 4, v1
    s_mov_b32 s72, s36
    s_mov_b32 s73, s37
    s_mov_b32 s74, 0x240000
    s_mov_b32 s75, 0x20000
    v_and_b32 v6, 1, v1
    v_and_b32 v7, 1, v3
    v_lshl_add_u32 v6, v7, 1, v6
    v_lshlrev_b32 v6, 2, v6
    ds_read_b32 v8, v6 offset:224
    s_lshl_b32 s92, s38, 11
    s_add_u32 s92, s92, 8896
    v_add_u32 v12, s92, v17
    s_waitcnt lgkmcnt(0)
    v_lshrrev_b32 v9, 3, v8
    v_lshrrev_b32 v10, 6, v8
    v_lshrrev_b32 v11, 9, v8
    s_cmp_eq_u32 s38, 8
    s_cbranch_scc1 KS_L2W
W_112:
    s_sleep 2
    ds_read_b32 v20, v4 offset:40
    s_sub_u32 s39, s39, 1
    s_cbranch_scc1 KS_ABORT
    s_waitcnt lgkmcnt(0)
    v_cmp_ne_u32 vcc, s84, v20
    s_cbranch_vccnz W_112
    ds_read_b64_tr_b16 v[80:81], v16 offset:0
    ds_read_b64_tr_b16 v[82:83], v16 offset:4608
    ds_read_b64_tr_b16 v[84:85], v16 offset:32
    ds_read_b64_tr_b16 v[86:87], v16 offset:4640
    ds_read_b64_tr_b16 v[88:89], v16 offset:64
    ds_read_b64_tr_b16 v[90:91], v16 offset:4672
    ds_read_b64_tr_b16 v[92:93], v16 offset:96
    ds_read_b64_tr_b16 v[94:95], v16 offset:4704
    v_and_b32 v16, 7, v2
    v_lshlrev_b32 v16, 6, v16
    v_lshl_add_u32 v16, v3, 4, v16
W_113:
    s_sleep 2
    ds_read_b32 v20, v4 offset:768
    s_sub_u32 s39, s39, 1
    s_cbranch_scc1 KS_ABORT
    s_waitcnt lgkmcnt(0)
    v_cmp_eq_u32 vcc, 0, v20
    s_cbranch_vccnz W_113
    s_setprio 1
W_114:
    s_sleep 1
    ds_read_b32 v20, v4 offset:32
    s_sub_u32 s39, s39, 1
    s_cbranch_scc1 KS_ABORT
    s_waitcnt lgkmcnt(0)
    v_cmp_eq_u32 vcc, 0, v20
    s_cbranch_vccnz W_114
    ds_read_b128 v[20:23], v12
    ds_read_b128 v[24:27], v12 offset:1024
    s_waitcnt lgkmcnt(1)
    v_xor_b32 v13, v8, v20
    v_bitop3_b32 v13, v13, v9, v21 bitop3:0xf6
    v_bitop3_b32 v13, v13, v10, v22 bitop3:0xf6
    v_bitop3_b32 v13, v13, v11, v23 bitop3:0xf6
    v_and_b32 v13, 0x70007, v13
    s_waitcnt lgkmcnt(0)
    v_xor_b32 v14, v8, v24
    v_bitop3_b32 v14, v14, v9, v25 bitop3:0xf6
    v_bitop3_b32 v14, v14, v10, v26 bitop3:0xf6
    v_bitop3_b32 v14, v14, v11, v27 bitop3:0xf6
    v_and_b32 v14, 0x70007, v14
    v_min_u32 v13, v13, v14
KS_CK:
    v_cmp_eq_u32 vcc, 0, v13
    s_cbranch_vccz KS_B
    ds_write_b32 v4, v5 offset:24
    s_branch KS_B
KS_L2W:
    s_movk_i32 s92, 4096
    s_movk_i32 s96, -1152
    s_mov_b32 s93, 0
    v_mov_b32 v57, 0
    v_and_b32 v41, 1, v1
    v_lshl_add_u32 v41, v3, 1, v41
    v_lshlrev_b32 v41, 4, v41
    v_add_u32 v41, 2358144, v41
    v_lshlrev_b32 v7, 1, v1
    v_and_b32 v7, 28, v7
W_115:
    s_sleep 2
    ds_read_b32 v20, v4 offset:20
    s_sub_u32 s39, s39, 1
    s_cbranch_scc1 KS_ABORT
    s_waitcnt lgkmcnt(0)
    v_cmp_ne_u32 vcc, s84, v20
    s_cbranch_vccnz W_115
    s_setprio 3
W_116:
    s_sleep 1
    ds_read_b32 v20, v4 offset:12
    s_sub_u32 s39, s39, 1
    s_cbranch_scc1 KS_ABORT
    s_waitcnt lgkmcnt(0)
    v_cmp_ne_u32 vcc, s84, v20
    s_cbranch_vccnz W_116
    s_setprio 3
    s_sleep 27
    s_branch KS_Q1
KS_Q0:
    s_sleep 1
KS_Q1:
    buffer_load_dwordx4 v[96:99], v17, s[76:79], 0 offen offset:0 sc1
    buffer_load_dwordx4 v[100:103], v17, s[76:79], 0 offen offset:1024 sc1
    buffer_load_dwordx4 v[104:107], v17, s[76:79], 0 offen offset:2048 sc1
    buffer_load_dwordx4 v[108:111], v17, s[76:79], 0 offen offset:3072 sc1
    buffer_load_dwordx4 v[112:115], v17, s[76:79], s92 offen offset:0 sc1
    buffer_load_dwordx4 v[116:119], v17, s[76:79], s92 offen offset:1024 sc1
    buffer_load_dwordx4 v[120:123], v17, s[76:79], s92 offen offset:2048 sc1
    buffer_load_dwordx4 v[124:127], v17, s[76:79], s92 offen offset:3072 sc1
    s_sub_u32 s39, s39, 1
    s_cbranch_scc1 KS_ABORT
    s_waitcnt vmcnt(7)
    v_max_u32 v42, v96, v97
    v_max_u32 v44, v98, v99
    v_min_u32 v43, v96, v97
    v_min_u32 v45, v98, v99
    s_waitcnt vmcnt(6)
    v_med3_u32 v46, v42, v100, v101
    v_med3_u32 v47, v44, v102, v103
    v_max3_u32 v42, v42, v100, v101
    v_max3_u32 v44, v44, v102, v103
    v_max_u32 v43, v43, v46
    v_max_u32 v45, v45, v47
    s_waitcnt vmcnt(5)
    v_med3_u32 v46, v42, v104, v105
    v_med3_u32 v47, v44, v106, v107
    v_max3_u32 v42, v42, v104, v105
    v_max3_u32 v44, v44, v106, v107
    v_max_u32 v43, v43, v46
    v_max_u32 v45, v45, v47
    s_waitcnt vmcnt(4)
    v_med3_u32 v46, v42, v108, v109
    v_med3_u32 v47, v44, v110, v111
    v_max3_u32 v42, v42, v108, v109
    v_max3_u32 v44, v44, v110, v111
    v_max_u32 v43, v43, v46
    v_max_u32 v45, v45, v47
    s_waitcnt vmcnt(3)
    v_med3_u32 v46, v42, v112, v113
    v_med3_u32 v47, v44, v114, v115
    v_max3_u32 v42, v42, v112, v113
    v_max3_u32 v44, v44, v114, v115
    v_max_u32 v43, v43, v46
    v_max_u32 v45, v45, v47
    s_waitcnt vmcnt(2)
    v_med3_u32 v46, v42, v116, v117
    v_med3_u32 v47, v44, v118, v119
    v_max3_u32 v42, v42, v116, v117
    v_max3_u32 v44, v44, v118, v119
    v_max_u32 v43, v43, v46
    v_max_u32 v45, v45, v47
    s_waitcnt vmcnt(1)
    v_med3_u32 v46, v42, v120, v121
    v_med3_u32 v47, v44, v122, v123
    v_max3_u32 v42, v42, v120, v121
    v_max3_u32 v44, v44, v122, v123
    v_max_u32 v43, v43, v46
    v_max_u32 v45, v45, v47
    v_max_u32 v43, v43, v45
    s_waitcnt vmcnt(0)
    v_med3_u32 v46, v42, v124, v125
    v_med3_u32 v47, v44, v126, v127
    v_max3_u32 v42, v42, v124, v125
    v_max3_u32 v44, v44, v126, v127
    v_max3_u32 v43, v43, v46, v47
    v_max_u32 v48, v42, v44
    v_med3_u32 v49, v42, v44, v43
    v_cmp_eq_u32 vcc, -1, v48
    v_mov_b32 v56, v49
KS_QN:
    v_max_u32_dpp v50, v49, v48 row_half_mirror row_mask:0xf bank_mask:0x5
    v_max_u32_dpp v51, v48, v49 row_half_mirror row_mask:0xf bank_mask:0x5
    v_min_u32_dpp v50, v49, v48 row_half_mirror row_mask:0xf bank_mask:0xa
    v_min_u32_dpp v51, v48, v49 row_half_mirror row_mask:0xf bank_mask:0xa
    s_cbranch_vccnz KS_Q0
    s_cmp_eq_u32 s93, 1
    s_mov_b32 m0, 17088
    v_min_u32 v53, v50, v51
    v_max_u32 v52, v50, v51
    s_nop 1
    v_max_u32_dpp v50, v53, v52 row_mirror row_mask:0xf bank_mask:0x3
    v_max_u32_dpp v51, v52, v53 row_mirror row_mask:0xf bank_mask:0x3
    v_min_u32_dpp v50, v53, v52 row_mirror row_mask:0xf bank_mask:0xc
    v_min_u32_dpp v51, v52, v53 row_mirror row_mask:0xf bank_mask:0xc
    s_nop 0
    v_max_u32_dpp v52, v50, v50 row_half_mirror row_mask:0xf bank_mask:0x5
    v_max_u32_dpp v53, v51, v51 row_half_mirror row_mask:0xf bank_mask:0x5
    v_min_u32_dpp v52, v50, v50 row_half_mirror row_mask:0xf bank_mask:0xa
    v_min_u32_dpp v53, v51, v51 row_half_mirror row_mask:0xf bank_mask:0xa
    v_max_u32 v48, v52, v53
    v_max_u32 v54, v52, v53
    v_min_u32 v49, v52, v53
    v_min_u32 v55, v52, v53
    v_permlane32_swap_b32 v48, v54
    s_nop 0
    v_permlane32_swap_b32 v49, v55
    s_nop 1
    v_max_u32_dpp v51, v54, v49 row_mirror row_mask:0xf bank_mask:0xf
    v_max_u32_dpp v50, v55, v48 row_mirror row_mask:0xf bank_mask:0xf
    s_nop 1
    v_max_u32_dpp v52, v50, v50 row_ror:8 row_mask:0xf bank_mask:0x3
    v_max_u32_dpp v53, v51, v51 row_ror:8 row_mask:0xf bank_mask:0x3
    v_min_u32_dpp v52, v50, v50 row_ror:8 row_mask:0xf bank_mask:0xc
    v_min_u32_dpp v53, v51, v51 row_ror:8 row_mask:0xf bank_mask:0xc
    s_nop 0
    v_max_u32_dpp v50, v52, v52 row_half_mirror row_mask:0xf bank_mask:0x5
    v_max_u32_dpp v51, v53, v53 row_half_mirror row_mask:0xf bank_mask:0x5
    v_min_u32_dpp v50, v52, v52 row_half_mirror row_mask:0xf bank_mask:0xa
    v_min_u32_dpp v51, v53, v53 row_half_mirror row_mask:0xf bank_mask:0xa
    v_max_u32 v48, v50, v51
    v_max_u32 v54, v50, v51
    v_min_u32 v49, v50, v51
    v_min_u32 v55, v50, v51
    v_permlane16_swap_b32 v48, v54
    s_nop 0
    v_permlane16_swap_b32 v49, v55
    s_nop 1
    v_max_u32_dpp v51, v54, v49 row_mirror row_mask:0xf bank_mask:0xf
    v_max_u32_dpp v50, v55, v48 row_mirror row_mask:0xf bank_mask:0xf
    s_nop 1
    v_max_u32_dpp v52, v50, v50 row_ror:8 row_mask:0xf bank_mask:0x3
    v_max_u32_dpp v53, v51, v51 row_ror:8 row_mask:0xf bank_mask:0x3
    v_min_u32_dpp v52, v50, v50 row_ror:8 row_mask:0xf bank_mask:0xc
    v_min_u32_dpp v53, v51, v51 row_ror:8 row_mask:0xf bank_mask:0xc
    s_nop 0
    v_max_u32_dpp v50, v52, v52 row_half_mirror row_mask:0xf bank_mask:0x5
    v_max_u32_dpp v51, v53, v53 row_half_mirror row_mask:0xf bank_mask:0x5
    v_min_u32_dpp v50, v52, v52 row_half_mirror row_mask:0xf bank_mask:0xa
    v_min_u32_dpp v51, v53, v53 row_half_mirror row_mask:0xf bank_mask:0xa
    v_min_u32 v49, v50, v51
    v_max_u32 v48, v50, v51
    s_nop 0
    v_mov_b32_dpp v55, v49 row_mirror row_mask:0xf bank_mask:0xf
    v_mov_b32_dpp v54, v48 row_mirror row_mask:0xf bank_mask:0xf
    s_nop 0
    v_max_u32_dpp v50, v55, v48 quad_perm:[1,0,3,2] row_mask:0xf bank_mask:0xf
    v_max_u32_dpp v51, v54, v49 quad_perm:[1,0,3,2] row_mask:0xf bank_mask:0xf
    s_nop 0
    v_max_u32_dpp v52, v50, v50 row_ror:8 row_mask:0xf bank_mask:0x3
    v_max_u32_dpp v53, v51, v51 row_ror:8 row_mask:0xf bank_mask:0x3
    v_min_u32_dpp v52, v50, v50 row_ror:8 row_mask:0xf bank_mask:0xc
    v_min_u32_dpp v53, v51, v51 row_ror:8 row_mask:0xf bank_mask:0xc
    s_nop 0
    v_max_u32_dpp v50, v52, v52 row_half_mirror row_mask:0xf bank_mask:0x5
    v_max_u32_dpp v51, v53, v53 row_half_mirror row_mask:0xf bank_mask:0x5
    v_min_u32_dpp v50, v52, v52 row_half_mirror row_mask:0xf bank_mask:0xa
    v_min_u32_dpp v51, v53, v53 row_half_mirror row_mask:0xf bank_mask:0xa
    v_min_u32 v49, v50, v51
    v_max_u32 v48, v50, v51
    s_nop 0
    v_mov_b32_dpp v55, v49 row_mirror row_mask:0xf bank_mask:0xf
    s_nop 1
    v_max_u32_dpp v59, v55, v48 quad_perm:[2,3,0,1] row_mask:0xf bank_mask:0xf
    s_cbranch_scc1 KS_QF2
    v_and_b32 v61, 0x7ff, v59
    v_mad_i32_i24 v61, v61, s96, v41
    buffer_load_dwordx4 v61, s[72:75], 0 offen offset:0 sc1 lds
    s_mov_b32 m0, 17984
    s_nop 0
    buffer_load_dwordx4 v61, s[72:75], 0 offen offset:128 sc1 lds
    s_mov_b32 m0, 18880
    s_nop 0
    buffer_load_dwordx4 v61, s[72:75], 0 offen offset:256 sc1 lds
    s_mov_b32 m0, 19776
    s_nop 0
    buffer_load_dwordx4 v61, s[72:75], 0 offen offset:384 sc1 lds
    s_mov_b32 m0, 20672
    s_nop 0
    buffer_load_dwordx4 v61, s[72:75], 0 offen offset:512 sc1 lds
    s_mov_b32 m0, 21568
    s_nop 0
    buffer_load_dwordx4 v61, s[72:75], 0 offen offset:640 sc1 lds
    s_mov_b32 m0, 22464
    s_nop 0
    buffer_load_dwordx4 v61, s[72:75], 0 offen offset:768 sc1 lds
    s_mov_b32 m0, 23360
    s_nop 0
    buffer_load_dwordx4 v61, s[72:75], 0 offen offset:896 sc1 lds
    s_mov_b32 m0, 24256
    s_nop 0
    buffer_load_dwordx4 v61, s[72:75], 0 offen offset:1024 sc1 lds
    v_sub_u32 v96, v96, v56
    v_min_u32_dpp v60, v59, v59 quad_perm:[2,3,0,1] row_mask:0xf bank_mask:0xf
    v_sub_u32 v97, v97, v56
    v_sub_u32 v98, v98, v56
    v_max3_u32 v47, v96, v97, v98
    v_sub_u32 v99, v99, v56
    v_sub_u32 v100, v100, v56
    v_min_u32_dpp v60, v60, v60 row_half_mirror row_mask:0xf bank_mask:0xf
    v_max3_u32 v47, v47, v99, v100
    v_sub_u32 v101, v101, v56
    v_sub_u32 v102, v102, v56
    v_max3_u32 v47, v47, v101, v102
    v_sub_u32 v103, v103, v56
    v_sub_u32 v104, v104, v56
    v_min_u32_dpp v60, v60, v60 row_ror:8 row_mask:0xf bank_mask:0xf
    v_max3_u32 v47, v47, v103, v104
    v_sub_u32 v105, v105, v56
    v_sub_u32 v106, v106, v56
    v_max3_u32 v47, v47, v105, v106
    v_sub_u32 v107, v107, v56
    v_sub_u32 v108, v108, v56
    v_max3_u32 v47, v47, v107, v108
    v_sub_u32 v109, v109, v56
    v_sub_u32 v110, v110, v56
    v_max3_u32 v47, v47, v109, v110
    v_sub_u32 v111, v111, v56
    v_sub_u32 v112, v112, v56
    v_max3_u32 v47, v47, v111, v112
    v_sub_u32 v113, v113, v56
    v_sub_u32 v114, v114, v56
    v_max3_u32 v47, v47, v113, v114
    v_sub_u32 v115, v115, v56
    v_sub_u32 v116, v116, v56
    v_max3_u32 v47, v47, v115, v116
    v_sub_u32 v117, v117, v56
    v_sub_u32 v118, v118, v56
    v_max3_u32 v47, v47, v117, v118
    v_sub_u32 v119, v119, v56
    v_sub_u32 v120, v120, v56
    v_max3_u32 v47, v47, v119, v120
    v_sub_u32 v121, v121, v56
    v_sub_u32 v122, v122, v56
    v_max3_u32 v47, v47, v121, v122
    v_sub_u32 v123, v123, v56
    v_sub_u32 v124, v124, v56
    v_max3_u32 v47, v47, v123, v124
    v_sub_u32 v125, v125, v56
    v_sub_u32 v126, v126, v56
    v_max3_u32 v47, v47, v125, v126
    v_sub_u32 v127, v127, v56
    v_add_u32 v57, v57, v56
    v_max_u32 v47, v47, v127
    v_add_u32 v47, v47, v57
    v_cmp_gt_u32 vcc, v47, v60
    s_cbranch_vccnz KS_QF1
    ds_write_b32 v7, v59 offset:768
W_117:
    s_sleep 2
    ds_read_b32 v20, v4 offset:40
    s_sub_u32 s39, s39, 1
    s_cbranch_scc1 KS_ABORT
    s_waitcnt lgkmcnt(0)
    v_cmp_ne_u32 vcc, s84, v20
    s_cbranch_vccnz W_117
    ds_read_b64_tr_b16 v[80:81], v16 offset:0
    ds_read_b64_tr_b16 v[82:83], v16 offset:4608
    ds_read_b64_tr_b16 v[84:85], v16 offset:32
    ds_read_b64_tr_b16 v[86:87], v16 offset:4640
    ds_read_b64_tr_b16 v[88:89], v16 offset:64
    ds_read_b64_tr_b16 v[90:91], v16 offset:4672
    ds_read_b64_tr_b16 v[92:93], v16 offset:96
    ds_read_b64_tr_b16 v[94:95], v16 offset:4704
    v_and_b32 v16, 7, v2
    v_lshlrev_b32 v16, 6, v16
    v_lshl_add_u32 v16, v3, 4, v16
    s_waitcnt vmcnt(0)
    ds_write_b32 v4, v5 offset:32
    s_setprio 1
    ds_read_b128 v[20:23], v12
    s_waitcnt lgkmcnt(0)
    v_xor_b32 v13, v8, v20
    v_bitop3_b32 v13, v13, v9, v21 bitop3:0xf6
    v_bitop3_b32 v13, v13, v10, v22 bitop3:0xf6
    v_bitop3_b32 v13, v13, v11, v23 bitop3:0xf6
    v_and_b32 v13, 0x70007, v13
    s_branch KS_CK
KS_QF1:
    s_sub_u32 s39, s39, 1
    s_cbranch_scc1 KS_ABORT
    v_mov_b32 v58, v59
    v_max_u32 v42, v96, v97
    v_max_u32 v44, v98, v99
    v_min_u32 v43, v96, v97
    v_min_u32 v45, v98, v99
    v_med3_u32 v46, v42, v100, v101
    v_med3_u32 v47, v44, v102, v103
    v_max3_u32 v42, v42, v100, v101
    v_max3_u32 v44, v44, v102, v103
    v_max_u32 v43, v43, v46
    v_max_u32 v45, v45, v47
    v_med3_u32 v46, v42, v104, v105
    v_med3_u32 v47, v44, v106, v107
    v_max3_u32 v42, v42, v104, v105
    v_max3_u32 v44, v44, v106, v107
    v_max_u32 v43, v43, v46
    v_max_u32 v45, v45, v47
    v_med3_u32 v46, v42, v108, v109
    v_med3_u32 v47, v44, v110, v111
    v_max3_u32 v42, v42, v108, v109
    v_max3_u32 v44, v44, v110, v111
    v_max_u32 v43, v43, v46
    v_max_u32 v45, v45, v47
    v_med3_u32 v46, v42, v112, v113
    v_med3_u32 v47, v44, v114, v115
    v_max3_u32 v42, v42, v112, v113
    v_max3_u32 v44, v44, v114, v115
    v_max_u32 v43, v43, v46
    v_max_u32 v45, v45, v47
    v_med3_u32 v46, v42, v116, v117
    v_med3_u32 v47, v44, v118, v119
    v_max3_u32 v42, v42, v116, v117
    v_max3_u32 v44, v44, v118, v119
    v_max_u32 v43, v43, v46
    v_max_u32 v45, v45, v47
    v_med3_u32 v46, v42, v120, v121
    v_med3_u32 v47, v44, v122, v123
    v_max3_u32 v42, v42, v120, v121
    v_max3_u32 v44, v44, v122, v123
    v_max_u32 v43, v43, v46
    v_max_u32 v45, v45, v47
    v_max_u32 v43, v43, v45
    v_med3_u32 v46, v42, v124, v125
    v_med3_u32 v47, v44, v126, v127
    v_max3_u32 v42, v42, v124, v125
    v_max3_u32 v44, v44, v126, v127
    v_max3_u32 v43, v43, v46, v47
    v_max_u32 v48, v42, v44
    v_med3_u32 v56, v42, v44, v43
    v_add_u32 v48, v48, v57
    v_add_u32 v49, v56, v57
    s_mov_b32 s93, 1
    s_mov_b64 vcc, 0
    s_nop 2
    s_branch KS_QN
KS_QF2:
    v_mov_b32 v48, 0
    v_mov_b32 v49, 0
    s_mov_b64 exec, 0x5555
    v_max_u32 v48, v59, v58
    v_min_u32 v49, v59, v58
    s_mov_b64 exec, -1
    s_mov_b32 s93, 2
    s_mov_b64 vcc, 0
    s_waitcnt vmcnt(0)
    s_nop 5
    s_branch KS_QN
KS_BR:
    s_mov_b64 exec, -1
    s_cmp_lg_u32 s38, 8
    s_cbranch_scc1 KS_BR1
    s_movk_i32 s92, 0x2000
    s_nop 7
    s_branch ZPE_119
ZP_118:
    s_sleep 2
ZPE_119:
    buffer_load_dword v20, v17, s[76:79], s92 offen offset:0 sc1
    buffer_load_dword v21, v17, s[76:79], s92 offen offset:1024 sc1
    buffer_load_dword v22, v17, s[76:79], s92 offen offset:2048 sc1
    buffer_load_dword v23, v17, s[76:79], s92 offen offset:3072 sc1
    s_sub_u32 s39, s39, 1
    s_cbranch_scc1 KS_ABORT
    s_waitcnt vmcnt(0)
    v_max3_u32 v44, v20, v21, v22
    v_max_u32 v44, v44, v23
    v_cmp_eq_u32 vcc, -1, v44
    s_cbranch_vccnz ZP_118
    s_mov_b32 m0, 17088
    s_nop 0
    buffer_load_dwordx4 v61, s[72:75], 0 offen offset:0 sc1 lds
    s_mov_b32 m0, 17984
    s_nop 0
    buffer_load_dwordx4 v61, s[72:75], 0 offen offset:128 sc1 lds
    s_mov_b32 m0, 18880
    s_nop 0
    buffer_load_dwordx4 v61, s[72:75], 0 offen offset:256 sc1 lds
    s_mov_b32 m0, 19776
    s_nop 0
    buffer_load_dwordx4 v61, s[72:75], 0 offen offset:384 sc1 lds
    s_mov_b32 m0, 20672
    s_nop 0
    buffer_load_dwordx4 v61, s[72:75], 0 offen offset:512 sc1 lds
    s_mov_b32 m0, 21568
    s_nop 0
    buffer_load_dwordx4 v61, s[72:75], 0 offen offset:640 sc1 lds
    s_mov_b32 m0, 22464
    s_nop 0
    buffer_load_dwordx4 v61, s[72:75], 0 offen offset:768 sc1 lds
    s_mov_b32 m0, 23360
    s_nop 0
    buffer_load_dwordx4 v61, s[72:75], 0 offen offset:896 sc1 lds
    s_mov_b32 m0, 24256
    s_nop 0
    buffer_load_dwordx4 v61, s[72:75], 0 offen offset:1024 sc1 lds
    s_waitcnt vmcnt(0)
    s_barrier
    ds_write_b32 v4, v4 offset:24
    s_branch KS_B
KS_BR1:
    s_barrier
    s_branch KS_B
KS_W9:
    v_lshlrev_b32 v33, 4, v1
    s_movk_i32 s92, 0x2000
    v_and_b32 v7, 7, v1
    v_lshlrev_b32 v7, 2, v7
    s_add_u32 s64, s36, 0x600000
    s_addc_u32 s65, s37, 0
    s_mov_b32 s66, 0x240000
    s_mov_b32 s67, 0x20000
    s_mov_b32 s68, s4
    s_mov_b32 s69, s5
    s_mov_b32 s70, 0x240000
    s_mov_b32 s71, 0x20000
    v_bfe_u32 v43, v1, 3, 2
    s_lshl_b32 s93, s89, 2
    v_add_u32 v43, s93, v43
    v_bfe_u32 v40, v43, 4, 1
    v_and_b32 v41, 3, v1
    v_lshl_add_u32 v40, v40, 2, v41
    v_lshlrev_b32 v40, 2, v40
    v_and_b32 v41, 0x3cf, v43
    v_bfe_u32 v42, v43, 5, 1
    v_lshl_add_u32 v41, v42, 4, v41
    v_bfe_u32 v42, v1, 2, 1
    v_lshl_add_u32 v41, v42, 5, v41
    v_lshrrev_b32 v42, 4, v41
    v_lshlrev_b32 v42, 8, v42
    v_lshl_add_u32 v42, v40, 3, v42
    v_and_b32 v43, 15, v41
    v_lshl_add_u32 v42, v43, 1, v42
W_120:
    s_sleep 1
    ds_read_b32 v12, v7 offset:768
    s_sub_u32 s39, s39, 1
    s_cbranch_scc1 KS_ABORT
    s_waitcnt lgkmcnt(0)
    v_cmp_eq_u32 vcc, 0, v12
    s_cbranch_vccnz W_120
    ds_read_b32 v19, v40 offset:768
    s_waitcnt lgkmcnt(0)
    v_and_b32 v14, 0x7ff, v19
    v_sub_u32 v14, 2047, v14
    v_mul_u32_u24 v23, 1152, v14
    v_lshl_add_u32 v23, v41, 1, v23
    buffer_load_ushort v17, v23, s[68:71], 0 offen
    v_lshrrev_b32 v15, 9, v14
    v_bfe_u32 v16, v14, 6, 2
    v_lshl_add_u32 v15, v15, 2, v16
    v_bfe_u32 v16, v14, 2, 2
    v_lshl_add_u32 v15, v15, 2, v16
    v_bfe_u32 v16, v14, 4, 1
    v_bfe_u32 v24, v14, 8, 1
    v_and_b32 v25, 3, v14
    v_lshl_add_u32 v24, v24, 2, v25
    v_lshlrev_b32 v24, 1, v24
    v_bfe_u32 v25, v14, 5, 1
    v_lshl_add_u32 v24, v25, 5, v24
    v_lshl_add_u32 v25, v15, 1, v16
    v_lshl_add_u32 v25, v25, 14, v24
    v_lshrrev_b32 v26, 1, v41
    v_lshl_add_u32 v25, v26, 6, v25
    v_xor_b32 v26, v41, v16
    v_not_b32 v26, v26
    v_and_b32 v26, 1, v26
    v_lshl_add_u32 v25, v26, 4, v25
    v_lshl_add_u32 v26, v15, 12, v24
    v_lshl_add_u32 v26, v16, 4, v26
    v_lshl_add_u32 v26, v41, 6, v26
    v_add_u32 v26, 2064384, v26
    v_lshl_add_u32 v27, v16, 6, v15
    v_lshlrev_b32 v27, 7, v27
    v_xor_b32 v25, v27, v25
    v_and_b32 v27, 0xf80, v27
    v_xor_b32 v26, v27, v26
    v_cmp_gt_u32 vcc, 0x200, v41
    s_nop 1
    v_cndmask_b32 v25, v26, v25, vcc
    buffer_load_ushort v18, v25, s[64:67], 0 offen sc1
    v_ashrrev_i32 v22, 31, v19
    v_not_b32 v22, v22
    v_or_b32 v22, 0x80000000, v22
    v_xor_b32 v22, v19, v22
    v_and_b32 v22, 0xffff0000, v22
    v_mul_f32 v22, 0xbfb8aa3b, v22
    v_exp_f32 v22, v22
    s_nop 0
    v_add_f32 v22, 1.0, v22
    v_rcp_f32 v22, v22
    s_nop 0
    v_cvt_pk_bf16_f32 v22, 0, v22
    s_add_u32 s72, s36, 0xb10000
    s_addc_u32 s73, s37, 0
    s_mov_b32 s74, 0x40
    s_mov_b32 s75, 0x20000
    s_mov_b32 s68, s32
    s_mov_b32 s69, s33
    s_mov_b32 s70, 0x240000
    s_mov_b32 s71, 0x20000
    buffer_load_dword v8, v33, s[76:79], s92 offen offset:0 sc1
    buffer_load_dword v9, v33, s[76:79], s92 offen offset:1024 sc1
    buffer_load_dword v10, v33, s[76:79], s92 offen offset:2048 sc1
    buffer_load_dword v11, v33, s[76:79], s92 offen offset:3072 sc1
    s_cmp_lg_u32 s2, 0
    s_cbranch_scc1 KS_W9B
    buffer_store_dword v12, v7, s[72:75], 0 offen
    s_branch KS_W9B
KS_W9R:
    s_barrier
KS_W9B:
    s_barrier
    ds_read_b32 v13, v4 offset:24
    ds_read_u16 v20, v42 offset:17088
    s_waitcnt lgkmcnt(0)
    v_cmp_ne_u32 vcc, 0, v13
    s_cbranch_vccnz KS_W9R
    s_setprio 2
    s_branch KS_F3B
KS_F3A:
    s_sleep 2
    buffer_load_dword v8, v33, s[76:79], s92 offen offset:0 sc1
    buffer_load_dword v9, v33, s[76:79], s92 offen offset:1024 sc1
    buffer_load_dword v10, v33, s[76:79], s92 offen offset:2048 sc1
    buffer_load_dword v11, v33, s[76:79], s92 offen offset:3072 sc1
KS_F3B:
    s_sub_u32 s39, s39, 1
    s_cbranch_scc1 KS_ABORT
    s_waitcnt vmcnt(0)
    v_max3_u32 v44, v8, v9, v10
    v_max_u32 v44, v44, v11
    v_cmp_eq_u32 vcc, -1, v44
    s_cbranch_vccnz KS_F3A
    ds_write_b32 v4, v5 offset:28
    s_movk_i32 s92, 0x3000
    s_sleep 12
    s_branch ZPE_122
ZP_121:
    s_sleep 2
ZPE_122:
    buffer_load_dword v8, v33, s[76:79], s92 offen offset:0 sc1
    buffer_load_dword v9, v33, s[76:79], s92 offen offset:1024 sc1
    buffer_load_dword v10, v33, s[76:79], s92 offen offset:2048 sc1
    buffer_load_dword v11, v33, s[76:79], s92 offen offset:3072 sc1
    s_sub_u32 s39, s39, 1
    s_cbranch_scc1 KS_ABORT
    s_waitcnt vmcnt(0)
    v_max3_u32 v44, v8, v9, v10
    v_max_u32 v44, v44, v11
    v_cmp_eq_u32 vcc, -1, v44
    s_cbranch_vccnz ZP_121
    v_lshlrev_b32 v17, 16, v17
    v_lshlrev_b32 v18, 16, v18
    v_add_f32 v17, v17, v18
    v_cvt_pk_bf16_f32 v17, v17, v17
    v_and_b32 v21, 0xffff0000, v17
    v_lshlrev_b32 v20, 16, v20
    v_lshlrev_b32 v14, 2, v1
    v_add_u32 v14, 1536, v14
    s_mov_b32 exec_lo, -1
    s_mov_b32 exec_hi, 0
    s_setprio 3
    s_barrier
    ds_read2_b32 v[32:33], v14 offset0:0 offset1:32
    ds_read2_b32 v[34:35], v14 offset0:64 offset1:96
    ds_read2_b32 v[36:37], v14 offset0:128 offset1:160
    ds_read2_b32 v[38:39], v14 offset0:192 offset1:224
    ds_read_b32 v40, v14 offset:1024
    s_waitcnt lgkmcnt(3)
    v_pk_add_f32 v[32:33], v[32:33], v[34:35]
    s_waitcnt lgkmcnt(1)
    v_pk_add_f32 v[36:37], v[36:37], v[38:39]
    v_add_f32 v32, v32, v33
    s_waitcnt lgkmcnt(0)
    v_add_f32 v36, v36, v37
    v_add_f32 v32, v32, v40
    v_add_f32 v8, v32, v36
    v_cvt_pk_bf16_f32 v8, 0, v8
    v_mul_f32 v8, v8, v22
    v_cvt_pk_bf16_f32 v8, 0, v8
    v_add_f32 v8, v8, v20
    v_cvt_pk_bf16_f32 v8, 0, v8
    v_add_f32 v8, v8, v21
    v_cvt_pk_bf16_f32 v8, v8, v8
    buffer_store_short v8, v23, s[68:71], 0 offen
    s_endpgm
KS_B:
    s_setprio 2
    s_waitcnt lgkmcnt(0)
    s_barrier
    ds_read_b128 v[20:23], v16 offset:1024
    ds_read_b32 v30, v4 offset:24
    s_waitcnt lgkmcnt(1)
    v_mfma_f32_16x16x32_bf16 v[32:35], v[20:23], v[80:83], 0
    v_mfma_f32_16x16x32_bf16 v[40:43], v[20:23], v[88:91], 0
    v_mfma_f32_16x16x32_bf16 v[36:39], v[20:23], v[84:87], 0
    v_mfma_f32_16x16x32_bf16 v[44:47], v[20:23], v[92:95], 0
    s_waitcnt lgkmcnt(0)
    v_cmp_ne_u32 vcc, 0, v30
    s_mov_b32 exec_lo, -1
    s_mov_b32 exec_hi, 0
    s_cbranch_vccnz KS_BR
    v_cvt_pk_bf16_f32 v24, v32, v33
    v_cvt_pk_bf16_f32 v25, v34, v35
    v_cvt_pk_bf16_f32 v26, v40, v41
    v_cvt_pk_bf16_f32 v27, v42, v43
    s_mov_b32 exec_lo, 0
    s_mov_b32 exec_hi, -1
    v_cvt_pk_bf16_f32 v24, v36, v37
    v_cvt_pk_bf16_f32 v25, v38, v39
    v_cvt_pk_bf16_f32 v26, v44, v45
    v_cvt_pk_bf16_f32 v27, v46, v47
    s_mov_b64 exec, -1
    v_min_u32 v24, -2, v24
    v_min_u32 v25, -2, v25
    v_min_u32 v26, -2, v26
    v_min_u32 v27, -2, v27
    buffer_store_dwordx4 v[24:27], v17, s[80:83], s8 offen sc1
    s_sleep 13
W_123:
    ds_read_b32 v30, v4 offset:28
    s_sub_u32 s39, s39, 1
    s_cbranch_scc1 KS_ABORT
    s_waitcnt lgkmcnt(0)
    v_cmp_eq_u32 vcc, 0, v30
    s_cbranch_vccnz W_123
    s_branch ZPE_125
ZP_124:
    s_sleep 1
ZPE_125:
    buffer_load_dwordx4 v[32:35], v18, s[80:83], s9 offen sc1
    s_sub_u32 s39, s39, 1
    s_cbranch_scc1 KS_ABORT
    s_waitcnt vmcnt(0)
    v_max3_u32 v44, v32, v33, v34
    v_max_u32 v44, v44, v35
    v_cmp_eq_u32 vcc, -1, v44
    s_cbranch_vccnz ZP_124
    v_permlane32_swap_b32 v32, v34
    v_permlane32_swap_b32 v33, v35
    s_nop 1
    v_permlane16_swap_b32 v32, v33
    v_permlane16_swap_b32 v34, v35
    v_dot2c_f32_bf16 v28, s10, v32
    v_dot2c_f32_bf16 v29, s11, v32
    v_dot2c_f32_bf16 v28, s10, v33
    v_dot2c_f32_bf16 v29, s11, v33
    v_dot2c_f32_bf16 v28, s10, v34
    v_dot2c_f32_bf16 v29, s11, v34
    v_dot2c_f32_bf16 v28, s10, v35
    v_dot2c_f32_bf16 v29, s11, v35
    s_nop 1
    v_add_f32_dpp v28, v28, v28 row_ror:8 row_mask:0xf bank_mask:0xf
    v_add_f32_dpp v29, v29, v29 row_ror:8 row_mask:0xf bank_mask:0xf
    s_nop 0
    v_add_f32_dpp v28, v28, v28 row_ror:4 row_mask:0xf bank_mask:0xf
    v_add_f32_dpp v29, v29, v29 row_ror:4 row_mask:0xf bank_mask:0xf
    s_mov_b32 exec_lo, 0x000f000f
    s_mov_b32 exec_hi, 0x000f000f
    ds_write_b64 v19, v[28:29] offset:1536
    s_waitcnt lgkmcnt(0)
    s_barrier
    s_endpgm
KS_G0:
    ds_write_b8 v15, v5 offset:68
    s_setprio 0
KS_G:
    s_waitcnt vmcnt(0)
KS_GN:
    s_sub_u32 s87, s38, 12
    s_and_b32 s95, s87, 1
    s_cselect_b32 s72, s28, s26
    s_cselect_b32 s73, s29, s27
    s_mov_b32 s74, 0x510000
    s_mov_b32 s75, 0x20000
    v_lshrrev_b32 v6, 3, v1
    v_lshrrev_b32 v7, 5, v1
    v_xor_b32 v6, v6, v7
    v_and_b32 v6, 1, v6
    v_lshl_add_u32 v6, s95, 1, v6
    v_xor_b32 v6, v6, v1
    v_and_b32 v6, 3, v6
    v_lshrrev_b32 v7, 2, v1
    v_mul_u32_u24 v7, 9216, v7
    v_lshl_add_u32 v46, v6, 4, v7
    s_lshl_b32 s96, s89, 6
    v_mov_b32 v6, s87
    s_mul_i32 s97, s95, 36864
    s_add_u32 s97, s97, 35328
    s_mov_b32 s68, s30
    s_mov_b32 s69, s31
    s_mov_b32 s70, 0x510000
    s_mov_b32 s71, 0x20000
    v_lshlrev_b32 v8, 4, v1
    s_mul_i32 s92, s89, 36864
    s_mul_i32 s93, s87, 9216
    s_add_u32 s92, s92, s93
    s_add_u32 s93, s93, 109184
    s_cmp_lt_u32 s41, 8
    s_cselect_b32 s94, 0, 100
    v_mov_b32 v9, s94
W_126:
    s_sleep 2
    ds_read_b32 v10, v9 offset:100
    s_sub_u32 s39, s39, 1
    s_cbranch_scc1 KS_ABORT
    s_waitcnt lgkmcnt(0)
    v_cmp_ne_u32 vcc, s84, v10
    s_cbranch_vccnz W_126
    s_cmp_ge_u32 s41, 8
    s_cselect_b64 vcc, -1, 0
    s_cbranch_scc1 KS_GD1
    s_add_u32 m0, s93, 0
    s_add_u32 s94, s92, 0
    buffer_load_dwordx4 v8, s[68:71], s94 offen offset:0 nt lds
    buffer_load_dwordx4 v8, s[68:71], s94 offen offset:1024 nt lds
    buffer_load_dwordx4 v8, s[68:71], s94 offen offset:2048 nt lds
    buffer_load_dwordx4 v8, s[68:71], s94 offen offset:3072 nt lds
    s_add_u32 m0, s93, 4096
    s_add_u32 s94, s92, 4096
    buffer_load_dwordx4 v8, s[68:71], s94 offen offset:0 nt lds
    buffer_load_dwordx4 v8, s[68:71], s94 offen offset:1024 nt lds
    buffer_load_dwordx4 v8, s[68:71], s94 offen offset:2048 nt lds
    buffer_load_dwordx4 v8, s[68:71], s94 offen offset:3072 nt lds
    s_add_u32 m0, s93, 8192
    s_add_u32 s94, s92, 8192
    buffer_load_dwordx4 v8, s[68:71], s94 offen offset:0 nt lds
KS_GD1:
    s_cmp_ge_u32 s87, 2
    s_cbranch_scc1 KS_GL
    buffer_load_dwordx4 v[48:51], v46, s[72:75], s96 offen nt
    s_sleep 6
    s_add_u32 s96, s96, 147456
    buffer_load_dwordx4 v[52:55], v46, s[72:75], s96 offen nt
    s_sleep 6
    s_add_u32 s96, s96, 147456
    buffer_load_dwordx4 v[56:59], v46, s[72:75], s96 offen nt
    s_sleep 6
    s_add_u32 s96, s96, 147456
    buffer_load_dwordx4 v[60:63], v46, s[72:75], s96 offen nt
    s_sleep 6
    s_add_u32 s96, s96, 147456
    buffer_load_dwordx4 v[64:67], v46, s[72:75], s96 offen nt
    s_sleep 6
    s_add_u32 s96, s96, 147456
    buffer_load_dwordx4 v[68:71], v46, s[72:75], s96 offen nt
    s_sleep 6
    s_add_u32 s96, s96, 147456
    buffer_load_dwordx4 v[72:75], v46, s[72:75], s96 offen nt
    s_sleep 6
    s_add_u32 s96, s96, 147456
    buffer_load_dwordx4 v[76:79], v46, s[72:75], s96 offen nt
    s_sleep 6
    s_add_u32 s96, s96, 147456
    buffer_load_dwordx4 v[80:83], v46, s[72:75], s96 offen nt
    s_sleep 6
    s_add_u32 s96, s96, 147456
    buffer_load_dwordx4 v[84:87], v46, s[72:75], s96 offen nt
    s_sleep 6
    s_add_u32 s96, s96, 147456
    buffer_load_dwordx4 v[88:91], v46, s[72:75], s96 offen nt
    s_sleep 6
    s_add_u32 s96, s96, 147456
    buffer_load_dwordx4 v[92:95], v46, s[72:75], s96 offen nt
    s_sleep 6
    s_add_u32 s96, s96, 147456
    buffer_load_dwordx4 v[96:99], v46, s[72:75], s96 offen nt
    s_sleep 6
    s_add_u32 s96, s96, 147456
    buffer_load_dwordx4 v[100:103], v46, s[72:75], s96 offen nt
    s_sleep 6
    s_add_u32 s96, s96, 147456
    buffer_load_dwordx4 v[104:107], v46, s[72:75], s96 offen nt
    s_sleep 6
    s_add_u32 s96, s96, 147456
    buffer_load_dwordx4 v[108:111], v46, s[72:75], s96 offen nt
    s_sleep 6
    s_add_u32 s96, s96, 147456
    buffer_load_dwordx4 v[112:115], v46, s[72:75], s96 offen nt
    s_sleep 6
    s_add_u32 s96, s96, 147456
    buffer_load_dwordx4 v[116:119], v46, s[72:75], s96 offen nt
    v_add_u32 v8, s97, v8
    s_waitcnt vmcnt(0)
    ds_write_b8 v6, v5 offset:40
W_127:
    s_sleep 2
    ds_read_b32 v10, v4 offset:52
    s_sub_u32 s39, s39, 1
    s_cbranch_scc1 KS_ABORT
    s_waitcnt lgkmcnt(0)
    v_cmp_ne_u32 vcc, s84, v10
    s_cbranch_vccnz W_127
W_128:
    s_sleep 2
    ds_read_b32 v10, v4 offset:12
    s_sub_u32 s39, s39, 1
    s_cbranch_scc1 KS_ABORT
    s_waitcnt lgkmcnt(0)
    v_cmp_ne_u32 vcc, s84, v10
    s_cbranch_vccnz W_128
    ds_write_b128 v8, v[48:51] offset:0
    ds_write_b128 v8, v[52:55] offset:1024
    ds_write_b128 v8, v[56:59] offset:2048
    ds_write_b128 v8, v[60:63] offset:3072
    ds_write_b128 v8, v[64:67] offset:4096
    ds_write_b128 v8, v[68:71] offset:5120
    ds_write_b128 v8, v[72:75] offset:6144
    ds_write_b128 v8, v[76:79] offset:7168
    ds_write_b128 v8, v[80:83] offset:8192
    ds_write_b128 v8, v[84:87] offset:9216
    ds_write_b128 v8, v[88:91] offset:10240
    ds_write_b128 v8, v[92:95] offset:11264
    ds_write_b128 v8, v[96:99] offset:12288
    ds_write_b128 v8, v[100:103] offset:13312
    ds_write_b128 v8, v[104:107] offset:14336
    ds_write_b128 v8, v[108:111] offset:15360
    ds_write_b128 v8, v[112:115] offset:16384
    ds_write_b128 v8, v[116:119] offset:17408
    s_branch KS_G4
KS_GL:
    s_add_u32 s96, s96, 2654208
    s_add_u32 s97, s97, 18432
    v_add_u32 v8, s97, v8
    s_waitcnt vmcnt(0)
    ds_write_b8 v6, v5 offset:40
W_129:
    s_sleep 2
    ds_read_b32 v10, v4 offset:52
    s_sub_u32 s39, s39, 1
    s_cbranch_scc1 KS_ABORT
    s_waitcnt lgkmcnt(0)
    v_cmp_ne_u32 vcc, s84, v10
    s_cbranch_vccnz W_129
    s_cmp_ge_u32 s41, 8
    s_cbranch_scc1 KS_GLZ
W_130:
    s_sleep 2
    ds_read_b32 v10, v4 offset:20
    s_sub_u32 s39, s39, 1
    s_cbranch_scc1 KS_ABORT
    s_waitcnt lgkmcnt(0)
    v_cmp_ne_u32 vcc, s84, v10
    s_cbranch_vccnz W_130
KS_GLZ:
    s_setprio 1
    s_add_u32 m0, s97, 0
    s_nop 0
    buffer_load_dwordx4 v46, s[72:75], s96 offen offset:0  lds
    s_add_u32 s96, s96, 146432
    buffer_load_dwordx4 v46, s[72:75], s96 offen offset:1024  lds
    s_add_u32 s96, s96, 146432
    buffer_load_dwordx4 v46, s[72:75], s96 offen offset:2048  lds
    s_add_u32 s96, s96, 146432
    buffer_load_dwordx4 v46, s[72:75], s96 offen offset:3072  lds
    s_add_u32 m0, s97, 4096
    s_add_u32 s96, s96, 150528
    buffer_load_dwordx4 v46, s[72:75], s96 offen offset:0  lds
    s_add_u32 s96, s96, 146432
    buffer_load_dwordx4 v46, s[72:75], s96 offen offset:1024  lds
    s_add_u32 s96, s96, 146432
    buffer_load_dwordx4 v46, s[72:75], s96 offen offset:2048  lds
    s_add_u32 s96, s96, 146432
    buffer_load_dwordx4 v46, s[72:75], s96 offen offset:3072  lds
    s_add_u32 m0, s97, 8192
    s_add_u32 s96, s96, 150528
    buffer_load_dwordx4 v46, s[72:75], s96 offen offset:0  lds
    s_add_u32 s96, s96, 146432
    buffer_load_dwordx4 v46, s[72:75], s96 offen offset:1024  lds
    s_add_u32 s96, s96, 146432
    buffer_load_dwordx4 v46, s[72:75], s96 offen offset:2048  lds
    s_add_u32 s96, s96, 146432
    buffer_load_dwordx4 v46, s[72:75], s96 offen offset:3072  lds
    s_add_u32 m0, s97, 12288
    s_add_u32 s96, s96, 150528
    buffer_load_dwordx4 v46, s[72:75], s96 offen offset:0  lds
    s_add_u32 s96, s96, 146432
    buffer_load_dwordx4 v46, s[72:75], s96 offen offset:1024  lds
    s_add_u32 s96, s96, 146432
    buffer_load_dwordx4 v46, s[72:75], s96 offen offset:2048  lds
    s_add_u32 s96, s96, 146432
    buffer_load_dwordx4 v46, s[72:75], s96 offen offset:3072  lds
    s_add_u32 m0, s97, 16384
    s_add_u32 s96, s96, 150528
    buffer_load_dwordx4 v46, s[72:75], s96 offen offset:0  lds
    s_add_u32 s96, s96, 146432
    buffer_load_dwordx4 v46, s[72:75], s96 offen offset:1024  lds
    s_setprio 0
    s_waitcnt vmcnt(0)
KS_G4:
    ds_write_b8 v6, v5 offset:192
    v_lshrrev_b32 v6, 3, v1
    v_xor_b32 v6, v6, v3
    v_and_b32 v6, 1, v6
    v_and_b32 v7, 2, v1
    v_or_b32 v6, v6, v7
    v_xor_b32 v6, s87, v6
    v_mul_u32_u24 v7, 18432, v7
    v_lshl_add_u32 v7, v6, 4, v7
    v_and_b32 v6, 1, v1
    v_lshl_add_u32 v7, v6, 3, v7
    v_bfe_u32 v6, v1, 2, 2
    v_lshl_add_u32 v6, v3, 3, v6
    v_lshl_add_u32 v7, v6, 6, v7
    v_add_u32 v8, 35328, v7
    v_and_b32 v9, 7, v1
    v_lshrrev_b32 v10, 1, v3
    v_and_b32 v11, 1, v3
    v_lshlrev_b32 v6, 5, v9
    v_lshl_add_u32 v6, v10, 8, v6
    v_lshl_add_u32 v6, v11, 4, v6
    v_add_u32 v6, 17088, v6
    s_lshl_b32 s92, s87, 4
    v_lshl_add_u32 v7, v9, 6, s92
    v_lshl_add_u32 v7, v11, 3, v7
    v_lshl_add_u32 v7, v10, 2, v7
    v_bfe_u32 v9, v1, 3, 1
    v_lshl_add_u32 v7, v9, 1, v7
W_131:
    s_sleep 2
    ds_read_b32 v10, v4 offset:192
    s_sub_u32 s39, s39, 1
    s_cbranch_scc1 KS_ABORT
    s_waitcnt lgkmcnt(0)
    v_cmp_ne_u32 vcc, s84, v10
    s_cbranch_vccnz W_131
W_132:
    s_sleep 2
    ds_read_b32 v10, v4 offset:12
    s_sub_u32 s39, s39, 1
    s_cbranch_scc1 KS_ABORT
    s_waitcnt lgkmcnt(0)
    v_cmp_ne_u32 vcc, s84, v10
    s_cbranch_vccnz W_132
    s_sleep 2
    ds_read_b64_tr_b16 v[48:49], v8 offset:0
    ds_read_b64_tr_b16 v[50:51], v8 offset:256
    ds_read_b64_tr_b16 v[52:53], v8 offset:2048
    ds_read_b64_tr_b16 v[54:55], v8 offset:2304
    ds_read_b64_tr_b16 v[56:57], v8 offset:4096
    ds_read_b64_tr_b16 v[58:59], v8 offset:4352
    ds_read_b64_tr_b16 v[60:61], v8 offset:6144
    ds_read_b64_tr_b16 v[62:63], v8 offset:6400
    ds_read_b64_tr_b16 v[64:65], v8 offset:8192
    ds_read_b64_tr_b16 v[66:67], v8 offset:8448
    ds_read_b64_tr_b16 v[68:69], v8 offset:10240
    ds_read_b64_tr_b16 v[70:71], v8 offset:10496
    ds_read_b64_tr_b16 v[72:73], v8 offset:12288
    ds_read_b64_tr_b16 v[74:75], v8 offset:12544
    ds_read_b64_tr_b16 v[76:77], v8 offset:14336
    ds_read_b64_tr_b16 v[78:79], v8 offset:14592
    ds_read_b64_tr_b16 v[80:81], v8 offset:16384
    ds_read_b64_tr_b16 v[82:83], v8 offset:16640
    ds_read_b64_tr_b16 v[84:85], v8 offset:18432
    ds_read_b64_tr_b16 v[86:87], v8 offset:18688
    ds_read_b64_tr_b16 v[88:89], v8 offset:20480
    ds_read_b64_tr_b16 v[90:91], v8 offset:20736
    ds_read_b64_tr_b16 v[92:93], v8 offset:22528
    ds_read_b64_tr_b16 v[94:95], v8 offset:22784
    ds_read_b64_tr_b16 v[96:97], v8 offset:24576
    ds_read_b64_tr_b16 v[98:99], v8 offset:24832
    ds_read_b64_tr_b16 v[100:101], v8 offset:26624
    ds_read_b64_tr_b16 v[102:103], v8 offset:26880
    ds_read_b64_tr_b16 v[104:105], v8 offset:28672
    ds_read_b64_tr_b16 v[106:107], v8 offset:28928
    ds_read_b64_tr_b16 v[108:109], v8 offset:30720
    ds_read_b64_tr_b16 v[110:111], v8 offset:30976
    ds_read_b64_tr_b16 v[112:113], v8 offset:32768
    ds_read_b64_tr_b16 v[114:115], v8 offset:33024
    ds_read_b64_tr_b16 v[116:117], v8 offset:34816
    ds_read_b64_tr_b16 v[118:119], v8 offset:35072
W_133:
    s_sleep 2
    ds_read_b32 v10, v4 offset:768
    s_sub_u32 s39, s39, 1
    s_cbranch_scc1 KS_ABORT
    s_waitcnt lgkmcnt(0)
    v_cmp_eq_u32 vcc, 0, v10
    s_cbranch_vccnz W_133
    s_setprio 3
KS_GC:
    s_mov_b32 exec_lo, 0x00ff00ff
    s_mov_b32 exec_hi, 0x00ff00ff
KS_GW:
    ds_read_b32 v0, v4 offset:32
    ds_read_b128 v[8:11], v6 offset:0
    ds_read_b128 v[12:15], v6 offset:512
    ds_read_b128 v[16:19], v6 offset:1024
    ds_read_b128 v[20:23], v6 offset:1536
    s_sub_u32 s39, s39, 1
    s_cbranch_scc1 KS_ABORT
    s_waitcnt lgkmcnt(4)
    v_cmp_eq_u32 vcc, 0, v0
    s_cbranch_vccnz KS_GW
    s_waitcnt lgkmcnt(3)
    v_mfma_f32_16x16x32_bf16 v[120:123], v[48:51], v[8:11], 0
    ds_read_b128 v[24:27], v6 offset:2048
    ds_read_b128 v[28:31], v6 offset:2560
    s_waitcnt lgkmcnt(4)
    v_mfma_f32_16x16x32_bf16 v[124:127], v[52:55], v[12:15], 0
    ds_read_b128 v[32:35], v6 offset:3072
    ds_read_b128 v[36:39], v6 offset:3584
    s_waitcnt lgkmcnt(5)
    v_mfma_f32_16x16x32_bf16 v[120:123], v[56:59], v[16:19], v[120:123]
    ds_read_b128 v[40:43], v6 offset:4096
    ds_read_b128 v[44:47], v6 offset:4608
    s_waitcnt lgkmcnt(6)
    v_mfma_f32_16x16x32_bf16 v[124:127], v[60:63], v[20:23], v[124:127]
    ds_read_b128 v[8:11], v6 offset:5120
    ds_read_b128 v[12:15], v6 offset:5632
    s_waitcnt lgkmcnt(7)
    v_mfma_f32_16x16x32_bf16 v[120:123], v[64:67], v[24:27], v[120:123]
    ds_read_b128 v[16:19], v6 offset:6144
    ds_read_b128 v[20:23], v6 offset:6656
    s_waitcnt lgkmcnt(8)
    v_mfma_f32_16x16x32_bf16 v[124:127], v[68:71], v[28:31], v[124:127]
    ds_read_b128 v[24:27], v6 offset:7168
    ds_read_b128 v[28:31], v6 offset:7680
    s_waitcnt lgkmcnt(9)
    v_mfma_f32_16x16x32_bf16 v[120:123], v[72:75], v[32:35], v[120:123]
    ds_read_b128 v[32:35], v6 offset:8192
    s_waitcnt lgkmcnt(9)
    v_mfma_f32_16x16x32_bf16 v[124:127], v[76:79], v[36:39], v[124:127]
    ds_read_b128 v[36:39], v6 offset:8704
    s_waitcnt lgkmcnt(9)
    v_mfma_f32_16x16x32_bf16 v[120:123], v[80:83], v[40:43], v[120:123]
    s_waitcnt lgkmcnt(8)
    v_mfma_f32_16x16x32_bf16 v[124:127], v[84:87], v[44:47], v[124:127]
    s_waitcnt lgkmcnt(7)
    v_mfma_f32_16x16x32_bf16 v[120:123], v[88:91], v[8:11], v[120:123]
    s_waitcnt lgkmcnt(6)
    v_mfma_f32_16x16x32_bf16 v[124:127], v[92:95], v[12:15], v[124:127]
    s_waitcnt lgkmcnt(5)
    v_mfma_f32_16x16x32_bf16 v[120:123], v[96:99], v[16:19], v[120:123]
    s_waitcnt lgkmcnt(4)
    v_mfma_f32_16x16x32_bf16 v[124:127], v[100:103], v[20:23], v[124:127]
    s_waitcnt lgkmcnt(3)
    v_mfma_f32_16x16x32_bf16 v[120:123], v[104:107], v[24:27], v[120:123]
    s_waitcnt lgkmcnt(2)
    v_mfma_f32_16x16x32_bf16 v[124:127], v[108:111], v[28:31], v[124:127]
    s_waitcnt lgkmcnt(1)
    v_mfma_f32_16x16x32_bf16 v[120:123], v[112:115], v[32:35], v[120:123]
    s_waitcnt lgkmcnt(0)
    v_mfma_f32_16x16x32_bf16 v[124:127], v[116:119], v[36:39], v[124:127]
    s_mov_b64 exec, -1
    s_nop 6
    v_pk_add_f32 v[120:121], v[120:121], v[124:125]
    v_pk_add_f32 v[122:123], v[122:123], v[126:127]
    s_nop 1
    v_permlane32_swap_b32 v121, v123
    v_permlane32_swap_b32 v120, v122
    s_nop 0
    v_mov_b32_dpp v120, v121 row_shr:8 row_mask:0xf bank_mask:0xc
    v_mov_b32_dpp v122, v123 row_shr:8 row_mask:0xf bank_mask:0xc
    v_cvt_pk_bf16_f32 v120, 0, v120
    v_mul_f32 v121, 0xbfb8aa3b, v120
    v_exp_f32 v121, v121
    v_cvt_pk_bf16_f32 v122, 0, v122
    v_add_f32 v121, 1.0, v121
    v_rcp_f32 v121, v121
    s_nop 0
    v_mul_f32 v121, v120, v121
    v_cvt_pk_bf16_f32 v121, 0, v121
    v_mul_f32 v121, v121, v122
    v_cvt_pk_bf16_f32 v121, v121, v121
    ds_write_b16 v7, v121 offset:1024
    s_waitcnt lgkmcnt(0)
    s_barrier
    s_setprio 0
    ds_read_b32 v0, v4 offset:24
    s_waitcnt lgkmcnt(0)
    v_cmp_eq_u32 vcc, 0, v0
    s_cbranch_vccnz KS_PEND
    s_barrier
    s_branch KS_GC
KS_PEND:
KS_ABORT:
KS_END:
    s_endpgm
.section .rodata,"a"
.p2align 6
.amdhsa_kernel sequential_preLN__ssm_conv_s4__moe_arch_mod__prompt_kernel
  .amdhsa_next_free_vgpr 128
  .amdhsa_next_free_sgpr 100
  .amdhsa_accum_offset 128
  .amdhsa_group_segment_fixed_size 0
  .amdhsa_kernarg_size 136
  .amdhsa_user_sgpr_count 2
  .amdhsa_user_sgpr_kernarg_segment_ptr 1
  .amdhsa_system_sgpr_workgroup_id_x 1
  .amdhsa_float_denorm_mode_32 3
.end_amdhsa_kernel
```

```asm
; @launch grid=(256,1,1) block=(1024,1,1) lds=154240
.amdgcn_target "amdgcn-amd-amdhsa--gfx950"
.text
.globl sequential_preLN__ssm_conv_s4__moe_arch_mod__prompt_kernel
.p2align 8
.type sequential_preLN__ssm_conv_s4__moe_arch_mod__prompt_kernel,@function
sequential_preLN__ssm_conv_s4__moe_arch_mod__prompt_kernel:
    s_cmp_ge_u32 s2, 256
    s_cbranch_scc1 KS_END
    s_load_dwordx16 s[4:19], s[0:1], 0
    s_load_dwordx16 s[20:35], s[0:1], 64
    s_load_dwordx2 s[36:37], s[0:1], 128
    v_readfirstlane_b32 s38, v0
    s_lshr_b32 s38, s38, 6
    s_and_b32 s40, s2, 7
    s_lshr_b32 s41, s2, 3
    s_cmp_lg_u32 s38, 0
    s_cbranch_scc1 KS_CPE
    s_getpc_b64 s[42:43]
KS_PC:
    s_and_b32 s92, s41, 7
    s_mul_i32 s92, s92, 4608
    v_and_b32 v126, 63, v0
    v_lshl_add_u32 v126, v126, 7, s92
    v_min_u32 v126, KS_END-KS_PC, v126
    global_load_dword v127, v126, s[42:43]
KS_CPE:
    s_add_u32 s92, s38, 8
    s_sub_u32 s93, s38, 4
    s_cmp_lt_u32 s38, 8
    s_cselect_b32 s92, s92, s93
    s_cmp_lt_u32 s38, 4
    s_cselect_b32 s38, s38, s92
    v_and_b32 v1, 63, v0
    v_and_b32 v2, 15, v1
    v_lshrrev_b32 v3, 4, v1
    v_mov_b32 v4, 0
    v_mov_b32 v5, 1
    s_mov_b32 s39, 524288
    s_mov_b32 s84, 0x01010101
    s_lshl_b32 s90, s40, 5
    s_add_u32 s90, s90, s41
    s_mul_i32 s89, s40, 18
    s_add_u32 s89, s89, s41
    s_cmp_lt_u32 s38, 4
    s_cbranch_scc1 KS_L
    s_cmp_ge_u32 s38, 12
    s_cbranch_scc1 KS_X
    s_setprio 2
    s_lshr_b32 s87, s38, 2
    s_sub_u32 s87, s87, 1
    s_mul_i32 s86, s87, 3
    s_xor_b32 s86, s86, s38
    s_and_b32 s86, s86, 3
    s_lshl_b32 s88, s90, 1
    s_add_u32 s88, s88, s87
    s_lshl_b32 s92, s86, 11
    s_add_u32 s92, s92, 146048
    v_lshl_add_u32 v28, v1, 3, s92
    s_cmp_eq_u32 s86, 3
    s_cbranch_scc1 PX_1
    v_lshlrev_b32 v26, 3, v2
    v_mov_b32 v21, 0x80
    s_cmp_eq_u32 s86, 1
    s_cbranch_scc1 PX_2
    s_cmp_eq_u32 s86, 2
    s_cbranch_scc1 PX_3
    v_lshl_add_u32 v26, v3, 1, v26
    v_mov_b32 v22, 1
    s_branch PX_4
PX_2:
    v_cmp_gt_u32 vcc, 2, v3
    v_lshl_add_u32 v20, v3, 2, v26
    v_add_u32 v20, 256, v20
    v_lshl_add_u32 v26, v3, 8, v26
    v_cndmask_b32 v26, v26, v20, vcc
    v_cndmask_b32 v22, v21, 2, vcc
    v_cndmask_b32 v21, 4, v21, vcc
    s_branch PX_4
PX_3:
    v_lshl_add_u32 v26, v3, 9, v26
    v_add_u32 v26, 0x400, v26
    v_mov_b32 v22, 0x100
PX_4:
    v_mad_u32_u24 v26, v22, s87, v26
    v_add_u32 v27, v26, v21
    s_movk_i32 s96, 31232
    s_movk_i32 s97, -19072
    s_lshl_b32 s95, s87, 9
    v_cvt_f32_u32 v20, v26
    v_max_u32 v22, 0x800, v26
    v_cvt_f32_u32 v21, v27
    v_max_u32 v23, 0x800, v27
    v_cmp_gt_u32 vcc, 0x80, v26
    v_lshrrev_b32 v24, 16, v20
    v_add3_u32 v24, v24, v22, s97
    v_cndmask_b32 v24, v24, v26, vcc
    v_cmp_gt_u32 vcc, 0x80, v27
    v_lshrrev_b32 v25, 16, v21
    v_add3_u32 v25, v25, v23, s97
    v_cndmask_b32 v25, v25, v27, vcc
    v_min_u32 v24, 642, v24
    v_lshl_add_u32 v24, v24, 1, s96
    v_min_u32 v25, 642, v25
    v_lshl_add_u32 v25, v25, 1, s96
    v_add_u32 v29, s95, v28
    v_lshl_or_b32 v24, v25, 16, v24
    v_lshl_or_b32 v25, v27, 16, v26
    ds_write_b64 v29, v[24:25]
PX_1:
KS_GRP:
    s_lshl_b32 s92, s88, 8
    v_lshl_add_u32 v20, v1, 2, s92
    s_lshl_b32 s92, s88, 1
    v_mov_b32 v21, s92
    s_mul_i32 s85, s87, 36672
    s_add_u32 s85, s85, 35840
    s_waitcnt lgkmcnt(0)
    global_load_ushort v46, v21, s[18:19]
    global_load_dword v40, v20, s[6:7]
    global_load_dword v41, v20, s[8:9]
    global_load_dword v42, v20, s[10:11]
    global_load_dword v43, v20, s[12:13]
    global_load_dword v44, v20, s[14:15]
    global_load_dword v45, v20, s[16:17]
    global_load_ushort v107, v21, s[20:21]
    s_barrier
    s_movk_i32 s96, 31232
    s_cmp_eq_u32 s87, 2
    s_cbranch_scc1 PREE_7
    v_mov_b32 v32, 641
    s_cmp_eq_u32 s87, 1
    s_cbranch_scc1 PREB_5
    v_mov_b32 v33, 32514
    s_cmp_eq_u32 s86, 1
    s_cbranch_scc1 PRE_9
    s_cmp_eq_u32 s86, 2
    s_cbranch_scc1 PRE_10
    s_cmp_eq_u32 s86, 3
    s_cbranch_scc1 PRE_11
    v_lshlrev_b32 v23, 1, v1
    v_sub_u32 v30, 93, v23
    v_cmp_lt_u32 vcc, 61, v30
    v_lshlrev_b32 v31, 2, v30
    v_add_u32 v31, 32010, v31
    v_cndmask_b32 v24, v31, v33, vcc
    v_sub_u32 v30, 92, v23
    v_cmp_lt_u32 vcc, 61, v30
    v_lshlrev_b32 v31, 2, v30
    v_add_u32 v31, 32010, v31
    v_cndmask_b32 v25, v31, v33, vcc
    v_sub_u32 v30, 94, v23
    v_cmp_lt_u32 vcc, 62, v30
    v_lshlrev_b32 v31, 2, v30
    v_add_u32 v31, 32008, v31
    v_cndmask_b32 v26, v31, v33, vcc
    v_sub_u32 v30, 93, v23
    v_cmp_lt_u32 vcc, 62, v30
    v_lshlrev_b32 v31, 2, v30
    v_add_u32 v31, 32008, v31
    v_cndmask_b32 v27, v31, v33, vcc
    s_branch PREW_6
PRE_9:
    v_min_u32 v23, 47, v1
    v_lshlrev_b32 v23, 1, v23
    v_sub_u32 v30, 64, v23
    v_cmp_lt_u32 vcc, 63, v30
    v_lshlrev_b32 v31, 2, v30
    v_add_u32 v31, 32258, v31
    v_cndmask_b32 v24, v31, v33, vcc
    v_sub_u32 v30, 63, v23
    v_cmp_lt_u32 vcc, 63, v30
    v_lshlrev_b32 v31, 2, v30
    v_add_u32 v31, 32258, v31
    v_cndmask_b32 v25, v31, v33, vcc
    v_sub_u32 v30, 62, v23
    v_cmp_lt_u32 vcc, 63, v30
    v_lshlrev_b32 v31, 2, v30
    v_add_u32 v31, 32258, v31
    v_cndmask_b32 v27, v31, v33, vcc
    v_mov_b32 v26, v25
    s_branch PREW_6
PRE_10:
    v_min_u32 v23, 47, v1
    v_lshlrev_b32 v23, 1, v23
    v_sub_u32 v30, 64, v23
    v_cmp_lt_u32 vcc, 63, v30
    v_lshlrev_b32 v31, 2, v30
    v_add_u32 v31, 32260, v31
    v_cndmask_b32 v24, v31, v33, vcc
    v_sub_u32 v30, 63, v23
    v_cmp_lt_u32 vcc, 63, v30
    v_lshlrev_b32 v31, 2, v30
    v_add_u32 v31, 32260, v31
    v_cndmask_b32 v25, v31, v33, vcc
    v_sub_u32 v30, 62, v23
    v_cmp_lt_u32 vcc, 63, v30
    v_lshlrev_b32 v31, 2, v30
    v_add_u32 v31, 32260, v31
    v_cndmask_b32 v27, v31, v33, vcc
    v_mov_b32 v26, v25
    s_branch PREW_6
PRE_11:
    v_cmp_gt_u32 vcc, 9, v1
    v_add_u32 v23, 0x100, v1
    v_mov_b32 v33, 0x200
    v_cndmask_b32 v23, v23, v1, vcc
    v_lshlrev_b32 v23, 1, v23
    v_sub_u32 v30, 544, v23
    v_cvt_f32_i32 v31, v30
    v_cmp_gt_u32 vcc, 0x100, v30
    v_cvt_pk_bf16_f32 v31, v31, v31
    v_and_b32 v31, 0xffff, v31
    v_subrev_u32 v31, 0x4280, v31
    v_cndmask_b32 v31, v31, v30, vcc
    v_cmp_lt_u32 vcc, 0x20d, v30
    v_or_b32 v30, 1, v23
    s_nop 0
    v_cndmask_b32 v31, v31, v32, vcc
    v_cmp_eq_u32 vcc, 0x25d, v30
    s_nop 1
    v_cndmask_b32 v31, v31, v33, vcc
    v_lshl_add_u32 v24, v31, 1, s96
    v_add_u32 v23, 1, v23
    v_sub_u32 v30, 544, v23
    v_cvt_f32_i32 v31, v30
    v_cmp_gt_u32 vcc, 0x100, v30
    v_cvt_pk_bf16_f32 v31, v31, v31
    v_and_b32 v31, 0xffff, v31
    v_subrev_u32 v31, 0x4280, v31
    v_cndmask_b32 v31, v31, v30, vcc
    v_cmp_lt_u32 vcc, 0x20d, v30
    v_or_b32 v30, 1, v23
    s_nop 0
    v_cndmask_b32 v31, v31, v32, vcc
    v_cmp_eq_u32 vcc, 0x25d, v30
    s_nop 1
    v_cndmask_b32 v31, v31, v33, vcc
    v_lshl_add_u32 v25, v31, 1, s96
    v_add_u32 v23, 1, v23
    v_sub_u32 v30, 544, v23
    v_cvt_f32_i32 v31, v30
    v_cmp_gt_u32 vcc, 0x100, v30
    v_cvt_pk_bf16_f32 v31, v31, v31
    v_and_b32 v31, 0xffff, v31
    v_subrev_u32 v31, 0x4280, v31
    v_cndmask_b32 v31, v31, v30, vcc
    v_cmp_lt_u32 vcc, 0x20d, v30
    v_or_b32 v30, 1, v23
    s_nop 0
    v_cndmask_b32 v31, v31, v32, vcc
    v_cmp_eq_u32 vcc, 0x25d, v30
    s_nop 1
    v_cndmask_b32 v31, v31, v33, vcc
    v_lshl_add_u32 v27, v31, 1, s96
    v_mov_b32 v26, v25
    s_branch PREW_6
PREB_5:
    s_lshl_b32 s93, s86, 7
    s_add_u32 s93, s93, 18
    v_lshl_add_u32 v23, v1, 1, s93
    v_sub_u32 v30, 544, v23
    v_cvt_f32_i32 v31, v30
    v_cmp_gt_u32 vcc, 0x100, v30
    v_cvt_pk_bf16_f32 v31, v31, v31
    v_and_b32 v31, 0xffff, v31
    v_subrev_u32 v31, 0x4280, v31
    v_cndmask_b32 v31, v31, v30, vcc
    v_cmp_lt_u32 vcc, 0x20d, v30
    s_nop 1
    v_cndmask_b32 v31, v31, v32, vcc
    v_lshl_add_u32 v24, v31, 1, s96
    v_add_u32 v23, 1, v23
    v_sub_u32 v30, 544, v23
    v_cvt_f32_i32 v31, v30
    v_cmp_gt_u32 vcc, 0x100, v30
    v_cvt_pk_bf16_f32 v31, v31, v31
    v_and_b32 v31, 0xffff, v31
    v_subrev_u32 v31, 0x4280, v31
    v_cndmask_b32 v31, v31, v30, vcc
    v_cmp_lt_u32 vcc, 0x20d, v30
    s_nop 1
    v_cndmask_b32 v31, v31, v32, vcc
    v_lshl_add_u32 v25, v31, 1, s96
    v_add_u32 v23, 1, v23
    v_sub_u32 v30, 544, v23
    v_cvt_f32_i32 v31, v30
    v_cmp_gt_u32 vcc, 0x100, v30
    v_cvt_pk_bf16_f32 v31, v31, v31
    v_and_b32 v31, 0xffff, v31
    v_subrev_u32 v31, 0x4280, v31
    v_cndmask_b32 v31, v31, v30, vcc
    v_cmp_lt_u32 vcc, 0x20d, v30
    s_nop 1
    v_cndmask_b32 v31, v31, v32, vcc
    v_lshl_add_u32 v26, v31, 1, s96
    s_sub_u32 s93, s86, 1
    s_cmp_lt_u32 s93, 2
    s_cselect_b32 s94, 47, 63
    s_mul_i32 s93, s93, 384
    s_add_u32 s93, s93, 35664
    s_cmp_eq_u32 s86, 0
    s_cselect_b32 s93, 35152, s93
    s_cmp_eq_u32 s86, 3
    s_cselect_b32 s93, 32528, s93
    s_cselect_b32 s95, 0x100, 0
    v_cmp_gt_u32 vcc, 9, v1
    v_min_u32 v23, s94, v1
    v_add_u32 v30, s95, v23
    v_cndmask_b32 v23, v30, v23, vcc
    s_sub_u32 s93, s93, 5244
    v_lshl_add_u32 v27, v23, 2, s93
    v_lshl_or_b32 v24, v25, 16, v24
    v_lshl_or_b32 v25, v27, 16, v26
    ds_write_b64 v28, v[24:25] offset:1024
    v_mov_b32 v24, s86
    ds_write_b8 v24, v5 offset:212
    s_branch PREE_7
PREW_6:
    v_lshl_or_b32 v24, v25, 16, v24
    v_lshl_or_b32 v25, v27, 16, v26
    ds_write_b64 v28, v[24:25] offset:1536
    v_mov_b32 v24, s86
    ds_write_b8 v24, v5 offset:208
PREE_7:
    s_mul_i32 s93, s86, 8704
    s_min_u32 s94, s93, 22304
    s_add_u32 s94, s94, s85
    s_lshl_b32 s92, s87, 4
    v_mov_b32 v14, s92
    v_add_u32 v15, s86, v14
    v_lshl_add_u32 v72, v1, 3, s94
    v_add_u32 v73, 2176, v72
    v_add_u32 v74, 4352, v72
    v_add_u32 v75, 6528, v72
    v_mul_u32_u24 v126, 544, v2
    v_lshl_add_u32 v126, v3, 4, v126
    v_add_u32 v126, s85, v126
    v_add_u32 v127, s93, v126
    v_lshlrev_b32 v20, 3, v3
    v_sub_u32 v20, v20, v2
    v_add_u32 v21, 16, v20
    v_lshrrev_b32 v21, 1, v21
    v_and_b32 v23, 1, v21
    s_movk_i32 s93, -5244
    v_and_b32 v22, 1, v2
    s_add_u32 s92, s85, 32528
    v_lshl_add_u32 v21, v21, 2, s92
    s_movk_i32 s92, 1344
    s_movk_i32 s94, 192
    v_mad_i32_i24 v21, v23, s93, v21
    v_mad_u32_u24 v6, v22, s92, v21
    v_add_u32 v7, 640, v6
    v_mad_u32_u24 v23, v22, s94, v21
    v_add_u32 v13, 3136, v23
    v_lshlrev_b32 v23, 2, v3
    v_sub_u32 v23, v23, v2
    s_add_u32 s92, s85, 29968
    v_lshl_add_u32 v11, v23, 2, s92
    s_movk_i32 s93, 5244
    v_mad_u32_u24 v11, v22, s93, v11
    s_mul_i32 s94, s87, 4672
    s_add_u32 s94, s94, 3072
    v_lshl_add_u32 v23, v2, 5, s94
    v_lshl_add_u32 v8, v3, 4, v23
    v_bfe_u32 v20, v1, 2, 2
    v_and_b32 v21, 3, v1
    v_lshl_add_u32 v20, v3, 3, v20
    v_lshlrev_b32 v105, 2, v21
    v_lshl_add_u32 v21, v21, 3, s85
    v_lshl_add_u32 v9, v20, 4, v21
    v_lshl_add_u32 v10, v20, 5, v21
    v_lshlrev_b32 v12, 4, v1
    s_add_u32 s64, s36, 0x600000
    s_addc_u32 s65, s37, 0
    s_mov_b32 s66, 0x240000
    s_mov_b32 s67, 0x20000
    s_mov_b32 s10, 0x8080
    s_lshl_b32 s92, s86, 19
    s_lshl_b32 s93, s90, 6
    s_add_u32 s92, s92, s93
    s_lshl_b32 s93, s86, 16
    s_lshl_b32 s95, s88, 6
    s_add_u32 s93, s93, s95
    s_add_u32 s93, s93, 2064384
    s_cmp_eq_u32 s87, 2
    s_cselect_b32 s6, s93, s92
    s_cselect_b32 s8, 0x1080, s10
    s_cselect_b32 s92, 1, 3
    s_and_b32 s92, s92, s86
    s_lshl_b32 s92, s92, 11
    s_xor_b32 s6, s6, s92
    s_and_b32 s10, s6, 0x7c0
    s_xor_b32 s6, s6, s10
    s_xor_b32 s7, s6, 0x6000
    s_and_b32 s9, s87, 1
    s_lshl_b32 s9, s9, 4
    s_mov_b32 s12, 0x55555555
    s_mov_b32 s13, 0x55555555
    s_lshl_b32 s92, s86, 8
    s_add_u32 s92, s92, s85
    s_add_u32 s92, s92, 36
    v_lshl_add_u32 v124, v1, 2, s92
    s_movk_i32 s92, 192
    s_cmp_eq_u32 s86, 0
    s_cselect_b32 s92, 256, s92
    s_cmp_eq_u32 s86, 3
    s_cselect_b32 s92, 1344, s92
    v_mov_b32 v20, s85
    ds_write_b16 v20, v4 offset:32514
    s_mov_b32 s18, s92
    v_mov_b32 v125, v28
W_12:
    ds_read_b64 v[18:19], v4 offset:208
    s_sub_u32 s39, s39, 1
    s_cbranch_scc1 KS_ABORT
    s_waitcnt lgkmcnt(0)
    v_and_b32 v18, v18, v19
    v_cmp_ne_u32 vcc, s84, v18
    s_cbranch_vccnz W_12
    ds_read2st64_b64 v[28:31], v125 offset0:0 offset1:1
    ds_read2st64_b64 v[32:35], v125 offset0:2 offset1:3
    s_waitcnt lgkmcnt(0)
    v_add_u32_sdwa v108, s85, v28 dst_sel:DWORD dst_unused:UNUSED_PAD src0_sel:DWORD src1_sel:WORD_0
    v_add_u32_sdwa v109, s85, v28 dst_sel:DWORD dst_unused:UNUSED_PAD src0_sel:DWORD src1_sel:WORD_1
    v_cvt_f32_u32_sdwa v110, v29 dst_sel:DWORD dst_unused:UNUSED_PAD src0_sel:WORD_0
    v_cvt_f32_u32_sdwa v111, v29 dst_sel:DWORD dst_unused:UNUSED_PAD src0_sel:WORD_1
    v_add_u32_sdwa v112, s85, v30 dst_sel:DWORD dst_unused:UNUSED_PAD src0_sel:DWORD src1_sel:WORD_0
    v_add_u32_sdwa v113, s85, v30 dst_sel:DWORD dst_unused:UNUSED_PAD src0_sel:DWORD src1_sel:WORD_1
    v_cvt_f32_u32_sdwa v114, v31 dst_sel:DWORD dst_unused:UNUSED_PAD src0_sel:WORD_0
    v_cvt_f32_u32_sdwa v115, v31 dst_sel:DWORD dst_unused:UNUSED_PAD src0_sel:WORD_1
    v_add_u32_sdwa v116, s85, v32 dst_sel:DWORD dst_unused:UNUSED_PAD src0_sel:DWORD src1_sel:WORD_0
    v_add_u32_sdwa v117, s85, v32 dst_sel:DWORD dst_unused:UNUSED_PAD src0_sel:DWORD src1_sel:WORD_1
    v_add_u32_sdwa v118, s85, v33 dst_sel:DWORD dst_unused:UNUSED_PAD src0_sel:DWORD src1_sel:WORD_0
    v_add_u32_sdwa v119, s85, v33 dst_sel:DWORD dst_unused:UNUSED_PAD src0_sel:DWORD src1_sel:WORD_1
    v_add_u32_sdwa v120, s85, v34 dst_sel:DWORD dst_unused:UNUSED_PAD src0_sel:DWORD src1_sel:WORD_0
    v_add_u32_sdwa v121, s85, v34 dst_sel:DWORD dst_unused:UNUSED_PAD src0_sel:DWORD src1_sel:WORD_1
    v_add_u32_sdwa v122, s85, v35 dst_sel:DWORD dst_unused:UNUSED_PAD src0_sel:DWORD src1_sel:WORD_0
    v_add_u32_sdwa v123, s85, v35 dst_sel:DWORD dst_unused:UNUSED_PAD src0_sel:DWORD src1_sel:WORD_1
    v_add_u32 v125, s18, v119
    s_lshl_b32 s92, s87, 5
    s_add_u32 s92, s92, s41
    s_cmp_ge_u32 s92, 88
    s_cbranch_scc1 KC_RECV
    s_mov_b32 s92, 0x3fb8aa3b
    s_mov_b32 s93, 0x32a57060
    s_mov_b32 s94, 0x3e22f983
    s_mov_b32 s95, 0x31dc9c88
    s_waitcnt vmcnt(7)
    v_lshlrev_b32 v16, 16, v46
    v_mul_f32 v17, s92, v16
    v_fma_f32 v19, v16, s92, -v17
    v_fmac_f32 v19, s93, v16
    v_exp_f32 v17, v17
    v_mul_f32 v19, 0x3f317218, v19
    v_fmac_f32 v17, v17, v19
    v_cvt_pk_bf16_f32 v16, 0, v17
    s_waitcnt vmcnt(5)
    ds_write_b32 v4, v5 offset:36
    v_lshlrev_b32 v20, 16, v40
    v_and_b32 v21, 0xffff0000, v40
    v_lshlrev_b32 v22, 16, v41
    v_and_b32 v23, 0xffff0000, v41
    v_pk_mul_f32 v[20:21], v[20:21], v[16:17] op_sel_hi:[1,0]
    v_pk_mul_f32 v[22:23], v[22:23], v[16:17] op_sel_hi:[1,0]
    v_max_f32 v36, v20, v21
    v_pk_mul_f32 v[68:69], v[22:23], s[94:95] op_sel_hi:[1,0]
    v_pk_fma_f32 v[70:71], v[22:23], s[94:95], v[68:69] op_sel_hi:[1,0,1] neg_lo:[0,0,1] neg_hi:[0,0,1]
    v_pk_fma_f32 v[70:71], v[22:23], s[94:95], v[70:71] op_sel:[0,1,0]
    s_cmp_eq_u32 s86, 3
    s_cbranch_scc1 SK_14
    s_waitcnt vmcnt(1)
    v_lshlrev_b32 v24, 16, v42
    v_and_b32 v25, 0xffff0000, v42
    v_lshlrev_b32 v26, 16, v43
    v_and_b32 v27, 0xffff0000, v43
    v_lshlrev_b32 v28, 16, v44
    v_and_b32 v29, 0xffff0000, v44
    v_lshlrev_b32 v30, 16, v45
    v_and_b32 v31, 0xffff0000, v45
    v_pk_mul_f32 v[24:25], v[24:25], v[16:17] op_sel_hi:[1,0]
    v_pk_mul_f32 v[26:27], v[26:27], v[16:17] op_sel_hi:[1,0]
    v_pk_mul_f32 v[90:91], v[30:31], v[26:27]
    v_pk_mul_f32 v[92:93], v[30:31], v[24:25]
    v_pk_fma_f32 v[34:35], v[28:29], v[26:27], v[92:93]
    v_pk_fma_f32 v[32:33], v[28:29], v[24:25], v[90:91] neg_lo:[0,0,1] neg_hi:[0,0,1]
    v_max3_f32 v37, abs(v34), abs(v35), abs(v32)
    v_max_f32 v37, v37, abs(v33)
SK_14:
    s_waitcnt vmcnt(0)
    s_nop 0
    v_permlane32_swap_b32 v36, v37
    v_max_f32 v36, v36, v37
    s_nop 1
    v_max_f32_dpp v36, v36, v36 row_ror:8 row_mask:0xf bank_mask:0xf
    s_nop 1
    v_max_f32_dpp v36, v36, v36 row_ror:4 row_mask:0xf bank_mask:0xf
    s_nop 1
    v_max_f32_dpp v36, v36, v36 row_ror:2 row_mask:0xf bank_mask:0xf
    s_nop 1
    v_max_f32_dpp v36, v36, v36 row_ror:1 row_mask:0xf bank_mask:0xf
    v_mov_b32 v38, v36
    s_nop 1
    v_permlane16_swap_b32 v36, v38
    v_max_f32 v36, v36, v38
    s_nop 0
    v_readlane_b32 s14, v36, 0
    v_readlane_b32 s15, v36, 32
    s_add_u32 s15, s15, 0x7fffff
    s_lshr_b32 s15, s15, 23
    s_max_u32 s15, s15, 24
    s_sub_u32 s16, 269, s15
    s_lshl_b32 s16, s16, 23
    v_subrev_f32 v20, s14, v20
    v_subrev_f32 v21, s14, v21
    v_mul_f32 v20, 0x3fb8aa3b, v20
    v_mul_f32 v21, 0x3fb8aa3b, v21
    s_cmp_eq_u32 s86, 3
    s_cbranch_scc1 JOB_18
    s_cmp_eq_u32 s86, 1
    s_cbranch_scc1 JOB_16
    s_cmp_eq_u32 s86, 2
    s_cbranch_scc1 JOB_17
    v_mul_f32 v91, 0x43000000, v68
    v_mul_f32 v90, 0x43000000, v20
    v_mul_f32 v95, 0x43000000, v69
    v_mul_f32 v94, 0x43000000, v21
    v_fract_f32 v91, v91
    v_fract_f32 v95, v95
    v_fmac_f32 v91, 0x43000000, v70
    v_fmac_f32 v95, 0x43000000, v71
    v_exp_f32 v90, v90
    v_cos_f32 v92, v91
    v_sin_f32 v91, v91
    v_exp_f32 v94, v94
    v_cos_f32 v96, v95
    v_sin_f32 v95, v95
    v_mul_f32 v44, v90, v92
    v_mul_f32 v46, v90, v91
    v_mul_f32 v45, v94, v96
    v_mul_f32 v47, v94, v95
    v_pk_mul_f32 v[32:33], v[32:33], s[16:17] op_sel_hi:[1,0]
    v_pk_mul_f32 v[34:35], v[34:35], s[16:17] op_sel_hi:[1,0]
    v_fract_f32 v91, v68
    v_fract_f32 v95, v69
    v_fmac_f32 v91, 1.0, v70
    v_fmac_f32 v95, 1.0, v71
    v_exp_f32 v90, v20
    v_cos_f32 v92, v91
    v_sin_f32 v91, v91
    v_exp_f32 v94, v21
    v_cos_f32 v96, v95
    v_sin_f32 v95, v95
    v_mul_f32 v40, v90, v92
    v_mul_f32 v42, v90, v91
    v_mul_f32 v41, v94, v96
    v_mul_f32 v43, v94, v95
    v_pk_mul_f32 v[90:91], v[34:35], v[46:47]
    v_pk_mul_f32 v[94:95], v[34:35], v[42:43]
    v_pk_mul_f32 v[92:93], v[34:35], v[44:45]
    v_pk_mul_f32 v[96:97], v[34:35], v[40:41]
    v_pk_fma_f32 v[62:63], v[32:33], v[46:47], v[92:93]
    v_pk_fma_f32 v[54:55], v[32:33], v[42:43], v[96:97]
    v_pk_fma_f32 v[60:61], v[32:33], v[44:45], v[90:91] neg_lo:[0,0,1] neg_hi:[0,0,1]
    v_pk_fma_f32 v[52:53], v[32:33], v[40:41], v[94:95] neg_lo:[0,0,1] neg_hi:[0,0,1]
    v_cvt_pk_f16_f32 v98, v32, v34
    v_cvt_pk_f16_f32 v99, v33, v35
    v_cvt_pk_f16_f32 v100, v60, v62
    v_cvt_pk_f16_f32 v101, v61, v63
    ds_write2_b64 v72, v[98:99], v[100:101] offset0:0 offset1:68
    v_pk_mul_f32 v[90:91], v[54:55], v[46:47]
    v_pk_mul_f32 v[94:95], v[54:55], v[42:43]
    v_pk_mul_f32 v[92:93], v[54:55], v[44:45]
    v_pk_mul_f32 v[96:97], v[54:55], v[40:41]
    v_pk_fma_f32 v[62:63], v[52:53], v[46:47], v[92:93]
    v_pk_fma_f32 v[58:59], v[52:53], v[42:43], v[96:97]
    v_pk_fma_f32 v[60:61], v[52:53], v[44:45], v[90:91] neg_lo:[0,0,1] neg_hi:[0,0,1]
    v_pk_fma_f32 v[56:57], v[52:53], v[40:41], v[94:95] neg_lo:[0,0,1] neg_hi:[0,0,1]
    v_cvt_pk_f16_f32 v76, v52, v54
    v_cvt_pk_f16_f32 v77, v53, v55
    v_cvt_pk_f16_f32 v78, v60, v62
    v_cvt_pk_f16_f32 v79, v61, v63
    ds_write2_b64 v72, v[76:77], v[78:79] offset0:136 offset1:204
    v_pk_mul_f32 v[90:91], v[58:59], v[46:47]
    v_pk_mul_f32 v[94:95], v[58:59], v[42:43]
    v_pk_mul_f32 v[92:93], v[58:59], v[44:45]
    v_pk_mul_f32 v[96:97], v[58:59], v[40:41]
    v_pk_fma_f32 v[62:63], v[56:57], v[46:47], v[92:93]
    v_pk_fma_f32 v[54:55], v[56:57], v[42:43], v[96:97]
    v_pk_fma_f32 v[60:61], v[56:57], v[44:45], v[90:91] neg_lo:[0,0,1] neg_hi:[0,0,1]
    v_pk_fma_f32 v[52:53], v[56:57], v[40:41], v[94:95] neg_lo:[0,0,1] neg_hi:[0,0,1]
    v_cvt_pk_f16_f32 v98, v56, v58
    v_cvt_pk_f16_f32 v99, v57, v59
    v_cvt_pk_f16_f32 v100, v60, v62
    v_cvt_pk_f16_f32 v101, v61, v63
    ds_write2_b64 v73, v[98:99], v[100:101] offset0:0 offset1:68
    v_pk_mul_f32 v[90:91], v[54:55], v[46:47]
    v_pk_mul_f32 v[94:95], v[54:55], v[42:43]
    v_pk_mul_f32 v[92:93], v[54:55], v[44:45]
    v_pk_mul_f32 v[96:97], v[54:55], v[40:41]
    v_pk_fma_f32 v[62:63], v[52:53], v[46:47], v[92:93]
    v_pk_fma_f32 v[58:59], v[52:53], v[42:43], v[96:97]
    v_pk_fma_f32 v[60:61], v[52:53], v[44:45], v[90:91] neg_lo:[0,0,1] neg_hi:[0,0,1]
    v_pk_fma_f32 v[56:57], v[52:53], v[40:41], v[94:95] neg_lo:[0,0,1] neg_hi:[0,0,1]
    v_cvt_pk_f16_f32 v76, v52, v54
    v_cvt_pk_f16_f32 v77, v53, v55
    v_cvt_pk_f16_f32 v78, v60, v62
    v_cvt_pk_f16_f32 v79, v61, v63
    ds_write2_b64 v73, v[76:77], v[78:79] offset0:136 offset1:204
    v_pk_mul_f32 v[90:91], v[58:59], v[46:47]
    v_pk_mul_f32 v[94:95], v[58:59], v[42:43]
    v_pk_mul_f32 v[92:93], v[58:59], v[44:45]
    v_pk_mul_f32 v[96:97], v[58:59], v[40:41]
    v_pk_fma_f32 v[62:63], v[56:57], v[46:47], v[92:93]
    v_pk_fma_f32 v[54:55], v[56:57], v[42:43], v[96:97]
    v_pk_fma_f32 v[60:61], v[56:57], v[44:45], v[90:91] neg_lo:[0,0,1] neg_hi:[0,0,1]
    v_pk_fma_f32 v[52:53], v[56:57], v[40:41], v[94:95] neg_lo:[0,0,1] neg_hi:[0,0,1]
    v_cvt_pk_f16_f32 v98, v56, v58
    v_cvt_pk_f16_f32 v99, v57, v59
    v_cvt_pk_f16_f32 v100, v60, v62
    v_cvt_pk_f16_f32 v101, v61, v63
    ds_write2_b64 v74, v[98:99], v[100:101] offset0:0 offset1:68
    v_pk_mul_f32 v[90:91], v[54:55], v[46:47]
    v_pk_mul_f32 v[94:95], v[54:55], v[42:43]
    v_pk_mul_f32 v[92:93], v[54:55], v[44:45]
    v_pk_mul_f32 v[96:97], v[54:55], v[40:41]
    v_pk_fma_f32 v[62:63], v[52:53], v[46:47], v[92:93]
    v_pk_fma_f32 v[58:59], v[52:53], v[42:43], v[96:97]
    v_pk_fma_f32 v[60:61], v[52:53], v[44:45], v[90:91] neg_lo:[0,0,1] neg_hi:[0,0,1]
    v_pk_fma_f32 v[56:57], v[52:53], v[40:41], v[94:95] neg_lo:[0,0,1] neg_hi:[0,0,1]
    v_cvt_pk_f16_f32 v76, v52, v54
    v_cvt_pk_f16_f32 v77, v53, v55
    v_cvt_pk_f16_f32 v78, v60, v62
    v_cvt_pk_f16_f32 v79, v61, v63
    ds_write2_b64 v74, v[76:77], v[78:79] offset0:136 offset1:204
    v_pk_mul_f32 v[90:91], v[58:59], v[46:47]
    v_pk_mul_f32 v[94:95], v[58:59], v[42:43]
    v_pk_mul_f32 v[92:93], v[58:59], v[44:45]
    v_pk_mul_f32 v[96:97], v[58:59], v[40:41]
    v_pk_fma_f32 v[62:63], v[56:57], v[46:47], v[92:93]
    v_pk_fma_f32 v[54:55], v[56:57], v[42:43], v[96:97]
    v_pk_fma_f32 v[60:61], v[56:57], v[44:45], v[90:91] neg_lo:[0,0,1] neg_hi:[0,0,1]
    v_pk_fma_f32 v[52:53], v[56:57], v[40:41], v[94:95] neg_lo:[0,0,1] neg_hi:[0,0,1]
    v_cvt_pk_f16_f32 v98, v56, v58
    v_cvt_pk_f16_f32 v99, v57, v59
    v_cvt_pk_f16_f32 v100, v60, v62
    v_cvt_pk_f16_f32 v101, v61, v63
    ds_write2_b64 v75, v[98:99], v[100:101] offset0:0 offset1:68
    v_pk_mul_f32 v[90:91], v[54:55], v[46:47]
    v_pk_mul_f32 v[92:93], v[54:55], v[44:45]
    v_pk_fma_f32 v[62:63], v[52:53], v[46:47], v[92:93]
    v_pk_fma_f32 v[60:61], v[52:53], v[44:45], v[90:91] neg_lo:[0,0,1] neg_hi:[0,0,1]
    v_cvt_pk_f16_f32 v76, v52, v54
    v_cvt_pk_f16_f32 v77, v53, v55
    v_cvt_pk_f16_f32 v78, v60, v62
    v_cvt_pk_f16_f32 v79, v61, v63
    ds_write2_b64 v75, v[76:77], v[78:79] offset0:136 offset1:204
    s_branch JOBJ_19
JOB_16:
    v_mul_f32 v91, 0x43000000, v68
    v_mul_f32 v90, 0x43000000, v20
    v_mul_f32 v95, 0x43000000, v69
    v_mul_f32 v94, 0x43000000, v21
    v_fract_f32 v91, v91
    v_fract_f32 v95, v95
    v_fmac_f32 v91, 0x43000000, v70
    v_fmac_f32 v95, 0x43000000, v71
    v_exp_f32 v90, v90
    v_cos_f32 v92, v91
    v_sin_f32 v91, v91
    v_exp_f32 v94, v94
    v_cos_f32 v96, v95
    v_sin_f32 v95, v95
    v_mul_f32 v44, v90, v92
    v_mul_f32 v46, v90, v91
    v_mul_f32 v45, v94, v96
    v_mul_f32 v47, v94, v95
    v_pk_mul_f32 v[32:33], v[32:33], s[16:17] op_sel_hi:[1,0]
    v_pk_mul_f32 v[34:35], v[34:35], s[16:17] op_sel_hi:[1,0]
    v_pk_mul_f32 v[90:91], v[46:47], v[46:47]
    v_pk_mul_f32 v[92:93], v[44:45], v[46:47]
    v_pk_fma_f32 v[48:49], v[44:45], v[44:45], v[90:91] neg_lo:[0,0,1] neg_hi:[0,0,1]
    v_pk_add_f32 v[50:51], v[92:93], v[92:93]
    v_mul_f32 v91, 2.0, v68
    v_mul_f32 v90, 2.0, v20
    v_mul_f32 v95, 2.0, v69
    v_mul_f32 v94, 2.0, v21
    v_fract_f32 v91, v91
    v_fract_f32 v95, v95
    v_fmac_f32 v91, 2.0, v70
    v_fmac_f32 v95, 2.0, v71
    v_exp_f32 v90, v90
    v_cos_f32 v92, v91
    v_sin_f32 v91, v91
    v_exp_f32 v94, v94
    v_cos_f32 v96, v95
    v_sin_f32 v95, v95
    v_mul_f32 v40, v90, v92
    v_mul_f32 v42, v90, v91
    v_mul_f32 v41, v94, v96
    v_mul_f32 v43, v94, v95
    v_pk_mul_f32 v[90:91], v[34:35], v[50:51]
    v_pk_mul_f32 v[92:93], v[34:35], v[48:49]
    v_pk_fma_f32 v[54:55], v[32:33], v[50:51], v[92:93]
    v_pk_fma_f32 v[52:53], v[32:33], v[48:49], v[90:91] neg_lo:[0,0,1] neg_hi:[0,0,1]
    v_pk_mul_f32 v[90:91], v[54:55], v[50:51]
    v_pk_mul_f32 v[92:93], v[54:55], v[48:49]
    v_pk_fma_f32 v[66:67], v[52:53], v[50:51], v[92:93]
    v_pk_fma_f32 v[64:65], v[52:53], v[48:49], v[90:91] neg_lo:[0,0,1] neg_hi:[0,0,1]
    v_pk_mul_f32 v[90:91], v[54:55], v[46:47]
    v_pk_mul_f32 v[94:95], v[54:55], v[42:43]
    v_pk_mul_f32 v[92:93], v[54:55], v[44:45]
    v_pk_mul_f32 v[96:97], v[54:55], v[40:41]
    v_pk_fma_f32 v[62:63], v[52:53], v[46:47], v[92:93]
    v_pk_fma_f32 v[58:59], v[52:53], v[42:43], v[96:97]
    v_pk_fma_f32 v[60:61], v[52:53], v[44:45], v[90:91] neg_lo:[0,0,1] neg_hi:[0,0,1]
    v_pk_fma_f32 v[56:57], v[52:53], v[40:41], v[94:95] neg_lo:[0,0,1] neg_hi:[0,0,1]
    v_cvt_pk_f16_f32 v98, v52, v54
    v_cvt_pk_f16_f32 v99, v53, v55
    v_cvt_pk_f16_f32 v100, v60, v62
    v_cvt_pk_f16_f32 v101, v61, v63
    ds_write2_b64 v72, v[98:99], v[100:101] offset0:0 offset1:68
    v_pk_mul_f32 v[90:91], v[58:59], v[46:47]
    v_pk_mul_f32 v[94:95], v[58:59], v[42:43]
    v_pk_mul_f32 v[92:93], v[58:59], v[44:45]
    v_pk_mul_f32 v[96:97], v[58:59], v[40:41]
    v_pk_fma_f32 v[62:63], v[56:57], v[46:47], v[92:93]
    v_pk_fma_f32 v[54:55], v[56:57], v[42:43], v[96:97]
    v_pk_fma_f32 v[60:61], v[56:57], v[44:45], v[90:91] neg_lo:[0,0,1] neg_hi:[0,0,1]
    v_pk_fma_f32 v[52:53], v[56:57], v[40:41], v[94:95] neg_lo:[0,0,1] neg_hi:[0,0,1]
    v_cvt_pk_f16_f32 v76, v56, v58
    v_cvt_pk_f16_f32 v77, v57, v59
    v_cvt_pk_f16_f32 v78, v60, v62
    v_cvt_pk_f16_f32 v79, v61, v63
    ds_write2_b64 v72, v[76:77], v[78:79] offset0:136 offset1:204
    v_pk_mul_f32 v[90:91], v[54:55], v[46:47]
    v_pk_mul_f32 v[94:95], v[54:55], v[42:43]
    v_pk_mul_f32 v[92:93], v[54:55], v[44:45]
    v_pk_mul_f32 v[96:97], v[54:55], v[40:41]
    v_pk_fma_f32 v[62:63], v[52:53], v[46:47], v[92:93]
    v_pk_fma_f32 v[58:59], v[52:53], v[42:43], v[96:97]
    v_pk_fma_f32 v[60:61], v[52:53], v[44:45], v[90:91] neg_lo:[0,0,1] neg_hi:[0,0,1]
    v_pk_fma_f32 v[56:57], v[52:53], v[40:41], v[94:95] neg_lo:[0,0,1] neg_hi:[0,0,1]
    v_cvt_pk_f16_f32 v98, v52, v54
    v_cvt_pk_f16_f32 v99, v53, v55
    v_cvt_pk_f16_f32 v100, v60, v62
    v_cvt_pk_f16_f32 v101, v61, v63
    ds_write2_b64 v73, v[98:99], v[100:101] offset0:0 offset1:68
    v_pk_mul_f32 v[90:91], v[58:59], v[46:47]
    v_pk_mul_f32 v[94:95], v[42:43], v[42:43]
    v_pk_mul_f32 v[92:93], v[58:59], v[44:45]
    v_pk_mul_f32 v[96:97], v[40:41], v[42:43]
    v_pk_fma_f32 v[62:63], v[56:57], v[46:47], v[92:93]
    v_pk_fma_f32 v[48:49], v[40:41], v[40:41], v[94:95] neg_lo:[0,0,1] neg_hi:[0,0,1]
    v_pk_fma_f32 v[60:61], v[56:57], v[44:45], v[90:91] neg_lo:[0,0,1] neg_hi:[0,0,1]
    v_pk_add_f32 v[50:51], v[96:97], v[96:97]
    v_cvt_pk_f16_f32 v76, v56, v58
    v_cvt_pk_f16_f32 v77, v57, v59
    v_cvt_pk_f16_f32 v78, v60, v62
    v_cvt_pk_f16_f32 v79, v61, v63
    ds_write2_b64 v73, v[76:77], v[78:79] offset0:136 offset1:204
    v_pk_mul_f32 v[90:91], v[66:67], v[50:51]
    v_pk_mul_f32 v[94:95], v[66:67], v[46:47]
    v_pk_mul_f32 v[92:93], v[66:67], v[48:49]
    v_pk_mul_f32 v[96:97], v[66:67], v[44:45]
    v_pk_fma_f32 v[62:63], v[64:65], v[50:51], v[92:93]
    v_pk_fma_f32 v[54:55], v[64:65], v[46:47], v[96:97]
    v_pk_fma_f32 v[60:61], v[64:65], v[48:49], v[90:91] neg_lo:[0,0,1] neg_hi:[0,0,1]
    v_pk_fma_f32 v[52:53], v[64:65], v[44:45], v[94:95] neg_lo:[0,0,1] neg_hi:[0,0,1]
    v_cvt_pk_f16_f32 v98, v64, v66
    v_cvt_pk_f16_f32 v99, v65, v67
    v_cvt_pk_f16_f32 v100, v60, v62
    v_cvt_pk_f16_f32 v101, v61, v63
    ds_write2_b64 v74, v[98:99], v[100:101] offset0:0 offset1:68
    v_pk_mul_f32 v[90:91], v[54:55], v[50:51]
    v_pk_mul_f32 v[94:95], v[54:55], v[46:47]
    v_pk_mul_f32 v[92:93], v[54:55], v[48:49]
    v_pk_mul_f32 v[96:97], v[54:55], v[44:45]
    v_pk_fma_f32 v[62:63], v[52:53], v[50:51], v[92:93]
    v_pk_fma_f32 v[58:59], v[52:53], v[46:47], v[96:97]
    v_pk_fma_f32 v[60:61], v[52:53], v[48:49], v[90:91] neg_lo:[0,0,1] neg_hi:[0,0,1]
    v_pk_fma_f32 v[56:57], v[52:53], v[44:45], v[94:95] neg_lo:[0,0,1] neg_hi:[0,0,1]
    v_cvt_pk_f16_f32 v76, v52, v54
    v_cvt_pk_f16_f32 v77, v53, v55
    v_cvt_pk_f16_f32 v78, v60, v62
    v_cvt_pk_f16_f32 v79, v61, v63
    ds_write2_b64 v74, v[76:77], v[78:79] offset0:136 offset1:204
    v_pk_mul_f32 v[90:91], v[58:59], v[50:51]
    v_pk_mul_f32 v[94:95], v[58:59], v[46:47]
    v_pk_mul_f32 v[92:93], v[58:59], v[48:49]
    v_pk_mul_f32 v[96:97], v[58:59], v[44:45]
    v_pk_fma_f32 v[62:63], v[56:57], v[50:51], v[92:93]
    v_pk_fma_f32 v[54:55], v[56:57], v[46:47], v[96:97]
    v_pk_fma_f32 v[60:61], v[56:57], v[48:49], v[90:91] neg_lo:[0,0,1] neg_hi:[0,0,1]
    v_pk_fma_f32 v[52:53], v[56:57], v[44:45], v[94:95] neg_lo:[0,0,1] neg_hi:[0,0,1]
    v_cvt_pk_f16_f32 v98, v56, v58
    v_cvt_pk_f16_f32 v99, v57, v59
    v_cvt_pk_f16_f32 v100, v60, v62
    v_cvt_pk_f16_f32 v101, v61, v63
    ds_write2_b64 v75, v[98:99], v[100:101] offset0:0 offset1:68
    v_pk_mul_f32 v[90:91], v[54:55], v[50:51]
    v_pk_mul_f32 v[92:93], v[54:55], v[48:49]
    v_pk_fma_f32 v[62:63], v[52:53], v[50:51], v[92:93]
    v_pk_fma_f32 v[60:61], v[52:53], v[48:49], v[90:91] neg_lo:[0,0,1] neg_hi:[0,0,1]
    v_cvt_pk_f16_f32 v76, v52, v54
    v_cvt_pk_f16_f32 v77, v53, v55
    v_cvt_pk_f16_f32 v78, v60, v62
    v_cvt_pk_f16_f32 v79, v61, v63
    ds_write2_b64 v75, v[76:77], v[78:79] offset0:136 offset1:204
    s_branch JOBJ_19
JOB_18:
    v_mul_f32 v91, 0x41000000, v68
    v_mul_f32 v90, 0x41000000, v20
    v_mul_f32 v95, 0x41000000, v69
    v_mul_f32 v94, 0x41000000, v21
    v_fract_f32 v91, v91
    v_fract_f32 v95, v95
    v_fmac_f32 v91, 0x41000000, v70
    v_fmac_f32 v95, 0x41000000, v71
    v_exp_f32 v90, v90
    v_cos_f32 v92, v91
    v_sin_f32 v91, v91
    v_exp_f32 v94, v94
    v_cos_f32 v96, v95
    v_sin_f32 v95, v95
    v_mul_f32 v40, v90, v92
    v_mul_f32 v42, v90, -v91
    v_mul_f32 v41, v94, v96
    v_mul_f32 v43, v94, -v95
    v_mov_b32 v52, 0x47000000
    v_mov_b32 v53, 0x47000000
    v_mov_b32 v54, 0
    v_mov_b32 v55, 0
    v_pk_mul_f32 v[90:91], v[42:43], v[42:43]
    v_pk_mul_f32 v[60:61], v[40:41], v[52:53]
    v_pk_mul_f32 v[92:93], v[40:41], v[42:43]
    v_pk_mul_f32 v[62:63], v[42:43], v[52:53]
    v_pk_fma_f32 v[44:45], v[40:41], v[40:41], v[90:91] neg_lo:[0,0,1] neg_hi:[0,0,1]
    v_pk_add_f32 v[46:47], v[92:93], v[92:93]
    v_pk_mul_f32 v[56:57], v[44:45], v[52:53]
    v_pk_mul_f32 v[94:95], v[62:63], v[46:47]
    v_pk_mul_f32 v[58:59], v[46:47], v[52:53]
    v_pk_mul_f32 v[96:97], v[62:63], v[44:45]
    v_pk_fma_f32 v[66:67], v[60:61], v[46:47], v[96:97]
    v_pk_fma_f32 v[64:65], v[60:61], v[44:45], v[94:95] neg_lo:[0,0,1] neg_hi:[0,0,1]
    v_cvt_pk_f16_f32 v98, v52, v54
    v_cvt_pk_f16_f32 v99, v53, v55
    v_cvt_pk_f16_f32 v100, v60, v62
    v_cvt_pk_f16_f32 v101, v61, v63
    ds_write2_b64 v72, v[98:99], v[100:101] offset0:0 offset1:68
    v_pk_mul_f32 v[90:91], v[58:59], v[46:47]
    v_pk_mul_f32 v[94:95], v[66:67], v[46:47]
    v_pk_mul_f32 v[92:93], v[58:59], v[44:45]
    v_pk_mul_f32 v[96:97], v[66:67], v[44:45]
    v_pk_fma_f32 v[54:55], v[56:57], v[46:47], v[92:93]
    v_pk_fma_f32 v[62:63], v[64:65], v[46:47], v[96:97]
    v_pk_fma_f32 v[52:53], v[56:57], v[44:45], v[90:91] neg_lo:[0,0,1] neg_hi:[0,0,1]
    v_pk_fma_f32 v[60:61], v[64:65], v[44:45], v[94:95] neg_lo:[0,0,1] neg_hi:[0,0,1]
    v_cvt_pk_f16_f32 v76, v56, v58
    v_cvt_pk_f16_f32 v77, v57, v59
    v_cvt_pk_f16_f32 v78, v64, v66
    v_cvt_pk_f16_f32 v79, v65, v67
    ds_write2_b64 v72, v[76:77], v[78:79] offset0:136 offset1:204
    v_pk_mul_f32 v[90:91], v[54:55], v[46:47]
    v_pk_mul_f32 v[94:95], v[62:63], v[46:47]
    v_pk_mul_f32 v[92:93], v[54:55], v[44:45]
    v_pk_mul_f32 v[96:97], v[62:63], v[44:45]
    v_pk_fma_f32 v[58:59], v[52:53], v[46:47], v[92:93]
    v_pk_fma_f32 v[66:67], v[60:61], v[46:47], v[96:97]
    v_pk_fma_f32 v[56:57], v[52:53], v[44:45], v[90:91] neg_lo:[0,0,1] neg_hi:[0,0,1]
    v_pk_fma_f32 v[64:65], v[60:61], v[44:45], v[94:95] neg_lo:[0,0,1] neg_hi:[0,0,1]
    v_cvt_pk_f16_f32 v98, v52, v54
    v_cvt_pk_f16_f32 v99, v53, v55
    v_cvt_pk_f16_f32 v100, v60, v62
    v_cvt_pk_f16_f32 v101, v61, v63
    ds_write2_b64 v73, v[98:99], v[100:101] offset0:0 offset1:68
    v_pk_mul_f32 v[90:91], v[58:59], v[46:47]
    v_pk_mul_f32 v[94:95], v[66:67], v[46:47]
    v_pk_mul_f32 v[92:93], v[58:59], v[44:45]
    v_pk_mul_f32 v[96:97], v[66:67], v[44:45]
    v_pk_fma_f32 v[54:55], v[56:57], v[46:47], v[92:93]
    v_pk_fma_f32 v[62:63], v[64:65], v[46:47], v[96:97]
    v_pk_fma_f32 v[52:53], v[56:57], v[44:45], v[90:91] neg_lo:[0,0,1] neg_hi:[0,0,1]
    v_pk_fma_f32 v[60:61], v[64:65], v[44:45], v[94:95] neg_lo:[0,0,1] neg_hi:[0,0,1]
    v_cvt_pk_f16_f32 v76, v56, v58
    v_cvt_pk_f16_f32 v77, v57, v59
    v_cvt_pk_f16_f32 v78, v64, v66
    v_cvt_pk_f16_f32 v79, v65, v67
    ds_write2_b64 v73, v[76:77], v[78:79] offset0:136 offset1:204
    v_pk_mul_f32 v[90:91], v[54:55], v[46:47]
    v_pk_mul_f32 v[94:95], v[62:63], v[46:47]
    v_pk_mul_f32 v[92:93], v[54:55], v[44:45]
    v_pk_mul_f32 v[96:97], v[62:63], v[44:45]
    v_pk_fma_f32 v[58:59], v[52:53], v[46:47], v[92:93]
    v_pk_fma_f32 v[66:67], v[60:61], v[46:47], v[96:97]
    v_pk_fma_f32 v[56:57], v[52:53], v[44:45], v[90:91] neg_lo:[0,0,1] neg_hi:[0,0,1]
    v_pk_fma_f32 v[64:65], v[60:61], v[44:45], v[94:95] neg_lo:[0,0,1] neg_hi:[0,0,1]
    v_cvt_pk_f16_f32 v98, v52, v54
    v_cvt_pk_f16_f32 v99, v53, v55
    v_cvt_pk_f16_f32 v100, v60, v62
    v_cvt_pk_f16_f32 v101, v61, v63
    ds_write2_b64 v74, v[98:99], v[100:101] offset0:0 offset1:68
    v_pk_mul_f32 v[90:91], v[58:59], v[46:47]
    v_pk_mul_f32 v[94:95], v[66:67], v[46:47]
    v_pk_mul_f32 v[92:93], v[58:59], v[44:45]
    v_pk_mul_f32 v[96:97], v[66:67], v[44:45]
    v_pk_fma_f32 v[54:55], v[56:57], v[46:47], v[92:93]
    v_pk_fma_f32 v[62:63], v[64:65], v[46:47], v[96:97]
    v_pk_fma_f32 v[52:53], v[56:57], v[44:45], v[90:91] neg_lo:[0,0,1] neg_hi:[0,0,1]
    v_pk_fma_f32 v[60:61], v[64:65], v[44:45], v[94:95] neg_lo:[0,0,1] neg_hi:[0,0,1]
    v_cvt_pk_f16_f32 v76, v56, v58
    v_cvt_pk_f16_f32 v77, v57, v59
    v_cvt_pk_f16_f32 v78, v64, v66
    v_cvt_pk_f16_f32 v79, v65, v67
    ds_write2_b64 v74, v[76:77], v[78:79] offset0:136 offset1:204
    v_pk_mul_f32 v[90:91], v[54:55], v[46:47]
    v_pk_mul_f32 v[94:95], v[62:63], v[46:47]
    v_pk_mul_f32 v[92:93], v[54:55], v[44:45]
    v_pk_mul_f32 v[96:97], v[62:63], v[44:45]
    v_pk_fma_f32 v[58:59], v[52:53], v[46:47], v[92:93]
    v_pk_fma_f32 v[66:67], v[60:61], v[46:47], v[96:97]
    v_pk_fma_f32 v[56:57], v[52:53], v[44:45], v[90:91] neg_lo:[0,0,1] neg_hi:[0,0,1]
    v_pk_fma_f32 v[64:65], v[60:61], v[44:45], v[94:95] neg_lo:[0,0,1] neg_hi:[0,0,1]
    v_cvt_pk_f16_f32 v98, v52, v54
    v_cvt_pk_f16_f32 v99, v53, v55
    v_cvt_pk_f16_f32 v100, v60, v62
    v_cvt_pk_f16_f32 v101, v61, v63
    ds_write2_b64 v75, v[98:99], v[100:101] offset0:0 offset1:68
    v_cvt_pk_f16_f32 v76, v56, v58
    v_cvt_pk_f16_f32 v77, v57, v59
    v_cvt_pk_f16_f32 v78, v64, v66
    v_cvt_pk_f16_f32 v79, v65, v67
    ds_write2_b64 v75, v[76:77], v[78:79] offset0:136 offset1:204
    ds_write_b8 v15, v5 offset:64
    s_cmp_eq_u32 s87, 2
    s_cbranch_scc1 KS_G0
KS_R3:
    ds_write_b8 v15, v5 offset:68
W_20:
    s_sleep 2
    ds_read_u16 v20, v14 offset:68
    s_sub_u32 s39, s39, 1
    s_cbranch_scc1 KS_ABORT
    s_waitcnt lgkmcnt(0)
    v_cmp_eq_u32 vcc, 0, v20
    s_cbranch_vccnz W_20
    s_branch EXP_13
KC_SEND:
W_21:
    ds_read_b32 v104, v105 offset:224
    s_sub_u32 s39, s39, 1
    s_cbranch_scc1 KS_ABORT
    s_waitcnt lgkmcnt(0)
    v_cmp_eq_u32 vcc, 0, v104
    s_cbranch_vccnz W_21
    s_lshl_b32 s92, s88, 12
    s_lshl_b32 s93, s86, 10
    s_add_u32 s92, s92, s93
    s_add_u32 s92, s92, 0x920000
    v_add_u32 v24, s92, v12
    s_mov_b32 s93, 0xffff
    v_lshlrev_b32 v25, 16, v104
    v_cvt_f16_f32 v20, v20
    v_cvt_f16_f32 v21, v21
    v_cvt_f16_f32 v22, v22
    v_cvt_f16_f32 v23, v23
    s_cmp_lg_u32 s86, 2
    s_cbranch_scc1 KC_S2
    s_mov_b32 exec_lo, 0
    s_mov_b32 exec_hi, 0xffff0000
    v_mov_b32 v20, v106
    v_lshrrev_b32 v21, 16, v106
    s_mov_b64 exec, -1
KC_S2:
    v_bfi_b32 v20, s93, v20, v104
    v_bfi_b32 v21, s93, v21, v25
    v_bfi_b32 v22, s93, v22, v104
    v_bfi_b32 v23, s93, v23, v25
    global_store_dwordx4 v24, v[20:23], s[36:37] sc1
    s_branch KS_G0
KC_RECV:
    s_cmp_eq_u32 s86, 3
    s_cbranch_scc1 KS_R3
    s_lshl_b32 s92, s88, 12
    s_lshl_b32 s93, s86, 10
    s_add_u32 s92, s92, s93
    s_add_u32 s92, s92, 0x920000
    v_add_u32 v24, s92, v12
W_22:
    s_sleep 2
    ds_read_b32 v104, v105 offset:224
    s_sub_u32 s39, s39, 1
    s_cbranch_scc1 KS_ABORT
    s_waitcnt lgkmcnt(0)
    v_cmp_eq_u32 vcc, 0, v104
    s_cbranch_vccnz W_22
    v_lshlrev_b32 v25, 16, v104
W_23:
    s_sleep 2
    ds_read_b32 v17, v4 offset:72
    s_sub_u32 s39, s39, 1
    s_cbranch_scc1 KS_ABORT
    s_waitcnt lgkmcnt(0)
    v_cmp_ne_u32 vcc, s84, v17
    s_cbranch_vccnz W_23
    s_sleep 8
    s_branch KPE_25
KP_24:
    s_sleep 2
KPE_25:
    global_load_dwordx4 v[20:23], v24, s[36:37] sc1
    s_sub_u32 s39, s39, 1
    s_cbranch_scc1 KS_ABORT
    s_waitcnt vmcnt(0)
    v_xor_b32 v20, v104, v20
    v_xor_b32 v21, v25, v21
    v_xor_b32 v22, v104, v22
    v_xor_b32 v23, v25, v23
    v_or3_b32 v26, v20, v21, v22
    v_or_b32 v26, v26, v23
    v_cmp_lt_u32 vcc, 0xffff, v26
    s_cbranch_vccnz KP_24
    v_xor_b32 v20, v104, v20
    v_xor_b32 v22, v104, v22
    ds_write_b16 v108, v20
    ds_write_b16 v109, v21
    ds_write_b16 v112, v22
    ds_write_b16 v113, v23
    s_cmp_lg_u32 s86, 2
    s_cbranch_scc1 EXP_13
    v_and_b32 v20, 0xffff, v20
    v_lshl_or_b32 v20, v21, 16, v20
    v_lshlrev_b32 v21, 16, v107
    s_mov_b32 exec_lo, 0
    s_mov_b32 exec_hi, 0x10000
    ds_write_b64 v14, v[20:21] offset:832
    s_mov_b64 exec, -1
    s_branch EXP_13
JOB_17:
    v_mul_f32 v91, 0x43000000, v68
    v_mul_f32 v90, 0x43000000, v20
    v_mul_f32 v95, 0x43000000, v69
    v_mul_f32 v94, 0x43000000, v21
    v_fract_f32 v91, v91
    v_fract_f32 v95, v95
    v_fmac_f32 v91, 0x43000000, v70
    v_fmac_f32 v95, 0x43000000, v71
    v_exp_f32 v90, v90
    v_cos_f32 v92, v91
    v_sin_f32 v91, v91
    v_exp_f32 v94, v94
    v_cos_f32 v96, v95
    v_sin_f32 v95, v95
    v_mul_f32 v44, v90, v92
    v_mul_f32 v46, v90, v91
    v_mul_f32 v45, v94, v96
    v_mul_f32 v47, v94, v95
    v_pk_mul_f32 v[32:33], v[32:33], s[16:17] op_sel_hi:[1,0]
    v_pk_mul_f32 v[34:35], v[34:35], s[16:17] op_sel_hi:[1,0]
    v_pk_mul_f32 v[90:91], v[46:47], v[46:47]
    v_pk_mul_f32 v[94:95], v[34:35], v[46:47]
    v_pk_mul_f32 v[92:93], v[44:45], v[46:47]
    v_pk_mul_f32 v[96:97], v[34:35], v[44:45]
    v_pk_fma_f32 v[40:41], v[44:45], v[44:45], v[90:91] neg_lo:[0,0,1] neg_hi:[0,0,1]
    v_pk_fma_f32 v[66:67], v[32:33], v[46:47], v[96:97]
    v_pk_add_f32 v[42:43], v[92:93], v[92:93]
    v_pk_fma_f32 v[64:65], v[32:33], v[44:45], v[94:95] neg_lo:[0,0,1] neg_hi:[0,0,1]
    v_pk_mul_f32 v[90:91], v[42:43], v[42:43]
    v_pk_mul_f32 v[92:93], v[40:41], v[42:43]
    v_pk_fma_f32 v[48:49], v[40:41], v[40:41], v[90:91] neg_lo:[0,0,1] neg_hi:[0,0,1]
    v_pk_add_f32 v[50:51], v[92:93], v[92:93]
    v_pk_mul_f32 v[90:91], v[50:51], v[50:51]
    v_pk_mul_f32 v[92:93], v[48:49], v[50:51]
    v_pk_fma_f32 v[48:49], v[48:49], v[48:49], v[90:91] neg_lo:[0,0,1] neg_hi:[0,0,1]
    v_pk_add_f32 v[50:51], v[92:93], v[92:93]
    v_pk_mul_f32 v[90:91], v[34:35], v[50:51]
    v_pk_mul_f32 v[94:95], v[66:67], v[50:51]
    v_pk_mul_f32 v[92:93], v[34:35], v[48:49]
    v_pk_mul_f32 v[96:97], v[66:67], v[48:49]
    v_pk_fma_f32 v[54:55], v[32:33], v[50:51], v[92:93]
    v_pk_fma_f32 v[62:63], v[64:65], v[50:51], v[96:97]
    v_pk_fma_f32 v[52:53], v[32:33], v[48:49], v[90:91] neg_lo:[0,0,1] neg_hi:[0,0,1]
    v_pk_fma_f32 v[60:61], v[64:65], v[48:49], v[94:95] neg_lo:[0,0,1] neg_hi:[0,0,1]
    v_pk_mul_f32 v[90:91], v[54:55], v[42:43]
    v_pk_mul_f32 v[94:95], v[62:63], v[42:43]
    v_pk_mul_f32 v[92:93], v[54:55], v[40:41]
    v_pk_mul_f32 v[96:97], v[62:63], v[40:41]
    v_pk_fma_f32 v[58:59], v[52:53], v[42:43], v[92:93]
    v_pk_fma_f32 v[66:67], v[60:61], v[42:43], v[96:97]
    v_pk_fma_f32 v[56:57], v[52:53], v[40:41], v[90:91] neg_lo:[0,0,1] neg_hi:[0,0,1]
    v_pk_fma_f32 v[64:65], v[60:61], v[40:41], v[94:95] neg_lo:[0,0,1] neg_hi:[0,0,1]
    v_cvt_pk_f16_f32 v98, v52, v54
    v_cvt_pk_f16_f32 v99, v53, v55
    v_cvt_pk_f16_f32 v100, v60, v62
    v_cvt_pk_f16_f32 v101, v61, v63
    ds_write2_b64 v72, v[98:99], v[100:101] offset0:0 offset1:68
    v_pk_mul_f32 v[90:91], v[58:59], v[42:43]
    v_pk_mul_f32 v[94:95], v[66:67], v[42:43]
    v_pk_mul_f32 v[92:93], v[58:59], v[40:41]
    v_pk_mul_f32 v[96:97], v[66:67], v[40:41]
    v_pk_fma_f32 v[54:55], v[56:57], v[42:43], v[92:93]
    v_pk_fma_f32 v[62:63], v[64:65], v[42:43], v[96:97]
    v_pk_fma_f32 v[52:53], v[56:57], v[40:41], v[90:91] neg_lo:[0,0,1] neg_hi:[0,0,1]
    v_pk_fma_f32 v[60:61], v[64:65], v[40:41], v[94:95] neg_lo:[0,0,1] neg_hi:[0,0,1]
    v_cvt_pk_f16_f32 v76, v56, v58
    v_cvt_pk_f16_f32 v77, v57, v59
    v_cvt_pk_f16_f32 v78, v64, v66
    v_cvt_pk_f16_f32 v79, v65, v67
    ds_write2_b64 v72, v[76:77], v[78:79] offset0:136 offset1:204
    v_pk_mul_f32 v[90:91], v[54:55], v[42:43]
    v_pk_mul_f32 v[94:95], v[62:63], v[42:43]
    v_pk_mul_f32 v[92:93], v[54:55], v[40:41]
    v_pk_mul_f32 v[96:97], v[62:63], v[40:41]
    v_pk_fma_f32 v[58:59], v[52:53], v[42:43], v[92:93]
    v_pk_fma_f32 v[66:67], v[60:61], v[42:43], v[96:97]
    v_pk_fma_f32 v[56:57], v[52:53], v[40:41], v[90:91] neg_lo:[0,0,1] neg_hi:[0,0,1]
    v_pk_fma_f32 v[64:65], v[60:61], v[40:41], v[94:95] neg_lo:[0,0,1] neg_hi:[0,0,1]
    v_cvt_pk_f16_f32 v98, v52, v54
    v_cvt_pk_f16_f32 v99, v53, v55
    v_cvt_pk_f16_f32 v100, v60, v62
    v_cvt_pk_f16_f32 v101, v61, v63
    ds_write2_b64 v73, v[98:99], v[100:101] offset0:0 offset1:68
    v_pk_mul_f32 v[90:91], v[58:59], v[42:43]
    v_pk_mul_f32 v[92:93], v[58:59], v[40:41]
    v_pk_fma_f32 v[54:55], v[56:57], v[42:43], v[92:93]
    v_pk_fma_f32 v[52:53], v[56:57], v[40:41], v[90:91] neg_lo:[0,0,1] neg_hi:[0,0,1]
    v_cvt_pk_f16_f32 v76, v56, v58
    v_cvt_pk_f16_f32 v77, v57, v59
    v_cvt_pk_f16_f32 v78, v64, v66
    v_cvt_pk_f16_f32 v79, v65, v67
    ds_write2_b64 v73, v[76:77], v[78:79] offset0:136 offset1:204
    v_cvt_pk_f16_f32 v98, v52, v54
    v_cvt_pk_f16_f32 v99, v53, v55
    v_mov_b32 v36, 0x4538aa3b
    v_mul_f32 v24, s14, v36
    v_max_f32 v24, 0, v24
    v_ceil_f32 v24, v24
    v_cvt_i32_f32 v24, v24
    ds_write_b64 v74, v[98:99] offset:0
    s_sub_u32 s11, s15, 7
    s_lshl_b32 s11, s11, 23
    v_lshlrev_b32 v25, 16, v107
    v_ldexp_f32 v24, s11, v24
    v_mov_b32 v106, v24
    ds_write_b64 v14, v[24:25] offset:832
JOBJ_19:
    ds_write_b8 v15, v5 offset:64
    ds_read_b128 v[40:43], v127 offset:0
    ds_read_b128 v[44:47], v127 offset:64
    ds_read_b128 v[48:51], v127 offset:128
    ds_read_b128 v[52:55], v127 offset:192
    ds_read_b128 v[56:59], v127 offset:256
    ds_read_b128 v[60:63], v127 offset:320
    ds_read_b128 v[64:67], v127 offset:384
    ds_read_b128 v[68:71], v127 offset:448
    v_mov_b32 v36, 0x3fb8aa3b
    v_mul_f32 v36, s14, v36
    v_mul_f32 v37, 0x45000000, v36
    v_max_f32 v37, 0, v37
    v_ceil_f32 v37, v37
    v_add_f32 v37, 0x41b80000, v37
    v_fma_f32 v110, v110, v36, -v37
    v_fma_f32 v111, v111, v36, -v37
    v_fma_f32 v114, v114, v36, -v37
    v_fma_f32 v115, v115, v36, -v37
    v_exp_f32 v110, v110
    v_exp_f32 v111, v111
    v_exp_f32 v114, v114
    v_exp_f32 v115, v115
W_27:
    ds_read_u8 v17, v14 offset:67
    s_sub_u32 s39, s39, 1
    s_cbranch_scc1 KS_ABORT
    s_waitcnt lgkmcnt(0)
    v_cmp_eq_u32 vcc, 0, v17
    s_cbranch_vccnz W_27
    ds_read_b128 v[72:75], v126 offset:22304
    ds_read_b128 v[76:79], v126 offset:22368
    ds_read_b128 v[80:83], v126 offset:22432
    ds_read_b128 v[84:87], v126 offset:22496
    ds_read_b128 v[88:91], v126 offset:22560
    ds_read_b128 v[92:95], v126 offset:22624
    ds_read_b128 v[96:99], v126 offset:22688
    ds_read_b128 v[100:103], v126 offset:22752
    s_waitcnt lgkmcnt(7)
    v_mfma_f32_16x16x32_f16 v[20:23], v[40:43], v[72:75], 0
    s_waitcnt lgkmcnt(6)
    v_mfma_f32_16x16x32_f16 v[24:27], v[44:47], v[76:79], 0
    s_waitcnt lgkmcnt(5)
    v_mfma_f32_16x16x32_f16 v[20:23], v[48:51], v[80:83], v[20:23]
    s_waitcnt lgkmcnt(4)
    v_mfma_f32_16x16x32_f16 v[24:27], v[52:55], v[84:87], v[24:27]
    s_waitcnt lgkmcnt(3)
    v_mfma_f32_16x16x32_f16 v[20:23], v[56:59], v[88:91], v[20:23]
    s_waitcnt lgkmcnt(2)
    v_mfma_f32_16x16x32_f16 v[24:27], v[60:63], v[92:95], v[24:27]
    s_waitcnt lgkmcnt(1)
    v_mfma_f32_16x16x32_f16 v[20:23], v[64:67], v[96:99], v[20:23]
    s_waitcnt lgkmcnt(0)
    v_mfma_f32_16x16x32_f16 v[24:27], v[68:71], v[100:103], v[24:27]
    s_nop 7
    v_add_f32 v20, v20, v24
    v_add_f32 v21, v21, v25
    v_add_f32 v22, v22, v26
    v_add_f32 v23, v23, v27
    v_mul_f32 v20, v20, v110
    v_mul_f32 v21, v21, v111
    v_mul_f32 v22, v22, v114
    v_mul_f32 v23, v23, v115
    s_cmp_eq_u32 s87, 2
    s_cbranch_scc1 KC_SEND
    v_cvt_f16_f32 v20, v20
    ds_write_b16 v108, v20
    v_cvt_f16_f32 v21, v21
    ds_write_b16 v109, v21
    v_cvt_f16_f32 v22, v22
    ds_write_b16 v112, v22
    v_cvt_f16_f32 v23, v23
    ds_write_b16 v113, v23
EXP_13:
    ds_write_b8 v15, v5 offset:68
    v_mov_b32 v28, 0
    v_mov_b32 v29, 0
    v_mov_b32 v30, 0
    v_mov_b32 v31, 0
    v_mov_b32 v32, s85
    s_waitcnt vmcnt(0)
W_29:
    ds_read_b32 v20, v14 offset:68
    s_sub_u32 s39, s39, 1
    s_cbranch_scc1 KS_ABORT
    s_waitcnt lgkmcnt(0)
    v_cmp_ne_u32 vcc, s84, v20
    s_cbranch_vccnz W_29
    ds_read_u16 v20, v116
    ds_read_u16 v21, v117
    ds_read_u16 v22, v118
    ds_read_u16 v23, v120
    ds_read_u16 v24, v121
    ds_read_u16 v25, v122
    ds_read_u16 v26, v123
    s_mov_b64 exec, 1
    ds_write_b128 v32, v[28:31] offset:3088
    ds_write_b128 v32, v[28:31] offset:8224
    ds_write_b128 v32, v[28:31] offset:3072
    s_mov_b64 exec, -1
    s_waitcnt lgkmcnt(7)
    v_lshl_or_b32 v28, v21, 16, v20
    v_lshl_or_b32 v29, v22, 16, v21
    ds_write_b32 v124, v28 offset:32528
    ds_write_b32 v124, v29 offset:33872
    ds_write_b32 v124, v28 offset:27284
    ds_write_b32 v124, v29 offset:28628
    s_waitcnt lgkmcnt(7)
    v_lshl_or_b32 v30, v24, 16, v23
    v_lshl_or_b32 v31, v26, 16, v25
    ds_write_b32 v119, v30
    ds_write_b32 v125, v31
    ds_write_b32 v119, v30 offset:5244
    ds_write_b32 v125, v31 offset:5244
    ds_write_b8 v15, v5 offset:72
    v_lshlrev_b32 v7, 3, v3
    v_sub_u32 v7, v8, v7
    v_lshrrev_b32 v19, 2, v2
    v_lshl_add_u32 v19, v19, 2, v3
    v_and_b32 v18, 3, v2
    v_mul_u32_u24 v19, s8, v19
    v_xor_b32 v19, s10, v19
    v_lshl_add_u32 v19, v18, 4, v19
    v_xor_b32 v12, s9, v12
W_30:
    ds_read_b32 v20, v14 offset:72
    s_sub_u32 s39, s39, 1
    s_cbranch_scc1 KS_ABORT
    s_waitcnt lgkmcnt(0)
    v_cmp_ne_u32 vcc, s84, v20
    s_cbranch_vccnz W_30
    ds_read_b64 v[16:17], v14 offset:832
    s_cmp_eq_u32 s86, 1
    s_cbranch_scc1 CV_32
    s_cmp_eq_u32 s86, 2
    s_cbranch_scc1 CV_33
    s_cmp_eq_u32 s86, 3
    s_cbranch_scc1 CV_34
    ds_read_b64 v[32:33], v6 offset:576
    ds_read_b64 v[34:35], v6 offset:584
    ds_read_b64 v[36:37], v6 offset:64
    ds_read_b64 v[38:39], v6 offset:72
    ds_read_b64 v[40:41], v6 offset:640
    ds_read_b64 v[42:43], v6 offset:648
    ds_read_b64 v[44:45], v6 offset:128
    ds_read_b64 v[46:47], v6 offset:136
    ds_read_b64 v[48:49], v6 offset:704
    ds_read_b64 v[50:51], v6 offset:712
    ds_read_b64 v[52:53], v6 offset:192
    ds_read_b64 v[54:55], v6 offset:200
    ds_read_b64 v[56:57], v6 offset:768
    ds_read_b64 v[58:59], v6 offset:776
    ds_read_b64 v[60:61], v6 offset:256
    ds_read_b64 v[62:63], v6 offset:264
    ds_read_b64 v[64:65], v6 offset:832
    ds_read_b64 v[66:67], v6 offset:840
    ds_read_b64 v[68:69], v6 offset:320
    ds_read_b64 v[70:71], v6 offset:328
    ds_read_b64 v[72:73], v6 offset:896
    ds_read_b64 v[74:75], v6 offset:904
    ds_read_b64 v[76:77], v6 offset:384
    ds_read_b64 v[78:79], v6 offset:392
    ds_read_b64 v[80:81], v6 offset:960
    ds_read_b64 v[82:83], v6 offset:968
    ds_read_b64 v[84:85], v6 offset:448
    ds_read_b64 v[86:87], v6 offset:456
    ds_read_b64 v[88:89], v6 offset:1024
    ds_read_b64 v[90:91], v6 offset:1032
    ds_read_b64 v[92:93], v6 offset:512
    ds_read_b64 v[94:95], v6 offset:520
    ds_read_b32 v18, v4 offset:16
    ds_read_b128 v[96:99], v8 offset:0
    ds_read_b128 v[100:103], v8 offset:64
    ds_read_b128 v[104:107], v8 offset:128
    ds_read_b128 v[108:111], v8 offset:192
    s_waitcnt lgkmcnt(4)
    v_cmp_ne_u32 vcc, s84, v18
    s_cbranch_vccnz US_36
UB_37:
    s_setprio 1
    s_waitcnt lgkmcnt(3)
    v_mfma_f32_16x16x32_f16 v[20:23], v[32:35], v[96:99], 0
    v_mov_b32 v6, v19
    v_mfma_f32_16x16x32_f16 v[24:27], v[36:39], v[96:99], 0
    ds_read_b128 v[112:115], v8 offset:256
    s_waitcnt lgkmcnt(3)
    v_mfma_f32_16x16x32_f16 v[20:23], v[40:43], v[100:103], v[20:23]
    ds_read_b64 v[28:29], v7 offset:480
    ds_read_b64 v[30:31], v7 offset:992
    v_mfma_f32_16x16x32_f16 v[24:27], v[44:47], v[100:103], v[24:27]
    ds_read_b128 v[116:119], v8 offset:320
    s_waitcnt lgkmcnt(5)
    v_mfma_f32_16x16x32_f16 v[20:23], v[48:51], v[104:107], v[20:23]
    v_mfma_f32_16x16x32_f16 v[24:27], v[52:55], v[104:107], v[24:27]
    ds_read_b128 v[120:123], v8 offset:384
    s_waitcnt lgkmcnt(2)
    v_fma_mix_f32 v104, v28, v17, 0 op_sel_hi:[1,0,0]
    v_fma_mix_f32 v105, v28, v17, 0 op_sel:[1,0,0] op_sel_hi:[1,0,0]
    v_mfma_f32_16x16x32_f16 v[20:23], v[56:59], v[108:111], v[20:23]
    v_fma_mix_f32 v106, v29, v17, 0 op_sel_hi:[1,0,0]
    v_fma_mix_f32 v107, v29, v17, 0 op_sel:[1,0,0] op_sel_hi:[1,0,0]
    v_mfma_f32_16x16x32_f16 v[24:27], v[60:63], v[108:111], v[24:27]
    ds_read_b128 v[124:127], v8 offset:448
    v_cvt_pk_bf16_f32 v104, 0, v104
    v_cvt_pk_bf16_f32 v105, 0, v105
    v_mfma_f32_16x16x32_f16 v[20:23], v[64:67], v[112:115], v[20:23]
    v_cvt_pk_bf16_f32 v106, 0, v106
    v_cvt_pk_bf16_f32 v107, 0, v107
    v_mfma_f32_16x16x32_f16 v[24:27], v[68:71], v[112:115], v[24:27]
    ds_read_b128 v[36:39], v8 offset:512
    v_fma_mix_f32 v112, v30, v17, 0 op_sel_hi:[1,0,0]
    v_fma_mix_f32 v113, v30, v17, 0 op_sel:[1,0,0] op_sel_hi:[1,0,0]
    s_waitcnt lgkmcnt(3)
    v_mfma_f32_16x16x32_f16 v[20:23], v[72:75], v[116:119], v[20:23]
    ds_read_b128 v[96:99], v8 offset:576
    v_fma_mix_f32 v114, v31, v17, 0 op_sel_hi:[1,0,0]
    v_fma_mix_f32 v115, v31, v17, 0 op_sel:[1,0,0] op_sel_hi:[1,0,0]
    v_mfma_f32_16x16x32_f16 v[24:27], v[76:79], v[116:119], v[24:27]
    ds_read_b128 v[44:47], v8 offset:640
    v_cvt_pk_bf16_f32 v112, 0, v112
    v_cvt_pk_bf16_f32 v113, 0, v113
    s_waitcnt lgkmcnt(4)
    v_mfma_f32_16x16x32_f16 v[20:23], v[80:83], v[120:123], v[20:23]
    ds_read_b128 v[100:103], v8 offset:704
    v_cvt_pk_bf16_f32 v114, 0, v114
    v_cvt_pk_bf16_f32 v115, 0, v115
    v_mfma_f32_16x16x32_f16 v[24:27], v[84:87], v[120:123], v[24:27]
    ds_read_b128 v[52:55], v8 offset:768
    s_waitcnt lgkmcnt(5)
    v_mfma_f32_16x16x32_f16 v[20:23], v[88:91], v[124:127], v[20:23]
    ds_read_b128 v[60:63], v8 offset:832
    v_mfma_f32_16x16x32_f16 v[24:27], v[92:95], v[124:127], v[24:27]
    ds_read_b128 v[108:111], v8 offset:896
    s_waitcnt lgkmcnt(6)
    v_mfma_f32_16x16x32_f16 v[24:27], v[32:35], v[36:39], v[24:27]
    ds_read_b128 v[68:71], v8 offset:960
    s_nop 1
    v_cvt_pk_bf16_f32 v20, 0, v20
    v_cvt_pk_bf16_f32 v21, 0, v21
    s_waitcnt lgkmcnt(6)
    v_mfma_f32_16x16x32_f16 v[24:27], v[40:43], v[96:99], v[24:27]
    v_cvt_pk_bf16_f32 v22, 0, v22
    v_cvt_pk_bf16_f32 v23, 0, v23
    s_waitcnt lgkmcnt(5)
    v_mfma_f32_16x16x32_f16 v[24:27], v[48:51], v[44:47], v[24:27]
    v_fma_f32 v20, v20, v16, v104
    v_fma_f32 v21, v21, v16, v105
    s_waitcnt lgkmcnt(4)
    v_mfma_f32_16x16x32_f16 v[24:27], v[56:59], v[100:103], v[24:27]
    v_fma_f32 v22, v22, v16, v106
    v_fma_f32 v23, v23, v16, v107
    s_waitcnt lgkmcnt(3)
    v_mfma_f32_16x16x32_f16 v[24:27], v[64:67], v[52:55], v[24:27]
    v_cvt_pk_bf16_f32 v28, v20, v21
    v_cvt_pk_bf16_f32 v29, v22, v23
    s_waitcnt lgkmcnt(2)
    v_mfma_f32_16x16x32_f16 v[24:27], v[72:75], v[60:63], v[24:27]
    v_min_u32 v28, -2, v28
    v_min_u32 v29, -2, v29
    s_waitcnt lgkmcnt(1)
    v_mfma_f32_16x16x32_f16 v[24:27], v[80:83], v[108:111], v[24:27]
    s_waitcnt lgkmcnt(0)
    v_mfma_f32_16x16x32_f16 v[24:27], v[88:91], v[68:71], v[24:27]
    ds_read_u8 v18, v14 offset:112
    ds_read_b128 v[20:23], v12 offset:46592
    s_nop 5
    v_cvt_pk_bf16_f32 v24, 0, v24
    v_cvt_pk_bf16_f32 v25, 0, v25
    v_cvt_pk_bf16_f32 v26, 0, v26
    v_cvt_pk_bf16_f32 v27, 0, v27
    v_fma_f32 v24, v24, v16, v112
    v_fma_f32 v25, v25, v16, v113
    v_fma_f32 v26, v26, v16, v114
    v_fma_f32 v27, v27, v16, v115
    v_cvt_pk_bf16_f32 v30, v24, v25
    v_cvt_pk_bf16_f32 v31, v26, v27
    v_min_u32 v30, -2, v30
    v_min_u32 v31, -2, v31
    s_branch CVE_35
CV_32:
    ds_read_b64 v[32:33], v6 offset:0
    ds_read_b64 v[34:35], v6 offset:8
    ds_read_b64 v[36:37], v6 offset:64
    ds_read_b64 v[38:39], v6 offset:72
    ds_read_b64 v[40:41], v6 offset:128
    ds_read_b64 v[42:43], v6 offset:136
    ds_read_b64 v[44:45], v6 offset:192
    ds_read_b64 v[46:47], v6 offset:200
    ds_read_b64 v[48:49], v6 offset:256
    ds_read_b64 v[50:51], v6 offset:264
    ds_read_b64 v[52:53], v6 offset:320
    ds_read_b64 v[54:55], v6 offset:328
    ds_read_b64 v[56:57], v6 offset:384
    ds_read_b64 v[58:59], v6 offset:392
    ds_read_b64 v[60:61], v6 offset:448
    ds_read_b64 v[62:63], v6 offset:456
    ds_read_b64 v[64:65], v6 offset:512
    ds_read_b64 v[66:67], v6 offset:520
    ds_read_b64 v[68:69], v6 offset:576
    ds_read_b64 v[70:71], v6 offset:584
    ds_read_b64 v[72:73], v6 offset:640
    ds_read_b64 v[74:75], v6 offset:648
    ds_read_b64 v[76:77], v6 offset:704
    ds_read_b64 v[78:79], v6 offset:712
    ds_read_b64 v[80:81], v6 offset:768
    ds_read_b64 v[82:83], v6 offset:776
    ds_read_b64 v[84:85], v6 offset:832
    ds_read_b64 v[86:87], v6 offset:840
    ds_read_b64 v[88:89], v6 offset:896
    ds_read_b64 v[90:91], v6 offset:904
    ds_read_b64 v[92:93], v6 offset:960
    ds_read_b64 v[94:95], v6 offset:968
    ds_read_b64 v[96:97], v6 offset:1024
    ds_read_b64 v[98:99], v6 offset:1032
    ds_read_b64 v[100:101], v11 offset:128
    ds_read_b64 v[102:103], v11 offset:136
    ds_read_b64 v[104:105], v11 offset:384
    ds_read_b64 v[106:107], v11 offset:392
    ds_read_b32 v18, v4 offset:16
    ds_read_b128 v[108:111], v8 offset:448
    ds_read_b128 v[112:115], v8 offset:512
    ds_read_b128 v[116:119], v8 offset:576
    ds_read_b128 v[120:123], v8 offset:640
    ds_read_b128 v[124:127], v8 offset:704
    s_waitcnt lgkmcnt(5)
    v_cmp_ne_u32 vcc, s84, v18
    s_cbranch_vccnz US_38
UB_39:
    s_setprio 1
    s_waitcnt lgkmcnt(4)
    v_mfma_f32_16x16x32_f16 v[20:23], v[32:35], v[108:111], 0
    ds_read_b128 v[108:111], v8 offset:768
    v_mov_b32 v6, v19
    s_waitcnt lgkmcnt(4)
    v_mfma_f32_16x16x32_f16 v[20:23], v[36:39], v[112:115], v[20:23]
    ds_read_b128 v[112:115], v8 offset:832
    s_waitcnt lgkmcnt(4)
    v_mfma_f32_16x16x32_f16 v[20:23], v[40:43], v[116:119], v[20:23]
    ds_read_b128 v[116:119], v8 offset:896
    ds_read_b64 v[28:29], v7 offset:1504
    ds_read_b64 v[30:31], v7 offset:2016
    s_waitcnt lgkmcnt(6)
    v_mfma_f32_16x16x32_f16 v[20:23], v[44:47], v[120:123], v[20:23]
    ds_read_b128 v[120:123], v8 offset:960
    s_waitcnt lgkmcnt(6)
    v_mfma_f32_16x16x32_f16 v[20:23], v[48:51], v[124:127], v[20:23]
    ds_read_b128 v[124:127], v8 offset:1024
    s_waitcnt lgkmcnt(6)
    v_mfma_f32_16x16x32_f16 v[20:23], v[52:55], v[108:111], v[20:23]
    ds_read_b128 v[108:111], v8 offset:1088
    s_waitcnt lgkmcnt(6)
    v_mfma_f32_16x16x32_f16 v[20:23], v[56:59], v[112:115], v[20:23]
    s_waitcnt lgkmcnt(5)
    v_mfma_f32_16x16x32_f16 v[20:23], v[60:63], v[116:119], v[20:23]
    ds_read_b128 v[112:115], v8 offset:1152
    s_waitcnt lgkmcnt(3)
    v_mfma_f32_16x16x32_f16 v[20:23], v[64:67], v[120:123], v[20:23]
    v_mfma_f32_16x16x32_f16 v[24:27], v[32:35], v[120:123], 0
    ds_read_b128 v[116:119], v8 offset:1216
    v_fma_mix_f32 v120, v28, v17, 0 op_sel_hi:[1,0,0]
    v_fma_mix_f32 v121, v28, v17, 0 op_sel:[1,0,0] op_sel_hi:[1,0,0]
    s_waitcnt lgkmcnt(3)
    v_mfma_f32_16x16x32_f16 v[20:23], v[68:71], v[124:127], v[20:23]
    v_fma_mix_f32 v122, v29, v17, 0 op_sel_hi:[1,0,0]
    v_fma_mix_f32 v123, v29, v17, 0 op_sel:[1,0,0] op_sel_hi:[1,0,0]
    v_mfma_f32_16x16x32_f16 v[24:27], v[36:39], v[124:127], v[24:27]
    ds_read_b128 v[32:35], v8 offset:1280
    v_cvt_pk_bf16_f32 v120, 0, v120
    v_cvt_pk_bf16_f32 v121, 0, v121
    s_waitcnt lgkmcnt(3)
    v_mfma_f32_16x16x32_f16 v[20:23], v[72:75], v[108:111], v[20:23]
    v_cvt_pk_bf16_f32 v122, 0, v122
    v_cvt_pk_bf16_f32 v123, 0, v123
    v_mfma_f32_16x16x32_f16 v[24:27], v[40:43], v[108:111], v[24:27]
    ds_read_b128 v[36:39], v8 offset:1344
    v_fma_mix_f32 v108, v30, v17, 0 op_sel_hi:[1,0,0]
    v_fma_mix_f32 v109, v30, v17, 0 op_sel:[1,0,0] op_sel_hi:[1,0,0]
    s_waitcnt lgkmcnt(3)
    v_mfma_f32_16x16x32_f16 v[20:23], v[76:79], v[112:115], v[20:23]
    v_fma_mix_f32 v110, v31, v17, 0 op_sel_hi:[1,0,0]
    v_fma_mix_f32 v111, v31, v17, 0 op_sel:[1,0,0] op_sel_hi:[1,0,0]
    v_mfma_f32_16x16x32_f16 v[24:27], v[44:47], v[112:115], v[24:27]
    ds_read_b128 v[124:127], v8 offset:1408
    v_cvt_pk_bf16_f32 v108, 0, v108
    v_cvt_pk_bf16_f32 v109, 0, v109
    s_waitcnt lgkmcnt(3)
    v_mfma_f32_16x16x32_f16 v[20:23], v[80:83], v[116:119], v[20:23]
    v_cvt_pk_bf16_f32 v110, 0, v110
    v_cvt_pk_bf16_f32 v111, 0, v111
    v_mfma_f32_16x16x32_f16 v[24:27], v[48:51], v[116:119], v[24:27]
    ds_read_b128 v[40:43], v8 offset:1472
    s_waitcnt lgkmcnt(3)
    v_mfma_f32_16x16x32_f16 v[20:23], v[84:87], v[32:35], v[20:23]
    v_mfma_f32_16x16x32_f16 v[24:27], v[52:55], v[32:35], v[24:27]
    ds_read_b128 v[44:47], v8 offset:1536
    s_waitcnt lgkmcnt(3)
    v_mfma_f32_16x16x32_f16 v[20:23], v[88:91], v[36:39], v[20:23]
    ds_read_b128 v[112:115], v8 offset:1600
    v_mfma_f32_16x16x32_f16 v[24:27], v[56:59], v[36:39], v[24:27]
    ds_read_b128 v[48:51], v8 offset:1664
    s_waitcnt lgkmcnt(4)
    v_mfma_f32_16x16x32_f16 v[20:23], v[92:95], v[124:127], v[20:23]
    ds_read_b128 v[116:119], v8 offset:1728
    v_mfma_f32_16x16x32_f16 v[24:27], v[60:63], v[124:127], v[24:27]
    ds_read_b128 v[52:55], v8 offset:1792
    s_waitcnt lgkmcnt(5)
    v_mfma_f32_16x16x32_f16 v[20:23], v[96:99], v[40:43], v[20:23]
    ds_read_b128 v[32:35], v8 offset:1856
    v_mfma_f32_16x16x32_f16 v[24:27], v[64:67], v[40:43], v[24:27]
    ds_read_b32 v18, v14 offset:76
    ds_read_b128 v[56:59], v8 offset:1920
    s_waitcnt lgkmcnt(7)
    v_mfma_f32_16x16x32_f16 v[24:27], v[68:71], v[44:47], v[24:27]
    ds_read_b128 v[36:39], v8 offset:1984
    s_waitcnt lgkmcnt(7)
    v_mfma_f32_16x16x32_f16 v[24:27], v[72:75], v[112:115], v[24:27]
    ds_read_b64 v[60:61], v11 offset:64
    ds_read_b64 v[62:63], v11 offset:72
    s_waitcnt lgkmcnt(8)
    v_mfma_f32_16x16x32_f16 v[24:27], v[76:79], v[48:51], v[24:27]
    s_waitcnt lgkmcnt(4)
    v_cmp_ne_u32 vcc, s84, v18
    s_cbranch_vccnz WS_40
WB_41:
    ds_read_b64_tr_b16 v[124:125], v9 offset:0
    ds_read_b64_tr_b16 v[126:127], v9 offset:64
    ds_read_b64_tr_b16 v[64:65], v9 offset:3088
    ds_read_b64_tr_b16 v[66:67], v9 offset:3152
    v_mfma_f32_16x16x32_f16 v[24:27], v[80:83], v[116:119], v[24:27]
    v_mfma_f32_16x16x32_f16 v[24:27], v[84:87], v[52:55], v[24:27]
    ds_read_b64_tr_b16 v[40:41], v9 offset:512
    ds_read_b64_tr_b16 v[42:43], v9 offset:576
    ds_read_b64 v[68:69], v11 offset:320
    ds_read_b64 v[70:71], v11 offset:328
    v_mfma_f32_16x16x32_f16 v[24:27], v[88:91], v[32:35], v[24:27]
    s_waitcnt lgkmcnt(11)
    v_mfma_f32_16x16x32_f16 v[24:27], v[92:95], v[56:59], v[24:27]
    ds_read_b64_tr_b16 v[44:45], v9 offset:3600
    ds_read_b64_tr_b16 v[46:47], v9 offset:3664
    s_waitcnt lgkmcnt(12)
    v_mfma_f32_16x16x32_f16 v[24:27], v[96:99], v[36:39], v[24:27]
    s_waitcnt lgkmcnt(8)
    v_mfma_f32_16x16x32_f16 v[20:23], v[124:127], v[100:103], v[20:23]
    s_waitcnt lgkmcnt(6)
    v_mfma_f32_16x16x32_f16 v[20:23], v[64:67], v[104:107], v[20:23]
    v_mfma_f32_16x16x32_f16 v[24:27], v[124:127], v[60:63], v[24:27]
    s_waitcnt lgkmcnt(4)
    v_mfma_f32_16x16x32_f16 v[24:27], v[40:43], v[100:103], v[24:27]
    s_nop 4
    v_cvt_pk_bf16_f32 v20, 0, v20
    v_cvt_pk_bf16_f32 v21, 0, v21
    s_waitcnt lgkmcnt(2)
    v_mfma_f32_16x16x32_f16 v[24:27], v[64:67], v[68:71], v[24:27]
    v_cvt_pk_bf16_f32 v22, 0, v22
    v_cvt_pk_bf16_f32 v23, 0, v23
    s_waitcnt lgkmcnt(0)
    v_mfma_f32_16x16x32_f16 v[24:27], v[44:47], v[104:107], v[24:27]
    v_fma_f32 v20, v20, v16, v120
    v_fma_f32 v21, v21, v16, v121
    v_fma_f32 v22, v22, v16, v122
    v_fma_f32 v23, v23, v16, v123
    v_cvt_pk_bf16_f32 v28, v20, v21
    v_cvt_pk_bf16_f32 v29, v22, v23
    v_min_u32 v28, -2, v28
    v_min_u32 v29, -2, v29
    ds_read_u8 v18, v14 offset:113
    ds_read_b128 v[20:23], v12 offset:47616
    v_cvt_pk_bf16_f32 v24, 0, v24
    v_cvt_pk_bf16_f32 v25, 0, v25
    v_cvt_pk_bf16_f32 v26, 0, v26
    v_cvt_pk_bf16_f32 v27, 0, v27
    v_fma_f32 v24, v24, v16, v108
    v_fma_f32 v25, v25, v16, v109
    v_fma_f32 v26, v26, v16, v110
    v_fma_f32 v27, v27, v16, v111
    v_cvt_pk_bf16_f32 v30, v24, v25
    v_cvt_pk_bf16_f32 v31, v26, v27
    v_min_u32 v30, -2, v30
    v_min_u32 v31, -2, v31
    s_branch CVE_35
CV_33:
    ds_read_b64 v[32:33], v6 offset:1152
    ds_read_b64 v[34:35], v6 offset:1160
    ds_read_b64 v[36:37], v6 offset:0
    ds_read_b64 v[38:39], v6 offset:8
    ds_read_b64 v[40:41], v6 offset:64
    ds_read_b64 v[42:43], v6 offset:72
    ds_read_b64 v[44:45], v6 offset:128
    ds_read_b64 v[46:47], v6 offset:136
    ds_read_b64 v[48:49], v6 offset:192
    ds_read_b64 v[50:51], v6 offset:200
    ds_read_b64 v[52:53], v6 offset:256
    ds_read_b64 v[54:55], v6 offset:264
    ds_read_b64 v[56:57], v6 offset:320
    ds_read_b64 v[58:59], v6 offset:328
    ds_read_b64 v[60:61], v6 offset:384
    ds_read_b64 v[62:63], v6 offset:392
    ds_read_b64 v[64:65], v6 offset:448
    ds_read_b64 v[66:67], v6 offset:456
    ds_read_b64 v[68:69], v6 offset:512
    ds_read_b64 v[70:71], v6 offset:520
    ds_read_b64 v[72:73], v6 offset:576
    ds_read_b64 v[74:75], v6 offset:584
    ds_read_b64 v[76:77], v6 offset:640
    ds_read_b64 v[78:79], v6 offset:648
    ds_read_b64 v[80:81], v6 offset:704
    ds_read_b64 v[82:83], v6 offset:712
    ds_read_b64 v[84:85], v6 offset:768
    ds_read_b64 v[86:87], v6 offset:776
    ds_read_b64 v[88:89], v6 offset:832
    ds_read_b64 v[90:91], v6 offset:840
    ds_read_b64 v[92:93], v6 offset:896
    ds_read_b64 v[94:95], v6 offset:904
    ds_read_b64 v[96:97], v6 offset:960
    ds_read_b64 v[98:99], v6 offset:968
    ds_read_b64 v[100:101], v6 offset:1024
    ds_read_b64 v[102:103], v6 offset:1032
    ds_read_b64 v[104:105], v11 offset:0
    ds_read_b64 v[106:107], v11 offset:8
    ds_read_b32 v18, v4 offset:16
    ds_read_b128 v[108:111], v8 offset:448
    ds_read_b128 v[112:115], v8 offset:960
    ds_read_b128 v[116:119], v8 offset:1472
    ds_read_b128 v[120:123], v8 offset:1536
    ds_read_b128 v[124:127], v8 offset:1600
    s_waitcnt lgkmcnt(5)
    v_cmp_ne_u32 vcc, s84, v18
    s_cbranch_vccnz US_42
UB_43:
    s_setprio 1
    s_waitcnt lgkmcnt(4)
    v_mfma_f32_16x16x32_f16 v[20:23], v[32:35], v[108:111], 0
    ds_read_b128 v[108:111], v8 offset:1664
    v_mov_b32 v6, v19
    s_waitcnt lgkmcnt(4)
    v_mfma_f32_16x16x32_f16 v[24:27], v[32:35], v[112:115], 0
    ds_read_b128 v[32:35], v8 offset:1728
    ds_read_b128 v[112:115], v8 offset:1792
    s_waitcnt lgkmcnt(5)
    v_mfma_f32_16x16x32_f16 v[20:23], v[36:39], v[116:119], v[20:23]
    ds_read_b128 v[116:119], v8 offset:1856
    ds_read_b64 v[28:29], v7 offset:2528
    ds_read_b64 v[30:31], v7 offset:3040
    s_waitcnt lgkmcnt(7)
    v_mfma_f32_16x16x32_f16 v[20:23], v[40:43], v[120:123], v[20:23]
    ds_read_b128 v[120:123], v8 offset:1920
    s_waitcnt lgkmcnt(7)
    v_mfma_f32_16x16x32_f16 v[20:23], v[44:47], v[124:127], v[20:23]
    ds_read_b128 v[124:127], v8 offset:1984
    s_waitcnt lgkmcnt(7)
    v_mfma_f32_16x16x32_f16 v[20:23], v[48:51], v[108:111], v[20:23]
    ds_read_b128 v[108:111], v8 offset:2048
    s_waitcnt lgkmcnt(7)
    v_mfma_f32_16x16x32_f16 v[20:23], v[52:55], v[32:35], v[20:23]
    s_waitcnt lgkmcnt(6)
    v_mfma_f32_16x16x32_f16 v[20:23], v[56:59], v[112:115], v[20:23]
    ds_read_b128 v[32:35], v8 offset:2112
    s_waitcnt lgkmcnt(6)
    v_mfma_f32_16x16x32_f16 v[20:23], v[60:63], v[116:119], v[20:23]
    s_waitcnt lgkmcnt(4)
    v_fma_mix_f32 v116, v28, v17, 0 op_sel_hi:[1,0,0]
    v_fma_mix_f32 v117, v28, v17, 0 op_sel:[1,0,0] op_sel_hi:[1,0,0]
    s_waitcnt lgkmcnt(3)
    v_mfma_f32_16x16x32_f16 v[20:23], v[64:67], v[120:123], v[20:23]
    ds_read_b128 v[112:115], v8 offset:2176
    v_fma_mix_f32 v118, v29, v17, 0 op_sel_hi:[1,0,0]
    v_fma_mix_f32 v119, v29, v17, 0 op_sel:[1,0,0] op_sel_hi:[1,0,0]
    s_waitcnt lgkmcnt(3)
    v_mfma_f32_16x16x32_f16 v[20:23], v[68:71], v[124:127], v[20:23]
    v_cvt_pk_bf16_f32 v116, 0, v116
    v_cvt_pk_bf16_f32 v117, 0, v117
    v_mfma_f32_16x16x32_f16 v[24:27], v[36:39], v[124:127], v[24:27]
    ds_read_b128 v[120:123], v8 offset:2240
    v_cvt_pk_bf16_f32 v118, 0, v118
    v_cvt_pk_bf16_f32 v119, 0, v119
    s_waitcnt lgkmcnt(3)
    v_mfma_f32_16x16x32_f16 v[20:23], v[72:75], v[108:111], v[20:23]
    v_fma_mix_f32 v124, v30, v17, 0 op_sel_hi:[1,0,0]
    v_fma_mix_f32 v125, v30, v17, 0 op_sel:[1,0,0] op_sel_hi:[1,0,0]
    v_mfma_f32_16x16x32_f16 v[24:27], v[40:43], v[108:111], v[24:27]
    ds_read_b128 v[36:39], v8 offset:2304
    v_fma_mix_f32 v126, v31, v17, 0 op_sel_hi:[1,0,0]
    v_fma_mix_f32 v127, v31, v17, 0 op_sel:[1,0,0] op_sel_hi:[1,0,0]
    s_waitcnt lgkmcnt(3)
    v_mfma_f32_16x16x32_f16 v[20:23], v[76:79], v[32:35], v[20:23]
    v_cvt_pk_bf16_f32 v124, 0, v124
    v_cvt_pk_bf16_f32 v125, 0, v125
    v_mfma_f32_16x16x32_f16 v[24:27], v[44:47], v[32:35], v[24:27]
    ds_read_b128 v[40:43], v8 offset:2368
    v_cvt_pk_bf16_f32 v126, 0, v126
    v_cvt_pk_bf16_f32 v127, 0, v127
    s_waitcnt lgkmcnt(3)
    v_mfma_f32_16x16x32_f16 v[20:23], v[80:83], v[112:115], v[20:23]
    v_mfma_f32_16x16x32_f16 v[24:27], v[48:51], v[112:115], v[24:27]
    ds_read_b128 v[108:111], v8 offset:2432
    s_waitcnt lgkmcnt(3)
    v_mfma_f32_16x16x32_f16 v[20:23], v[84:87], v[120:123], v[20:23]
    v_mfma_f32_16x16x32_f16 v[24:27], v[52:55], v[120:123], v[24:27]
    ds_read_b128 v[44:47], v8 offset:2496
    s_waitcnt lgkmcnt(3)
    v_mfma_f32_16x16x32_f16 v[20:23], v[88:91], v[36:39], v[20:23]
    v_mfma_f32_16x16x32_f16 v[24:27], v[56:59], v[36:39], v[24:27]
    ds_read_b128 v[32:35], v8 offset:2560
    s_waitcnt lgkmcnt(3)
    v_mfma_f32_16x16x32_f16 v[20:23], v[92:95], v[40:43], v[20:23]
    ds_read_b128 v[48:51], v8 offset:2624
    v_mfma_f32_16x16x32_f16 v[24:27], v[60:63], v[40:43], v[24:27]
    ds_read_b128 v[112:115], v8 offset:2688
    s_waitcnt lgkmcnt(4)
    v_mfma_f32_16x16x32_f16 v[20:23], v[96:99], v[108:111], v[20:23]
    ds_read_b128 v[52:55], v8 offset:2752
    v_mfma_f32_16x16x32_f16 v[24:27], v[64:67], v[108:111], v[24:27]
    ds_read_b128 v[120:123], v8 offset:2816
    s_waitcnt lgkmcnt(5)
    v_mfma_f32_16x16x32_f16 v[20:23], v[100:103], v[44:47], v[20:23]
    ds_read_b128 v[56:59], v8 offset:2880
    v_mfma_f32_16x16x32_f16 v[24:27], v[68:71], v[44:47], v[24:27]
    ds_read_b32 v18, v14 offset:76
    ds_read_b128 v[36:39], v8 offset:2944
    s_waitcnt lgkmcnt(7)
    v_mfma_f32_16x16x32_f16 v[24:27], v[72:75], v[32:35], v[24:27]
    ds_read_b128 v[60:63], v8 offset:3008
    s_waitcnt lgkmcnt(7)
    v_mfma_f32_16x16x32_f16 v[24:27], v[76:79], v[48:51], v[24:27]
    ds_read_b64 v[40:41], v11 offset:64
    ds_read_b64 v[42:43], v11 offset:72
    ds_read_b64 v[64:65], v11 offset:128
    ds_read_b64 v[66:67], v11 offset:136
    s_waitcnt lgkmcnt(10)
    v_mfma_f32_16x16x32_f16 v[24:27], v[80:83], v[112:115], v[24:27]
    s_waitcnt lgkmcnt(6)
    v_cmp_ne_u32 vcc, s84, v18
    s_cbranch_vccnz WS_44
WB_45:
    ds_read_b64_tr_b16 v[108:109], v9 offset:0
    ds_read_b64_tr_b16 v[110:111], v9 offset:64
    ds_read_b64_tr_b16 v[68:69], v9 offset:512
    ds_read_b64_tr_b16 v[70:71], v9 offset:576
    v_mfma_f32_16x16x32_f16 v[24:27], v[84:87], v[52:55], v[24:27]
    ds_read_b64_tr_b16 v[44:45], v9 offset:1024
    ds_read_b64_tr_b16 v[46:47], v9 offset:1088
    v_mfma_f32_16x16x32_f16 v[24:27], v[88:91], v[120:123], v[24:27]
    ds_read_b64_tr_b16 v[72:73], v9 offset:3088
    ds_read_b64_tr_b16 v[74:75], v9 offset:3152
    ds_read_b64 v[32:33], v11 offset:256
    ds_read_b64 v[34:35], v11 offset:264
    v_mfma_f32_16x16x32_f16 v[24:27], v[92:95], v[56:59], v[24:27]
    ds_read_b64_tr_b16 v[76:77], v9 offset:3600
    ds_read_b64_tr_b16 v[78:79], v9 offset:3664
    ds_read_b64 v[48:49], v11 offset:320
    ds_read_b64 v[50:51], v11 offset:328
    v_mfma_f32_16x16x32_f16 v[24:27], v[96:99], v[36:39], v[24:27]
    ds_read_b64_tr_b16 v[80:81], v9 offset:4112
    ds_read_b64_tr_b16 v[82:83], v9 offset:4176
    ds_read_b64 v[112:113], v11 offset:384
    ds_read_b64 v[114:115], v11 offset:392
    v_mfma_f32_16x16x32_f16 v[24:27], v[100:103], v[60:63], v[24:27]
    ds_read_b64_tr_b16 v[84:85], v10 offset:6176
    ds_read_b64_tr_b16 v[86:87], v10 offset:6304
    ds_read_b64 v[52:53], v13 offset:96
    ds_read_b64 v[54:55], v13 offset:104
    v_mfma_f32_16x16x32_f16 v[20:23], v[108:111], v[104:107], v[20:23]
    ds_read_b64_tr_b16 v[88:89], v10 offset:8224
    ds_read_b64_tr_b16 v[90:91], v10 offset:8352
    ds_read_b64 v[120:121], v13 offset:480
    ds_read_b64 v[122:123], v13 offset:488
    v_mfma_f32_16x16x32_f16 v[20:23], v[68:71], v[40:43], v[20:23]
    v_mfma_f32_16x16x32_f16 v[20:23], v[44:47], v[64:67], v[20:23]
    v_mfma_f32_16x16x32_f16 v[20:23], v[72:75], v[32:35], v[20:23]
    ds_read_b64_tr_b16 v[92:93], v9 offset:1536
    ds_read_b64_tr_b16 v[94:95], v9 offset:1600
    s_waitcnt lgkmcnt(14)
    v_mfma_f32_16x16x32_f16 v[20:23], v[76:79], v[48:51], v[20:23]
    s_waitcnt lgkmcnt(10)
    v_mfma_f32_16x16x32_f16 v[20:23], v[80:83], v[112:115], v[20:23]
    s_waitcnt lgkmcnt(6)
    v_mfma_f32_16x16x32_f16 v[20:23], v[84:87], v[52:55], v[20:23]
    ds_read_b64_tr_b16 v[56:57], v9 offset:4624
    ds_read_b64_tr_b16 v[58:59], v9 offset:4688
    ds_read_b64 v[96:97], v13 offset:64
    ds_read_b64 v[98:99], v13 offset:72
    s_waitcnt lgkmcnt(6)
    v_mfma_f32_16x16x32_f16 v[20:23], v[88:91], v[120:123], v[20:23]
    ds_read_b64 v[36:37], v13 offset:448
    ds_read_b64 v[38:39], v13 offset:456
    v_mfma_f32_16x16x32_f16 v[24:27], v[68:71], v[104:107], v[24:27]
    v_mfma_f32_16x16x32_f16 v[24:27], v[44:47], v[40:43], v[24:27]
    s_nop 3
    v_cvt_pk_bf16_f32 v20, 0, v20
    v_cvt_pk_bf16_f32 v21, 0, v21
    s_waitcnt lgkmcnt(6)
    v_mfma_f32_16x16x32_f16 v[24:27], v[92:95], v[64:67], v[24:27]
    v_cvt_pk_bf16_f32 v22, 0, v22
    v_cvt_pk_bf16_f32 v23, 0, v23
    v_mfma_f32_16x16x32_f16 v[24:27], v[76:79], v[32:35], v[24:27]
    v_fma_f32 v20, v20, v16, v116
    v_fma_f32 v21, v21, v16, v117
    v_mfma_f32_16x16x32_f16 v[24:27], v[80:83], v[48:51], v[24:27]
    v_fma_f32 v22, v22, v16, v118
    v_fma_f32 v23, v23, v16, v119
    s_waitcnt lgkmcnt(4)
    v_mfma_f32_16x16x32_f16 v[24:27], v[56:59], v[112:115], v[24:27]
    v_cvt_pk_bf16_f32 v28, v20, v21
    v_cvt_pk_bf16_f32 v29, v22, v23
    s_waitcnt lgkmcnt(2)
    v_mfma_f32_16x16x32_f16 v[24:27], v[84:87], v[96:99], v[24:27]
    v_min_u32 v28, -2, v28
    v_min_u32 v29, -2, v29
    s_waitcnt lgkmcnt(0)
    v_mfma_f32_16x16x32_f16 v[24:27], v[88:91], v[36:39], v[24:27]
    ds_read_u8 v18, v14 offset:114
    ds_read_b128 v[20:23], v12 offset:48640
    s_nop 5
    v_cvt_pk_bf16_f32 v24, 0, v24
    v_cvt_pk_bf16_f32 v25, 0, v25
    v_cvt_pk_bf16_f32 v26, 0, v26
    v_cvt_pk_bf16_f32 v27, 0, v27
    v_fma_f32 v24, v24, v16, v124
    v_fma_f32 v25, v25, v16, v125
    v_fma_f32 v26, v26, v16, v126
    v_fma_f32 v27, v27, v16, v127
    v_cvt_pk_bf16_f32 v30, v24, v25
    v_cvt_pk_bf16_f32 v31, v26, v27
    v_min_u32 v30, -2, v30
    v_min_u32 v31, -2, v31
    s_branch CVE_35
CV_34:
    ds_read_b64 v[32:33], v6 offset:1152
    ds_read_b64 v[34:35], v6 offset:1160
    ds_read_b64 v[36:37], v6 offset:0
    ds_read_b64 v[38:39], v6 offset:8
    ds_read_b64 v[40:41], v6 offset:64
    ds_read_b64 v[42:43], v6 offset:72
    ds_read_b64 v[44:45], v6 offset:128
    ds_read_b64 v[46:47], v6 offset:136
    ds_read_b64 v[48:49], v6 offset:192
    ds_read_b64 v[50:51], v6 offset:200
    ds_read_b64 v[52:53], v6 offset:256
    ds_read_b64 v[54:55], v6 offset:264
    ds_read_b64 v[56:57], v6 offset:320
    ds_read_b64 v[58:59], v6 offset:328
    ds_read_b64 v[60:61], v6 offset:384
    ds_read_b64 v[62:63], v6 offset:392
    ds_read_b64 v[64:65], v6 offset:448
    ds_read_b64 v[66:67], v6 offset:456
    ds_read_b64 v[68:69], v6 offset:512
    ds_read_b64 v[70:71], v6 offset:520
    ds_read_b64 v[72:73], v6 offset:576
    ds_read_b64 v[74:75], v6 offset:584
    ds_read_b64 v[76:77], v6 offset:640
    ds_read_b64 v[78:79], v6 offset:648
    ds_read_b64 v[80:81], v6 offset:704
    ds_read_b64 v[82:83], v6 offset:712
    ds_read_b64 v[84:85], v6 offset:768
    ds_read_b64 v[86:87], v6 offset:776
    ds_read_b64 v[88:89], v6 offset:832
    ds_read_b64 v[90:91], v6 offset:840
    ds_read_b64 v[92:93], v6 offset:896
    ds_read_b64 v[94:95], v6 offset:904
    ds_read_b64 v[96:97], v6 offset:960
    ds_read_b64 v[98:99], v6 offset:968
    ds_read_b64 v[100:101], v6 offset:1024
    ds_read_b64 v[102:103], v6 offset:1032
    ds_read_b64 v[104:105], v11 offset:0
    ds_read_b64 v[106:107], v11 offset:8
    ds_read_b32 v18, v4 offset:16
    ds_read_b128 v[108:111], v8 offset:1472
    ds_read_b128 v[112:115], v8 offset:1984
    ds_read_b128 v[116:119], v8 offset:2496
    ds_read_b128 v[120:123], v8 offset:2560
    ds_read_b128 v[124:127], v8 offset:2624
    s_waitcnt lgkmcnt(5)
    v_cmp_ne_u32 vcc, s84, v18
    s_cbranch_vccnz US_46
UB_47:
    s_setprio 1
    s_waitcnt lgkmcnt(4)
    v_mfma_f32_16x16x32_f16 v[20:23], v[32:35], v[108:111], 0
    ds_read_b128 v[108:111], v8 offset:2688
    v_mov_b32 v6, v19
    s_waitcnt lgkmcnt(4)
    v_mfma_f32_16x16x32_f16 v[24:27], v[32:35], v[112:115], 0
    ds_read_b128 v[32:35], v8 offset:2752
    ds_read_b128 v[112:115], v8 offset:2816
    s_waitcnt lgkmcnt(5)
    v_mfma_f32_16x16x32_f16 v[20:23], v[36:39], v[116:119], v[20:23]
    ds_read_b128 v[116:119], v8 offset:2880
    ds_read_b64 v[28:29], v7 offset:3552
    ds_read_b64 v[30:31], v7 offset:4064
    s_waitcnt lgkmcnt(7)
    v_mfma_f32_16x16x32_f16 v[20:23], v[40:43], v[120:123], v[20:23]
    ds_read_b128 v[120:123], v8 offset:2944
    s_waitcnt lgkmcnt(7)
    v_mfma_f32_16x16x32_f16 v[20:23], v[44:47], v[124:127], v[20:23]
    ds_read_b128 v[124:127], v8 offset:3008
    s_waitcnt lgkmcnt(7)
    v_mfma_f32_16x16x32_f16 v[20:23], v[48:51], v[108:111], v[20:23]
    ds_read_b128 v[108:111], v8 offset:3072
    s_waitcnt lgkmcnt(7)
    v_mfma_f32_16x16x32_f16 v[20:23], v[52:55], v[32:35], v[20:23]
    s_waitcnt lgkmcnt(6)
    v_mfma_f32_16x16x32_f16 v[20:23], v[56:59], v[112:115], v[20:23]
    ds_read_b128 v[32:35], v8 offset:3136
    s_waitcnt lgkmcnt(6)
    v_mfma_f32_16x16x32_f16 v[20:23], v[60:63], v[116:119], v[20:23]
    s_waitcnt lgkmcnt(4)
    v_fma_mix_f32 v116, v28, v17, 0 op_sel_hi:[1,0,0]
    v_fma_mix_f32 v117, v28, v17, 0 op_sel:[1,0,0] op_sel_hi:[1,0,0]
    s_waitcnt lgkmcnt(3)
    v_mfma_f32_16x16x32_f16 v[20:23], v[64:67], v[120:123], v[20:23]
    ds_read_b128 v[112:115], v8 offset:3200
    v_fma_mix_f32 v118, v29, v17, 0 op_sel_hi:[1,0,0]
    v_fma_mix_f32 v119, v29, v17, 0 op_sel:[1,0,0] op_sel_hi:[1,0,0]
    s_waitcnt lgkmcnt(3)
    v_mfma_f32_16x16x32_f16 v[20:23], v[68:71], v[124:127], v[20:23]
    v_cvt_pk_bf16_f32 v116, 0, v116
    v_cvt_pk_bf16_f32 v117, 0, v117
    v_mfma_f32_16x16x32_f16 v[24:27], v[36:39], v[124:127], v[24:27]
    ds_read_b128 v[120:123], v8 offset:3264
    v_cvt_pk_bf16_f32 v118, 0, v118
    v_cvt_pk_bf16_f32 v119, 0, v119
    s_waitcnt lgkmcnt(3)
    v_mfma_f32_16x16x32_f16 v[20:23], v[72:75], v[108:111], v[20:23]
    v_fma_mix_f32 v124, v30, v17, 0 op_sel_hi:[1,0,0]
    v_fma_mix_f32 v125, v30, v17, 0 op_sel:[1,0,0] op_sel_hi:[1,0,0]
    v_mfma_f32_16x16x32_f16 v[24:27], v[40:43], v[108:111], v[24:27]
    ds_read_b128 v[36:39], v8 offset:3328
    v_fma_mix_f32 v126, v31, v17, 0 op_sel_hi:[1,0,0]
    v_fma_mix_f32 v127, v31, v17, 0 op_sel:[1,0,0] op_sel_hi:[1,0,0]
    s_waitcnt lgkmcnt(3)
    v_mfma_f32_16x16x32_f16 v[20:23], v[76:79], v[32:35], v[20:23]
    v_cvt_pk_bf16_f32 v124, 0, v124
    v_cvt_pk_bf16_f32 v125, 0, v125
    v_mfma_f32_16x16x32_f16 v[24:27], v[44:47], v[32:35], v[24:27]
    ds_read_b128 v[40:43], v8 offset:3392
    v_cvt_pk_bf16_f32 v126, 0, v126
    v_cvt_pk_bf16_f32 v127, 0, v127
    s_waitcnt lgkmcnt(3)
    v_mfma_f32_16x16x32_f16 v[20:23], v[80:83], v[112:115], v[20:23]
    v_mfma_f32_16x16x32_f16 v[24:27], v[48:51], v[112:115], v[24:27]
    ds_read_b128 v[108:111], v8 offset:3456
    s_waitcnt lgkmcnt(3)
    v_mfma_f32_16x16x32_f16 v[20:23], v[84:87], v[120:123], v[20:23]
    v_mfma_f32_16x16x32_f16 v[24:27], v[52:55], v[120:123], v[24:27]
    ds_read_b128 v[44:47], v8 offset:3520
    s_waitcnt lgkmcnt(3)
    v_mfma_f32_16x16x32_f16 v[20:23], v[88:91], v[36:39], v[20:23]
    v_mfma_f32_16x16x32_f16 v[24:27], v[56:59], v[36:39], v[24:27]
    ds_read_b128 v[32:35], v8 offset:3584
    s_waitcnt lgkmcnt(3)
    v_mfma_f32_16x16x32_f16 v[20:23], v[92:95], v[40:43], v[20:23]
    ds_read_b128 v[48:51], v8 offset:3648
    v_mfma_f32_16x16x32_f16 v[24:27], v[60:63], v[40:43], v[24:27]
    ds_read_b128 v[112:115], v8 offset:3712
    s_waitcnt lgkmcnt(4)
    v_mfma_f32_16x16x32_f16 v[20:23], v[96:99], v[108:111], v[20:23]
    ds_read_b128 v[52:55], v8 offset:3776
    v_mfma_f32_16x16x32_f16 v[24:27], v[64:67], v[108:111], v[24:27]
    ds_read_b128 v[120:123], v8 offset:3840
    s_waitcnt lgkmcnt(5)
    v_mfma_f32_16x16x32_f16 v[20:23], v[100:103], v[44:47], v[20:23]
    ds_read_b128 v[56:59], v8 offset:3904
    v_mfma_f32_16x16x32_f16 v[24:27], v[68:71], v[44:47], v[24:27]
    ds_read_b32 v18, v14 offset:76
    ds_read_b128 v[36:39], v8 offset:3968
    s_waitcnt lgkmcnt(7)
    v_mfma_f32_16x16x32_f16 v[24:27], v[72:75], v[32:35], v[24:27]
    ds_read_b128 v[60:63], v8 offset:4032
    s_waitcnt lgkmcnt(7)
    v_mfma_f32_16x16x32_f16 v[24:27], v[76:79], v[48:51], v[24:27]
    ds_read_b64 v[40:41], v11 offset:64
    ds_read_b64 v[42:43], v11 offset:72
    ds_read_b64 v[64:65], v11 offset:128
    ds_read_b64 v[66:67], v11 offset:136
    s_waitcnt lgkmcnt(10)
    v_mfma_f32_16x16x32_f16 v[24:27], v[80:83], v[112:115], v[24:27]
    s_waitcnt lgkmcnt(6)
    v_cmp_ne_u32 vcc, s84, v18
    s_cbranch_vccnz WS_48
WB_49:
    ds_read_b64_tr_b16 v[108:109], v9 offset:1024
    ds_read_b64_tr_b16 v[110:111], v9 offset:1088
    ds_read_b64_tr_b16 v[68:69], v9 offset:1536
    ds_read_b64_tr_b16 v[70:71], v9 offset:1600
    v_mfma_f32_16x16x32_f16 v[24:27], v[84:87], v[52:55], v[24:27]
    ds_read_b64_tr_b16 v[44:45], v9 offset:2048
    ds_read_b64_tr_b16 v[46:47], v9 offset:2112
    v_mfma_f32_16x16x32_f16 v[24:27], v[88:91], v[120:123], v[24:27]
    ds_read_b64_tr_b16 v[72:73], v9 offset:4112
    ds_read_b64_tr_b16 v[74:75], v9 offset:4176
    ds_read_b64 v[32:33], v11 offset:256
    ds_read_b64 v[34:35], v11 offset:264
    v_mfma_f32_16x16x32_f16 v[24:27], v[92:95], v[56:59], v[24:27]
    ds_read_b64_tr_b16 v[76:77], v9 offset:4624
    ds_read_b64_tr_b16 v[78:79], v9 offset:4688
    ds_read_b64 v[48:49], v11 offset:320
    ds_read_b64 v[50:51], v11 offset:328
    v_mfma_f32_16x16x32_f16 v[24:27], v[96:99], v[36:39], v[24:27]
    ds_read_b64_tr_b16 v[80:81], v9 offset:5136
    ds_read_b64_tr_b16 v[82:83], v9 offset:5200
    ds_read_b64 v[112:113], v11 offset:384
    ds_read_b64 v[114:115], v11 offset:392
    v_mfma_f32_16x16x32_f16 v[24:27], v[100:103], v[60:63], v[24:27]
    ds_read_b64_tr_b16 v[84:85], v10 offset:6176
    ds_read_b64_tr_b16 v[86:87], v10 offset:6304
    ds_read_b64 v[52:53], v13 offset:32
    ds_read_b64 v[54:55], v13 offset:40
    v_mfma_f32_16x16x32_f16 v[20:23], v[108:111], v[104:107], v[20:23]
    ds_read_b64_tr_b16 v[88:89], v10 offset:7200
    ds_read_b64_tr_b16 v[90:91], v10 offset:7328
    ds_read_b64 v[120:121], v13 offset:96
    ds_read_b64 v[122:123], v13 offset:104
    v_mfma_f32_16x16x32_f16 v[20:23], v[68:71], v[40:43], v[20:23]
    ds_read_b64_tr_b16 v[92:93], v10 offset:8224
    ds_read_b64_tr_b16 v[94:95], v10 offset:8352
    ds_read_b64 v[56:57], v13 offset:416
    ds_read_b64 v[58:59], v13 offset:424
    v_mfma_f32_16x16x32_f16 v[20:23], v[44:47], v[64:67], v[20:23]
    ds_read_b64_tr_b16 v[96:97], v10 offset:9248
    ds_read_b64_tr_b16 v[98:99], v10 offset:9376
    ds_read_b64 v[36:37], v13 offset:480
    ds_read_b64 v[38:39], v13 offset:488
    v_mfma_f32_16x16x32_f16 v[20:23], v[72:75], v[32:35], v[20:23]
    v_mfma_f32_16x16x32_f16 v[20:23], v[76:79], v[48:51], v[20:23]
    v_mfma_f32_16x16x32_f16 v[20:23], v[80:83], v[112:115], v[20:23]
    ds_read_b64_tr_b16 v[100:101], v9 offset:2560
    ds_read_b64_tr_b16 v[102:103], v9 offset:2624
    s_waitcnt lgkmcnt(14)
    v_mfma_f32_16x16x32_f16 v[20:23], v[84:87], v[52:55], v[20:23]
    s_waitcnt lgkmcnt(10)
    v_mfma_f32_16x16x32_f16 v[20:23], v[88:91], v[120:123], v[20:23]
    s_waitcnt lgkmcnt(6)
    v_mfma_f32_16x16x32_f16 v[20:23], v[92:95], v[56:59], v[20:23]
    ds_read_b64_tr_b16 v[60:61], v9 offset:5648
    ds_read_b64_tr_b16 v[62:63], v9 offset:5712
    ds_read_b64 v[108:109], v13 offset:0
    ds_read_b64 v[110:111], v13 offset:8
    s_waitcnt lgkmcnt(6)
    v_mfma_f32_16x16x32_f16 v[20:23], v[96:99], v[36:39], v[20:23]
    ds_read_b64 v[72:73], v13 offset:64
    ds_read_b64 v[74:75], v13 offset:72
    ds_read_b64 v[52:53], v13 offset:384
    ds_read_b64 v[54:55], v13 offset:392
    v_mfma_f32_16x16x32_f16 v[24:27], v[68:71], v[104:107], v[24:27]
    ds_read_b64 v[120:121], v13 offset:448
    ds_read_b64 v[122:123], v13 offset:456
    v_mfma_f32_16x16x32_f16 v[24:27], v[44:47], v[40:43], v[24:27]
    v_cvt_pk_bf16_f32 v20, 0, v20
    v_cvt_pk_bf16_f32 v21, 0, v21
    s_waitcnt lgkmcnt(10)
    v_mfma_f32_16x16x32_f16 v[24:27], v[100:103], v[64:67], v[24:27]
    v_cvt_pk_bf16_f32 v22, 0, v22
    v_cvt_pk_bf16_f32 v23, 0, v23
    v_mfma_f32_16x16x32_f16 v[24:27], v[76:79], v[32:35], v[24:27]
    v_fma_f32 v20, v20, v16, v116
    v_fma_f32 v21, v21, v16, v117
    v_mfma_f32_16x16x32_f16 v[24:27], v[80:83], v[48:51], v[24:27]
    v_fma_f32 v22, v22, v16, v118
    v_fma_f32 v23, v23, v16, v119
    s_waitcnt lgkmcnt(8)
    v_mfma_f32_16x16x32_f16 v[24:27], v[60:63], v[112:115], v[24:27]
    v_cvt_pk_bf16_f32 v28, v20, v21
    v_cvt_pk_bf16_f32 v29, v22, v23
    s_waitcnt lgkmcnt(6)
    v_mfma_f32_16x16x32_f16 v[24:27], v[84:87], v[108:111], v[24:27]
    v_min_u32 v28, -2, v28
    v_min_u32 v29, -2, v29
    s_waitcnt lgkmcnt(4)
    v_mfma_f32_16x16x32_f16 v[24:27], v[88:91], v[72:75], v[24:27]
    s_waitcnt lgkmcnt(2)
    v_mfma_f32_16x16x32_f16 v[24:27], v[92:95], v[52:55], v[24:27]
    s_waitcnt lgkmcnt(0)
    v_mfma_f32_16x16x32_f16 v[24:27], v[96:99], v[120:123], v[24:27]
    ds_read_u8 v18, v14 offset:115
    ds_read_b128 v[20:23], v12 offset:49664
    s_nop 5
    v_cvt_pk_bf16_f32 v24, 0, v24
    v_cvt_pk_bf16_f32 v25, 0, v25
    v_cvt_pk_bf16_f32 v26, 0, v26
    v_cvt_pk_bf16_f32 v27, 0, v27
    v_fma_f32 v24, v24, v16, v124
    v_fma_f32 v25, v25, v16, v125
    v_fma_f32 v26, v26, v16, v126
    v_fma_f32 v27, v27, v16, v127
    v_cvt_pk_bf16_f32 v30, v24, v25
    v_cvt_pk_bf16_f32 v31, v26, v27
    v_min_u32 v30, -2, v30
    v_min_u32 v31, -2, v31
CVE_35:
    s_waitcnt lgkmcnt(0)
    s_cmp_lg_u32 s87, 1
    s_cbranch_scc1 ZA_50
    v_cmp_ne_u32 vcc, 1, v18
    s_cbranch_vccnz ZS_52
ZB_53:
    s_mov_b64 exec, s[12:13]
    v_swap_b32 v28, v20
    v_swap_b32 v29, v21
    v_swap_b32 v30, v22
    v_swap_b32 v31, v23
    s_mov_b64 exec, -1
    buffer_store_dwordx4 v[28:31], v6, s[64:67], s7 offen sc1
    buffer_store_dwordx4 v[20:23], v6, s[64:67], s6 offen sc1
    s_branch ZD_55
WS_40:
W_56:
    ds_read_b32 v18, v14 offset:76
    s_sub_u32 s39, s39, 1
    s_cbranch_scc1 KS_ABORT
    s_waitcnt lgkmcnt(0)
    v_cmp_ne_u32 vcc, s84, v18
    s_cbranch_vccnz W_56
    s_branch WB_41
WS_44:
W_57:
    ds_read_b32 v18, v14 offset:76
    s_sub_u32 s39, s39, 1
    s_cbranch_scc1 KS_ABORT
    s_waitcnt lgkmcnt(0)
    v_cmp_ne_u32 vcc, s84, v18
    s_cbranch_vccnz W_57
    s_branch WB_45
WS_48:
W_58:
    ds_read_b32 v18, v14 offset:76
    s_sub_u32 s39, s39, 1
    s_cbranch_scc1 KS_ABORT
    s_waitcnt lgkmcnt(0)
    v_cmp_ne_u32 vcc, s84, v18
    s_cbranch_vccnz W_58
    s_branch WB_49
US_36:
    s_setprio 0
W_59:
    s_sleep 1
    ds_read_b32 v18, v4 offset:16
    s_sub_u32 s39, s39, 1
    s_cbranch_scc1 KS_ABORT
    s_waitcnt lgkmcnt(0)
    v_cmp_eq_u32 vcc, 0, v18
    s_cbranch_vccnz W_59
W_60:
    ds_read_b32 v18, v4 offset:16
    s_sub_u32 s39, s39, 1
    s_cbranch_scc1 KS_ABORT
    s_waitcnt lgkmcnt(0)
    v_cmp_ne_u32 vcc, s84, v18
    s_cbranch_vccnz W_60
    ds_read_b128 v[96:99], v8 offset:0
    ds_read_b128 v[100:103], v8 offset:64
    ds_read_b128 v[104:107], v8 offset:128
    ds_read_b128 v[108:111], v8 offset:192
    s_branch UB_37
US_38:
    s_setprio 0
W_61:
    s_sleep 1
    ds_read_b32 v18, v4 offset:16
    s_sub_u32 s39, s39, 1
    s_cbranch_scc1 KS_ABORT
    s_waitcnt lgkmcnt(0)
    v_cmp_eq_u32 vcc, 0, v18
    s_cbranch_vccnz W_61
W_62:
    ds_read_b32 v18, v4 offset:16
    s_sub_u32 s39, s39, 1
    s_cbranch_scc1 KS_ABORT
    s_waitcnt lgkmcnt(0)
    v_cmp_ne_u32 vcc, s84, v18
    s_cbranch_vccnz W_62
    ds_read_b128 v[108:111], v8 offset:448
    ds_read_b128 v[112:115], v8 offset:512
    ds_read_b128 v[116:119], v8 offset:576
    ds_read_b128 v[120:123], v8 offset:640
    ds_read_b128 v[124:127], v8 offset:704
    s_branch UB_39
US_42:
    s_setprio 0
W_63:
    s_sleep 1
    ds_read_b32 v18, v4 offset:16
    s_sub_u32 s39, s39, 1
    s_cbranch_scc1 KS_ABORT
    s_waitcnt lgkmcnt(0)
    v_cmp_eq_u32 vcc, 0, v18
    s_cbranch_vccnz W_63
W_64:
    ds_read_b32 v18, v4 offset:16
    s_sub_u32 s39, s39, 1
    s_cbranch_scc1 KS_ABORT
    s_waitcnt lgkmcnt(0)
    v_cmp_ne_u32 vcc, s84, v18
    s_cbranch_vccnz W_64
    ds_read_b128 v[108:111], v8 offset:448
    ds_read_b128 v[112:115], v8 offset:960
    ds_read_b128 v[116:119], v8 offset:1472
    ds_read_b128 v[120:123], v8 offset:1536
    ds_read_b128 v[124:127], v8 offset:1600
    s_branch UB_43
US_46:
    s_setprio 0
W_65:
    s_sleep 1
    ds_read_b32 v18, v4 offset:16
    s_sub_u32 s39, s39, 1
    s_cbranch_scc1 KS_ABORT
    s_waitcnt lgkmcnt(0)
    v_cmp_eq_u32 vcc, 0, v18
    s_cbranch_vccnz W_65
W_66:
    ds_read_b32 v18, v4 offset:16
    s_sub_u32 s39, s39, 1
    s_cbranch_scc1 KS_ABORT
    s_waitcnt lgkmcnt(0)
    v_cmp_ne_u32 vcc, s84, v18
    s_cbranch_vccnz W_66
    ds_read_b128 v[108:111], v8 offset:1472
    ds_read_b128 v[112:115], v8 offset:1984
    ds_read_b128 v[116:119], v8 offset:2496
    ds_read_b128 v[120:123], v8 offset:2560
    ds_read_b128 v[124:127], v8 offset:2624
    s_branch UB_47
ZS_52:
    v_mov_b32 v19, s86
    v_lshl_add_u32 v16, v19, 10, v12
ZW_67:
    ds_read_u8 v18, v19 offset:128
    ds_read_b128 v[20:23], v16 offset:46592
    s_sub_u32 s39, s39, 1
    s_cbranch_scc1 KS_ABORT
    s_waitcnt lgkmcnt(0)
    v_cmp_ne_u32 vcc, 1, v18
    s_cbranch_vccnz ZW_67
    s_branch ZB_53
ZA_50:
    v_cmp_eq_u32 vcc, 1, v18
    s_cbranch_vccnz KS_CLK
W_68:
    ds_read_b32 v18, v4 offset:112
    s_sub_u32 s39, s39, 1
    s_cbranch_scc1 KS_ABORT
    s_waitcnt lgkmcnt(0)
    v_cmp_ne_u32 vcc, s84, v18
    s_cbranch_vccnz W_68
KS_CLK:
    s_cmp_lg_u32 s87, 0
    s_cbranch_scc1 ZC_51
    v_mov_b32 v19, s86
    v_lshl_add_u32 v18, v19, 10, v12
    ds_write_b128 v18, v[28:31] offset:46592
    ds_write_b8 v19, v5 offset:128
    s_branch ZD_55
ZC_51:
    buffer_store_dwordx4 v[28:31], v6, s[64:67], s6 offen sc1
ZD_55:
    s_lshl_b32 s92, s87, 2
    s_add_u32 s92, s92, s86
    v_mov_b32 v8, s92
    s_waitcnt vmcnt(0)
    ds_write_b8 v8, v5 offset:48
    s_branch KS_K1
    s_cmp_lg_u32 s38, 4
    s_cbranch_scc1 KS_K1
    s_setprio 0
    s_add_u32 s76, s36, 0x840000
    s_addc_u32 s77, s37, 0
    s_mov_b32 s78, 0x4000
    s_mov_b32 s79, 0x20000
    v_and_b32 v6, 1, v1
    v_lshlrev_b32 v6, 4, v6
    s_lshl_b32 s92, s90, 5
W_69:
    s_sleep 1
    ds_read_b32 v8, v4 offset:20
    s_sub_u32 s39, s39, 1
    s_cbranch_scc1 KS_ABORT
    s_waitcnt lgkmcnt(0)
    v_cmp_ne_u32 vcc, s84, v8
    s_cbranch_vccnz W_69
    s_mov_b64 exec, 3
    s_setprio 1
KS_K0:
    ds_read_b128 v[8:11], v6 offset:800
    s_sub_u32 s39, s39, 1
    s_cbranch_scc1 KS_ABORT
    s_waitcnt lgkmcnt(0)
    v_min3_u32 v12, v8, v9, v10
    v_min_u32 v12, v12, v11
    v_cmp_eq_u32 vcc, 0, v12
    s_cbranch_vccnz KS_K0
    buffer_store_dwordx4 v[8:11], v6, s[76:79], s92 offen sc1
    s_mov_b64 exec, -1
    s_waitcnt vmcnt(0)
    ds_write_b32 v4, v5 offset:24
KS_K1:
    s_cmp_lt_u32 s41, 18
    s_cbranch_scc1 KS_T
    s_waitcnt lgkmcnt(0)
    s_endpgm
KS_X:
    s_cmp_lt_u32 s41, 24
    s_cbranch_scc1 KS_X2
    s_setprio 2
KS_XC:
    s_add_u32 s86, s38, 3
KS_XD:
    s_mov_b32 s87, 2
    s_and_b32 s86, s86, 3
    s_lshl_b32 s88, s40, 3
    s_and_b32 s92, s41, 7
    s_add_u32 s88, s88, s92
    s_add_u32 s88, s88, 512
    s_lshl_b32 s92, s86, 11
    s_add_u32 s92, s92, 146048
    v_lshl_add_u32 v28, v1, 3, s92
    s_branch KS_GRP
KS_X2:
    s_cmp_lt_u32 s41, 8
    s_cbranch_scc1 KS_X3
    s_sub_u32 s97, s38, 8
    s_branch KS_LN1
KS_X3:
    s_lshl_b32 s92, s2, 4
    s_add_u32 s92, s92, s38
    s_cmp_lg_u32 s92, 44
    s_cbranch_scc1 KS_X3B
    s_setprio 3
    s_memrealtime s[92:93]
    v_and_b32 v6, 3, v1
    v_lshlrev_b32 v7, 2, v6
    v_min_u32 v6, 2, v6
    v_lshlrev_b32 v6, 2, v6
    v_cmp_eq_u32 vcc, 3, v1
    s_waitcnt lgkmcnt(0)
    v_mov_b32 v8, s92
    v_mov_b32 v9, s93
    v_alignbit_b32 v8, v8, v8, v6
    v_cndmask_b32 v9, v4, v9, vcc
    v_xor_b32 v8, v8, v9
    v_and_b32 v9, 0xf0000fff, v8
    v_and_b32 v10, 0xfff000, v8
    v_lshl_or_b32 v9, v10, 4, v9
    v_lshrrev_b32 v10, 12, v8
    v_and_b32 v10, 0xf000, v10
    v_or3_b32 v9, v9, v10, v9
    v_or_b32 v9, 0x80000000, v9
    s_mov_b64 exec, 15
    global_store_dword v7, v9, s[34:35] sc1
    s_mov_b64 exec, -1
    s_setprio 0
KS_X3B:
    s_setprio 3
    s_branch KS_XC
    s_waitcnt lgkmcnt(0)
    s_barrier
    s_branch KS_G
KS_X4:
    s_setprio 0
    s_cmp_lt_u32 s41, 18
    s_cbranch_scc1 KS_GN
KS_X5:
    v_mul_u32_u24 v46, 57, v1
    v_lshrrev_b32 v46, 9, v46
    v_mul_u32_u24 v47, 9, v46
    v_sub_u32 v47, v1, v47
    v_mul_u32_u24 v46, 9216, v46
    v_lshl_add_u32 v46, v47, 7, v46
    s_mul_i32 s94, s38, 6
    s_add_u32 s94, s94, s41
    s_sub_u32 s94, s94, 90
W_70:
    s_sleep 2
    ds_read_b32 v10, v4 offset:200
    s_sub_u32 s39, s39, 1
    s_cbranch_scc1 KS_ABORT
    s_waitcnt lgkmcnt(0)
    v_cmp_ne_u32 vcc, s84, v10
    s_cbranch_vccnz W_70
    s_bitcmp1_b32 s94, 0
    s_cselect_b32 s72, s28, s26
    s_cselect_b32 s73, s29, s27
    s_mov_b32 s74, 0x510000
    s_mov_b32 s75, 0x20000
    s_lshr_b32 s95, s94, 1
    s_mul_i32 s95, s95, 64512
    s_mul_i32 s96, s40, 1152
    s_add_u32 s95, s95, s96
    s_add_u32 s96, s95, 2644992
    buffer_load_dword v47, v46, s[72:75], s96 offen nt
    buffer_load_dword v47, v46, s[72:75], s96 offen sc1
KS_XPE:
    s_waitcnt vmcnt(0) lgkmcnt(0)
    s_endpgm
KS_L:
    v_lshlrev_b32 v6, 2, v0
    ds_write_b32 v6, v4
    v_mov_b32 v8, 0
    v_mov_b32 v9, 0
    s_min_u32 s92, s38, 2
    s_mul_i32 s92, s92, 4672
    v_min_u32 v6, 59, v1
    v_lshl_add_u32 v6, v6, 3, s92
    ds_write_b64 v6, v[8:9] offset:3072
    s_mov_b32 s97, s38
    s_sub_u32 s92, s41, 8
    s_cmp_lt_u32 s92, 16
    s_cbranch_scc0 KS_L0
KS_LN1:
    s_setprio 3
    s_sub_u32 s92, s41, 8
    s_and_b32 s88, s92, 7
    s_lshr_b32 s92, s92, 3
    s_lshl_b32 s92, s92, 4
    s_add_u32 s88, s88, s92
    s_and_b32 s92, s40, 1
    s_lshl_b32 s92, s92, 3
    s_add_u32 s88, s88, s92
    s_lshr_b32 s92, s40, 1
    s_lshl_b32 s92, s92, 5
    s_add_u32 s88, s88, s92
    v_lshrrev_b32 v36, 5, v1
    v_and_b32 v37, 31, v1
    v_mul_u32_u24 v38, 9216, v36
    v_lshl_add_u32 v39, v37, 2, v38
    v_lshl_add_u32 v38, v37, 4, v38
    s_mul_i32 s93, s88, 18432
    s_mul_i32 s94, s97, 1152
    s_add_u32 s93, s93, s94
    s_mov_b32 s66, 0x240000
    s_mov_b32 s67, 0x20000
    s_waitcnt lgkmcnt(0)
    s_mov_b32 s64, s4
    s_mov_b32 s65, s5
    buffer_load_dwordx4 v[26:29], v38, s[64:67], s93 offen
    buffer_load_dwordx4 v[30:33], v38, s[64:67], s93 offen offset:512
    buffer_load_dword v34, v39, s[64:67], s93 offen offset:1024
    s_barrier
    s_mul_i32 s94, s97, 2368
    s_add_u32 s94, s94, 16576
    v_lshl_add_u32 v6, v37, 1, v36
    v_lshl_add_u32 v6, v6, 2, s94
    v_and_b32 v59, 3, v1
    v_bfe_u32 v7, v1, 2, 2
    v_mul_u32_u24 v7, 2368, v7
    v_lshl_add_u32 v40, v3, 2, v59
    v_lshl_add_u32 v7, v40, 3, v7
    s_lshl_b32 s94, s97, 7
    s_add_u32 s92, s94, 18624
    v_add_u32 v44, s92, v7
    s_lshl_b32 s94, s97, 8
    s_add_u32 s94, s94, 16576
    v_add_u32 v7, s94, v7
    v_lshlrev_b32 v41, 4, v59
    s_nop 1
    v_mov_b32_dpp v40, v41 quad_perm:[0,2,1,3] row_mask:0xf bank_mask:0xf
    v_lshlrev_b32 v59, 2, v59
    v_lshrrev_b32 v41, 2, v1
    v_mul_u32_u24 v35, 0x8200, v41
    s_lshl_b32 s92, s88, 6
    s_and_b32 s93, s92, 0x1e00
    v_xad_u32 v35, v35, s93, v40
    s_lshl_b32 s93, s97, 4
    v_add_u32 v41, s93, v41
    v_mul_u32_u24 v45, 0x2080, v41
    v_xad_u32 v45, v45, s92, v40
    s_and_b32 s93, s97, 3
    s_mul_i32 s93, s93, 0x2080
    s_and_b32 s92, s92, 0x1c0
    s_xor_b32 s83, s92, s93
    s_lshr_b32 s93, s97, 2
    s_lshl_b32 s93, s93, 20
    s_add_u32 s83, s83, s93
    s_add_u32 s96, s83, 0x80000
    s_mov_b32 s80, 0x3f80
    s_mov_b32 s81, 0x3f800000
    s_mov_b32 s82, 0x3f803f80
    s_mov_b32 s98, 0x70007
    s_mov_b32 s99, 0x200000
    v_mov_b32 v40, 0
    v_mov_b32 v41, 0
    v_mov_b32 v42, 0x3ae38e39
    s_mov_b32 s72, s36
    s_mov_b32 s73, s37
    s_mov_b32 s74, 0x240000
    s_mov_b32 s75, 0x20000
    s_cmp_lt_u32 s97, 4
    s_cbranch_scc1 LN1A_71
    s_cmp_ge_u32 s41, 18
    s_cbranch_scc1 LN1A_71
    s_mov_b32 s68, s30
    s_mov_b32 s69, s31
    s_mov_b32 s70, 0x510000
    s_mov_b32 s71, 0x20000
    v_lshlrev_b32 v46, 4, v1
    s_mul_i32 s92, s89, 36864
    s_mul_i32 s93, s97, 9216
    s_add_u32 s92, s92, s93
    s_sub_u32 s92, s92, 36864
    s_add_u32 s93, s93, 72320
    s_add_u32 m0, s93, 0
    s_nop 0
    buffer_load_dwordx4 v46, s[68:71], s92 offen offset:0 nt lds
    buffer_load_dwordx4 v46, s[68:71], s92 offen offset:1024 nt lds
    buffer_load_dwordx4 v46, s[68:71], s92 offen offset:2048 nt lds
    buffer_load_dwordx4 v46, s[68:71], s92 offen offset:3072 nt lds
    s_add_u32 m0, s93, 4096
    s_add_u32 s92, s92, 4096
    buffer_load_dwordx4 v46, s[68:71], s92 offen offset:0 nt lds
    buffer_load_dwordx4 v46, s[68:71], s92 offen offset:1024 nt lds
    buffer_load_dwordx4 v46, s[68:71], s92 offen offset:2048 nt lds
    buffer_load_dwordx4 v46, s[68:71], s92 offen offset:3072 nt lds
    s_add_u32 m0, s93, 8192
    s_add_u32 s92, s92, 4096
    buffer_load_dwordx4 v46, s[68:71], s92 offen offset:0 nt lds
    s_waitcnt vmcnt(11)
    v_dot2c_f32_bf16 v40, s82, v26
    v_dot2c_f32_bf16 v41, v26, v26
    v_dot2c_f32_bf16 v40, s82, v27
    v_dot2c_f32_bf16 v41, v27, v27
    v_dot2c_f32_bf16 v40, s82, v28
    v_dot2c_f32_bf16 v41, v28, v28
    v_dot2c_f32_bf16 v40, s82, v29
    v_dot2c_f32_bf16 v41, v29, v29
    s_waitcnt vmcnt(10)
    v_dot2c_f32_bf16 v40, s82, v30
    v_dot2c_f32_bf16 v41, v30, v30
    v_dot2c_f32_bf16 v40, s82, v31
    v_dot2c_f32_bf16 v41, v31, v31
    v_dot2c_f32_bf16 v40, s82, v32
    v_dot2c_f32_bf16 v41, v32, v32
    v_dot2c_f32_bf16 v40, s82, v33
    v_dot2c_f32_bf16 v41, v33, v33
    s_waitcnt vmcnt(9)
    v_dot2c_f32_bf16 v40, s82, v34
    v_dot2c_f32_bf16 v41, v34, v34
    s_branch LN1B_72
LN1A_71:
    s_waitcnt vmcnt(2)
    v_dot2c_f32_bf16 v40, s82, v26
    v_dot2c_f32_bf16 v41, v26, v26
    v_dot2c_f32_bf16 v40, s82, v27
    v_dot2c_f32_bf16 v41, v27, v27
    v_dot2c_f32_bf16 v40, s82, v28
    v_dot2c_f32_bf16 v41, v28, v28
    v_dot2c_f32_bf16 v40, s82, v29
    v_dot2c_f32_bf16 v41, v29, v29
    s_waitcnt vmcnt(1)
    v_dot2c_f32_bf16 v40, s82, v30
    v_dot2c_f32_bf16 v41, v30, v30
    v_dot2c_f32_bf16 v40, s82, v31
    v_dot2c_f32_bf16 v41, v31, v31
    v_dot2c_f32_bf16 v40, s82, v32
    v_dot2c_f32_bf16 v41, v32, v32
    v_dot2c_f32_bf16 v40, s82, v33
    v_dot2c_f32_bf16 v41, v33, v33
    s_waitcnt vmcnt(0)
    v_dot2c_f32_bf16 v40, s82, v34
    v_dot2c_f32_bf16 v41, v34, v34
LN1B_72:
    s_nop 1
    v_add_f32_dpp v36, v40, v40 row_ror:8 row_mask:0xf bank_mask:0x3
    v_add_f32_dpp v36, v41, v41 row_ror:8 row_mask:0xf bank_mask:0xc
    s_nop 1
    v_add_f32_dpp v36, v36, v36 row_half_mirror row_mask:0xf bank_mask:0xf
    s_nop 1
    v_add_f32_dpp v36, v36, v36 quad_perm:[1,0,3,2] row_mask:0xf bank_mask:0xf
    s_nop 1
    v_add_f32_dpp v36, v36, v36 quad_perm:[2,3,0,1] row_mask:0xf bank_mask:0xf
    v_mov_b32 v37, v36
    s_nop 1
    v_permlane16_swap_b32 v36, v37
    v_add_f32 v36, v36, v37
    s_nop 1
    v_mul_f32_dpp v40, v36, v42 row_newbcast:0 row_mask:0xf bank_mask:0xf
    v_mul_f32_dpp v41, v36, v42 row_newbcast:8 row_mask:0xf bank_mask:0xf
    v_cvt_pk_bf16_f32 v36, 0, -v40
    v_fma_f32 v41, -v40, v40, v41
    v_dot2_f32_bf16 v8, v26, s80, v36
    v_dot2_f32_bf16 v9, v26, s81, v36
    v_max_f32 v41, 0, v41
    v_dot2_f32_bf16 v10, v27, s80, v36
    v_dot2_f32_bf16 v11, v27, s81, v36
    v_cvt_pk_bf16_f32 v41, 0, v41
    v_dot2_f32_bf16 v12, v28, s80, v36
    v_dot2_f32_bf16 v13, v28, s81, v36
    v_add_f32 v41, 0x3727c5ac, v41
    v_cvt_pk_bf16_f32 v8, 0, v8
    v_cvt_pk_bf16_f32 v9, 0, v9
    v_dot2_f32_bf16 v14, v29, s80, v36
    v_dot2_f32_bf16 v15, v29, s81, v36
    v_cvt_pk_bf16_f32 v41, 0, v41
    v_cvt_pk_bf16_f32 v10, 0, v10
    v_cvt_pk_bf16_f32 v11, 0, v11
    v_dot2_f32_bf16 v16, v30, s80, v36
    v_dot2_f32_bf16 v17, v30, s81, v36
    v_sqrt_f32 v41, v41
    v_cvt_pk_bf16_f32 v12, 0, v12
    v_cvt_pk_bf16_f32 v13, 0, v13
    v_dot2_f32_bf16 v18, v31, s80, v36
    v_dot2_f32_bf16 v19, v31, s81, v36
    v_cvt_pk_bf16_f32 v41, 0, v41
    v_cvt_pk_bf16_f32 v14, 0, v14
    v_cvt_pk_bf16_f32 v15, 0, v15
    v_dot2_f32_bf16 v20, v32, s80, v36
    v_dot2_f32_bf16 v21, v32, s81, v36
    v_rcp_f32 v38, v41
    v_cvt_pk_bf16_f32 v16, 0, v16
    v_cvt_pk_bf16_f32 v17, 0, v17
    v_dot2_f32_bf16 v22, v33, s80, v36
    v_dot2_f32_bf16 v23, v33, s81, v36
    v_cvt_pk_bf16_f32 v18, 0, v18
    v_cvt_pk_bf16_f32 v19, 0, v19
    v_dot2_f32_bf16 v24, v34, s80, v36
    v_dot2_f32_bf16 v25, v34, s81, v36
    v_cvt_pk_bf16_f32 v20, 0, v20
    v_cvt_pk_bf16_f32 v21, 0, v21
    v_cvt_pk_bf16_f32 v22, 0, v22
    v_cvt_pk_bf16_f32 v23, 0, v23
    v_pk_mul_f32 v[8:9], v[8:9], v[38:39] op_sel_hi:[1,0]
    v_cvt_pkrtz_f16_f32 v26, v8, v9
    v_add_u32 v26, 0x40004, v26
    v_cvt_pk_bf16_f32 v24, 0, v24
    v_cvt_pk_bf16_f32 v25, 0, v25
    v_pk_mul_f32 v[10:11], v[10:11], v[38:39] op_sel_hi:[1,0]
    v_cvt_pkrtz_f16_f32 v27, v10, v11
    v_add_u32 v27, 0x40004, v27
    ds_write2st64_b32 v6, v26, v27 offset0:0 offset1:1
    v_pk_mul_f32 v[12:13], v[12:13], v[38:39] op_sel_hi:[1,0]
    v_cvt_pkrtz_f16_f32 v28, v12, v13
    v_add_u32 v28, 0x40004, v28
    s_load_dwordx4 s[76:79], s[34:35], 0
    v_pk_mul_f32 v[14:15], v[14:15], v[38:39] op_sel_hi:[1,0]
    v_cvt_pkrtz_f16_f32 v29, v14, v15
    v_add_u32 v29, 0x40004, v29
    ds_write2st64_b32 v6, v28, v29 offset0:2 offset1:3
    v_pk_mul_f32 v[16:17], v[16:17], v[38:39] op_sel_hi:[1,0]
    v_cvt_pkrtz_f16_f32 v30, v16, v17
    v_add_u32 v30, 0x40004, v30
    v_pk_mul_f32 v[18:19], v[18:19], v[38:39] op_sel_hi:[1,0]
    v_cvt_pkrtz_f16_f32 v31, v18, v19
    v_add_u32 v31, 0x40004, v31
    ds_write2st64_b32 v6, v30, v31 offset0:4 offset1:5
    v_pk_mul_f32 v[20:21], v[20:21], v[38:39] op_sel_hi:[1,0]
    v_cvt_pkrtz_f16_f32 v32, v20, v21
    v_add_u32 v32, 0x40004, v32
    v_pk_mul_f32 v[22:23], v[22:23], v[38:39] op_sel_hi:[1,0]
    v_cvt_pkrtz_f16_f32 v33, v22, v23
    v_add_u32 v33, 0x40004, v33
    ds_write2st64_b32 v6, v32, v33 offset0:6 offset1:7
    v_pk_mul_f32 v[24:25], v[24:25], v[38:39] op_sel_hi:[1,0]
    v_cvt_pkrtz_f16_f32 v34, v24, v25
    v_add_u32 v34, 0x40004, v34
    ds_write_b32 v6, v34 offset:2048
    v_mov_b32 v6, s97
    ds_write_b8 v6, v5 offset:0
    s_waitcnt lgkmcnt(0)
    v_mov_b32 v58, s76
    v_mov_b32 v57, s77
    v_mov_b32 v56, s78
    v_mov_b32 v55, s79
    v_cmp_eq_u32 vcc, 4, v59
    s_nop 1
    v_cndmask_b32 v58, v58, v57, vcc
    v_cmp_eq_u32 vcc, 12, v59
    s_nop 1
    v_cndmask_b32 v56, v56, v55, vcc
    v_cmp_lt_u32 vcc, 4, v59
    s_nop 1
    v_cndmask_b32 v58, v58, v56, vcc
    s_waitcnt vmcnt(63)
DBP_73:
    v_cmp_eq_u32 vcc, 0, v58
    s_cbranch_vccz DBG_74
    s_sleep 1
    global_load_dword v58, v59, s[34:35] sc1
    s_sub_u32 s39, s39, 1
    s_cbranch_scc1 KS_ABORT
    s_waitcnt vmcnt(0)
    s_branch DBP_73
DBG_74:
    v_mov_b32_dpp v40, v58 quad_perm:[0,2,1,3] row_mask:0xf bank_mask:0xf
    v_lshrrev_b32 v41, 3, v40
    v_lshrrev_b32 v42, 6, v40
    v_lshrrev_b32 v43, 9, v40
W_75:
    ds_read_b64 v[20:21], v4 offset:0
    s_sub_u32 s39, s39, 1
    s_cbranch_scc1 KS_ABORT
    s_waitcnt lgkmcnt(0)
    v_and_b32 v20, v20, v21
    v_cmp_ne_u32 vcc, s84, v20
    s_cbranch_vccnz W_75
    ds_read_b64_tr_b16 v[20:21], v7 offset:0
    ds_read_b64_tr_b16 v[22:23], v7 offset:9472
    ds_read_b64_tr_b16 v[24:25], v7 offset:128
    ds_read_b64_tr_b16 v[26:27], v7 offset:9600
    ds_read_b64_tr_b16 v[28:29], v44 offset:0
    ds_read_b64_tr_b16 v[30:31], v44 offset:9472
    s_waitcnt lgkmcnt(4)
    v_bfi_b32 v20, s98, v40, v20
    v_bfi_b32 v21, s98, v41, v21
    v_bfi_b32 v22, s98, v42, v22
    v_bfi_b32 v23, s98, v43, v23
    buffer_store_dwordx4 v[20:23], v35, s[72:75], s83 offen sc1
    s_waitcnt lgkmcnt(2)
    v_bfi_b32 v24, s98, v40, v24
    v_bfi_b32 v25, s98, v41, v25
    v_bfi_b32 v26, s98, v42, v26
    v_bfi_b32 v27, s98, v43, v27
    buffer_store_dwordx4 v[24:27], v35, s[72:75], s96 offen sc1
    s_waitcnt lgkmcnt(0)
    s_cmp_ge_u32 s97, 4
    s_cbranch_scc1 KS_X4
    v_bfi_b32 v28, s98, v40, v28
    v_bfi_b32 v29, s98, v41, v29
    v_bfi_b32 v30, s98, v42, v30
    v_bfi_b32 v31, s98, v43, v31
    buffer_store_dwordx4 v[28:31], v45, s[72:75], s99 offen sc1
    ds_write_b8 v6, v5 offset:200
    ds_write_b32 v59, v58 offset:224
    v_lshrrev_b32 v57, 3, v58
    v_lshrrev_b32 v56, 6, v58
    v_lshrrev_b32 v55, 9, v58
    s_mov_b32 s87, 1
    s_branch KS_L2B
KS_L0:
    s_and_b32 s92, s41, 15
    s_lshl_b32 s93, s40, 4
    s_add_u32 s92, s92, s93
    v_and_b32 v59, 3, v1
    v_lshlrev_b32 v59, 2, v59
    s_lshl_b32 s96, s92, 6
    s_add_u32 s93, s96, 0xb00000
    v_add_u32 v7, s93, v59
    s_mul_i32 s93, s92, 18560
    s_add_u32 s93, s93, 0x600000
    v_lshlrev_b32 v6, 4, v0
    v_mov_b32 v12, -1
    v_mov_b32 v13, -1
    v_mov_b32 v14, -1
    v_mov_b32 v15, -1
    s_setprio 3
    v_mul_u32_u24 v16, 57, v1
    v_lshrrev_b32 v16, 9, v16
    v_mul_u32_u24 v17, 9, v16
    v_sub_u32 v17, v1, v17
    v_mul_u32_u24 v16, 9216, v16
    v_lshl_add_u32 v16, v17, 7, v16
    s_waitcnt lgkmcnt(0)
    s_add_u32 s68, s36, s93
    s_addc_u32 s69, s37, 0
    s_mov_b32 s70, 18560
    s_mov_b32 s71, 0x20000
    s_barrier
W_76:
    s_sleep 2
    ds_read_b32 v8, v4 offset:36
    s_sub_u32 s39, s39, 1
    s_cbranch_scc1 KS_ABORT
    s_waitcnt lgkmcnt(0)
    v_cmp_eq_u32 vcc, 0, v8
    s_cbranch_vccnz W_76
    s_mov_b32 s92, 0
    buffer_store_dwordx4 v[12:15], v6, s[68:71], s92 offen sc1
    s_mov_b32 s92, 4096
    buffer_store_dwordx4 v[12:15], v6, s[68:71], s92 offen sc1
    s_mov_b32 s92, 8192
    buffer_store_dwordx4 v[12:15], v6, s[68:71], s92 offen sc1
    s_mov_b32 s92, 12288
    buffer_store_dwordx4 v[12:15], v6, s[68:71], s92 offen sc1
    s_mov_b32 s92, 16384
    buffer_store_dwordx4 v[12:15], v6, s[68:71], s92 offen sc1
    global_load_dword v58, v59, s[34:35] sc1
    s_and_b32 s94, s41, 7
    s_lshl_b32 s95, s38, 3
    s_add_u32 s94, s94, s95
    s_bitcmp1_b32 s94, 0
    s_cselect_b32 s72, s28, s26
    s_cselect_b32 s73, s29, s27
    s_mov_b32 s74, 0x510000
    s_mov_b32 s75, 0x20000
    s_lshr_b32 s95, s94, 1
    s_mul_i32 s95, s95, 64512
    s_mul_i32 s96, s40, 1152
    s_add_u32 s95, s95, s96
    s_cmp_lt_u32 s41, 24
    s_cselect_b32 s74, 0, s74
    s_add_u32 s96, s95, 3419136
    s_cmp_ge_u32 s38, 4
    s_cselect_b32 s74, 0, s74
    buffer_load_dword v18, v16, s[72:75], s96 offen nt
    buffer_load_dword v18, v16, s[72:75], s96 offen sc1
    s_waitcnt vmcnt(2)
DBP_77:
    v_cmp_eq_u32 vcc, 0, v58
    s_cbranch_vccz DBG_78
    s_sleep 1
    global_load_dword v58, v59, s[34:35] sc1
    s_sub_u32 s39, s39, 1
    s_cbranch_scc1 KS_ABORT
    s_waitcnt vmcnt(0)
    s_branch DBP_77
DBG_78:
    ds_write_b32 v59, v58 offset:224
    s_mov_b64 exec, 1
    ds_add_rtn_u32 v8, v4, v5 offset:8
    s_mov_b64 exec, -1
    v_lshrrev_b32 v57, 3, v58
    v_lshrrev_b32 v56, 6, v58
    v_lshrrev_b32 v55, 9, v58
    s_waitcnt lgkmcnt(0)
    v_readfirstlane_b32 s92, v8
    s_cmp_lg_u32 s92, 3
    s_cbranch_scc1 KS_L2
    s_mov_b64 exec, 15
    global_store_dword v7, v58, s[36:37] sc1
    s_mov_b64 exec, -1
    s_and_b32 s94, s41, 7
    s_cmp_ge_u32 s41, 8
    s_cbranch_scc1 KS_L1C
    s_branch KS_L2
KS_L1C:
KS_L2:
    s_mov_b32 s87, 0
KS_L2B:
    s_mov_b32 s64, s36
    s_mov_b32 s65, s37
    s_mov_b32 s66, 0x240000
    s_mov_b32 s67, 0x20000
    v_lshrrev_b32 v7, 1, v1
    v_lshlrev_b32 v7, 6, v7
    v_and_b32 v10, 1, v1
    v_lshl_add_u32 v7, v10, 4, v7
    v_lshlrev_b32 v9, 4, v1
    s_lshl_b32 s92, s38, 11
    s_lshl_b32 s93, s90, 13
    s_add_u32 s93, s93, s92
    s_lshl_b32 s94, s90, 7
    s_and_b32 s95, s94, 0x380
    v_xor_b32 v13, s95, v9
    s_and_b32 s94, s94, 0x1c00
    s_xor_b32 s93, s93, s94
    s_xor_b32 s97, s93, 0x400
    s_lshl_b32 s95, s40, 3
    s_add_u32 s95, s95, s41
    s_add_u32 s95, s95, 488
    s_lshr_b32 s96, s95, 1
    s_lshl_b32 s96, s96, 13
    s_and_b32 s95, s95, 1
    s_lshl_b32 s95, s95, 5
    s_add_u32 s95, s95, s96
    s_add_u32 s95, s95, s92
    s_lshr_b32 s96, s96, 6
    s_and_b32 s94, s96, 0x780
    v_xor_b32 v7, s94, v7
    s_and_b32 s96, s96, 0x1800
    s_xor_b32 s95, s95, s96
    s_cmp_lt_u32 s41, 24
    s_cselect_b32 s95, 2359296, s95
    s_cselect_b32 s94, 0, 0x70007
    v_mov_b32_dpp v64, v58 quad_perm:[0,1,0,1] row_mask:0xf bank_mask:0xf
    v_mov_b32_dpp v65, v58 quad_perm:[2,3,2,3] row_mask:0xf bank_mask:0xf
    s_bitcmp1_b32 s41, 0
    s_cselect_b64 vcc, -1, 0
    v_cndmask_b32 v64, v64, v65, vcc
    v_and_b32 v60, 0x70007, v58
    v_and_b32 v61, 0x70007, v57
    v_and_b32 v62, 0x70007, v56
    v_and_b32 v63, 0x70007, v55
    v_lshrrev_b32 v67, 9, v64
    v_lshrrev_b32 v66, 6, v64
    v_lshrrev_b32 v65, 3, v64
    v_and_b32 v64, s94, v64
    v_and_b32 v65, s94, v65
    v_and_b32 v66, s94, v66
    v_and_b32 v67, s94, v67
    s_lshl_b32 s96, s38, 10
    s_add_u32 s96, s96, 3552
    v_bfe_u32 v11, v1, 1, 1
    v_mul_u32_u24 v11, 4672, v11
    v_lshl_add_u32 v11, v10, 4, v11
    v_lshrrev_b32 v10, 2, v1
    v_lshl_add_u32 v11, v10, 5, v11
    v_add_u32 v11, s96, v11
    v_add_u32 v10, s96, v9
    v_mov_b32 v116, s38
    s_add_u32 s92, s92, 0xb00000
    v_lshrrev_b32 v12, 2, v1
    v_lshl_add_u32 v12, v12, 6, v59
    v_add_u32 v12, s92, v12
    s_cmp_lt_u32 s41, 8
    s_cselect_b32 s94, 8, 8
    s_cmp_ge_u32 s41, 24
    s_cselect_b32 s94, 20, s94
    v_mov_b32 v14, s94
    s_setprio 0
    ds_write_b8 v116, v5 offset:204
W_79:
    s_sleep 2
    ds_read_b32 v8, v14 offset:64
    s_sub_u32 s39, s39, 1
    s_cbranch_scc1 KS_ABORT
    s_waitcnt lgkmcnt(0)
    v_cmp_ne_u32 vcc, s84, v8
    s_cbranch_vccnz W_79
    s_setprio 3
    s_branch UPE_81
UP_80:
    s_sleep 1
UPE_81:
    buffer_load_dwordx4 v[20:23], v13, s[64:67], s93 offen sc1
    buffer_load_dwordx4 v[24:27], v13, s[64:67], s97 offen sc1
    buffer_load_dwordx4 v[28:31], v7, s[64:67], s95 offen sc1
    s_sub_u32 s39, s39, 1
    s_cbranch_scc1 KS_ABORT
    s_waitcnt vmcnt(2)
    v_xor_b32 v20, v60, v20
    v_xor_b32 v21, v61, v21
    v_xor_b32 v22, v62, v22
    v_xor_b32 v23, v63, v23
    ds_write_b128 v11, v[20:23]
    v_or3_b32 v44, v20, v21, v21
    v_or3_b32 v44, v22, v23, v44
    s_waitcnt vmcnt(1)
    v_xor_b32 v24, v60, v24
    v_xor_b32 v25, v61, v25
    v_xor_b32 v26, v62, v26
    v_xor_b32 v27, v63, v27
    ds_write_b128 v11, v[24:27] offset:512
    v_or3_b32 v44, v24, v25, v44
    v_or3_b32 v44, v26, v27, v44
    s_waitcnt vmcnt(0)
    v_xor_b32 v28, v64, v28
    v_xor_b32 v29, v65, v29
    v_xor_b32 v30, v66, v30
    v_xor_b32 v31, v67, v31
    ds_write_b128 v10, v[28:31] offset:9344
    v_or3_b32 v44, v28, v29, v44
    v_or3_b32 v44, v30, v31, v44
    v_and_b32 v44, 0x70007, v44
    v_cmp_ne_u32 vcc, 0, v44
    s_cbranch_vccnz UP_80
    ds_write_b8 v116, v5 offset:16
    s_cmp_eq_u32 s38, 2
    s_cbranch_scc1 WJ2_84
    s_add_u32 s92, s38, 1
    s_lshr_b32 s92, s92, 2
    s_cmp_eq_u32 s38, 1
    s_cselect_b32 s92, 2, s92
    s_lshl_b32 s92, s92, 10
    v_lshl_add_u32 v10, v1, 4, s92
    v_add_u32 v11, 35840, v10
W_85:
    ds_read_b32 v12, v4 offset:16
    s_sub_u32 s39, s39, 1
    s_cbranch_scc1 KS_ABORT
    s_waitcnt lgkmcnt(0)
    v_cmp_ne_u32 vcc, s84, v12
    s_cbranch_vccnz W_85
    s_setprio 3
    ds_read_b128 v[20:23], v10 offset:3520
    ds_read_b128 v[24:27], v10 offset:3536
    ds_read_b64 v[28:29], v10 offset:3552
    ds_read_b128 v[32:35], v10 offset:8192
    ds_read_b128 v[36:39], v10 offset:8208
    ds_read_b64 v[40:41], v10 offset:8224
    ds_read_b128 v[44:47], v10 offset:12864
    ds_read_b128 v[48:51], v10 offset:12880
    ds_read_b64 v[52:53], v10 offset:12896
    s_cmp_eq_u32 s38, 1
    s_cbranch_scc1 WJ1_83
    ds_read_b32 v12, v4 offset:68
    s_waitcnt lgkmcnt(7)
    v_alignbit_b32 v57, v22, v21, 16
    v_alignbit_b32 v58, v23, v22, 16
    v_alignbit_b32 v59, v24, v23, 16
    v_alignbit_b32 v60, v25, v24, 16
    v_alignbit_b32 v61, v26, v25, 16
    v_alignbit_b32 v62, v27, v26, 16
    v_alignbit_b32 v63, v28, v27, 16
    v_alignbit_b32 v64, v29, v28, 16
    v_pk_add_f16 v66, v57, v22
    v_pk_add_f16 v67, v58, v23
    v_pk_add_f16 v68, v59, v24
    v_pk_add_f16 v69, v60, v25
    v_pk_add_f16 v70, v61, v26
    v_pk_add_f16 v71, v62, v27
    v_pk_add_f16 v72, v63, v28
    v_pk_add_f16 v73, v64, v29
    v_pk_add_f16 v80, v66, v58
    v_pk_add_f16 v81, v67, v59
    v_pk_add_f16 v82, v68, v60
    v_pk_add_f16 v83, v69, v61
    v_pk_add_f16 v74, v67, v68
    v_pk_add_f16 v75, v68, v69
    v_pk_add_f16 v76, v69, v70
    v_pk_add_f16 v77, v70, v71
    v_pk_add_f16 v78, v71, v72
    v_pk_add_f16 v79, v72, v73
    s_waitcnt lgkmcnt(0)
    v_cmp_eq_u32 vcc, s84, v12
    s_cbranch_vccnz WJK_86
W_87:
    s_sleep 1
    ds_read_b32 v12, v4 offset:68
    s_sub_u32 s39, s39, 1
    s_cbranch_scc1 KS_ABORT
    s_waitcnt lgkmcnt(0)
    v_cmp_ne_u32 vcc, s84, v12
    s_cbranch_vccnz W_87
WJK_86:
    ds_write_b128 v11, v[80:83] offset:0
    v_pk_add_f16 v87, v22, v74
    v_pk_add_f16 v88, v23, v75
    v_pk_add_f16 v89, v24, v76
    v_pk_add_f16 v90, v25, v77
    v_pk_add_f16 v91, v26, v78
    ds_write_b128 v11, v[88:91] offset:3104
    v_pk_add_f16 v84, v70, v62
    v_pk_add_f16 v85, v71, v63
    v_pk_add_f16 v86, v72, v64
    v_pk_add_f16 v92, v74, v83
    v_pk_add_f16 v93, v75, v84
    v_pk_add_f16 v94, v76, v85
    v_pk_add_f16 v95, v77, v86
    ds_write_b128 v11, v[92:95] offset:6176
    v_pk_add_f16 v96, v87, v76
    v_pk_add_f16 v97, v88, v77
    v_pk_add_f16 v98, v89, v78
    v_pk_add_f16 v99, v90, v79
    ds_write_b128 v11, v[96:99] offset:8240
    ds_write_b8 v116, v5 offset:76
    ds_read_b32 v12, v4 offset:84
    v_alignbit_b32 v57, v34, v33, 16
    v_alignbit_b32 v58, v35, v34, 16
    v_alignbit_b32 v59, v36, v35, 16
    v_alignbit_b32 v60, v37, v36, 16
    v_alignbit_b32 v61, v38, v37, 16
    v_alignbit_b32 v62, v39, v38, 16
    v_alignbit_b32 v63, v40, v39, 16
    v_alignbit_b32 v64, v41, v40, 16
    v_pk_add_f16 v66, v57, v34
    v_pk_add_f16 v67, v58, v35
    v_pk_add_f16 v68, v59, v36
    v_pk_add_f16 v69, v60, v37
    v_pk_add_f16 v70, v61, v38
    v_pk_add_f16 v71, v62, v39
    v_pk_add_f16 v72, v63, v40
    v_pk_add_f16 v73, v64, v41
    v_pk_add_f16 v80, v66, v58
    v_pk_add_f16 v81, v67, v59
    v_pk_add_f16 v82, v68, v60
    v_pk_add_f16 v83, v69, v61
    v_pk_add_f16 v74, v67, v68
    v_pk_add_f16 v75, v68, v69
    v_pk_add_f16 v76, v69, v70
    v_pk_add_f16 v77, v70, v71
    v_pk_add_f16 v78, v71, v72
    v_pk_add_f16 v79, v72, v73
    s_waitcnt lgkmcnt(0)
    v_cmp_eq_u32 vcc, s84, v12
    s_cbranch_vccnz WJK_88
W_89:
    s_sleep 1
    ds_read_b32 v12, v4 offset:84
    s_sub_u32 s39, s39, 1
    s_cbranch_scc1 KS_ABORT
    s_waitcnt lgkmcnt(0)
    v_cmp_ne_u32 vcc, s84, v12
    s_cbranch_vccnz W_89
WJK_88:
    ds_write_b128 v11, v[80:83] offset:36672
    v_pk_add_f16 v87, v34, v74
    v_pk_add_f16 v88, v35, v75
    v_pk_add_f16 v89, v36, v76
    v_pk_add_f16 v90, v37, v77
    v_pk_add_f16 v91, v38, v78
    ds_write_b128 v11, v[88:91] offset:39776
    v_pk_add_f16 v84, v70, v62
    v_pk_add_f16 v85, v71, v63
    v_pk_add_f16 v86, v72, v64
    v_pk_add_f16 v92, v74, v83
    v_pk_add_f16 v93, v75, v84
    v_pk_add_f16 v94, v76, v85
    v_pk_add_f16 v95, v77, v86
    ds_write_b128 v11, v[92:95] offset:42848
    v_pk_add_f16 v96, v87, v76
    v_pk_add_f16 v97, v88, v77
    v_pk_add_f16 v98, v89, v78
    v_pk_add_f16 v99, v90, v79
    ds_write_b128 v11, v[96:99] offset:44912
    ds_write_b8 v116, v5 offset:92
    s_cmp_lt_u32 s41, 24
    s_cbranch_scc1 WJE_82
    ds_read_b32 v12, v4 offset:100
    v_alignbit_b32 v57, v46, v45, 16
    v_alignbit_b32 v58, v47, v46, 16
    v_alignbit_b32 v59, v48, v47, 16
    v_alignbit_b32 v60, v49, v48, 16
    v_alignbit_b32 v61, v50, v49, 16
    v_alignbit_b32 v62, v51, v50, 16
    v_alignbit_b32 v63, v52, v51, 16
    v_alignbit_b32 v64, v53, v52, 16
    v_pk_add_f16 v66, v57, v46
    v_pk_add_f16 v67, v58, v47
    v_pk_add_f16 v68, v59, v48
    v_pk_add_f16 v69, v60, v49
    v_pk_add_f16 v70, v61, v50
    v_pk_add_f16 v71, v62, v51
    v_pk_add_f16 v72, v63, v52
    v_pk_add_f16 v73, v64, v53
    v_pk_add_f16 v80, v66, v58
    v_pk_add_f16 v81, v67, v59
    v_pk_add_f16 v82, v68, v60
    v_pk_add_f16 v83, v69, v61
    v_pk_add_f16 v74, v67, v68
    v_pk_add_f16 v75, v68, v69
    v_pk_add_f16 v76, v69, v70
    v_pk_add_f16 v77, v70, v71
    v_pk_add_f16 v78, v71, v72
    v_pk_add_f16 v79, v72, v73
    s_waitcnt lgkmcnt(0)
    v_cmp_eq_u32 vcc, s84, v12
    s_cbranch_vccnz WJK_90
W_91:
    s_sleep 1
    ds_read_b32 v12, v4 offset:100
    s_sub_u32 s39, s39, 1
    s_cbranch_scc1 KS_ABORT
    s_waitcnt lgkmcnt(0)
    v_cmp_ne_u32 vcc, s84, v12
    s_cbranch_vccnz W_91
WJK_90:
    v_add_u32 v11, 73344, v11
    ds_write_b128 v11, v[80:83] offset:0
    v_pk_add_f16 v87, v46, v74
    v_pk_add_f16 v88, v47, v75
    v_pk_add_f16 v89, v48, v76
    v_pk_add_f16 v90, v49, v77
    v_pk_add_f16 v91, v50, v78
    ds_write_b128 v11, v[88:91] offset:3104
    v_pk_add_f16 v84, v70, v62
    v_pk_add_f16 v85, v71, v63
    v_pk_add_f16 v86, v72, v64
    v_pk_add_f16 v92, v74, v83
    v_pk_add_f16 v93, v75, v84
    v_pk_add_f16 v94, v76, v85
    v_pk_add_f16 v95, v77, v86
    ds_write_b128 v11, v[92:95] offset:6176
    v_pk_add_f16 v96, v87, v76
    v_pk_add_f16 v97, v88, v77
    v_pk_add_f16 v98, v89, v78
    v_pk_add_f16 v99, v90, v79
    ds_write_b128 v11, v[96:99] offset:8240
    ds_write_b8 v116, v5 offset:108
    s_branch WJE_82
WJ1_83:
    ds_read_b32 v12, v4 offset:68
    s_waitcnt lgkmcnt(7)
    v_alignbit_b32 v57, v22, v21, 16
    v_alignbit_b32 v58, v23, v22, 16
    v_alignbit_b32 v59, v24, v23, 16
    v_alignbit_b32 v60, v25, v24, 16
    v_alignbit_b32 v61, v26, v25, 16
    v_alignbit_b32 v62, v27, v26, 16
    v_alignbit_b32 v63, v28, v27, 16
    v_pk_add_f16 v66, v57, v22
    v_pk_add_f16 v67, v58, v23
    v_pk_add_f16 v68, v59, v24
    v_pk_add_f16 v69, v60, v25
    v_pk_add_f16 v70, v61, v26
    v_pk_add_f16 v71, v62, v27
    v_pk_add_f16 v72, v63, v28
    v_pk_add_f16 v80, v66, v58
    v_pk_add_f16 v81, v67, v59
    v_pk_add_f16 v82, v68, v60
    v_pk_add_f16 v83, v69, v61
    v_pk_add_f16 v75, v68, v69
    v_pk_add_f16 v76, v69, v70
    v_pk_add_f16 v77, v70, v71
    v_pk_add_f16 v78, v71, v72
    s_waitcnt lgkmcnt(0)
    v_cmp_eq_u32 vcc, s84, v12
    s_cbranch_vccnz WJK_92
W_93:
    s_sleep 1
    ds_read_b32 v12, v4 offset:68
    s_sub_u32 s39, s39, 1
    s_cbranch_scc1 KS_ABORT
    s_waitcnt lgkmcnt(0)
    v_cmp_ne_u32 vcc, s84, v12
    s_cbranch_vccnz W_93
WJK_92:
    ds_write_b128 v11, v[80:83] offset:0
    v_pk_add_f16 v88, v23, v75
    v_pk_add_f16 v89, v24, v76
    v_pk_add_f16 v90, v25, v77
    v_pk_add_f16 v91, v26, v78
    ds_write_b128 v11, v[88:91] offset:3104
    ds_write_b8 v116, v5 offset:76
    ds_read_b32 v12, v4 offset:84
    v_alignbit_b32 v57, v34, v33, 16
    v_alignbit_b32 v58, v35, v34, 16
    v_alignbit_b32 v59, v36, v35, 16
    v_alignbit_b32 v60, v37, v36, 16
    v_alignbit_b32 v61, v38, v37, 16
    v_alignbit_b32 v62, v39, v38, 16
    v_alignbit_b32 v63, v40, v39, 16
    v_pk_add_f16 v66, v57, v34
    v_pk_add_f16 v67, v58, v35
    v_pk_add_f16 v68, v59, v36
    v_pk_add_f16 v69, v60, v37
    v_pk_add_f16 v70, v61, v38
    v_pk_add_f16 v71, v62, v39
    v_pk_add_f16 v72, v63, v40
    v_pk_add_f16 v80, v66, v58
    v_pk_add_f16 v81, v67, v59
    v_pk_add_f16 v82, v68, v60
    v_pk_add_f16 v83, v69, v61
    v_pk_add_f16 v75, v68, v69
    v_pk_add_f16 v76, v69, v70
    v_pk_add_f16 v77, v70, v71
    v_pk_add_f16 v78, v71, v72
    s_waitcnt lgkmcnt(0)
    v_cmp_eq_u32 vcc, s84, v12
    s_cbranch_vccnz WJK_94
W_95:
    s_sleep 1
    ds_read_b32 v12, v4 offset:84
    s_sub_u32 s39, s39, 1
    s_cbranch_scc1 KS_ABORT
    s_waitcnt lgkmcnt(0)
    v_cmp_ne_u32 vcc, s84, v12
    s_cbranch_vccnz W_95
WJK_94:
    ds_write_b128 v11, v[80:83] offset:36672
    v_pk_add_f16 v88, v35, v75
    v_pk_add_f16 v89, v36, v76
    v_pk_add_f16 v90, v37, v77
    v_pk_add_f16 v91, v38, v78
    ds_write_b128 v11, v[88:91] offset:39776
    ds_write_b8 v116, v5 offset:92
    s_cmp_lt_u32 s41, 24
    s_cbranch_scc1 WJE_82
    ds_read_b32 v12, v4 offset:100
    v_alignbit_b32 v57, v46, v45, 16
    v_alignbit_b32 v58, v47, v46, 16
    v_alignbit_b32 v59, v48, v47, 16
    v_alignbit_b32 v60, v49, v48, 16
    v_alignbit_b32 v61, v50, v49, 16
    v_alignbit_b32 v62, v51, v50, 16
    v_alignbit_b32 v63, v52, v51, 16
    v_pk_add_f16 v66, v57, v46
    v_pk_add_f16 v67, v58, v47
    v_pk_add_f16 v68, v59, v48
    v_pk_add_f16 v69, v60, v49
    v_pk_add_f16 v70, v61, v50
    v_pk_add_f16 v71, v62, v51
    v_pk_add_f16 v72, v63, v52
    v_pk_add_f16 v80, v66, v58
    v_pk_add_f16 v81, v67, v59
    v_pk_add_f16 v82, v68, v60
    v_pk_add_f16 v83, v69, v61
    v_pk_add_f16 v75, v68, v69
    v_pk_add_f16 v76, v69, v70
    v_pk_add_f16 v77, v70, v71
    v_pk_add_f16 v78, v71, v72
    s_waitcnt lgkmcnt(0)
    v_cmp_eq_u32 vcc, s84, v12
    s_cbranch_vccnz WJK_96
W_97:
    s_sleep 1
    ds_read_b32 v12, v4 offset:100
    s_sub_u32 s39, s39, 1
    s_cbranch_scc1 KS_ABORT
    s_waitcnt lgkmcnt(0)
    v_cmp_ne_u32 vcc, s84, v12
    s_cbranch_vccnz W_97
WJK_96:
    v_add_u32 v11, 73344, v11
    ds_write_b128 v11, v[80:83] offset:0
    v_pk_add_f16 v88, v47, v75
    v_pk_add_f16 v89, v48, v76
    v_pk_add_f16 v90, v49, v77
    v_pk_add_f16 v91, v50, v78
    ds_write_b128 v11, v[88:91] offset:3104
    ds_write_b8 v116, v5 offset:108
    s_branch WJE_82
WJ2_84:
    ds_write_b8 v116, v5 offset:76
    ds_write_b8 v116, v5 offset:92
    ds_write_b8 v116, v5 offset:108
    s_setprio 0
    v_mov_b32_dpp v32, v58 quad_perm:[0,0,0,0] row_mask:0xf bank_mask:0xf
    v_mov_b32_dpp v33, v58 quad_perm:[1,1,1,1] row_mask:0xf bank_mask:0xf
    v_mov_b32_dpp v34, v58 quad_perm:[2,2,2,2] row_mask:0xf bank_mask:0xf
    v_mov_b32_dpp v35, v58 quad_perm:[3,3,3,3] row_mask:0xf bank_mask:0xf
    v_lshlrev_b32 v12, 6, v1
    v_add_u32 v12, 0xb00800, v12
    v_mov_b32 v13, s84
    global_load_dwordx4 v[20:23], v12, s[36:37] offset:-2048 sc1
    global_load_dwordx4 v[24:27], v12, s[36:37] offset:2048 sc1
    s_sub_u32 s94, s41, 18
    s_and_b32 s94, s94, 31
    v_mul_u32_u24 v100, 57, v1
    v_lshrrev_b32 v100, 9, v100
    v_mul_u32_u24 v101, 9, v100
    v_sub_u32 v101, v1, v101
    v_mul_u32_u24 v100, 9216, v100
    v_lshl_add_u32 v100, v101, 7, v100
    s_bitcmp1_b32 s94, 0
    s_cselect_b32 s72, s28, s26
    s_cselect_b32 s73, s29, s27
    s_mov_b32 s74, 0x510000
    s_mov_b32 s75, 0x20000
    s_lshr_b32 s95, s94, 1
    s_mul_i32 s95, s95, 64512
    s_mul_i32 s96, s40, 1152
    s_add_u32 s95, s95, s96
    s_cmp_ge_u32 s94, 14
    s_cselect_b32 s74, 0, s74
W_100:
    s_sleep 1
    ds_read_b32 v102, v4 offset:16
    s_sub_u32 s39, s39, 1
    s_cbranch_scc1 KS_ABORT
    s_waitcnt lgkmcnt(0)
    v_cmp_ne_u32 vcc, s84, v102
    s_cbranch_vccnz W_100
    s_add_u32 s96, s95, 4451328
    buffer_load_dword v102, v100, s[72:75], s96 offen nt
    buffer_load_dword v102, v100, s[72:75], s96 offen sc1
    s_add_u32 s96, s95, 4902912
    buffer_load_dword v102, v100, s[72:75], s96 offen nt
    buffer_load_dword v102, v100, s[72:75], s96 offen sc1
    s_waitcnt vmcnt(4)
    s_branch FPE_99
FP_98:
    s_sleep 2
    global_load_dwordx4 v[20:23], v12, s[36:37] offset:-2048 sc1
    global_load_dwordx4 v[24:27], v12, s[36:37] offset:2048 sc1
    s_sub_u32 s39, s39, 1
    s_cbranch_scc1 KS_ABORT
    s_waitcnt vmcnt(0)
FPE_99:
    v_xor_b32 v20, v32, v20
    v_xor_b32 v21, v33, v21
    v_xor_b32 v22, v34, v22
    v_xor_b32 v23, v35, v23
    v_xor_b32 v24, v32, v24
    v_xor_b32 v25, v33, v25
    v_xor_b32 v26, v34, v26
    v_xor_b32 v27, v35, v27
    v_or3_b32 v20, v20, v21, v22
    v_or3_b32 v23, v23, v24, v25
    v_or3_b32 v20, v20, v26, v27
    v_or_b32 v20, v20, v23
    v_cmp_ne_u32 vcc, 0, v20
    s_cbranch_vccnz FP_98
    ds_write2_b32 v4, v13, v13 offset0:28 offset1:36
    s_branch WJE_82
    s_sub_u32 s94, s41, 18
    s_and_b32 s94, s94, 31
    s_cmp_ge_u32 s94, 14
    s_cbranch_scc1 WJE_82
    v_mul_u32_u24 v100, 57, v1
    v_lshrrev_b32 v100, 9, v100
    v_mul_u32_u24 v101, 9, v100
    v_sub_u32 v101, v1, v101
    v_mul_u32_u24 v100, 9216, v100
    v_lshl_add_u32 v100, v101, 7, v100
W_101:
    s_sleep 1
    ds_read_b32 v12, v4 offset:16
    s_sub_u32 s39, s39, 1
    s_cbranch_scc1 KS_ABORT
    s_waitcnt lgkmcnt(0)
    v_cmp_ne_u32 vcc, s84, v12
    s_cbranch_vccnz W_101
    s_bitcmp1_b32 s94, 0
    s_cselect_b32 s72, s28, s26
    s_cselect_b32 s73, s29, s27
    s_mov_b32 s74, 0x510000
    s_mov_b32 s75, 0x20000
    s_lshr_b32 s95, s94, 1
    s_mul_i32 s95, s95, 64512
    s_mul_i32 s96, s40, 1152
    s_add_u32 s95, s95, s96
    s_add_u32 s96, s95, 4451328
    buffer_load_dword v102, v100, s[72:75], s96 offen nt
    buffer_load_dword v102, v100, s[72:75], s96 offen sc1
    s_add_u32 s96, s95, 4902912
    buffer_load_dword v102, v100, s[72:75], s96 offen nt
    buffer_load_dword v102, v100, s[72:75], s96 offen sc1
KS_PF2D:
WJE_82:
    s_setprio 0
    s_lshr_b32 s92, s90, 6
    s_lshl_b32 s92, s92, 9
    s_bfe_u32 s93, s90, 0x20004
    s_lshl_b32 s93, s93, 6
    s_add_u32 s92, s92, s93
    s_and_b32 s93, s90, 3
    s_lshl_b32 s93, s93, 4
    s_add_u32 s92, s92, s93
    s_and_b32 s93, s90, 12
    s_add_u32 s92, s92, s93
    s_lshr_b32 s93, s38, 1
    s_lshl_b32 s93, s93, 8
    s_add_u32 s92, s92, s93
    s_and_b32 s93, s38, 1
    s_lshl_b32 s93, s93, 1
    s_add_u32 s92, s92, s93
    v_lshrrev_b32 v113, 5, v1
    v_and_b32 v114, 31, v1
    v_add_u32 v112, s92, v113
    v_mul_u32_u24 v115, 1152, v112
    v_lshl_add_u32 v8, v114, 2, v115
    v_lshl_add_u32 v115, v114, 4, v115
    v_lshlrev_b32 v7, 2, v114
    v_lshlrev_b32 v6, 4, v114
    v_bfe_u32 v111, v1, 3, 1
    v_add_u32 v111, s92, v111
    v_mul_u32_u24 v111, 1152, v111
    v_and_b32 v9, 7, v1
    v_lshl_add_u32 v111, v9, 4, v111
    s_mov_b32 s64, s4
    s_mov_b32 s65, s5
    s_mov_b32 s66, 0x240000
    s_mov_b32 s67, 0x20000
    s_mov_b32 s68, s24
    s_mov_b32 s69, s25
    s_mov_b32 s70, 0x480
    s_mov_b32 s71, 0x20000
    buffer_load_dwordx4 v[10:13], v115, s[64:67], 0 offen
    buffer_load_dwordx4 v[14:17], v115, s[64:67], 0 offen offset:512
    buffer_load_dword v18, v8, s[64:67], 0 offen offset:1024
    buffer_load_dwordx4 v[50:53], v6, s[68:71], 0 offen
    buffer_load_dwordx4 v[54:57], v6, s[68:71], 0 offen offset:512
    buffer_load_dword v58, v7, s[68:71], 0 offen offset:1024
KS_L4:
    s_add_u32 s64, s36, 0x600000
    s_addc_u32 s65, s37, 0
    s_mov_b32 s66, 0x240000
    s_mov_b32 s67, 0x20000
    s_mov_b32 s68, s32
    s_mov_b32 s69, s33
    s_mov_b32 s70, 0x240000
    s_mov_b32 s71, 0x20000
    s_mov_b32 s72, s36
    s_mov_b32 s73, s37
    s_mov_b32 s74, 0x240000
    s_mov_b32 s75, 0x20000
    s_add_u32 s76, s36, 0x840000
    s_addc_u32 s77, s37, 0
    s_mov_b32 s78, 0x4000
    s_mov_b32 s79, 0x20000
    s_not_b32 s93, s90
    v_xor_b32 v8, s93, v0
    v_lshrrev_b32 v6, 1, v0
    v_lshlrev_b32 v6, 6, v6
    v_and_b32 v8, 1, v8
    v_lshl_add_u32 v6, v8, 4, v6
    s_lshr_b32 s92, s90, 2
    s_lshl_b32 s92, s92, 15
    s_and_b32 s93, s90, 1
    s_lshl_b32 s93, s93, 14
    s_add_u32 s92, s92, s93
    s_and_b32 s93, s90, 2
    s_lshl_b32 s93, s93, 4
    s_add_u32 s92, s92, s93
    s_lshr_b32 s94, s90, 2
    s_lshl_b32 s94, s94, 12
    s_and_b32 s93, s90, 3
    s_lshl_b32 s93, s93, 4
    s_add_u32 s94, s94, s93
    s_lshl_b32 s93, s38, 10
    s_add_u32 s94, s94, s93
    s_add_u32 s94, s94, 0x200000
    v_lshlrev_b32 v9, 6, v2
    s_lshl_b32 s93, s90, 5
    s_and_b32 s95, s93, 0x1f80
    v_xor_b32 v6, s95, v6
    s_and_b32 s95, s93, 0x380
    v_xor_b32 v9, s95, v9
    s_and_b32 s95, s93, 0xc00
    s_xor_b32 s94, s94, s95
    s_and_b32 s93, s90, 1
    s_lshl_b32 s93, s93, 13
    s_xor_b32 s92, s92, s93
    s_xor_b32 s93, s92, 0x2000
    s_mul_i32 s95, s38, 2304
    s_add_u32 s95, s95, 17088
    v_lshl_add_u32 v117, v114, 5, s95
    v_lshl_add_u32 v110, v114, 3, s95
    s_lshl_b32 s95, s38, 9
    s_add_u32 s95, s95, 26368
    v_lshl_add_u32 v108, v1, 2, s95
    v_lshl_add_u32 v109, v1, 4, s95
    v_lshlrev_b32 v118, 4, v113
    s_movk_i32 s95, 0x3f80
    v_lshlrev_b32 v118, v118, s95
    v_lshlrev_b32 v8, 2, v0
    v_add_u32 v8, 17088, v8
    s_lshl_b32 s95, s38, 6
    s_add_u32 s95, s95, 19136
    v_lshl_add_u32 v119, v2, 2, s95
    s_waitcnt vmcnt(0)
    v_lshlrev_b32 v20, 16, v10
    v_and_b32 v21, 0xffff0000, v10
    v_lshlrev_b32 v22, 16, v11
    v_and_b32 v23, 0xffff0000, v11
    v_lshlrev_b32 v24, 16, v12
    v_and_b32 v25, 0xffff0000, v12
    v_lshlrev_b32 v26, 16, v13
    v_and_b32 v27, 0xffff0000, v13
    v_lshlrev_b32 v28, 16, v14
    v_and_b32 v29, 0xffff0000, v14
    v_lshlrev_b32 v30, 16, v15
    v_and_b32 v31, 0xffff0000, v15
    v_lshlrev_b32 v32, 16, v16
    v_and_b32 v33, 0xffff0000, v16
    v_lshlrev_b32 v34, 16, v17
    v_and_b32 v35, 0xffff0000, v17
    v_lshlrev_b32 v36, 16, v18
    v_and_b32 v37, 0xffff0000, v18
    v_lshlrev_b32 v80, 16, v50
    v_and_b32 v81, 0xffff0000, v50
    v_lshlrev_b32 v82, 16, v51
    v_and_b32 v83, 0xffff0000, v51
    v_lshlrev_b32 v84, 16, v52
    v_and_b32 v85, 0xffff0000, v52
    v_lshlrev_b32 v86, 16, v53
    v_and_b32 v87, 0xffff0000, v53
    v_lshlrev_b32 v88, 16, v54
    v_and_b32 v89, 0xffff0000, v54
    v_lshlrev_b32 v90, 16, v55
    v_and_b32 v91, 0xffff0000, v55
    v_lshlrev_b32 v92, 16, v56
    v_and_b32 v93, 0xffff0000, v56
    v_lshlrev_b32 v94, 16, v57
    v_and_b32 v95, 0xffff0000, v57
    v_lshlrev_b32 v96, 16, v58
    v_and_b32 v97, 0xffff0000, v58
    v_pk_add_f32 v[78:79], v[80:81], v[82:83]
    v_pk_add_f32 v[78:79], v[78:79], v[84:85]
    v_pk_add_f32 v[78:79], v[78:79], v[86:87]
    v_pk_add_f32 v[78:79], v[78:79], v[88:89]
    v_pk_add_f32 v[78:79], v[78:79], v[90:91]
    v_pk_add_f32 v[78:79], v[78:79], v[92:93]
    v_pk_add_f32 v[78:79], v[78:79], v[94:95]
    v_pk_add_f32 v[78:79], v[78:79], v[96:97]
    v_add_f32 v78, v78, v79
    s_nop 1
    v_add_f32_dpp v78, v78, v78 row_ror:8 row_mask:0xf bank_mask:0xf
    s_nop 1
    v_add_f32_dpp v78, v78, v78 row_ror:4 row_mask:0xf bank_mask:0xf
    s_nop 1
    v_add_f32_dpp v78, v78, v78 row_ror:2 row_mask:0xf bank_mask:0xf
    s_nop 1
    v_add_f32_dpp v78, v78, v78 row_ror:1 row_mask:0xf bank_mask:0xf
    v_mov_b32 v79, v78
    s_nop 1
    v_permlane16_swap_b32 v78, v79
    v_add_f32 v78, v78, v79
    v_sub_u32 v98, 0x87ff, v112
    v_lshl_add_u32 v99, v116, 1, v113
    v_lshlrev_b32 v99, 2, v99
    s_lshl_b32 s97, s90, 5
W_102:
    s_sleep 1
    ds_read_b32 v60, v4 offset:52
    s_sub_u32 s39, s39, 1
    s_cbranch_scc1 KS_ABORT
    s_waitcnt lgkmcnt(0)
    v_cmp_ne_u32 vcc, s84, v60
    s_cbranch_vccnz W_102
    s_setprio 3
    s_sub_u32 s95, s41, 8
    s_cmp_ge_u32 s95, 16
    s_cbranch_scc1 KS_ZGC
    s_branch ZPE_104
ZP_103:
    s_sleep 1
ZPE_104:
    buffer_load_dwordx4 v[68:71], v4, s[64:67], s94 offen sc1
    s_sub_u32 s39, s39, 1
    s_cbranch_scc1 KS_ABORT
    s_waitcnt vmcnt(0)
    v_max3_u32 v44, v68, v69, v70
    v_max_u32 v44, v44, v71
    v_cmp_eq_u32 vcc, -1, v44
    s_cbranch_vccnz ZP_103
KS_ZGC:
    s_branch ZPE_106
ZP_105:
    s_sleep 1
ZPE_106:
    buffer_load_dwordx4 v[60:63], v6, s[64:67], s92 offen sc1
    buffer_load_dwordx4 v[64:67], v6, s[64:67], s93 offen sc1
    buffer_load_dwordx4 v[68:71], v9, s[64:67], s94 offen sc1
    s_sub_u32 s39, s39, 1
    s_cbranch_scc1 KS_ABORT
    s_waitcnt vmcnt(2)
    ds_write2st64_b32 v8, v60, v61 offset0:0 offset1:9
    ds_write2st64_b32 v8, v62, v63 offset0:18 offset1:27
    v_max3_u32 v44, v60, v61, v61
    v_max3_u32 v44, v62, v63, v44
    s_waitcnt vmcnt(1)
    ds_write2st64_b32 v8, v64, v65 offset0:4 offset1:13
    ds_write2st64_b32 v8, v66, v67 offset0:22 offset1:31
    v_max3_u32 v44, v64, v65, v44
    v_max3_u32 v44, v66, v67, v44
    s_waitcnt vmcnt(0)
    ds_write2st64_b32 v119, v68, v69 offset0:0 offset1:9
    ds_write2st64_b32 v119, v70, v71 offset0:18 offset1:27
    v_max3_u32 v44, v68, v69, v44
    v_max3_u32 v44, v70, v71, v44
    v_cmp_eq_u32 vcc, -1, v44
    s_cbranch_vccnz ZP_105
    ds_write_b8 v116, v5 offset:20
ZW_107:
    ds_read_b32 v44, v4 offset:20
    ds_read_b128 v[60:63], v117 offset:0
    ds_read_b128 v[64:67], v117 offset:16
    ds_read_b128 v[68:71], v117 offset:1024
    ds_read_b128 v[72:75], v117 offset:1040
    ds_read_b64 v[76:77], v110 offset:2048
    s_sub_u32 s39, s39, 1
    s_cbranch_scc1 KS_ABORT
    s_waitcnt lgkmcnt(5)
    v_cmp_ne_u32 vcc, s84, v44
    s_cbranch_vccnz ZW_107
    s_waitcnt lgkmcnt(4)
    v_dot2c_f32_bf16 v20, v60, v118
    v_dot2c_f32_bf16 v21, v61, v118
    v_dot2c_f32_bf16 v22, v62, v118
    v_dot2c_f32_bf16 v23, v63, v118
    s_waitcnt lgkmcnt(3)
    v_dot2c_f32_bf16 v24, v64, v118
    v_dot2c_f32_bf16 v25, v65, v118
    v_pk_mul_f32 v[42:43], v[20:21], v[20:21]
    v_pk_mul_f32 v[44:45], v[20:21], v[80:81]
    v_dot2c_f32_bf16 v26, v66, v118
    v_dot2c_f32_bf16 v27, v67, v118
    v_pk_fma_f32 v[42:43], v[22:23], v[22:23], v[42:43]
    v_pk_fma_f32 v[44:45], v[22:23], v[82:83], v[44:45]
    v_pk_add_f32 v[40:41], v[22:23], v[20:21]
    s_waitcnt lgkmcnt(2)
    v_dot2c_f32_bf16 v28, v68, v118
    v_dot2c_f32_bf16 v29, v69, v118
    v_pk_fma_f32 v[42:43], v[24:25], v[24:25], v[42:43]
    v_pk_fma_f32 v[44:45], v[24:25], v[84:85], v[44:45]
    v_pk_add_f32 v[40:41], v[24:25], v[40:41]
    v_dot2c_f32_bf16 v30, v70, v118
    v_dot2c_f32_bf16 v31, v71, v118
    v_pk_fma_f32 v[42:43], v[26:27], v[26:27], v[42:43]
    v_pk_fma_f32 v[44:45], v[26:27], v[86:87], v[44:45]
    v_pk_add_f32 v[40:41], v[26:27], v[40:41]
    s_waitcnt lgkmcnt(1)
    v_dot2c_f32_bf16 v32, v72, v118
    v_dot2c_f32_bf16 v33, v73, v118
    v_pk_fma_f32 v[42:43], v[28:29], v[28:29], v[42:43]
    v_pk_fma_f32 v[44:45], v[28:29], v[88:89], v[44:45]
    v_pk_add_f32 v[40:41], v[28:29], v[40:41]
    v_dot2c_f32_bf16 v34, v74, v118
    v_dot2c_f32_bf16 v35, v75, v118
    v_pk_fma_f32 v[42:43], v[30:31], v[30:31], v[42:43]
    v_pk_fma_f32 v[44:45], v[30:31], v[90:91], v[44:45]
    v_pk_add_f32 v[40:41], v[30:31], v[40:41]
    s_waitcnt lgkmcnt(0)
    v_dot2c_f32_bf16 v36, v76, v118
    v_dot2c_f32_bf16 v37, v77, v118
    v_pk_fma_f32 v[42:43], v[32:33], v[32:33], v[42:43]
    v_pk_fma_f32 v[44:45], v[32:33], v[92:93], v[44:45]
    v_pk_add_f32 v[40:41], v[32:33], v[40:41]
    v_pk_fma_f32 v[42:43], v[34:35], v[34:35], v[42:43]
    v_pk_fma_f32 v[44:45], v[34:35], v[94:95], v[44:45]
    v_pk_add_f32 v[40:41], v[34:35], v[40:41]
    v_pk_fma_f32 v[42:43], v[36:37], v[36:37], v[42:43]
    v_pk_fma_f32 v[44:45], v[36:37], v[96:97], v[44:45]
    v_pk_add_f32 v[40:41], v[36:37], v[40:41]
    v_add_f32 v42, v42, v43
    v_add_f32 v44, v44, v45
    v_add_f32 v40, v40, v41
    v_mov_b32 v41, v40
    v_permlane16_swap_b32 v42, v44
    s_nop 0
    v_permlane16_swap_b32 v40, v41
    v_add_f32 v42, v42, v44
    v_add_f32 v40, v40, v41
    s_nop 0
    v_add_f32_dpp v42, v42, v42 row_ror:8 row_mask:0xf bank_mask:0xf
    v_add_f32_dpp v40, v40, v40 row_ror:8 row_mask:0xf bank_mask:0xf
    s_nop 0
    v_add_f32_dpp v42, v42, v42 row_ror:4 row_mask:0xf bank_mask:0xf
    v_add_f32_dpp v40, v40, v40 row_ror:4 row_mask:0xf bank_mask:0xf
    s_nop 0
    v_add_f32_dpp v42, v42, v42 row_ror:2 row_mask:0xf bank_mask:0xf
    v_add_f32_dpp v40, v40, v40 row_ror:2 row_mask:0xf bank_mask:0xf
    s_nop 0
    v_add_f32_dpp v42, v42, v42 row_ror:1 row_mask:0xf bank_mask:0xf
    v_add_f32_dpp v40, v40, v40 row_ror:1 row_mask:0xf bank_mask:0xf
    v_mul_f32 v40, 0x3ae38e39, v40
    v_mov_b32 v44, v42
    v_cvt_pk_bf16_f32 v41, 0, v40
    v_mul_f32 v40, v40, v40
    v_permlane16_swap_b32 v42, v44
    v_mov_b32 v43, 0x3ae38e39
    v_fma_f32 v42, v42, v43, -v40
    v_fma_f32 v44, -v41, v78, v44
    v_max_f32 v42, 0, v42
    v_cvt_pk_bf16_f32 v42, 0, v42
    v_add_f32 v42, 0x3727c5ac, v42
    v_cvt_pk_bf16_f32 v42, 0, v42
    v_sqrt_f32 v42, v42
    s_nop 0
    v_cvt_pk_bf16_f32 v42, 0, v42
    v_rcp_f32 v42, v42
    s_nop 0
    v_mul_f32 v60, v44, v42
    v_cvt_pk_bf16_f32 v60, v60, v60
    v_ashrrev_i32 v61, 31, v60
    v_or_b32 v61, 0x80000000, v61
    s_mov_b32 s95, 0xffff0000
    v_xor_b32 v60, v60, v61
    v_and_or_b32 v60, v60, s95, v98
    v_mov_b32 v61, v60
    s_nop 1
    v_permlane32_swap_b32 v60, v61
    s_mov_b64 exec, 1
    buffer_store_dwordx2 v[60:61], v99, s[76:79], s97 offen sc1
    ds_write_b8 v116, v5 offset:12
    s_mov_b64 exec, -1
    s_setprio 2
    v_cvt_pk_bf16_f32 v20, 0, v20
    v_cvt_pk_bf16_f32 v21, 0, v21
    v_cvt_pk_bf16_f32 v22, 0, v22
    v_cvt_pk_bf16_f32 v23, 0, v23
    v_cvt_pk_bf16_f32 v24, 0, v24
    v_cvt_pk_bf16_f32 v25, 0, v25
    v_cvt_pk_bf16_f32 v26, 0, v26
    v_cvt_pk_bf16_f32 v27, 0, v27
    v_cvt_pk_bf16_f32 v28, 0, v28
    v_cvt_pk_bf16_f32 v29, 0, v29
    v_cvt_pk_bf16_f32 v30, 0, v30
    v_cvt_pk_bf16_f32 v31, 0, v31
    v_cvt_pk_bf16_f32 v32, 0, v32
    v_cvt_pk_bf16_f32 v33, 0, v33
    v_cvt_pk_bf16_f32 v34, 0, v34
    v_cvt_pk_bf16_f32 v35, 0, v35
    v_cvt_pk_bf16_f32 v36, 0, v36
    v_cvt_pk_bf16_f32 v37, 0, v37
    v_pk_add_f32 v[44:45], v[20:21], v[22:23]
    v_pk_add_f32 v[46:47], v[24:25], v[26:27]
    v_pk_add_f32 v[44:45], v[44:45], v[28:29]
    v_pk_add_f32 v[46:47], v[46:47], v[30:31]
    v_pk_add_f32 v[44:45], v[44:45], v[32:33]
    v_pk_add_f32 v[46:47], v[46:47], v[34:35]
    v_pk_add_f32 v[44:45], v[44:45], v[36:37]
    v_pk_add_f32 v[44:45], v[44:45], v[46:47]
    v_add_f32 v44, v44, v45
    s_nop 1
    v_add_f32_dpp v44, v44, v44 row_ror:8 row_mask:0xf bank_mask:0xf
    s_nop 1
    v_add_f32_dpp v44, v44, v44 row_ror:4 row_mask:0xf bank_mask:0xf
    s_nop 1
    v_add_f32_dpp v44, v44, v44 row_ror:2 row_mask:0xf bank_mask:0xf
    s_nop 1
    v_add_f32_dpp v44, v44, v44 row_ror:1 row_mask:0xf bank_mask:0xf
    v_mov_b32 v46, v44
    s_nop 1
    v_permlane16_swap_b32 v44, v46
    v_add_f32 v44, v44, v46
    v_mul_f32 v48, 0x3ae38e39, v44
    v_mov_b32 v49, v48
    v_cvt_pk_bf16_f32 v40, 0, v48
    v_cvt_pk_bf16_f32 v41, 0, v48
    v_pk_add_f32 v[42:43], v[20:21], v[48:49] neg_lo:[0,1] neg_hi:[0,1]
    v_pk_mul_f32 v[44:45], v[42:43], v[42:43]
    v_pk_add_f32 v[42:43], v[22:23], v[48:49] neg_lo:[0,1] neg_hi:[0,1]
    v_pk_mul_f32 v[46:47], v[42:43], v[42:43]
    v_pk_add_f32 v[42:43], v[24:25], v[48:49] neg_lo:[0,1] neg_hi:[0,1]
    v_pk_fma_f32 v[44:45], v[42:43], v[42:43], v[44:45]
    v_pk_add_f32 v[42:43], v[26:27], v[48:49] neg_lo:[0,1] neg_hi:[0,1]
    v_pk_fma_f32 v[46:47], v[42:43], v[42:43], v[46:47]
    v_pk_add_f32 v[42:43], v[28:29], v[48:49] neg_lo:[0,1] neg_hi:[0,1]
    v_pk_fma_f32 v[44:45], v[42:43], v[42:43], v[44:45]
    v_pk_add_f32 v[42:43], v[30:31], v[48:49] neg_lo:[0,1] neg_hi:[0,1]
    v_pk_fma_f32 v[46:47], v[42:43], v[42:43], v[46:47]
    v_pk_add_f32 v[42:43], v[32:33], v[48:49] neg_lo:[0,1] neg_hi:[0,1]
    v_pk_fma_f32 v[44:45], v[42:43], v[42:43], v[44:45]
    v_pk_add_f32 v[42:43], v[34:35], v[48:49] neg_lo:[0,1] neg_hi:[0,1]
    v_pk_fma_f32 v[46:47], v[42:43], v[42:43], v[46:47]
    v_pk_add_f32 v[42:43], v[36:37], v[48:49] neg_lo:[0,1] neg_hi:[0,1]
    v_pk_fma_f32 v[44:45], v[42:43], v[42:43], v[44:45]
    v_pk_add_f32 v[44:45], v[44:45], v[46:47]
    v_add_f32 v44, v44, v45
    s_nop 1
    v_add_f32_dpp v44, v44, v44 row_ror:8 row_mask:0xf bank_mask:0xf
    s_nop 1
    v_add_f32_dpp v44, v44, v44 row_ror:4 row_mask:0xf bank_mask:0xf
    s_nop 1
    v_add_f32_dpp v44, v44, v44 row_ror:2 row_mask:0xf bank_mask:0xf
    s_nop 1
    v_add_f32_dpp v44, v44, v44 row_ror:1 row_mask:0xf bank_mask:0xf
    v_mov_b32 v46, v44
    s_nop 1
    v_permlane16_swap_b32 v44, v46
    v_add_f32 v44, v44, v46
    v_mul_f32 v44, 0x3ae38e39, v44
    v_cvt_pk_bf16_f32 v44, 0, v44
    v_add_f32 v44, 0x3727c5ac, v44
    v_cvt_pk_bf16_f32 v44, 0, v44
    v_sqrt_f32 v44, v44
    s_nop 0
    v_cvt_pk_bf16_f32 v44, 0, v44
    v_rcp_f32 v42, v44
    s_nop 0
    v_mov_b32 v43, v42
    v_pk_add_f32 v[44:45], v[20:21], v[40:41] neg_lo:[0,1] neg_hi:[0,1]
    v_cvt_pk_bf16_f32 v44, 0, v44
    v_cvt_pk_bf16_f32 v45, 0, v45
    v_pk_mul_f32 v[44:45], v[44:45], v[42:43]
    v_cvt_pk_bf16_f32 v10, v44, v45
    v_cvt_pk_bf16_f32 v44, 0, v44
    v_cvt_pk_bf16_f32 v45, 0, v45
    v_pk_add_f32 v[20:21], v[44:45], v[20:21]
    v_pk_add_f32 v[44:45], v[22:23], v[40:41] neg_lo:[0,1] neg_hi:[0,1]
    v_cvt_pk_bf16_f32 v44, 0, v44
    v_cvt_pk_bf16_f32 v45, 0, v45
    v_pk_mul_f32 v[44:45], v[44:45], v[42:43]
    v_cvt_pk_bf16_f32 v11, v44, v45
    v_cvt_pk_bf16_f32 v44, 0, v44
    v_cvt_pk_bf16_f32 v45, 0, v45
    v_pk_add_f32 v[22:23], v[44:45], v[22:23]
    v_pk_add_f32 v[44:45], v[24:25], v[40:41] neg_lo:[0,1] neg_hi:[0,1]
    v_cvt_pk_bf16_f32 v44, 0, v44
    v_cvt_pk_bf16_f32 v45, 0, v45
    v_pk_mul_f32 v[44:45], v[44:45], v[42:43]
    v_cvt_pk_bf16_f32 v12, v44, v45
    v_cvt_pk_bf16_f32 v44, 0, v44
    v_cvt_pk_bf16_f32 v45, 0, v45
    v_pk_add_f32 v[24:25], v[44:45], v[24:25]
    v_pk_add_f32 v[44:45], v[26:27], v[40:41] neg_lo:[0,1] neg_hi:[0,1]
    v_cvt_pk_bf16_f32 v44, 0, v44
    v_cvt_pk_bf16_f32 v45, 0, v45
    v_pk_mul_f32 v[44:45], v[44:45], v[42:43]
    v_cvt_pk_bf16_f32 v13, v44, v45
    v_cvt_pk_bf16_f32 v44, 0, v44
    v_cvt_pk_bf16_f32 v45, 0, v45
    v_pk_add_f32 v[26:27], v[44:45], v[26:27]
    v_pk_add_f32 v[44:45], v[28:29], v[40:41] neg_lo:[0,1] neg_hi:[0,1]
    v_cvt_pk_bf16_f32 v44, 0, v44
    v_cvt_pk_bf16_f32 v45, 0, v45
    v_pk_mul_f32 v[44:45], v[44:45], v[42:43]
    v_cvt_pk_bf16_f32 v14, v44, v45
    v_cvt_pk_bf16_f32 v44, 0, v44
    v_cvt_pk_bf16_f32 v45, 0, v45
    v_pk_add_f32 v[28:29], v[44:45], v[28:29]
    v_pk_add_f32 v[44:45], v[30:31], v[40:41] neg_lo:[0,1] neg_hi:[0,1]
    v_cvt_pk_bf16_f32 v44, 0, v44
    v_cvt_pk_bf16_f32 v45, 0, v45
    v_pk_mul_f32 v[44:45], v[44:45], v[42:43]
    v_cvt_pk_bf16_f32 v15, v44, v45
    v_cvt_pk_bf16_f32 v44, 0, v44
    v_cvt_pk_bf16_f32 v45, 0, v45
    v_pk_add_f32 v[30:31], v[44:45], v[30:31]
    v_pk_add_f32 v[44:45], v[32:33], v[40:41] neg_lo:[0,1] neg_hi:[0,1]
    v_cvt_pk_bf16_f32 v44, 0, v44
    v_cvt_pk_bf16_f32 v45, 0, v45
    v_pk_mul_f32 v[44:45], v[44:45], v[42:43]
    v_cvt_pk_bf16_f32 v16, v44, v45
    v_cvt_pk_bf16_f32 v44, 0, v44
    v_cvt_pk_bf16_f32 v45, 0, v45
    v_pk_add_f32 v[32:33], v[44:45], v[32:33]
    v_pk_add_f32 v[44:45], v[34:35], v[40:41] neg_lo:[0,1] neg_hi:[0,1]
    v_cvt_pk_bf16_f32 v44, 0, v44
    v_cvt_pk_bf16_f32 v45, 0, v45
    v_pk_mul_f32 v[44:45], v[44:45], v[42:43]
    v_cvt_pk_bf16_f32 v17, v44, v45
    v_cvt_pk_bf16_f32 v44, 0, v44
    v_cvt_pk_bf16_f32 v45, 0, v45
    v_pk_add_f32 v[34:35], v[44:45], v[34:35]
    v_pk_add_f32 v[44:45], v[36:37], v[40:41] neg_lo:[0,1] neg_hi:[0,1]
    v_cvt_pk_bf16_f32 v44, 0, v44
    v_cvt_pk_bf16_f32 v45, 0, v45
    v_pk_mul_f32 v[44:45], v[44:45], v[42:43]
    v_cvt_pk_bf16_f32 v18, v44, v45
    v_cvt_pk_bf16_f32 v44, 0, v44
    v_cvt_pk_bf16_f32 v45, 0, v45
    v_pk_add_f32 v[36:37], v[44:45], v[36:37]
    v_cvt_pk_bf16_f32 v58, v36, v37
    ds_write_b32 v108, v18
    ds_write_b32 v108, v58 offset:256
    ds_read_b128 v[64:67], v109
    buffer_store_dwordx4 v[10:13], v115, s[72:75], 0 offen sc1
    buffer_store_dwordx4 v[14:17], v115, s[72:75], 0 offen offset:512 sc1
    v_cvt_pk_bf16_f32 v50, v20, v21
    v_cvt_pk_bf16_f32 v51, v22, v23
    v_cvt_pk_bf16_f32 v52, v24, v25
    v_cvt_pk_bf16_f32 v53, v26, v27
    v_cvt_pk_bf16_f32 v54, v28, v29
    v_cvt_pk_bf16_f32 v55, v30, v31
    v_cvt_pk_bf16_f32 v56, v32, v33
    v_cvt_pk_bf16_f32 v57, v34, v35
    s_mov_b64 exec, 0xffff
    s_waitcnt lgkmcnt(0)
    buffer_store_dwordx4 v[64:67], v111, s[72:75], 0 offen offset:1024 sc1
    s_mov_b64 exec, -1
    s_setprio 0
    s_add_u32 s80, s36, 0x850000
    s_addc_u32 s81, s37, 0
    s_mov_b32 s82, 0x148800
    s_mov_b32 s83, 0x20000
    v_bfe_u32 v16, v1, 2, 2
    v_lshl_add_u32 v16, v3, 3, v16
    v_mul_u32_u24 v16, 1152, v16
    v_and_b32 v17, 3, v1
    v_lshl_add_u32 v16, v17, 3, v16
    s_lshl_b32 s10, s38, 7
    s_add_u32 s11, s10, 109184
    v_add_u32 v16, s11, v16
    v_lshrrev_b32 v18, 2, v1
    v_mul_u32_u24 v18, 9344, v18
    v_lshl_add_u32 v18, v17, 4, v18
    s_mul_i32 s9, s38, 149504
    s_lshl_b32 s11, s89, 6
    s_add_u32 s9, s9, s11
    v_lshl_add_u32 v19, v17, 5, s10
    v_lshl_add_u32 v19, v3, 3, v19
    s_mul_i32 s8, s89, 9344
    s_lshl_b32 s11, s38, 10
    s_add_u32 s8, s8, s11
    s_movk_i32 s10, 0x3f80
    s_mov_b32 s11, 0x3f800000
    v_mov_b32 v28, 0
    v_mov_b32 v29, 0
    v_lshlrev_b32 v17, 4, v1
    s_cmp_ge_u32 s41, 18
    s_cbranch_scc1 KS_LO
W_108:
    s_sleep 2
    ds_read_b32 v20, v4 offset:40
    s_sub_u32 s39, s39, 1
    s_cbranch_scc1 KS_ABORT
    s_waitcnt lgkmcnt(0)
    v_cmp_ne_u32 vcc, s84, v20
    s_cbranch_vccnz W_108
    ds_read_b64_tr_b16 v[80:81], v16 offset:0
    ds_read_b64_tr_b16 v[82:83], v16 offset:4608
    ds_read_b64_tr_b16 v[84:85], v16 offset:32
    ds_read_b64_tr_b16 v[86:87], v16 offset:4640
    ds_read_b64_tr_b16 v[88:89], v16 offset:64
    ds_read_b64_tr_b16 v[90:91], v16 offset:4672
    ds_read_b64_tr_b16 v[92:93], v16 offset:96
    ds_read_b64_tr_b16 v[94:95], v16 offset:4704
    v_and_b32 v16, 7, v2
    v_lshlrev_b32 v16, 6, v16
    v_lshl_add_u32 v16, v3, 4, v16
    s_mul_i32 s92, s89, 9344
    s_add_u32 s92, s92, 0x850000
    s_add_u32 s64, s36, s92
    s_addc_u32 s65, s37, 0
    s_cmp_lt_u32 s41, 18
    s_cselect_b32 s66, 9216, 0
    s_mov_b32 s67, 0x20000
    s_mul_i32 s92, s38, 3072
    v_lshlrev_b32 v8, 4, v1
    v_mov_b32 v60, -1
    v_mov_b32 v61, -1
    v_mov_b32 v62, -1
    v_mov_b32 v63, -1
    buffer_store_dwordx4 v[60:63], v8, s[64:67], s92 offen offset:0 sc1
    buffer_store_dwordx4 v[60:63], v8, s[64:67], s92 offen offset:1024 sc1
    buffer_store_dwordx4 v[60:63], v8, s[64:67], s92 offen offset:2048 sc1
    s_waitcnt vmcnt(0)
    s_mov_b64 exec, 1
    ds_add_rtn_u32 v62, v4, v5 offset:196
    s_lshl_b32 s92, s2, 4
    s_add_u32 s92, s92, 8192
    s_waitcnt lgkmcnt(0)
    v_cmp_eq_u32 vcc, 3, v62
    s_and_b64 exec, exec, vcc
    s_cbranch_execz NOF_109
    buffer_store_dword v5, v4, s[76:79], s92 offen sc1
NOF_109:
    s_mov_b64 exec, -1
    s_sleep 16
    s_branch KS_LO2
KS_LO:
    s_sleep 8
    s_waitcnt vmcnt(0)
    s_mov_b64 exec, 1
    ds_add_rtn_u32 v62, v4, v5 offset:196
    s_lshl_b32 s92, s2, 4
    s_add_u32 s92, s92, 8192
    s_waitcnt lgkmcnt(0)
    v_cmp_eq_u32 vcc, 3, v62
    s_and_b64 exec, exec, vcc
    s_cbranch_execz NOF_110
    buffer_store_dword v5, v4, s[76:79], s92 offen sc1
NOF_110:
    s_mov_b64 exec, -1
    s_sleep 24
KS_LO2:
    s_mov_b64 exec, 0xffff0000
    buffer_store_dwordx4 v[64:67], v111, s[68:71], 0 offen offset:1024 sc1
    s_mov_b64 exec, -1
    buffer_store_dwordx4 v[50:53], v115, s[68:71], 0 offen sc1
    buffer_store_dwordx4 v[54:57], v115, s[68:71], 0 offen offset:512 sc1
    s_setprio 2
    s_waitcnt vmcnt(0)
    s_mov_b64 exec, 1
    ds_add_rtn_u32 v62, v4, v5 offset:176
    s_lshl_b32 s92, s2, 4
    s_add_u32 s92, s92, 12288
    s_waitcnt lgkmcnt(0)
    v_cmp_eq_u32 vcc, 3, v62
    s_and_b64 exec, exec, vcc
    s_cbranch_execz NOF_111
    buffer_store_dword v5, v4, s[76:79], s92 offen sc1
NOF_111:
    s_mov_b64 exec, -1
    s_cmp_lt_u32 s41, 18
    s_cbranch_scc1 KS_B
    s_waitcnt lgkmcnt(0)
    s_endpgm
KS_T:
    s_setprio 0
    s_cmp_ge_u32 s38, 10
    s_cbranch_scc1 KS_PEND
    s_add_u32 s76, s36, 0x840000
    s_addc_u32 s77, s37, 0
    s_mov_b32 s78, 0x4000
    s_mov_b32 s79, 0x20000
    s_cmp_eq_u32 s38, 9
    s_cbranch_scc1 KS_W9
    s_add_u32 s80, s36, 0x850000
    s_addc_u32 s81, s37, 0
    s_mov_b32 s82, 0x148800
    s_mov_b32 s83, 0x20000
    v_bfe_u32 v16, v1, 2, 2
    v_lshl_add_u32 v16, v3, 3, v16
    v_mul_u32_u24 v16, 1152, v16
    v_and_b32 v17, 3, v1
    v_lshl_add_u32 v16, v17, 3, v16
    s_lshl_b32 s10, s38, 7
    s_add_u32 s11, s10, 109184
    v_add_u32 v16, s11, v16
    v_lshrrev_b32 v18, 2, v1
    v_mul_u32_u24 v18, 9344, v18
    v_lshl_add_u32 v18, v17, 4, v18
    s_mul_i32 s9, s38, 149504
    s_lshl_b32 s11, s89, 6
    s_add_u32 s9, s9, s11
    v_lshl_add_u32 v19, v17, 5, s10
    v_lshl_add_u32 v19, v3, 3, v19
    s_mul_i32 s8, s89, 9344
    s_lshl_b32 s11, s38, 10
    s_add_u32 s8, s8, s11
    s_movk_i32 s10, 0x3f80
    s_mov_b32 s11, 0x3f800000
    v_mov_b32 v28, 0
    v_mov_b32 v29, 0
    v_lshlrev_b32 v17, 4, v1
    s_mov_b32 s72, s36
    s_mov_b32 s73, s37
    s_mov_b32 s74, 0x240000
    s_mov_b32 s75, 0x20000
    v_and_b32 v6, 1, v1
    v_and_b32 v7, 1, v3
    v_lshl_add_u32 v6, v7, 1, v6
    v_lshlrev_b32 v6, 2, v6
    ds_read_b32 v8, v6 offset:224
    s_lshl_b32 s92, s38, 11
    s_add_u32 s92, s92, 8896
    v_add_u32 v12, s92, v17
    s_waitcnt lgkmcnt(0)
    v_lshrrev_b32 v9, 3, v8
    v_lshrrev_b32 v10, 6, v8
    v_lshrrev_b32 v11, 9, v8
    s_cmp_eq_u32 s38, 8
    s_cbranch_scc1 KS_L2W
W_112:
    s_sleep 2
    ds_read_b32 v20, v4 offset:40
    s_sub_u32 s39, s39, 1
    s_cbranch_scc1 KS_ABORT
    s_waitcnt lgkmcnt(0)
    v_cmp_ne_u32 vcc, s84, v20
    s_cbranch_vccnz W_112
    ds_read_b64_tr_b16 v[80:81], v16 offset:0
    ds_read_b64_tr_b16 v[82:83], v16 offset:4608
    ds_read_b64_tr_b16 v[84:85], v16 offset:32
    ds_read_b64_tr_b16 v[86:87], v16 offset:4640
    ds_read_b64_tr_b16 v[88:89], v16 offset:64
    ds_read_b64_tr_b16 v[90:91], v16 offset:4672
    ds_read_b64_tr_b16 v[92:93], v16 offset:96
    ds_read_b64_tr_b16 v[94:95], v16 offset:4704
    v_and_b32 v16, 7, v2
    v_lshlrev_b32 v16, 6, v16
    v_lshl_add_u32 v16, v3, 4, v16
W_113:
    s_sleep 2
    ds_read_b32 v20, v4 offset:768
    s_sub_u32 s39, s39, 1
    s_cbranch_scc1 KS_ABORT
    s_waitcnt lgkmcnt(0)
    v_cmp_eq_u32 vcc, 0, v20
    s_cbranch_vccnz W_113
    s_setprio 1
W_114:
    s_sleep 1
    ds_read_b32 v20, v4 offset:32
    s_sub_u32 s39, s39, 1
    s_cbranch_scc1 KS_ABORT
    s_waitcnt lgkmcnt(0)
    v_cmp_eq_u32 vcc, 0, v20
    s_cbranch_vccnz W_114
    ds_read_b128 v[20:23], v12
    ds_read_b128 v[24:27], v12 offset:1024
    s_waitcnt lgkmcnt(1)
    v_xor_b32 v13, v8, v20
    v_bitop3_b32 v13, v13, v9, v21 bitop3:0xf6
    v_bitop3_b32 v13, v13, v10, v22 bitop3:0xf6
    v_bitop3_b32 v13, v13, v11, v23 bitop3:0xf6
    v_and_b32 v13, 0x70007, v13
    s_waitcnt lgkmcnt(0)
    v_xor_b32 v14, v8, v24
    v_bitop3_b32 v14, v14, v9, v25 bitop3:0xf6
    v_bitop3_b32 v14, v14, v10, v26 bitop3:0xf6
    v_bitop3_b32 v14, v14, v11, v27 bitop3:0xf6
    v_and_b32 v14, 0x70007, v14
    v_min_u32 v13, v13, v14
KS_CK:
    v_cmp_eq_u32 vcc, 0, v13
    s_cbranch_vccz KS_B
    ds_write_b32 v4, v5 offset:24
    s_branch KS_B
KS_L2W:
    s_movk_i32 s92, 4096
    s_movk_i32 s96, -1152
    s_mov_b32 s93, 0
    v_mov_b32 v57, 0
    v_and_b32 v41, 1, v1
    v_lshl_add_u32 v41, v3, 1, v41
    v_lshlrev_b32 v41, 4, v41
    v_add_u32 v41, 2358144, v41
    v_lshlrev_b32 v7, 1, v1
    v_and_b32 v7, 28, v7
W_115:
    s_sleep 2
    ds_read_b32 v20, v4 offset:20
    s_sub_u32 s39, s39, 1
    s_cbranch_scc1 KS_ABORT
    s_waitcnt lgkmcnt(0)
    v_cmp_ne_u32 vcc, s84, v20
    s_cbranch_vccnz W_115
    s_setprio 3
W_116:
    s_sleep 1
    ds_read_b32 v20, v4 offset:12
    s_sub_u32 s39, s39, 1
    s_cbranch_scc1 KS_ABORT
    s_waitcnt lgkmcnt(0)
    v_cmp_ne_u32 vcc, s84, v20
    s_cbranch_vccnz W_116
    s_setprio 3
    s_sleep 27
    s_branch KS_Q1
KS_Q0:
    s_sleep 1
KS_Q1:
    buffer_load_dwordx4 v[96:99], v17, s[76:79], 0 offen offset:0 sc1
    buffer_load_dwordx4 v[100:103], v17, s[76:79], 0 offen offset:1024 sc1
    buffer_load_dwordx4 v[104:107], v17, s[76:79], 0 offen offset:2048 sc1
    buffer_load_dwordx4 v[108:111], v17, s[76:79], 0 offen offset:3072 sc1
    buffer_load_dwordx4 v[112:115], v17, s[76:79], s92 offen offset:0 sc1
    buffer_load_dwordx4 v[116:119], v17, s[76:79], s92 offen offset:1024 sc1
    buffer_load_dwordx4 v[120:123], v17, s[76:79], s92 offen offset:2048 sc1
    buffer_load_dwordx4 v[124:127], v17, s[76:79], s92 offen offset:3072 sc1
    s_sub_u32 s39, s39, 1
    s_cbranch_scc1 KS_ABORT
    s_waitcnt vmcnt(7)
    v_max_u32 v42, v96, v97
    v_max_u32 v44, v98, v99
    v_min_u32 v43, v96, v97
    v_min_u32 v45, v98, v99
    s_waitcnt vmcnt(6)
    v_med3_u32 v46, v42, v100, v101
    v_med3_u32 v47, v44, v102, v103
    v_max3_u32 v42, v42, v100, v101
    v_max3_u32 v44, v44, v102, v103
    v_max_u32 v43, v43, v46
    v_max_u32 v45, v45, v47
    s_waitcnt vmcnt(5)
    v_med3_u32 v46, v42, v104, v105
    v_med3_u32 v47, v44, v106, v107
    v_max3_u32 v42, v42, v104, v105
    v_max3_u32 v44, v44, v106, v107
    v_max_u32 v43, v43, v46
    v_max_u32 v45, v45, v47
    s_waitcnt vmcnt(4)
    v_med3_u32 v46, v42, v108, v109
    v_med3_u32 v47, v44, v110, v111
    v_max3_u32 v42, v42, v108, v109
    v_max3_u32 v44, v44, v110, v111
    v_max_u32 v43, v43, v46
    v_max_u32 v45, v45, v47
    s_waitcnt vmcnt(3)
    v_med3_u32 v46, v42, v112, v113
    v_med3_u32 v47, v44, v114, v115
    v_max3_u32 v42, v42, v112, v113
    v_max3_u32 v44, v44, v114, v115
    v_max_u32 v43, v43, v46
    v_max_u32 v45, v45, v47
    s_waitcnt vmcnt(2)
    v_med3_u32 v46, v42, v116, v117
    v_med3_u32 v47, v44, v118, v119
    v_max3_u32 v42, v42, v116, v117
    v_max3_u32 v44, v44, v118, v119
    v_max_u32 v43, v43, v46
    v_max_u32 v45, v45, v47
    s_waitcnt vmcnt(1)
    v_med3_u32 v46, v42, v120, v121
    v_med3_u32 v47, v44, v122, v123
    v_max3_u32 v42, v42, v120, v121
    v_max3_u32 v44, v44, v122, v123
    v_max_u32 v43, v43, v46
    v_max_u32 v45, v45, v47
    v_max_u32 v43, v43, v45
    s_waitcnt vmcnt(0)
    v_med3_u32 v46, v42, v124, v125
    v_med3_u32 v47, v44, v126, v127
    v_max3_u32 v42, v42, v124, v125
    v_max3_u32 v44, v44, v126, v127
    v_max3_u32 v43, v43, v46, v47
    v_max_u32 v48, v42, v44
    v_med3_u32 v49, v42, v44, v43
    v_cmp_eq_u32 vcc, -1, v48
    v_mov_b32 v56, v49
KS_QN:
    v_max_u32_dpp v50, v49, v48 row_half_mirror row_mask:0xf bank_mask:0x5
    v_max_u32_dpp v51, v48, v49 row_half_mirror row_mask:0xf bank_mask:0x5
    v_min_u32_dpp v50, v49, v48 row_half_mirror row_mask:0xf bank_mask:0xa
    v_min_u32_dpp v51, v48, v49 row_half_mirror row_mask:0xf bank_mask:0xa
    s_cbranch_vccnz KS_Q0
    s_cmp_eq_u32 s93, 1
    s_mov_b32 m0, 17088
    v_min_u32 v53, v50, v51
    v_max_u32 v52, v50, v51
    s_nop 1
    v_max_u32_dpp v50, v53, v52 row_mirror row_mask:0xf bank_mask:0x3
    v_max_u32_dpp v51, v52, v53 row_mirror row_mask:0xf bank_mask:0x3
    v_min_u32_dpp v50, v53, v52 row_mirror row_mask:0xf bank_mask:0xc
    v_min_u32_dpp v51, v52, v53 row_mirror row_mask:0xf bank_mask:0xc
    s_nop 0
    v_max_u32_dpp v52, v50, v50 row_half_mirror row_mask:0xf bank_mask:0x5
    v_max_u32_dpp v53, v51, v51 row_half_mirror row_mask:0xf bank_mask:0x5
    v_min_u32_dpp v52, v50, v50 row_half_mirror row_mask:0xf bank_mask:0xa
    v_min_u32_dpp v53, v51, v51 row_half_mirror row_mask:0xf bank_mask:0xa
    v_max_u32 v48, v52, v53
    v_max_u32 v54, v52, v53
    v_min_u32 v49, v52, v53
    v_min_u32 v55, v52, v53
    v_permlane32_swap_b32 v48, v54
    s_nop 0
    v_permlane32_swap_b32 v49, v55
    s_nop 1
    v_max_u32_dpp v51, v54, v49 row_mirror row_mask:0xf bank_mask:0xf
    v_max_u32_dpp v50, v55, v48 row_mirror row_mask:0xf bank_mask:0xf
    s_nop 1
    v_max_u32_dpp v52, v50, v50 row_ror:8 row_mask:0xf bank_mask:0x3
    v_max_u32_dpp v53, v51, v51 row_ror:8 row_mask:0xf bank_mask:0x3
    v_min_u32_dpp v52, v50, v50 row_ror:8 row_mask:0xf bank_mask:0xc
    v_min_u32_dpp v53, v51, v51 row_ror:8 row_mask:0xf bank_mask:0xc
    s_nop 0
    v_max_u32_dpp v50, v52, v52 row_half_mirror row_mask:0xf bank_mask:0x5
    v_max_u32_dpp v51, v53, v53 row_half_mirror row_mask:0xf bank_mask:0x5
    v_min_u32_dpp v50, v52, v52 row_half_mirror row_mask:0xf bank_mask:0xa
    v_min_u32_dpp v51, v53, v53 row_half_mirror row_mask:0xf bank_mask:0xa
    v_max_u32 v48, v50, v51
    v_max_u32 v54, v50, v51
    v_min_u32 v49, v50, v51
    v_min_u32 v55, v50, v51
    v_permlane16_swap_b32 v48, v54
    s_nop 0
    v_permlane16_swap_b32 v49, v55
    s_nop 1
    v_max_u32_dpp v51, v54, v49 row_mirror row_mask:0xf bank_mask:0xf
    v_max_u32_dpp v50, v55, v48 row_mirror row_mask:0xf bank_mask:0xf
    s_nop 1
    v_max_u32_dpp v52, v50, v50 row_ror:8 row_mask:0xf bank_mask:0x3
    v_max_u32_dpp v53, v51, v51 row_ror:8 row_mask:0xf bank_mask:0x3
    v_min_u32_dpp v52, v50, v50 row_ror:8 row_mask:0xf bank_mask:0xc
    v_min_u32_dpp v53, v51, v51 row_ror:8 row_mask:0xf bank_mask:0xc
    s_nop 0
    v_max_u32_dpp v50, v52, v52 row_half_mirror row_mask:0xf bank_mask:0x5
    v_max_u32_dpp v51, v53, v53 row_half_mirror row_mask:0xf bank_mask:0x5
    v_min_u32_dpp v50, v52, v52 row_half_mirror row_mask:0xf bank_mask:0xa
    v_min_u32_dpp v51, v53, v53 row_half_mirror row_mask:0xf bank_mask:0xa
    v_min_u32 v49, v50, v51
    v_max_u32 v48, v50, v51
    s_nop 0
    v_mov_b32_dpp v55, v49 row_mirror row_mask:0xf bank_mask:0xf
    v_mov_b32_dpp v54, v48 row_mirror row_mask:0xf bank_mask:0xf
    s_nop 0
    v_max_u32_dpp v50, v55, v48 quad_perm:[1,0,3,2] row_mask:0xf bank_mask:0xf
    v_max_u32_dpp v51, v54, v49 quad_perm:[1,0,3,2] row_mask:0xf bank_mask:0xf
    s_nop 0
    v_max_u32_dpp v52, v50, v50 row_ror:8 row_mask:0xf bank_mask:0x3
    v_max_u32_dpp v53, v51, v51 row_ror:8 row_mask:0xf bank_mask:0x3
    v_min_u32_dpp v52, v50, v50 row_ror:8 row_mask:0xf bank_mask:0xc
    v_min_u32_dpp v53, v51, v51 row_ror:8 row_mask:0xf bank_mask:0xc
    s_nop 0
    v_max_u32_dpp v50, v52, v52 row_half_mirror row_mask:0xf bank_mask:0x5
    v_max_u32_dpp v51, v53, v53 row_half_mirror row_mask:0xf bank_mask:0x5
    v_min_u32_dpp v50, v52, v52 row_half_mirror row_mask:0xf bank_mask:0xa
    v_min_u32_dpp v51, v53, v53 row_half_mirror row_mask:0xf bank_mask:0xa
    v_min_u32 v49, v50, v51
    v_max_u32 v48, v50, v51
    s_nop 0
    v_mov_b32_dpp v55, v49 row_mirror row_mask:0xf bank_mask:0xf
    s_nop 1
    v_max_u32_dpp v59, v55, v48 quad_perm:[2,3,0,1] row_mask:0xf bank_mask:0xf
    s_cbranch_scc1 KS_QF2
    v_and_b32 v61, 0x7ff, v59
    v_mad_i32_i24 v61, v61, s96, v41
    buffer_load_dwordx4 v61, s[72:75], 0 offen offset:0 sc1 lds
    s_mov_b32 m0, 17984
    s_nop 0
    buffer_load_dwordx4 v61, s[72:75], 0 offen offset:128 sc1 lds
    s_mov_b32 m0, 18880
    s_nop 0
    buffer_load_dwordx4 v61, s[72:75], 0 offen offset:256 sc1 lds
    s_mov_b32 m0, 19776
    s_nop 0
    buffer_load_dwordx4 v61, s[72:75], 0 offen offset:384 sc1 lds
    s_mov_b32 m0, 20672
    s_nop 0
    buffer_load_dwordx4 v61, s[72:75], 0 offen offset:512 sc1 lds
    s_mov_b32 m0, 21568
    s_nop 0
    buffer_load_dwordx4 v61, s[72:75], 0 offen offset:640 sc1 lds
    s_mov_b32 m0, 22464
    s_nop 0
    buffer_load_dwordx4 v61, s[72:75], 0 offen offset:768 sc1 lds
    s_mov_b32 m0, 23360
    s_nop 0
    buffer_load_dwordx4 v61, s[72:75], 0 offen offset:896 sc1 lds
    s_mov_b32 m0, 24256
    s_nop 0
    buffer_load_dwordx4 v61, s[72:75], 0 offen offset:1024 sc1 lds
    v_sub_u32 v96, v96, v56
    v_min_u32_dpp v60, v59, v59 quad_perm:[2,3,0,1] row_mask:0xf bank_mask:0xf
    v_sub_u32 v97, v97, v56
    v_sub_u32 v98, v98, v56
    v_max3_u32 v47, v96, v97, v98
    v_sub_u32 v99, v99, v56
    v_sub_u32 v100, v100, v56
    v_min_u32_dpp v60, v60, v60 row_half_mirror row_mask:0xf bank_mask:0xf
    v_max3_u32 v47, v47, v99, v100
    v_sub_u32 v101, v101, v56
    v_sub_u32 v102, v102, v56
    v_max3_u32 v47, v47, v101, v102
    v_sub_u32 v103, v103, v56
    v_sub_u32 v104, v104, v56
    v_min_u32_dpp v60, v60, v60 row_ror:8 row_mask:0xf bank_mask:0xf
    v_max3_u32 v47, v47, v103, v104
    v_sub_u32 v105, v105, v56
    v_sub_u32 v106, v106, v56
    v_max3_u32 v47, v47, v105, v106
    v_sub_u32 v107, v107, v56
    v_sub_u32 v108, v108, v56
    v_max3_u32 v47, v47, v107, v108
    v_sub_u32 v109, v109, v56
    v_sub_u32 v110, v110, v56
    v_max3_u32 v47, v47, v109, v110
    v_sub_u32 v111, v111, v56
    v_sub_u32 v112, v112, v56
    v_max3_u32 v47, v47, v111, v112
    v_sub_u32 v113, v113, v56
    v_sub_u32 v114, v114, v56
    v_max3_u32 v47, v47, v113, v114
    v_sub_u32 v115, v115, v56
    v_sub_u32 v116, v116, v56
    v_max3_u32 v47, v47, v115, v116
    v_sub_u32 v117, v117, v56
    v_sub_u32 v118, v118, v56
    v_max3_u32 v47, v47, v117, v118
    v_sub_u32 v119, v119, v56
    v_sub_u32 v120, v120, v56
    v_max3_u32 v47, v47, v119, v120
    v_sub_u32 v121, v121, v56
    v_sub_u32 v122, v122, v56
    v_max3_u32 v47, v47, v121, v122
    v_sub_u32 v123, v123, v56
    v_sub_u32 v124, v124, v56
    v_max3_u32 v47, v47, v123, v124
    v_sub_u32 v125, v125, v56
    v_sub_u32 v126, v126, v56
    v_max3_u32 v47, v47, v125, v126
    v_sub_u32 v127, v127, v56
    v_add_u32 v57, v57, v56
    v_max_u32 v47, v47, v127
    v_add_u32 v47, v47, v57
    v_cmp_gt_u32 vcc, v47, v60
    s_cbranch_vccnz KS_QF1
    ds_write_b32 v7, v59 offset:768
W_117:
    s_sleep 2
    ds_read_b32 v20, v4 offset:40
    s_sub_u32 s39, s39, 1
    s_cbranch_scc1 KS_ABORT
    s_waitcnt lgkmcnt(0)
    v_cmp_ne_u32 vcc, s84, v20
    s_cbranch_vccnz W_117
    ds_read_b64_tr_b16 v[80:81], v16 offset:0
    ds_read_b64_tr_b16 v[82:83], v16 offset:4608
    ds_read_b64_tr_b16 v[84:85], v16 offset:32
    ds_read_b64_tr_b16 v[86:87], v16 offset:4640
    ds_read_b64_tr_b16 v[88:89], v16 offset:64
    ds_read_b64_tr_b16 v[90:91], v16 offset:4672
    ds_read_b64_tr_b16 v[92:93], v16 offset:96
    ds_read_b64_tr_b16 v[94:95], v16 offset:4704
    v_and_b32 v16, 7, v2
    v_lshlrev_b32 v16, 6, v16
    v_lshl_add_u32 v16, v3, 4, v16
    s_waitcnt vmcnt(0)
    ds_write_b32 v4, v5 offset:32
    s_setprio 1
    ds_read_b128 v[20:23], v12
    s_waitcnt lgkmcnt(0)
    v_xor_b32 v13, v8, v20
    v_bitop3_b32 v13, v13, v9, v21 bitop3:0xf6
    v_bitop3_b32 v13, v13, v10, v22 bitop3:0xf6
    v_bitop3_b32 v13, v13, v11, v23 bitop3:0xf6
    v_and_b32 v13, 0x70007, v13
    s_branch KS_CK
KS_QF1:
    s_sub_u32 s39, s39, 1
    s_cbranch_scc1 KS_ABORT
    v_mov_b32 v58, v59
    v_max_u32 v42, v96, v97
    v_max_u32 v44, v98, v99
    v_min_u32 v43, v96, v97
    v_min_u32 v45, v98, v99
    v_med3_u32 v46, v42, v100, v101
    v_med3_u32 v47, v44, v102, v103
    v_max3_u32 v42, v42, v100, v101
    v_max3_u32 v44, v44, v102, v103
    v_max_u32 v43, v43, v46
    v_max_u32 v45, v45, v47
    v_med3_u32 v46, v42, v104, v105
    v_med3_u32 v47, v44, v106, v107
    v_max3_u32 v42, v42, v104, v105
    v_max3_u32 v44, v44, v106, v107
    v_max_u32 v43, v43, v46
    v_max_u32 v45, v45, v47
    v_med3_u32 v46, v42, v108, v109
    v_med3_u32 v47, v44, v110, v111
    v_max3_u32 v42, v42, v108, v109
    v_max3_u32 v44, v44, v110, v111
    v_max_u32 v43, v43, v46
    v_max_u32 v45, v45, v47
    v_med3_u32 v46, v42, v112, v113
    v_med3_u32 v47, v44, v114, v115
    v_max3_u32 v42, v42, v112, v113
    v_max3_u32 v44, v44, v114, v115
    v_max_u32 v43, v43, v46
    v_max_u32 v45, v45, v47
    v_med3_u32 v46, v42, v116, v117
    v_med3_u32 v47, v44, v118, v119
    v_max3_u32 v42, v42, v116, v117
    v_max3_u32 v44, v44, v118, v119
    v_max_u32 v43, v43, v46
    v_max_u32 v45, v45, v47
    v_med3_u32 v46, v42, v120, v121
    v_med3_u32 v47, v44, v122, v123
    v_max3_u32 v42, v42, v120, v121
    v_max3_u32 v44, v44, v122, v123
    v_max_u32 v43, v43, v46
    v_max_u32 v45, v45, v47
    v_max_u32 v43, v43, v45
    v_med3_u32 v46, v42, v124, v125
    v_med3_u32 v47, v44, v126, v127
    v_max3_u32 v42, v42, v124, v125
    v_max3_u32 v44, v44, v126, v127
    v_max3_u32 v43, v43, v46, v47
    v_max_u32 v48, v42, v44
    v_med3_u32 v56, v42, v44, v43
    v_add_u32 v48, v48, v57
    v_add_u32 v49, v56, v57
    s_mov_b32 s93, 1
    s_mov_b64 vcc, 0
    s_nop 2
    s_branch KS_QN
KS_QF2:
    v_mov_b32 v48, 0
    v_mov_b32 v49, 0
    s_mov_b64 exec, 0x5555
    v_max_u32 v48, v59, v58
    v_min_u32 v49, v59, v58
    s_mov_b64 exec, -1
    s_mov_b32 s93, 2
    s_mov_b64 vcc, 0
    s_waitcnt vmcnt(0)
    s_nop 5
    s_branch KS_QN
KS_BR:
    s_mov_b64 exec, -1
    s_cmp_lg_u32 s38, 8
    s_cbranch_scc1 KS_BR1
    s_movk_i32 s92, 0x2000
    s_nop 7
    s_branch ZPE_119
ZP_118:
    s_sleep 2
ZPE_119:
    buffer_load_dword v20, v17, s[76:79], s92 offen offset:0 sc1
    buffer_load_dword v21, v17, s[76:79], s92 offen offset:1024 sc1
    buffer_load_dword v22, v17, s[76:79], s92 offen offset:2048 sc1
    buffer_load_dword v23, v17, s[76:79], s92 offen offset:3072 sc1
    s_sub_u32 s39, s39, 1
    s_cbranch_scc1 KS_ABORT
    s_waitcnt vmcnt(0)
    v_max3_u32 v44, v20, v21, v22
    v_max_u32 v44, v44, v23
    v_cmp_eq_u32 vcc, -1, v44
    s_cbranch_vccnz ZP_118
    s_mov_b32 m0, 17088
    s_nop 0
    buffer_load_dwordx4 v61, s[72:75], 0 offen offset:0 sc1 lds
    s_mov_b32 m0, 17984
    s_nop 0
    buffer_load_dwordx4 v61, s[72:75], 0 offen offset:128 sc1 lds
    s_mov_b32 m0, 18880
    s_nop 0
    buffer_load_dwordx4 v61, s[72:75], 0 offen offset:256 sc1 lds
    s_mov_b32 m0, 19776
    s_nop 0
    buffer_load_dwordx4 v61, s[72:75], 0 offen offset:384 sc1 lds
    s_mov_b32 m0, 20672
    s_nop 0
    buffer_load_dwordx4 v61, s[72:75], 0 offen offset:512 sc1 lds
    s_mov_b32 m0, 21568
    s_nop 0
    buffer_load_dwordx4 v61, s[72:75], 0 offen offset:640 sc1 lds
    s_mov_b32 m0, 22464
    s_nop 0
    buffer_load_dwordx4 v61, s[72:75], 0 offen offset:768 sc1 lds
    s_mov_b32 m0, 23360
    s_nop 0
    buffer_load_dwordx4 v61, s[72:75], 0 offen offset:896 sc1 lds
    s_mov_b32 m0, 24256
    s_nop 0
    buffer_load_dwordx4 v61, s[72:75], 0 offen offset:1024 sc1 lds
    s_waitcnt vmcnt(0)
    s_barrier
    ds_write_b32 v4, v4 offset:24
    s_branch KS_B
KS_BR1:
    s_barrier
    s_branch KS_B
KS_W9:
    v_lshlrev_b32 v33, 4, v1
    s_movk_i32 s92, 0x2000
    v_and_b32 v7, 7, v1
    v_lshlrev_b32 v7, 2, v7
    s_add_u32 s64, s36, 0x600000
    s_addc_u32 s65, s37, 0
    s_mov_b32 s66, 0x240000
    s_mov_b32 s67, 0x20000
    s_mov_b32 s68, s4
    s_mov_b32 s69, s5
    s_mov_b32 s70, 0x240000
    s_mov_b32 s71, 0x20000
    v_bfe_u32 v43, v1, 3, 2
    s_lshl_b32 s93, s89, 2
    v_add_u32 v43, s93, v43
    v_bfe_u32 v40, v43, 4, 1
    v_and_b32 v41, 3, v1
    v_lshl_add_u32 v40, v40, 2, v41
    v_lshlrev_b32 v40, 2, v40
    v_and_b32 v41, 0x3cf, v43
    v_bfe_u32 v42, v43, 5, 1
    v_lshl_add_u32 v41, v42, 4, v41
    v_bfe_u32 v42, v1, 2, 1
    v_lshl_add_u32 v41, v42, 5, v41
    v_lshrrev_b32 v42, 4, v41
    v_lshlrev_b32 v42, 8, v42
    v_lshl_add_u32 v42, v40, 3, v42
    v_and_b32 v43, 15, v41
    v_lshl_add_u32 v42, v43, 1, v42
W_120:
    s_sleep 1
    ds_read_b32 v12, v7 offset:768
    s_sub_u32 s39, s39, 1
    s_cbranch_scc1 KS_ABORT
    s_waitcnt lgkmcnt(0)
    v_cmp_eq_u32 vcc, 0, v12
    s_cbranch_vccnz W_120
    ds_read_b32 v19, v40 offset:768
    s_waitcnt lgkmcnt(0)
    v_and_b32 v14, 0x7ff, v19
    v_sub_u32 v14, 2047, v14
    v_mul_u32_u24 v23, 1152, v14
    v_lshl_add_u32 v23, v41, 1, v23
    buffer_load_ushort v17, v23, s[68:71], 0 offen
    v_lshrrev_b32 v15, 9, v14
    v_bfe_u32 v16, v14, 6, 2
    v_lshl_add_u32 v15, v15, 2, v16
    v_bfe_u32 v16, v14, 2, 2
    v_lshl_add_u32 v15, v15, 2, v16
    v_bfe_u32 v16, v14, 4, 1
    v_bfe_u32 v24, v14, 8, 1
    v_and_b32 v25, 3, v14
    v_lshl_add_u32 v24, v24, 2, v25
    v_lshlrev_b32 v24, 1, v24
    v_bfe_u32 v25, v14, 5, 1
    v_lshl_add_u32 v24, v25, 5, v24
    v_lshl_add_u32 v25, v15, 1, v16
    v_lshl_add_u32 v25, v25, 14, v24
    v_lshrrev_b32 v26, 1, v41
    v_lshl_add_u32 v25, v26, 6, v25
    v_xor_b32 v26, v41, v16
    v_not_b32 v26, v26
    v_and_b32 v26, 1, v26
    v_lshl_add_u32 v25, v26, 4, v25
    v_lshl_add_u32 v26, v15, 12, v24
    v_lshl_add_u32 v26, v16, 4, v26
    v_lshl_add_u32 v26, v41, 6, v26
    v_add_u32 v26, 2064384, v26
    v_lshl_add_u32 v27, v16, 6, v15
    v_lshlrev_b32 v27, 7, v27
    v_xor_b32 v25, v27, v25
    v_and_b32 v27, 0xf80, v27
    v_xor_b32 v26, v27, v26
    v_cmp_gt_u32 vcc, 0x200, v41
    s_nop 1
    v_cndmask_b32 v25, v26, v25, vcc
    buffer_load_ushort v18, v25, s[64:67], 0 offen sc1
    v_ashrrev_i32 v22, 31, v19
    v_not_b32 v22, v22
    v_or_b32 v22, 0x80000000, v22
    v_xor_b32 v22, v19, v22
    v_and_b32 v22, 0xffff0000, v22
    v_mul_f32 v22, 0xbfb8aa3b, v22
    v_exp_f32 v22, v22
    s_nop 0
    v_add_f32 v22, 1.0, v22
    v_rcp_f32 v22, v22
    s_nop 0
    v_cvt_pk_bf16_f32 v22, 0, v22
    s_add_u32 s72, s36, 0xb10000
    s_addc_u32 s73, s37, 0
    s_mov_b32 s74, 0x40
    s_mov_b32 s75, 0x20000
    s_mov_b32 s68, s32
    s_mov_b32 s69, s33
    s_mov_b32 s70, 0x240000
    s_mov_b32 s71, 0x20000
    buffer_load_dword v8, v33, s[76:79], s92 offen offset:0 sc1
    buffer_load_dword v9, v33, s[76:79], s92 offen offset:1024 sc1
    buffer_load_dword v10, v33, s[76:79], s92 offen offset:2048 sc1
    buffer_load_dword v11, v33, s[76:79], s92 offen offset:3072 sc1
    s_cmp_lg_u32 s2, 0
    s_cbranch_scc1 KS_W9B
    buffer_store_dword v12, v7, s[72:75], 0 offen
    s_branch KS_W9B
KS_W9R:
    s_barrier
KS_W9B:
    s_barrier
    ds_read_b32 v13, v4 offset:24
    ds_read_u16 v20, v42 offset:17088
    s_waitcnt lgkmcnt(0)
    v_cmp_ne_u32 vcc, 0, v13
    s_cbranch_vccnz KS_W9R
    s_setprio 2
    s_branch KS_F3B
KS_F3A:
    s_sleep 2
    buffer_load_dword v8, v33, s[76:79], s92 offen offset:0 sc1
    buffer_load_dword v9, v33, s[76:79], s92 offen offset:1024 sc1
    buffer_load_dword v10, v33, s[76:79], s92 offen offset:2048 sc1
    buffer_load_dword v11, v33, s[76:79], s92 offen offset:3072 sc1
KS_F3B:
    s_sub_u32 s39, s39, 1
    s_cbranch_scc1 KS_ABORT
    s_waitcnt vmcnt(0)
    v_max3_u32 v44, v8, v9, v10
    v_max_u32 v44, v44, v11
    v_cmp_eq_u32 vcc, -1, v44
    s_cbranch_vccnz KS_F3A
    ds_write_b32 v4, v5 offset:28
    s_movk_i32 s92, 0x3000
    s_sleep 12
    s_branch ZPE_122
ZP_121:
    s_sleep 2
ZPE_122:
    buffer_load_dword v8, v33, s[76:79], s92 offen offset:0 sc1
    buffer_load_dword v9, v33, s[76:79], s92 offen offset:1024 sc1
    buffer_load_dword v10, v33, s[76:79], s92 offen offset:2048 sc1
    buffer_load_dword v11, v33, s[76:79], s92 offen offset:3072 sc1
    s_sub_u32 s39, s39, 1
    s_cbranch_scc1 KS_ABORT
    s_waitcnt vmcnt(0)
    v_max3_u32 v44, v8, v9, v10
    v_max_u32 v44, v44, v11
    v_cmp_eq_u32 vcc, -1, v44
    s_cbranch_vccnz ZP_121
    v_lshlrev_b32 v17, 16, v17
    v_lshlrev_b32 v18, 16, v18
    v_add_f32 v17, v17, v18
    v_cvt_pk_bf16_f32 v17, v17, v17
    v_and_b32 v21, 0xffff0000, v17
    v_lshlrev_b32 v20, 16, v20
    v_lshlrev_b32 v14, 2, v1
    v_add_u32 v14, 1536, v14
    s_mov_b32 exec_lo, -1
    s_mov_b32 exec_hi, 0
    s_setprio 3
    s_barrier
    ds_read2_b32 v[32:33], v14 offset0:0 offset1:32
    ds_read2_b32 v[34:35], v14 offset0:64 offset1:96
    ds_read2_b32 v[36:37], v14 offset0:128 offset1:160
    ds_read2_b32 v[38:39], v14 offset0:192 offset1:224
    ds_read_b32 v40, v14 offset:1024
    s_waitcnt lgkmcnt(3)
    v_pk_add_f32 v[32:33], v[32:33], v[34:35]
    s_waitcnt lgkmcnt(1)
    v_pk_add_f32 v[36:37], v[36:37], v[38:39]
    v_add_f32 v32, v32, v33
    s_waitcnt lgkmcnt(0)
    v_add_f32 v36, v36, v37
    v_add_f32 v32, v32, v40
    v_add_f32 v8, v32, v36
    v_cvt_pk_bf16_f32 v8, 0, v8
    v_mul_f32 v8, v8, v22
    v_cvt_pk_bf16_f32 v8, 0, v8
    v_add_f32 v8, v8, v20
    v_cvt_pk_bf16_f32 v8, 0, v8
    v_add_f32 v8, v8, v21
    v_cvt_pk_bf16_f32 v8, v8, v8
    buffer_store_short v8, v23, s[68:71], 0 offen
    s_endpgm
KS_B:
    s_setprio 2
    s_waitcnt lgkmcnt(0)
    s_barrier
    ds_read_b128 v[20:23], v16 offset:1024
    ds_read_b32 v30, v4 offset:24
    s_waitcnt lgkmcnt(1)
    v_mfma_f32_16x16x32_bf16 v[32:35], v[20:23], v[80:83], 0
    v_mfma_f32_16x16x32_bf16 v[40:43], v[20:23], v[88:91], 0
    v_mfma_f32_16x16x32_bf16 v[36:39], v[20:23], v[84:87], 0
    v_mfma_f32_16x16x32_bf16 v[44:47], v[20:23], v[92:95], 0
    s_waitcnt lgkmcnt(0)
    v_cmp_ne_u32 vcc, 0, v30
    s_mov_b32 exec_lo, -1
    s_mov_b32 exec_hi, 0
    s_cbranch_vccnz KS_BR
    v_cvt_pk_bf16_f32 v24, v32, v33
    v_cvt_pk_bf16_f32 v25, v34, v35
    v_cvt_pk_bf16_f32 v26, v40, v41
    v_cvt_pk_bf16_f32 v27, v42, v43
    s_mov_b32 exec_lo, 0
    s_mov_b32 exec_hi, -1
    v_cvt_pk_bf16_f32 v24, v36, v37
    v_cvt_pk_bf16_f32 v25, v38, v39
    v_cvt_pk_bf16_f32 v26, v44, v45
    v_cvt_pk_bf16_f32 v27, v46, v47
    s_mov_b64 exec, -1
    v_min_u32 v24, -2, v24
    v_min_u32 v25, -2, v25
    v_min_u32 v26, -2, v26
    v_min_u32 v27, -2, v27
    buffer_store_dwordx4 v[24:27], v17, s[80:83], s8 offen sc1
    s_sleep 13
W_123:
    ds_read_b32 v30, v4 offset:28
    s_sub_u32 s39, s39, 1
    s_cbranch_scc1 KS_ABORT
    s_waitcnt lgkmcnt(0)
    v_cmp_eq_u32 vcc, 0, v30
    s_cbranch_vccnz W_123
    s_branch ZPE_125
ZP_124:
    s_sleep 1
ZPE_125:
    buffer_load_dwordx4 v[32:35], v18, s[80:83], s9 offen sc1
    s_sub_u32 s39, s39, 1
    s_cbranch_scc1 KS_ABORT
    s_waitcnt vmcnt(0)
    v_max3_u32 v44, v32, v33, v34
    v_max_u32 v44, v44, v35
    v_cmp_eq_u32 vcc, -1, v44
    s_cbranch_vccnz ZP_124
    v_permlane32_swap_b32 v32, v34
    v_permlane32_swap_b32 v33, v35
    s_nop 1
    v_permlane16_swap_b32 v32, v33
    v_permlane16_swap_b32 v34, v35
    v_dot2c_f32_bf16 v28, s10, v32
    v_dot2c_f32_bf16 v29, s11, v32
    v_dot2c_f32_bf16 v28, s10, v33
    v_dot2c_f32_bf16 v29, s11, v33
    v_dot2c_f32_bf16 v28, s10, v34
    v_dot2c_f32_bf16 v29, s11, v34
    v_dot2c_f32_bf16 v28, s10, v35
    v_dot2c_f32_bf16 v29, s11, v35
    s_nop 1
    v_add_f32_dpp v28, v28, v28 row_ror:8 row_mask:0xf bank_mask:0xf
    v_add_f32_dpp v29, v29, v29 row_ror:8 row_mask:0xf bank_mask:0xf
    s_nop 0
    v_add_f32_dpp v28, v28, v28 row_ror:4 row_mask:0xf bank_mask:0xf
    v_add_f32_dpp v29, v29, v29 row_ror:4 row_mask:0xf bank_mask:0xf
    s_mov_b32 exec_lo, 0x000f000f
    s_mov_b32 exec_hi, 0x000f000f
    ds_write_b64 v19, v[28:29] offset:1536
    s_waitcnt lgkmcnt(0)
    s_barrier
    s_endpgm
KS_G0:
    ds_write_b8 v15, v5 offset:68
    s_setprio 0
KS_G:
    s_waitcnt vmcnt(0)
KS_GN:
    s_sub_u32 s87, s38, 12
    s_and_b32 s95, s87, 1
    s_cselect_b32 s72, s28, s26
    s_cselect_b32 s73, s29, s27
    s_mov_b32 s74, 0x510000
    s_mov_b32 s75, 0x20000
    v_lshrrev_b32 v6, 3, v1
    v_lshrrev_b32 v7, 5, v1
    v_xor_b32 v6, v6, v7
    v_and_b32 v6, 1, v6
    v_lshl_add_u32 v6, s95, 1, v6
    v_xor_b32 v6, v6, v1
    v_and_b32 v6, 3, v6
    v_lshrrev_b32 v7, 2, v1
    v_mul_u32_u24 v7, 9216, v7
    v_lshl_add_u32 v46, v6, 4, v7
    s_lshl_b32 s96, s89, 6
    v_mov_b32 v6, s87
    s_mul_i32 s97, s95, 36864
    s_add_u32 s97, s97, 35328
    s_mov_b32 s68, s30
    s_mov_b32 s69, s31
    s_mov_b32 s70, 0x510000
    s_mov_b32 s71, 0x20000
    v_lshlrev_b32 v8, 4, v1
    s_mul_i32 s92, s89, 36864
    s_mul_i32 s93, s87, 9216
    s_add_u32 s92, s92, s93
    s_add_u32 s93, s93, 109184
    s_cmp_lt_u32 s41, 8
    s_cselect_b32 s94, 0, 100
    v_mov_b32 v9, s94
W_126:
    s_sleep 2
    ds_read_b32 v10, v9 offset:100
    s_sub_u32 s39, s39, 1
    s_cbranch_scc1 KS_ABORT
    s_waitcnt lgkmcnt(0)
    v_cmp_ne_u32 vcc, s84, v10
    s_cbranch_vccnz W_126
    s_cmp_ge_u32 s41, 8
    s_cselect_b64 vcc, -1, 0
    s_cbranch_scc1 KS_GD1
    s_add_u32 m0, s93, 0
    s_add_u32 s94, s92, 0
    buffer_load_dwordx4 v8, s[68:71], s94 offen offset:0 nt lds
    buffer_load_dwordx4 v8, s[68:71], s94 offen offset:1024 nt lds
    buffer_load_dwordx4 v8, s[68:71], s94 offen offset:2048 nt lds
    buffer_load_dwordx4 v8, s[68:71], s94 offen offset:3072 nt lds
    s_add_u32 m0, s93, 4096
    s_add_u32 s94, s92, 4096
    buffer_load_dwordx4 v8, s[68:71], s94 offen offset:0 nt lds
    buffer_load_dwordx4 v8, s[68:71], s94 offen offset:1024 nt lds
    buffer_load_dwordx4 v8, s[68:71], s94 offen offset:2048 nt lds
    buffer_load_dwordx4 v8, s[68:71], s94 offen offset:3072 nt lds
    s_add_u32 m0, s93, 8192
    s_add_u32 s94, s92, 8192
    buffer_load_dwordx4 v8, s[68:71], s94 offen offset:0 nt lds
KS_GD1:
    s_cmp_ge_u32 s87, 2
    s_cbranch_scc1 KS_GL
    buffer_load_dwordx4 v[48:51], v46, s[72:75], s96 offen nt
    s_sleep 6
    s_add_u32 s96, s96, 147456
    buffer_load_dwordx4 v[52:55], v46, s[72:75], s96 offen nt
    s_sleep 6
    s_add_u32 s96, s96, 147456
    buffer_load_dwordx4 v[56:59], v46, s[72:75], s96 offen nt
    s_sleep 6
    s_add_u32 s96, s96, 147456
    buffer_load_dwordx4 v[60:63], v46, s[72:75], s96 offen nt
    s_sleep 6
    s_add_u32 s96, s96, 147456
    buffer_load_dwordx4 v[64:67], v46, s[72:75], s96 offen nt
    s_sleep 6
    s_add_u32 s96, s96, 147456
    buffer_load_dwordx4 v[68:71], v46, s[72:75], s96 offen nt
    s_sleep 6
    s_add_u32 s96, s96, 147456
    buffer_load_dwordx4 v[72:75], v46, s[72:75], s96 offen nt
    s_sleep 6
    s_add_u32 s96, s96, 147456
    buffer_load_dwordx4 v[76:79], v46, s[72:75], s96 offen nt
    s_sleep 6
    s_add_u32 s96, s96, 147456
    buffer_load_dwordx4 v[80:83], v46, s[72:75], s96 offen nt
    s_sleep 6
    s_add_u32 s96, s96, 147456
    buffer_load_dwordx4 v[84:87], v46, s[72:75], s96 offen nt
    s_sleep 6
    s_add_u32 s96, s96, 147456
    buffer_load_dwordx4 v[88:91], v46, s[72:75], s96 offen nt
    s_sleep 6
    s_add_u32 s96, s96, 147456
    buffer_load_dwordx4 v[92:95], v46, s[72:75], s96 offen nt
    s_sleep 6
    s_add_u32 s96, s96, 147456
    buffer_load_dwordx4 v[96:99], v46, s[72:75], s96 offen nt
    s_sleep 6
    s_add_u32 s96, s96, 147456
    buffer_load_dwordx4 v[100:103], v46, s[72:75], s96 offen nt
    s_sleep 6
    s_add_u32 s96, s96, 147456
    buffer_load_dwordx4 v[104:107], v46, s[72:75], s96 offen nt
    s_sleep 6
    s_add_u32 s96, s96, 147456
    buffer_load_dwordx4 v[108:111], v46, s[72:75], s96 offen nt
    s_sleep 6
    s_add_u32 s96, s96, 147456
    buffer_load_dwordx4 v[112:115], v46, s[72:75], s96 offen nt
    s_sleep 6
    s_add_u32 s96, s96, 147456
    buffer_load_dwordx4 v[116:119], v46, s[72:75], s96 offen nt
    v_add_u32 v8, s97, v8
    s_waitcnt vmcnt(0)
    ds_write_b8 v6, v5 offset:40
W_127:
    s_sleep 2
    ds_read_b32 v10, v4 offset:52
    s_sub_u32 s39, s39, 1
    s_cbranch_scc1 KS_ABORT
    s_waitcnt lgkmcnt(0)
    v_cmp_ne_u32 vcc, s84, v10
    s_cbranch_vccnz W_127
W_128:
    s_sleep 2
    ds_read_b32 v10, v4 offset:12
    s_sub_u32 s39, s39, 1
    s_cbranch_scc1 KS_ABORT
    s_waitcnt lgkmcnt(0)
    v_cmp_ne_u32 vcc, s84, v10
    s_cbranch_vccnz W_128
    ds_write_b128 v8, v[48:51] offset:0
    ds_write_b128 v8, v[52:55] offset:1024
    ds_write_b128 v8, v[56:59] offset:2048
    ds_write_b128 v8, v[60:63] offset:3072
    ds_write_b128 v8, v[64:67] offset:4096
    ds_write_b128 v8, v[68:71] offset:5120
    ds_write_b128 v8, v[72:75] offset:6144
    ds_write_b128 v8, v[76:79] offset:7168
    ds_write_b128 v8, v[80:83] offset:8192
    ds_write_b128 v8, v[84:87] offset:9216
    ds_write_b128 v8, v[88:91] offset:10240
    ds_write_b128 v8, v[92:95] offset:11264
    ds_write_b128 v8, v[96:99] offset:12288
    ds_write_b128 v8, v[100:103] offset:13312
    ds_write_b128 v8, v[104:107] offset:14336
    ds_write_b128 v8, v[108:111] offset:15360
    ds_write_b128 v8, v[112:115] offset:16384
    ds_write_b128 v8, v[116:119] offset:17408
    s_branch KS_G4
KS_GL:
    s_add_u32 s96, s96, 2654208
    s_add_u32 s97, s97, 18432
    v_add_u32 v8, s97, v8
    s_waitcnt vmcnt(0)
    ds_write_b8 v6, v5 offset:40
W_129:
    s_sleep 2
    ds_read_b32 v10, v4 offset:52
    s_sub_u32 s39, s39, 1
    s_cbranch_scc1 KS_ABORT
    s_waitcnt lgkmcnt(0)
    v_cmp_ne_u32 vcc, s84, v10
    s_cbranch_vccnz W_129
    s_cmp_ge_u32 s41, 8
    s_cbranch_scc1 KS_GLZ
W_130:
    s_sleep 2
    ds_read_b32 v10, v4 offset:20
    s_sub_u32 s39, s39, 1
    s_cbranch_scc1 KS_ABORT
    s_waitcnt lgkmcnt(0)
    v_cmp_ne_u32 vcc, s84, v10
    s_cbranch_vccnz W_130
KS_GLZ:
    s_setprio 1
    s_add_u32 m0, s97, 0
    s_nop 0
    buffer_load_dwordx4 v46, s[72:75], s96 offen offset:0  lds
    s_add_u32 s96, s96, 146432
    buffer_load_dwordx4 v46, s[72:75], s96 offen offset:1024  lds
    s_add_u32 s96, s96, 146432
    buffer_load_dwordx4 v46, s[72:75], s96 offen offset:2048  lds
    s_add_u32 s96, s96, 146432
    buffer_load_dwordx4 v46, s[72:75], s96 offen offset:3072  lds
    s_add_u32 m0, s97, 4096
    s_add_u32 s96, s96, 150528
    buffer_load_dwordx4 v46, s[72:75], s96 offen offset:0  lds
    s_add_u32 s96, s96, 146432
    buffer_load_dwordx4 v46, s[72:75], s96 offen offset:1024  lds
    s_add_u32 s96, s96, 146432
    buffer_load_dwordx4 v46, s[72:75], s96 offen offset:2048  lds
    s_add_u32 s96, s96, 146432
    buffer_load_dwordx4 v46, s[72:75], s96 offen offset:3072  lds
    s_add_u32 m0, s97, 8192
    s_add_u32 s96, s96, 150528
    buffer_load_dwordx4 v46, s[72:75], s96 offen offset:0  lds
    s_add_u32 s96, s96, 146432
    buffer_load_dwordx4 v46, s[72:75], s96 offen offset:1024  lds
    s_add_u32 s96, s96, 146432
    buffer_load_dwordx4 v46, s[72:75], s96 offen offset:2048  lds
    s_add_u32 s96, s96, 146432
    buffer_load_dwordx4 v46, s[72:75], s96 offen offset:3072  lds
    s_add_u32 m0, s97, 12288
    s_add_u32 s96, s96, 150528
    buffer_load_dwordx4 v46, s[72:75], s96 offen offset:0  lds
    s_add_u32 s96, s96, 146432
    buffer_load_dwordx4 v46, s[72:75], s96 offen offset:1024  lds
    s_add_u32 s96, s96, 146432
    buffer_load_dwordx4 v46, s[72:75], s96 offen offset:2048  lds
    s_add_u32 s96, s96, 146432
    buffer_load_dwordx4 v46, s[72:75], s96 offen offset:3072  lds
    s_add_u32 m0, s97, 16384
    s_add_u32 s96, s96, 150528
    buffer_load_dwordx4 v46, s[72:75], s96 offen offset:0  lds
    s_add_u32 s96, s96, 146432
    buffer_load_dwordx4 v46, s[72:75], s96 offen offset:1024  lds
    s_setprio 0
    s_waitcnt vmcnt(0)
KS_G4:
    ds_write_b8 v6, v5 offset:192
    v_lshrrev_b32 v6, 3, v1
    v_xor_b32 v6, v6, v3
    v_and_b32 v6, 1, v6
    v_and_b32 v7, 2, v1
    v_or_b32 v6, v6, v7
    v_xor_b32 v6, s87, v6
    v_mul_u32_u24 v7, 18432, v7
    v_lshl_add_u32 v7, v6, 4, v7
    v_and_b32 v6, 1, v1
    v_lshl_add_u32 v7, v6, 3, v7
    v_bfe_u32 v6, v1, 2, 2
    v_lshl_add_u32 v6, v3, 3, v6
    v_lshl_add_u32 v7, v6, 6, v7
    v_add_u32 v8, 35328, v7
    v_and_b32 v9, 7, v1
    v_lshrrev_b32 v10, 1, v3
    v_and_b32 v11, 1, v3
    v_lshlrev_b32 v6, 5, v9
    v_lshl_add_u32 v6, v10, 8, v6
    v_lshl_add_u32 v6, v11, 4, v6
    v_add_u32 v6, 17088, v6
    s_lshl_b32 s92, s87, 4
    v_lshl_add_u32 v7, v9, 6, s92
    v_lshl_add_u32 v7, v11, 3, v7
    v_lshl_add_u32 v7, v10, 2, v7
    v_bfe_u32 v9, v1, 3, 1
    v_lshl_add_u32 v7, v9, 1, v7
W_131:
    s_sleep 2
    ds_read_b32 v10, v4 offset:192
    s_sub_u32 s39, s39, 1
    s_cbranch_scc1 KS_ABORT
    s_waitcnt lgkmcnt(0)
    v_cmp_ne_u32 vcc, s84, v10
    s_cbranch_vccnz W_131
W_132:
    s_sleep 2
    ds_read_b32 v10, v4 offset:12
    s_sub_u32 s39, s39, 1
    s_cbranch_scc1 KS_ABORT
    s_waitcnt lgkmcnt(0)
    v_cmp_ne_u32 vcc, s84, v10
    s_cbranch_vccnz W_132
    s_sleep 2
    ds_read_b64_tr_b16 v[48:49], v8 offset:0
    ds_read_b64_tr_b16 v[50:51], v8 offset:256
    ds_read_b64_tr_b16 v[52:53], v8 offset:2048
    ds_read_b64_tr_b16 v[54:55], v8 offset:2304
    ds_read_b64_tr_b16 v[56:57], v8 offset:4096
    ds_read_b64_tr_b16 v[58:59], v8 offset:4352
    ds_read_b64_tr_b16 v[60:61], v8 offset:6144
    ds_read_b64_tr_b16 v[62:63], v8 offset:6400
    ds_read_b64_tr_b16 v[64:65], v8 offset:8192
    ds_read_b64_tr_b16 v[66:67], v8 offset:8448
    ds_read_b64_tr_b16 v[68:69], v8 offset:10240
    ds_read_b64_tr_b16 v[70:71], v8 offset:10496
    ds_read_b64_tr_b16 v[72:73], v8 offset:12288
    ds_read_b64_tr_b16 v[74:75], v8 offset:12544
    ds_read_b64_tr_b16 v[76:77], v8 offset:14336
    ds_read_b64_tr_b16 v[78:79], v8 offset:14592
    ds_read_b64_tr_b16 v[80:81], v8 offset:16384
    ds_read_b64_tr_b16 v[82:83], v8 offset:16640
    ds_read_b64_tr_b16 v[84:85], v8 offset:18432
    ds_read_b64_tr_b16 v[86:87], v8 offset:18688
    ds_read_b64_tr_b16 v[88:89], v8 offset:20480
    ds_read_b64_tr_b16 v[90:91], v8 offset:20736
    ds_read_b64_tr_b16 v[92:93], v8 offset:22528
    ds_read_b64_tr_b16 v[94:95], v8 offset:22784
    ds_read_b64_tr_b16 v[96:97], v8 offset:24576
    ds_read_b64_tr_b16 v[98:99], v8 offset:24832
    ds_read_b64_tr_b16 v[100:101], v8 offset:26624
    ds_read_b64_tr_b16 v[102:103], v8 offset:26880
    ds_read_b64_tr_b16 v[104:105], v8 offset:28672
    ds_read_b64_tr_b16 v[106:107], v8 offset:28928
    ds_read_b64_tr_b16 v[108:109], v8 offset:30720
    ds_read_b64_tr_b16 v[110:111], v8 offset:30976
    ds_read_b64_tr_b16 v[112:113], v8 offset:32768
    ds_read_b64_tr_b16 v[114:115], v8 offset:33024
    ds_read_b64_tr_b16 v[116:117], v8 offset:34816
    ds_read_b64_tr_b16 v[118:119], v8 offset:35072
W_133:
    s_sleep 2
    ds_read_b32 v10, v4 offset:768
    s_sub_u32 s39, s39, 1
    s_cbranch_scc1 KS_ABORT
    s_waitcnt lgkmcnt(0)
    v_cmp_eq_u32 vcc, 0, v10
    s_cbranch_vccnz W_133
    s_setprio 3
KS_GC:
    s_mov_b32 exec_lo, 0x00ff00ff
    s_mov_b32 exec_hi, 0x00ff00ff
KS_GW:
    ds_read_b32 v0, v4 offset:32
    ds_read_b128 v[8:11], v6 offset:0
    ds_read_b128 v[12:15], v6 offset:512
    ds_read_b128 v[16:19], v6 offset:1024
    ds_read_b128 v[20:23], v6 offset:1536
    s_sub_u32 s39, s39, 1
    s_cbranch_scc1 KS_ABORT
    s_waitcnt lgkmcnt(4)
    v_cmp_eq_u32 vcc, 0, v0
    s_cbranch_vccnz KS_GW
    s_waitcnt lgkmcnt(3)
    v_mfma_f32_16x16x32_bf16 v[120:123], v[48:51], v[8:11], 0
    ds_read_b128 v[24:27], v6 offset:2048
    ds_read_b128 v[28:31], v6 offset:2560
    s_waitcnt lgkmcnt(4)
    v_mfma_f32_16x16x32_bf16 v[124:127], v[52:55], v[12:15], 0
    ds_read_b128 v[32:35], v6 offset:3072
    ds_read_b128 v[36:39], v6 offset:3584
    s_waitcnt lgkmcnt(5)
    v_mfma_f32_16x16x32_bf16 v[120:123], v[56:59], v[16:19], v[120:123]
    ds_read_b128 v[40:43], v6 offset:4096
    ds_read_b128 v[44:47], v6 offset:4608
    s_waitcnt lgkmcnt(6)
    v_mfma_f32_16x16x32_bf16 v[124:127], v[60:63], v[20:23], v[124:127]
    ds_read_b128 v[8:11], v6 offset:5120
    ds_read_b128 v[12:15], v6 offset:5632
    s_waitcnt lgkmcnt(7)
    v_mfma_f32_16x16x32_bf16 v[120:123], v[64:67], v[24:27], v[120:123]
    ds_read_b128 v[16:19], v6 offset:6144
    ds_read_b128 v[20:23], v6 offset:6656
    s_waitcnt lgkmcnt(8)
    v_mfma_f32_16x16x32_bf16 v[124:127], v[68:71], v[28:31], v[124:127]
    ds_read_b128 v[24:27], v6 offset:7168
    ds_read_b128 v[28:31], v6 offset:7680
    s_waitcnt lgkmcnt(9)
    v_mfma_f32_16x16x32_bf16 v[120:123], v[72:75], v[32:35], v[120:123]
    ds_read_b128 v[32:35], v6 offset:8192
    s_waitcnt lgkmcnt(9)
    v_mfma_f32_16x16x32_bf16 v[124:127], v[76:79], v[36:39], v[124:127]
    ds_read_b128 v[36:39], v6 offset:8704
    s_waitcnt lgkmcnt(9)
    v_mfma_f32_16x16x32_bf16 v[120:123], v[80:83], v[40:43], v[120:123]
    s_waitcnt lgkmcnt(8)
    v_mfma_f32_16x16x32_bf16 v[124:127], v[84:87], v[44:47], v[124:127]
    s_waitcnt lgkmcnt(7)
    v_mfma_f32_16x16x32_bf16 v[120:123], v[88:91], v[8:11], v[120:123]
    s_waitcnt lgkmcnt(6)
    v_mfma_f32_16x16x32_bf16 v[124:127], v[92:95], v[12:15], v[124:127]
    s_waitcnt lgkmcnt(5)
    v_mfma_f32_16x16x32_bf16 v[120:123], v[96:99], v[16:19], v[120:123]
    s_waitcnt lgkmcnt(4)
    v_mfma_f32_16x16x32_bf16 v[124:127], v[100:103], v[20:23], v[124:127]
    s_waitcnt lgkmcnt(3)
    v_mfma_f32_16x16x32_bf16 v[120:123], v[104:107], v[24:27], v[120:123]
    s_waitcnt lgkmcnt(2)
    v_mfma_f32_16x16x32_bf16 v[124:127], v[108:111], v[28:31], v[124:127]
    s_waitcnt lgkmcnt(1)
    v_mfma_f32_16x16x32_bf16 v[120:123], v[112:115], v[32:35], v[120:123]
    s_waitcnt lgkmcnt(0)
    v_mfma_f32_16x16x32_bf16 v[124:127], v[116:119], v[36:39], v[124:127]
    s_mov_b64 exec, -1
    s_nop 6
    v_pk_add_f32 v[120:121], v[120:121], v[124:125]
    v_pk_add_f32 v[122:123], v[122:123], v[126:127]
    s_nop 1
    v_permlane32_swap_b32 v121, v123
    v_permlane32_swap_b32 v120, v122
    s_nop 0
    v_mov_b32_dpp v120, v121 row_shr:8 row_mask:0xf bank_mask:0xc
    v_mov_b32_dpp v122, v123 row_shr:8 row_mask:0xf bank_mask:0xc
    v_cvt_pk_bf16_f32 v120, 0, v120
    v_mul_f32 v121, 0xbfb8aa3b, v120
    v_exp_f32 v121, v121
    v_cvt_pk_bf16_f32 v122, 0, v122
    v_add_f32 v121, 1.0, v121
    v_rcp_f32 v121, v121
    s_nop 0
    v_mul_f32 v121, v120, v121
    v_cvt_pk_bf16_f32 v121, 0, v121
    v_mul_f32 v121, v121, v122
    v_cvt_pk_bf16_f32 v121, v121, v121
    ds_write_b16 v7, v121 offset:1024
    s_waitcnt lgkmcnt(0)
    s_barrier
    s_setprio 0
    ds_read_b32 v0, v4 offset:24
    s_waitcnt lgkmcnt(0)
    v_cmp_eq_u32 vcc, 0, v0
    s_cbranch_vccnz KS_PEND
    s_barrier
    s_branch KS_GC
KS_PEND:
KS_ABORT:
KS_END:
    s_endpgm
.section .rodata,"a"
.p2align 6
.amdhsa_kernel sequential_preLN__ssm_conv_s4__moe_arch_mod__prompt_kernel
  .amdhsa_next_free_vgpr 128
  .amdhsa_next_free_sgpr 100
  .amdhsa_accum_offset 128
  .amdhsa_group_segment_fixed_size 0
  .amdhsa_kernarg_size 136
  .amdhsa_user_sgpr_count 2
  .amdhsa_user_sgpr_kernarg_segment_ptr 1
  .amdhsa_system_sgpr_workgroup_id_x 1
  .amdhsa_float_denorm_mode_32 3
.end_amdhsa_kernel
```

```asm
; @launch grid=(256,1,1) block=(1024,1,1) lds=154240
.amdgcn_target "amdgcn-amd-amdhsa--gfx950"
.text
.globl sequential_preLN__ssm_conv_s4__moe_arch_mod__prompt_kernel
.p2align 8
.type sequential_preLN__ssm_conv_s4__moe_arch_mod__prompt_kernel,@function
sequential_preLN__ssm_conv_s4__moe_arch_mod__prompt_kernel:
    s_cmp_ge_u32 s2, 256
    s_cbranch_scc1 KS_END
    s_load_dwordx16 s[4:19], s[0:1], 0
    s_load_dwordx16 s[20:35], s[0:1], 64
    s_load_dwordx2 s[36:37], s[0:1], 128
    v_readfirstlane_b32 s38, v0
    s_lshr_b32 s38, s38, 6
    s_and_b32 s40, s2, 7
    s_lshr_b32 s41, s2, 3
    s_cmp_lg_u32 s38, 0
    s_cbranch_scc1 KS_CPE
    s_getpc_b64 s[42:43]
KS_PC:
    s_and_b32 s92, s41, 7
    s_mul_i32 s92, s92, 4608
    v_and_b32 v126, 63, v0
    v_lshl_add_u32 v126, v126, 7, s92
    v_min_u32 v126, KS_END-KS_PC, v126
    global_load_dword v127, v126, s[42:43]
KS_CPE:
    s_add_u32 s92, s38, 8
    s_sub_u32 s93, s38, 4
    s_cmp_lt_u32 s38, 8
    s_cselect_b32 s92, s92, s93
    s_cmp_lt_u32 s38, 4
    s_cselect_b32 s38, s38, s92
    v_and_b32 v1, 63, v0
    v_and_b32 v2, 15, v1
    v_lshrrev_b32 v3, 4, v1
    v_mov_b32 v4, 0
    v_mov_b32 v5, 1
    s_mov_b32 s39, 524288
    s_mov_b32 s84, 0x01010101
    s_lshl_b32 s90, s40, 5
    s_add_u32 s90, s90, s41
    s_mul_i32 s89, s40, 18
    s_add_u32 s89, s89, s41
    s_cmp_lt_u32 s38, 4
    s_cbranch_scc1 KS_L
    s_cmp_ge_u32 s38, 12
    s_cbranch_scc1 KS_X
    s_setprio 2
    s_lshr_b32 s87, s38, 2
    s_sub_u32 s87, s87, 1
    s_mul_i32 s86, s87, 3
    s_xor_b32 s86, s86, s38
    s_and_b32 s86, s86, 3
    s_lshl_b32 s88, s90, 1
    s_add_u32 s88, s88, s87
    s_lshl_b32 s92, s86, 11
    s_add_u32 s92, s92, 146048
    v_lshl_add_u32 v28, v1, 3, s92
    s_cmp_eq_u32 s86, 3
    s_cbranch_scc1 PX_1
    v_lshlrev_b32 v26, 3, v2
    v_mov_b32 v21, 0x80
    s_cmp_eq_u32 s86, 1
    s_cbranch_scc1 PX_2
    s_cmp_eq_u32 s86, 2
    s_cbranch_scc1 PX_3
    v_lshl_add_u32 v26, v3, 1, v26
    v_mov_b32 v22, 1
    s_branch PX_4
PX_2:
    v_cmp_gt_u32 vcc, 2, v3
    v_lshl_add_u32 v20, v3, 2, v26
    v_add_u32 v20, 256, v20
    v_lshl_add_u32 v26, v3, 8, v26
    v_cndmask_b32 v26, v26, v20, vcc
    v_cndmask_b32 v22, v21, 2, vcc
    v_cndmask_b32 v21, 4, v21, vcc
    s_branch PX_4
PX_3:
    v_lshl_add_u32 v26, v3, 9, v26
    v_add_u32 v26, 0x400, v26
    v_mov_b32 v22, 0x100
PX_4:
    v_mad_u32_u24 v26, v22, s87, v26
    v_add_u32 v27, v26, v21
    s_movk_i32 s96, 31232
    s_movk_i32 s97, -19072
    s_lshl_b32 s95, s87, 9
    v_cvt_f32_u32 v20, v26
    v_max_u32 v22, 0x800, v26
    v_cvt_f32_u32 v21, v27
    v_max_u32 v23, 0x800, v27
    v_cmp_gt_u32 vcc, 0x80, v26
    v_lshrrev_b32 v24, 16, v20
    v_add3_u32 v24, v24, v22, s97
    v_cndmask_b32 v24, v24, v26, vcc
    v_cmp_gt_u32 vcc, 0x80, v27
    v_lshrrev_b32 v25, 16, v21
    v_add3_u32 v25, v25, v23, s97
    v_cndmask_b32 v25, v25, v27, vcc
    v_min_u32 v24, 642, v24
    v_lshl_add_u32 v24, v24, 1, s96
    v_min_u32 v25, 642, v25
    v_lshl_add_u32 v25, v25, 1, s96
    v_add_u32 v29, s95, v28
    v_lshl_or_b32 v24, v25, 16, v24
    v_lshl_or_b32 v25, v27, 16, v26
    ds_write_b64 v29, v[24:25]
PX_1:
KS_GRP:
    s_lshl_b32 s92, s88, 8
    v_lshl_add_u32 v20, v1, 2, s92
    s_lshl_b32 s92, s88, 1
    v_mov_b32 v21, s92
    s_mul_i32 s85, s87, 36672
    s_add_u32 s85, s85, 35840
    s_waitcnt lgkmcnt(0)
    global_load_ushort v46, v21, s[18:19]
    global_load_dword v40, v20, s[6:7]
    global_load_dword v41, v20, s[8:9]
    global_load_dword v42, v20, s[10:11]
    global_load_dword v43, v20, s[12:13]
    global_load_dword v44, v20, s[14:15]
    global_load_dword v45, v20, s[16:17]
    global_load_ushort v107, v21, s[20:21]
    s_barrier
    s_movk_i32 s96, 31232
    s_cmp_eq_u32 s87, 2
    s_cbranch_scc1 PREE_7
    v_mov_b32 v32, 641
    s_cmp_eq_u32 s87, 1
    s_cbranch_scc1 PREB_5
    v_mov_b32 v33, 32514
    s_cmp_eq_u32 s86, 1
    s_cbranch_scc1 PRE_9
    s_cmp_eq_u32 s86, 2
    s_cbranch_scc1 PRE_10
    s_cmp_eq_u32 s86, 3
    s_cbranch_scc1 PRE_11
    v_lshlrev_b32 v23, 1, v1
    v_sub_u32 v30, 93, v23
    v_cmp_lt_u32 vcc, 61, v30
    v_lshlrev_b32 v31, 2, v30
    v_add_u32 v31, 32010, v31
    v_cndmask_b32 v24, v31, v33, vcc
    v_sub_u32 v30, 92, v23
    v_cmp_lt_u32 vcc, 61, v30
    v_lshlrev_b32 v31, 2, v30
    v_add_u32 v31, 32010, v31
    v_cndmask_b32 v25, v31, v33, vcc
    v_sub_u32 v30, 94, v23
    v_cmp_lt_u32 vcc, 62, v30
    v_lshlrev_b32 v31, 2, v30
    v_add_u32 v31, 32008, v31
    v_cndmask_b32 v26, v31, v33, vcc
    v_sub_u32 v30, 93, v23
    v_cmp_lt_u32 vcc, 62, v30
    v_lshlrev_b32 v31, 2, v30
    v_add_u32 v31, 32008, v31
    v_cndmask_b32 v27, v31, v33, vcc
    s_branch PREW_6
PRE_9:
    v_min_u32 v23, 47, v1
    v_lshlrev_b32 v23, 1, v23
    v_sub_u32 v30, 64, v23
    v_cmp_lt_u32 vcc, 63, v30
    v_lshlrev_b32 v31, 2, v30
    v_add_u32 v31, 32258, v31
    v_cndmask_b32 v24, v31, v33, vcc
    v_sub_u32 v30, 63, v23
    v_cmp_lt_u32 vcc, 63, v30
    v_lshlrev_b32 v31, 2, v30
    v_add_u32 v31, 32258, v31
    v_cndmask_b32 v25, v31, v33, vcc
    v_sub_u32 v30, 62, v23
    v_cmp_lt_u32 vcc, 63, v30
    v_lshlrev_b32 v31, 2, v30
    v_add_u32 v31, 32258, v31
    v_cndmask_b32 v27, v31, v33, vcc
    v_mov_b32 v26, v25
    s_branch PREW_6
PRE_10:
    v_min_u32 v23, 47, v1
    v_lshlrev_b32 v23, 1, v23
    v_sub_u32 v30, 64, v23
    v_cmp_lt_u32 vcc, 63, v30
    v_lshlrev_b32 v31, 2, v30
    v_add_u32 v31, 32260, v31
    v_cndmask_b32 v24, v31, v33, vcc
    v_sub_u32 v30, 63, v23
    v_cmp_lt_u32 vcc, 63, v30
    v_lshlrev_b32 v31, 2, v30
    v_add_u32 v31, 32260, v31
    v_cndmask_b32 v25, v31, v33, vcc
    v_sub_u32 v30, 62, v23
    v_cmp_lt_u32 vcc, 63, v30
    v_lshlrev_b32 v31, 2, v30
    v_add_u32 v31, 32260, v31
    v_cndmask_b32 v27, v31, v33, vcc
    v_mov_b32 v26, v25
    s_branch PREW_6
PRE_11:
    v_cmp_gt_u32 vcc, 9, v1
    v_add_u32 v23, 0x100, v1
    v_mov_b32 v33, 0x200
    v_cndmask_b32 v23, v23, v1, vcc
    v_lshlrev_b32 v23, 1, v23
    v_sub_u32 v30, 544, v23
    v_cvt_f32_i32 v31, v30
    v_cmp_gt_u32 vcc, 0x100, v30
    v_cvt_pk_bf16_f32 v31, v31, v31
    v_and_b32 v31, 0xffff, v31
    v_subrev_u32 v31, 0x4280, v31
    v_cndmask_b32 v31, v31, v30, vcc
    v_cmp_lt_u32 vcc, 0x20d, v30
    v_or_b32 v30, 1, v23
    s_nop 0
    v_cndmask_b32 v31, v31, v32, vcc
    v_cmp_eq_u32 vcc, 0x25d, v30
    s_nop 1
    v_cndmask_b32 v31, v31, v33, vcc
    v_lshl_add_u32 v24, v31, 1, s96
    v_add_u32 v23, 1, v23
    v_sub_u32 v30, 544, v23
    v_cvt_f32_i32 v31, v30
    v_cmp_gt_u32 vcc, 0x100, v30
    v_cvt_pk_bf16_f32 v31, v31, v31
    v_and_b32 v31, 0xffff, v31
    v_subrev_u32 v31, 0x4280, v31
    v_cndmask_b32 v31, v31, v30, vcc
    v_cmp_lt_u32 vcc, 0x20d, v30
    v_or_b32 v30, 1, v23
    s_nop 0
    v_cndmask_b32 v31, v31, v32, vcc
    v_cmp_eq_u32 vcc, 0x25d, v30
    s_nop 1
    v_cndmask_b32 v31, v31, v33, vcc
    v_lshl_add_u32 v25, v31, 1, s96
    v_add_u32 v23, 1, v23
    v_sub_u32 v30, 544, v23
    v_cvt_f32_i32 v31, v30
    v_cmp_gt_u32 vcc, 0x100, v30
    v_cvt_pk_bf16_f32 v31, v31, v31
    v_and_b32 v31, 0xffff, v31
    v_subrev_u32 v31, 0x4280, v31
    v_cndmask_b32 v31, v31, v30, vcc
    v_cmp_lt_u32 vcc, 0x20d, v30
    v_or_b32 v30, 1, v23
    s_nop 0
    v_cndmask_b32 v31, v31, v32, vcc
    v_cmp_eq_u32 vcc, 0x25d, v30
    s_nop 1
    v_cndmask_b32 v31, v31, v33, vcc
    v_lshl_add_u32 v27, v31, 1, s96
    v_mov_b32 v26, v25
    s_branch PREW_6
PREB_5:
    s_lshl_b32 s93, s86, 7
    s_add_u32 s93, s93, 18
    v_lshl_add_u32 v23, v1, 1, s93
    v_sub_u32 v30, 544, v23
    v_cvt_f32_i32 v31, v30
    v_cmp_gt_u32 vcc, 0x100, v30
    v_cvt_pk_bf16_f32 v31, v31, v31
    v_and_b32 v31, 0xffff, v31
    v_subrev_u32 v31, 0x4280, v31
    v_cndmask_b32 v31, v31, v30, vcc
    v_cmp_lt_u32 vcc, 0x20d, v30
    s_nop 1
    v_cndmask_b32 v31, v31, v32, vcc
    v_lshl_add_u32 v24, v31, 1, s96
    v_add_u32 v23, 1, v23
    v_sub_u32 v30, 544, v23
    v_cvt_f32_i32 v31, v30
    v_cmp_gt_u32 vcc, 0x100, v30
    v_cvt_pk_bf16_f32 v31, v31, v31
    v_and_b32 v31, 0xffff, v31
    v_subrev_u32 v31, 0x4280, v31
    v_cndmask_b32 v31, v31, v30, vcc
    v_cmp_lt_u32 vcc, 0x20d, v30
    s_nop 1
    v_cndmask_b32 v31, v31, v32, vcc
    v_lshl_add_u32 v25, v31, 1, s96
    v_add_u32 v23, 1, v23
    v_sub_u32 v30, 544, v23
    v_cvt_f32_i32 v31, v30
    v_cmp_gt_u32 vcc, 0x100, v30
    v_cvt_pk_bf16_f32 v31, v31, v31
    v_and_b32 v31, 0xffff, v31
    v_subrev_u32 v31, 0x4280, v31
    v_cndmask_b32 v31, v31, v30, vcc
    v_cmp_lt_u32 vcc, 0x20d, v30
    s_nop 1
    v_cndmask_b32 v31, v31, v32, vcc
    v_lshl_add_u32 v26, v31, 1, s96
    s_sub_u32 s93, s86, 1
    s_cmp_lt_u32 s93, 2
    s_cselect_b32 s94, 47, 63
    s_mul_i32 s93, s93, 384
    s_add_u32 s93, s93, 35664
    s_cmp_eq_u32 s86, 0
    s_cselect_b32 s93, 35152, s93
    s_cmp_eq_u32 s86, 3
    s_cselect_b32 s93, 32528, s93
    s_cselect_b32 s95, 0x100, 0
    v_cmp_gt_u32 vcc, 9, v1
    v_min_u32 v23, s94, v1
    v_add_u32 v30, s95, v23
    v_cndmask_b32 v23, v30, v23, vcc
    s_sub_u32 s93, s93, 5244
    v_lshl_add_u32 v27, v23, 2, s93
    v_lshl_or_b32 v24, v25, 16, v24
    v_lshl_or_b32 v25, v27, 16, v26
    ds_write_b64 v28, v[24:25] offset:1024
    v_mov_b32 v24, s86
    ds_write_b8 v24, v5 offset:212
    s_branch PREE_7
PREW_6:
    v_lshl_or_b32 v24, v25, 16, v24
    v_lshl_or_b32 v25, v27, 16, v26
    ds_write_b64 v28, v[24:25] offset:1536
    v_mov_b32 v24, s86
    ds_write_b8 v24, v5 offset:208
PREE_7:
    s_mul_i32 s93, s86, 8704
    s_min_u32 s94, s93, 22304
    s_add_u32 s94, s94, s85
    s_lshl_b32 s92, s87, 4
    v_mov_b32 v14, s92
    v_add_u32 v15, s86, v14
    v_lshl_add_u32 v72, v1, 3, s94
    v_add_u32 v73, 2176, v72
    v_add_u32 v74, 4352, v72
    v_add_u32 v75, 6528, v72
    v_mul_u32_u24 v126, 544, v2
    v_lshl_add_u32 v126, v3, 4, v126
    v_add_u32 v126, s85, v126
    v_add_u32 v127, s93, v126
    v_lshlrev_b32 v20, 3, v3
    v_sub_u32 v20, v20, v2
    v_add_u32 v21, 16, v20
    v_lshrrev_b32 v21, 1, v21
    v_and_b32 v23, 1, v21
    s_movk_i32 s93, -5244
    v_and_b32 v22, 1, v2
    s_add_u32 s92, s85, 32528
    v_lshl_add_u32 v21, v21, 2, s92
    s_movk_i32 s92, 1344
    s_movk_i32 s94, 192
    v_mad_i32_i24 v21, v23, s93, v21
    v_mad_u32_u24 v6, v22, s92, v21
    v_add_u32 v7, 640, v6
    v_mad_u32_u24 v23, v22, s94, v21
    v_add_u32 v13, 3136, v23
    v_lshlrev_b32 v23, 2, v3
    v_sub_u32 v23, v23, v2
    s_add_u32 s92, s85, 29968
    v_lshl_add_u32 v11, v23, 2, s92
    s_movk_i32 s93, 5244
    v_mad_u32_u24 v11, v22, s93, v11
    s_mul_i32 s94, s87, 4672
    s_add_u32 s94, s94, 3072
    v_lshl_add_u32 v23, v2, 5, s94
    v_lshl_add_u32 v8, v3, 4, v23
    v_bfe_u32 v20, v1, 2, 2
    v_and_b32 v21, 3, v1
    v_lshl_add_u32 v20, v3, 3, v20
    v_lshlrev_b32 v105, 2, v21
    v_lshl_add_u32 v21, v21, 3, s85
    v_lshl_add_u32 v9, v20, 4, v21
    v_lshl_add_u32 v10, v20, 5, v21
    v_lshlrev_b32 v12, 4, v1
    s_add_u32 s64, s36, 0x600000
    s_addc_u32 s65, s37, 0
    s_mov_b32 s66, 0x240000
    s_mov_b32 s67, 0x20000
    s_mov_b32 s10, 0x8080
    s_lshl_b32 s92, s86, 19
    s_lshl_b32 s93, s90, 6
    s_add_u32 s92, s92, s93
    s_lshl_b32 s93, s86, 16
    s_lshl_b32 s95, s88, 6
    s_add_u32 s93, s93, s95
    s_add_u32 s93, s93, 2064384
    s_cmp_eq_u32 s87, 2
    s_cselect_b32 s6, s93, s92
    s_cselect_b32 s8, 0x1080, s10
    s_cselect_b32 s92, 1, 3
    s_and_b32 s92, s92, s86
    s_lshl_b32 s92, s92, 11
    s_xor_b32 s6, s6, s92
    s_and_b32 s10, s6, 0x7c0
    s_xor_b32 s6, s6, s10
    s_xor_b32 s7, s6, 0x6000
    s_and_b32 s9, s87, 1
    s_lshl_b32 s9, s9, 4
    s_mov_b32 s12, 0x55555555
    s_mov_b32 s13, 0x55555555
    s_lshl_b32 s92, s86, 8
    s_add_u32 s92, s92, s85
    s_add_u32 s92, s92, 36
    v_lshl_add_u32 v124, v1, 2, s92
    s_movk_i32 s92, 192
    s_cmp_eq_u32 s86, 0
    s_cselect_b32 s92, 256, s92
    s_cmp_eq_u32 s86, 3
    s_cselect_b32 s92, 1344, s92
    v_mov_b32 v20, s85
    ds_write_b16 v20, v4 offset:32514
    s_mov_b32 s18, s92
    v_mov_b32 v125, v28
W_12:
    ds_read_b64 v[18:19], v4 offset:208
    s_sub_u32 s39, s39, 1
    s_cbranch_scc1 KS_ABORT
    s_waitcnt lgkmcnt(0)
    v_and_b32 v18, v18, v19
    v_cmp_ne_u32 vcc, s84, v18
    s_cbranch_vccnz W_12
    ds_read2st64_b64 v[28:31], v125 offset0:0 offset1:1
    ds_read2st64_b64 v[32:35], v125 offset0:2 offset1:3
    s_waitcnt lgkmcnt(0)
    v_add_u32_sdwa v108, s85, v28 dst_sel:DWORD dst_unused:UNUSED_PAD src0_sel:DWORD src1_sel:WORD_0
    v_add_u32_sdwa v109, s85, v28 dst_sel:DWORD dst_unused:UNUSED_PAD src0_sel:DWORD src1_sel:WORD_1
    v_cvt_f32_u32_sdwa v110, v29 dst_sel:DWORD dst_unused:UNUSED_PAD src0_sel:WORD_0
    v_cvt_f32_u32_sdwa v111, v29 dst_sel:DWORD dst_unused:UNUSED_PAD src0_sel:WORD_1
    v_add_u32_sdwa v112, s85, v30 dst_sel:DWORD dst_unused:UNUSED_PAD src0_sel:DWORD src1_sel:WORD_0
    v_add_u32_sdwa v113, s85, v30 dst_sel:DWORD dst_unused:UNUSED_PAD src0_sel:DWORD src1_sel:WORD_1
    v_cvt_f32_u32_sdwa v114, v31 dst_sel:DWORD dst_unused:UNUSED_PAD src0_sel:WORD_0
    v_cvt_f32_u32_sdwa v115, v31 dst_sel:DWORD dst_unused:UNUSED_PAD src0_sel:WORD_1
    v_add_u32_sdwa v116, s85, v32 dst_sel:DWORD dst_unused:UNUSED_PAD src0_sel:DWORD src1_sel:WORD_0
    v_add_u32_sdwa v117, s85, v32 dst_sel:DWORD dst_unused:UNUSED_PAD src0_sel:DWORD src1_sel:WORD_1
    v_add_u32_sdwa v118, s85, v33 dst_sel:DWORD dst_unused:UNUSED_PAD src0_sel:DWORD src1_sel:WORD_0
    v_add_u32_sdwa v119, s85, v33 dst_sel:DWORD dst_unused:UNUSED_PAD src0_sel:DWORD src1_sel:WORD_1
    v_add_u32_sdwa v120, s85, v34 dst_sel:DWORD dst_unused:UNUSED_PAD src0_sel:DWORD src1_sel:WORD_0
    v_add_u32_sdwa v121, s85, v34 dst_sel:DWORD dst_unused:UNUSED_PAD src0_sel:DWORD src1_sel:WORD_1
    v_add_u32_sdwa v122, s85, v35 dst_sel:DWORD dst_unused:UNUSED_PAD src0_sel:DWORD src1_sel:WORD_0
    v_add_u32_sdwa v123, s85, v35 dst_sel:DWORD dst_unused:UNUSED_PAD src0_sel:DWORD src1_sel:WORD_1
    v_add_u32 v125, s18, v119
    s_lshl_b32 s92, s87, 5
    s_add_u32 s92, s92, s41
    s_cmp_ge_u32 s92, 88
    s_cbranch_scc1 KC_RECV
    s_mov_b32 s92, 0x3fb8aa3b
    s_mov_b32 s93, 0x32a57060
    s_mov_b32 s94, 0x3e22f983
    s_mov_b32 s95, 0x31dc9c88
    s_waitcnt vmcnt(7)
    v_lshlrev_b32 v16, 16, v46
    v_mul_f32 v17, s92, v16
    v_fma_f32 v19, v16, s92, -v17
    v_fmac_f32 v19, s93, v16
    v_exp_f32 v17, v17
    v_mul_f32 v19, 0x3f317218, v19
    v_fmac_f32 v17, v17, v19
    v_cvt_pk_bf16_f32 v16, 0, v17
    s_waitcnt vmcnt(5)
    ds_write_b32 v4, v5 offset:36
    v_lshlrev_b32 v20, 16, v40
    v_and_b32 v21, 0xffff0000, v40
    v_lshlrev_b32 v22, 16, v41
    v_and_b32 v23, 0xffff0000, v41
    v_pk_mul_f32 v[20:21], v[20:21], v[16:17] op_sel_hi:[1,0]
    v_pk_mul_f32 v[22:23], v[22:23], v[16:17] op_sel_hi:[1,0]
    v_max_f32 v36, v20, v21
    v_pk_mul_f32 v[68:69], v[22:23], s[94:95] op_sel_hi:[1,0]
    v_pk_fma_f32 v[70:71], v[22:23], s[94:95], v[68:69] op_sel_hi:[1,0,1] neg_lo:[0,0,1] neg_hi:[0,0,1]
    v_pk_fma_f32 v[70:71], v[22:23], s[94:95], v[70:71] op_sel:[0,1,0]
    s_cmp_eq_u32 s86, 3
    s_cbranch_scc1 SK_14
    s_waitcnt vmcnt(1)
    v_lshlrev_b32 v24, 16, v42
    v_and_b32 v25, 0xffff0000, v42
    v_lshlrev_b32 v26, 16, v43
    v_and_b32 v27, 0xffff0000, v43
    v_lshlrev_b32 v28, 16, v44
    v_and_b32 v29, 0xffff0000, v44
    v_lshlrev_b32 v30, 16, v45
    v_and_b32 v31, 0xffff0000, v45
    v_pk_mul_f32 v[24:25], v[24:25], v[16:17] op_sel_hi:[1,0]
    v_pk_mul_f32 v[26:27], v[26:27], v[16:17] op_sel_hi:[1,0]
    v_pk_mul_f32 v[90:91], v[30:31], v[26:27]
    v_pk_mul_f32 v[92:93], v[30:31], v[24:25]
    v_pk_fma_f32 v[34:35], v[28:29], v[26:27], v[92:93]
    v_pk_fma_f32 v[32:33], v[28:29], v[24:25], v[90:91] neg_lo:[0,0,1] neg_hi:[0,0,1]
    v_max3_f32 v37, abs(v34), abs(v35), abs(v32)
    v_max_f32 v37, v37, abs(v33)
SK_14:
    s_waitcnt vmcnt(0)
    s_nop 0
    v_permlane32_swap_b32 v36, v37
    v_max_f32 v36, v36, v37
    s_nop 1
    v_max_f32_dpp v36, v36, v36 row_ror:8 row_mask:0xf bank_mask:0xf
    s_nop 1
    v_max_f32_dpp v36, v36, v36 row_ror:4 row_mask:0xf bank_mask:0xf
    s_nop 1
    v_max_f32_dpp v36, v36, v36 row_ror:2 row_mask:0xf bank_mask:0xf
    s_nop 1
    v_max_f32_dpp v36, v36, v36 row_ror:1 row_mask:0xf bank_mask:0xf
    v_mov_b32 v38, v36
    s_nop 1
    v_permlane16_swap_b32 v36, v38
    v_max_f32 v36, v36, v38
    s_nop 0
    v_readlane_b32 s14, v36, 0
    v_readlane_b32 s15, v36, 32
    s_add_u32 s15, s15, 0x7fffff
    s_lshr_b32 s15, s15, 23
    s_max_u32 s15, s15, 24
    s_sub_u32 s16, 269, s15
    s_lshl_b32 s16, s16, 23
    v_subrev_f32 v20, s14, v20
    v_subrev_f32 v21, s14, v21
    v_mul_f32 v20, 0x3fb8aa3b, v20
    v_mul_f32 v21, 0x3fb8aa3b, v21
    s_cmp_eq_u32 s86, 3
    s_cbranch_scc1 JOB_18
    s_cmp_eq_u32 s86, 1
    s_cbranch_scc1 JOB_16
    s_cmp_eq_u32 s86, 2
    s_cbranch_scc1 JOB_17
    v_mul_f32 v91, 0x43000000, v68
    v_mul_f32 v90, 0x43000000, v20
    v_mul_f32 v95, 0x43000000, v69
    v_mul_f32 v94, 0x43000000, v21
    v_fract_f32 v91, v91
    v_fract_f32 v95, v95
    v_fmac_f32 v91, 0x43000000, v70
    v_fmac_f32 v95, 0x43000000, v71
    v_exp_f32 v90, v90
    v_cos_f32 v92, v91
    v_sin_f32 v91, v91
    v_exp_f32 v94, v94
    v_cos_f32 v96, v95
    v_sin_f32 v95, v95
    v_mul_f32 v44, v90, v92
    v_mul_f32 v46, v90, v91
    v_mul_f32 v45, v94, v96
    v_mul_f32 v47, v94, v95
    v_pk_mul_f32 v[32:33], v[32:33], s[16:17] op_sel_hi:[1,0]
    v_pk_mul_f32 v[34:35], v[34:35], s[16:17] op_sel_hi:[1,0]
    v_fract_f32 v91, v68
    v_fract_f32 v95, v69
    v_fmac_f32 v91, 1.0, v70
    v_fmac_f32 v95, 1.0, v71
    v_exp_f32 v90, v20
    v_cos_f32 v92, v91
    v_sin_f32 v91, v91
    v_exp_f32 v94, v21
    v_cos_f32 v96, v95
    v_sin_f32 v95, v95
    v_mul_f32 v40, v90, v92
    v_mul_f32 v42, v90, v91
    v_mul_f32 v41, v94, v96
    v_mul_f32 v43, v94, v95
    v_pk_mul_f32 v[90:91], v[34:35], v[46:47]
    v_pk_mul_f32 v[94:95], v[34:35], v[42:43]
    v_pk_mul_f32 v[92:93], v[34:35], v[44:45]
    v_pk_mul_f32 v[96:97], v[34:35], v[40:41]
    v_pk_fma_f32 v[62:63], v[32:33], v[46:47], v[92:93]
    v_pk_fma_f32 v[54:55], v[32:33], v[42:43], v[96:97]
    v_pk_fma_f32 v[60:61], v[32:33], v[44:45], v[90:91] neg_lo:[0,0,1] neg_hi:[0,0,1]
    v_pk_fma_f32 v[52:53], v[32:33], v[40:41], v[94:95] neg_lo:[0,0,1] neg_hi:[0,0,1]
    v_cvt_pk_f16_f32 v98, v32, v34
    v_cvt_pk_f16_f32 v99, v33, v35
    v_cvt_pk_f16_f32 v100, v60, v62
    v_cvt_pk_f16_f32 v101, v61, v63
    ds_write2_b64 v72, v[98:99], v[100:101] offset0:0 offset1:68
    v_pk_mul_f32 v[90:91], v[54:55], v[46:47]
    v_pk_mul_f32 v[94:95], v[54:55], v[42:43]
    v_pk_mul_f32 v[92:93], v[54:55], v[44:45]
    v_pk_mul_f32 v[96:97], v[54:55], v[40:41]
    v_pk_fma_f32 v[62:63], v[52:53], v[46:47], v[92:93]
    v_pk_fma_f32 v[58:59], v[52:53], v[42:43], v[96:97]
    v_pk_fma_f32 v[60:61], v[52:53], v[44:45], v[90:91] neg_lo:[0,0,1] neg_hi:[0,0,1]
    v_pk_fma_f32 v[56:57], v[52:53], v[40:41], v[94:95] neg_lo:[0,0,1] neg_hi:[0,0,1]
    v_cvt_pk_f16_f32 v76, v52, v54
    v_cvt_pk_f16_f32 v77, v53, v55
    v_cvt_pk_f16_f32 v78, v60, v62
    v_cvt_pk_f16_f32 v79, v61, v63
    ds_write2_b64 v72, v[76:77], v[78:79] offset0:136 offset1:204
    v_pk_mul_f32 v[90:91], v[58:59], v[46:47]
    v_pk_mul_f32 v[94:95], v[58:59], v[42:43]
    v_pk_mul_f32 v[92:93], v[58:59], v[44:45]
    v_pk_mul_f32 v[96:97], v[58:59], v[40:41]
    v_pk_fma_f32 v[62:63], v[56:57], v[46:47], v[92:93]
    v_pk_fma_f32 v[54:55], v[56:57], v[42:43], v[96:97]
    v_pk_fma_f32 v[60:61], v[56:57], v[44:45], v[90:91] neg_lo:[0,0,1] neg_hi:[0,0,1]
    v_pk_fma_f32 v[52:53], v[56:57], v[40:41], v[94:95] neg_lo:[0,0,1] neg_hi:[0,0,1]
    v_cvt_pk_f16_f32 v98, v56, v58
    v_cvt_pk_f16_f32 v99, v57, v59
    v_cvt_pk_f16_f32 v100, v60, v62
    v_cvt_pk_f16_f32 v101, v61, v63
    ds_write2_b64 v73, v[98:99], v[100:101] offset0:0 offset1:68
    v_pk_mul_f32 v[90:91], v[54:55], v[46:47]
    v_pk_mul_f32 v[94:95], v[54:55], v[42:43]
    v_pk_mul_f32 v[92:93], v[54:55], v[44:45]
    v_pk_mul_f32 v[96:97], v[54:55], v[40:41]
    v_pk_fma_f32 v[62:63], v[52:53], v[46:47], v[92:93]
    v_pk_fma_f32 v[58:59], v[52:53], v[42:43], v[96:97]
    v_pk_fma_f32 v[60:61], v[52:53], v[44:45], v[90:91] neg_lo:[0,0,1] neg_hi:[0,0,1]
    v_pk_fma_f32 v[56:57], v[52:53], v[40:41], v[94:95] neg_lo:[0,0,1] neg_hi:[0,0,1]
    v_cvt_pk_f16_f32 v76, v52, v54
    v_cvt_pk_f16_f32 v77, v53, v55
    v_cvt_pk_f16_f32 v78, v60, v62
    v_cvt_pk_f16_f32 v79, v61, v63
    ds_write2_b64 v73, v[76:77], v[78:79] offset0:136 offset1:204
    v_pk_mul_f32 v[90:91], v[58:59], v[46:47]
    v_pk_mul_f32 v[94:95], v[58:59], v[42:43]
    v_pk_mul_f32 v[92:93], v[58:59], v[44:45]
    v_pk_mul_f32 v[96:97], v[58:59], v[40:41]
    v_pk_fma_f32 v[62:63], v[56:57], v[46:47], v[92:93]
    v_pk_fma_f32 v[54:55], v[56:57], v[42:43], v[96:97]
    v_pk_fma_f32 v[60:61], v[56:57], v[44:45], v[90:91] neg_lo:[0,0,1] neg_hi:[0,0,1]
    v_pk_fma_f32 v[52:53], v[56:57], v[40:41], v[94:95] neg_lo:[0,0,1] neg_hi:[0,0,1]
    v_cvt_pk_f16_f32 v98, v56, v58
    v_cvt_pk_f16_f32 v99, v57, v59
    v_cvt_pk_f16_f32 v100, v60, v62
    v_cvt_pk_f16_f32 v101, v61, v63
    ds_write2_b64 v74, v[98:99], v[100:101] offset0:0 offset1:68
    v_pk_mul_f32 v[90:91], v[54:55], v[46:47]
    v_pk_mul_f32 v[94:95], v[54:55], v[42:43]
    v_pk_mul_f32 v[92:93], v[54:55], v[44:45]
    v_pk_mul_f32 v[96:97], v[54:55], v[40:41]
    v_pk_fma_f32 v[62:63], v[52:53], v[46:47], v[92:93]
    v_pk_fma_f32 v[58:59], v[52:53], v[42:43], v[96:97]
    v_pk_fma_f32 v[60:61], v[52:53], v[44:45], v[90:91] neg_lo:[0,0,1] neg_hi:[0,0,1]
    v_pk_fma_f32 v[56:57], v[52:53], v[40:41], v[94:95] neg_lo:[0,0,1] neg_hi:[0,0,1]
    v_cvt_pk_f16_f32 v76, v52, v54
    v_cvt_pk_f16_f32 v77, v53, v55
    v_cvt_pk_f16_f32 v78, v60, v62
    v_cvt_pk_f16_f32 v79, v61, v63
    ds_write2_b64 v74, v[76:77], v[78:79] offset0:136 offset1:204
    v_pk_mul_f32 v[90:91], v[58:59], v[46:47]
    v_pk_mul_f32 v[94:95], v[58:59], v[42:43]
    v_pk_mul_f32 v[92:93], v[58:59], v[44:45]
    v_pk_mul_f32 v[96:97], v[58:59], v[40:41]
    v_pk_fma_f32 v[62:63], v[56:57], v[46:47], v[92:93]
    v_pk_fma_f32 v[54:55], v[56:57], v[42:43], v[96:97]
    v_pk_fma_f32 v[60:61], v[56:57], v[44:45], v[90:91] neg_lo:[0,0,1] neg_hi:[0,0,1]
    v_pk_fma_f32 v[52:53], v[56:57], v[40:41], v[94:95] neg_lo:[0,0,1] neg_hi:[0,0,1]
    v_cvt_pk_f16_f32 v98, v56, v58
    v_cvt_pk_f16_f32 v99, v57, v59
    v_cvt_pk_f16_f32 v100, v60, v62
    v_cvt_pk_f16_f32 v101, v61, v63
    ds_write2_b64 v75, v[98:99], v[100:101] offset0:0 offset1:68
    v_pk_mul_f32 v[90:91], v[54:55], v[46:47]
    v_pk_mul_f32 v[92:93], v[54:55], v[44:45]
    v_pk_fma_f32 v[62:63], v[52:53], v[46:47], v[92:93]
    v_pk_fma_f32 v[60:61], v[52:53], v[44:45], v[90:91] neg_lo:[0,0,1] neg_hi:[0,0,1]
    v_cvt_pk_f16_f32 v76, v52, v54
    v_cvt_pk_f16_f32 v77, v53, v55
    v_cvt_pk_f16_f32 v78, v60, v62
    v_cvt_pk_f16_f32 v79, v61, v63
    ds_write2_b64 v75, v[76:77], v[78:79] offset0:136 offset1:204
    s_branch JOBJ_19
JOB_16:
    v_mul_f32 v91, 0x43000000, v68
    v_mul_f32 v90, 0x43000000, v20
    v_mul_f32 v95, 0x43000000, v69
    v_mul_f32 v94, 0x43000000, v21
    v_fract_f32 v91, v91
    v_fract_f32 v95, v95
    v_fmac_f32 v91, 0x43000000, v70
    v_fmac_f32 v95, 0x43000000, v71
    v_exp_f32 v90, v90
    v_cos_f32 v92, v91
    v_sin_f32 v91, v91
    v_exp_f32 v94, v94
    v_cos_f32 v96, v95
    v_sin_f32 v95, v95
    v_mul_f32 v44, v90, v92
    v_mul_f32 v46, v90, v91
    v_mul_f32 v45, v94, v96
    v_mul_f32 v47, v94, v95
    v_pk_mul_f32 v[32:33], v[32:33], s[16:17] op_sel_hi:[1,0]
    v_pk_mul_f32 v[34:35], v[34:35], s[16:17] op_sel_hi:[1,0]
    v_pk_mul_f32 v[90:91], v[46:47], v[46:47]
    v_pk_mul_f32 v[92:93], v[44:45], v[46:47]
    v_pk_fma_f32 v[48:49], v[44:45], v[44:45], v[90:91] neg_lo:[0,0,1] neg_hi:[0,0,1]
    v_pk_add_f32 v[50:51], v[92:93], v[92:93]
    v_mul_f32 v91, 2.0, v68
    v_mul_f32 v90, 2.0, v20
    v_mul_f32 v95, 2.0, v69
    v_mul_f32 v94, 2.0, v21
    v_fract_f32 v91, v91
    v_fract_f32 v95, v95
    v_fmac_f32 v91, 2.0, v70
    v_fmac_f32 v95, 2.0, v71
    v_exp_f32 v90, v90
    v_cos_f32 v92, v91
    v_sin_f32 v91, v91
    v_exp_f32 v94, v94
    v_cos_f32 v96, v95
    v_sin_f32 v95, v95
    v_mul_f32 v40, v90, v92
    v_mul_f32 v42, v90, v91
    v_mul_f32 v41, v94, v96
    v_mul_f32 v43, v94, v95
    v_pk_mul_f32 v[90:91], v[34:35], v[50:51]
    v_pk_mul_f32 v[92:93], v[34:35], v[48:49]
    v_pk_fma_f32 v[54:55], v[32:33], v[50:51], v[92:93]
    v_pk_fma_f32 v[52:53], v[32:33], v[48:49], v[90:91] neg_lo:[0,0,1] neg_hi:[0,0,1]
    v_pk_mul_f32 v[90:91], v[54:55], v[50:51]
    v_pk_mul_f32 v[92:93], v[54:55], v[48:49]
    v_pk_fma_f32 v[66:67], v[52:53], v[50:51], v[92:93]
    v_pk_fma_f32 v[64:65], v[52:53], v[48:49], v[90:91] neg_lo:[0,0,1] neg_hi:[0,0,1]
    v_pk_mul_f32 v[90:91], v[54:55], v[46:47]
    v_pk_mul_f32 v[94:95], v[54:55], v[42:43]
    v_pk_mul_f32 v[92:93], v[54:55], v[44:45]
    v_pk_mul_f32 v[96:97], v[54:55], v[40:41]
    v_pk_fma_f32 v[62:63], v[52:53], v[46:47], v[92:93]
    v_pk_fma_f32 v[58:59], v[52:53], v[42:43], v[96:97]
    v_pk_fma_f32 v[60:61], v[52:53], v[44:45], v[90:91] neg_lo:[0,0,1] neg_hi:[0,0,1]
    v_pk_fma_f32 v[56:57], v[52:53], v[40:41], v[94:95] neg_lo:[0,0,1] neg_hi:[0,0,1]
    v_cvt_pk_f16_f32 v98, v52, v54
    v_cvt_pk_f16_f32 v99, v53, v55
    v_cvt_pk_f16_f32 v100, v60, v62
    v_cvt_pk_f16_f32 v101, v61, v63
    ds_write2_b64 v72, v[98:99], v[100:101] offset0:0 offset1:68
    v_pk_mul_f32 v[90:91], v[58:59], v[46:47]
    v_pk_mul_f32 v[94:95], v[58:59], v[42:43]
    v_pk_mul_f32 v[92:93], v[58:59], v[44:45]
    v_pk_mul_f32 v[96:97], v[58:59], v[40:41]
    v_pk_fma_f32 v[62:63], v[56:57], v[46:47], v[92:93]
    v_pk_fma_f32 v[54:55], v[56:57], v[42:43], v[96:97]
    v_pk_fma_f32 v[60:61], v[56:57], v[44:45], v[90:91] neg_lo:[0,0,1] neg_hi:[0,0,1]
    v_pk_fma_f32 v[52:53], v[56:57], v[40:41], v[94:95] neg_lo:[0,0,1] neg_hi:[0,0,1]
    v_cvt_pk_f16_f32 v76, v56, v58
    v_cvt_pk_f16_f32 v77, v57, v59
    v_cvt_pk_f16_f32 v78, v60, v62
    v_cvt_pk_f16_f32 v79, v61, v63
    ds_write2_b64 v72, v[76:77], v[78:79] offset0:136 offset1:204
    v_pk_mul_f32 v[90:91], v[54:55], v[46:47]
    v_pk_mul_f32 v[94:95], v[54:55], v[42:43]
    v_pk_mul_f32 v[92:93], v[54:55], v[44:45]
    v_pk_mul_f32 v[96:97], v[54:55], v[40:41]
    v_pk_fma_f32 v[62:63], v[52:53], v[46:47], v[92:93]
    v_pk_fma_f32 v[58:59], v[52:53], v[42:43], v[96:97]
    v_pk_fma_f32 v[60:61], v[52:53], v[44:45], v[90:91] neg_lo:[0,0,1] neg_hi:[0,0,1]
    v_pk_fma_f32 v[56:57], v[52:53], v[40:41], v[94:95] neg_lo:[0,0,1] neg_hi:[0,0,1]
    v_cvt_pk_f16_f32 v98, v52, v54
    v_cvt_pk_f16_f32 v99, v53, v55
    v_cvt_pk_f16_f32 v100, v60, v62
    v_cvt_pk_f16_f32 v101, v61, v63
    ds_write2_b64 v73, v[98:99], v[100:101] offset0:0 offset1:68
    v_pk_mul_f32 v[90:91], v[58:59], v[46:47]
    v_pk_mul_f32 v[94:95], v[42:43], v[42:43]
    v_pk_mul_f32 v[92:93], v[58:59], v[44:45]
    v_pk_mul_f32 v[96:97], v[40:41], v[42:43]
    v_pk_fma_f32 v[62:63], v[56:57], v[46:47], v[92:93]
    v_pk_fma_f32 v[48:49], v[40:41], v[40:41], v[94:95] neg_lo:[0,0,1] neg_hi:[0,0,1]
    v_pk_fma_f32 v[60:61], v[56:57], v[44:45], v[90:91] neg_lo:[0,0,1] neg_hi:[0,0,1]
    v_pk_add_f32 v[50:51], v[96:97], v[96:97]
    v_cvt_pk_f16_f32 v76, v56, v58
    v_cvt_pk_f16_f32 v77, v57, v59
    v_cvt_pk_f16_f32 v78, v60, v62
    v_cvt_pk_f16_f32 v79, v61, v63
    ds_write2_b64 v73, v[76:77], v[78:79] offset0:136 offset1:204
    v_pk_mul_f32 v[90:91], v[66:67], v[50:51]
    v_pk_mul_f32 v[94:95], v[66:67], v[46:47]
    v_pk_mul_f32 v[92:93], v[66:67], v[48:49]
    v_pk_mul_f32 v[96:97], v[66:67], v[44:45]
    v_pk_fma_f32 v[62:63], v[64:65], v[50:51], v[92:93]
    v_pk_fma_f32 v[54:55], v[64:65], v[46:47], v[96:97]
    v_pk_fma_f32 v[60:61], v[64:65], v[48:49], v[90:91] neg_lo:[0,0,1] neg_hi:[0,0,1]
    v_pk_fma_f32 v[52:53], v[64:65], v[44:45], v[94:95] neg_lo:[0,0,1] neg_hi:[0,0,1]
    v_cvt_pk_f16_f32 v98, v64, v66
    v_cvt_pk_f16_f32 v99, v65, v67
    v_cvt_pk_f16_f32 v100, v60, v62
    v_cvt_pk_f16_f32 v101, v61, v63
    ds_write2_b64 v74, v[98:99], v[100:101] offset0:0 offset1:68
    v_pk_mul_f32 v[90:91], v[54:55], v[50:51]
    v_pk_mul_f32 v[94:95], v[54:55], v[46:47]
    v_pk_mul_f32 v[92:93], v[54:55], v[48:49]
    v_pk_mul_f32 v[96:97], v[54:55], v[44:45]
    v_pk_fma_f32 v[62:63], v[52:53], v[50:51], v[92:93]
    v_pk_fma_f32 v[58:59], v[52:53], v[46:47], v[96:97]
    v_pk_fma_f32 v[60:61], v[52:53], v[48:49], v[90:91] neg_lo:[0,0,1] neg_hi:[0,0,1]
    v_pk_fma_f32 v[56:57], v[52:53], v[44:45], v[94:95] neg_lo:[0,0,1] neg_hi:[0,0,1]
    v_cvt_pk_f16_f32 v76, v52, v54
    v_cvt_pk_f16_f32 v77, v53, v55
    v_cvt_pk_f16_f32 v78, v60, v62
    v_cvt_pk_f16_f32 v79, v61, v63
    ds_write2_b64 v74, v[76:77], v[78:79] offset0:136 offset1:204
    v_pk_mul_f32 v[90:91], v[58:59], v[50:51]
    v_pk_mul_f32 v[94:95], v[58:59], v[46:47]
    v_pk_mul_f32 v[92:93], v[58:59], v[48:49]
    v_pk_mul_f32 v[96:97], v[58:59], v[44:45]
    v_pk_fma_f32 v[62:63], v[56:57], v[50:51], v[92:93]
    v_pk_fma_f32 v[54:55], v[56:57], v[46:47], v[96:97]
    v_pk_fma_f32 v[60:61], v[56:57], v[48:49], v[90:91] neg_lo:[0,0,1] neg_hi:[0,0,1]
    v_pk_fma_f32 v[52:53], v[56:57], v[44:45], v[94:95] neg_lo:[0,0,1] neg_hi:[0,0,1]
    v_cvt_pk_f16_f32 v98, v56, v58
    v_cvt_pk_f16_f32 v99, v57, v59
    v_cvt_pk_f16_f32 v100, v60, v62
    v_cvt_pk_f16_f32 v101, v61, v63
    ds_write2_b64 v75, v[98:99], v[100:101] offset0:0 offset1:68
    v_pk_mul_f32 v[90:91], v[54:55], v[50:51]
    v_pk_mul_f32 v[92:93], v[54:55], v[48:49]
    v_pk_fma_f32 v[62:63], v[52:53], v[50:51], v[92:93]
    v_pk_fma_f32 v[60:61], v[52:53], v[48:49], v[90:91] neg_lo:[0,0,1] neg_hi:[0,0,1]
    v_cvt_pk_f16_f32 v76, v52, v54
    v_cvt_pk_f16_f32 v77, v53, v55
    v_cvt_pk_f16_f32 v78, v60, v62
    v_cvt_pk_f16_f32 v79, v61, v63
    ds_write2_b64 v75, v[76:77], v[78:79] offset0:136 offset1:204
    s_branch JOBJ_19
JOB_18:
    v_mul_f32 v91, 0x41000000, v68
    v_mul_f32 v90, 0x41000000, v20
    v_mul_f32 v95, 0x41000000, v69
    v_mul_f32 v94, 0x41000000, v21
    v_fract_f32 v91, v91
    v_fract_f32 v95, v95
    v_fmac_f32 v91, 0x41000000, v70
    v_fmac_f32 v95, 0x41000000, v71
    v_exp_f32 v90, v90
    v_cos_f32 v92, v91
    v_sin_f32 v91, v91
    v_exp_f32 v94, v94
    v_cos_f32 v96, v95
    v_sin_f32 v95, v95
    v_mul_f32 v40, v90, v92
    v_mul_f32 v42, v90, -v91
    v_mul_f32 v41, v94, v96
    v_mul_f32 v43, v94, -v95
    v_mov_b32 v52, 0x47000000
    v_mov_b32 v53, 0x47000000
    v_mov_b32 v54, 0
    v_mov_b32 v55, 0
    v_pk_mul_f32 v[90:91], v[42:43], v[42:43]
    v_pk_mul_f32 v[60:61], v[40:41], v[52:53]
    v_pk_mul_f32 v[92:93], v[40:41], v[42:43]
    v_pk_mul_f32 v[62:63], v[42:43], v[52:53]
    v_pk_fma_f32 v[44:45], v[40:41], v[40:41], v[90:91] neg_lo:[0,0,1] neg_hi:[0,0,1]
    v_pk_add_f32 v[46:47], v[92:93], v[92:93]
    v_pk_mul_f32 v[56:57], v[44:45], v[52:53]
    v_pk_mul_f32 v[94:95], v[62:63], v[46:47]
    v_pk_mul_f32 v[58:59], v[46:47], v[52:53]
    v_pk_mul_f32 v[96:97], v[62:63], v[44:45]
    v_pk_fma_f32 v[66:67], v[60:61], v[46:47], v[96:97]
    v_pk_fma_f32 v[64:65], v[60:61], v[44:45], v[94:95] neg_lo:[0,0,1] neg_hi:[0,0,1]
    v_cvt_pk_f16_f32 v98, v52, v54
    v_cvt_pk_f16_f32 v99, v53, v55
    v_cvt_pk_f16_f32 v100, v60, v62
    v_cvt_pk_f16_f32 v101, v61, v63
    ds_write2_b64 v72, v[98:99], v[100:101] offset0:0 offset1:68
    v_pk_mul_f32 v[90:91], v[58:59], v[46:47]
    v_pk_mul_f32 v[94:95], v[66:67], v[46:47]
    v_pk_mul_f32 v[92:93], v[58:59], v[44:45]
    v_pk_mul_f32 v[96:97], v[66:67], v[44:45]
    v_pk_fma_f32 v[54:55], v[56:57], v[46:47], v[92:93]
    v_pk_fma_f32 v[62:63], v[64:65], v[46:47], v[96:97]
    v_pk_fma_f32 v[52:53], v[56:57], v[44:45], v[90:91] neg_lo:[0,0,1] neg_hi:[0,0,1]
    v_pk_fma_f32 v[60:61], v[64:65], v[44:45], v[94:95] neg_lo:[0,0,1] neg_hi:[0,0,1]
    v_cvt_pk_f16_f32 v76, v56, v58
    v_cvt_pk_f16_f32 v77, v57, v59
    v_cvt_pk_f16_f32 v78, v64, v66
    v_cvt_pk_f16_f32 v79, v65, v67
    ds_write2_b64 v72, v[76:77], v[78:79] offset0:136 offset1:204
    v_pk_mul_f32 v[90:91], v[54:55], v[46:47]
    v_pk_mul_f32 v[94:95], v[62:63], v[46:47]
    v_pk_mul_f32 v[92:93], v[54:55], v[44:45]
    v_pk_mul_f32 v[96:97], v[62:63], v[44:45]
    v_pk_fma_f32 v[58:59], v[52:53], v[46:47], v[92:93]
    v_pk_fma_f32 v[66:67], v[60:61], v[46:47], v[96:97]
    v_pk_fma_f32 v[56:57], v[52:53], v[44:45], v[90:91] neg_lo:[0,0,1] neg_hi:[0,0,1]
    v_pk_fma_f32 v[64:65], v[60:61], v[44:45], v[94:95] neg_lo:[0,0,1] neg_hi:[0,0,1]
    v_cvt_pk_f16_f32 v98, v52, v54
    v_cvt_pk_f16_f32 v99, v53, v55
    v_cvt_pk_f16_f32 v100, v60, v62
    v_cvt_pk_f16_f32 v101, v61, v63
    ds_write2_b64 v73, v[98:99], v[100:101] offset0:0 offset1:68
    v_pk_mul_f32 v[90:91], v[58:59], v[46:47]
    v_pk_mul_f32 v[94:95], v[66:67], v[46:47]
    v_pk_mul_f32 v[92:93], v[58:59], v[44:45]
    v_pk_mul_f32 v[96:97], v[66:67], v[44:45]
    v_pk_fma_f32 v[54:55], v[56:57], v[46:47], v[92:93]
    v_pk_fma_f32 v[62:63], v[64:65], v[46:47], v[96:97]
    v_pk_fma_f32 v[52:53], v[56:57], v[44:45], v[90:91] neg_lo:[0,0,1] neg_hi:[0,0,1]
    v_pk_fma_f32 v[60:61], v[64:65], v[44:45], v[94:95] neg_lo:[0,0,1] neg_hi:[0,0,1]
    v_cvt_pk_f16_f32 v76, v56, v58
    v_cvt_pk_f16_f32 v77, v57, v59
    v_cvt_pk_f16_f32 v78, v64, v66
    v_cvt_pk_f16_f32 v79, v65, v67
    ds_write2_b64 v73, v[76:77], v[78:79] offset0:136 offset1:204
    v_pk_mul_f32 v[90:91], v[54:55], v[46:47]
    v_pk_mul_f32 v[94:95], v[62:63], v[46:47]
    v_pk_mul_f32 v[92:93], v[54:55], v[44:45]
    v_pk_mul_f32 v[96:97], v[62:63], v[44:45]
    v_pk_fma_f32 v[58:59], v[52:53], v[46:47], v[92:93]
    v_pk_fma_f32 v[66:67], v[60:61], v[46:47], v[96:97]
    v_pk_fma_f32 v[56:57], v[52:53], v[44:45], v[90:91] neg_lo:[0,0,1] neg_hi:[0,0,1]
    v_pk_fma_f32 v[64:65], v[60:61], v[44:45], v[94:95] neg_lo:[0,0,1] neg_hi:[0,0,1]
    v_cvt_pk_f16_f32 v98, v52, v54
    v_cvt_pk_f16_f32 v99, v53, v55
    v_cvt_pk_f16_f32 v100, v60, v62
    v_cvt_pk_f16_f32 v101, v61, v63
    ds_write2_b64 v74, v[98:99], v[100:101] offset0:0 offset1:68
    v_pk_mul_f32 v[90:91], v[58:59], v[46:47]
    v_pk_mul_f32 v[94:95], v[66:67], v[46:47]
    v_pk_mul_f32 v[92:93], v[58:59], v[44:45]
    v_pk_mul_f32 v[96:97], v[66:67], v[44:45]
    v_pk_fma_f32 v[54:55], v[56:57], v[46:47], v[92:93]
    v_pk_fma_f32 v[62:63], v[64:65], v[46:47], v[96:97]
    v_pk_fma_f32 v[52:53], v[56:57], v[44:45], v[90:91] neg_lo:[0,0,1] neg_hi:[0,0,1]
    v_pk_fma_f32 v[60:61], v[64:65], v[44:45], v[94:95] neg_lo:[0,0,1] neg_hi:[0,0,1]
    v_cvt_pk_f16_f32 v76, v56, v58
    v_cvt_pk_f16_f32 v77, v57, v59
    v_cvt_pk_f16_f32 v78, v64, v66
    v_cvt_pk_f16_f32 v79, v65, v67
    ds_write2_b64 v74, v[76:77], v[78:79] offset0:136 offset1:204
    v_pk_mul_f32 v[90:91], v[54:55], v[46:47]
    v_pk_mul_f32 v[94:95], v[62:63], v[46:47]
    v_pk_mul_f32 v[92:93], v[54:55], v[44:45]
    v_pk_mul_f32 v[96:97], v[62:63], v[44:45]
    v_pk_fma_f32 v[58:59], v[52:53], v[46:47], v[92:93]
    v_pk_fma_f32 v[66:67], v[60:61], v[46:47], v[96:97]
    v_pk_fma_f32 v[56:57], v[52:53], v[44:45], v[90:91] neg_lo:[0,0,1] neg_hi:[0,0,1]
    v_pk_fma_f32 v[64:65], v[60:61], v[44:45], v[94:95] neg_lo:[0,0,1] neg_hi:[0,0,1]
    v_cvt_pk_f16_f32 v98, v52, v54
    v_cvt_pk_f16_f32 v99, v53, v55
    v_cvt_pk_f16_f32 v100, v60, v62
    v_cvt_pk_f16_f32 v101, v61, v63
    ds_write2_b64 v75, v[98:99], v[100:101] offset0:0 offset1:68
    v_cvt_pk_f16_f32 v76, v56, v58
    v_cvt_pk_f16_f32 v77, v57, v59
    v_cvt_pk_f16_f32 v78, v64, v66
    v_cvt_pk_f16_f32 v79, v65, v67
    ds_write2_b64 v75, v[76:77], v[78:79] offset0:136 offset1:204
    ds_write_b8 v15, v5 offset:64
    s_cmp_eq_u32 s87, 2
    s_cbranch_scc1 KS_G0
KS_R3:
    ds_write_b8 v15, v5 offset:68
W_20:
    s_sleep 2
    ds_read_u16 v20, v14 offset:68
    s_sub_u32 s39, s39, 1
    s_cbranch_scc1 KS_ABORT
    s_waitcnt lgkmcnt(0)
    v_cmp_eq_u32 vcc, 0, v20
    s_cbranch_vccnz W_20
    s_branch EXP_13
KC_SEND:
W_21:
    ds_read_b32 v104, v105 offset:224
    s_sub_u32 s39, s39, 1
    s_cbranch_scc1 KS_ABORT
    s_waitcnt lgkmcnt(0)
    v_cmp_eq_u32 vcc, 0, v104
    s_cbranch_vccnz W_21
    s_lshl_b32 s92, s88, 12
    s_lshl_b32 s93, s86, 10
    s_add_u32 s92, s92, s93
    s_add_u32 s92, s92, 0x920000
    v_add_u32 v24, s92, v12
    s_mov_b32 s93, 0xffff
    v_lshlrev_b32 v25, 16, v104
    v_cvt_f16_f32 v20, v20
    v_cvt_f16_f32 v21, v21
    v_cvt_f16_f32 v22, v22
    v_cvt_f16_f32 v23, v23
    s_cmp_lg_u32 s86, 2
    s_cbranch_scc1 KC_S2
    s_mov_b32 exec_lo, 0
    s_mov_b32 exec_hi, 0xffff0000
    v_mov_b32 v20, v106
    v_lshrrev_b32 v21, 16, v106
    s_mov_b64 exec, -1
KC_S2:
    v_bfi_b32 v20, s93, v20, v104
    v_bfi_b32 v21, s93, v21, v25
    v_bfi_b32 v22, s93, v22, v104
    v_bfi_b32 v23, s93, v23, v25
    global_store_dwordx4 v24, v[20:23], s[36:37] sc1
    s_branch KS_G0
KC_RECV:
    s_cmp_eq_u32 s86, 3
    s_cbranch_scc1 KS_R3
    s_lshl_b32 s92, s88, 12
    s_lshl_b32 s93, s86, 10
    s_add_u32 s92, s92, s93
    s_add_u32 s92, s92, 0x920000
    v_add_u32 v24, s92, v12
W_22:
    s_sleep 2
    ds_read_b32 v104, v105 offset:224
    s_sub_u32 s39, s39, 1
    s_cbranch_scc1 KS_ABORT
    s_waitcnt lgkmcnt(0)
    v_cmp_eq_u32 vcc, 0, v104
    s_cbranch_vccnz W_22
    v_lshlrev_b32 v25, 16, v104
W_23:
    s_sleep 2
    ds_read_b32 v17, v4 offset:72
    s_sub_u32 s39, s39, 1
    s_cbranch_scc1 KS_ABORT
    s_waitcnt lgkmcnt(0)
    v_cmp_ne_u32 vcc, s84, v17
    s_cbranch_vccnz W_23
    s_sleep 8
    s_branch KPE_25
KP_24:
    s_sleep 2
KPE_25:
    global_load_dwordx4 v[20:23], v24, s[36:37] sc1
    s_sub_u32 s39, s39, 1
    s_cbranch_scc1 KS_ABORT
    s_waitcnt vmcnt(0)
    v_xor_b32 v20, v104, v20
    v_xor_b32 v21, v25, v21
    v_xor_b32 v22, v104, v22
    v_xor_b32 v23, v25, v23
    v_or3_b32 v26, v20, v21, v22
    v_or_b32 v26, v26, v23
    v_cmp_lt_u32 vcc, 0xffff, v26
    s_cbranch_vccnz KP_24
    v_xor_b32 v20, v104, v20
    v_xor_b32 v22, v104, v22
    ds_write_b16 v108, v20
    ds_write_b16 v109, v21
    ds_write_b16 v112, v22
    ds_write_b16 v113, v23
    s_cmp_lg_u32 s86, 2
    s_cbranch_scc1 EXP_13
    v_and_b32 v20, 0xffff, v20
    v_lshl_or_b32 v20, v21, 16, v20
    v_lshlrev_b32 v21, 16, v107
    s_mov_b32 exec_lo, 0
    s_mov_b32 exec_hi, 0x10000
    ds_write_b64 v14, v[20:21] offset:832
    s_mov_b64 exec, -1
    s_branch EXP_13
JOB_17:
    v_mul_f32 v91, 0x43000000, v68
    v_mul_f32 v90, 0x43000000, v20
    v_mul_f32 v95, 0x43000000, v69
    v_mul_f32 v94, 0x43000000, v21
    v_fract_f32 v91, v91
    v_fract_f32 v95, v95
    v_fmac_f32 v91, 0x43000000, v70
    v_fmac_f32 v95, 0x43000000, v71
    v_exp_f32 v90, v90
    v_cos_f32 v92, v91
    v_sin_f32 v91, v91
    v_exp_f32 v94, v94
    v_cos_f32 v96, v95
    v_sin_f32 v95, v95
    v_mul_f32 v44, v90, v92
    v_mul_f32 v46, v90, v91
    v_mul_f32 v45, v94, v96
    v_mul_f32 v47, v94, v95
    v_pk_mul_f32 v[32:33], v[32:33], s[16:17] op_sel_hi:[1,0]
    v_pk_mul_f32 v[34:35], v[34:35], s[16:17] op_sel_hi:[1,0]
    v_pk_mul_f32 v[90:91], v[46:47], v[46:47]
    v_pk_mul_f32 v[94:95], v[34:35], v[46:47]
    v_pk_mul_f32 v[92:93], v[44:45], v[46:47]
    v_pk_mul_f32 v[96:97], v[34:35], v[44:45]
    v_pk_fma_f32 v[40:41], v[44:45], v[44:45], v[90:91] neg_lo:[0,0,1] neg_hi:[0,0,1]
    v_pk_fma_f32 v[66:67], v[32:33], v[46:47], v[96:97]
    v_pk_add_f32 v[42:43], v[92:93], v[92:93]
    v_pk_fma_f32 v[64:65], v[32:33], v[44:45], v[94:95] neg_lo:[0,0,1] neg_hi:[0,0,1]
    v_pk_mul_f32 v[90:91], v[42:43], v[42:43]
    v_pk_mul_f32 v[92:93], v[40:41], v[42:43]
    v_pk_fma_f32 v[48:49], v[40:41], v[40:41], v[90:91] neg_lo:[0,0,1] neg_hi:[0,0,1]
    v_pk_add_f32 v[50:51], v[92:93], v[92:93]
    v_pk_mul_f32 v[90:91], v[50:51], v[50:51]
    v_pk_mul_f32 v[92:93], v[48:49], v[50:51]
    v_pk_fma_f32 v[48:49], v[48:49], v[48:49], v[90:91] neg_lo:[0,0,1] neg_hi:[0,0,1]
    v_pk_add_f32 v[50:51], v[92:93], v[92:93]
    v_pk_mul_f32 v[90:91], v[34:35], v[50:51]
    v_pk_mul_f32 v[94:95], v[66:67], v[50:51]
    v_pk_mul_f32 v[92:93], v[34:35], v[48:49]
    v_pk_mul_f32 v[96:97], v[66:67], v[48:49]
    v_pk_fma_f32 v[54:55], v[32:33], v[50:51], v[92:93]
    v_pk_fma_f32 v[62:63], v[64:65], v[50:51], v[96:97]
    v_pk_fma_f32 v[52:53], v[32:33], v[48:49], v[90:91] neg_lo:[0,0,1] neg_hi:[0,0,1]
    v_pk_fma_f32 v[60:61], v[64:65], v[48:49], v[94:95] neg_lo:[0,0,1] neg_hi:[0,0,1]
    v_pk_mul_f32 v[90:91], v[54:55], v[42:43]
    v_pk_mul_f32 v[94:95], v[62:63], v[42:43]
    v_pk_mul_f32 v[92:93], v[54:55], v[40:41]
    v_pk_mul_f32 v[96:97], v[62:63], v[40:41]
    v_pk_fma_f32 v[58:59], v[52:53], v[42:43], v[92:93]
    v_pk_fma_f32 v[66:67], v[60:61], v[42:43], v[96:97]
    v_pk_fma_f32 v[56:57], v[52:53], v[40:41], v[90:91] neg_lo:[0,0,1] neg_hi:[0,0,1]
    v_pk_fma_f32 v[64:65], v[60:61], v[40:41], v[94:95] neg_lo:[0,0,1] neg_hi:[0,0,1]
    v_cvt_pk_f16_f32 v98, v52, v54
    v_cvt_pk_f16_f32 v99, v53, v55
    v_cvt_pk_f16_f32 v100, v60, v62
    v_cvt_pk_f16_f32 v101, v61, v63
    ds_write2_b64 v72, v[98:99], v[100:101] offset0:0 offset1:68
    v_pk_mul_f32 v[90:91], v[58:59], v[42:43]
    v_pk_mul_f32 v[94:95], v[66:67], v[42:43]
    v_pk_mul_f32 v[92:93], v[58:59], v[40:41]
    v_pk_mul_f32 v[96:97], v[66:67], v[40:41]
    v_pk_fma_f32 v[54:55], v[56:57], v[42:43], v[92:93]
    v_pk_fma_f32 v[62:63], v[64:65], v[42:43], v[96:97]
    v_pk_fma_f32 v[52:53], v[56:57], v[40:41], v[90:91] neg_lo:[0,0,1] neg_hi:[0,0,1]
    v_pk_fma_f32 v[60:61], v[64:65], v[40:41], v[94:95] neg_lo:[0,0,1] neg_hi:[0,0,1]
    v_cvt_pk_f16_f32 v76, v56, v58
    v_cvt_pk_f16_f32 v77, v57, v59
    v_cvt_pk_f16_f32 v78, v64, v66
    v_cvt_pk_f16_f32 v79, v65, v67
    ds_write2_b64 v72, v[76:77], v[78:79] offset0:136 offset1:204
    v_pk_mul_f32 v[90:91], v[54:55], v[42:43]
    v_pk_mul_f32 v[94:95], v[62:63], v[42:43]
    v_pk_mul_f32 v[92:93], v[54:55], v[40:41]
    v_pk_mul_f32 v[96:97], v[62:63], v[40:41]
    v_pk_fma_f32 v[58:59], v[52:53], v[42:43], v[92:93]
    v_pk_fma_f32 v[66:67], v[60:61], v[42:43], v[96:97]
    v_pk_fma_f32 v[56:57], v[52:53], v[40:41], v[90:91] neg_lo:[0,0,1] neg_hi:[0,0,1]
    v_pk_fma_f32 v[64:65], v[60:61], v[40:41], v[94:95] neg_lo:[0,0,1] neg_hi:[0,0,1]
    v_cvt_pk_f16_f32 v98, v52, v54
    v_cvt_pk_f16_f32 v99, v53, v55
    v_cvt_pk_f16_f32 v100, v60, v62
    v_cvt_pk_f16_f32 v101, v61, v63
    ds_write2_b64 v73, v[98:99], v[100:101] offset0:0 offset1:68
    v_pk_mul_f32 v[90:91], v[58:59], v[42:43]
    v_pk_mul_f32 v[92:93], v[58:59], v[40:41]
    v_pk_fma_f32 v[54:55], v[56:57], v[42:43], v[92:93]
    v_pk_fma_f32 v[52:53], v[56:57], v[40:41], v[90:91] neg_lo:[0,0,1] neg_hi:[0,0,1]
    v_cvt_pk_f16_f32 v76, v56, v58
    v_cvt_pk_f16_f32 v77, v57, v59
    v_cvt_pk_f16_f32 v78, v64, v66
    v_cvt_pk_f16_f32 v79, v65, v67
    ds_write2_b64 v73, v[76:77], v[78:79] offset0:136 offset1:204
    v_cvt_pk_f16_f32 v98, v52, v54
    v_cvt_pk_f16_f32 v99, v53, v55
    v_mov_b32 v36, 0x4538aa3b
    v_mul_f32 v24, s14, v36
    v_max_f32 v24, 0, v24
    v_ceil_f32 v24, v24
    v_cvt_i32_f32 v24, v24
    ds_write_b64 v74, v[98:99] offset:0
    s_sub_u32 s11, s15, 7
    s_lshl_b32 s11, s11, 23
    v_lshlrev_b32 v25, 16, v107
    v_ldexp_f32 v24, s11, v24
    v_mov_b32 v106, v24
    ds_write_b64 v14, v[24:25] offset:832
JOBJ_19:
    ds_write_b8 v15, v5 offset:64
    ds_read_b128 v[40:43], v127 offset:0
    ds_read_b128 v[44:47], v127 offset:64
    ds_read_b128 v[48:51], v127 offset:128
    ds_read_b128 v[52:55], v127 offset:192
    ds_read_b128 v[56:59], v127 offset:256
    ds_read_b128 v[60:63], v127 offset:320
    ds_read_b128 v[64:67], v127 offset:384
    ds_read_b128 v[68:71], v127 offset:448
    v_mov_b32 v36, 0x3fb8aa3b
    v_mul_f32 v36, s14, v36
    v_mul_f32 v37, 0x45000000, v36
    v_max_f32 v37, 0, v37
    v_ceil_f32 v37, v37
    v_add_f32 v37, 0x41b80000, v37
    v_fma_f32 v110, v110, v36, -v37
    v_fma_f32 v111, v111, v36, -v37
    v_fma_f32 v114, v114, v36, -v37
    v_fma_f32 v115, v115, v36, -v37
    v_exp_f32 v110, v110
    v_exp_f32 v111, v111
    v_exp_f32 v114, v114
    v_exp_f32 v115, v115
W_27:
    ds_read_u8 v17, v14 offset:67
    s_sub_u32 s39, s39, 1
    s_cbranch_scc1 KS_ABORT
    s_waitcnt lgkmcnt(0)
    v_cmp_eq_u32 vcc, 0, v17
    s_cbranch_vccnz W_27
    ds_read_b128 v[72:75], v126 offset:22304
    ds_read_b128 v[76:79], v126 offset:22368
    ds_read_b128 v[80:83], v126 offset:22432
    ds_read_b128 v[84:87], v126 offset:22496
    ds_read_b128 v[88:91], v126 offset:22560
    ds_read_b128 v[92:95], v126 offset:22624
    ds_read_b128 v[96:99], v126 offset:22688
    ds_read_b128 v[100:103], v126 offset:22752
    s_waitcnt lgkmcnt(7)
    v_mfma_f32_16x16x32_f16 v[20:23], v[40:43], v[72:75], 0
    s_waitcnt lgkmcnt(6)
    v_mfma_f32_16x16x32_f16 v[24:27], v[44:47], v[76:79], 0
    s_waitcnt lgkmcnt(5)
    v_mfma_f32_16x16x32_f16 v[20:23], v[48:51], v[80:83], v[20:23]
    s_waitcnt lgkmcnt(4)
    v_mfma_f32_16x16x32_f16 v[24:27], v[52:55], v[84:87], v[24:27]
    s_waitcnt lgkmcnt(3)
    v_mfma_f32_16x16x32_f16 v[20:23], v[56:59], v[88:91], v[20:23]
    s_waitcnt lgkmcnt(2)
    v_mfma_f32_16x16x32_f16 v[24:27], v[60:63], v[92:95], v[24:27]
    s_waitcnt lgkmcnt(1)
    v_mfma_f32_16x16x32_f16 v[20:23], v[64:67], v[96:99], v[20:23]
    s_waitcnt lgkmcnt(0)
    v_mfma_f32_16x16x32_f16 v[24:27], v[68:71], v[100:103], v[24:27]
    s_nop 7
    v_add_f32 v20, v20, v24
    v_add_f32 v21, v21, v25
    v_add_f32 v22, v22, v26
    v_add_f32 v23, v23, v27
    v_mul_f32 v20, v20, v110
    v_mul_f32 v21, v21, v111
    v_mul_f32 v22, v22, v114
    v_mul_f32 v23, v23, v115
    s_cmp_eq_u32 s87, 2
    s_cbranch_scc1 KC_SEND
    v_cvt_f16_f32 v20, v20
    ds_write_b16 v108, v20
    v_cvt_f16_f32 v21, v21
    ds_write_b16 v109, v21
    v_cvt_f16_f32 v22, v22
    ds_write_b16 v112, v22
    v_cvt_f16_f32 v23, v23
    ds_write_b16 v113, v23
EXP_13:
    ds_write_b8 v15, v5 offset:68
    v_mov_b32 v28, 0
    v_mov_b32 v29, 0
    v_mov_b32 v30, 0
    v_mov_b32 v31, 0
    v_mov_b32 v32, s85
    s_waitcnt vmcnt(0)
W_29:
    ds_read_b32 v20, v14 offset:68
    s_sub_u32 s39, s39, 1
    s_cbranch_scc1 KS_ABORT
    s_waitcnt lgkmcnt(0)
    v_cmp_ne_u32 vcc, s84, v20
    s_cbranch_vccnz W_29
    ds_read_u16 v20, v116
    ds_read_u16 v21, v117
    ds_read_u16 v22, v118
    ds_read_u16 v23, v120
    ds_read_u16 v24, v121
    ds_read_u16 v25, v122
    ds_read_u16 v26, v123
    s_mov_b64 exec, 1
    ds_write_b128 v32, v[28:31] offset:3088
    ds_write_b128 v32, v[28:31] offset:8224
    ds_write_b128 v32, v[28:31] offset:3072
    s_mov_b64 exec, -1
    s_waitcnt lgkmcnt(7)
    v_lshl_or_b32 v28, v21, 16, v20
    v_lshl_or_b32 v29, v22, 16, v21
    ds_write_b32 v124, v28 offset:32528
    ds_write_b32 v124, v29 offset:33872
    ds_write_b32 v124, v28 offset:27284
    ds_write_b32 v124, v29 offset:28628
    s_waitcnt lgkmcnt(7)
    v_lshl_or_b32 v30, v24, 16, v23
    v_lshl_or_b32 v31, v26, 16, v25
    ds_write_b32 v119, v30
    ds_write_b32 v125, v31
    ds_write_b32 v119, v30 offset:5244
    ds_write_b32 v125, v31 offset:5244
    ds_write_b8 v15, v5 offset:72
    v_lshlrev_b32 v7, 3, v3
    v_sub_u32 v7, v8, v7
    v_lshrrev_b32 v19, 2, v2
    v_lshl_add_u32 v19, v19, 2, v3
    v_and_b32 v18, 3, v2
    v_mul_u32_u24 v19, s8, v19
    v_xor_b32 v19, s10, v19
    v_lshl_add_u32 v19, v18, 4, v19
    v_xor_b32 v12, s9, v12
W_30:
    ds_read_b32 v20, v14 offset:72
    s_sub_u32 s39, s39, 1
    s_cbranch_scc1 KS_ABORT
    s_waitcnt lgkmcnt(0)
    v_cmp_ne_u32 vcc, s84, v20
    s_cbranch_vccnz W_30
    ds_read_b64 v[16:17], v14 offset:832
    s_cmp_eq_u32 s86, 1
    s_cbranch_scc1 CV_32
    s_cmp_eq_u32 s86, 2
    s_cbranch_scc1 CV_33
    s_cmp_eq_u32 s86, 3
    s_cbranch_scc1 CV_34
    ds_read_b64 v[32:33], v6 offset:576
    ds_read_b64 v[34:35], v6 offset:584
    ds_read_b64 v[36:37], v6 offset:64
    ds_read_b64 v[38:39], v6 offset:72
    ds_read_b64 v[40:41], v6 offset:640
    ds_read_b64 v[42:43], v6 offset:648
    ds_read_b64 v[44:45], v6 offset:128
    ds_read_b64 v[46:47], v6 offset:136
    ds_read_b64 v[48:49], v6 offset:704
    ds_read_b64 v[50:51], v6 offset:712
    ds_read_b64 v[52:53], v6 offset:192
    ds_read_b64 v[54:55], v6 offset:200
    ds_read_b64 v[56:57], v6 offset:768
    ds_read_b64 v[58:59], v6 offset:776
    ds_read_b64 v[60:61], v6 offset:256
    ds_read_b64 v[62:63], v6 offset:264
    ds_read_b64 v[64:65], v6 offset:832
    ds_read_b64 v[66:67], v6 offset:840
    ds_read_b64 v[68:69], v6 offset:320
    ds_read_b64 v[70:71], v6 offset:328
    ds_read_b64 v[72:73], v6 offset:896
    ds_read_b64 v[74:75], v6 offset:904
    ds_read_b64 v[76:77], v6 offset:384
    ds_read_b64 v[78:79], v6 offset:392
    ds_read_b64 v[80:81], v6 offset:960
    ds_read_b64 v[82:83], v6 offset:968
    ds_read_b64 v[84:85], v6 offset:448
    ds_read_b64 v[86:87], v6 offset:456
    ds_read_b64 v[88:89], v6 offset:1024
    ds_read_b64 v[90:91], v6 offset:1032
    ds_read_b64 v[92:93], v6 offset:512
    ds_read_b64 v[94:95], v6 offset:520
    ds_read_b32 v18, v4 offset:16
    ds_read_b128 v[96:99], v8 offset:0
    ds_read_b128 v[100:103], v8 offset:64
    ds_read_b128 v[104:107], v8 offset:128
    ds_read_b128 v[108:111], v8 offset:192
    s_waitcnt lgkmcnt(4)
    v_cmp_ne_u32 vcc, s84, v18
    s_cbranch_vccnz US_36
UB_37:
    s_setprio 1
    s_waitcnt lgkmcnt(3)
    v_mfma_f32_16x16x32_f16 v[20:23], v[32:35], v[96:99], 0
    v_mov_b32 v6, v19
    v_mfma_f32_16x16x32_f16 v[24:27], v[36:39], v[96:99], 0
    ds_read_b128 v[112:115], v8 offset:256
    s_waitcnt lgkmcnt(3)
    v_mfma_f32_16x16x32_f16 v[20:23], v[40:43], v[100:103], v[20:23]
    ds_read_b64 v[28:29], v7 offset:480
    ds_read_b64 v[30:31], v7 offset:992
    v_mfma_f32_16x16x32_f16 v[24:27], v[44:47], v[100:103], v[24:27]
    ds_read_b128 v[116:119], v8 offset:320
    s_waitcnt lgkmcnt(5)
    v_mfma_f32_16x16x32_f16 v[20:23], v[48:51], v[104:107], v[20:23]
    v_mfma_f32_16x16x32_f16 v[24:27], v[52:55], v[104:107], v[24:27]
    ds_read_b128 v[120:123], v8 offset:384
    s_waitcnt lgkmcnt(2)
    v_fma_mix_f32 v104, v28, v17, 0 op_sel_hi:[1,0,0]
    v_fma_mix_f32 v105, v28, v17, 0 op_sel:[1,0,0] op_sel_hi:[1,0,0]
    v_mfma_f32_16x16x32_f16 v[20:23], v[56:59], v[108:111], v[20:23]
    v_fma_mix_f32 v106, v29, v17, 0 op_sel_hi:[1,0,0]
    v_fma_mix_f32 v107, v29, v17, 0 op_sel:[1,0,0] op_sel_hi:[1,0,0]
    v_mfma_f32_16x16x32_f16 v[24:27], v[60:63], v[108:111], v[24:27]
    ds_read_b128 v[124:127], v8 offset:448
    v_cvt_pk_bf16_f32 v104, 0, v104
    v_cvt_pk_bf16_f32 v105, 0, v105
    v_mfma_f32_16x16x32_f16 v[20:23], v[64:67], v[112:115], v[20:23]
    v_cvt_pk_bf16_f32 v106, 0, v106
    v_cvt_pk_bf16_f32 v107, 0, v107
    v_mfma_f32_16x16x32_f16 v[24:27], v[68:71], v[112:115], v[24:27]
    ds_read_b128 v[36:39], v8 offset:512
    v_fma_mix_f32 v112, v30, v17, 0 op_sel_hi:[1,0,0]
    v_fma_mix_f32 v113, v30, v17, 0 op_sel:[1,0,0] op_sel_hi:[1,0,0]
    s_waitcnt lgkmcnt(3)
    v_mfma_f32_16x16x32_f16 v[20:23], v[72:75], v[116:119], v[20:23]
    ds_read_b128 v[96:99], v8 offset:576
    v_fma_mix_f32 v114, v31, v17, 0 op_sel_hi:[1,0,0]
    v_fma_mix_f32 v115, v31, v17, 0 op_sel:[1,0,0] op_sel_hi:[1,0,0]
    v_mfma_f32_16x16x32_f16 v[24:27], v[76:79], v[116:119], v[24:27]
    ds_read_b128 v[44:47], v8 offset:640
    v_cvt_pk_bf16_f32 v112, 0, v112
    v_cvt_pk_bf16_f32 v113, 0, v113
    s_waitcnt lgkmcnt(4)
    v_mfma_f32_16x16x32_f16 v[20:23], v[80:83], v[120:123], v[20:23]
    ds_read_b128 v[100:103], v8 offset:704
    v_cvt_pk_bf16_f32 v114, 0, v114
    v_cvt_pk_bf16_f32 v115, 0, v115
    v_mfma_f32_16x16x32_f16 v[24:27], v[84:87], v[120:123], v[24:27]
    ds_read_b128 v[52:55], v8 offset:768
    s_waitcnt lgkmcnt(5)
    v_mfma_f32_16x16x32_f16 v[20:23], v[88:91], v[124:127], v[20:23]
    ds_read_b128 v[60:63], v8 offset:832
    v_mfma_f32_16x16x32_f16 v[24:27], v[92:95], v[124:127], v[24:27]
    ds_read_b128 v[108:111], v8 offset:896
    s_waitcnt lgkmcnt(6)
    v_mfma_f32_16x16x32_f16 v[24:27], v[32:35], v[36:39], v[24:27]
    ds_read_b128 v[68:71], v8 offset:960
    s_nop 1
    v_cvt_pk_bf16_f32 v20, 0, v20
    v_cvt_pk_bf16_f32 v21, 0, v21
    s_waitcnt lgkmcnt(6)
    v_mfma_f32_16x16x32_f16 v[24:27], v[40:43], v[96:99], v[24:27]
    v_cvt_pk_bf16_f32 v22, 0, v22
    v_cvt_pk_bf16_f32 v23, 0, v23
    s_waitcnt lgkmcnt(5)
    v_mfma_f32_16x16x32_f16 v[24:27], v[48:51], v[44:47], v[24:27]
    v_fma_f32 v20, v20, v16, v104
    v_fma_f32 v21, v21, v16, v105
    s_waitcnt lgkmcnt(4)
    v_mfma_f32_16x16x32_f16 v[24:27], v[56:59], v[100:103], v[24:27]
    v_fma_f32 v22, v22, v16, v106
    v_fma_f32 v23, v23, v16, v107
    s_waitcnt lgkmcnt(3)
    v_mfma_f32_16x16x32_f16 v[24:27], v[64:67], v[52:55], v[24:27]
    v_cvt_pk_bf16_f32 v28, v20, v21
    v_cvt_pk_bf16_f32 v29, v22, v23
    s_waitcnt lgkmcnt(2)
    v_mfma_f32_16x16x32_f16 v[24:27], v[72:75], v[60:63], v[24:27]
    v_min_u32 v28, -2, v28
    v_min_u32 v29, -2, v29
    s_waitcnt lgkmcnt(1)
    v_mfma_f32_16x16x32_f16 v[24:27], v[80:83], v[108:111], v[24:27]
    s_waitcnt lgkmcnt(0)
    v_mfma_f32_16x16x32_f16 v[24:27], v[88:91], v[68:71], v[24:27]
    ds_read_u8 v18, v14 offset:112
    ds_read_b128 v[20:23], v12 offset:46592
    s_nop 5
    v_cvt_pk_bf16_f32 v24, 0, v24
    v_cvt_pk_bf16_f32 v25, 0, v25
    v_cvt_pk_bf16_f32 v26, 0, v26
    v_cvt_pk_bf16_f32 v27, 0, v27
    v_fma_f32 v24, v24, v16, v112
    v_fma_f32 v25, v25, v16, v113
    v_fma_f32 v26, v26, v16, v114
    v_fma_f32 v27, v27, v16, v115
    v_cvt_pk_bf16_f32 v30, v24, v25
    v_cvt_pk_bf16_f32 v31, v26, v27
    v_min_u32 v30, -2, v30
    v_min_u32 v31, -2, v31
    s_branch CVE_35
CV_32:
    ds_read_b64 v[32:33], v6 offset:0
    ds_read_b64 v[34:35], v6 offset:8
    ds_read_b64 v[36:37], v6 offset:64
    ds_read_b64 v[38:39], v6 offset:72
    ds_read_b64 v[40:41], v6 offset:128
    ds_read_b64 v[42:43], v6 offset:136
    ds_read_b64 v[44:45], v6 offset:192
    ds_read_b64 v[46:47], v6 offset:200
    ds_read_b64 v[48:49], v6 offset:256
    ds_read_b64 v[50:51], v6 offset:264
    ds_read_b64 v[52:53], v6 offset:320
    ds_read_b64 v[54:55], v6 offset:328
    ds_read_b64 v[56:57], v6 offset:384
    ds_read_b64 v[58:59], v6 offset:392
    ds_read_b64 v[60:61], v6 offset:448
    ds_read_b64 v[62:63], v6 offset:456
    ds_read_b64 v[64:65], v6 offset:512
    ds_read_b64 v[66:67], v6 offset:520
    ds_read_b64 v[68:69], v6 offset:576
    ds_read_b64 v[70:71], v6 offset:584
    ds_read_b64 v[72:73], v6 offset:640
    ds_read_b64 v[74:75], v6 offset:648
    ds_read_b64 v[76:77], v6 offset:704
    ds_read_b64 v[78:79], v6 offset:712
    ds_read_b64 v[80:81], v6 offset:768
    ds_read_b64 v[82:83], v6 offset:776
    ds_read_b64 v[84:85], v6 offset:832
    ds_read_b64 v[86:87], v6 offset:840
    ds_read_b64 v[88:89], v6 offset:896
    ds_read_b64 v[90:91], v6 offset:904
    ds_read_b64 v[92:93], v6 offset:960
    ds_read_b64 v[94:95], v6 offset:968
    ds_read_b64 v[96:97], v6 offset:1024
    ds_read_b64 v[98:99], v6 offset:1032
    ds_read_b64 v[100:101], v11 offset:128
    ds_read_b64 v[102:103], v11 offset:136
    ds_read_b64 v[104:105], v11 offset:384
    ds_read_b64 v[106:107], v11 offset:392
    ds_read_b32 v18, v4 offset:16
    ds_read_b128 v[108:111], v8 offset:448
    ds_read_b128 v[112:115], v8 offset:512
    ds_read_b128 v[116:119], v8 offset:576
    ds_read_b128 v[120:123], v8 offset:640
    ds_read_b128 v[124:127], v8 offset:704
    s_waitcnt lgkmcnt(5)
    v_cmp_ne_u32 vcc, s84, v18
    s_cbranch_vccnz US_38
UB_39:
    s_setprio 1
    s_waitcnt lgkmcnt(4)
    v_mfma_f32_16x16x32_f16 v[20:23], v[32:35], v[108:111], 0
    ds_read_b128 v[108:111], v8 offset:768
    v_mov_b32 v6, v19
    s_waitcnt lgkmcnt(4)
    v_mfma_f32_16x16x32_f16 v[20:23], v[36:39], v[112:115], v[20:23]
    ds_read_b128 v[112:115], v8 offset:832
    s_waitcnt lgkmcnt(4)
    v_mfma_f32_16x16x32_f16 v[20:23], v[40:43], v[116:119], v[20:23]
    ds_read_b128 v[116:119], v8 offset:896
    ds_read_b64 v[28:29], v7 offset:1504
    ds_read_b64 v[30:31], v7 offset:2016
    s_waitcnt lgkmcnt(6)
    v_mfma_f32_16x16x32_f16 v[20:23], v[44:47], v[120:123], v[20:23]
    ds_read_b128 v[120:123], v8 offset:960
    s_waitcnt lgkmcnt(6)
    v_mfma_f32_16x16x32_f16 v[20:23], v[48:51], v[124:127], v[20:23]
    ds_read_b128 v[124:127], v8 offset:1024
    s_waitcnt lgkmcnt(6)
    v_mfma_f32_16x16x32_f16 v[20:23], v[52:55], v[108:111], v[20:23]
    ds_read_b128 v[108:111], v8 offset:1088
    s_waitcnt lgkmcnt(6)
    v_mfma_f32_16x16x32_f16 v[20:23], v[56:59], v[112:115], v[20:23]
    s_waitcnt lgkmcnt(5)
    v_mfma_f32_16x16x32_f16 v[20:23], v[60:63], v[116:119], v[20:23]
    ds_read_b128 v[112:115], v8 offset:1152
    s_waitcnt lgkmcnt(3)
    v_mfma_f32_16x16x32_f16 v[20:23], v[64:67], v[120:123], v[20:23]
    v_mfma_f32_16x16x32_f16 v[24:27], v[32:35], v[120:123], 0
    ds_read_b128 v[116:119], v8 offset:1216
    v_fma_mix_f32 v120, v28, v17, 0 op_sel_hi:[1,0,0]
    v_fma_mix_f32 v121, v28, v17, 0 op_sel:[1,0,0] op_sel_hi:[1,0,0]
    s_waitcnt lgkmcnt(3)
    v_mfma_f32_16x16x32_f16 v[20:23], v[68:71], v[124:127], v[20:23]
    v_fma_mix_f32 v122, v29, v17, 0 op_sel_hi:[1,0,0]
    v_fma_mix_f32 v123, v29, v17, 0 op_sel:[1,0,0] op_sel_hi:[1,0,0]
    v_mfma_f32_16x16x32_f16 v[24:27], v[36:39], v[124:127], v[24:27]
    ds_read_b128 v[32:35], v8 offset:1280
    v_cvt_pk_bf16_f32 v120, 0, v120
    v_cvt_pk_bf16_f32 v121, 0, v121
    s_waitcnt lgkmcnt(3)
    v_mfma_f32_16x16x32_f16 v[20:23], v[72:75], v[108:111], v[20:23]
    v_cvt_pk_bf16_f32 v122, 0, v122
    v_cvt_pk_bf16_f32 v123, 0, v123
    v_mfma_f32_16x16x32_f16 v[24:27], v[40:43], v[108:111], v[24:27]
    ds_read_b128 v[36:39], v8 offset:1344
    v_fma_mix_f32 v108, v30, v17, 0 op_sel_hi:[1,0,0]
    v_fma_mix_f32 v109, v30, v17, 0 op_sel:[1,0,0] op_sel_hi:[1,0,0]
    s_waitcnt lgkmcnt(3)
    v_mfma_f32_16x16x32_f16 v[20:23], v[76:79], v[112:115], v[20:23]
    v_fma_mix_f32 v110, v31, v17, 0 op_sel_hi:[1,0,0]
    v_fma_mix_f32 v111, v31, v17, 0 op_sel:[1,0,0] op_sel_hi:[1,0,0]
    v_mfma_f32_16x16x32_f16 v[24:27], v[44:47], v[112:115], v[24:27]
    ds_read_b128 v[124:127], v8 offset:1408
    v_cvt_pk_bf16_f32 v108, 0, v108
    v_cvt_pk_bf16_f32 v109, 0, v109
    s_waitcnt lgkmcnt(3)
    v_mfma_f32_16x16x32_f16 v[20:23], v[80:83], v[116:119], v[20:23]
    v_cvt_pk_bf16_f32 v110, 0, v110
    v_cvt_pk_bf16_f32 v111, 0, v111
    v_mfma_f32_16x16x32_f16 v[24:27], v[48:51], v[116:119], v[24:27]
    ds_read_b128 v[40:43], v8 offset:1472
    s_waitcnt lgkmcnt(3)
    v_mfma_f32_16x16x32_f16 v[20:23], v[84:87], v[32:35], v[20:23]
    v_mfma_f32_16x16x32_f16 v[24:27], v[52:55], v[32:35], v[24:27]
    ds_read_b128 v[44:47], v8 offset:1536
    s_waitcnt lgkmcnt(3)
    v_mfma_f32_16x16x32_f16 v[20:23], v[88:91], v[36:39], v[20:23]
    ds_read_b128 v[112:115], v8 offset:1600
    v_mfma_f32_16x16x32_f16 v[24:27], v[56:59], v[36:39], v[24:27]
    ds_read_b128 v[48:51], v8 offset:1664
    s_waitcnt lgkmcnt(4)
    v_mfma_f32_16x16x32_f16 v[20:23], v[92:95], v[124:127], v[20:23]
    ds_read_b128 v[116:119], v8 offset:1728
    v_mfma_f32_16x16x32_f16 v[24:27], v[60:63], v[124:127], v[24:27]
    ds_read_b128 v[52:55], v8 offset:1792
    s_waitcnt lgkmcnt(5)
    v_mfma_f32_16x16x32_f16 v[20:23], v[96:99], v[40:43], v[20:23]
    ds_read_b128 v[32:35], v8 offset:1856
    v_mfma_f32_16x16x32_f16 v[24:27], v[64:67], v[40:43], v[24:27]
    ds_read_b32 v18, v14 offset:76
    ds_read_b128 v[56:59], v8 offset:1920
    s_waitcnt lgkmcnt(7)
    v_mfma_f32_16x16x32_f16 v[24:27], v[68:71], v[44:47], v[24:27]
    ds_read_b128 v[36:39], v8 offset:1984
    s_waitcnt lgkmcnt(7)
    v_mfma_f32_16x16x32_f16 v[24:27], v[72:75], v[112:115], v[24:27]
    ds_read_b64 v[60:61], v11 offset:64
    ds_read_b64 v[62:63], v11 offset:72
    s_waitcnt lgkmcnt(8)
    v_mfma_f32_16x16x32_f16 v[24:27], v[76:79], v[48:51], v[24:27]
    s_waitcnt lgkmcnt(4)
    v_cmp_ne_u32 vcc, s84, v18
    s_cbranch_vccnz WS_40
WB_41:
    ds_read_b64_tr_b16 v[124:125], v9 offset:0
    ds_read_b64_tr_b16 v[126:127], v9 offset:64
    ds_read_b64_tr_b16 v[64:65], v9 offset:3088
    ds_read_b64_tr_b16 v[66:67], v9 offset:3152
    v_mfma_f32_16x16x32_f16 v[24:27], v[80:83], v[116:119], v[24:27]
    v_mfma_f32_16x16x32_f16 v[24:27], v[84:87], v[52:55], v[24:27]
    ds_read_b64_tr_b16 v[40:41], v9 offset:512
    ds_read_b64_tr_b16 v[42:43], v9 offset:576
    ds_read_b64 v[68:69], v11 offset:320
    ds_read_b64 v[70:71], v11 offset:328
    v_mfma_f32_16x16x32_f16 v[24:27], v[88:91], v[32:35], v[24:27]
    s_waitcnt lgkmcnt(11)
    v_mfma_f32_16x16x32_f16 v[24:27], v[92:95], v[56:59], v[24:27]
    ds_read_b64_tr_b16 v[44:45], v9 offset:3600
    ds_read_b64_tr_b16 v[46:47], v9 offset:3664
    s_waitcnt lgkmcnt(12)
    v_mfma_f32_16x16x32_f16 v[24:27], v[96:99], v[36:39], v[24:27]
    s_waitcnt lgkmcnt(8)
    v_mfma_f32_16x16x32_f16 v[20:23], v[124:127], v[100:103], v[20:23]
    s_waitcnt lgkmcnt(6)
    v_mfma_f32_16x16x32_f16 v[20:23], v[64:67], v[104:107], v[20:23]
    v_mfma_f32_16x16x32_f16 v[24:27], v[124:127], v[60:63], v[24:27]
    s_waitcnt lgkmcnt(4)
    v_mfma_f32_16x16x32_f16 v[24:27], v[40:43], v[100:103], v[24:27]
    s_nop 4
    v_cvt_pk_bf16_f32 v20, 0, v20
    v_cvt_pk_bf16_f32 v21, 0, v21
    s_waitcnt lgkmcnt(2)
    v_mfma_f32_16x16x32_f16 v[24:27], v[64:67], v[68:71], v[24:27]
    v_cvt_pk_bf16_f32 v22, 0, v22
    v_cvt_pk_bf16_f32 v23, 0, v23
    s_waitcnt lgkmcnt(0)
    v_mfma_f32_16x16x32_f16 v[24:27], v[44:47], v[104:107], v[24:27]
    v_fma_f32 v20, v20, v16, v120
    v_fma_f32 v21, v21, v16, v121
    v_fma_f32 v22, v22, v16, v122
    v_fma_f32 v23, v23, v16, v123
    v_cvt_pk_bf16_f32 v28, v20, v21
    v_cvt_pk_bf16_f32 v29, v22, v23
    v_min_u32 v28, -2, v28
    v_min_u32 v29, -2, v29
    ds_read_u8 v18, v14 offset:113
    ds_read_b128 v[20:23], v12 offset:47616
    v_cvt_pk_bf16_f32 v24, 0, v24
    v_cvt_pk_bf16_f32 v25, 0, v25
    v_cvt_pk_bf16_f32 v26, 0, v26
    v_cvt_pk_bf16_f32 v27, 0, v27
    v_fma_f32 v24, v24, v16, v108
    v_fma_f32 v25, v25, v16, v109
    v_fma_f32 v26, v26, v16, v110
    v_fma_f32 v27, v27, v16, v111
    v_cvt_pk_bf16_f32 v30, v24, v25
    v_cvt_pk_bf16_f32 v31, v26, v27
    v_min_u32 v30, -2, v30
    v_min_u32 v31, -2, v31
    s_branch CVE_35
CV_33:
    ds_read_b64 v[32:33], v6 offset:1152
    ds_read_b64 v[34:35], v6 offset:1160
    ds_read_b64 v[36:37], v6 offset:0
    ds_read_b64 v[38:39], v6 offset:8
    ds_read_b64 v[40:41], v6 offset:64
    ds_read_b64 v[42:43], v6 offset:72
    ds_read_b64 v[44:45], v6 offset:128
    ds_read_b64 v[46:47], v6 offset:136
    ds_read_b64 v[48:49], v6 offset:192
    ds_read_b64 v[50:51], v6 offset:200
    ds_read_b64 v[52:53], v6 offset:256
    ds_read_b64 v[54:55], v6 offset:264
    ds_read_b64 v[56:57], v6 offset:320
    ds_read_b64 v[58:59], v6 offset:328
    ds_read_b64 v[60:61], v6 offset:384
    ds_read_b64 v[62:63], v6 offset:392
    ds_read_b64 v[64:65], v6 offset:448
    ds_read_b64 v[66:67], v6 offset:456
    ds_read_b64 v[68:69], v6 offset:512
    ds_read_b64 v[70:71], v6 offset:520
    ds_read_b64 v[72:73], v6 offset:576
    ds_read_b64 v[74:75], v6 offset:584
    ds_read_b64 v[76:77], v6 offset:640
    ds_read_b64 v[78:79], v6 offset:648
    ds_read_b64 v[80:81], v6 offset:704
    ds_read_b64 v[82:83], v6 offset:712
    ds_read_b64 v[84:85], v6 offset:768
    ds_read_b64 v[86:87], v6 offset:776
    ds_read_b64 v[88:89], v6 offset:832
    ds_read_b64 v[90:91], v6 offset:840
    ds_read_b64 v[92:93], v6 offset:896
    ds_read_b64 v[94:95], v6 offset:904
    ds_read_b64 v[96:97], v6 offset:960
    ds_read_b64 v[98:99], v6 offset:968
    ds_read_b64 v[100:101], v6 offset:1024
    ds_read_b64 v[102:103], v6 offset:1032
    ds_read_b64 v[104:105], v11 offset:0
    ds_read_b64 v[106:107], v11 offset:8
    ds_read_b32 v18, v4 offset:16
    ds_read_b128 v[108:111], v8 offset:448
    ds_read_b128 v[112:115], v8 offset:960
    ds_read_b128 v[116:119], v8 offset:1472
    ds_read_b128 v[120:123], v8 offset:1536
    ds_read_b128 v[124:127], v8 offset:1600
    s_waitcnt lgkmcnt(5)
    v_cmp_ne_u32 vcc, s84, v18
    s_cbranch_vccnz US_42
UB_43:
    s_setprio 1
    s_waitcnt lgkmcnt(4)
    v_mfma_f32_16x16x32_f16 v[20:23], v[32:35], v[108:111], 0
    ds_read_b128 v[108:111], v8 offset:1664
    v_mov_b32 v6, v19
    s_waitcnt lgkmcnt(4)
    v_mfma_f32_16x16x32_f16 v[24:27], v[32:35], v[112:115], 0
    ds_read_b128 v[32:35], v8 offset:1728
    ds_read_b128 v[112:115], v8 offset:1792
    s_waitcnt lgkmcnt(5)
    v_mfma_f32_16x16x32_f16 v[20:23], v[36:39], v[116:119], v[20:23]
    ds_read_b128 v[116:119], v8 offset:1856
    ds_read_b64 v[28:29], v7 offset:2528
    ds_read_b64 v[30:31], v7 offset:3040
    s_waitcnt lgkmcnt(7)
    v_mfma_f32_16x16x32_f16 v[20:23], v[40:43], v[120:123], v[20:23]
    ds_read_b128 v[120:123], v8 offset:1920
    s_waitcnt lgkmcnt(7)
    v_mfma_f32_16x16x32_f16 v[20:23], v[44:47], v[124:127], v[20:23]
    ds_read_b128 v[124:127], v8 offset:1984
    s_waitcnt lgkmcnt(7)
    v_mfma_f32_16x16x32_f16 v[20:23], v[48:51], v[108:111], v[20:23]
    ds_read_b128 v[108:111], v8 offset:2048
    s_waitcnt lgkmcnt(7)
    v_mfma_f32_16x16x32_f16 v[20:23], v[52:55], v[32:35], v[20:23]
    s_waitcnt lgkmcnt(6)
    v_mfma_f32_16x16x32_f16 v[20:23], v[56:59], v[112:115], v[20:23]
    ds_read_b128 v[32:35], v8 offset:2112
    s_waitcnt lgkmcnt(6)
    v_mfma_f32_16x16x32_f16 v[20:23], v[60:63], v[116:119], v[20:23]
    s_waitcnt lgkmcnt(4)
    v_fma_mix_f32 v116, v28, v17, 0 op_sel_hi:[1,0,0]
    v_fma_mix_f32 v117, v28, v17, 0 op_sel:[1,0,0] op_sel_hi:[1,0,0]
    s_waitcnt lgkmcnt(3)
    v_mfma_f32_16x16x32_f16 v[20:23], v[64:67], v[120:123], v[20:23]
    ds_read_b128 v[112:115], v8 offset:2176
    v_fma_mix_f32 v118, v29, v17, 0 op_sel_hi:[1,0,0]
    v_fma_mix_f32 v119, v29, v17, 0 op_sel:[1,0,0] op_sel_hi:[1,0,0]
    s_waitcnt lgkmcnt(3)
    v_mfma_f32_16x16x32_f16 v[20:23], v[68:71], v[124:127], v[20:23]
    v_cvt_pk_bf16_f32 v116, 0, v116
    v_cvt_pk_bf16_f32 v117, 0, v117
    v_mfma_f32_16x16x32_f16 v[24:27], v[36:39], v[124:127], v[24:27]
    ds_read_b128 v[120:123], v8 offset:2240
    v_cvt_pk_bf16_f32 v118, 0, v118
    v_cvt_pk_bf16_f32 v119, 0, v119
    s_waitcnt lgkmcnt(3)
    v_mfma_f32_16x16x32_f16 v[20:23], v[72:75], v[108:111], v[20:23]
    v_fma_mix_f32 v124, v30, v17, 0 op_sel_hi:[1,0,0]
    v_fma_mix_f32 v125, v30, v17, 0 op_sel:[1,0,0] op_sel_hi:[1,0,0]
    v_mfma_f32_16x16x32_f16 v[24:27], v[40:43], v[108:111], v[24:27]
    ds_read_b128 v[36:39], v8 offset:2304
    v_fma_mix_f32 v126, v31, v17, 0 op_sel_hi:[1,0,0]
    v_fma_mix_f32 v127, v31, v17, 0 op_sel:[1,0,0] op_sel_hi:[1,0,0]
    s_waitcnt lgkmcnt(3)
    v_mfma_f32_16x16x32_f16 v[20:23], v[76:79], v[32:35], v[20:23]
    v_cvt_pk_bf16_f32 v124, 0, v124
    v_cvt_pk_bf16_f32 v125, 0, v125
    v_mfma_f32_16x16x32_f16 v[24:27], v[44:47], v[32:35], v[24:27]
    ds_read_b128 v[40:43], v8 offset:2368
    v_cvt_pk_bf16_f32 v126, 0, v126
    v_cvt_pk_bf16_f32 v127, 0, v127
    s_waitcnt lgkmcnt(3)
    v_mfma_f32_16x16x32_f16 v[20:23], v[80:83], v[112:115], v[20:23]
    v_mfma_f32_16x16x32_f16 v[24:27], v[48:51], v[112:115], v[24:27]
    ds_read_b128 v[108:111], v8 offset:2432
    s_waitcnt lgkmcnt(3)
    v_mfma_f32_16x16x32_f16 v[20:23], v[84:87], v[120:123], v[20:23]
    v_mfma_f32_16x16x32_f16 v[24:27], v[52:55], v[120:123], v[24:27]
    ds_read_b128 v[44:47], v8 offset:2496
    s_waitcnt lgkmcnt(3)
    v_mfma_f32_16x16x32_f16 v[20:23], v[88:91], v[36:39], v[20:23]
    v_mfma_f32_16x16x32_f16 v[24:27], v[56:59], v[36:39], v[24:27]
    ds_read_b128 v[32:35], v8 offset:2560
    s_waitcnt lgkmcnt(3)
    v_mfma_f32_16x16x32_f16 v[20:23], v[92:95], v[40:43], v[20:23]
    ds_read_b128 v[48:51], v8 offset:2624
    v_mfma_f32_16x16x32_f16 v[24:27], v[60:63], v[40:43], v[24:27]
    ds_read_b128 v[112:115], v8 offset:2688
    s_waitcnt lgkmcnt(4)
    v_mfma_f32_16x16x32_f16 v[20:23], v[96:99], v[108:111], v[20:23]
    ds_read_b128 v[52:55], v8 offset:2752
    v_mfma_f32_16x16x32_f16 v[24:27], v[64:67], v[108:111], v[24:27]
    ds_read_b128 v[120:123], v8 offset:2816
    s_waitcnt lgkmcnt(5)
    v_mfma_f32_16x16x32_f16 v[20:23], v[100:103], v[44:47], v[20:23]
    ds_read_b128 v[56:59], v8 offset:2880
    v_mfma_f32_16x16x32_f16 v[24:27], v[68:71], v[44:47], v[24:27]
    ds_read_b32 v18, v14 offset:76
    ds_read_b128 v[36:39], v8 offset:2944
    s_waitcnt lgkmcnt(7)
    v_mfma_f32_16x16x32_f16 v[24:27], v[72:75], v[32:35], v[24:27]
    ds_read_b128 v[60:63], v8 offset:3008
    s_waitcnt lgkmcnt(7)
    v_mfma_f32_16x16x32_f16 v[24:27], v[76:79], v[48:51], v[24:27]
    ds_read_b64 v[40:41], v11 offset:64
    ds_read_b64 v[42:43], v11 offset:72
    ds_read_b64 v[64:65], v11 offset:128
    ds_read_b64 v[66:67], v11 offset:136
    s_waitcnt lgkmcnt(10)
    v_mfma_f32_16x16x32_f16 v[24:27], v[80:83], v[112:115], v[24:27]
    s_waitcnt lgkmcnt(6)
    v_cmp_ne_u32 vcc, s84, v18
    s_cbranch_vccnz WS_44
WB_45:
    ds_read_b64_tr_b16 v[108:109], v9 offset:0
    ds_read_b64_tr_b16 v[110:111], v9 offset:64
    ds_read_b64_tr_b16 v[68:69], v9 offset:512
    ds_read_b64_tr_b16 v[70:71], v9 offset:576
    v_mfma_f32_16x16x32_f16 v[24:27], v[84:87], v[52:55], v[24:27]
    ds_read_b64_tr_b16 v[44:45], v9 offset:1024
    ds_read_b64_tr_b16 v[46:47], v9 offset:1088
    v_mfma_f32_16x16x32_f16 v[24:27], v[88:91], v[120:123], v[24:27]
    ds_read_b64_tr_b16 v[72:73], v9 offset:3088
    ds_read_b64_tr_b16 v[74:75], v9 offset:3152
    ds_read_b64 v[32:33], v11 offset:256
    ds_read_b64 v[34:35], v11 offset:264
    v_mfma_f32_16x16x32_f16 v[24:27], v[92:95], v[56:59], v[24:27]
    ds_read_b64_tr_b16 v[76:77], v9 offset:3600
    ds_read_b64_tr_b16 v[78:79], v9 offset:3664
    ds_read_b64 v[48:49], v11 offset:320
    ds_read_b64 v[50:51], v11 offset:328
    v_mfma_f32_16x16x32_f16 v[24:27], v[96:99], v[36:39], v[24:27]
    ds_read_b64_tr_b16 v[80:81], v9 offset:4112
    ds_read_b64_tr_b16 v[82:83], v9 offset:4176
    ds_read_b64 v[112:113], v11 offset:384
    ds_read_b64 v[114:115], v11 offset:392
    v_mfma_f32_16x16x32_f16 v[24:27], v[100:103], v[60:63], v[24:27]
    ds_read_b64_tr_b16 v[84:85], v10 offset:6176
    ds_read_b64_tr_b16 v[86:87], v10 offset:6304
    ds_read_b64 v[52:53], v13 offset:96
    ds_read_b64 v[54:55], v13 offset:104
    v_mfma_f32_16x16x32_f16 v[20:23], v[108:111], v[104:107], v[20:23]
    ds_read_b64_tr_b16 v[88:89], v10 offset:8224
    ds_read_b64_tr_b16 v[90:91], v10 offset:8352
    ds_read_b64 v[120:121], v13 offset:480
    ds_read_b64 v[122:123], v13 offset:488
    v_mfma_f32_16x16x32_f16 v[20:23], v[68:71], v[40:43], v[20:23]
    v_mfma_f32_16x16x32_f16 v[20:23], v[44:47], v[64:67], v[20:23]
    v_mfma_f32_16x16x32_f16 v[20:23], v[72:75], v[32:35], v[20:23]
    ds_read_b64_tr_b16 v[92:93], v9 offset:1536
    ds_read_b64_tr_b16 v[94:95], v9 offset:1600
    s_waitcnt lgkmcnt(14)
    v_mfma_f32_16x16x32_f16 v[20:23], v[76:79], v[48:51], v[20:23]
    s_waitcnt lgkmcnt(10)
    v_mfma_f32_16x16x32_f16 v[20:23], v[80:83], v[112:115], v[20:23]
    s_waitcnt lgkmcnt(6)
    v_mfma_f32_16x16x32_f16 v[20:23], v[84:87], v[52:55], v[20:23]
    ds_read_b64_tr_b16 v[56:57], v9 offset:4624
    ds_read_b64_tr_b16 v[58:59], v9 offset:4688
    ds_read_b64 v[96:97], v13 offset:64
    ds_read_b64 v[98:99], v13 offset:72
    s_waitcnt lgkmcnt(6)
    v_mfma_f32_16x16x32_f16 v[20:23], v[88:91], v[120:123], v[20:23]
    ds_read_b64 v[36:37], v13 offset:448
    ds_read_b64 v[38:39], v13 offset:456
    v_mfma_f32_16x16x32_f16 v[24:27], v[68:71], v[104:107], v[24:27]
    v_mfma_f32_16x16x32_f16 v[24:27], v[44:47], v[40:43], v[24:27]
    s_nop 3
    v_cvt_pk_bf16_f32 v20, 0, v20
    v_cvt_pk_bf16_f32 v21, 0, v21
    s_waitcnt lgkmcnt(6)
    v_mfma_f32_16x16x32_f16 v[24:27], v[92:95], v[64:67], v[24:27]
    v_cvt_pk_bf16_f32 v22, 0, v22
    v_cvt_pk_bf16_f32 v23, 0, v23
    v_mfma_f32_16x16x32_f16 v[24:27], v[76:79], v[32:35], v[24:27]
    v_fma_f32 v20, v20, v16, v116
    v_fma_f32 v21, v21, v16, v117
    v_mfma_f32_16x16x32_f16 v[24:27], v[80:83], v[48:51], v[24:27]
    v_fma_f32 v22, v22, v16, v118
    v_fma_f32 v23, v23, v16, v119
    s_waitcnt lgkmcnt(4)
    v_mfma_f32_16x16x32_f16 v[24:27], v[56:59], v[112:115], v[24:27]
    v_cvt_pk_bf16_f32 v28, v20, v21
    v_cvt_pk_bf16_f32 v29, v22, v23
    s_waitcnt lgkmcnt(2)
    v_mfma_f32_16x16x32_f16 v[24:27], v[84:87], v[96:99], v[24:27]
    v_min_u32 v28, -2, v28
    v_min_u32 v29, -2, v29
    s_waitcnt lgkmcnt(0)
    v_mfma_f32_16x16x32_f16 v[24:27], v[88:91], v[36:39], v[24:27]
    ds_read_u8 v18, v14 offset:114
    ds_read_b128 v[20:23], v12 offset:48640
    s_nop 5
    v_cvt_pk_bf16_f32 v24, 0, v24
    v_cvt_pk_bf16_f32 v25, 0, v25
    v_cvt_pk_bf16_f32 v26, 0, v26
    v_cvt_pk_bf16_f32 v27, 0, v27
    v_fma_f32 v24, v24, v16, v124
    v_fma_f32 v25, v25, v16, v125
    v_fma_f32 v26, v26, v16, v126
    v_fma_f32 v27, v27, v16, v127
    v_cvt_pk_bf16_f32 v30, v24, v25
    v_cvt_pk_bf16_f32 v31, v26, v27
    v_min_u32 v30, -2, v30
    v_min_u32 v31, -2, v31
    s_branch CVE_35
CV_34:
    ds_read_b64 v[32:33], v6 offset:1152
    ds_read_b64 v[34:35], v6 offset:1160
    ds_read_b64 v[36:37], v6 offset:0
    ds_read_b64 v[38:39], v6 offset:8
    ds_read_b64 v[40:41], v6 offset:64
    ds_read_b64 v[42:43], v6 offset:72
    ds_read_b64 v[44:45], v6 offset:128
    ds_read_b64 v[46:47], v6 offset:136
    ds_read_b64 v[48:49], v6 offset:192
    ds_read_b64 v[50:51], v6 offset:200
    ds_read_b64 v[52:53], v6 offset:256
    ds_read_b64 v[54:55], v6 offset:264
    ds_read_b64 v[56:57], v6 offset:320
    ds_read_b64 v[58:59], v6 offset:328
    ds_read_b64 v[60:61], v6 offset:384
    ds_read_b64 v[62:63], v6 offset:392
    ds_read_b64 v[64:65], v6 offset:448
    ds_read_b64 v[66:67], v6 offset:456
    ds_read_b64 v[68:69], v6 offset:512
    ds_read_b64 v[70:71], v6 offset:520
    ds_read_b64 v[72:73], v6 offset:576
    ds_read_b64 v[74:75], v6 offset:584
    ds_read_b64 v[76:77], v6 offset:640
    ds_read_b64 v[78:79], v6 offset:648
    ds_read_b64 v[80:81], v6 offset:704
    ds_read_b64 v[82:83], v6 offset:712
    ds_read_b64 v[84:85], v6 offset:768
    ds_read_b64 v[86:87], v6 offset:776
    ds_read_b64 v[88:89], v6 offset:832
    ds_read_b64 v[90:91], v6 offset:840
    ds_read_b64 v[92:93], v6 offset:896
    ds_read_b64 v[94:95], v6 offset:904
    ds_read_b64 v[96:97], v6 offset:960
    ds_read_b64 v[98:99], v6 offset:968
    ds_read_b64 v[100:101], v6 offset:1024
    ds_read_b64 v[102:103], v6 offset:1032
    ds_read_b64 v[104:105], v11 offset:0
    ds_read_b64 v[106:107], v11 offset:8
    ds_read_b32 v18, v4 offset:16
    ds_read_b128 v[108:111], v8 offset:1472
    ds_read_b128 v[112:115], v8 offset:1984
    ds_read_b128 v[116:119], v8 offset:2496
    ds_read_b128 v[120:123], v8 offset:2560
    ds_read_b128 v[124:127], v8 offset:2624
    s_waitcnt lgkmcnt(5)
    v_cmp_ne_u32 vcc, s84, v18
    s_cbranch_vccnz US_46
UB_47:
    s_setprio 1
    s_waitcnt lgkmcnt(4)
    v_mfma_f32_16x16x32_f16 v[20:23], v[32:35], v[108:111], 0
    ds_read_b128 v[108:111], v8 offset:2688
    v_mov_b32 v6, v19
    s_waitcnt lgkmcnt(4)
    v_mfma_f32_16x16x32_f16 v[24:27], v[32:35], v[112:115], 0
    ds_read_b128 v[32:35], v8 offset:2752
    ds_read_b128 v[112:115], v8 offset:2816
    s_waitcnt lgkmcnt(5)
    v_mfma_f32_16x16x32_f16 v[20:23], v[36:39], v[116:119], v[20:23]
    ds_read_b128 v[116:119], v8 offset:2880
    ds_read_b64 v[28:29], v7 offset:3552
    ds_read_b64 v[30:31], v7 offset:4064
    s_waitcnt lgkmcnt(7)
    v_mfma_f32_16x16x32_f16 v[20:23], v[40:43], v[120:123], v[20:23]
    ds_read_b128 v[120:123], v8 offset:2944
    s_waitcnt lgkmcnt(7)
    v_mfma_f32_16x16x32_f16 v[20:23], v[44:47], v[124:127], v[20:23]
    ds_read_b128 v[124:127], v8 offset:3008
    s_waitcnt lgkmcnt(7)
    v_mfma_f32_16x16x32_f16 v[20:23], v[48:51], v[108:111], v[20:23]
    ds_read_b128 v[108:111], v8 offset:3072
    s_waitcnt lgkmcnt(7)
    v_mfma_f32_16x16x32_f16 v[20:23], v[52:55], v[32:35], v[20:23]
    s_waitcnt lgkmcnt(6)
    v_mfma_f32_16x16x32_f16 v[20:23], v[56:59], v[112:115], v[20:23]
    ds_read_b128 v[32:35], v8 offset:3136
    s_waitcnt lgkmcnt(6)
    v_mfma_f32_16x16x32_f16 v[20:23], v[60:63], v[116:119], v[20:23]
    s_waitcnt lgkmcnt(4)
    v_fma_mix_f32 v116, v28, v17, 0 op_sel_hi:[1,0,0]
    v_fma_mix_f32 v117, v28, v17, 0 op_sel:[1,0,0] op_sel_hi:[1,0,0]
    s_waitcnt lgkmcnt(3)
    v_mfma_f32_16x16x32_f16 v[20:23], v[64:67], v[120:123], v[20:23]
    ds_read_b128 v[112:115], v8 offset:3200
    v_fma_mix_f32 v118, v29, v17, 0 op_sel_hi:[1,0,0]
    v_fma_mix_f32 v119, v29, v17, 0 op_sel:[1,0,0] op_sel_hi:[1,0,0]
    s_waitcnt lgkmcnt(3)
    v_mfma_f32_16x16x32_f16 v[20:23], v[68:71], v[124:127], v[20:23]
    v_cvt_pk_bf16_f32 v116, 0, v116
    v_cvt_pk_bf16_f32 v117, 0, v117
    v_mfma_f32_16x16x32_f16 v[24:27], v[36:39], v[124:127], v[24:27]
    ds_read_b128 v[120:123], v8 offset:3264
    v_cvt_pk_bf16_f32 v118, 0, v118
    v_cvt_pk_bf16_f32 v119, 0, v119
    s_waitcnt lgkmcnt(3)
    v_mfma_f32_16x16x32_f16 v[20:23], v[72:75], v[108:111], v[20:23]
    v_fma_mix_f32 v124, v30, v17, 0 op_sel_hi:[1,0,0]
    v_fma_mix_f32 v125, v30, v17, 0 op_sel:[1,0,0] op_sel_hi:[1,0,0]
    v_mfma_f32_16x16x32_f16 v[24:27], v[40:43], v[108:111], v[24:27]
    ds_read_b128 v[36:39], v8 offset:3328
    v_fma_mix_f32 v126, v31, v17, 0 op_sel_hi:[1,0,0]
    v_fma_mix_f32 v127, v31, v17, 0 op_sel:[1,0,0] op_sel_hi:[1,0,0]
    s_waitcnt lgkmcnt(3)
    v_mfma_f32_16x16x32_f16 v[20:23], v[76:79], v[32:35], v[20:23]
    v_cvt_pk_bf16_f32 v124, 0, v124
    v_cvt_pk_bf16_f32 v125, 0, v125
    v_mfma_f32_16x16x32_f16 v[24:27], v[44:47], v[32:35], v[24:27]
    ds_read_b128 v[40:43], v8 offset:3392
    v_cvt_pk_bf16_f32 v126, 0, v126
    v_cvt_pk_bf16_f32 v127, 0, v127
    s_waitcnt lgkmcnt(3)
    v_mfma_f32_16x16x32_f16 v[20:23], v[80:83], v[112:115], v[20:23]
    v_mfma_f32_16x16x32_f16 v[24:27], v[48:51], v[112:115], v[24:27]
    ds_read_b128 v[108:111], v8 offset:3456
    s_waitcnt lgkmcnt(3)
    v_mfma_f32_16x16x32_f16 v[20:23], v[84:87], v[120:123], v[20:23]
    v_mfma_f32_16x16x32_f16 v[24:27], v[52:55], v[120:123], v[24:27]
    ds_read_b128 v[44:47], v8 offset:3520
    s_waitcnt lgkmcnt(3)
    v_mfma_f32_16x16x32_f16 v[20:23], v[88:91], v[36:39], v[20:23]
    v_mfma_f32_16x16x32_f16 v[24:27], v[56:59], v[36:39], v[24:27]
    ds_read_b128 v[32:35], v8 offset:3584
    s_waitcnt lgkmcnt(3)
    v_mfma_f32_16x16x32_f16 v[20:23], v[92:95], v[40:43], v[20:23]
    ds_read_b128 v[48:51], v8 offset:3648
    v_mfma_f32_16x16x32_f16 v[24:27], v[60:63], v[40:43], v[24:27]
    ds_read_b128 v[112:115], v8 offset:3712
    s_waitcnt lgkmcnt(4)
    v_mfma_f32_16x16x32_f16 v[20:23], v[96:99], v[108:111], v[20:23]
    ds_read_b128 v[52:55], v8 offset:3776
    v_mfma_f32_16x16x32_f16 v[24:27], v[64:67], v[108:111], v[24:27]
    ds_read_b128 v[120:123], v8 offset:3840
    s_waitcnt lgkmcnt(5)
    v_mfma_f32_16x16x32_f16 v[20:23], v[100:103], v[44:47], v[20:23]
    ds_read_b128 v[56:59], v8 offset:3904
    v_mfma_f32_16x16x32_f16 v[24:27], v[68:71], v[44:47], v[24:27]
    ds_read_b32 v18, v14 offset:76
    ds_read_b128 v[36:39], v8 offset:3968
    s_waitcnt lgkmcnt(7)
    v_mfma_f32_16x16x32_f16 v[24:27], v[72:75], v[32:35], v[24:27]
    ds_read_b128 v[60:63], v8 offset:4032
    s_waitcnt lgkmcnt(7)
    v_mfma_f32_16x16x32_f16 v[24:27], v[76:79], v[48:51], v[24:27]
    ds_read_b64 v[40:41], v11 offset:64
    ds_read_b64 v[42:43], v11 offset:72
    ds_read_b64 v[64:65], v11 offset:128
    ds_read_b64 v[66:67], v11 offset:136
    s_waitcnt lgkmcnt(10)
    v_mfma_f32_16x16x32_f16 v[24:27], v[80:83], v[112:115], v[24:27]
    s_waitcnt lgkmcnt(6)
    v_cmp_ne_u32 vcc, s84, v18
    s_cbranch_vccnz WS_48
WB_49:
    ds_read_b64_tr_b16 v[108:109], v9 offset:1024
    ds_read_b64_tr_b16 v[110:111], v9 offset:1088
    ds_read_b64_tr_b16 v[68:69], v9 offset:1536
    ds_read_b64_tr_b16 v[70:71], v9 offset:1600
    v_mfma_f32_16x16x32_f16 v[24:27], v[84:87], v[52:55], v[24:27]
    ds_read_b64_tr_b16 v[44:45], v9 offset:2048
    ds_read_b64_tr_b16 v[46:47], v9 offset:2112
    v_mfma_f32_16x16x32_f16 v[24:27], v[88:91], v[120:123], v[24:27]
    ds_read_b64_tr_b16 v[72:73], v9 offset:4112
    ds_read_b64_tr_b16 v[74:75], v9 offset:4176
    ds_read_b64 v[32:33], v11 offset:256
    ds_read_b64 v[34:35], v11 offset:264
    v_mfma_f32_16x16x32_f16 v[24:27], v[92:95], v[56:59], v[24:27]
    ds_read_b64_tr_b16 v[76:77], v9 offset:4624
    ds_read_b64_tr_b16 v[78:79], v9 offset:4688
    ds_read_b64 v[48:49], v11 offset:320
    ds_read_b64 v[50:51], v11 offset:328
    v_mfma_f32_16x16x32_f16 v[24:27], v[96:99], v[36:39], v[24:27]
    ds_read_b64_tr_b16 v[80:81], v9 offset:5136
    ds_read_b64_tr_b16 v[82:83], v9 offset:5200
    ds_read_b64 v[112:113], v11 offset:384
    ds_read_b64 v[114:115], v11 offset:392
    v_mfma_f32_16x16x32_f16 v[24:27], v[100:103], v[60:63], v[24:27]
    ds_read_b64_tr_b16 v[84:85], v10 offset:6176
    ds_read_b64_tr_b16 v[86:87], v10 offset:6304
    ds_read_b64 v[52:53], v13 offset:32
    ds_read_b64 v[54:55], v13 offset:40
    v_mfma_f32_16x16x32_f16 v[20:23], v[108:111], v[104:107], v[20:23]
    ds_read_b64_tr_b16 v[88:89], v10 offset:7200
    ds_read_b64_tr_b16 v[90:91], v10 offset:7328
    ds_read_b64 v[120:121], v13 offset:96
    ds_read_b64 v[122:123], v13 offset:104
    v_mfma_f32_16x16x32_f16 v[20:23], v[68:71], v[40:43], v[20:23]
    ds_read_b64_tr_b16 v[92:93], v10 offset:8224
    ds_read_b64_tr_b16 v[94:95], v10 offset:8352
    ds_read_b64 v[56:57], v13 offset:416
    ds_read_b64 v[58:59], v13 offset:424
    v_mfma_f32_16x16x32_f16 v[20:23], v[44:47], v[64:67], v[20:23]
    ds_read_b64_tr_b16 v[96:97], v10 offset:9248
    ds_read_b64_tr_b16 v[98:99], v10 offset:9376
    ds_read_b64 v[36:37], v13 offset:480
    ds_read_b64 v[38:39], v13 offset:488
    v_mfma_f32_16x16x32_f16 v[20:23], v[72:75], v[32:35], v[20:23]
    v_mfma_f32_16x16x32_f16 v[20:23], v[76:79], v[48:51], v[20:23]
    v_mfma_f32_16x16x32_f16 v[20:23], v[80:83], v[112:115], v[20:23]
    ds_read_b64_tr_b16 v[100:101], v9 offset:2560
    ds_read_b64_tr_b16 v[102:103], v9 offset:2624
    s_waitcnt lgkmcnt(14)
    v_mfma_f32_16x16x32_f16 v[20:23], v[84:87], v[52:55], v[20:23]
    s_waitcnt lgkmcnt(10)
    v_mfma_f32_16x16x32_f16 v[20:23], v[88:91], v[120:123], v[20:23]
    s_waitcnt lgkmcnt(6)
    v_mfma_f32_16x16x32_f16 v[20:23], v[92:95], v[56:59], v[20:23]
    ds_read_b64_tr_b16 v[60:61], v9 offset:5648
    ds_read_b64_tr_b16 v[62:63], v9 offset:5712
    ds_read_b64 v[108:109], v13 offset:0
    ds_read_b64 v[110:111], v13 offset:8
    s_waitcnt lgkmcnt(6)
    v_mfma_f32_16x16x32_f16 v[20:23], v[96:99], v[36:39], v[20:23]
    ds_read_b64 v[72:73], v13 offset:64
    ds_read_b64 v[74:75], v13 offset:72
    ds_read_b64 v[52:53], v13 offset:384
    ds_read_b64 v[54:55], v13 offset:392
    v_mfma_f32_16x16x32_f16 v[24:27], v[68:71], v[104:107], v[24:27]
    ds_read_b64 v[120:121], v13 offset:448
    ds_read_b64 v[122:123], v13 offset:456
    v_mfma_f32_16x16x32_f16 v[24:27], v[44:47], v[40:43], v[24:27]
    v_cvt_pk_bf16_f32 v20, 0, v20
    v_cvt_pk_bf16_f32 v21, 0, v21
    s_waitcnt lgkmcnt(10)
    v_mfma_f32_16x16x32_f16 v[24:27], v[100:103], v[64:67], v[24:27]
    v_cvt_pk_bf16_f32 v22, 0, v22
    v_cvt_pk_bf16_f32 v23, 0, v23
    v_mfma_f32_16x16x32_f16 v[24:27], v[76:79], v[32:35], v[24:27]
    v_fma_f32 v20, v20, v16, v116
    v_fma_f32 v21, v21, v16, v117
    v_mfma_f32_16x16x32_f16 v[24:27], v[80:83], v[48:51], v[24:27]
    v_fma_f32 v22, v22, v16, v118
    v_fma_f32 v23, v23, v16, v119
    s_waitcnt lgkmcnt(8)
    v_mfma_f32_16x16x32_f16 v[24:27], v[60:63], v[112:115], v[24:27]
    v_cvt_pk_bf16_f32 v28, v20, v21
    v_cvt_pk_bf16_f32 v29, v22, v23
    s_waitcnt lgkmcnt(6)
    v_mfma_f32_16x16x32_f16 v[24:27], v[84:87], v[108:111], v[24:27]
    v_min_u32 v28, -2, v28
    v_min_u32 v29, -2, v29
    s_waitcnt lgkmcnt(4)
    v_mfma_f32_16x16x32_f16 v[24:27], v[88:91], v[72:75], v[24:27]
    s_waitcnt lgkmcnt(2)
    v_mfma_f32_16x16x32_f16 v[24:27], v[92:95], v[52:55], v[24:27]
    s_waitcnt lgkmcnt(0)
    v_mfma_f32_16x16x32_f16 v[24:27], v[96:99], v[120:123], v[24:27]
    ds_read_u8 v18, v14 offset:115
    ds_read_b128 v[20:23], v12 offset:49664
    s_nop 5
    v_cvt_pk_bf16_f32 v24, 0, v24
    v_cvt_pk_bf16_f32 v25, 0, v25
    v_cvt_pk_bf16_f32 v26, 0, v26
    v_cvt_pk_bf16_f32 v27, 0, v27
    v_fma_f32 v24, v24, v16, v124
    v_fma_f32 v25, v25, v16, v125
    v_fma_f32 v26, v26, v16, v126
    v_fma_f32 v27, v27, v16, v127
    v_cvt_pk_bf16_f32 v30, v24, v25
    v_cvt_pk_bf16_f32 v31, v26, v27
    v_min_u32 v30, -2, v30
    v_min_u32 v31, -2, v31
CVE_35:
    s_waitcnt lgkmcnt(0)
    s_cmp_lg_u32 s87, 1
    s_cbranch_scc1 ZA_50
    v_cmp_ne_u32 vcc, 1, v18
    s_cbranch_vccnz ZS_52
ZB_53:
    s_mov_b64 exec, s[12:13]
    v_swap_b32 v28, v20
    v_swap_b32 v29, v21
    v_swap_b32 v30, v22
    v_swap_b32 v31, v23
    s_mov_b64 exec, -1
    buffer_store_dwordx4 v[28:31], v6, s[64:67], s7 offen sc1
    buffer_store_dwordx4 v[20:23], v6, s[64:67], s6 offen sc1
    s_branch ZD_55
WS_40:
W_56:
    ds_read_b32 v18, v14 offset:76
    s_sub_u32 s39, s39, 1
    s_cbranch_scc1 KS_ABORT
    s_waitcnt lgkmcnt(0)
    v_cmp_ne_u32 vcc, s84, v18
    s_cbranch_vccnz W_56
    s_branch WB_41
WS_44:
W_57:
    ds_read_b32 v18, v14 offset:76
    s_sub_u32 s39, s39, 1
    s_cbranch_scc1 KS_ABORT
    s_waitcnt lgkmcnt(0)
    v_cmp_ne_u32 vcc, s84, v18
    s_cbranch_vccnz W_57
    s_branch WB_45
WS_48:
W_58:
    ds_read_b32 v18, v14 offset:76
    s_sub_u32 s39, s39, 1
    s_cbranch_scc1 KS_ABORT
    s_waitcnt lgkmcnt(0)
    v_cmp_ne_u32 vcc, s84, v18
    s_cbranch_vccnz W_58
    s_branch WB_49
US_36:
    s_setprio 0
W_59:
    s_sleep 1
    ds_read_b32 v18, v4 offset:16
    s_sub_u32 s39, s39, 1
    s_cbranch_scc1 KS_ABORT
    s_waitcnt lgkmcnt(0)
    v_cmp_eq_u32 vcc, 0, v18
    s_cbranch_vccnz W_59
W_60:
    ds_read_b32 v18, v4 offset:16
    s_sub_u32 s39, s39, 1
    s_cbranch_scc1 KS_ABORT
    s_waitcnt lgkmcnt(0)
    v_cmp_ne_u32 vcc, s84, v18
    s_cbranch_vccnz W_60
    ds_read_b128 v[96:99], v8 offset:0
    ds_read_b128 v[100:103], v8 offset:64
    ds_read_b128 v[104:107], v8 offset:128
    ds_read_b128 v[108:111], v8 offset:192
    s_branch UB_37
US_38:
    s_setprio 0
W_61:
    s_sleep 1
    ds_read_b32 v18, v4 offset:16
    s_sub_u32 s39, s39, 1
    s_cbranch_scc1 KS_ABORT
    s_waitcnt lgkmcnt(0)
    v_cmp_eq_u32 vcc, 0, v18
    s_cbranch_vccnz W_61
W_62:
    ds_read_b32 v18, v4 offset:16
    s_sub_u32 s39, s39, 1
    s_cbranch_scc1 KS_ABORT
    s_waitcnt lgkmcnt(0)
    v_cmp_ne_u32 vcc, s84, v18
    s_cbranch_vccnz W_62
    ds_read_b128 v[108:111], v8 offset:448
    ds_read_b128 v[112:115], v8 offset:512
    ds_read_b128 v[116:119], v8 offset:576
    ds_read_b128 v[120:123], v8 offset:640
    ds_read_b128 v[124:127], v8 offset:704
    s_branch UB_39
US_42:
    s_setprio 0
W_63:
    s_sleep 1
    ds_read_b32 v18, v4 offset:16
    s_sub_u32 s39, s39, 1
    s_cbranch_scc1 KS_ABORT
    s_waitcnt lgkmcnt(0)
    v_cmp_eq_u32 vcc, 0, v18
    s_cbranch_vccnz W_63
W_64:
    ds_read_b32 v18, v4 offset:16
    s_sub_u32 s39, s39, 1
    s_cbranch_scc1 KS_ABORT
    s_waitcnt lgkmcnt(0)
    v_cmp_ne_u32 vcc, s84, v18
    s_cbranch_vccnz W_64
    ds_read_b128 v[108:111], v8 offset:448
    ds_read_b128 v[112:115], v8 offset:960
    ds_read_b128 v[116:119], v8 offset:1472
    ds_read_b128 v[120:123], v8 offset:1536
    ds_read_b128 v[124:127], v8 offset:1600
    s_branch UB_43
US_46:
    s_setprio 0
W_65:
    s_sleep 1
    ds_read_b32 v18, v4 offset:16
    s_sub_u32 s39, s39, 1
    s_cbranch_scc1 KS_ABORT
    s_waitcnt lgkmcnt(0)
    v_cmp_eq_u32 vcc, 0, v18
    s_cbranch_vccnz W_65
W_66:
    ds_read_b32 v18, v4 offset:16
    s_sub_u32 s39, s39, 1
    s_cbranch_scc1 KS_ABORT
    s_waitcnt lgkmcnt(0)
    v_cmp_ne_u32 vcc, s84, v18
    s_cbranch_vccnz W_66
    ds_read_b128 v[108:111], v8 offset:1472
    ds_read_b128 v[112:115], v8 offset:1984
    ds_read_b128 v[116:119], v8 offset:2496
    ds_read_b128 v[120:123], v8 offset:2560
    ds_read_b128 v[124:127], v8 offset:2624
    s_branch UB_47
ZS_52:
    v_mov_b32 v19, s86
    v_lshl_add_u32 v16, v19, 10, v12
ZW_67:
    ds_read_u8 v18, v19 offset:128
    ds_read_b128 v[20:23], v16 offset:46592
    s_sub_u32 s39, s39, 1
    s_cbranch_scc1 KS_ABORT
    s_waitcnt lgkmcnt(0)
    v_cmp_ne_u32 vcc, 1, v18
    s_cbranch_vccnz ZW_67
    s_branch ZB_53
ZA_50:
    v_cmp_eq_u32 vcc, 1, v18
    s_cbranch_vccnz KS_CLK
W_68:
    ds_read_b32 v18, v4 offset:112
    s_sub_u32 s39, s39, 1
    s_cbranch_scc1 KS_ABORT
    s_waitcnt lgkmcnt(0)
    v_cmp_ne_u32 vcc, s84, v18
    s_cbranch_vccnz W_68
KS_CLK:
    s_cmp_lg_u32 s87, 0
    s_cbranch_scc1 ZC_51
    v_mov_b32 v19, s86
    v_lshl_add_u32 v18, v19, 10, v12
    ds_write_b128 v18, v[28:31] offset:46592
    ds_write_b8 v19, v5 offset:128
    s_branch ZD_55
ZC_51:
    buffer_store_dwordx4 v[28:31], v6, s[64:67], s6 offen sc1
ZD_55:
    s_lshl_b32 s92, s87, 2
    s_add_u32 s92, s92, s86
    v_mov_b32 v8, s92
    s_waitcnt vmcnt(0)
    ds_write_b8 v8, v5 offset:48
    s_branch KS_K1
    s_cmp_lg_u32 s38, 4
    s_cbranch_scc1 KS_K1
    s_setprio 0
    s_add_u32 s76, s36, 0x840000
    s_addc_u32 s77, s37, 0
    s_mov_b32 s78, 0x4000
    s_mov_b32 s79, 0x20000
    v_and_b32 v6, 1, v1
    v_lshlrev_b32 v6, 4, v6
    s_lshl_b32 s92, s90, 5
W_69:
    s_sleep 1
    ds_read_b32 v8, v4 offset:20
    s_sub_u32 s39, s39, 1
    s_cbranch_scc1 KS_ABORT
    s_waitcnt lgkmcnt(0)
    v_cmp_ne_u32 vcc, s84, v8
    s_cbranch_vccnz W_69
    s_mov_b64 exec, 3
    s_setprio 1
KS_K0:
    ds_read_b128 v[8:11], v6 offset:800
    s_sub_u32 s39, s39, 1
    s_cbranch_scc1 KS_ABORT
    s_waitcnt lgkmcnt(0)
    v_min3_u32 v12, v8, v9, v10
    v_min_u32 v12, v12, v11
    v_cmp_eq_u32 vcc, 0, v12
    s_cbranch_vccnz KS_K0
    buffer_store_dwordx4 v[8:11], v6, s[76:79], s92 offen sc1
    s_mov_b64 exec, -1
    s_waitcnt vmcnt(0)
    ds_write_b32 v4, v5 offset:24
KS_K1:
    s_cmp_lt_u32 s41, 18
    s_cbranch_scc1 KS_T
    s_waitcnt lgkmcnt(0)
    s_endpgm
KS_X:
    s_cmp_lt_u32 s41, 24
    s_cbranch_scc1 KS_X2
    s_setprio 2
KS_XC:
    s_add_u32 s86, s38, 3
KS_XD:
    s_mov_b32 s87, 2
    s_and_b32 s86, s86, 3
    s_lshl_b32 s88, s40, 3
    s_and_b32 s92, s41, 7
    s_add_u32 s88, s88, s92
    s_add_u32 s88, s88, 512
    s_lshl_b32 s92, s86, 11
    s_add_u32 s92, s92, 146048
    v_lshl_add_u32 v28, v1, 3, s92
    s_branch KS_GRP
KS_X2:
    s_cmp_lt_u32 s41, 8
    s_cbranch_scc1 KS_X3
    s_sub_u32 s97, s38, 8
    s_branch KS_LN1
KS_X3:
    s_lshl_b32 s92, s2, 4
    s_add_u32 s92, s92, s38
    s_cmp_lg_u32 s92, 44
    s_cbranch_scc1 KS_X3B
    s_setprio 3
    s_memrealtime s[92:93]
    v_and_b32 v6, 3, v1
    v_lshlrev_b32 v7, 2, v6
    v_min_u32 v6, 2, v6
    v_lshlrev_b32 v6, 2, v6
    v_cmp_eq_u32 vcc, 3, v1
    s_waitcnt lgkmcnt(0)
    v_mov_b32 v8, s92
    v_mov_b32 v9, s93
    v_alignbit_b32 v8, v8, v8, v6
    v_cndmask_b32 v9, v4, v9, vcc
    v_xor_b32 v8, v8, v9
    v_and_b32 v9, 0xf0000fff, v8
    v_and_b32 v10, 0xfff000, v8
    v_lshl_or_b32 v9, v10, 4, v9
    v_lshrrev_b32 v10, 12, v8
    v_and_b32 v10, 0xf000, v10
    v_or3_b32 v9, v9, v10, v9
    v_or_b32 v9, 0x80000000, v9
    s_mov_b64 exec, 15
    global_store_dword v7, v9, s[34:35] sc1
    s_mov_b64 exec, -1
    s_setprio 0
KS_X3B:
    s_setprio 3
    s_branch KS_XC
    s_waitcnt lgkmcnt(0)
    s_barrier
    s_branch KS_G
KS_X4:
    s_setprio 0
    s_cmp_lt_u32 s41, 18
    s_cbranch_scc1 KS_GN
KS_X5:
    v_mul_u32_u24 v46, 57, v1
    v_lshrrev_b32 v46, 9, v46
    v_mul_u32_u24 v47, 9, v46
    v_sub_u32 v47, v1, v47
    v_mul_u32_u24 v46, 9216, v46
    v_lshl_add_u32 v46, v47, 7, v46
    s_mul_i32 s94, s38, 6
    s_add_u32 s94, s94, s41
    s_sub_u32 s94, s94, 90
W_70:
    s_sleep 2
    ds_read_b32 v10, v4 offset:200
    s_sub_u32 s39, s39, 1
    s_cbranch_scc1 KS_ABORT
    s_waitcnt lgkmcnt(0)
    v_cmp_ne_u32 vcc, s84, v10
    s_cbranch_vccnz W_70
    s_bitcmp1_b32 s94, 0
    s_cselect_b32 s72, s28, s26
    s_cselect_b32 s73, s29, s27
    s_mov_b32 s74, 0x510000
    s_mov_b32 s75, 0x20000
    s_lshr_b32 s95, s94, 1
    s_mul_i32 s95, s95, 64512
    s_mul_i32 s96, s40, 1152
    s_add_u32 s95, s95, s96
    s_add_u32 s96, s95, 2644992
    buffer_load_dword v47, v46, s[72:75], s96 offen nt
    buffer_load_dword v47, v46, s[72:75], s96 offen sc1
KS_XPE:
    s_waitcnt vmcnt(0) lgkmcnt(0)
    s_endpgm
KS_L:
    v_lshlrev_b32 v6, 2, v0
    ds_write_b32 v6, v4
    v_mov_b32 v8, 0
    v_mov_b32 v9, 0
    s_min_u32 s92, s38, 2
    s_mul_i32 s92, s92, 4672
    v_min_u32 v6, 59, v1
    v_lshl_add_u32 v6, v6, 3, s92
    ds_write_b64 v6, v[8:9] offset:3072
    s_mov_b32 s97, s38
    s_sub_u32 s92, s41, 8
    s_cmp_lt_u32 s92, 16
    s_cbranch_scc0 KS_L0
KS_LN1:
    s_setprio 3
    s_sub_u32 s92, s41, 8
    s_and_b32 s88, s92, 7
    s_lshr_b32 s92, s92, 3
    s_lshl_b32 s92, s92, 4
    s_add_u32 s88, s88, s92
    s_and_b32 s92, s40, 1
    s_lshl_b32 s92, s92, 3
    s_add_u32 s88, s88, s92
    s_lshr_b32 s92, s40, 1
    s_lshl_b32 s92, s92, 5
    s_add_u32 s88, s88, s92
    v_lshrrev_b32 v36, 5, v1
    v_and_b32 v37, 31, v1
    v_mul_u32_u24 v38, 9216, v36
    v_lshl_add_u32 v39, v37, 2, v38
    v_lshl_add_u32 v38, v37, 4, v38
    s_mul_i32 s93, s88, 18432
    s_mul_i32 s94, s97, 1152
    s_add_u32 s93, s93, s94
    s_mov_b32 s66, 0x240000
    s_mov_b32 s67, 0x20000
    s_waitcnt lgkmcnt(0)
    s_mov_b32 s64, s4
    s_mov_b32 s65, s5
    buffer_load_dwordx4 v[26:29], v38, s[64:67], s93 offen
    buffer_load_dwordx4 v[30:33], v38, s[64:67], s93 offen offset:512
    buffer_load_dword v34, v39, s[64:67], s93 offen offset:1024
    s_barrier
    s_mul_i32 s94, s97, 2368
    s_add_u32 s94, s94, 16576
    v_lshl_add_u32 v6, v37, 1, v36
    v_lshl_add_u32 v6, v6, 2, s94
    v_and_b32 v59, 3, v1
    v_bfe_u32 v7, v1, 2, 2
    v_mul_u32_u24 v7, 2368, v7
    v_lshl_add_u32 v40, v3, 2, v59
    v_lshl_add_u32 v7, v40, 3, v7
    s_lshl_b32 s94, s97, 7
    s_add_u32 s92, s94, 18624
    v_add_u32 v44, s92, v7
    s_lshl_b32 s94, s97, 8
    s_add_u32 s94, s94, 16576
    v_add_u32 v7, s94, v7
    v_lshlrev_b32 v41, 4, v59
    s_nop 1
    v_mov_b32_dpp v40, v41 quad_perm:[0,2,1,3] row_mask:0xf bank_mask:0xf
    v_lshlrev_b32 v59, 2, v59
    v_lshrrev_b32 v41, 2, v1
    v_mul_u32_u24 v35, 0x8200, v41
    s_lshl_b32 s92, s88, 6
    s_and_b32 s93, s92, 0x1e00
    v_xad_u32 v35, v35, s93, v40
    s_lshl_b32 s93, s97, 4
    v_add_u32 v41, s93, v41
    v_mul_u32_u24 v45, 0x2080, v41
    v_xad_u32 v45, v45, s92, v40
    s_and_b32 s93, s97, 3
    s_mul_i32 s93, s93, 0x2080
    s_and_b32 s92, s92, 0x1c0
    s_xor_b32 s83, s92, s93
    s_lshr_b32 s93, s97, 2
    s_lshl_b32 s93, s93, 20
    s_add_u32 s83, s83, s93
    s_add_u32 s96, s83, 0x80000
    s_mov_b32 s80, 0x3f80
    s_mov_b32 s81, 0x3f800000
    s_mov_b32 s82, 0x3f803f80
    s_mov_b32 s98, 0x70007
    s_mov_b32 s99, 0x200000
    v_mov_b32 v40, 0
    v_mov_b32 v41, 0
    v_mov_b32 v42, 0x3ae38e39
    s_mov_b32 s72, s36
    s_mov_b32 s73, s37
    s_mov_b32 s74, 0x240000
    s_mov_b32 s75, 0x20000
    s_cmp_lt_u32 s97, 4
    s_cbranch_scc1 LN1A_71
    s_cmp_ge_u32 s41, 18
    s_cbranch_scc1 LN1A_71
    s_mov_b32 s68, s30
    s_mov_b32 s69, s31
    s_mov_b32 s70, 0x510000
    s_mov_b32 s71, 0x20000
    v_lshlrev_b32 v46, 4, v1
    s_mul_i32 s92, s89, 36864
    s_mul_i32 s93, s97, 9216
    s_add_u32 s92, s92, s93
    s_sub_u32 s92, s92, 36864
    s_add_u32 s93, s93, 72320
    s_add_u32 m0, s93, 0
    s_nop 0
    buffer_load_dwordx4 v46, s[68:71], s92 offen offset:0 nt lds
    buffer_load_dwordx4 v46, s[68:71], s92 offen offset:1024 nt lds
    buffer_load_dwordx4 v46, s[68:71], s92 offen offset:2048 nt lds
    buffer_load_dwordx4 v46, s[68:71], s92 offen offset:3072 nt lds
    s_add_u32 m0, s93, 4096
    s_add_u32 s92, s92, 4096
    buffer_load_dwordx4 v46, s[68:71], s92 offen offset:0 nt lds
    buffer_load_dwordx4 v46, s[68:71], s92 offen offset:1024 nt lds
    buffer_load_dwordx4 v46, s[68:71], s92 offen offset:2048 nt lds
    buffer_load_dwordx4 v46, s[68:71], s92 offen offset:3072 nt lds
    s_add_u32 m0, s93, 8192
    s_add_u32 s92, s92, 4096
    buffer_load_dwordx4 v46, s[68:71], s92 offen offset:0 nt lds
    s_waitcnt vmcnt(11)
    v_dot2c_f32_bf16 v40, s82, v26
    v_dot2c_f32_bf16 v41, v26, v26
    v_dot2c_f32_bf16 v40, s82, v27
    v_dot2c_f32_bf16 v41, v27, v27
    v_dot2c_f32_bf16 v40, s82, v28
    v_dot2c_f32_bf16 v41, v28, v28
    v_dot2c_f32_bf16 v40, s82, v29
    v_dot2c_f32_bf16 v41, v29, v29
    s_waitcnt vmcnt(10)
    v_dot2c_f32_bf16 v40, s82, v30
    v_dot2c_f32_bf16 v41, v30, v30
    v_dot2c_f32_bf16 v40, s82, v31
    v_dot2c_f32_bf16 v41, v31, v31
    v_dot2c_f32_bf16 v40, s82, v32
    v_dot2c_f32_bf16 v41, v32, v32
    v_dot2c_f32_bf16 v40, s82, v33
    v_dot2c_f32_bf16 v41, v33, v33
    s_waitcnt vmcnt(9)
    v_dot2c_f32_bf16 v40, s82, v34
    v_dot2c_f32_bf16 v41, v34, v34
    s_branch LN1B_72
LN1A_71:
    s_waitcnt vmcnt(2)
    v_dot2c_f32_bf16 v40, s82, v26
    v_dot2c_f32_bf16 v41, v26, v26
    v_dot2c_f32_bf16 v40, s82, v27
    v_dot2c_f32_bf16 v41, v27, v27
    v_dot2c_f32_bf16 v40, s82, v28
    v_dot2c_f32_bf16 v41, v28, v28
    v_dot2c_f32_bf16 v40, s82, v29
    v_dot2c_f32_bf16 v41, v29, v29
    s_waitcnt vmcnt(1)
    v_dot2c_f32_bf16 v40, s82, v30
    v_dot2c_f32_bf16 v41, v30, v30
    v_dot2c_f32_bf16 v40, s82, v31
    v_dot2c_f32_bf16 v41, v31, v31
    v_dot2c_f32_bf16 v40, s82, v32
    v_dot2c_f32_bf16 v41, v32, v32
    v_dot2c_f32_bf16 v40, s82, v33
    v_dot2c_f32_bf16 v41, v33, v33
    s_waitcnt vmcnt(0)
    v_dot2c_f32_bf16 v40, s82, v34
    v_dot2c_f32_bf16 v41, v34, v34
LN1B_72:
    s_nop 1
    v_add_f32_dpp v36, v40, v40 row_ror:8 row_mask:0xf bank_mask:0x3
    v_add_f32_dpp v36, v41, v41 row_ror:8 row_mask:0xf bank_mask:0xc
    s_nop 1
    v_add_f32_dpp v36, v36, v36 row_half_mirror row_mask:0xf bank_mask:0xf
    s_nop 1
    v_add_f32_dpp v36, v36, v36 quad_perm:[1,0,3,2] row_mask:0xf bank_mask:0xf
    s_nop 1
    v_add_f32_dpp v36, v36, v36 quad_perm:[2,3,0,1] row_mask:0xf bank_mask:0xf
    v_mov_b32 v37, v36
    s_nop 1
    v_permlane16_swap_b32 v36, v37
    v_add_f32 v36, v36, v37
    s_nop 1
    v_mul_f32_dpp v40, v36, v42 row_newbcast:0 row_mask:0xf bank_mask:0xf
    v_mul_f32_dpp v41, v36, v42 row_newbcast:8 row_mask:0xf bank_mask:0xf
    v_cvt_pk_bf16_f32 v36, 0, -v40
    v_fma_f32 v41, -v40, v40, v41
    v_dot2_f32_bf16 v8, v26, s80, v36
    v_dot2_f32_bf16 v9, v26, s81, v36
    v_max_f32 v41, 0, v41
    v_dot2_f32_bf16 v10, v27, s80, v36
    v_dot2_f32_bf16 v11, v27, s81, v36
    v_cvt_pk_bf16_f32 v41, 0, v41
    v_dot2_f32_bf16 v12, v28, s80, v36
    v_dot2_f32_bf16 v13, v28, s81, v36
    v_add_f32 v41, 0x3727c5ac, v41
    v_cvt_pk_bf16_f32 v8, 0, v8
    v_cvt_pk_bf16_f32 v9, 0, v9
    v_dot2_f32_bf16 v14, v29, s80, v36
    v_dot2_f32_bf16 v15, v29, s81, v36
    v_cvt_pk_bf16_f32 v41, 0, v41
    v_cvt_pk_bf16_f32 v10, 0, v10
    v_cvt_pk_bf16_f32 v11, 0, v11
    v_dot2_f32_bf16 v16, v30, s80, v36
    v_dot2_f32_bf16 v17, v30, s81, v36
    v_sqrt_f32 v41, v41
    v_cvt_pk_bf16_f32 v12, 0, v12
    v_cvt_pk_bf16_f32 v13, 0, v13
    v_dot2_f32_bf16 v18, v31, s80, v36
    v_dot2_f32_bf16 v19, v31, s81, v36
    v_cvt_pk_bf16_f32 v41, 0, v41
    v_cvt_pk_bf16_f32 v14, 0, v14
    v_cvt_pk_bf16_f32 v15, 0, v15
    v_dot2_f32_bf16 v20, v32, s80, v36
    v_dot2_f32_bf16 v21, v32, s81, v36
    v_rcp_f32 v38, v41
    v_cvt_pk_bf16_f32 v16, 0, v16
    v_cvt_pk_bf16_f32 v17, 0, v17
    v_dot2_f32_bf16 v22, v33, s80, v36
    v_dot2_f32_bf16 v23, v33, s81, v36
    v_cvt_pk_bf16_f32 v18, 0, v18
    v_cvt_pk_bf16_f32 v19, 0, v19
    v_dot2_f32_bf16 v24, v34, s80, v36
    v_dot2_f32_bf16 v25, v34, s81, v36
    v_cvt_pk_bf16_f32 v20, 0, v20
    v_cvt_pk_bf16_f32 v21, 0, v21
    v_cvt_pk_bf16_f32 v22, 0, v22
    v_cvt_pk_bf16_f32 v23, 0, v23
    v_pk_mul_f32 v[8:9], v[8:9], v[38:39] op_sel_hi:[1,0]
    v_cvt_pkrtz_f16_f32 v26, v8, v9
    v_add_u32 v26, 0x40004, v26
    v_cvt_pk_bf16_f32 v24, 0, v24
    v_cvt_pk_bf16_f32 v25, 0, v25
    v_pk_mul_f32 v[10:11], v[10:11], v[38:39] op_sel_hi:[1,0]
    v_cvt_pkrtz_f16_f32 v27, v10, v11
    v_add_u32 v27, 0x40004, v27
    ds_write2st64_b32 v6, v26, v27 offset0:0 offset1:1
    v_pk_mul_f32 v[12:13], v[12:13], v[38:39] op_sel_hi:[1,0]
    v_cvt_pkrtz_f16_f32 v28, v12, v13
    v_add_u32 v28, 0x40004, v28
    s_load_dwordx4 s[76:79], s[34:35], 0
    v_pk_mul_f32 v[14:15], v[14:15], v[38:39] op_sel_hi:[1,0]
    v_cvt_pkrtz_f16_f32 v29, v14, v15
    v_add_u32 v29, 0x40004, v29
    ds_write2st64_b32 v6, v28, v29 offset0:2 offset1:3
    v_pk_mul_f32 v[16:17], v[16:17], v[38:39] op_sel_hi:[1,0]
    v_cvt_pkrtz_f16_f32 v30, v16, v17
    v_add_u32 v30, 0x40004, v30
    v_pk_mul_f32 v[18:19], v[18:19], v[38:39] op_sel_hi:[1,0]
    v_cvt_pkrtz_f16_f32 v31, v18, v19
    v_add_u32 v31, 0x40004, v31
    ds_write2st64_b32 v6, v30, v31 offset0:4 offset1:5
    v_pk_mul_f32 v[20:21], v[20:21], v[38:39] op_sel_hi:[1,0]
    v_cvt_pkrtz_f16_f32 v32, v20, v21
    v_add_u32 v32, 0x40004, v32
    v_pk_mul_f32 v[22:23], v[22:23], v[38:39] op_sel_hi:[1,0]
    v_cvt_pkrtz_f16_f32 v33, v22, v23
    v_add_u32 v33, 0x40004, v33
    ds_write2st64_b32 v6, v32, v33 offset0:6 offset1:7
    v_pk_mul_f32 v[24:25], v[24:25], v[38:39] op_sel_hi:[1,0]
    v_cvt_pkrtz_f16_f32 v34, v24, v25
    v_add_u32 v34, 0x40004, v34
    ds_write_b32 v6, v34 offset:2048
    v_mov_b32 v6, s97
    ds_write_b8 v6, v5 offset:0
    s_waitcnt lgkmcnt(0)
    v_mov_b32 v58, s76
    v_mov_b32 v57, s77
    v_mov_b32 v56, s78
    v_mov_b32 v55, s79
    v_cmp_eq_u32 vcc, 4, v59
    s_nop 1
    v_cndmask_b32 v58, v58, v57, vcc
    v_cmp_eq_u32 vcc, 12, v59
    s_nop 1
    v_cndmask_b32 v56, v56, v55, vcc
    v_cmp_lt_u32 vcc, 4, v59
    s_nop 1
    v_cndmask_b32 v58, v58, v56, vcc
    s_waitcnt vmcnt(63)
DBP_73:
    v_cmp_eq_u32 vcc, 0, v58
    s_cbranch_vccz DBG_74
    s_sleep 1
    global_load_dword v58, v59, s[34:35] sc1
    s_sub_u32 s39, s39, 1
    s_cbranch_scc1 KS_ABORT
    s_waitcnt vmcnt(0)
    s_branch DBP_73
DBG_74:
    v_mov_b32_dpp v40, v58 quad_perm:[0,2,1,3] row_mask:0xf bank_mask:0xf
    v_lshrrev_b32 v41, 3, v40
    v_lshrrev_b32 v42, 6, v40
    v_lshrrev_b32 v43, 9, v40
W_75:
    ds_read_b64 v[20:21], v4 offset:0
    s_sub_u32 s39, s39, 1
    s_cbranch_scc1 KS_ABORT
    s_waitcnt lgkmcnt(0)
    v_and_b32 v20, v20, v21
    v_cmp_ne_u32 vcc, s84, v20
    s_cbranch_vccnz W_75
    ds_read_b64_tr_b16 v[20:21], v7 offset:0
    ds_read_b64_tr_b16 v[22:23], v7 offset:9472
    ds_read_b64_tr_b16 v[24:25], v7 offset:128
    ds_read_b64_tr_b16 v[26:27], v7 offset:9600
    ds_read_b64_tr_b16 v[28:29], v44 offset:0
    ds_read_b64_tr_b16 v[30:31], v44 offset:9472
    s_waitcnt lgkmcnt(4)
    v_bfi_b32 v20, s98, v40, v20
    v_bfi_b32 v21, s98, v41, v21
    v_bfi_b32 v22, s98, v42, v22
    v_bfi_b32 v23, s98, v43, v23
    buffer_store_dwordx4 v[20:23], v35, s[72:75], s83 offen sc1
    s_waitcnt lgkmcnt(2)
    v_bfi_b32 v24, s98, v40, v24
    v_bfi_b32 v25, s98, v41, v25
    v_bfi_b32 v26, s98, v42, v26
    v_bfi_b32 v27, s98, v43, v27
    buffer_store_dwordx4 v[24:27], v35, s[72:75], s96 offen sc1
    s_waitcnt lgkmcnt(0)
    s_cmp_ge_u32 s97, 4
    s_cbranch_scc1 KS_X4
    v_bfi_b32 v28, s98, v40, v28
    v_bfi_b32 v29, s98, v41, v29
    v_bfi_b32 v30, s98, v42, v30
    v_bfi_b32 v31, s98, v43, v31
    buffer_store_dwordx4 v[28:31], v45, s[72:75], s99 offen sc1
    ds_write_b8 v6, v5 offset:200
    ds_write_b32 v59, v58 offset:224
    v_lshrrev_b32 v57, 3, v58
    v_lshrrev_b32 v56, 6, v58
    v_lshrrev_b32 v55, 9, v58
    s_mov_b32 s87, 1
    s_branch KS_L2B
KS_L0:
    s_and_b32 s92, s41, 15
    s_lshl_b32 s93, s40, 4
    s_add_u32 s92, s92, s93
    v_and_b32 v59, 3, v1
    v_lshlrev_b32 v59, 2, v59
    s_lshl_b32 s96, s92, 6
    s_add_u32 s93, s96, 0xb00000
    v_add_u32 v7, s93, v59
    s_mul_i32 s93, s92, 18560
    s_add_u32 s93, s93, 0x600000
    v_lshlrev_b32 v6, 4, v0
    v_mov_b32 v12, -1
    v_mov_b32 v13, -1
    v_mov_b32 v14, -1
    v_mov_b32 v15, -1
    s_setprio 3
    v_mul_u32_u24 v16, 57, v1
    v_lshrrev_b32 v16, 9, v16
    v_mul_u32_u24 v17, 9, v16
    v_sub_u32 v17, v1, v17
    v_mul_u32_u24 v16, 9216, v16
    v_lshl_add_u32 v16, v17, 7, v16
    s_waitcnt lgkmcnt(0)
    s_add_u32 s68, s36, s93
    s_addc_u32 s69, s37, 0
    s_mov_b32 s70, 18560
    s_mov_b32 s71, 0x20000
    s_barrier
W_76:
    s_sleep 2
    ds_read_b32 v8, v4 offset:36
    s_sub_u32 s39, s39, 1
    s_cbranch_scc1 KS_ABORT
    s_waitcnt lgkmcnt(0)
    v_cmp_eq_u32 vcc, 0, v8
    s_cbranch_vccnz W_76
    s_mov_b32 s92, 0
    buffer_store_dwordx4 v[12:15], v6, s[68:71], s92 offen sc1
    s_mov_b32 s92, 4096
    buffer_store_dwordx4 v[12:15], v6, s[68:71], s92 offen sc1
    s_mov_b32 s92, 8192
    buffer_store_dwordx4 v[12:15], v6, s[68:71], s92 offen sc1
    s_mov_b32 s92, 12288
    buffer_store_dwordx4 v[12:15], v6, s[68:71], s92 offen sc1
    s_mov_b32 s92, 16384
    buffer_store_dwordx4 v[12:15], v6, s[68:71], s92 offen sc1
    global_load_dword v58, v59, s[34:35] sc1
    s_and_b32 s94, s41, 7
    s_lshl_b32 s95, s38, 3
    s_add_u32 s94, s94, s95
    s_bitcmp1_b32 s94, 0
    s_cselect_b32 s72, s28, s26
    s_cselect_b32 s73, s29, s27
    s_mov_b32 s74, 0x510000
    s_mov_b32 s75, 0x20000
    s_lshr_b32 s95, s94, 1
    s_mul_i32 s95, s95, 64512
    s_mul_i32 s96, s40, 1152
    s_add_u32 s95, s95, s96
    s_cmp_lt_u32 s41, 24
    s_cselect_b32 s74, 0, s74
    s_add_u32 s96, s95, 3419136
    s_cmp_ge_u32 s38, 4
    s_cselect_b32 s74, 0, s74
    buffer_load_dword v18, v16, s[72:75], s96 offen nt
    buffer_load_dword v18, v16, s[72:75], s96 offen sc1
    s_waitcnt vmcnt(2)
DBP_77:
    v_cmp_eq_u32 vcc, 0, v58
    s_cbranch_vccz DBG_78
    s_sleep 1
    global_load_dword v58, v59, s[34:35] sc1
    s_sub_u32 s39, s39, 1
    s_cbranch_scc1 KS_ABORT
    s_waitcnt vmcnt(0)
    s_branch DBP_77
DBG_78:
    ds_write_b32 v59, v58 offset:224
    s_mov_b64 exec, 1
    ds_add_rtn_u32 v8, v4, v5 offset:8
    s_mov_b64 exec, -1
    v_lshrrev_b32 v57, 3, v58
    v_lshrrev_b32 v56, 6, v58
    v_lshrrev_b32 v55, 9, v58
    s_waitcnt lgkmcnt(0)
    v_readfirstlane_b32 s92, v8
    s_cmp_lg_u32 s92, 3
    s_cbranch_scc1 KS_L2
    s_mov_b64 exec, 15
    global_store_dword v7, v58, s[36:37] sc1
    s_mov_b64 exec, -1
    s_and_b32 s94, s41, 7
    s_cmp_ge_u32 s41, 8
    s_cbranch_scc1 KS_L1C
    s_branch KS_L2
KS_L1C:
KS_L2:
    s_mov_b32 s87, 0
KS_L2B:
    s_mov_b32 s64, s36
    s_mov_b32 s65, s37
    s_mov_b32 s66, 0x240000
    s_mov_b32 s67, 0x20000
    v_lshrrev_b32 v7, 1, v1
    v_lshlrev_b32 v7, 6, v7
    v_and_b32 v10, 1, v1
    v_lshl_add_u32 v7, v10, 4, v7
    v_lshlrev_b32 v9, 4, v1
    s_lshl_b32 s92, s38, 11
    s_lshl_b32 s93, s90, 13
    s_add_u32 s93, s93, s92
    s_lshl_b32 s94, s90, 7
    s_and_b32 s95, s94, 0x380
    v_xor_b32 v13, s95, v9
    s_and_b32 s94, s94, 0x1c00
    s_xor_b32 s93, s93, s94
    s_xor_b32 s97, s93, 0x400
    s_lshl_b32 s95, s40, 3
    s_add_u32 s95, s95, s41
    s_add_u32 s95, s95, 488
    s_lshr_b32 s96, s95, 1
    s_lshl_b32 s96, s96, 13
    s_and_b32 s95, s95, 1
    s_lshl_b32 s95, s95, 5
    s_add_u32 s95, s95, s96
    s_add_u32 s95, s95, s92
    s_lshr_b32 s96, s96, 6
    s_and_b32 s94, s96, 0x780
    v_xor_b32 v7, s94, v7
    s_and_b32 s96, s96, 0x1800
    s_xor_b32 s95, s95, s96
    s_cmp_lt_u32 s41, 24
    s_cselect_b32 s95, 2359296, s95
    s_cselect_b32 s94, 0, 0x70007
    v_mov_b32_dpp v64, v58 quad_perm:[0,1,0,1] row_mask:0xf bank_mask:0xf
    v_mov_b32_dpp v65, v58 quad_perm:[2,3,2,3] row_mask:0xf bank_mask:0xf
    s_bitcmp1_b32 s41, 0
    s_cselect_b64 vcc, -1, 0
    v_cndmask_b32 v64, v64, v65, vcc
    v_and_b32 v60, 0x70007, v58
    v_and_b32 v61, 0x70007, v57
    v_and_b32 v62, 0x70007, v56
    v_and_b32 v63, 0x70007, v55
    v_lshrrev_b32 v67, 9, v64
    v_lshrrev_b32 v66, 6, v64
    v_lshrrev_b32 v65, 3, v64
    v_and_b32 v64, s94, v64
    v_and_b32 v65, s94, v65
    v_and_b32 v66, s94, v66
    v_and_b32 v67, s94, v67
    s_lshl_b32 s96, s38, 10
    s_add_u32 s96, s96, 3552
    v_bfe_u32 v11, v1, 1, 1
    v_mul_u32_u24 v11, 4672, v11
    v_lshl_add_u32 v11, v10, 4, v11
    v_lshrrev_b32 v10, 2, v1
    v_lshl_add_u32 v11, v10, 5, v11
    v_add_u32 v11, s96, v11
    v_add_u32 v10, s96, v9
    v_mov_b32 v116, s38
    s_add_u32 s92, s92, 0xb00000
    v_lshrrev_b32 v12, 2, v1
    v_lshl_add_u32 v12, v12, 6, v59
    v_add_u32 v12, s92, v12
    s_cmp_lt_u32 s41, 8
    s_cselect_b32 s94, 8, 8
    s_cmp_ge_u32 s41, 24
    s_cselect_b32 s94, 20, s94
    v_mov_b32 v14, s94
    s_setprio 0
    ds_write_b8 v116, v5 offset:204
W_79:
    s_sleep 2
    ds_read_b32 v8, v14 offset:64
    s_sub_u32 s39, s39, 1
    s_cbranch_scc1 KS_ABORT
    s_waitcnt lgkmcnt(0)
    v_cmp_ne_u32 vcc, s84, v8
    s_cbranch_vccnz W_79
    s_setprio 3
    s_branch UPE_81
UP_80:
    s_sleep 1
UPE_81:
    buffer_load_dwordx4 v[20:23], v13, s[64:67], s93 offen sc1
    buffer_load_dwordx4 v[24:27], v13, s[64:67], s97 offen sc1
    buffer_load_dwordx4 v[28:31], v7, s[64:67], s95 offen sc1
    s_sub_u32 s39, s39, 1
    s_cbranch_scc1 KS_ABORT
    s_waitcnt vmcnt(2)
    v_xor_b32 v20, v60, v20
    v_xor_b32 v21, v61, v21
    v_xor_b32 v22, v62, v22
    v_xor_b32 v23, v63, v23
    ds_write_b128 v11, v[20:23]
    v_or3_b32 v44, v20, v21, v21
    v_or3_b32 v44, v22, v23, v44
    s_waitcnt vmcnt(1)
    v_xor_b32 v24, v60, v24
    v_xor_b32 v25, v61, v25
    v_xor_b32 v26, v62, v26
    v_xor_b32 v27, v63, v27
    ds_write_b128 v11, v[24:27] offset:512
    v_or3_b32 v44, v24, v25, v44
    v_or3_b32 v44, v26, v27, v44
    s_waitcnt vmcnt(0)
    v_xor_b32 v28, v64, v28
    v_xor_b32 v29, v65, v29
    v_xor_b32 v30, v66, v30
    v_xor_b32 v31, v67, v31
    ds_write_b128 v10, v[28:31] offset:9344
    v_or3_b32 v44, v28, v29, v44
    v_or3_b32 v44, v30, v31, v44
    v_and_b32 v44, 0x70007, v44
    v_cmp_ne_u32 vcc, 0, v44
    s_cbranch_vccnz UP_80
    ds_write_b8 v116, v5 offset:16
    s_cmp_eq_u32 s38, 2
    s_cbranch_scc1 WJ2_84
    s_add_u32 s92, s38, 1
    s_lshr_b32 s92, s92, 2
    s_cmp_eq_u32 s38, 1
    s_cselect_b32 s92, 2, s92
    s_lshl_b32 s92, s92, 10
    v_lshl_add_u32 v10, v1, 4, s92
    v_add_u32 v11, 35840, v10
W_85:
    ds_read_b32 v12, v4 offset:16
    s_sub_u32 s39, s39, 1
    s_cbranch_scc1 KS_ABORT
    s_waitcnt lgkmcnt(0)
    v_cmp_ne_u32 vcc, s84, v12
    s_cbranch_vccnz W_85
    s_setprio 3
    ds_read_b128 v[20:23], v10 offset:3520
    ds_read_b128 v[24:27], v10 offset:3536
    ds_read_b64 v[28:29], v10 offset:3552
    ds_read_b128 v[32:35], v10 offset:8192
    ds_read_b128 v[36:39], v10 offset:8208
    ds_read_b64 v[40:41], v10 offset:8224
    ds_read_b128 v[44:47], v10 offset:12864
    ds_read_b128 v[48:51], v10 offset:12880
    ds_read_b64 v[52:53], v10 offset:12896
    s_cmp_eq_u32 s38, 1
    s_cbranch_scc1 WJ1_83
    ds_read_b32 v12, v4 offset:68
    s_waitcnt lgkmcnt(7)
    v_alignbit_b32 v57, v22, v21, 16
    v_alignbit_b32 v58, v23, v22, 16
    v_alignbit_b32 v59, v24, v23, 16
    v_alignbit_b32 v60, v25, v24, 16
    v_alignbit_b32 v61, v26, v25, 16
    v_alignbit_b32 v62, v27, v26, 16
    v_alignbit_b32 v63, v28, v27, 16
    v_alignbit_b32 v64, v29, v28, 16
    v_pk_add_f16 v66, v57, v22
    v_pk_add_f16 v67, v58, v23
    v_pk_add_f16 v68, v59, v24
    v_pk_add_f16 v69, v60, v25
    v_pk_add_f16 v70, v61, v26
    v_pk_add_f16 v71, v62, v27
    v_pk_add_f16 v72, v63, v28
    v_pk_add_f16 v73, v64, v29
    v_pk_add_f16 v80, v66, v58
    v_pk_add_f16 v81, v67, v59
    v_pk_add_f16 v82, v68, v60
    v_pk_add_f16 v83, v69, v61
    v_pk_add_f16 v74, v67, v68
    v_pk_add_f16 v75, v68, v69
    v_pk_add_f16 v76, v69, v70
    v_pk_add_f16 v77, v70, v71
    v_pk_add_f16 v78, v71, v72
    v_pk_add_f16 v79, v72, v73
    s_waitcnt lgkmcnt(0)
    v_cmp_eq_u32 vcc, s84, v12
    s_cbranch_vccnz WJK_86
W_87:
    s_sleep 1
    ds_read_b32 v12, v4 offset:68
    s_sub_u32 s39, s39, 1
    s_cbranch_scc1 KS_ABORT
    s_waitcnt lgkmcnt(0)
    v_cmp_ne_u32 vcc, s84, v12
    s_cbranch_vccnz W_87
WJK_86:
    ds_write_b128 v11, v[80:83] offset:0
    v_pk_add_f16 v87, v22, v74
    v_pk_add_f16 v88, v23, v75
    v_pk_add_f16 v89, v24, v76
    v_pk_add_f16 v90, v25, v77
    v_pk_add_f16 v91, v26, v78
    ds_write_b128 v11, v[88:91] offset:3104
    v_pk_add_f16 v84, v70, v62
    v_pk_add_f16 v85, v71, v63
    v_pk_add_f16 v86, v72, v64
    v_pk_add_f16 v92, v74, v83
    v_pk_add_f16 v93, v75, v84
    v_pk_add_f16 v94, v76, v85
    v_pk_add_f16 v95, v77, v86
    ds_write_b128 v11, v[92:95] offset:6176
    v_pk_add_f16 v96, v87, v76
    v_pk_add_f16 v97, v88, v77
    v_pk_add_f16 v98, v89, v78
    v_pk_add_f16 v99, v90, v79
    ds_write_b128 v11, v[96:99] offset:8240
    ds_write_b8 v116, v5 offset:76
    ds_read_b32 v12, v4 offset:84
    v_alignbit_b32 v57, v34, v33, 16
    v_alignbit_b32 v58, v35, v34, 16
    v_alignbit_b32 v59, v36, v35, 16
    v_alignbit_b32 v60, v37, v36, 16
    v_alignbit_b32 v61, v38, v37, 16
    v_alignbit_b32 v62, v39, v38, 16
    v_alignbit_b32 v63, v40, v39, 16
    v_alignbit_b32 v64, v41, v40, 16
    v_pk_add_f16 v66, v57, v34
    v_pk_add_f16 v67, v58, v35
    v_pk_add_f16 v68, v59, v36
    v_pk_add_f16 v69, v60, v37
    v_pk_add_f16 v70, v61, v38
    v_pk_add_f16 v71, v62, v39
    v_pk_add_f16 v72, v63, v40
    v_pk_add_f16 v73, v64, v41
    v_pk_add_f16 v80, v66, v58
    v_pk_add_f16 v81, v67, v59
    v_pk_add_f16 v82, v68, v60
    v_pk_add_f16 v83, v69, v61
    v_pk_add_f16 v74, v67, v68
    v_pk_add_f16 v75, v68, v69
    v_pk_add_f16 v76, v69, v70
    v_pk_add_f16 v77, v70, v71
    v_pk_add_f16 v78, v71, v72
    v_pk_add_f16 v79, v72, v73
    s_waitcnt lgkmcnt(0)
    v_cmp_eq_u32 vcc, s84, v12
    s_cbranch_vccnz WJK_88
W_89:
    s_sleep 1
    ds_read_b32 v12, v4 offset:84
    s_sub_u32 s39, s39, 1
    s_cbranch_scc1 KS_ABORT
    s_waitcnt lgkmcnt(0)
    v_cmp_ne_u32 vcc, s84, v12
    s_cbranch_vccnz W_89
WJK_88:
    ds_write_b128 v11, v[80:83] offset:36672
    v_pk_add_f16 v87, v34, v74
    v_pk_add_f16 v88, v35, v75
    v_pk_add_f16 v89, v36, v76
    v_pk_add_f16 v90, v37, v77
    v_pk_add_f16 v91, v38, v78
    ds_write_b128 v11, v[88:91] offset:39776
    v_pk_add_f16 v84, v70, v62
    v_pk_add_f16 v85, v71, v63
    v_pk_add_f16 v86, v72, v64
    v_pk_add_f16 v92, v74, v83
    v_pk_add_f16 v93, v75, v84
    v_pk_add_f16 v94, v76, v85
    v_pk_add_f16 v95, v77, v86
    ds_write_b128 v11, v[92:95] offset:42848
    v_pk_add_f16 v96, v87, v76
    v_pk_add_f16 v97, v88, v77
    v_pk_add_f16 v98, v89, v78
    v_pk_add_f16 v99, v90, v79
    ds_write_b128 v11, v[96:99] offset:44912
    ds_write_b8 v116, v5 offset:92
    s_cmp_lt_u32 s41, 24
    s_cbranch_scc1 WJE_82
    ds_read_b32 v12, v4 offset:100
    v_alignbit_b32 v57, v46, v45, 16
    v_alignbit_b32 v58, v47, v46, 16
    v_alignbit_b32 v59, v48, v47, 16
    v_alignbit_b32 v60, v49, v48, 16
    v_alignbit_b32 v61, v50, v49, 16
    v_alignbit_b32 v62, v51, v50, 16
    v_alignbit_b32 v63, v52, v51, 16
    v_alignbit_b32 v64, v53, v52, 16
    v_pk_add_f16 v66, v57, v46
    v_pk_add_f16 v67, v58, v47
    v_pk_add_f16 v68, v59, v48
    v_pk_add_f16 v69, v60, v49
    v_pk_add_f16 v70, v61, v50
    v_pk_add_f16 v71, v62, v51
    v_pk_add_f16 v72, v63, v52
    v_pk_add_f16 v73, v64, v53
    v_pk_add_f16 v80, v66, v58
    v_pk_add_f16 v81, v67, v59
    v_pk_add_f16 v82, v68, v60
    v_pk_add_f16 v83, v69, v61
    v_pk_add_f16 v74, v67, v68
    v_pk_add_f16 v75, v68, v69
    v_pk_add_f16 v76, v69, v70
    v_pk_add_f16 v77, v70, v71
    v_pk_add_f16 v78, v71, v72
    v_pk_add_f16 v79, v72, v73
    s_waitcnt lgkmcnt(0)
    v_cmp_eq_u32 vcc, s84, v12
    s_cbranch_vccnz WJK_90
W_91:
    s_sleep 1
    ds_read_b32 v12, v4 offset:100
    s_sub_u32 s39, s39, 1
    s_cbranch_scc1 KS_ABORT
    s_waitcnt lgkmcnt(0)
    v_cmp_ne_u32 vcc, s84, v12
    s_cbranch_vccnz W_91
WJK_90:
    v_add_u32 v11, 73344, v11
    ds_write_b128 v11, v[80:83] offset:0
    v_pk_add_f16 v87, v46, v74
    v_pk_add_f16 v88, v47, v75
    v_pk_add_f16 v89, v48, v76
    v_pk_add_f16 v90, v49, v77
    v_pk_add_f16 v91, v50, v78
    ds_write_b128 v11, v[88:91] offset:3104
    v_pk_add_f16 v84, v70, v62
    v_pk_add_f16 v85, v71, v63
    v_pk_add_f16 v86, v72, v64
    v_pk_add_f16 v92, v74, v83
    v_pk_add_f16 v93, v75, v84
    v_pk_add_f16 v94, v76, v85
    v_pk_add_f16 v95, v77, v86
    ds_write_b128 v11, v[92:95] offset:6176
    v_pk_add_f16 v96, v87, v76
    v_pk_add_f16 v97, v88, v77
    v_pk_add_f16 v98, v89, v78
    v_pk_add_f16 v99, v90, v79
    ds_write_b128 v11, v[96:99] offset:8240
    ds_write_b8 v116, v5 offset:108
    s_branch WJE_82
WJ1_83:
    ds_read_b32 v12, v4 offset:68
    s_waitcnt lgkmcnt(7)
    v_alignbit_b32 v57, v22, v21, 16
    v_alignbit_b32 v58, v23, v22, 16
    v_alignbit_b32 v59, v24, v23, 16
    v_alignbit_b32 v60, v25, v24, 16
    v_alignbit_b32 v61, v26, v25, 16
    v_alignbit_b32 v62, v27, v26, 16
    v_alignbit_b32 v63, v28, v27, 16
    v_pk_add_f16 v66, v57, v22
    v_pk_add_f16 v67, v58, v23
    v_pk_add_f16 v68, v59, v24
    v_pk_add_f16 v69, v60, v25
    v_pk_add_f16 v70, v61, v26
    v_pk_add_f16 v71, v62, v27
    v_pk_add_f16 v72, v63, v28
    v_pk_add_f16 v80, v66, v58
    v_pk_add_f16 v81, v67, v59
    v_pk_add_f16 v82, v68, v60
    v_pk_add_f16 v83, v69, v61
    v_pk_add_f16 v75, v68, v69
    v_pk_add_f16 v76, v69, v70
    v_pk_add_f16 v77, v70, v71
    v_pk_add_f16 v78, v71, v72
    s_waitcnt lgkmcnt(0)
    v_cmp_eq_u32 vcc, s84, v12
    s_cbranch_vccnz WJK_92
W_93:
    s_sleep 1
    ds_read_b32 v12, v4 offset:68
    s_sub_u32 s39, s39, 1
    s_cbranch_scc1 KS_ABORT
    s_waitcnt lgkmcnt(0)
    v_cmp_ne_u32 vcc, s84, v12
    s_cbranch_vccnz W_93
WJK_92:
    ds_write_b128 v11, v[80:83] offset:0
    v_pk_add_f16 v88, v23, v75
    v_pk_add_f16 v89, v24, v76
    v_pk_add_f16 v90, v25, v77
    v_pk_add_f16 v91, v26, v78
    ds_write_b128 v11, v[88:91] offset:3104
    ds_write_b8 v116, v5 offset:76
    ds_read_b32 v12, v4 offset:84
    v_alignbit_b32 v57, v34, v33, 16
    v_alignbit_b32 v58, v35, v34, 16
    v_alignbit_b32 v59, v36, v35, 16
    v_alignbit_b32 v60, v37, v36, 16
    v_alignbit_b32 v61, v38, v37, 16
    v_alignbit_b32 v62, v39, v38, 16
    v_alignbit_b32 v63, v40, v39, 16
    v_pk_add_f16 v66, v57, v34
    v_pk_add_f16 v67, v58, v35
    v_pk_add_f16 v68, v59, v36
    v_pk_add_f16 v69, v60, v37
    v_pk_add_f16 v70, v61, v38
    v_pk_add_f16 v71, v62, v39
    v_pk_add_f16 v72, v63, v40
    v_pk_add_f16 v80, v66, v58
    v_pk_add_f16 v81, v67, v59
    v_pk_add_f16 v82, v68, v60
    v_pk_add_f16 v83, v69, v61
    v_pk_add_f16 v75, v68, v69
    v_pk_add_f16 v76, v69, v70
    v_pk_add_f16 v77, v70, v71
    v_pk_add_f16 v78, v71, v72
    s_waitcnt lgkmcnt(0)
    v_cmp_eq_u32 vcc, s84, v12
    s_cbranch_vccnz WJK_94
W_95:
    s_sleep 1
    ds_read_b32 v12, v4 offset:84
    s_sub_u32 s39, s39, 1
    s_cbranch_scc1 KS_ABORT
    s_waitcnt lgkmcnt(0)
    v_cmp_ne_u32 vcc, s84, v12
    s_cbranch_vccnz W_95
WJK_94:
    ds_write_b128 v11, v[80:83] offset:36672
    v_pk_add_f16 v88, v35, v75
    v_pk_add_f16 v89, v36, v76
    v_pk_add_f16 v90, v37, v77
    v_pk_add_f16 v91, v38, v78
    ds_write_b128 v11, v[88:91] offset:39776
    ds_write_b8 v116, v5 offset:92
    s_cmp_lt_u32 s41, 24
    s_cbranch_scc1 WJE_82
    ds_read_b32 v12, v4 offset:100
    v_alignbit_b32 v57, v46, v45, 16
    v_alignbit_b32 v58, v47, v46, 16
    v_alignbit_b32 v59, v48, v47, 16
    v_alignbit_b32 v60, v49, v48, 16
    v_alignbit_b32 v61, v50, v49, 16
    v_alignbit_b32 v62, v51, v50, 16
    v_alignbit_b32 v63, v52, v51, 16
    v_pk_add_f16 v66, v57, v46
    v_pk_add_f16 v67, v58, v47
    v_pk_add_f16 v68, v59, v48
    v_pk_add_f16 v69, v60, v49
    v_pk_add_f16 v70, v61, v50
    v_pk_add_f16 v71, v62, v51
    v_pk_add_f16 v72, v63, v52
    v_pk_add_f16 v80, v66, v58
    v_pk_add_f16 v81, v67, v59
    v_pk_add_f16 v82, v68, v60
    v_pk_add_f16 v83, v69, v61
    v_pk_add_f16 v75, v68, v69
    v_pk_add_f16 v76, v69, v70
    v_pk_add_f16 v77, v70, v71
    v_pk_add_f16 v78, v71, v72
    s_waitcnt lgkmcnt(0)
    v_cmp_eq_u32 vcc, s84, v12
    s_cbranch_vccnz WJK_96
W_97:
    s_sleep 1
    ds_read_b32 v12, v4 offset:100
    s_sub_u32 s39, s39, 1
    s_cbranch_scc1 KS_ABORT
    s_waitcnt lgkmcnt(0)
    v_cmp_ne_u32 vcc, s84, v12
    s_cbranch_vccnz W_97
WJK_96:
    v_add_u32 v11, 73344, v11
    ds_write_b128 v11, v[80:83] offset:0
    v_pk_add_f16 v88, v47, v75
    v_pk_add_f16 v89, v48, v76
    v_pk_add_f16 v90, v49, v77
    v_pk_add_f16 v91, v50, v78
    ds_write_b128 v11, v[88:91] offset:3104
    ds_write_b8 v116, v5 offset:108
    s_branch WJE_82
WJ2_84:
    ds_write_b8 v116, v5 offset:76
    ds_write_b8 v116, v5 offset:92
    ds_write_b8 v116, v5 offset:108
    s_setprio 0
    v_mov_b32_dpp v32, v58 quad_perm:[0,0,0,0] row_mask:0xf bank_mask:0xf
    v_mov_b32_dpp v33, v58 quad_perm:[1,1,1,1] row_mask:0xf bank_mask:0xf
    v_mov_b32_dpp v34, v58 quad_perm:[2,2,2,2] row_mask:0xf bank_mask:0xf
    v_mov_b32_dpp v35, v58 quad_perm:[3,3,3,3] row_mask:0xf bank_mask:0xf
    v_lshlrev_b32 v12, 6, v1
    v_add_u32 v12, 0xb00800, v12
    v_mov_b32 v13, s84
    global_load_dwordx4 v[20:23], v12, s[36:37] offset:-2048 sc1
    global_load_dwordx4 v[24:27], v12, s[36:37] offset:2048 sc1
    s_sub_u32 s94, s41, 18
    s_and_b32 s94, s94, 31
    v_mul_u32_u24 v100, 57, v1
    v_lshrrev_b32 v100, 9, v100
    v_mul_u32_u24 v101, 9, v100
    v_sub_u32 v101, v1, v101
    v_mul_u32_u24 v100, 9216, v100
    v_lshl_add_u32 v100, v101, 7, v100
    s_bitcmp1_b32 s94, 0
    s_cselect_b32 s72, s28, s26
    s_cselect_b32 s73, s29, s27
    s_mov_b32 s74, 0x510000
    s_mov_b32 s75, 0x20000
    s_lshr_b32 s95, s94, 1
    s_mul_i32 s95, s95, 64512
    s_mul_i32 s96, s40, 1152
    s_add_u32 s95, s95, s96
    s_cmp_ge_u32 s94, 14
    s_cselect_b32 s74, 0, s74
W_100:
    s_sleep 1
    ds_read_b32 v102, v4 offset:16
    s_sub_u32 s39, s39, 1
    s_cbranch_scc1 KS_ABORT
    s_waitcnt lgkmcnt(0)
    v_cmp_ne_u32 vcc, s84, v102
    s_cbranch_vccnz W_100
    s_add_u32 s96, s95, 4451328
    buffer_load_dword v102, v100, s[72:75], s96 offen nt
    buffer_load_dword v102, v100, s[72:75], s96 offen sc1
    s_add_u32 s96, s95, 4902912
    buffer_load_dword v102, v100, s[72:75], s96 offen nt
    buffer_load_dword v102, v100, s[72:75], s96 offen sc1
    s_waitcnt vmcnt(4)
    s_branch FPE_99
FP_98:
    s_sleep 2
    global_load_dwordx4 v[20:23], v12, s[36:37] offset:-2048 sc1
    global_load_dwordx4 v[24:27], v12, s[36:37] offset:2048 sc1
    s_sub_u32 s39, s39, 1
    s_cbranch_scc1 KS_ABORT
    s_waitcnt vmcnt(0)
FPE_99:
    v_xor_b32 v20, v32, v20
    v_xor_b32 v21, v33, v21
    v_xor_b32 v22, v34, v22
    v_xor_b32 v23, v35, v23
    v_xor_b32 v24, v32, v24
    v_xor_b32 v25, v33, v25
    v_xor_b32 v26, v34, v26
    v_xor_b32 v27, v35, v27
    v_or3_b32 v20, v20, v21, v22
    v_or3_b32 v23, v23, v24, v25
    v_or3_b32 v20, v20, v26, v27
    v_or_b32 v20, v20, v23
    v_cmp_ne_u32 vcc, 0, v20
    s_cbranch_vccnz FP_98
    ds_write2_b32 v4, v13, v13 offset0:28 offset1:36
    s_branch WJE_82
    s_sub_u32 s94, s41, 18
    s_and_b32 s94, s94, 31
    s_cmp_ge_u32 s94, 14
    s_cbranch_scc1 WJE_82
    v_mul_u32_u24 v100, 57, v1
    v_lshrrev_b32 v100, 9, v100
    v_mul_u32_u24 v101, 9, v100
    v_sub_u32 v101, v1, v101
    v_mul_u32_u24 v100, 9216, v100
    v_lshl_add_u32 v100, v101, 7, v100
W_101:
    s_sleep 1
    ds_read_b32 v12, v4 offset:16
    s_sub_u32 s39, s39, 1
    s_cbranch_scc1 KS_ABORT
    s_waitcnt lgkmcnt(0)
    v_cmp_ne_u32 vcc, s84, v12
    s_cbranch_vccnz W_101
    s_bitcmp1_b32 s94, 0
    s_cselect_b32 s72, s28, s26
    s_cselect_b32 s73, s29, s27
    s_mov_b32 s74, 0x510000
    s_mov_b32 s75, 0x20000
    s_lshr_b32 s95, s94, 1
    s_mul_i32 s95, s95, 64512
    s_mul_i32 s96, s40, 1152
    s_add_u32 s95, s95, s96
    s_add_u32 s96, s95, 4451328
    buffer_load_dword v102, v100, s[72:75], s96 offen nt
    buffer_load_dword v102, v100, s[72:75], s96 offen sc1
    s_add_u32 s96, s95, 4902912
    buffer_load_dword v102, v100, s[72:75], s96 offen nt
    buffer_load_dword v102, v100, s[72:75], s96 offen sc1
KS_PF2D:
WJE_82:
    s_setprio 0
    s_lshr_b32 s92, s90, 6
    s_lshl_b32 s92, s92, 9
    s_bfe_u32 s93, s90, 0x20004
    s_lshl_b32 s93, s93, 6
    s_add_u32 s92, s92, s93
    s_and_b32 s93, s90, 3
    s_lshl_b32 s93, s93, 4
    s_add_u32 s92, s92, s93
    s_and_b32 s93, s90, 12
    s_add_u32 s92, s92, s93
    s_lshr_b32 s93, s38, 1
    s_lshl_b32 s93, s93, 8
    s_add_u32 s92, s92, s93
    s_and_b32 s93, s38, 1
    s_lshl_b32 s93, s93, 1
    s_add_u32 s92, s92, s93
    v_lshrrev_b32 v113, 5, v1
    v_and_b32 v114, 31, v1
    v_add_u32 v112, s92, v113
    v_mul_u32_u24 v115, 1152, v112
    v_lshl_add_u32 v8, v114, 2, v115
    v_lshl_add_u32 v115, v114, 4, v115
    v_lshlrev_b32 v7, 2, v114
    v_lshlrev_b32 v6, 4, v114
    v_bfe_u32 v111, v1, 3, 1
    v_add_u32 v111, s92, v111
    v_mul_u32_u24 v111, 1152, v111
    v_and_b32 v9, 7, v1
    v_lshl_add_u32 v111, v9, 4, v111
    s_mov_b32 s64, s4
    s_mov_b32 s65, s5
    s_mov_b32 s66, 0x240000
    s_mov_b32 s67, 0x20000
    s_mov_b32 s68, s24
    s_mov_b32 s69, s25
    s_mov_b32 s70, 0x480
    s_mov_b32 s71, 0x20000
    buffer_load_dwordx4 v[10:13], v115, s[64:67], 0 offen
    buffer_load_dwordx4 v[14:17], v115, s[64:67], 0 offen offset:512
    buffer_load_dword v18, v8, s[64:67], 0 offen offset:1024
    buffer_load_dwordx4 v[50:53], v6, s[68:71], 0 offen
    buffer_load_dwordx4 v[54:57], v6, s[68:71], 0 offen offset:512
    buffer_load_dword v58, v7, s[68:71], 0 offen offset:1024
KS_L4:
    s_add_u32 s64, s36, 0x600000
    s_addc_u32 s65, s37, 0
    s_mov_b32 s66, 0x240000
    s_mov_b32 s67, 0x20000
    s_mov_b32 s68, s32
    s_mov_b32 s69, s33
    s_mov_b32 s70, 0x240000
    s_mov_b32 s71, 0x20000
    s_mov_b32 s72, s36
    s_mov_b32 s73, s37
    s_mov_b32 s74, 0x240000
    s_mov_b32 s75, 0x20000
    s_add_u32 s76, s36, 0x840000
    s_addc_u32 s77, s37, 0
    s_mov_b32 s78, 0x4000
    s_mov_b32 s79, 0x20000
    s_not_b32 s93, s90
    v_xor_b32 v8, s93, v0
    v_lshrrev_b32 v6, 1, v0
    v_lshlrev_b32 v6, 6, v6
    v_and_b32 v8, 1, v8
    v_lshl_add_u32 v6, v8, 4, v6
    s_lshr_b32 s92, s90, 2
    s_lshl_b32 s92, s92, 15
    s_and_b32 s93, s90, 1
    s_lshl_b32 s93, s93, 14
    s_add_u32 s92, s92, s93
    s_and_b32 s93, s90, 2
    s_lshl_b32 s93, s93, 4
    s_add_u32 s92, s92, s93
    s_lshr_b32 s94, s90, 2
    s_lshl_b32 s94, s94, 12
    s_and_b32 s93, s90, 3
    s_lshl_b32 s93, s93, 4
    s_add_u32 s94, s94, s93
    s_lshl_b32 s93, s38, 10
    s_add_u32 s94, s94, s93
    s_add_u32 s94, s94, 0x200000
    v_lshlrev_b32 v9, 6, v2
    s_lshl_b32 s93, s90, 5
    s_and_b32 s95, s93, 0x1f80
    v_xor_b32 v6, s95, v6
    s_and_b32 s95, s93, 0x380
    v_xor_b32 v9, s95, v9
    s_and_b32 s95, s93, 0xc00
    s_xor_b32 s94, s94, s95
    s_and_b32 s93, s90, 1
    s_lshl_b32 s93, s93, 13
    s_xor_b32 s92, s92, s93
    s_xor_b32 s93, s92, 0x2000
    s_mul_i32 s95, s38, 2304
    s_add_u32 s95, s95, 17088
    v_lshl_add_u32 v117, v114, 5, s95
    v_lshl_add_u32 v110, v114, 3, s95
    s_lshl_b32 s95, s38, 9
    s_add_u32 s95, s95, 26368
    v_lshl_add_u32 v108, v1, 2, s95
    v_lshl_add_u32 v109, v1, 4, s95
    v_lshlrev_b32 v118, 4, v113
    s_movk_i32 s95, 0x3f80
    v_lshlrev_b32 v118, v118, s95
    v_lshlrev_b32 v8, 2, v0
    v_add_u32 v8, 17088, v8
    s_lshl_b32 s95, s38, 6
    s_add_u32 s95, s95, 19136
    v_lshl_add_u32 v119, v2, 2, s95
    s_waitcnt vmcnt(0)
    v_lshlrev_b32 v20, 16, v10
    v_and_b32 v21, 0xffff0000, v10
    v_lshlrev_b32 v22, 16, v11
    v_and_b32 v23, 0xffff0000, v11
    v_lshlrev_b32 v24, 16, v12
    v_and_b32 v25, 0xffff0000, v12
    v_lshlrev_b32 v26, 16, v13
    v_and_b32 v27, 0xffff0000, v13
    v_lshlrev_b32 v28, 16, v14
    v_and_b32 v29, 0xffff0000, v14
    v_lshlrev_b32 v30, 16, v15
    v_and_b32 v31, 0xffff0000, v15
    v_lshlrev_b32 v32, 16, v16
    v_and_b32 v33, 0xffff0000, v16
    v_lshlrev_b32 v34, 16, v17
    v_and_b32 v35, 0xffff0000, v17
    v_lshlrev_b32 v36, 16, v18
    v_and_b32 v37, 0xffff0000, v18
    v_lshlrev_b32 v80, 16, v50
    v_and_b32 v81, 0xffff0000, v50
    v_lshlrev_b32 v82, 16, v51
    v_and_b32 v83, 0xffff0000, v51
    v_lshlrev_b32 v84, 16, v52
    v_and_b32 v85, 0xffff0000, v52
    v_lshlrev_b32 v86, 16, v53
    v_and_b32 v87, 0xffff0000, v53
    v_lshlrev_b32 v88, 16, v54
    v_and_b32 v89, 0xffff0000, v54
    v_lshlrev_b32 v90, 16, v55
    v_and_b32 v91, 0xffff0000, v55
    v_lshlrev_b32 v92, 16, v56
    v_and_b32 v93, 0xffff0000, v56
    v_lshlrev_b32 v94, 16, v57
    v_and_b32 v95, 0xffff0000, v57
    v_lshlrev_b32 v96, 16, v58
    v_and_b32 v97, 0xffff0000, v58
    v_pk_add_f32 v[78:79], v[80:81], v[82:83]
    v_pk_add_f32 v[78:79], v[78:79], v[84:85]
    v_pk_add_f32 v[78:79], v[78:79], v[86:87]
    v_pk_add_f32 v[78:79], v[78:79], v[88:89]
    v_pk_add_f32 v[78:79], v[78:79], v[90:91]
    v_pk_add_f32 v[78:79], v[78:79], v[92:93]
    v_pk_add_f32 v[78:79], v[78:79], v[94:95]
    v_pk_add_f32 v[78:79], v[78:79], v[96:97]
    v_add_f32 v78, v78, v79
    s_nop 1
    v_add_f32_dpp v78, v78, v78 row_ror:8 row_mask:0xf bank_mask:0xf
    s_nop 1
    v_add_f32_dpp v78, v78, v78 row_ror:4 row_mask:0xf bank_mask:0xf
    s_nop 1
    v_add_f32_dpp v78, v78, v78 row_ror:2 row_mask:0xf bank_mask:0xf
    s_nop 1
    v_add_f32_dpp v78, v78, v78 row_ror:1 row_mask:0xf bank_mask:0xf
    v_mov_b32 v79, v78
    s_nop 1
    v_permlane16_swap_b32 v78, v79
    v_add_f32 v78, v78, v79
    v_sub_u32 v98, 0x87ff, v112
    v_lshl_add_u32 v99, v116, 1, v113
    v_lshlrev_b32 v99, 2, v99
    s_lshl_b32 s97, s90, 5
W_102:
    s_sleep 1
    ds_read_b32 v60, v4 offset:52
    s_sub_u32 s39, s39, 1
    s_cbranch_scc1 KS_ABORT
    s_waitcnt lgkmcnt(0)
    v_cmp_ne_u32 vcc, s84, v60
    s_cbranch_vccnz W_102
    s_setprio 3
    s_sub_u32 s95, s41, 8
    s_cmp_ge_u32 s95, 16
    s_cbranch_scc1 KS_ZGC
    s_branch ZPE_104
ZP_103:
    s_sleep 1
ZPE_104:
    buffer_load_dwordx4 v[68:71], v4, s[64:67], s94 offen sc1
    s_sub_u32 s39, s39, 1
    s_cbranch_scc1 KS_ABORT
    s_waitcnt vmcnt(0)
    v_max3_u32 v44, v68, v69, v70
    v_max_u32 v44, v44, v71
    v_cmp_eq_u32 vcc, -1, v44
    s_cbranch_vccnz ZP_103
KS_ZGC:
    s_branch ZPE_106
ZP_105:
    s_sleep 1
ZPE_106:
    buffer_load_dwordx4 v[60:63], v6, s[64:67], s92 offen sc1
    buffer_load_dwordx4 v[64:67], v6, s[64:67], s93 offen sc1
    buffer_load_dwordx4 v[68:71], v9, s[64:67], s94 offen sc1
    s_sub_u32 s39, s39, 1
    s_cbranch_scc1 KS_ABORT
    s_waitcnt vmcnt(2)
    ds_write2st64_b32 v8, v60, v61 offset0:0 offset1:9
    ds_write2st64_b32 v8, v62, v63 offset0:18 offset1:27
    v_max3_u32 v44, v60, v61, v61
    v_max3_u32 v44, v62, v63, v44
    s_waitcnt vmcnt(1)
    ds_write2st64_b32 v8, v64, v65 offset0:4 offset1:13
    ds_write2st64_b32 v8, v66, v67 offset0:22 offset1:31
    v_max3_u32 v44, v64, v65, v44
    v_max3_u32 v44, v66, v67, v44
    s_waitcnt vmcnt(0)
    ds_write2st64_b32 v119, v68, v69 offset0:0 offset1:9
    ds_write2st64_b32 v119, v70, v71 offset0:18 offset1:27
    v_max3_u32 v44, v68, v69, v44
    v_max3_u32 v44, v70, v71, v44
    v_cmp_eq_u32 vcc, -1, v44
    s_cbranch_vccnz ZP_105
    ds_write_b8 v116, v5 offset:20
ZW_107:
    ds_read_b32 v44, v4 offset:20
    ds_read_b128 v[60:63], v117 offset:0
    ds_read_b128 v[64:67], v117 offset:16
    ds_read_b128 v[68:71], v117 offset:1024
    ds_read_b128 v[72:75], v117 offset:1040
    ds_read_b64 v[76:77], v110 offset:2048
    s_sub_u32 s39, s39, 1
    s_cbranch_scc1 KS_ABORT
    s_waitcnt lgkmcnt(5)
    v_cmp_ne_u32 vcc, s84, v44
    s_cbranch_vccnz ZW_107
    s_waitcnt lgkmcnt(4)
    v_dot2c_f32_bf16 v20, v60, v118
    v_dot2c_f32_bf16 v21, v61, v118
    v_dot2c_f32_bf16 v22, v62, v118
    v_dot2c_f32_bf16 v23, v63, v118
    s_waitcnt lgkmcnt(3)
    v_dot2c_f32_bf16 v24, v64, v118
    v_dot2c_f32_bf16 v25, v65, v118
    v_pk_mul_f32 v[42:43], v[20:21], v[20:21]
    v_pk_mul_f32 v[44:45], v[20:21], v[80:81]
    v_dot2c_f32_bf16 v26, v66, v118
    v_dot2c_f32_bf16 v27, v67, v118
    v_pk_fma_f32 v[42:43], v[22:23], v[22:23], v[42:43]
    v_pk_fma_f32 v[44:45], v[22:23], v[82:83], v[44:45]
    v_pk_add_f32 v[40:41], v[22:23], v[20:21]
    s_waitcnt lgkmcnt(2)
    v_dot2c_f32_bf16 v28, v68, v118
    v_dot2c_f32_bf16 v29, v69, v118
    v_pk_fma_f32 v[42:43], v[24:25], v[24:25], v[42:43]
    v_pk_fma_f32 v[44:45], v[24:25], v[84:85], v[44:45]
    v_pk_add_f32 v[40:41], v[24:25], v[40:41]
    v_dot2c_f32_bf16 v30, v70, v118
    v_dot2c_f32_bf16 v31, v71, v118
    v_pk_fma_f32 v[42:43], v[26:27], v[26:27], v[42:43]
    v_pk_fma_f32 v[44:45], v[26:27], v[86:87], v[44:45]
    v_pk_add_f32 v[40:41], v[26:27], v[40:41]
    s_waitcnt lgkmcnt(1)
    v_dot2c_f32_bf16 v32, v72, v118
    v_dot2c_f32_bf16 v33, v73, v118
    v_pk_fma_f32 v[42:43], v[28:29], v[28:29], v[42:43]
    v_pk_fma_f32 v[44:45], v[28:29], v[88:89], v[44:45]
    v_pk_add_f32 v[40:41], v[28:29], v[40:41]
    v_dot2c_f32_bf16 v34, v74, v118
    v_dot2c_f32_bf16 v35, v75, v118
    v_pk_fma_f32 v[42:43], v[30:31], v[30:31], v[42:43]
    v_pk_fma_f32 v[44:45], v[30:31], v[90:91], v[44:45]
    v_pk_add_f32 v[40:41], v[30:31], v[40:41]
    s_waitcnt lgkmcnt(0)
    v_dot2c_f32_bf16 v36, v76, v118
    v_dot2c_f32_bf16 v37, v77, v118
    v_pk_fma_f32 v[42:43], v[32:33], v[32:33], v[42:43]
    v_pk_fma_f32 v[44:45], v[32:33], v[92:93], v[44:45]
    v_pk_add_f32 v[40:41], v[32:33], v[40:41]
    v_pk_fma_f32 v[42:43], v[34:35], v[34:35], v[42:43]
    v_pk_fma_f32 v[44:45], v[34:35], v[94:95], v[44:45]
    v_pk_add_f32 v[40:41], v[34:35], v[40:41]
    v_pk_fma_f32 v[42:43], v[36:37], v[36:37], v[42:43]
    v_pk_fma_f32 v[44:45], v[36:37], v[96:97], v[44:45]
    v_pk_add_f32 v[40:41], v[36:37], v[40:41]
    v_add_f32 v42, v42, v43
    v_add_f32 v44, v44, v45
    v_add_f32 v40, v40, v41
    v_mov_b32 v41, v40
    v_permlane16_swap_b32 v42, v44
    s_nop 0
    v_permlane16_swap_b32 v40, v41
    v_add_f32 v42, v42, v44
    v_add_f32 v40, v40, v41
    s_nop 0
    v_add_f32_dpp v42, v42, v42 row_ror:8 row_mask:0xf bank_mask:0xf
    v_add_f32_dpp v40, v40, v40 row_ror:8 row_mask:0xf bank_mask:0xf
    s_nop 0
    v_add_f32_dpp v42, v42, v42 row_ror:4 row_mask:0xf bank_mask:0xf
    v_add_f32_dpp v40, v40, v40 row_ror:4 row_mask:0xf bank_mask:0xf
    s_nop 0
    v_add_f32_dpp v42, v42, v42 row_ror:2 row_mask:0xf bank_mask:0xf
    v_add_f32_dpp v40, v40, v40 row_ror:2 row_mask:0xf bank_mask:0xf
    s_nop 0
    v_add_f32_dpp v42, v42, v42 row_ror:1 row_mask:0xf bank_mask:0xf
    v_add_f32_dpp v40, v40, v40 row_ror:1 row_mask:0xf bank_mask:0xf
    v_mul_f32 v40, 0x3ae38e39, v40
    v_mov_b32 v44, v42
    v_cvt_pk_bf16_f32 v41, 0, v40
    v_mul_f32 v40, v40, v40
    v_permlane16_swap_b32 v42, v44
    v_mov_b32 v43, 0x3ae38e39
    v_fma_f32 v42, v42, v43, -v40
    v_fma_f32 v44, -v41, v78, v44
    v_max_f32 v42, 0, v42
    v_cvt_pk_bf16_f32 v42, 0, v42
    v_add_f32 v42, 0x3727c5ac, v42
    v_cvt_pk_bf16_f32 v42, 0, v42
    v_sqrt_f32 v42, v42
    s_nop 0
    v_cvt_pk_bf16_f32 v42, 0, v42
    v_rcp_f32 v42, v42
    s_nop 0
    v_mul_f32 v60, v44, v42
    v_cvt_pk_bf16_f32 v60, v60, v60
    v_ashrrev_i32 v61, 31, v60
    v_or_b32 v61, 0x80000000, v61
    s_mov_b32 s95, 0xffff0000
    v_xor_b32 v60, v60, v61
    v_and_or_b32 v60, v60, s95, v98
    v_mov_b32 v61, v60
    s_nop 1
    v_permlane32_swap_b32 v60, v61
    s_mov_b64 exec, 1
    buffer_store_dwordx2 v[60:61], v99, s[76:79], s97 offen sc1
    ds_write_b8 v116, v5 offset:12
    s_mov_b64 exec, -1
    s_setprio 2
    v_cvt_pk_bf16_f32 v20, 0, v20
    v_cvt_pk_bf16_f32 v21, 0, v21
    v_cvt_pk_bf16_f32 v22, 0, v22
    v_cvt_pk_bf16_f32 v23, 0, v23
    v_cvt_pk_bf16_f32 v24, 0, v24
    v_cvt_pk_bf16_f32 v25, 0, v25
    v_cvt_pk_bf16_f32 v26, 0, v26
    v_cvt_pk_bf16_f32 v27, 0, v27
    v_cvt_pk_bf16_f32 v28, 0, v28
    v_cvt_pk_bf16_f32 v29, 0, v29
    v_cvt_pk_bf16_f32 v30, 0, v30
    v_cvt_pk_bf16_f32 v31, 0, v31
    v_cvt_pk_bf16_f32 v32, 0, v32
    v_cvt_pk_bf16_f32 v33, 0, v33
    v_cvt_pk_bf16_f32 v34, 0, v34
    v_cvt_pk_bf16_f32 v35, 0, v35
    v_cvt_pk_bf16_f32 v36, 0, v36
    v_cvt_pk_bf16_f32 v37, 0, v37
    v_pk_add_f32 v[44:45], v[20:21], v[22:23]
    v_pk_add_f32 v[46:47], v[24:25], v[26:27]
    v_pk_add_f32 v[44:45], v[44:45], v[28:29]
    v_pk_add_f32 v[46:47], v[46:47], v[30:31]
    v_pk_add_f32 v[44:45], v[44:45], v[32:33]
    v_pk_add_f32 v[46:47], v[46:47], v[34:35]
    v_pk_add_f32 v[44:45], v[44:45], v[36:37]
    v_pk_add_f32 v[44:45], v[44:45], v[46:47]
    v_add_f32 v44, v44, v45
    s_nop 1
    v_add_f32_dpp v44, v44, v44 row_ror:8 row_mask:0xf bank_mask:0xf
    s_nop 1
    v_add_f32_dpp v44, v44, v44 row_ror:4 row_mask:0xf bank_mask:0xf
    s_nop 1
    v_add_f32_dpp v44, v44, v44 row_ror:2 row_mask:0xf bank_mask:0xf
    s_nop 1
    v_add_f32_dpp v44, v44, v44 row_ror:1 row_mask:0xf bank_mask:0xf
    v_mov_b32 v46, v44
    s_nop 1
    v_permlane16_swap_b32 v44, v46
    v_add_f32 v44, v44, v46
    v_mul_f32 v48, 0x3ae38e39, v44
    v_mov_b32 v49, v48
    v_cvt_pk_bf16_f32 v40, 0, v48
    v_cvt_pk_bf16_f32 v41, 0, v48
    v_pk_add_f32 v[42:43], v[20:21], v[48:49] neg_lo:[0,1] neg_hi:[0,1]
    v_pk_mul_f32 v[44:45], v[42:43], v[42:43]
    v_pk_add_f32 v[42:43], v[22:23], v[48:49] neg_lo:[0,1] neg_hi:[0,1]
    v_pk_mul_f32 v[46:47], v[42:43], v[42:43]
    v_pk_add_f32 v[42:43], v[24:25], v[48:49] neg_lo:[0,1] neg_hi:[0,1]
    v_pk_fma_f32 v[44:45], v[42:43], v[42:43], v[44:45]
    v_pk_add_f32 v[42:43], v[26:27], v[48:49] neg_lo:[0,1] neg_hi:[0,1]
    v_pk_fma_f32 v[46:47], v[42:43], v[42:43], v[46:47]
    v_pk_add_f32 v[42:43], v[28:29], v[48:49] neg_lo:[0,1] neg_hi:[0,1]
    v_pk_fma_f32 v[44:45], v[42:43], v[42:43], v[44:45]
    v_pk_add_f32 v[42:43], v[30:31], v[48:49] neg_lo:[0,1] neg_hi:[0,1]
    v_pk_fma_f32 v[46:47], v[42:43], v[42:43], v[46:47]
    v_pk_add_f32 v[42:43], v[32:33], v[48:49] neg_lo:[0,1] neg_hi:[0,1]
    v_pk_fma_f32 v[44:45], v[42:43], v[42:43], v[44:45]
    v_pk_add_f32 v[42:43], v[34:35], v[48:49] neg_lo:[0,1] neg_hi:[0,1]
    v_pk_fma_f32 v[46:47], v[42:43], v[42:43], v[46:47]
    v_pk_add_f32 v[42:43], v[36:37], v[48:49] neg_lo:[0,1] neg_hi:[0,1]
    v_pk_fma_f32 v[44:45], v[42:43], v[42:43], v[44:45]
    v_pk_add_f32 v[44:45], v[44:45], v[46:47]
    v_add_f32 v44, v44, v45
    s_nop 1
    v_add_f32_dpp v44, v44, v44 row_ror:8 row_mask:0xf bank_mask:0xf
    s_nop 1
    v_add_f32_dpp v44, v44, v44 row_ror:4 row_mask:0xf bank_mask:0xf
    s_nop 1
    v_add_f32_dpp v44, v44, v44 row_ror:2 row_mask:0xf bank_mask:0xf
    s_nop 1
    v_add_f32_dpp v44, v44, v44 row_ror:1 row_mask:0xf bank_mask:0xf
    v_mov_b32 v46, v44
    s_nop 1
    v_permlane16_swap_b32 v44, v46
    v_add_f32 v44, v44, v46
    v_mul_f32 v44, 0x3ae38e39, v44
    v_cvt_pk_bf16_f32 v44, 0, v44
    v_add_f32 v44, 0x3727c5ac, v44
    v_cvt_pk_bf16_f32 v44, 0, v44
    v_sqrt_f32 v44, v44
    s_nop 0
    v_cvt_pk_bf16_f32 v44, 0, v44
    v_rcp_f32 v42, v44
    s_nop 0
    v_mov_b32 v43, v42
    v_pk_add_f32 v[44:45], v[20:21], v[40:41] neg_lo:[0,1] neg_hi:[0,1]
    v_cvt_pk_bf16_f32 v44, 0, v44
    v_cvt_pk_bf16_f32 v45, 0, v45
    v_pk_mul_f32 v[44:45], v[44:45], v[42:43]
    v_cvt_pk_bf16_f32 v10, v44, v45
    v_cvt_pk_bf16_f32 v44, 0, v44
    v_cvt_pk_bf16_f32 v45, 0, v45
    v_pk_add_f32 v[20:21], v[44:45], v[20:21]
    v_pk_add_f32 v[44:45], v[22:23], v[40:41] neg_lo:[0,1] neg_hi:[0,1]
    v_cvt_pk_bf16_f32 v44, 0, v44
    v_cvt_pk_bf16_f32 v45, 0, v45
    v_pk_mul_f32 v[44:45], v[44:45], v[42:43]
    v_cvt_pk_bf16_f32 v11, v44, v45
    v_cvt_pk_bf16_f32 v44, 0, v44
    v_cvt_pk_bf16_f32 v45, 0, v45
    v_pk_add_f32 v[22:23], v[44:45], v[22:23]
    v_pk_add_f32 v[44:45], v[24:25], v[40:41] neg_lo:[0,1] neg_hi:[0,1]
    v_cvt_pk_bf16_f32 v44, 0, v44
    v_cvt_pk_bf16_f32 v45, 0, v45
    v_pk_mul_f32 v[44:45], v[44:45], v[42:43]
    v_cvt_pk_bf16_f32 v12, v44, v45
    v_cvt_pk_bf16_f32 v44, 0, v44
    v_cvt_pk_bf16_f32 v45, 0, v45
    v_pk_add_f32 v[24:25], v[44:45], v[24:25]
    v_pk_add_f32 v[44:45], v[26:27], v[40:41] neg_lo:[0,1] neg_hi:[0,1]
    v_cvt_pk_bf16_f32 v44, 0, v44
    v_cvt_pk_bf16_f32 v45, 0, v45
    v_pk_mul_f32 v[44:45], v[44:45], v[42:43]
    v_cvt_pk_bf16_f32 v13, v44, v45
    v_cvt_pk_bf16_f32 v44, 0, v44
    v_cvt_pk_bf16_f32 v45, 0, v45
    v_pk_add_f32 v[26:27], v[44:45], v[26:27]
    v_pk_add_f32 v[44:45], v[28:29], v[40:41] neg_lo:[0,1] neg_hi:[0,1]
    v_cvt_pk_bf16_f32 v44, 0, v44
    v_cvt_pk_bf16_f32 v45, 0, v45
    v_pk_mul_f32 v[44:45], v[44:45], v[42:43]
    v_cvt_pk_bf16_f32 v14, v44, v45
    v_cvt_pk_bf16_f32 v44, 0, v44
    v_cvt_pk_bf16_f32 v45, 0, v45
    v_pk_add_f32 v[28:29], v[44:45], v[28:29]
    v_pk_add_f32 v[44:45], v[30:31], v[40:41] neg_lo:[0,1] neg_hi:[0,1]
    v_cvt_pk_bf16_f32 v44, 0, v44
    v_cvt_pk_bf16_f32 v45, 0, v45
    v_pk_mul_f32 v[44:45], v[44:45], v[42:43]
    v_cvt_pk_bf16_f32 v15, v44, v45
    v_cvt_pk_bf16_f32 v44, 0, v44
    v_cvt_pk_bf16_f32 v45, 0, v45
    v_pk_add_f32 v[30:31], v[44:45], v[30:31]
    v_pk_add_f32 v[44:45], v[32:33], v[40:41] neg_lo:[0,1] neg_hi:[0,1]
    v_cvt_pk_bf16_f32 v44, 0, v44
    v_cvt_pk_bf16_f32 v45, 0, v45
    v_pk_mul_f32 v[44:45], v[44:45], v[42:43]
    v_cvt_pk_bf16_f32 v16, v44, v45
    v_cvt_pk_bf16_f32 v44, 0, v44
    v_cvt_pk_bf16_f32 v45, 0, v45
    v_pk_add_f32 v[32:33], v[44:45], v[32:33]
    v_pk_add_f32 v[44:45], v[34:35], v[40:41] neg_lo:[0,1] neg_hi:[0,1]
    v_cvt_pk_bf16_f32 v44, 0, v44
    v_cvt_pk_bf16_f32 v45, 0, v45
    v_pk_mul_f32 v[44:45], v[44:45], v[42:43]
    v_cvt_pk_bf16_f32 v17, v44, v45
    v_cvt_pk_bf16_f32 v44, 0, v44
    v_cvt_pk_bf16_f32 v45, 0, v45
    v_pk_add_f32 v[34:35], v[44:45], v[34:35]
    v_pk_add_f32 v[44:45], v[36:37], v[40:41] neg_lo:[0,1] neg_hi:[0,1]
    v_cvt_pk_bf16_f32 v44, 0, v44
    v_cvt_pk_bf16_f32 v45, 0, v45
    v_pk_mul_f32 v[44:45], v[44:45], v[42:43]
    v_cvt_pk_bf16_f32 v18, v44, v45
    v_cvt_pk_bf16_f32 v44, 0, v44
    v_cvt_pk_bf16_f32 v45, 0, v45
    v_pk_add_f32 v[36:37], v[44:45], v[36:37]
    v_cvt_pk_bf16_f32 v58, v36, v37
    ds_write_b32 v108, v18
    ds_write_b32 v108, v58 offset:256
    ds_read_b128 v[64:67], v109
    buffer_store_dwordx4 v[10:13], v115, s[72:75], 0 offen sc1
    buffer_store_dwordx4 v[14:17], v115, s[72:75], 0 offen offset:512 sc1
    v_cvt_pk_bf16_f32 v50, v20, v21
    v_cvt_pk_bf16_f32 v51, v22, v23
    v_cvt_pk_bf16_f32 v52, v24, v25
    v_cvt_pk_bf16_f32 v53, v26, v27
    v_cvt_pk_bf16_f32 v54, v28, v29
    v_cvt_pk_bf16_f32 v55, v30, v31
    v_cvt_pk_bf16_f32 v56, v32, v33
    v_cvt_pk_bf16_f32 v57, v34, v35
    s_mov_b64 exec, 0xffff
    s_waitcnt lgkmcnt(0)
    buffer_store_dwordx4 v[64:67], v111, s[72:75], 0 offen offset:1024 sc1
    s_mov_b64 exec, -1
    s_setprio 0
    s_add_u32 s80, s36, 0x850000
    s_addc_u32 s81, s37, 0
    s_mov_b32 s82, 0x148800
    s_mov_b32 s83, 0x20000
    v_bfe_u32 v16, v1, 2, 2
    v_lshl_add_u32 v16, v3, 3, v16
    v_mul_u32_u24 v16, 1152, v16
    v_and_b32 v17, 3, v1
    v_lshl_add_u32 v16, v17, 3, v16
    s_lshl_b32 s10, s38, 7
    s_add_u32 s11, s10, 109184
    v_add_u32 v16, s11, v16
    v_lshrrev_b32 v18, 2, v1
    v_mul_u32_u24 v18, 9344, v18
    v_lshl_add_u32 v18, v17, 4, v18
    s_mul_i32 s9, s38, 149504
    s_lshl_b32 s11, s89, 6
    s_add_u32 s9, s9, s11
    v_lshl_add_u32 v19, v17, 5, s10
    v_lshl_add_u32 v19, v3, 3, v19
    s_mul_i32 s8, s89, 9344
    s_lshl_b32 s11, s38, 10
    s_add_u32 s8, s8, s11
    s_movk_i32 s10, 0x3f80
    s_mov_b32 s11, 0x3f800000
    v_mov_b32 v28, 0
    v_mov_b32 v29, 0
    v_lshlrev_b32 v17, 4, v1
    s_cmp_ge_u32 s41, 18
    s_cbranch_scc1 KS_LO
W_108:
    s_sleep 2
    ds_read_b32 v20, v4 offset:40
    s_sub_u32 s39, s39, 1
    s_cbranch_scc1 KS_ABORT
    s_waitcnt lgkmcnt(0)
    v_cmp_ne_u32 vcc, s84, v20
    s_cbranch_vccnz W_108
    ds_read_b64_tr_b16 v[80:81], v16 offset:0
    ds_read_b64_tr_b16 v[82:83], v16 offset:4608
    ds_read_b64_tr_b16 v[84:85], v16 offset:32
    ds_read_b64_tr_b16 v[86:87], v16 offset:4640
    ds_read_b64_tr_b16 v[88:89], v16 offset:64
    ds_read_b64_tr_b16 v[90:91], v16 offset:4672
    ds_read_b64_tr_b16 v[92:93], v16 offset:96
    ds_read_b64_tr_b16 v[94:95], v16 offset:4704
    v_and_b32 v16, 7, v2
    v_lshlrev_b32 v16, 6, v16
    v_lshl_add_u32 v16, v3, 4, v16
    s_mul_i32 s92, s89, 9344
    s_add_u32 s92, s92, 0x850000
    s_add_u32 s64, s36, s92
    s_addc_u32 s65, s37, 0
    s_cmp_lt_u32 s41, 18
    s_cselect_b32 s66, 9216, 0
    s_mov_b32 s67, 0x20000
    s_mul_i32 s92, s38, 3072
    v_lshlrev_b32 v8, 4, v1
    v_mov_b32 v60, -1
    v_mov_b32 v61, -1
    v_mov_b32 v62, -1
    v_mov_b32 v63, -1
    buffer_store_dwordx4 v[60:63], v8, s[64:67], s92 offen offset:0 sc1
    buffer_store_dwordx4 v[60:63], v8, s[64:67], s92 offen offset:1024 sc1
    buffer_store_dwordx4 v[60:63], v8, s[64:67], s92 offen offset:2048 sc1
    s_waitcnt vmcnt(0)
    s_mov_b64 exec, 1
    ds_add_rtn_u32 v62, v4, v5 offset:196
    s_lshl_b32 s92, s2, 4
    s_add_u32 s92, s92, 8192
    s_waitcnt lgkmcnt(0)
    v_cmp_eq_u32 vcc, 3, v62
    s_and_b64 exec, exec, vcc
    s_cbranch_execz NOF_109
    buffer_store_dword v5, v4, s[76:79], s92 offen sc1
NOF_109:
    s_mov_b64 exec, -1
    s_sleep 16
    s_branch KS_LO2
KS_LO:
    s_sleep 8
    s_waitcnt vmcnt(0)
    s_mov_b64 exec, 1
    ds_add_rtn_u32 v62, v4, v5 offset:196
    s_lshl_b32 s92, s2, 4
    s_add_u32 s92, s92, 8192
    s_waitcnt lgkmcnt(0)
    v_cmp_eq_u32 vcc, 3, v62
    s_and_b64 exec, exec, vcc
    s_cbranch_execz NOF_110
    buffer_store_dword v5, v4, s[76:79], s92 offen sc1
NOF_110:
    s_mov_b64 exec, -1
    s_sleep 24
KS_LO2:
    s_mov_b64 exec, 0xffff0000
    buffer_store_dwordx4 v[64:67], v111, s[68:71], 0 offen offset:1024 sc1
    s_mov_b64 exec, -1
    buffer_store_dwordx4 v[50:53], v115, s[68:71], 0 offen sc1
    buffer_store_dwordx4 v[54:57], v115, s[68:71], 0 offen offset:512 sc1
    s_setprio 2
    s_waitcnt vmcnt(0)
    s_mov_b64 exec, 1
    ds_add_rtn_u32 v62, v4, v5 offset:176
    s_lshl_b32 s92, s2, 4
    s_add_u32 s92, s92, 12288
    s_waitcnt lgkmcnt(0)
    v_cmp_eq_u32 vcc, 3, v62
    s_and_b64 exec, exec, vcc
    s_cbranch_execz NOF_111
    buffer_store_dword v5, v4, s[76:79], s92 offen sc1
NOF_111:
    s_mov_b64 exec, -1
    s_cmp_lt_u32 s41, 18
    s_cbranch_scc1 KS_B
    s_waitcnt lgkmcnt(0)
    s_endpgm
KS_T:
    s_setprio 0
    s_cmp_ge_u32 s38, 10
    s_cbranch_scc1 KS_PEND
    s_add_u32 s76, s36, 0x840000
    s_addc_u32 s77, s37, 0
    s_mov_b32 s78, 0x4000
    s_mov_b32 s79, 0x20000
    s_cmp_eq_u32 s38, 9
    s_cbranch_scc1 KS_W9
    s_add_u32 s80, s36, 0x850000
    s_addc_u32 s81, s37, 0
    s_mov_b32 s82, 0x148800
    s_mov_b32 s83, 0x20000
    v_bfe_u32 v16, v1, 2, 2
    v_lshl_add_u32 v16, v3, 3, v16
    v_mul_u32_u24 v16, 1152, v16
    v_and_b32 v17, 3, v1
    v_lshl_add_u32 v16, v17, 3, v16
    s_lshl_b32 s10, s38, 7
    s_add_u32 s11, s10, 109184
    v_add_u32 v16, s11, v16
    v_lshrrev_b32 v18, 2, v1
    v_mul_u32_u24 v18, 9344, v18
    v_lshl_add_u32 v18, v17, 4, v18
    s_mul_i32 s9, s38, 149504
    s_lshl_b32 s11, s89, 6
    s_add_u32 s9, s9, s11
    v_lshl_add_u32 v19, v17, 5, s10
    v_lshl_add_u32 v19, v3, 3, v19
    s_mul_i32 s8, s89, 9344
    s_lshl_b32 s11, s38, 10
    s_add_u32 s8, s8, s11
    s_movk_i32 s10, 0x3f80
    s_mov_b32 s11, 0x3f800000
    v_mov_b32 v28, 0
    v_mov_b32 v29, 0
    v_lshlrev_b32 v17, 4, v1
    s_mov_b32 s72, s36
    s_mov_b32 s73, s37
    s_mov_b32 s74, 0x240000
    s_mov_b32 s75, 0x20000
    v_and_b32 v6, 1, v1
    v_and_b32 v7, 1, v3
    v_lshl_add_u32 v6, v7, 1, v6
    v_lshlrev_b32 v6, 2, v6
    ds_read_b32 v8, v6 offset:224
    s_lshl_b32 s92, s38, 11
    s_add_u32 s92, s92, 8896
    v_add_u32 v12, s92, v17
    s_waitcnt lgkmcnt(0)
    v_lshrrev_b32 v9, 3, v8
    v_lshrrev_b32 v10, 6, v8
    v_lshrrev_b32 v11, 9, v8
    s_cmp_eq_u32 s38, 8
    s_cbranch_scc1 KS_L2W
W_112:
    s_sleep 2
    ds_read_b32 v20, v4 offset:40
    s_sub_u32 s39, s39, 1
    s_cbranch_scc1 KS_ABORT
    s_waitcnt lgkmcnt(0)
    v_cmp_ne_u32 vcc, s84, v20
    s_cbranch_vccnz W_112
    ds_read_b64_tr_b16 v[80:81], v16 offset:0
    ds_read_b64_tr_b16 v[82:83], v16 offset:4608
    ds_read_b64_tr_b16 v[84:85], v16 offset:32
    ds_read_b64_tr_b16 v[86:87], v16 offset:4640
    ds_read_b64_tr_b16 v[88:89], v16 offset:64
    ds_read_b64_tr_b16 v[90:91], v16 offset:4672
    ds_read_b64_tr_b16 v[92:93], v16 offset:96
    ds_read_b64_tr_b16 v[94:95], v16 offset:4704
    v_and_b32 v16, 7, v2
    v_lshlrev_b32 v16, 6, v16
    v_lshl_add_u32 v16, v3, 4, v16
W_113:
    s_sleep 2
    ds_read_b32 v20, v4 offset:768
    s_sub_u32 s39, s39, 1
    s_cbranch_scc1 KS_ABORT
    s_waitcnt lgkmcnt(0)
    v_cmp_eq_u32 vcc, 0, v20
    s_cbranch_vccnz W_113
    s_setprio 1
W_114:
    s_sleep 1
    ds_read_b32 v20, v4 offset:32
    s_sub_u32 s39, s39, 1
    s_cbranch_scc1 KS_ABORT
    s_waitcnt lgkmcnt(0)
    v_cmp_eq_u32 vcc, 0, v20
    s_cbranch_vccnz W_114
    ds_read_b128 v[20:23], v12
    ds_read_b128 v[24:27], v12 offset:1024
    s_waitcnt lgkmcnt(1)
    v_xor_b32 v13, v8, v20
    v_bitop3_b32 v13, v13, v9, v21 bitop3:0xf6
    v_bitop3_b32 v13, v13, v10, v22 bitop3:0xf6
    v_bitop3_b32 v13, v13, v11, v23 bitop3:0xf6
    v_and_b32 v13, 0x70007, v13
    s_waitcnt lgkmcnt(0)
    v_xor_b32 v14, v8, v24
    v_bitop3_b32 v14, v14, v9, v25 bitop3:0xf6
    v_bitop3_b32 v14, v14, v10, v26 bitop3:0xf6
    v_bitop3_b32 v14, v14, v11, v27 bitop3:0xf6
    v_and_b32 v14, 0x70007, v14
    v_min_u32 v13, v13, v14
KS_CK:
    v_cmp_eq_u32 vcc, 0, v13
    s_cbranch_vccz KS_B
    ds_write_b32 v4, v5 offset:24
    s_branch KS_B
KS_L2W:
    s_movk_i32 s92, 4096
    s_movk_i32 s96, -1152
    s_mov_b32 s93, 0
    v_mov_b32 v57, 0
    v_and_b32 v41, 1, v1
    v_lshl_add_u32 v41, v3, 1, v41
    v_lshlrev_b32 v41, 4, v41
    v_add_u32 v41, 2358144, v41
    v_lshlrev_b32 v7, 1, v1
    v_and_b32 v7, 28, v7
W_115:
    s_sleep 2
    ds_read_b32 v20, v4 offset:20
    s_sub_u32 s39, s39, 1
    s_cbranch_scc1 KS_ABORT
    s_waitcnt lgkmcnt(0)
    v_cmp_ne_u32 vcc, s84, v20
    s_cbranch_vccnz W_115
    s_setprio 3
W_116:
    s_sleep 1
    ds_read_b32 v20, v4 offset:12
    s_sub_u32 s39, s39, 1
    s_cbranch_scc1 KS_ABORT
    s_waitcnt lgkmcnt(0)
    v_cmp_ne_u32 vcc, s84, v20
    s_cbranch_vccnz W_116
    s_setprio 3
    s_sleep 27
    s_branch KS_Q1
KS_Q0:
    s_sleep 1
KS_Q1:
    buffer_load_dwordx4 v[96:99], v17, s[76:79], 0 offen offset:0 sc1
    buffer_load_dwordx4 v[100:103], v17, s[76:79], 0 offen offset:1024 sc1
    buffer_load_dwordx4 v[104:107], v17, s[76:79], 0 offen offset:2048 sc1
    buffer_load_dwordx4 v[108:111], v17, s[76:79], 0 offen offset:3072 sc1
    buffer_load_dwordx4 v[112:115], v17, s[76:79], s92 offen offset:0 sc1
    buffer_load_dwordx4 v[116:119], v17, s[76:79], s92 offen offset:1024 sc1
    buffer_load_dwordx4 v[120:123], v17, s[76:79], s92 offen offset:2048 sc1
    buffer_load_dwordx4 v[124:127], v17, s[76:79], s92 offen offset:3072 sc1
    s_sub_u32 s39, s39, 1
    s_cbranch_scc1 KS_ABORT
    s_waitcnt vmcnt(7)
    v_max_u32 v42, v96, v97
    v_max_u32 v44, v98, v99
    v_min_u32 v43, v96, v97
    v_min_u32 v45, v98, v99
    s_waitcnt vmcnt(6)
    v_med3_u32 v46, v42, v100, v101
    v_med3_u32 v47, v44, v102, v103
    v_max3_u32 v42, v42, v100, v101
    v_max3_u32 v44, v44, v102, v103
    v_max_u32 v43, v43, v46
    v_max_u32 v45, v45, v47
    s_waitcnt vmcnt(5)
    v_med3_u32 v46, v42, v104, v105
    v_med3_u32 v47, v44, v106, v107
    v_max3_u32 v42, v42, v104, v105
    v_max3_u32 v44, v44, v106, v107
    v_max_u32 v43, v43, v46
    v_max_u32 v45, v45, v47
    s_waitcnt vmcnt(4)
    v_med3_u32 v46, v42, v108, v109
    v_med3_u32 v47, v44, v110, v111
    v_max3_u32 v42, v42, v108, v109
    v_max3_u32 v44, v44, v110, v111
    v_max_u32 v43, v43, v46
    v_max_u32 v45, v45, v47
    s_waitcnt vmcnt(3)
    v_med3_u32 v46, v42, v112, v113
    v_med3_u32 v47, v44, v114, v115
    v_max3_u32 v42, v42, v112, v113
    v_max3_u32 v44, v44, v114, v115
    v_max_u32 v43, v43, v46
    v_max_u32 v45, v45, v47
    s_waitcnt vmcnt(2)
    v_med3_u32 v46, v42, v116, v117
    v_med3_u32 v47, v44, v118, v119
    v_max3_u32 v42, v42, v116, v117
    v_max3_u32 v44, v44, v118, v119
    v_max_u32 v43, v43, v46
    v_max_u32 v45, v45, v47
    s_waitcnt vmcnt(1)
    v_med3_u32 v46, v42, v120, v121
    v_med3_u32 v47, v44, v122, v123
    v_max3_u32 v42, v42, v120, v121
    v_max3_u32 v44, v44, v122, v123
    v_max_u32 v43, v43, v46
    v_max_u32 v45, v45, v47
    v_max_u32 v43, v43, v45
    s_waitcnt vmcnt(0)
    v_med3_u32 v46, v42, v124, v125
    v_med3_u32 v47, v44, v126, v127
    v_max3_u32 v42, v42, v124, v125
    v_max3_u32 v44, v44, v126, v127
    v_max3_u32 v43, v43, v46, v47
    v_max_u32 v48, v42, v44
    v_med3_u32 v49, v42, v44, v43
    v_cmp_eq_u32 vcc, -1, v48
    v_mov_b32 v56, v49
KS_QN:
    v_max_u32_dpp v50, v49, v48 row_half_mirror row_mask:0xf bank_mask:0x5
    v_max_u32_dpp v51, v48, v49 row_half_mirror row_mask:0xf bank_mask:0x5
    v_min_u32_dpp v50, v49, v48 row_half_mirror row_mask:0xf bank_mask:0xa
    v_min_u32_dpp v51, v48, v49 row_half_mirror row_mask:0xf bank_mask:0xa
    s_cbranch_vccnz KS_Q0
    s_cmp_eq_u32 s93, 1
    s_mov_b32 m0, 17088
    v_min_u32 v53, v50, v51
    v_max_u32 v52, v50, v51
    s_nop 1
    v_max_u32_dpp v50, v53, v52 row_mirror row_mask:0xf bank_mask:0x3
    v_max_u32_dpp v51, v52, v53 row_mirror row_mask:0xf bank_mask:0x3
    v_min_u32_dpp v50, v53, v52 row_mirror row_mask:0xf bank_mask:0xc
    v_min_u32_dpp v51, v52, v53 row_mirror row_mask:0xf bank_mask:0xc
    s_nop 0
    v_max_u32_dpp v52, v50, v50 row_half_mirror row_mask:0xf bank_mask:0x5
    v_max_u32_dpp v53, v51, v51 row_half_mirror row_mask:0xf bank_mask:0x5
    v_min_u32_dpp v52, v50, v50 row_half_mirror row_mask:0xf bank_mask:0xa
    v_min_u32_dpp v53, v51, v51 row_half_mirror row_mask:0xf bank_mask:0xa
    v_max_u32 v48, v52, v53
    v_max_u32 v54, v52, v53
    v_min_u32 v49, v52, v53
    v_min_u32 v55, v52, v53
    v_permlane32_swap_b32 v48, v54
    s_nop 0
    v_permlane32_swap_b32 v49, v55
    s_nop 1
    v_max_u32_dpp v51, v54, v49 row_mirror row_mask:0xf bank_mask:0xf
    v_max_u32_dpp v50, v55, v48 row_mirror row_mask:0xf bank_mask:0xf
    s_nop 1
    v_max_u32_dpp v52, v50, v50 row_ror:8 row_mask:0xf bank_mask:0x3
    v_max_u32_dpp v53, v51, v51 row_ror:8 row_mask:0xf bank_mask:0x3
    v_min_u32_dpp v52, v50, v50 row_ror:8 row_mask:0xf bank_mask:0xc
    v_min_u32_dpp v53, v51, v51 row_ror:8 row_mask:0xf bank_mask:0xc
    s_nop 0
    v_max_u32_dpp v50, v52, v52 row_half_mirror row_mask:0xf bank_mask:0x5
    v_max_u32_dpp v51, v53, v53 row_half_mirror row_mask:0xf bank_mask:0x5
    v_min_u32_dpp v50, v52, v52 row_half_mirror row_mask:0xf bank_mask:0xa
    v_min_u32_dpp v51, v53, v53 row_half_mirror row_mask:0xf bank_mask:0xa
    v_max_u32 v48, v50, v51
    v_max_u32 v54, v50, v51
    v_min_u32 v49, v50, v51
    v_min_u32 v55, v50, v51
    v_permlane16_swap_b32 v48, v54
    s_nop 0
    v_permlane16_swap_b32 v49, v55
    s_nop 1
    v_max_u32_dpp v51, v54, v49 row_mirror row_mask:0xf bank_mask:0xf
    v_max_u32_dpp v50, v55, v48 row_mirror row_mask:0xf bank_mask:0xf
    s_nop 1
    v_max_u32_dpp v52, v50, v50 row_ror:8 row_mask:0xf bank_mask:0x3
    v_max_u32_dpp v53, v51, v51 row_ror:8 row_mask:0xf bank_mask:0x3
    v_min_u32_dpp v52, v50, v50 row_ror:8 row_mask:0xf bank_mask:0xc
    v_min_u32_dpp v53, v51, v51 row_ror:8 row_mask:0xf bank_mask:0xc
    s_nop 0
    v_max_u32_dpp v50, v52, v52 row_half_mirror row_mask:0xf bank_mask:0x5
    v_max_u32_dpp v51, v53, v53 row_half_mirror row_mask:0xf bank_mask:0x5
    v_min_u32_dpp v50, v52, v52 row_half_mirror row_mask:0xf bank_mask:0xa
    v_min_u32_dpp v51, v53, v53 row_half_mirror row_mask:0xf bank_mask:0xa
    v_min_u32 v49, v50, v51
    v_max_u32 v48, v50, v51
    s_nop 0
    v_mov_b32_dpp v55, v49 row_mirror row_mask:0xf bank_mask:0xf
    v_mov_b32_dpp v54, v48 row_mirror row_mask:0xf bank_mask:0xf
    s_nop 0
    v_max_u32_dpp v50, v55, v48 quad_perm:[1,0,3,2] row_mask:0xf bank_mask:0xf
    v_max_u32_dpp v51, v54, v49 quad_perm:[1,0,3,2] row_mask:0xf bank_mask:0xf
    s_nop 0
    v_max_u32_dpp v52, v50, v50 row_ror:8 row_mask:0xf bank_mask:0x3
    v_max_u32_dpp v53, v51, v51 row_ror:8 row_mask:0xf bank_mask:0x3
    v_min_u32_dpp v52, v50, v50 row_ror:8 row_mask:0xf bank_mask:0xc
    v_min_u32_dpp v53, v51, v51 row_ror:8 row_mask:0xf bank_mask:0xc
    s_nop 0
    v_max_u32_dpp v50, v52, v52 row_half_mirror row_mask:0xf bank_mask:0x5
    v_max_u32_dpp v51, v53, v53 row_half_mirror row_mask:0xf bank_mask:0x5
    v_min_u32_dpp v50, v52, v52 row_half_mirror row_mask:0xf bank_mask:0xa
    v_min_u32_dpp v51, v53, v53 row_half_mirror row_mask:0xf bank_mask:0xa
    v_min_u32 v49, v50, v51
    v_max_u32 v48, v50, v51
    s_nop 0
    v_mov_b32_dpp v55, v49 row_mirror row_mask:0xf bank_mask:0xf
    s_nop 1
    v_max_u32_dpp v59, v55, v48 quad_perm:[2,3,0,1] row_mask:0xf bank_mask:0xf
    s_cbranch_scc1 KS_QF2
    v_and_b32 v61, 0x7ff, v59
    v_mad_i32_i24 v61, v61, s96, v41
    buffer_load_dwordx4 v61, s[72:75], 0 offen offset:0 sc1 lds
    s_mov_b32 m0, 17984
    s_nop 0
    buffer_load_dwordx4 v61, s[72:75], 0 offen offset:128 sc1 lds
    s_mov_b32 m0, 18880
    s_nop 0
    buffer_load_dwordx4 v61, s[72:75], 0 offen offset:256 sc1 lds
    s_mov_b32 m0, 19776
    s_nop 0
    buffer_load_dwordx4 v61, s[72:75], 0 offen offset:384 sc1 lds
    s_mov_b32 m0, 20672
    s_nop 0
    buffer_load_dwordx4 v61, s[72:75], 0 offen offset:512 sc1 lds
    s_mov_b32 m0, 21568
    s_nop 0
    buffer_load_dwordx4 v61, s[72:75], 0 offen offset:640 sc1 lds
    s_mov_b32 m0, 22464
    s_nop 0
    buffer_load_dwordx4 v61, s[72:75], 0 offen offset:768 sc1 lds
    s_mov_b32 m0, 23360
    s_nop 0
    buffer_load_dwordx4 v61, s[72:75], 0 offen offset:896 sc1 lds
    s_mov_b32 m0, 24256
    s_nop 0
    buffer_load_dwordx4 v61, s[72:75], 0 offen offset:1024 sc1 lds
    v_sub_u32 v96, v96, v56
    v_min_u32_dpp v60, v59, v59 quad_perm:[2,3,0,1] row_mask:0xf bank_mask:0xf
    v_sub_u32 v97, v97, v56
    v_sub_u32 v98, v98, v56
    v_max3_u32 v47, v96, v97, v98
    v_sub_u32 v99, v99, v56
    v_sub_u32 v100, v100, v56
    v_min_u32_dpp v60, v60, v60 row_half_mirror row_mask:0xf bank_mask:0xf
    v_max3_u32 v47, v47, v99, v100
    v_sub_u32 v101, v101, v56
    v_sub_u32 v102, v102, v56
    v_max3_u32 v47, v47, v101, v102
    v_sub_u32 v103, v103, v56
    v_sub_u32 v104, v104, v56
    v_min_u32_dpp v60, v60, v60 row_ror:8 row_mask:0xf bank_mask:0xf
    v_max3_u32 v47, v47, v103, v104
    v_sub_u32 v105, v105, v56
    v_sub_u32 v106, v106, v56
    v_max3_u32 v47, v47, v105, v106
    v_sub_u32 v107, v107, v56
    v_sub_u32 v108, v108, v56
    v_max3_u32 v47, v47, v107, v108
    v_sub_u32 v109, v109, v56
    v_sub_u32 v110, v110, v56
    v_max3_u32 v47, v47, v109, v110
    v_sub_u32 v111, v111, v56
    v_sub_u32 v112, v112, v56
    v_max3_u32 v47, v47, v111, v112
    v_sub_u32 v113, v113, v56
    v_sub_u32 v114, v114, v56
    v_max3_u32 v47, v47, v113, v114
    v_sub_u32 v115, v115, v56
    v_sub_u32 v116, v116, v56
    v_max3_u32 v47, v47, v115, v116
    v_sub_u32 v117, v117, v56
    v_sub_u32 v118, v118, v56
    v_max3_u32 v47, v47, v117, v118
    v_sub_u32 v119, v119, v56
    v_sub_u32 v120, v120, v56
    v_max3_u32 v47, v47, v119, v120
    v_sub_u32 v121, v121, v56
    v_sub_u32 v122, v122, v56
    v_max3_u32 v47, v47, v121, v122
    v_sub_u32 v123, v123, v56
    v_sub_u32 v124, v124, v56
    v_max3_u32 v47, v47, v123, v124
    v_sub_u32 v125, v125, v56
    v_sub_u32 v126, v126, v56
    v_max3_u32 v47, v47, v125, v126
    v_sub_u32 v127, v127, v56
    v_add_u32 v57, v57, v56
    v_max_u32 v47, v47, v127
    v_add_u32 v47, v47, v57
    v_cmp_gt_u32 vcc, v47, v60
    s_cbranch_vccnz KS_QF1
    ds_write_b32 v7, v59 offset:768
W_117:
    s_sleep 2
    ds_read_b32 v20, v4 offset:40
    s_sub_u32 s39, s39, 1
    s_cbranch_scc1 KS_ABORT
    s_waitcnt lgkmcnt(0)
    v_cmp_ne_u32 vcc, s84, v20
    s_cbranch_vccnz W_117
    ds_read_b64_tr_b16 v[80:81], v16 offset:0
    ds_read_b64_tr_b16 v[82:83], v16 offset:4608
    ds_read_b64_tr_b16 v[84:85], v16 offset:32
    ds_read_b64_tr_b16 v[86:87], v16 offset:4640
    ds_read_b64_tr_b16 v[88:89], v16 offset:64
    ds_read_b64_tr_b16 v[90:91], v16 offset:4672
    ds_read_b64_tr_b16 v[92:93], v16 offset:96
    ds_read_b64_tr_b16 v[94:95], v16 offset:4704
    v_and_b32 v16, 7, v2
    v_lshlrev_b32 v16, 6, v16
    v_lshl_add_u32 v16, v3, 4, v16
    s_waitcnt vmcnt(0)
    ds_write_b32 v4, v5 offset:32
    s_setprio 1
    ds_read_b128 v[20:23], v12
    s_waitcnt lgkmcnt(0)
    v_xor_b32 v13, v8, v20
    v_bitop3_b32 v13, v13, v9, v21 bitop3:0xf6
    v_bitop3_b32 v13, v13, v10, v22 bitop3:0xf6
    v_bitop3_b32 v13, v13, v11, v23 bitop3:0xf6
    v_and_b32 v13, 0x70007, v13
    s_branch KS_CK
KS_QF1:
    s_sub_u32 s39, s39, 1
    s_cbranch_scc1 KS_ABORT
    v_mov_b32 v58, v59
    v_max_u32 v42, v96, v97
    v_max_u32 v44, v98, v99
    v_min_u32 v43, v96, v97
    v_min_u32 v45, v98, v99
    v_med3_u32 v46, v42, v100, v101
    v_med3_u32 v47, v44, v102, v103
    v_max3_u32 v42, v42, v100, v101
    v_max3_u32 v44, v44, v102, v103
    v_max_u32 v43, v43, v46
    v_max_u32 v45, v45, v47
    v_med3_u32 v46, v42, v104, v105
    v_med3_u32 v47, v44, v106, v107
    v_max3_u32 v42, v42, v104, v105
    v_max3_u32 v44, v44, v106, v107
    v_max_u32 v43, v43, v46
    v_max_u32 v45, v45, v47
    v_med3_u32 v46, v42, v108, v109
    v_med3_u32 v47, v44, v110, v111
    v_max3_u32 v42, v42, v108, v109
    v_max3_u32 v44, v44, v110, v111
    v_max_u32 v43, v43, v46
    v_max_u32 v45, v45, v47
    v_med3_u32 v46, v42, v112, v113
    v_med3_u32 v47, v44, v114, v115
    v_max3_u32 v42, v42, v112, v113
    v_max3_u32 v44, v44, v114, v115
    v_max_u32 v43, v43, v46
    v_max_u32 v45, v45, v47
    v_med3_u32 v46, v42, v116, v117
    v_med3_u32 v47, v44, v118, v119
    v_max3_u32 v42, v42, v116, v117
    v_max3_u32 v44, v44, v118, v119
    v_max_u32 v43, v43, v46
    v_max_u32 v45, v45, v47
    v_med3_u32 v46, v42, v120, v121
    v_med3_u32 v47, v44, v122, v123
    v_max3_u32 v42, v42, v120, v121
    v_max3_u32 v44, v44, v122, v123
    v_max_u32 v43, v43, v46
    v_max_u32 v45, v45, v47
    v_max_u32 v43, v43, v45
    v_med3_u32 v46, v42, v124, v125
    v_med3_u32 v47, v44, v126, v127
    v_max3_u32 v42, v42, v124, v125
    v_max3_u32 v44, v44, v126, v127
    v_max3_u32 v43, v43, v46, v47
    v_max_u32 v48, v42, v44
    v_med3_u32 v56, v42, v44, v43
    v_add_u32 v48, v48, v57
    v_add_u32 v49, v56, v57
    s_mov_b32 s93, 1
    s_mov_b64 vcc, 0
    s_nop 2
    s_branch KS_QN
KS_QF2:
    v_mov_b32 v48, 0
    v_mov_b32 v49, 0
    s_mov_b64 exec, 0x5555
    v_max_u32 v48, v59, v58
    v_min_u32 v49, v59, v58
    s_mov_b64 exec, -1
    s_mov_b32 s93, 2
    s_mov_b64 vcc, 0
    s_waitcnt vmcnt(0)
    s_nop 5
    s_branch KS_QN
KS_BR:
    s_mov_b64 exec, -1
    s_cmp_lg_u32 s38, 8
    s_cbranch_scc1 KS_BR1
    s_movk_i32 s92, 0x2000
    s_nop 7
    s_branch ZPE_119
ZP_118:
    s_sleep 2
ZPE_119:
    buffer_load_dword v20, v17, s[76:79], s92 offen offset:0 sc1
    buffer_load_dword v21, v17, s[76:79], s92 offen offset:1024 sc1
    buffer_load_dword v22, v17, s[76:79], s92 offen offset:2048 sc1
    buffer_load_dword v23, v17, s[76:79], s92 offen offset:3072 sc1
    s_sub_u32 s39, s39, 1
    s_cbranch_scc1 KS_ABORT
    s_waitcnt vmcnt(0)
    v_max3_u32 v44, v20, v21, v22
    v_max_u32 v44, v44, v23
    v_cmp_eq_u32 vcc, -1, v44
    s_cbranch_vccnz ZP_118
    s_mov_b32 m0, 17088
    s_nop 0
    buffer_load_dwordx4 v61, s[72:75], 0 offen offset:0 sc1 lds
    s_mov_b32 m0, 17984
    s_nop 0
    buffer_load_dwordx4 v61, s[72:75], 0 offen offset:128 sc1 lds
    s_mov_b32 m0, 18880
    s_nop 0
    buffer_load_dwordx4 v61, s[72:75], 0 offen offset:256 sc1 lds
    s_mov_b32 m0, 19776
    s_nop 0
    buffer_load_dwordx4 v61, s[72:75], 0 offen offset:384 sc1 lds
    s_mov_b32 m0, 20672
    s_nop 0
    buffer_load_dwordx4 v61, s[72:75], 0 offen offset:512 sc1 lds
    s_mov_b32 m0, 21568
    s_nop 0
    buffer_load_dwordx4 v61, s[72:75], 0 offen offset:640 sc1 lds
    s_mov_b32 m0, 22464
    s_nop 0
    buffer_load_dwordx4 v61, s[72:75], 0 offen offset:768 sc1 lds
    s_mov_b32 m0, 23360
    s_nop 0
    buffer_load_dwordx4 v61, s[72:75], 0 offen offset:896 sc1 lds
    s_mov_b32 m0, 24256
    s_nop 0
    buffer_load_dwordx4 v61, s[72:75], 0 offen offset:1024 sc1 lds
    s_waitcnt vmcnt(0)
    s_barrier
    ds_write_b32 v4, v4 offset:24
    s_branch KS_B
KS_BR1:
    s_barrier
    s_branch KS_B
KS_W9:
    v_lshlrev_b32 v33, 4, v1
    s_movk_i32 s92, 0x2000
    v_and_b32 v7, 7, v1
    v_lshlrev_b32 v7, 2, v7
    s_add_u32 s64, s36, 0x600000
    s_addc_u32 s65, s37, 0
    s_mov_b32 s66, 0x240000
    s_mov_b32 s67, 0x20000
    s_mov_b32 s68, s4
    s_mov_b32 s69, s5
    s_mov_b32 s70, 0x240000
    s_mov_b32 s71, 0x20000
    v_bfe_u32 v43, v1, 3, 2
    s_lshl_b32 s93, s89, 2
    v_add_u32 v43, s93, v43
    v_bfe_u32 v40, v43, 4, 1
    v_and_b32 v41, 3, v1
    v_lshl_add_u32 v40, v40, 2, v41
    v_lshlrev_b32 v40, 2, v40
    v_and_b32 v41, 0x3cf, v43
    v_bfe_u32 v42, v43, 5, 1
    v_lshl_add_u32 v41, v42, 4, v41
    v_bfe_u32 v42, v1, 2, 1
    v_lshl_add_u32 v41, v42, 5, v41
    v_lshrrev_b32 v42, 4, v41
    v_lshlrev_b32 v42, 8, v42
    v_lshl_add_u32 v42, v40, 3, v42
    v_and_b32 v43, 15, v41
    v_lshl_add_u32 v42, v43, 1, v42
W_120:
    s_sleep 1
    ds_read_b32 v12, v7 offset:768
    s_sub_u32 s39, s39, 1
    s_cbranch_scc1 KS_ABORT
    s_waitcnt lgkmcnt(0)
    v_cmp_eq_u32 vcc, 0, v12
    s_cbranch_vccnz W_120
    ds_read_b32 v19, v40 offset:768
    s_waitcnt lgkmcnt(0)
    v_and_b32 v14, 0x7ff, v19
    v_sub_u32 v14, 2047, v14
    v_mul_u32_u24 v23, 1152, v14
    v_lshl_add_u32 v23, v41, 1, v23
    buffer_load_ushort v17, v23, s[68:71], 0 offen
    v_lshrrev_b32 v15, 9, v14
    v_bfe_u32 v16, v14, 6, 2
    v_lshl_add_u32 v15, v15, 2, v16
    v_bfe_u32 v16, v14, 2, 2
    v_lshl_add_u32 v15, v15, 2, v16
    v_bfe_u32 v16, v14, 4, 1
    v_bfe_u32 v24, v14, 8, 1
    v_and_b32 v25, 3, v14
    v_lshl_add_u32 v24, v24, 2, v25
    v_lshlrev_b32 v24, 1, v24
    v_bfe_u32 v25, v14, 5, 1
    v_lshl_add_u32 v24, v25, 5, v24
    v_lshl_add_u32 v25, v15, 1, v16
    v_lshl_add_u32 v25, v25, 14, v24
    v_lshrrev_b32 v26, 1, v41
    v_lshl_add_u32 v25, v26, 6, v25
    v_xor_b32 v26, v41, v16
    v_not_b32 v26, v26
    v_and_b32 v26, 1, v26
    v_lshl_add_u32 v25, v26, 4, v25
    v_lshl_add_u32 v26, v15, 12, v24
    v_lshl_add_u32 v26, v16, 4, v26
    v_lshl_add_u32 v26, v41, 6, v26
    v_add_u32 v26, 2064384, v26
    v_lshl_add_u32 v27, v16, 6, v15
    v_lshlrev_b32 v27, 7, v27
    v_xor_b32 v25, v27, v25
    v_and_b32 v27, 0xf80, v27
    v_xor_b32 v26, v27, v26
    v_cmp_gt_u32 vcc, 0x200, v41
    s_nop 1
    v_cndmask_b32 v25, v26, v25, vcc
    buffer_load_ushort v18, v25, s[64:67], 0 offen sc1
    v_ashrrev_i32 v22, 31, v19
    v_not_b32 v22, v22
    v_or_b32 v22, 0x80000000, v22
    v_xor_b32 v22, v19, v22
    v_and_b32 v22, 0xffff0000, v22
    v_mul_f32 v22, 0xbfb8aa3b, v22
    v_exp_f32 v22, v22
    s_nop 0
    v_add_f32 v22, 1.0, v22
    v_rcp_f32 v22, v22
    s_nop 0
    v_cvt_pk_bf16_f32 v22, 0, v22
    s_add_u32 s72, s36, 0xb10000
    s_addc_u32 s73, s37, 0
    s_mov_b32 s74, 0x40
    s_mov_b32 s75, 0x20000
    s_mov_b32 s68, s32
    s_mov_b32 s69, s33
    s_mov_b32 s70, 0x240000
    s_mov_b32 s71, 0x20000
    buffer_load_dword v8, v33, s[76:79], s92 offen offset:0 sc1
    buffer_load_dword v9, v33, s[76:79], s92 offen offset:1024 sc1
    buffer_load_dword v10, v33, s[76:79], s92 offen offset:2048 sc1
    buffer_load_dword v11, v33, s[76:79], s92 offen offset:3072 sc1
    s_cmp_lg_u32 s2, 0
    s_cbranch_scc1 KS_W9B
    buffer_store_dword v12, v7, s[72:75], 0 offen
    s_branch KS_W9B
KS_W9R:
    s_barrier
KS_W9B:
    s_barrier
    ds_read_b32 v13, v4 offset:24
    ds_read_u16 v20, v42 offset:17088
    s_waitcnt lgkmcnt(0)
    v_cmp_ne_u32 vcc, 0, v13
    s_cbranch_vccnz KS_W9R
    s_setprio 2
    s_branch KS_F3B
KS_F3A:
    s_sleep 2
    buffer_load_dword v8, v33, s[76:79], s92 offen offset:0 sc1
    buffer_load_dword v9, v33, s[76:79], s92 offen offset:1024 sc1
    buffer_load_dword v10, v33, s[76:79], s92 offen offset:2048 sc1
    buffer_load_dword v11, v33, s[76:79], s92 offen offset:3072 sc1
KS_F3B:
    s_sub_u32 s39, s39, 1
    s_cbranch_scc1 KS_ABORT
    s_waitcnt vmcnt(0)
    v_max3_u32 v44, v8, v9, v10
    v_max_u32 v44, v44, v11
    v_cmp_eq_u32 vcc, -1, v44
    s_cbranch_vccnz KS_F3A
    ds_write_b32 v4, v5 offset:28
    s_movk_i32 s92, 0x3000
    s_sleep 12
    s_branch ZPE_122
ZP_121:
    s_sleep 2
ZPE_122:
    buffer_load_dword v8, v33, s[76:79], s92 offen offset:0 sc1
    buffer_load_dword v9, v33, s[76:79], s92 offen offset:1024 sc1
    buffer_load_dword v10, v33, s[76:79], s92 offen offset:2048 sc1
    buffer_load_dword v11, v33, s[76:79], s92 offen offset:3072 sc1
    s_sub_u32 s39, s39, 1
    s_cbranch_scc1 KS_ABORT
    s_waitcnt vmcnt(0)
    v_max3_u32 v44, v8, v9, v10
    v_max_u32 v44, v44, v11
    v_cmp_eq_u32 vcc, -1, v44
    s_cbranch_vccnz ZP_121
    v_lshlrev_b32 v17, 16, v17
    v_lshlrev_b32 v18, 16, v18
    v_add_f32 v17, v17, v18
    v_cvt_pk_bf16_f32 v17, v17, v17
    v_and_b32 v21, 0xffff0000, v17
    v_lshlrev_b32 v20, 16, v20
    v_lshlrev_b32 v14, 2, v1
    v_add_u32 v14, 1536, v14
    s_mov_b32 exec_lo, -1
    s_mov_b32 exec_hi, 0
    s_setprio 3
    s_barrier
    ds_read2_b32 v[32:33], v14 offset0:0 offset1:32
    ds_read2_b32 v[34:35], v14 offset0:64 offset1:96
    ds_read2_b32 v[36:37], v14 offset0:128 offset1:160
    ds_read2_b32 v[38:39], v14 offset0:192 offset1:224
    ds_read_b32 v40, v14 offset:1024
    s_waitcnt lgkmcnt(3)
    v_pk_add_f32 v[32:33], v[32:33], v[34:35]
    s_waitcnt lgkmcnt(1)
    v_pk_add_f32 v[36:37], v[36:37], v[38:39]
    v_add_f32 v32, v32, v33
    s_waitcnt lgkmcnt(0)
    v_add_f32 v36, v36, v37
    v_add_f32 v32, v32, v40
    v_add_f32 v8, v32, v36
    v_cvt_pk_bf16_f32 v8, 0, v8
    v_mul_f32 v8, v8, v22
    v_cvt_pk_bf16_f32 v8, 0, v8
    v_add_f32 v8, v8, v20
    v_cvt_pk_bf16_f32 v8, 0, v8
    v_add_f32 v8, v8, v21
    v_cvt_pk_bf16_f32 v8, v8, v8
    buffer_store_short v8, v23, s[68:71], 0 offen
    s_endpgm
KS_B:
    s_setprio 2
    s_waitcnt lgkmcnt(0)
    s_barrier
    ds_read_b128 v[20:23], v16 offset:1024
    ds_read_b32 v30, v4 offset:24
    s_waitcnt lgkmcnt(1)
    v_mfma_f32_16x16x32_bf16 v[32:35], v[20:23], v[80:83], 0
    v_mfma_f32_16x16x32_bf16 v[40:43], v[20:23], v[88:91], 0
    v_mfma_f32_16x16x32_bf16 v[36:39], v[20:23], v[84:87], 0
    v_mfma_f32_16x16x32_bf16 v[44:47], v[20:23], v[92:95], 0
    s_waitcnt lgkmcnt(0)
    v_cmp_ne_u32 vcc, 0, v30
    s_mov_b32 exec_lo, -1
    s_mov_b32 exec_hi, 0
    s_cbranch_vccnz KS_BR
    v_cvt_pk_bf16_f32 v24, v32, v33
    v_cvt_pk_bf16_f32 v25, v34, v35
    v_cvt_pk_bf16_f32 v26, v40, v41
    v_cvt_pk_bf16_f32 v27, v42, v43
    s_mov_b32 exec_lo, 0
    s_mov_b32 exec_hi, -1
    v_cvt_pk_bf16_f32 v24, v36, v37
    v_cvt_pk_bf16_f32 v25, v38, v39
    v_cvt_pk_bf16_f32 v26, v44, v45
    v_cvt_pk_bf16_f32 v27, v46, v47
    s_mov_b64 exec, -1
    v_min_u32 v24, -2, v24
    v_min_u32 v25, -2, v25
    v_min_u32 v26, -2, v26
    v_min_u32 v27, -2, v27
    buffer_store_dwordx4 v[24:27], v17, s[80:83], s8 offen sc1
    s_sleep 13
W_123:
    ds_read_b32 v30, v4 offset:28
    s_sub_u32 s39, s39, 1
    s_cbranch_scc1 KS_ABORT
    s_waitcnt lgkmcnt(0)
    v_cmp_eq_u32 vcc, 0, v30
    s_cbranch_vccnz W_123
    s_branch ZPE_125
ZP_124:
    s_sleep 1
ZPE_125:
    buffer_load_dwordx4 v[32:35], v18, s[80:83], s9 offen sc1
    s_sub_u32 s39, s39, 1
    s_cbranch_scc1 KS_ABORT
    s_waitcnt vmcnt(0)
    v_max3_u32 v44, v32, v33, v34
    v_max_u32 v44, v44, v35
    v_cmp_eq_u32 vcc, -1, v44
    s_cbranch_vccnz ZP_124
    v_permlane32_swap_b32 v32, v34
    v_permlane32_swap_b32 v33, v35
    s_nop 1
    v_permlane16_swap_b32 v32, v33
    v_permlane16_swap_b32 v34, v35
    v_dot2c_f32_bf16 v28, s10, v32
    v_dot2c_f32_bf16 v29, s11, v32
    v_dot2c_f32_bf16 v28, s10, v33
    v_dot2c_f32_bf16 v29, s11, v33
    v_dot2c_f32_bf16 v28, s10, v34
    v_dot2c_f32_bf16 v29, s11, v34
    v_dot2c_f32_bf16 v28, s10, v35
    v_dot2c_f32_bf16 v29, s11, v35
    s_nop 1
    v_add_f32_dpp v28, v28, v28 row_ror:8 row_mask:0xf bank_mask:0xf
    v_add_f32_dpp v29, v29, v29 row_ror:8 row_mask:0xf bank_mask:0xf
    s_nop 0
    v_add_f32_dpp v28, v28, v28 row_ror:4 row_mask:0xf bank_mask:0xf
    v_add_f32_dpp v29, v29, v29 row_ror:4 row_mask:0xf bank_mask:0xf
    s_mov_b32 exec_lo, 0x000f000f
    s_mov_b32 exec_hi, 0x000f000f
    ds_write_b64 v19, v[28:29] offset:1536
    s_waitcnt lgkmcnt(0)
    s_barrier
    s_endpgm
KS_G0:
    ds_write_b8 v15, v5 offset:68
    s_setprio 0
KS_G:
    s_waitcnt vmcnt(0)
KS_GN:
    s_sub_u32 s87, s38, 12
    s_and_b32 s95, s87, 1
    s_cselect_b32 s72, s28, s26
    s_cselect_b32 s73, s29, s27
    s_mov_b32 s74, 0x510000
    s_mov_b32 s75, 0x20000
    v_lshrrev_b32 v6, 3, v1
    v_lshrrev_b32 v7, 5, v1
    v_xor_b32 v6, v6, v7
    v_and_b32 v6, 1, v6
    v_lshl_add_u32 v6, s95, 1, v6
    v_xor_b32 v6, v6, v1
    v_and_b32 v6, 3, v6
    v_lshrrev_b32 v7, 2, v1
    v_mul_u32_u24 v7, 9216, v7
    v_lshl_add_u32 v46, v6, 4, v7
    s_lshl_b32 s96, s89, 6
    v_mov_b32 v6, s87
    s_mul_i32 s97, s95, 36864
    s_add_u32 s97, s97, 35328
    s_mov_b32 s68, s30
    s_mov_b32 s69, s31
    s_mov_b32 s70, 0x510000
    s_mov_b32 s71, 0x20000
    v_lshlrev_b32 v8, 4, v1
    s_mul_i32 s92, s89, 36864
    s_mul_i32 s93, s87, 9216
    s_add_u32 s92, s92, s93
    s_add_u32 s93, s93, 109184
    s_cmp_lt_u32 s41, 8
    s_cselect_b32 s94, 0, 100
    v_mov_b32 v9, s94
W_126:
    s_sleep 2
    ds_read_b32 v10, v9 offset:100
    s_sub_u32 s39, s39, 1
    s_cbranch_scc1 KS_ABORT
    s_waitcnt lgkmcnt(0)
    v_cmp_ne_u32 vcc, s84, v10
    s_cbranch_vccnz W_126
    s_cmp_ge_u32 s41, 8
    s_cselect_b64 vcc, -1, 0
    s_cbranch_scc1 KS_GD1
    s_add_u32 m0, s93, 0
    s_add_u32 s94, s92, 0
    buffer_load_dwordx4 v8, s[68:71], s94 offen offset:0 nt lds
    buffer_load_dwordx4 v8, s[68:71], s94 offen offset:1024 nt lds
    buffer_load_dwordx4 v8, s[68:71], s94 offen offset:2048 nt lds
    buffer_load_dwordx4 v8, s[68:71], s94 offen offset:3072 nt lds
    s_add_u32 m0, s93, 4096
    s_add_u32 s94, s92, 4096
    buffer_load_dwordx4 v8, s[68:71], s94 offen offset:0 nt lds
    buffer_load_dwordx4 v8, s[68:71], s94 offen offset:1024 nt lds
    buffer_load_dwordx4 v8, s[68:71], s94 offen offset:2048 nt lds
    buffer_load_dwordx4 v8, s[68:71], s94 offen offset:3072 nt lds
    s_add_u32 m0, s93, 8192
    s_add_u32 s94, s92, 8192
    buffer_load_dwordx4 v8, s[68:71], s94 offen offset:0 nt lds
KS_GD1:
    s_cmp_ge_u32 s87, 2
    s_cbranch_scc1 KS_GL
    buffer_load_dwordx4 v[48:51], v46, s[72:75], s96 offen nt
    s_sleep 6
    s_add_u32 s96, s96, 147456
    buffer_load_dwordx4 v[52:55], v46, s[72:75], s96 offen nt
    s_sleep 6
    s_add_u32 s96, s96, 147456
    buffer_load_dwordx4 v[56:59], v46, s[72:75], s96 offen nt
    s_sleep 6
    s_add_u32 s96, s96, 147456
    buffer_load_dwordx4 v[60:63], v46, s[72:75], s96 offen nt
    s_sleep 6
    s_add_u32 s96, s96, 147456
    buffer_load_dwordx4 v[64:67], v46, s[72:75], s96 offen nt
    s_sleep 6
    s_add_u32 s96, s96, 147456
    buffer_load_dwordx4 v[68:71], v46, s[72:75], s96 offen nt
    s_sleep 6
    s_add_u32 s96, s96, 147456
    buffer_load_dwordx4 v[72:75], v46, s[72:75], s96 offen nt
    s_sleep 6
    s_add_u32 s96, s96, 147456
    buffer_load_dwordx4 v[76:79], v46, s[72:75], s96 offen nt
    s_sleep 6
    s_add_u32 s96, s96, 147456
    buffer_load_dwordx4 v[80:83], v46, s[72:75], s96 offen nt
    s_sleep 6
    s_add_u32 s96, s96, 147456
    buffer_load_dwordx4 v[84:87], v46, s[72:75], s96 offen nt
    s_sleep 6
    s_add_u32 s96, s96, 147456
    buffer_load_dwordx4 v[88:91], v46, s[72:75], s96 offen nt
    s_sleep 3
    ds_read_u8 v10, v4 offset:131
    s_waitcnt lgkmcnt(0)
    v_cmp_ne_u32 vcc, 0, v10
    s_cbranch_vccnz GA_127
    s_sleep 2
GA_127:
    s_add_u32 s96, s96, 147456
    buffer_load_dwordx4 v[92:95], v46, s[72:75], s96 offen nt
    s_sleep 3
    ds_read_u8 v10, v4 offset:131
    s_waitcnt lgkmcnt(0)
    v_cmp_ne_u32 vcc, 0, v10
    s_cbranch_vccnz GA_128
    s_sleep 2
GA_128:
    s_add_u32 s96, s96, 147456
    buffer_load_dwordx4 v[96:99], v46, s[72:75], s96 offen nt
    s_sleep 3
    ds_read_u8 v10, v4 offset:131
    s_waitcnt lgkmcnt(0)
    v_cmp_ne_u32 vcc, 0, v10
    s_cbranch_vccnz GA_129
    s_sleep 2
GA_129:
    s_add_u32 s96, s96, 147456
    buffer_load_dwordx4 v[100:103], v46, s[72:75], s96 offen nt
    s_sleep 3
    ds_read_u8 v10, v4 offset:131
    s_waitcnt lgkmcnt(0)
    v_cmp_ne_u32 vcc, 0, v10
    s_cbranch_vccnz GA_130
    s_sleep 2
GA_130:
    s_add_u32 s96, s96, 147456
    buffer_load_dwordx4 v[104:107], v46, s[72:75], s96 offen nt
    s_sleep 3
    ds_read_u8 v10, v4 offset:131
    s_waitcnt lgkmcnt(0)
    v_cmp_ne_u32 vcc, 0, v10
    s_cbranch_vccnz GA_131
    s_sleep 2
GA_131:
    s_add_u32 s96, s96, 147456
    buffer_load_dwordx4 v[108:111], v46, s[72:75], s96 offen nt
    s_sleep 3
    ds_read_u8 v10, v4 offset:131
    s_waitcnt lgkmcnt(0)
    v_cmp_ne_u32 vcc, 0, v10
    s_cbranch_vccnz GA_132
    s_sleep 2
GA_132:
    s_add_u32 s96, s96, 147456
    buffer_load_dwordx4 v[112:115], v46, s[72:75], s96 offen nt
    s_sleep 3
    ds_read_u8 v10, v4 offset:131
    s_waitcnt lgkmcnt(0)
    v_cmp_ne_u32 vcc, 0, v10
    s_cbranch_vccnz GA_133
    s_sleep 2
GA_133:
    s_add_u32 s96, s96, 147456
    buffer_load_dwordx4 v[116:119], v46, s[72:75], s96 offen nt
    v_add_u32 v8, s97, v8
    s_waitcnt vmcnt(0)
    ds_write_b8 v6, v5 offset:40
W_134:
    s_sleep 2
    ds_read_b32 v10, v4 offset:52
    s_sub_u32 s39, s39, 1
    s_cbranch_scc1 KS_ABORT
    s_waitcnt lgkmcnt(0)
    v_cmp_ne_u32 vcc, s84, v10
    s_cbranch_vccnz W_134
W_135:
    s_sleep 2
    ds_read_b32 v10, v4 offset:12
    s_sub_u32 s39, s39, 1
    s_cbranch_scc1 KS_ABORT
    s_waitcnt lgkmcnt(0)
    v_cmp_ne_u32 vcc, s84, v10
    s_cbranch_vccnz W_135
    ds_write_b128 v8, v[48:51] offset:0
    ds_write_b128 v8, v[52:55] offset:1024
    ds_write_b128 v8, v[56:59] offset:2048
    ds_write_b128 v8, v[60:63] offset:3072
    ds_write_b128 v8, v[64:67] offset:4096
    ds_write_b128 v8, v[68:71] offset:5120
    ds_write_b128 v8, v[72:75] offset:6144
    ds_write_b128 v8, v[76:79] offset:7168
    ds_write_b128 v8, v[80:83] offset:8192
    ds_write_b128 v8, v[84:87] offset:9216
    ds_write_b128 v8, v[88:91] offset:10240
    ds_write_b128 v8, v[92:95] offset:11264
    ds_write_b128 v8, v[96:99] offset:12288
    ds_write_b128 v8, v[100:103] offset:13312
    ds_write_b128 v8, v[104:107] offset:14336
    ds_write_b128 v8, v[108:111] offset:15360
    ds_write_b128 v8, v[112:115] offset:16384
    ds_write_b128 v8, v[116:119] offset:17408
    s_branch KS_G4
KS_GL:
    s_add_u32 s96, s96, 2654208
    s_add_u32 s97, s97, 18432
    v_add_u32 v8, s97, v8
    s_waitcnt vmcnt(0)
    ds_write_b8 v6, v5 offset:40
W_136:
    s_sleep 2
    ds_read_b32 v10, v4 offset:52
    s_sub_u32 s39, s39, 1
    s_cbranch_scc1 KS_ABORT
    s_waitcnt lgkmcnt(0)
    v_cmp_ne_u32 vcc, s84, v10
    s_cbranch_vccnz W_136
    s_cmp_ge_u32 s41, 8
    s_cbranch_scc1 KS_GLZ
W_137:
    s_sleep 2
    ds_read_b32 v10, v4 offset:20
    s_sub_u32 s39, s39, 1
    s_cbranch_scc1 KS_ABORT
    s_waitcnt lgkmcnt(0)
    v_cmp_ne_u32 vcc, s84, v10
    s_cbranch_vccnz W_137
KS_GLZ:
    s_setprio 1
    s_add_u32 m0, s97, 0
    s_nop 0
    buffer_load_dwordx4 v46, s[72:75], s96 offen offset:0  lds
    s_add_u32 s96, s96, 146432
    buffer_load_dwordx4 v46, s[72:75], s96 offen offset:1024  lds
    s_add_u32 s96, s96, 146432
    buffer_load_dwordx4 v46, s[72:75], s96 offen offset:2048  lds
    s_add_u32 s96, s96, 146432
    buffer_load_dwordx4 v46, s[72:75], s96 offen offset:3072  lds
    s_add_u32 m0, s97, 4096
    s_add_u32 s96, s96, 150528
    buffer_load_dwordx4 v46, s[72:75], s96 offen offset:0  lds
    s_add_u32 s96, s96, 146432
    buffer_load_dwordx4 v46, s[72:75], s96 offen offset:1024  lds
    s_add_u32 s96, s96, 146432
    buffer_load_dwordx4 v46, s[72:75], s96 offen offset:2048  lds
    s_add_u32 s96, s96, 146432
    buffer_load_dwordx4 v46, s[72:75], s96 offen offset:3072  lds
    s_add_u32 m0, s97, 8192
    s_add_u32 s96, s96, 150528
    buffer_load_dwordx4 v46, s[72:75], s96 offen offset:0  lds
    s_add_u32 s96, s96, 146432
    buffer_load_dwordx4 v46, s[72:75], s96 offen offset:1024  lds
    s_add_u32 s96, s96, 146432
    buffer_load_dwordx4 v46, s[72:75], s96 offen offset:2048  lds
    s_add_u32 s96, s96, 146432
    buffer_load_dwordx4 v46, s[72:75], s96 offen offset:3072  lds
    s_add_u32 m0, s97, 12288
    s_add_u32 s96, s96, 150528
    buffer_load_dwordx4 v46, s[72:75], s96 offen offset:0  lds
    s_add_u32 s96, s96, 146432
    buffer_load_dwordx4 v46, s[72:75], s96 offen offset:1024  lds
    s_add_u32 s96, s96, 146432
    buffer_load_dwordx4 v46, s[72:75], s96 offen offset:2048  lds
    s_add_u32 s96, s96, 146432
    buffer_load_dwordx4 v46, s[72:75], s96 offen offset:3072  lds
    s_add_u32 m0, s97, 16384
    s_add_u32 s96, s96, 150528
    buffer_load_dwordx4 v46, s[72:75], s96 offen offset:0  lds
    s_add_u32 s96, s96, 146432
    buffer_load_dwordx4 v46, s[72:75], s96 offen offset:1024  lds
    s_setprio 0
    s_waitcnt vmcnt(0)
KS_G4:
    ds_write_b8 v6, v5 offset:192
    v_lshrrev_b32 v6, 3, v1
    v_xor_b32 v6, v6, v3
    v_and_b32 v6, 1, v6
    v_and_b32 v7, 2, v1
    v_or_b32 v6, v6, v7
    v_xor_b32 v6, s87, v6
    v_mul_u32_u24 v7, 18432, v7
    v_lshl_add_u32 v7, v6, 4, v7
    v_and_b32 v6, 1, v1
    v_lshl_add_u32 v7, v6, 3, v7
    v_bfe_u32 v6, v1, 2, 2
    v_lshl_add_u32 v6, v3, 3, v6
    v_lshl_add_u32 v7, v6, 6, v7
    v_add_u32 v8, 35328, v7
    v_and_b32 v9, 7, v1
    v_lshrrev_b32 v10, 1, v3
    v_and_b32 v11, 1, v3
    v_lshlrev_b32 v6, 5, v9
    v_lshl_add_u32 v6, v10, 8, v6
    v_lshl_add_u32 v6, v11, 4, v6
    v_add_u32 v6, 17088, v6
    s_lshl_b32 s92, s87, 4
    v_lshl_add_u32 v7, v9, 6, s92
    v_lshl_add_u32 v7, v11, 3, v7
    v_lshl_add_u32 v7, v10, 2, v7
    v_bfe_u32 v9, v1, 3, 1
    v_lshl_add_u32 v7, v9, 1, v7
W_138:
    s_sleep 2
    ds_read_b32 v10, v4 offset:192
    s_sub_u32 s39, s39, 1
    s_cbranch_scc1 KS_ABORT
    s_waitcnt lgkmcnt(0)
    v_cmp_ne_u32 vcc, s84, v10
    s_cbranch_vccnz W_138
W_139:
    s_sleep 2
    ds_read_b32 v10, v4 offset:12
    s_sub_u32 s39, s39, 1
    s_cbranch_scc1 KS_ABORT
    s_waitcnt lgkmcnt(0)
    v_cmp_ne_u32 vcc, s84, v10
    s_cbranch_vccnz W_139
    s_sleep 2
    ds_read_b64_tr_b16 v[48:49], v8 offset:0
    ds_read_b64_tr_b16 v[50:51], v8 offset:256
    ds_read_b64_tr_b16 v[52:53], v8 offset:2048
    ds_read_b64_tr_b16 v[54:55], v8 offset:2304
    ds_read_b64_tr_b16 v[56:57], v8 offset:4096
    ds_read_b64_tr_b16 v[58:59], v8 offset:4352
    ds_read_b64_tr_b16 v[60:61], v8 offset:6144
    ds_read_b64_tr_b16 v[62:63], v8 offset:6400
    ds_read_b64_tr_b16 v[64:65], v8 offset:8192
    ds_read_b64_tr_b16 v[66:67], v8 offset:8448
    ds_read_b64_tr_b16 v[68:69], v8 offset:10240
    ds_read_b64_tr_b16 v[70:71], v8 offset:10496
    ds_read_b64_tr_b16 v[72:73], v8 offset:12288
    ds_read_b64_tr_b16 v[74:75], v8 offset:12544
    ds_read_b64_tr_b16 v[76:77], v8 offset:14336
    ds_read_b64_tr_b16 v[78:79], v8 offset:14592
    ds_read_b64_tr_b16 v[80:81], v8 offset:16384
    ds_read_b64_tr_b16 v[82:83], v8 offset:16640
    ds_read_b64_tr_b16 v[84:85], v8 offset:18432
    ds_read_b64_tr_b16 v[86:87], v8 offset:18688
    ds_read_b64_tr_b16 v[88:89], v8 offset:20480
    ds_read_b64_tr_b16 v[90:91], v8 offset:20736
    ds_read_b64_tr_b16 v[92:93], v8 offset:22528
    ds_read_b64_tr_b16 v[94:95], v8 offset:22784
    ds_read_b64_tr_b16 v[96:97], v8 offset:24576
    ds_read_b64_tr_b16 v[98:99], v8 offset:24832
    ds_read_b64_tr_b16 v[100:101], v8 offset:26624
    ds_read_b64_tr_b16 v[102:103], v8 offset:26880
    ds_read_b64_tr_b16 v[104:105], v8 offset:28672
    ds_read_b64_tr_b16 v[106:107], v8 offset:28928
    ds_read_b64_tr_b16 v[108:109], v8 offset:30720
    ds_read_b64_tr_b16 v[110:111], v8 offset:30976
    ds_read_b64_tr_b16 v[112:113], v8 offset:32768
    ds_read_b64_tr_b16 v[114:115], v8 offset:33024
    ds_read_b64_tr_b16 v[116:117], v8 offset:34816
    ds_read_b64_tr_b16 v[118:119], v8 offset:35072
W_140:
    s_sleep 2
    ds_read_b32 v10, v4 offset:768
    s_sub_u32 s39, s39, 1
    s_cbranch_scc1 KS_ABORT
    s_waitcnt lgkmcnt(0)
    v_cmp_eq_u32 vcc, 0, v10
    s_cbranch_vccnz W_140
    s_setprio 3
KS_GC:
    s_mov_b32 exec_lo, 0x00ff00ff
    s_mov_b32 exec_hi, 0x00ff00ff
KS_GW:
    ds_read_b32 v0, v4 offset:32
    ds_read_b128 v[8:11], v6 offset:0
    ds_read_b128 v[12:15], v6 offset:512
    ds_read_b128 v[16:19], v6 offset:1024
    ds_read_b128 v[20:23], v6 offset:1536
    s_sub_u32 s39, s39, 1
    s_cbranch_scc1 KS_ABORT
    s_waitcnt lgkmcnt(4)
    v_cmp_eq_u32 vcc, 0, v0
    s_cbranch_vccnz KS_GW
    s_waitcnt lgkmcnt(3)
    v_mfma_f32_16x16x32_bf16 v[120:123], v[48:51], v[8:11], 0
    ds_read_b128 v[24:27], v6 offset:2048
    ds_read_b128 v[28:31], v6 offset:2560
    s_waitcnt lgkmcnt(4)
    v_mfma_f32_16x16x32_bf16 v[124:127], v[52:55], v[12:15], 0
    ds_read_b128 v[32:35], v6 offset:3072
    ds_read_b128 v[36:39], v6 offset:3584
    s_waitcnt lgkmcnt(5)
    v_mfma_f32_16x16x32_bf16 v[120:123], v[56:59], v[16:19], v[120:123]
    ds_read_b128 v[40:43], v6 offset:4096
    ds_read_b128 v[44:47], v6 offset:4608
    s_waitcnt lgkmcnt(6)
    v_mfma_f32_16x16x32_bf16 v[124:127], v[60:63], v[20:23], v[124:127]
    ds_read_b128 v[8:11], v6 offset:5120
    ds_read_b128 v[12:15], v6 offset:5632
    s_waitcnt lgkmcnt(7)
    v_mfma_f32_16x16x32_bf16 v[120:123], v[64:67], v[24:27], v[120:123]
    ds_read_b128 v[16:19], v6 offset:6144
    ds_read_b128 v[20:23], v6 offset:6656
    s_waitcnt lgkmcnt(8)
    v_mfma_f32_16x16x32_bf16 v[124:127], v[68:71], v[28:31], v[124:127]
    ds_read_b128 v[24:27], v6 offset:7168
    ds_read_b128 v[28:31], v6 offset:7680
    s_waitcnt lgkmcnt(9)
    v_mfma_f32_16x16x32_bf16 v[120:123], v[72:75], v[32:35], v[120:123]
    ds_read_b128 v[32:35], v6 offset:8192
    s_waitcnt lgkmcnt(9)
    v_mfma_f32_16x16x32_bf16 v[124:127], v[76:79], v[36:39], v[124:127]
    ds_read_b128 v[36:39], v6 offset:8704
    s_waitcnt lgkmcnt(9)
    v_mfma_f32_16x16x32_bf16 v[120:123], v[80:83], v[40:43], v[120:123]
    s_waitcnt lgkmcnt(8)
    v_mfma_f32_16x16x32_bf16 v[124:127], v[84:87], v[44:47], v[124:127]
    s_waitcnt lgkmcnt(7)
    v_mfma_f32_16x16x32_bf16 v[120:123], v[88:91], v[8:11], v[120:123]
    s_waitcnt lgkmcnt(6)
    v_mfma_f32_16x16x32_bf16 v[124:127], v[92:95], v[12:15], v[124:127]
    s_waitcnt lgkmcnt(5)
    v_mfma_f32_16x16x32_bf16 v[120:123], v[96:99], v[16:19], v[120:123]
    s_waitcnt lgkmcnt(4)
    v_mfma_f32_16x16x32_bf16 v[124:127], v[100:103], v[20:23], v[124:127]
    s_waitcnt lgkmcnt(3)
    v_mfma_f32_16x16x32_bf16 v[120:123], v[104:107], v[24:27], v[120:123]
    s_waitcnt lgkmcnt(2)
    v_mfma_f32_16x16x32_bf16 v[124:127], v[108:111], v[28:31], v[124:127]
    s_waitcnt lgkmcnt(1)
    v_mfma_f32_16x16x32_bf16 v[120:123], v[112:115], v[32:35], v[120:123]
    s_waitcnt lgkmcnt(0)
    v_mfma_f32_16x16x32_bf16 v[124:127], v[116:119], v[36:39], v[124:127]
    s_mov_b64 exec, -1
    s_nop 6
    v_pk_add_f32 v[120:121], v[120:121], v[124:125]
    v_pk_add_f32 v[122:123], v[122:123], v[126:127]
    s_nop 1
    v_permlane32_swap_b32 v121, v123
    v_permlane32_swap_b32 v120, v122
    s_nop 0
    v_mov_b32_dpp v120, v121 row_shr:8 row_mask:0xf bank_mask:0xc
    v_mov_b32_dpp v122, v123 row_shr:8 row_mask:0xf bank_mask:0xc
    v_cvt_pk_bf16_f32 v120, 0, v120
    v_mul_f32 v121, 0xbfb8aa3b, v120
    v_exp_f32 v121, v121
    v_cvt_pk_bf16_f32 v122, 0, v122
    v_add_f32 v121, 1.0, v121
    v_rcp_f32 v121, v121
    s_nop 0
    v_mul_f32 v121, v120, v121
    v_cvt_pk_bf16_f32 v121, 0, v121
    v_mul_f32 v121, v121, v122
    v_cvt_pk_bf16_f32 v121, v121, v121
    ds_write_b16 v7, v121 offset:1024
    s_waitcnt lgkmcnt(0)
    s_barrier
    s_setprio 0
    ds_read_b32 v0, v4 offset:24
    s_waitcnt lgkmcnt(0)
    v_cmp_eq_u32 vcc, 0, v0
    s_cbranch_vccnz KS_PEND
    s_barrier
    s_branch KS_GC
KS_PEND:
KS_ABORT:
KS_END:
    s_endpgm
.section .rodata,"a"
.p2align 6
.amdhsa_kernel sequential_preLN__ssm_conv_s4__moe_arch_mod__prompt_kernel
  .amdhsa_next_free_vgpr 128
  .amdhsa_next_free_sgpr 100
  .amdhsa_accum_offset 128
  .amdhsa_group_segment_fixed_size 0
  .amdhsa_kernarg_size 136
  .amdhsa_user_sgpr_count 2
  .amdhsa_user_sgpr_kernarg_segment_ptr 1
  .amdhsa_system_sgpr_workgroup_id_x 1
  .amdhsa_float_denorm_mode_32 3
.end_amdhsa_kernel
```
